```python
import torch

def _softmax(x, axis=-1):
    return torch.softmax(x, dim=axis)

def _gelu(x):
    return torch.nn.functional.gelu(x, approximate='tanh')

def _silu(x):
    return torch.nn.functional.silu(x)

def _sigmoid(x):
    return torch.sigmoid(x)

def _layernorm(x, axis=-1, eps=1e-05):
    m = x.mean(dim=axis, keepdim=True)
    v = x.var(dim=axis, keepdim=True, unbiased=False)
    return (x - m) / torch.sqrt(v + eps)

def _scatter_add(tgt, idx, src, axis=0):
    return tgt.clone().index_add_(axis, idx, src)

def _segment_sum(src, seg, n):
    out = torch.zeros((n,) + src.shape[1:], dtype=src.dtype)
    return out.index_add_(0, seg, src)

def _pad(x, pw):
    flat = tuple((v for pair in reversed(pw) for v in pair))
    return torch.nn.functional.pad(x, flat)
kernel_name = 'adaLN_cond__ssm_conv_h3__glu_gated_bilinear__prompt'

def setup_inputs():

    _w = lambda a: (lambda t: t.to(torch.bfloat16) if t.is_floating_point() else t)(torch.as_tensor(a))

    def _A_setup():
        B, S, D = (1, 2048, 640)
        ks = 4
        return {'q': _w((lambda *s: torch.randn(*s, dtype=torch.bfloat16) * 0.05)(B, S, D)), 'k': _w((lambda *s: torch.randn(*s, dtype=torch.bfloat16) * 1.6)(B, S, D)), 'v': _w((lambda *s: torch.randn(*s, dtype=torch.bfloat16) * 1.6)(B, S, D)), 'shift_k': _w((lambda *s: torch.randn(*s, dtype=torch.bfloat16) * 1.6)(D, ks) * 0.5), 'ssm_k': _w((lambda *s: torch.randn(*s, dtype=torch.bfloat16) * 1.6)(D, S) * (1.0 / S ** 0.5)), 'ssm_D': _w((lambda *s: torch.randn(*s, dtype=torch.bfloat16) * 1.6)(D))}
    _A_in = _A_setup()

    def _B_setup():
        B, S, D, F = (1, 2048, 640, 1536)
        return {'x': _w((lambda *s: torch.randn(*s, dtype=torch.bfloat16) * 0.05)(B, S, D)), 'w_gate': _w((lambda *s: torch.randn(*s, dtype=torch.bfloat16) * 3.2)(D, F) * D ** (-0.5)), 'w_up': _w((lambda *s: torch.randn(*s, dtype=torch.bfloat16) * 3.2)(D, F) * D ** (-0.5)), 'w_down': _w((lambda *s: torch.randn(*s, dtype=torch.bfloat16) * 3.2)(F, D) * F ** (-0.5))}
    _B_in = _B_setup()
    return {'A_q': _A_in['q'], 'A_k': _A_in['k'], 'A_v': _A_in['v'], 'A_shift_k': _A_in['shift_k'], 'A_ssm_k': _A_in['ssm_k'], 'A_ssm_D': _A_in['ssm_D'], 'B_x': _B_in['x'], 'B_w_gate': _B_in['w_gate'], 'B_w_up': _B_in['w_up'], 'B_w_down': _B_in['w_down'], 'c': _w((lambda *s: torch.randn(*s, dtype=torch.bfloat16) * 0.2)(1, 640) * 8.0), 'w_mod': _w((lambda *s: torch.randn(*s, dtype=torch.bfloat16) * 0.2)(640, 6 * 640) * 640 ** (-0.5) * 8.0)}

def reference(A_q, A_k, A_v, A_shift_k, A_ssm_k, A_ssm_D, B_x, B_w_gate, B_w_up, B_w_down, c, w_mod):

    def _A_ref(q, k, v, shift_k, ssm_k, ssm_D):
        B, S, D = q.shape
        ks = shift_k.shape[-1]
        k_pad = _pad(k, ((0, 0), (ks - 1, 0), (0, 0)))
        k_shift = torch.zeros_like(k)
        for t in range(ks):
            k_shift = k_shift + k_pad[:, t:t + S, :] * shift_k[:, ks - 1 - t][None, None, :]
        kv = k_shift * v
        L = 2 * S
        kv_pad = _pad(kv, ((0, 0), (0, S), (0, 0)))
        kf_pad = _pad(ssm_k, ((0, 0), (0, S)))
        kv_f = (lambda x, axes=(-2, -1): torch.fft.rfft2(x.float(), dim=axes))(kv_pad[:, None, :, :], axes=(1, 2))
        kf_f = (lambda x, axes=(-2, -1): torch.fft.rfft2(x.float(), dim=axes))(kf_pad[:, None, :], axes=(1, 2))
        kf_f = (lambda x, *d: x.permute(*d))(kf_f, 1, 2, 0)
        y_f = kv_f * kf_f[None, :, :, :]
        y = (lambda x, s, axes=(-2, -1): torch.fft.irfft2(x, s=s, dim=axes).to(torch.bfloat16))(y_f, (1, L), axes=(1, 2))[:, 0, :S, :]
        y = y + kv * ssm_D[None, None, :]
        return q * y

    def _B_ref(x, w_gate, w_up, w_down):
        g = torch.einsum('bsd,df->bsf', x, w_gate)
        u = torch.einsum('bsd,df->bsf', x, w_up)
        h = g * u
        return torch.einsum('bsf,fd->bsd', h, w_down)
    x = A_q
    mod = (_silu(c) @ w_mod).reshape(c.shape[0], 6, 1, -1)
    sa, ca, ga, sb, cb, gb = (mod[:, 0].clone(), mod[:, 1].clone(), mod[:, 2].clone(), mod[:, 3].clone(), mod[:, 4].clone(), mod[:, 5].clone())
    h = _layernorm(x, axis=-1) * (1 + ca) + sa
    x = x + ga * _A_ref(h, A_k, A_v, A_shift_k, A_ssm_k, A_ssm_D)
    h = _layernorm(x, axis=-1) * (1 + cb) + sb
    x = x + gb * _B_ref(h, B_w_gate, B_w_up, B_w_down)
    return x
```

```asm
; @launch grid=(256,1,1) block=(256,1,1) lds=163840
.amdgcn_target "amdgcn-amd-amdhsa--gfx950"
.text
.globl adaLN_cond__ssm_conv_h3__glu_gated_bilinear__prompt_kernel
.p2align 8
.type adaLN_cond__ssm_conv_h3__glu_gated_bilinear__prompt_kernel,@function
adaLN_cond__ssm_conv_h3__glu_gated_bilinear__prompt_kernel:
    s_cmp_ge_u32 s2, 256
    s_cbranch_scc1 L_end
    s_load_dwordx16 s[4:19], s[0:1], 0
    s_load_dwordx8 s[20:27], s[0:1], 64
    s_load_dwordx4 s[28:31], s[0:1], 96
    s_load_dwordx2 s[32:33], s[0:1], 112
    v_lshrrev_b32 v1, 6, v0
    s_nop 0
    v_readfirstlane_b32 s3, v1
    v_and_b32 v1, 63, v0
    s_getpc_b64 s[40:41]
L_pc0:
    s_lshr_b32 s51, s2, 3
    s_mul_i32 s51, s51, 2176
    s_mov_b32 s42, L_code_end-L_pc0
    s_mov_b32 s43, 0x20000
    v_min_u32 v2, 16, v1
    v_lshlrev_b32 v2, 7, v2
    s_cmp_eq_u32 s3, 3
    s_cbranch_scc0 L_pf0
    buffer_load_dword v252, v2, s[40:43], s51 offen
L_pf0:
    s_mov_b32 s49, 400000
    s_and_b32 s50, s2, 7
    s_lshr_b32 s51, s2, 3
    s_lshr_b32 s52, s50, 2
    s_lshl_b32 s52, s52, 3
    s_lshr_b32 s53, s51, 2
    s_add_u32 s72, s52, s53
    s_lshl_b32 s53, s53, 3
    s_mov_b32 s54, 0x6040200
    s_mov_b32 s55, 0x9050108
    s_lshr_b64 s[54:55], s[54:55], s53
    s_and_b32 s34, s54, 255
    s_lshr_b32 s54, s50, 2
    s_mul_i32 s54, s54, 10
    s_add_u32 s34, s34, s54
    s_sub_u32 s54, s34, 20
    s_min_u32 s34, s34, s54
    s_and_b32 s52, s50, 3
    s_lshl_b32 s52, s52, 2
    s_and_b32 s53, s51, 3
    s_add_u32 s73, s52, s53
    s_and_b32 s75, s51, 7
    s_lshr_b32 s53, s51, 3
    s_lshl_b32 s52, s50, 2
    s_add_u32 s74, s52, s53
    s_mul_i32 s70, s50, 20
    s_add_u32 s70, s70, s51
    s_sub_u32 s71, s2, 160
    s_lshl_b32 s52, s50, 1
    s_cmp_ge_u32 s51, 10
    s_addc_u32 s52, s52, 0
    s_cmp_ge_u32 s51, 10
    s_cselect_b32 s53, 10, 0
    s_sub_u32 s53, s51, s53
    s_lshl_b32 s53, s53, 4
    s_add_u32 s76, s52, s53
    s_lshl_b32 s58, s70, 2
    s_add_u32 s58, s58, s3
    v_lshlrev_b32 v248, 4, v1
    s_lshr_b32 s50, s76, 4
    s_and_b32 s51, s76, 15
    s_mul_i32 s52, s51, 163840
    s_lshl_b32 s53, s50, 7
    s_add_u32 s52, s52, s53
    v_lshrrev_b32 v3, 3, v1
    v_mul_u32_u24 v3, 1280, v3
    v_and_b32 v4, 7, v1
    v_lshl_add_u32 v3, v4, 4, v3
    s_mul_i32 s53, s3, 40960
    s_add_u32 s53, s53, s52
    s_mul_i32 s54, s3, 4352
    v_add_u32 v10, 9152, v3
    v_add_u32 v11, 18304, v3
    v_add_u32 v12, 27456, v3
    s_sub_u32 s55, s52, 10240
    v_add_u32 v5, s55, v3
    s_add_u32 s56, s54, 44032
    s_add_u32 m0, s54, 26624
    s_mov_b32 s42, 2621440
    s_mov_b32 s43, 0x20000
    s_mov_b32 s46, 2621440
    s_mov_b32 s47, 0x20000
    s_waitcnt lgkmcnt(0)
    s_cmp_ge_u32 s2, 160
    s_cbranch_scc1 L_prep
    s_mov_b64 s[40:41], s[6:7]
    s_mov_b64 s[44:45], s[8:9]
    buffer_load_dwordx4 v3, s[40:43], s53 offen offset:0 nt lds
    buffer_load_dwordx4 v10, s[40:43], s53 offen offset:1088 nt lds
    buffer_load_dwordx4 v11, s[40:43], s53 offen offset:2176 nt lds
    buffer_load_dwordx4 v12, s[40:43], s53 offen offset:3264 nt lds
    s_mov_b32 m0, s56
    s_cmp_eq_u32 s3, 0
    buffer_load_dwordx4 v3, s[44:47], s53 offen offset:0 nt lds
    buffer_load_dwordx4 v10, s[44:47], s53 offen offset:1088 nt lds
    buffer_load_dwordx4 v11, s[44:47], s53 offen offset:2176 nt lds
    buffer_load_dwordx4 v12, s[44:47], s53 offen offset:3264 nt lds
    s_cbranch_scc0 L_nohalo
    s_mov_b32 m0, 25536
    s_nop 0
    buffer_load_dwordx4 v5, s[40:43], 0 offen nt lds
L_nohalo:
    s_mov_b32 s36, s32
    s_mov_b32 s37, s33
    s_mov_b32 s38, 0x10000000
    s_mov_b32 s39, 0x20000
    v_mov_b32 v2, 0
    s_mov_b32 s57, 23461888
    buffer_load_dword v246, v2, s[36:39], s57 offen sc1
    s_lshr_b32 s55, s3, 1
    s_and_b32 s56, s3, 1
    s_lshl_b32 s51, s51, 7
    s_lshl_b32 s57, s55, 6
    s_add_u32 s51, s51, s57
    s_lshl_b32 s50, s50, 6
    s_lshl_b32 s57, s56, 5
    s_add_u32 s50, s50, s57
    v_lshrrev_b32 v5, 3, v1
    v_lshl_add_u32 v6, v5, 3, s51
    v_lshl_add_u32 v7, v4, 2, s50
    v_lshlrev_b32 v8, 3, v7
    global_load_dwordx4 v[48:51], v8, s[10:11]
    global_load_dwordx4 v[52:55], v8, s[10:11] offset:16
    v_mul_u32_u24 v7, 4096, v7
    v_lshl_add_u32 v245, v6, 1, v7
    v_sub_u32 v6, 2040, v6
    v_lshl_add_u32 v247, v6, 1, v7
    s_mul_i32 s55, s55, 8704
    s_lshl_b32 s56, s56, 6
    s_add_u32 s55, s55, s56
    s_add_u32 s55, s55, 25536
    v_mul_u32_u24 v5, 1088, v5
    v_lshl_add_u32 v5, v4, 3, v5
    v_add_u32 v244, s55, v5
    s_mov_b32 s44, s4
    s_mov_b32 s45, s5
    s_mov_b32 s46, 0x280000
    s_mov_b32 s47, 0x20000
    s_add_u32 m0, s54, 61440
    s_nop 0
    buffer_load_dwordx4 v3, s[44:47], s53 offen nt lds
    s_add_u32 s53, s53, 10240
    s_add_u32 m0, s54, 62528
    s_nop 0
    buffer_load_dwordx4 v3, s[44:47], s53 offen nt lds
    s_add_u32 s53, s53, 10240
    s_add_u32 m0, s54, 63616
    s_nop 0
    buffer_load_dwordx4 v3, s[44:47], s53 offen nt lds
    s_add_u32 s53, s53, 10240
    s_add_u32 m0, s54, 64704
    s_nop 0
    buffer_load_dwordx4 v3, s[44:47], s53 offen nt lds
    v_mov_b32 v243, v3
    s_and_b32 s50, s3, 1
    s_mul_i32 s61, s50, 3104
    s_mul_i32 s50, s50, 12288
    s_mul_i32 s64, s73, 192
    s_add_u32 s64, s64, s50
    s_mul_i32 s50, s34, 98304
    s_add_u32 s64, s64, s50
    s_cmp_ge_u32 s3, 2
    s_cselect_b32 s40, s20, s18
    s_cselect_b32 s41, s21, s19
    s_cselect_b32 s50, 6224, 0
    s_add_u32 s61, s61, s50
    s_mov_b32 s42, 1966080
    s_mov_b32 s43, 0x20000
    v_add_u32 v2, 0, v1
    v_mul_u32_u24 v3, 171, v2
    v_lshrrev_b32 v3, 11, v3
    v_mul_u32_u24 v4, 12, v3
    v_sub_u32 v4, v2, v4
    v_and_b32 v2, 12, v3
    v_add_u32 v3, v3, v2
    v_mul_u32_u24 v3, 3072, v3
    v_lshl_add_u32 v224, v4, 4, v3
    v_add_u32 v2, 64, v1
    v_mul_u32_u24 v3, 171, v2
    v_lshrrev_b32 v3, 11, v3
    v_mul_u32_u24 v4, 12, v3
    v_sub_u32 v4, v2, v4
    v_and_b32 v2, 12, v3
    v_add_u32 v3, v3, v2
    v_mul_u32_u24 v3, 3072, v3
    v_lshl_add_u32 v225, v4, 4, v3
    v_subrev_u32 v225, 1024, v225
    v_add_u32 v2, 128, v1
    v_mul_u32_u24 v3, 171, v2
    v_lshrrev_b32 v3, 11, v3
    v_mul_u32_u24 v4, 12, v3
    v_sub_u32 v4, v2, v4
    v_and_b32 v2, 12, v3
    v_add_u32 v3, v3, v2
    v_mul_u32_u24 v3, 3072, v3
    v_lshl_add_u32 v226, v4, 4, v3
    v_subrev_u32 v226, 2048, v226
    s_mul_i32 s50, s3, 48
    v_lshrrev_b32 v2, 5, v1
    v_bfe_u32 v3, v1, 2, 2
    v_lshl_add_u32 v2, v2, 2, v3
    v_mul_u32_u24 v2, 192, v2
    v_bfe_u32 v3, v1, 4, 1
    v_mul_u32_u24 v3, 3104, v3
    v_add3_u32 v2, v2, v3, s50
    v_and_b32 v3, 3, v1
    v_lshl_add_u32 v227, v3, 3, v2
    v_and_b32 v3, 1, v1
    v_lshl_add_u32 v2, v3, 3, v2
    v_bfe_u32 v3, v1, 1, 1
    v_mul_u32_u24 v3, 6224, v3
    v_add3_u32 v228, v2, v3, 32
    s_mul_i32 s51, s3, 16640
    s_add_u32 s51, s51, 78848
    v_add_u32 v223, s51, v248
    v_lshrrev_b32 v8, 1, v1
    v_mul_u32_u24 v8, 4160, v8
    v_and_b32 v4, 1, v1
    v_lshl_add_u32 v8, v4, 4, v8
    v_add_u32 v8, s51, v8
    v_mov_b32 v4, 0
    v_mov_b32 v5, 0
    v_mov_b32 v6, 0
    v_mov_b32 v7, 0
    s_mov_b64 exec, 0xff
    ds_write_b128 v8, v[4:7]
    s_mul_i32 s52, s3, 4608
    s_add_u32 s52, s52, 149504
    s_mov_b64 exec, 0x3fffffff
    v_add_u32 v8, s52, v248
    ds_write_b128 v8, v[4:7]
    s_mov_b64 exec, -1
    v_and_b32 v2, 15, v1
    v_lshrrev_b32 v8, 4, v1
    v_lshlrev_b32 v249, 6, v2
    v_lshl_add_u32 v249, v8, 4, v249
    v_add_u32 v249, 62464, v249
    v_and_b32 v231, 1, v8
    v_lshlrev_b32 v231, 9, v231
    v_lshl_add_u32 v231, v2, 5, v231
    v_lshrrev_b32 v8, 1, v8
    v_lshl_add_u32 v231, v8, 4, v231
    s_mul_i32 s68, s58, 4096
    s_add_u32 s65, s68, 2883584
    s_add_u32 s68, s68, 0
    s_lshl_b32 s66, s3, 12
    s_add_u32 s67, s66, 23068672
    s_lshl_b32 s59, s58, 1
    v_mov_b32 v250, 0
    v_mov_b32 v251, s59
    global_load_short_d16_hi v250, v251, s[14:15]
    v_min_u32 v240, 11, v1
    v_lshlrev_b32 v240, 7, v240
    s_lshr_b32 s52, s70, 4
    s_lshl_b32 s52, s52, 11
    s_add_u32 s59, s52, 23199744
    s_lshl_b32 s69, s3, 9
    s_sub_u32 s52, s52, s69
    s_add_u32 s52, s52, 153600
    v_cmp_lt_u32 vcc, 7, v1
    v_mov_b32 v241, s52
    s_nop 0
    v_cndmask_b32 v241, 0, v241, vcc
    v_add_u32 v240, v240, v241
    s_lshl_b32 s69, s3, 10
    s_add_u32 s69, s69, 23220224
    s_lshl_b32 s55, s58, 3
    s_add_u32 s55, s55, 23560192
    v_and_b32 v253, 3, v1
    v_cmp_eq_u32 vcc, 3, v253
    s_nop 1
    v_addc_co_u32 v253, vcc, 0, v253, vcc
    v_mul_u32_u24 v253, 5120, v253
    v_min_u32 v241, 9, v1
    v_lshlrev_b32 v241, 7, v241
    s_mov_b32 s60, 23230464
    v_min_u32 v242, 15, v1
    v_lshlrev_b32 v242, 7, v242
    v_and_b32 v2, 15, v1
    v_lshrrev_b32 v8, 4, v1
    v_add_u32 v4, 1, v2
    v_and_b32 v5, 3, v4
    v_sub_u32 v4, v4, v5
    v_add_u32 v4, 24, v4
    v_lshlrev_b32 v4, 1, v4
    v_mul_u32_u24 v5, 4160, v5
    v_add_u32 v4, v4, v5
    v_lshlrev_b32 v5, 4, v8
    v_sub_u32 v4, v4, v5
    s_mul_i32 s51, s3, 16640
    s_add_u32 s51, s51, 78848
    v_add_u32 v229, s51, v4
    v_lshlrev_b32 v2, 5, v2
    v_add_u32 v2, v2, v5
    s_mul_i32 s52, s3, 4608
    s_add_u32 s52, s52, 145936
    v_sub_u32 v230, s52, v2
    v_lshrrev_b32 v2, 3, v1
    v_bfe_u32 v3, v1, 4, 2
    v_lshlrev_b32 v3, 1, v3
    v_xor_b32 v3, v3, v1
    v_and_b32 v3, 7, v3
    v_mul_u32_u24 v2, 4096, v2
    v_lshl_add_u32 v172, v3, 4, v2
    v_add_u32 v172, 0, v172
    v_lshrrev_b32 v2, 2, v1
    v_lshlrev_b32 v2, 7, v2
    v_and_b32 v3, 3, v1
    v_lshl_add_u32 v2, v3, 3, v2
    v_bfe_u32 v3, v1, 3, 2
    v_xor_b32 v168, 0, v3
    v_lshl_add_u32 v168, v168, 5, v2
    v_xor_b32 v169, 1, v3
    v_lshl_add_u32 v169, v169, 5, v2
    v_xor_b32 v170, 2, v3
    v_lshl_add_u32 v170, v170, 5, v2
    v_xor_b32 v171, 3, v3
    v_lshl_add_u32 v171, v171, 5, v2
    v_and_b32 v175, 15, v1
    v_lshlrev_b32 v175, 4, v175
    v_bfe_u32 v2, v1, 4, 1
    v_lshrrev_b32 v3, 5, v1
    v_mul_u32_u24 v173, 49152, v2
    v_lshl_add_u32 v173, v3, 8, v173
    v_add_u32 v173, v173, v175
    v_lshl_add_u32 v2, v2, 1, v3
    v_mul_u32_u24 v174, 49152, v2
    v_add_u32 v174, v174, v175
    v_bfe_u32 v2, v0, 1, 2
    v_lshlrev_b32 v2, 1, v2
    s_lshr_b32 s50, s73, 1
    v_xor_b32 v2, s50, v2
    v_lshlrev_b32 v2, 4, v2
    v_lshl_add_u32 v216, v0, 7, v2
    s_and_b32 s50, s73, 1
    s_lshl_b32 s50, s50, 3
    v_add_u32 v216, s50, v216
    v_add_u32 v217, 0x8000, v216
    v_add_u32 v218, 0x10000, v216
    v_cmp_gt_u32 vcc, 128, v0
    s_nop 1
    v_cndmask_b32 v218, v217, v218, vcc
    v_lshrrev_b32 v2, 1, v1
    v_lshlrev_b32 v2, 10, v2
    v_and_b32 v3, 1, v1
    v_lshl_add_u32 v219, v3, 7, v2
    s_lshl_b32 s50, s3, 8
    s_add_u32 s50, s50, 46080
    v_add_u32 v219, s50, v219
    s_add_u32 s50, s50, 19456
    v_mov_b32 v2, s50
    v_cmp_lt_u32 vcc, 39, v1
    s_nop 1
    v_cndmask_b32 v219, v219, v2, vcc
    v_mov_b32 v3, v243
    s_waitcnt vmcnt(7)
    s_barrier
    ds_read_b64 v[10:11], v244 offset:640
    ds_read_b64 v[12:13], v244 offset:768
    ds_read_b64 v[14:15], v244 offset:896
    ds_read_b64 v[16:17], v244 offset:1088
    ds_read_b64 v[18:19], v244 offset:1216
    ds_read_b64 v[20:21], v244 offset:1344
    ds_read_b64 v[22:23], v244 offset:1472
    ds_read_b64 v[24:25], v244 offset:1600
    ds_read_b64 v[26:27], v244 offset:1728
    ds_read_b64 v[28:29], v244 offset:1856
    ds_read_b64 v[30:31], v244 offset:1984
    ds_read_b64 v[32:33], v244 offset:18496
    ds_read_b64 v[34:35], v244 offset:18624
    ds_read_b64 v[36:37], v244 offset:18752
    ds_read_b64 v[38:39], v244 offset:18880
    ds_read_b64 v[40:41], v244 offset:19008
    ds_read_b64 v[42:43], v244 offset:19136
    ds_read_b64 v[44:45], v244 offset:19264
    ds_read_b64 v[46:47], v244 offset:19392
    s_lshl_b32 s50, s58, 12
    s_mul_i32 s51, s3, 16640
    s_add_u32 m0, s51, 78880
    s_mov_b32 s44, s12
    s_mov_b32 s45, s13
    s_mov_b32 s46, 0x280000
    s_mov_b32 s47, 0x20000
    buffer_load_dwordx4 v248, s[44:47], s50 offen offset:0 nt lds
    buffer_load_dwordx4 v248, s[44:47], s50 offen offset:1024 nt lds
    buffer_load_dwordx4 v248, s[44:47], s50 offen offset:2048 nt lds
    buffer_load_dwordx4 v248, s[44:47], s50 offen offset:3072 nt lds
    s_waitcnt lgkmcnt(14)
    v_lshlrev_b32 v60, 16, v10
    v_and_b32 v61, 0xffff0000, v10
    v_lshlrev_b32 v62, 16, v11
    v_and_b32 v63, 0xffff0000, v11
    v_lshlrev_b32 v64, 16, v12
    v_and_b32 v65, 0xffff0000, v12
    v_lshlrev_b32 v66, 16, v13
    v_and_b32 v67, 0xffff0000, v13
    v_lshlrev_b32 v68, 16, v14
    v_and_b32 v69, 0xffff0000, v14
    v_lshlrev_b32 v70, 16, v15
    v_and_b32 v71, 0xffff0000, v15
    v_lshlrev_b32 v72, 16, v16
    v_and_b32 v73, 0xffff0000, v16
    v_lshlrev_b32 v74, 16, v17
    v_and_b32 v75, 0xffff0000, v17
    v_lshlrev_b32 v76, 16, v18
    v_and_b32 v77, 0xffff0000, v18
    v_lshlrev_b32 v78, 16, v19
    v_and_b32 v79, 0xffff0000, v19
    s_waitcnt lgkmcnt(13)
    v_lshlrev_b32 v80, 16, v20
    v_and_b32 v81, 0xffff0000, v20
    v_lshlrev_b32 v82, 16, v21
    v_and_b32 v83, 0xffff0000, v21
    s_waitcnt lgkmcnt(12)
    v_lshlrev_b32 v84, 16, v22
    v_and_b32 v85, 0xffff0000, v22
    v_lshlrev_b32 v86, 16, v23
    v_and_b32 v87, 0xffff0000, v23
    s_waitcnt lgkmcnt(11)
    v_lshlrev_b32 v88, 16, v24
    v_and_b32 v89, 0xffff0000, v24
    v_lshlrev_b32 v90, 16, v25
    v_and_b32 v91, 0xffff0000, v25
    s_waitcnt lgkmcnt(10)
    v_lshlrev_b32 v92, 16, v26
    v_and_b32 v93, 0xffff0000, v26
    v_lshlrev_b32 v94, 16, v27
    v_and_b32 v95, 0xffff0000, v27
    s_waitcnt lgkmcnt(9)
    v_lshlrev_b32 v96, 16, v28
    v_and_b32 v97, 0xffff0000, v28
    v_lshlrev_b32 v98, 16, v29
    v_and_b32 v99, 0xffff0000, v29
    s_waitcnt lgkmcnt(8)
    v_lshlrev_b32 v100, 16, v30
    v_and_b32 v101, 0xffff0000, v30
    v_lshlrev_b32 v102, 16, v31
    v_and_b32 v103, 0xffff0000, v31
    s_waitcnt vmcnt(10)
    v_lshlrev_b32 v104, 16, v48
    v_and_b32 v108, 0xffff0000, v48
    v_lshlrev_b32 v112, 16, v49
    v_and_b32 v116, 0xffff0000, v49
    v_lshlrev_b32 v105, 16, v50
    v_and_b32 v109, 0xffff0000, v50
    v_lshlrev_b32 v113, 16, v51
    v_and_b32 v117, 0xffff0000, v51
    s_waitcnt vmcnt(9)
    v_lshlrev_b32 v106, 16, v52
    v_and_b32 v110, 0xffff0000, v52
    v_lshlrev_b32 v114, 16, v53
    v_and_b32 v118, 0xffff0000, v53
    v_lshlrev_b32 v107, 16, v54
    v_and_b32 v111, 0xffff0000, v54
    v_lshlrev_b32 v115, 16, v55
    v_and_b32 v119, 0xffff0000, v55
    s_movk_i32 s16, 4096
    s_movk_i32 s17, 8192
    s_movk_i32 s62, 12288
    v_pk_mul_f32 v[120:121], v[60:61], v[116:117]
    v_pk_fma_f32 v[120:121], v[64:65], v[112:113], v[120:121]
    v_pk_fma_f32 v[120:121], v[68:69], v[108:109], v[120:121]
    v_pk_fma_f32 v[120:121], v[72:73], v[104:105], v[120:121]
    s_waitcnt lgkmcnt(7)
    v_lshlrev_b32 v56, 16, v32
    v_and_b32 v57, 0xffff0000, v32
    v_pk_mul_f32 v[120:121], v[120:121], v[56:57]
    v_pk_mul_f32 v[124:125], v[64:65], v[116:117]
    v_pk_fma_f32 v[124:125], v[68:69], v[112:113], v[124:125]
    v_pk_fma_f32 v[124:125], v[72:73], v[108:109], v[124:125]
    v_pk_fma_f32 v[124:125], v[76:77], v[104:105], v[124:125]
    s_waitcnt lgkmcnt(6)
    v_lshlrev_b32 v58, 16, v34
    v_and_b32 v59, 0xffff0000, v34
    v_pk_mul_f32 v[124:125], v[124:125], v[58:59]
    v_pk_mul_f32 v[128:129], v[68:69], v[116:117]
    v_pk_fma_f32 v[128:129], v[72:73], v[112:113], v[128:129]
    v_pk_fma_f32 v[128:129], v[76:77], v[108:109], v[128:129]
    v_pk_fma_f32 v[128:129], v[80:81], v[104:105], v[128:129]
    s_waitcnt lgkmcnt(5)
    v_lshlrev_b32 v56, 16, v36
    v_and_b32 v57, 0xffff0000, v36
    v_pk_mul_f32 v[128:129], v[128:129], v[56:57]
    v_pk_mul_f32 v[132:133], v[72:73], v[116:117]
    v_pk_fma_f32 v[132:133], v[76:77], v[112:113], v[132:133]
    v_pk_fma_f32 v[132:133], v[80:81], v[108:109], v[132:133]
    v_pk_fma_f32 v[132:133], v[84:85], v[104:105], v[132:133]
    s_waitcnt lgkmcnt(4)
    v_lshlrev_b32 v58, 16, v38
    v_and_b32 v59, 0xffff0000, v38
    v_pk_mul_f32 v[132:133], v[132:133], v[58:59]
    v_pk_mul_f32 v[136:137], v[76:77], v[116:117]
    v_pk_fma_f32 v[136:137], v[80:81], v[112:113], v[136:137]
    v_pk_fma_f32 v[136:137], v[84:85], v[108:109], v[136:137]
    v_pk_fma_f32 v[136:137], v[88:89], v[104:105], v[136:137]
    s_waitcnt lgkmcnt(3)
    v_lshlrev_b32 v56, 16, v40
    v_and_b32 v57, 0xffff0000, v40
    v_pk_mul_f32 v[136:137], v[136:137], v[56:57]
    v_pk_mul_f32 v[140:141], v[80:81], v[116:117]
    v_pk_fma_f32 v[140:141], v[84:85], v[112:113], v[140:141]
    v_pk_fma_f32 v[140:141], v[88:89], v[108:109], v[140:141]
    v_pk_fma_f32 v[140:141], v[92:93], v[104:105], v[140:141]
    s_waitcnt lgkmcnt(2)
    v_lshlrev_b32 v58, 16, v42
    v_and_b32 v59, 0xffff0000, v42
    v_pk_mul_f32 v[140:141], v[140:141], v[58:59]
    v_pk_mul_f32 v[144:145], v[84:85], v[116:117]
    v_pk_fma_f32 v[144:145], v[88:89], v[112:113], v[144:145]
    v_pk_fma_f32 v[144:145], v[92:93], v[108:109], v[144:145]
    v_pk_fma_f32 v[144:145], v[96:97], v[104:105], v[144:145]
    s_waitcnt lgkmcnt(1)
    v_lshlrev_b32 v56, 16, v44
    v_and_b32 v57, 0xffff0000, v44
    v_pk_mul_f32 v[144:145], v[144:145], v[56:57]
    v_pk_mul_f32 v[148:149], v[88:89], v[116:117]
    v_pk_fma_f32 v[148:149], v[92:93], v[112:113], v[148:149]
    v_pk_fma_f32 v[148:149], v[96:97], v[108:109], v[148:149]
    v_pk_fma_f32 v[148:149], v[100:101], v[104:105], v[148:149]
    s_waitcnt lgkmcnt(0)
    v_lshlrev_b32 v58, 16, v46
    v_and_b32 v59, 0xffff0000, v46
    v_pk_mul_f32 v[148:149], v[148:149], v[58:59]
    v_cvt_pk_bf16_f32 v152, v148, v144
    v_cvt_pk_bf16_f32 v153, v140, v136
    v_cvt_pk_bf16_f32 v154, v132, v128
    v_cvt_pk_bf16_f32 v155, v124, v120
    buffer_store_dwordx4 v[152:155], v247, s[36:39], 0 offen sc1
    v_cvt_pk_bf16_f32 v156, v149, v145
    v_cvt_pk_bf16_f32 v157, v141, v137
    v_cvt_pk_bf16_f32 v158, v133, v129
    v_cvt_pk_bf16_f32 v159, v125, v121
    buffer_store_dwordx4 v[156:159], v247, s[36:39], s16 offen sc1
    v_pk_mul_f32 v[122:123], v[62:63], v[118:119]
    v_pk_fma_f32 v[122:123], v[66:67], v[114:115], v[122:123]
    v_pk_fma_f32 v[122:123], v[70:71], v[110:111], v[122:123]
    v_pk_fma_f32 v[122:123], v[74:75], v[106:107], v[122:123]
    v_lshlrev_b32 v56, 16, v33
    v_and_b32 v57, 0xffff0000, v33
    v_pk_mul_f32 v[122:123], v[122:123], v[56:57]
    v_pk_mul_f32 v[126:127], v[66:67], v[118:119]
    v_pk_fma_f32 v[126:127], v[70:71], v[114:115], v[126:127]
    v_pk_fma_f32 v[126:127], v[74:75], v[110:111], v[126:127]
    v_pk_fma_f32 v[126:127], v[78:79], v[106:107], v[126:127]
    v_lshlrev_b32 v58, 16, v35
    v_and_b32 v59, 0xffff0000, v35
    v_pk_mul_f32 v[126:127], v[126:127], v[58:59]
    v_pk_mul_f32 v[130:131], v[70:71], v[118:119]
    v_pk_fma_f32 v[130:131], v[74:75], v[114:115], v[130:131]
    v_pk_fma_f32 v[130:131], v[78:79], v[110:111], v[130:131]
    v_pk_fma_f32 v[130:131], v[82:83], v[106:107], v[130:131]
    v_lshlrev_b32 v56, 16, v37
    v_and_b32 v57, 0xffff0000, v37
    v_pk_mul_f32 v[130:131], v[130:131], v[56:57]
    v_pk_mul_f32 v[134:135], v[74:75], v[118:119]
    v_pk_fma_f32 v[134:135], v[78:79], v[114:115], v[134:135]
    v_pk_fma_f32 v[134:135], v[82:83], v[110:111], v[134:135]
    v_pk_fma_f32 v[134:135], v[86:87], v[106:107], v[134:135]
    v_lshlrev_b32 v58, 16, v39
    v_and_b32 v59, 0xffff0000, v39
    v_pk_mul_f32 v[134:135], v[134:135], v[58:59]
    v_pk_mul_f32 v[138:139], v[78:79], v[118:119]
    v_pk_fma_f32 v[138:139], v[82:83], v[114:115], v[138:139]
    v_pk_fma_f32 v[138:139], v[86:87], v[110:111], v[138:139]
    v_pk_fma_f32 v[138:139], v[90:91], v[106:107], v[138:139]
    v_lshlrev_b32 v56, 16, v41
    v_and_b32 v57, 0xffff0000, v41
    v_pk_mul_f32 v[138:139], v[138:139], v[56:57]
    v_pk_mul_f32 v[142:143], v[82:83], v[118:119]
    v_pk_fma_f32 v[142:143], v[86:87], v[114:115], v[142:143]
    v_pk_fma_f32 v[142:143], v[90:91], v[110:111], v[142:143]
    v_pk_fma_f32 v[142:143], v[94:95], v[106:107], v[142:143]
    v_lshlrev_b32 v58, 16, v43
    v_and_b32 v59, 0xffff0000, v43
    v_pk_mul_f32 v[142:143], v[142:143], v[58:59]
    v_pk_mul_f32 v[146:147], v[86:87], v[118:119]
    v_pk_fma_f32 v[146:147], v[90:91], v[114:115], v[146:147]
    v_pk_fma_f32 v[146:147], v[94:95], v[110:111], v[146:147]
    v_pk_fma_f32 v[146:147], v[98:99], v[106:107], v[146:147]
    v_lshlrev_b32 v56, 16, v45
    v_and_b32 v57, 0xffff0000, v45
    v_pk_mul_f32 v[146:147], v[146:147], v[56:57]
    v_pk_mul_f32 v[150:151], v[90:91], v[118:119]
    v_pk_fma_f32 v[150:151], v[94:95], v[114:115], v[150:151]
    v_pk_fma_f32 v[150:151], v[98:99], v[110:111], v[150:151]
    v_pk_fma_f32 v[150:151], v[102:103], v[106:107], v[150:151]
    v_lshlrev_b32 v58, 16, v47
    v_and_b32 v59, 0xffff0000, v47
    v_pk_mul_f32 v[150:151], v[150:151], v[58:59]
    v_cvt_pk_bf16_f32 v160, v150, v146
    v_cvt_pk_bf16_f32 v161, v142, v138
    v_cvt_pk_bf16_f32 v162, v134, v130
    v_cvt_pk_bf16_f32 v163, v126, v122
    buffer_store_dwordx4 v[160:163], v247, s[36:39], s17 offen sc1
    v_cvt_pk_bf16_f32 v164, v151, v147
    v_cvt_pk_bf16_f32 v165, v143, v139
    v_cvt_pk_bf16_f32 v166, v135, v131
    v_cvt_pk_bf16_f32 v167, v127, v123
    buffer_store_dwordx4 v[164:167], v247, s[36:39], s62 offen sc1
    s_waitcnt vmcnt(9)
    s_barrier
    s_mov_b32 s51, 0x05040100
    s_mov_b32 s52, 0x07060302
    s_mov_b32 s53, 2883584
    ds_read_b64 v[40:41], v244 offset:35904
    ds_read_b64 v[42:43], v244 offset:36032
    ds_read_b64 v[44:45], v244 offset:36160
    ds_read_b64 v[46:47], v244 offset:36288
    ds_read_b64 v[48:49], v244 offset:36416
    ds_read_b64 v[50:51], v244 offset:36544
    ds_read_b64 v[52:53], v244 offset:36672
    ds_read_b64 v[54:55], v244 offset:36800
    s_waitcnt lgkmcnt(6)
    v_perm_b32 v184, v42, v40, s51
    s_waitcnt lgkmcnt(4)
    v_perm_b32 v185, v46, v44, s51
    s_waitcnt lgkmcnt(2)
    v_perm_b32 v186, v50, v48, s51
    s_waitcnt lgkmcnt(0)
    v_perm_b32 v187, v54, v52, s51
    buffer_store_dwordx4 v[184:187], v245, s[36:39], s53 offen sc1
    s_add_u32 s53, s53, 4096
    v_perm_b32 v188, v42, v40, s52
    v_perm_b32 v189, v46, v44, s52
    v_perm_b32 v190, v50, v48, s52
    v_perm_b32 v191, v54, v52, s52
    buffer_store_dwordx4 v[188:191], v245, s[36:39], s53 offen sc1
    s_add_u32 s53, s53, 4096
    v_perm_b32 v192, v43, v41, s51
    v_perm_b32 v193, v47, v45, s51
    v_perm_b32 v194, v51, v49, s51
    v_perm_b32 v195, v55, v53, s51
    buffer_store_dwordx4 v[192:195], v245, s[36:39], s53 offen sc1
    s_add_u32 s53, s53, 4096
    v_perm_b32 v196, v43, v41, s52
    v_perm_b32 v197, v47, v45, s52
    v_perm_b32 v198, v51, v49, s52
    v_perm_b32 v199, v55, v53, s52
    buffer_store_dwordx4 v[196:199], v245, s[36:39], s53 offen sc1
    s_waitcnt vmcnt(8)
    ds_read_b128 v[8:11], v223 offset:32
    ds_read_b64 v[12:13], v223 offset:48
    ds_read_b128 v[14:17], v223 offset:1056
    ds_read_b64 v[18:19], v223 offset:1072
    ds_read_b128 v[20:23], v223 offset:2080
    ds_read_b64 v[24:25], v223 offset:2096
    ds_read_b128 v[26:29], v223 offset:3104
    ds_read_b64 v[30:31], v223 offset:3120
    s_mov_b64 exec, 1
    s_waitcnt lgkmcnt(7)
    v_lshlrev_b32 v80, 16, v8
    v_alignbit_b32 v81, v9, v8, 16
    ds_write_b32 v223, v80 offset:4188
    ds_write_b32 v223, v8 offset:8348
    ds_write_b32 v223, v80 offset:12504
    ds_write_b32 v223, v81 offset:12508
    s_mov_b64 exec, -1
    v_alignbit_b32 v56, v9, v8, 16
    v_alignbit_b32 v57, v10, v9, 16
    v_alignbit_b32 v58, v11, v10, 16
    s_waitcnt lgkmcnt(10)
    v_alignbit_b32 v59, v12, v11, 16
    v_pk_mov_b32 v[60:61], v[8:9], v[10:11] op_sel:[1,0]
    v_pk_mov_b32 v[62:63], v[10:11], v[12:13] op_sel:[1,0]
    v_alignbit_b32 v64, v10, v9, 16
    v_alignbit_b32 v65, v11, v10, 16
    v_alignbit_b32 v66, v12, v11, 16
    v_alignbit_b32 v67, v13, v12, 16
    ds_write_b128 v223, v[56:59] offset:4192
    ds_write_b128 v223, v[60:63] offset:8352
    ds_write_b128 v223, v[64:67] offset:12512
    s_waitcnt lgkmcnt(12)
    v_alignbit_b32 v68, v15, v14, 16
    v_alignbit_b32 v69, v16, v15, 16
    v_alignbit_b32 v70, v17, v16, 16
    s_waitcnt lgkmcnt(11)
    v_alignbit_b32 v71, v18, v17, 16
    v_pk_mov_b32 v[72:73], v[14:15], v[16:17] op_sel:[1,0]
    v_pk_mov_b32 v[74:75], v[16:17], v[18:19] op_sel:[1,0]
    v_alignbit_b32 v76, v16, v15, 16
    v_alignbit_b32 v77, v17, v16, 16
    v_alignbit_b32 v78, v18, v17, 16
    v_alignbit_b32 v79, v19, v18, 16
    ds_write_b128 v223, v[68:71] offset:5216
    ds_write_b128 v223, v[72:75] offset:9376
    ds_write_b128 v223, v[76:79] offset:13536
    s_waitcnt lgkmcnt(13)
    v_alignbit_b32 v56, v21, v20, 16
    v_alignbit_b32 v57, v22, v21, 16
    v_alignbit_b32 v58, v23, v22, 16
    s_waitcnt lgkmcnt(12)
    v_alignbit_b32 v59, v24, v23, 16
    v_pk_mov_b32 v[60:61], v[20:21], v[22:23] op_sel:[1,0]
    v_pk_mov_b32 v[62:63], v[22:23], v[24:25] op_sel:[1,0]
    v_alignbit_b32 v64, v22, v21, 16
    v_alignbit_b32 v65, v23, v22, 16
    v_alignbit_b32 v66, v24, v23, 16
    v_alignbit_b32 v67, v25, v24, 16
    ds_write_b128 v223, v[56:59] offset:6240
    ds_write_b128 v223, v[60:63] offset:10400
    ds_write_b128 v223, v[64:67] offset:14560
    s_waitcnt lgkmcnt(14)
    v_alignbit_b32 v68, v27, v26, 16
    v_alignbit_b32 v69, v28, v27, 16
    v_alignbit_b32 v70, v29, v28, 16
    s_waitcnt lgkmcnt(13)
    v_alignbit_b32 v71, v30, v29, 16
    v_pk_mov_b32 v[72:73], v[26:27], v[28:29] op_sel:[1,0]
    v_pk_mov_b32 v[74:75], v[28:29], v[30:31] op_sel:[1,0]
    v_alignbit_b32 v76, v28, v27, 16
    v_alignbit_b32 v77, v29, v28, 16
    v_alignbit_b32 v78, v30, v29, 16
    v_alignbit_b32 v79, v31, v30, 16
    ds_write_b128 v223, v[68:71] offset:7264
    ds_write_b128 v223, v[72:75] offset:11424
    ds_write_b128 v223, v[76:79] offset:15584
    s_waitcnt vmcnt(4)
    s_waitcnt lgkmcnt(0)
    s_barrier
    v_readfirstlane_b32 s48, v246
    s_mul_i32 s48, s48, 0x9E3779B1
    s_add_u32 s48, s48, 0x7F4A7C15
    s_cmp_eq_u32 s3, 0
    s_cbranch_scc0 L_wf1
    s_lshl_b32 s54, s76, 7
    s_add_u32 s54, s54, 23199744
    v_mov_b32 v2, 0
    v_mov_b32 v3, s48
    s_mov_b64 exec, 1
    buffer_store_dword v3, v2, s[36:39], s54 offen sc1
    s_mov_b64 exec, -1
L_wf1:
    s_add_u32 m0, s61, 0
    s_nop 0
    buffer_load_dwordx4 v224, s[40:43], s64 offen offset:0 lds
    buffer_load_dwordx4 v225, s[40:43], s64 offen offset:1024 lds
    buffer_load_dwordx4 v226, s[40:43], s64 offen offset:2048 lds
    s_add_u32 s64, s64, 98304
    s_sub_u32 s35, s64, 1966080
    s_min_u32 s64, s64, s35
    s_add_u32 m0, s61, 12416
    s_nop 0
    buffer_load_dwordx4 v224, s[40:43], s64 offen offset:0 lds
    buffer_load_dwordx4 v225, s[40:43], s64 offen offset:1024 lds
    buffer_load_dwordx4 v226, s[40:43], s64 offen offset:2048 lds
    s_add_u32 s64, s64, 98304
    s_sub_u32 s35, s64, 1966080
    s_min_u32 s64, s64, s35
    s_add_u32 m0, s61, 24832
    s_nop 0
    buffer_load_dwordx4 v224, s[40:43], s64 offen offset:0 lds
    buffer_load_dwordx4 v225, s[40:43], s64 offen offset:1024 lds
    buffer_load_dwordx4 v226, s[40:43], s64 offen offset:2048 lds
    s_add_u32 s64, s64, 98304
    s_sub_u32 s35, s64, 1966080
    s_min_u32 s64, s64, s35
    s_add_u32 m0, s61, 37248
    s_nop 0
    buffer_load_dwordx4 v224, s[40:43], s64 offen offset:0 lds
    buffer_load_dwordx4 v225, s[40:43], s64 offen offset:1024 lds
    buffer_load_dwordx4 v226, s[40:43], s64 offen offset:2048 lds
    s_add_u32 s64, s64, 98304
    s_sub_u32 s35, s64, 1966080
    s_min_u32 s64, s64, s35
    v_lshrrev_b32 v3, 4, v1
    v_lshlrev_b32 v2, 3, v3
    v_and_b32 v3, 15, v1
    v_sub_u32 v2, v2, v3
    v_subrev_u32 v2, 9, v2
    v_and_b32 v3, 1, v2
    v_cmp_eq_u32 vcc, 1, v3
    v_lshrrev_b32 v3, 16, v250
    s_nop 0
    v_cndmask_b32 v3, v3, v250, vcc
    v_lshrrev_b32 v2, 1, v2
    v_cmp_eq_u32 vcc, 0, v2
    s_nop 1
    v_cndmask_b32 v244, 0, v3, vcc
    v_cmp_eq_u32 vcc, 1, v2
    s_nop 1
    v_cndmask_b32 v245, 0, v3, vcc
    v_cmp_eq_u32 vcc, 2, v2
    s_nop 1
    v_cndmask_b32 v246, 0, v3, vcc
    v_cmp_eq_u32 vcc, 3, v2
    s_nop 1
    v_cndmask_b32 v247, 0, v3, vcc
    v_mov_b32 v4, v229
    v_mov_b32 v5, v230
    s_waitcnt vmcnt(0)
    s_barrier
    s_cmp_eq_u32 s3, 0
    s_cbranch_scc0 L_wf2
    s_lshl_b32 s54, s76, 7
    s_add_u32 s54, s54, 23374848
    v_mov_b32 v254, 0
    v_mov_b32 v255, s48
    s_mov_b64 exec, 1
    buffer_store_dword v255, v254, s[36:39], s54 offen sc1
    s_mov_b64 exec, -1
L_wf2:
    ds_read_b64_tr_b16 a[0:1], v227 offset:0
    ds_read_b64_tr_b16 a[2:3], v227 offset:1536
    ds_read_b64_tr_b16 a[4:5], v227 offset:6224
    ds_read_b64_tr_b16 a[6:7], v227 offset:7760
    ds_read_b64_tr_b16 a[8:9], v228 offset:0
    ds_read_b64_tr_b16 a[10:11], v228 offset:1536
    ds_read_b64_tr_b16 a[12:13], v227 offset:12416
    ds_read_b64_tr_b16 a[14:15], v227 offset:13952
    ds_read_b64_tr_b16 a[16:17], v227 offset:18640
    ds_read_b64_tr_b16 a[18:19], v227 offset:20176
    ds_read_b64_tr_b16 a[20:21], v228 offset:12416
    ds_read_b64_tr_b16 a[22:23], v228 offset:13952
    ds_read_b64_tr_b16 a[24:25], v227 offset:24832
    ds_read_b64_tr_b16 a[26:27], v227 offset:26368
    ds_read_b64_tr_b16 a[28:29], v227 offset:31056
    ds_read_b64_tr_b16 a[30:31], v227 offset:32592
    ds_read_b64_tr_b16 a[32:33], v228 offset:24832
    ds_read_b64_tr_b16 a[34:35], v228 offset:26368
    ds_read_b64_tr_b16 a[36:37], v227 offset:37248
    ds_read_b64_tr_b16 a[38:39], v227 offset:38784
    ds_read_b64_tr_b16 a[40:41], v227 offset:43472
    ds_read_b64_tr_b16 a[42:43], v227 offset:45008
    ds_read_b64_tr_b16 a[44:45], v228 offset:37248
    ds_read_b64_tr_b16 a[46:47], v228 offset:38784
L_poll3:
    buffer_load_dword v2, v242, s[36:39], s59 offen sc1
    s_waitcnt vmcnt(0)
    v_cmp_ne_u32 vcc, s48, v2
    s_cbranch_vccz L_poll3_ok
    s_cmp_eq_u32 s49, 0
    s_cbranch_scc1 L_poll3_ok
    s_sub_u32 s49, s49, 1
    s_sleep 1
    s_branch L_poll3
L_poll3_ok:
    s_mul_i32 s50, s58, 4096
    s_mul_i32 s52, s3, 4608
    s_add_u32 m0, s52, 145408
    s_nop 0
    buffer_load_dwordx4 v248, s[36:39], s50 offen offset:0 sc1 lds
    buffer_load_dwordx4 v248, s[36:39], s50 offen offset:1024 sc1 lds
    buffer_load_dwordx4 v248, s[36:39], s50 offen offset:2048 sc1 lds
    buffer_load_dwordx4 v248, s[36:39], s50 offen offset:3072 sc1 lds
    buffer_load_dword v243, v240, s[36:39], s69 offen sc1
    s_waitcnt vmcnt(1)
    ds_read_b128 v[104:107], v5 offset:3584
    ds_read_b64 v[40:41], v4 offset:0
    ds_read_b64 v[42:43], v4 offset:8
    ds_read_b128 v[108:111], v5 offset:3072
    ds_read_b64 v[44:45], v4 offset:512
    ds_read_b64 v[46:47], v4 offset:520
    ds_read_b128 v[112:115], v5 offset:2560
    ds_read_b64 v[48:49], v4 offset:1024
    ds_read_b64 v[50:51], v4 offset:1032
    ds_read_b128 v[116:119], v5 offset:2048
    ds_read_b64 v[52:53], v4 offset:1536
    ds_read_b64 v[54:55], v4 offset:1544
    s_waitcnt lgkmcnt(9)
    v_mfma_f32_16x16x32_bf16 v[8:11], v[40:43], v[104:107], 0
    v_mfma_f32_16x16x32_bf16 v[8:11], v[244:247], v[104:107], v[8:11]
    s_waitcnt lgkmcnt(8)
    s_mov_b32 s17, 23199744
    ds_read_b128 v[136:139], v5 offset:3648
    v_mfma_f32_16x16x32_bf16 v[12:15], v[40:43], v[108:111], 0
    s_movk_i32 s4, 4096
    ds_read_b64 v[72:73], v4 offset:64
    v_mfma_f32_16x16x32_bf16 v[12:15], v[244:247], v[108:111], v[12:15]
    s_waitcnt lgkmcnt(8)
    s_movk_i32 s5, 8192
    ds_read_b64 v[74:75], v4 offset:72
    v_mfma_f32_16x16x32_bf16 v[12:15], v[44:47], v[104:107], v[12:15]
    s_lshl_b32 s6, s72, 10
    ds_read_b128 v[140:143], v5 offset:3136
    v_mfma_f32_16x16x32_bf16 v[16:19], v[44:47], v[108:111], 0
    s_waitcnt lgkmcnt(9)
    s_add_u32 s6, s6, 23101440
    ds_read_b64 v[76:77], v4 offset:576
    v_mfma_f32_16x16x32_bf16 v[16:19], v[40:43], v[112:115], v[16:19]
    s_lshl_b32 s7, s73, 6
    ds_read_b64 v[78:79], v4 offset:584
    v_mfma_f32_16x16x32_bf16 v[16:19], v[244:247], v[112:115], v[16:19]
    s_waitcnt lgkmcnt(9)
    s_add_u32 s7, s7, s6
    ds_read_b128 v[144:147], v5 offset:2624
    v_mfma_f32_16x16x32_bf16 v[16:19], v[48:51], v[104:107], v[16:19]
    s_mul_i32 s8, s72, 768
    ds_read_b64 v[80:81], v4 offset:1088
    v_mfma_f32_16x16x32_bf16 v[20:23], v[44:47], v[112:115], 0
    s_mul_i32 s53, s73, 12
    ds_read_b64 v[82:83], v4 offset:1096
    v_mfma_f32_16x16x32_bf16 v[20:23], v[48:51], v[108:111], v[20:23]
    s_waitcnt lgkmcnt(11)
    s_add_u32 s8, s8, s53
    ds_read_b128 v[148:151], v5 offset:2112
    v_mfma_f32_16x16x32_bf16 v[20:23], v[40:43], v[116:119], v[20:23]
    s_mul_i32 s53, s3, 3
    ds_read_b64 v[84:85], v4 offset:1600
    v_mfma_f32_16x16x32_bf16 v[20:23], v[244:247], v[116:119], v[20:23]
    s_waitcnt lgkmcnt(11)
    s_add_u32 s8, s8, s53
    ds_read_b64 v[86:87], v4 offset:1608
    v_mfma_f32_16x16x32_bf16 v[20:23], v[52:55], v[104:107], v[20:23]
    s_add_u32 m0, s66, 62464
    s_waitcnt vmcnt(0)
    v_cmp_ne_u32 vcc, s48, v243
    s_cbranch_vccnz L_chk4_slow
L_chk4_back:
    s_barrier
    s_waitcnt lgkmcnt(9)
    v_mfma_f32_16x16x32_bf16 v[8:11], v[72:75], v[136:139], v[8:11]
    s_lshl_b32 s8, s8, 8
    ds_read_b128 v[104:107], v5 offset:3712
    ds_read_b64 v[40:41], v4 offset:128
    buffer_load_dwordx4 v248, s[36:39], s67 offen offset:0 sc1 lds
    s_waitcnt lgkmcnt(10)
    v_mfma_f32_16x16x32_bf16 v[12:15], v[72:75], v[140:143], v[12:15]
    s_waitcnt lgkmcnt(8)
    s_add_u32 s8, s8, 16777216
    ds_read_b64 v[42:43], v4 offset:136
    ds_read_b128 v[108:111], v5 offset:3200
    v_mfma_f32_16x16x32_bf16 v[12:15], v[76:79], v[136:139], v[12:15]
    s_lshl_b32 s9, s73, 2
    ds_read_b64 v[44:45], v4 offset:640
    v_mfma_f32_16x16x32_bf16 v[16:19], v[76:79], v[140:143], v[16:19]
    s_waitcnt lgkmcnt(10)
    s_add_u32 m0, s66, 62464
    s_add_u32 s9, s9, s3
    ds_read_b64 v[46:47], v4 offset:648
    v_mfma_f32_16x16x32_bf16 v[16:19], v[72:75], v[144:147], v[16:19]
    s_waitcnt lgkmcnt(9)
    s_mul_i32 s9, s9, 384
    ds_read_b128 v[112:115], v5 offset:2688
    buffer_load_dwordx4 v248, s[36:39], s67 offen offset:1024 sc1 lds
    v_mfma_f32_16x16x32_bf16 v[16:19], v[80:83], v[136:139], v[16:19]
    s_add_u32 s9, s9, 23527424
    ds_read_b64 v[48:49], v4 offset:1152
    v_mfma_f32_16x16x32_bf16 v[20:23], v[76:79], v[144:147], v[20:23]
    s_mul_i32 s16, s3, 32768
    ds_read_b64 v[50:51], v4 offset:1160
    v_mfma_f32_16x16x32_bf16 v[20:23], v[80:83], v[140:143], v[20:23]
    s_waitcnt lgkmcnt(11)
    s_add_u32 m0, s66, 62464
    s_lshl_b32 s53, s72, 7
    ds_read_b128 v[116:119], v5 offset:2176
    v_mfma_f32_16x16x32_bf16 v[20:23], v[72:75], v[148:151], v[20:23]
    s_waitcnt lgkmcnt(10)
    s_add_u32 s16, s16, s53
    ds_read_b64 v[52:53], v4 offset:1664
    buffer_load_dwordx4 v248, s[36:39], s67 offen offset:2048 sc1 lds
    v_mfma_f32_16x16x32_bf16 v[20:23], v[84:87], v[136:139], v[20:23]
    s_waitcnt lgkmcnt(8)
    s_mul_i32 s53, s34, 131072
    ds_read_b64 v[54:55], v4 offset:1672
    v_mfma_f32_16x16x32_bf16 v[8:11], v[40:43], v[104:107], v[8:11]
    s_waitcnt lgkmcnt(8)
    s_add_u32 s10, s16, s53
    ds_read_b128 v[136:139], v5 offset:3776
    ds_read_b64 v[72:73], v4 offset:192
    v_mfma_f32_16x16x32_bf16 v[12:15], v[40:43], v[108:111], v[12:15]
    s_waitcnt lgkmcnt(8)
    s_add_u32 m0, s66, 62464
    ds_read_b64 v[74:75], v4 offset:200
    ds_read_b128 v[140:143], v5 offset:3264
    v_mfma_f32_16x16x32_bf16 v[12:15], v[44:47], v[104:107], v[12:15]
    s_lshl_b32 s63, s3, 10
    ds_read_b64 v[76:77], v4 offset:704
    buffer_load_dwordx4 v248, s[36:39], s67 offen offset:3072 sc1 lds
    v_mfma_f32_16x16x32_bf16 v[16:19], v[44:47], v[108:111], v[16:19]
    s_waitcnt lgkmcnt(10)
    s_add_u32 s11, s10, 131072
    ds_read_b64 v[78:79], v4 offset:712
    v_mfma_f32_16x16x32_bf16 v[16:19], v[40:43], v[112:115], v[16:19]
    s_waitcnt lgkmcnt(9)
    s_sub_u32 s52, s11, 2621440
    ds_read_b128 v[144:147], v5 offset:2752
    v_mfma_f32_16x16x32_bf16 v[16:19], v[48:51], v[104:107], v[16:19]
    s_min_u32 s11, s11, s52
    ds_read_b64 v[80:81], v4 offset:1216
    v_mfma_f32_16x16x32_bf16 v[20:23], v[44:47], v[112:115], v[20:23]
    s_add_u32 s12, s11, 131072
    ds_read_b64 v[82:83], v4 offset:1224
    buffer_load_dwordx4 v[176:179], v231, s[36:39], s65 offen offset:0 sc1
    v_mfma_f32_16x16x32_bf16 v[20:23], v[48:51], v[108:111], v[20:23]
    s_waitcnt lgkmcnt(11)
    s_sub_u32 s52, s12, 2621440
    ds_read_b128 v[148:151], v5 offset:2240
    v_mfma_f32_16x16x32_bf16 v[20:23], v[40:43], v[116:119], v[20:23]
    s_waitcnt lgkmcnt(10)
    s_min_u32 s12, s12, s52
    ds_read_b64 v[84:85], v4 offset:1728
    v_mfma_f32_16x16x32_bf16 v[20:23], v[52:55], v[104:107], v[20:23]
    s_waitcnt lgkmcnt(8)
    s_add_u32 s13, s12, 131072
    ds_read_b64 v[86:87], v4 offset:1736
    v_mfma_f32_16x16x32_bf16 v[8:11], v[72:75], v[136:139], v[8:11]
    s_sub_u32 s52, s13, 2621440
    ds_read_b128 v[104:107], v5 offset:3840
    ds_read_b64 v[40:41], v4 offset:256
    buffer_load_dwordx4 v[180:183], v231, s[36:39], s65 offen offset:1024 sc1
    s_waitcnt lgkmcnt(10)
    v_mfma_f32_16x16x32_bf16 v[12:15], v[72:75], v[140:143], v[12:15]
    s_waitcnt lgkmcnt(8)
    s_min_u32 s13, s13, s52
    ds_read_b64 v[42:43], v4 offset:264
    ds_read_b128 v[108:111], v5 offset:3328
    v_mfma_f32_16x16x32_bf16 v[12:15], v[76:79], v[136:139], v[12:15]
    s_add_u32 s14, s13, 131072
    ds_read_b64 v[44:45], v4 offset:768
    v_mfma_f32_16x16x32_bf16 v[16:19], v[76:79], v[140:143], v[16:19]
    s_waitcnt lgkmcnt(10)
    s_add_u32 m0, s61, 49664
    s_sub_u32 s52, s14, 2621440
    ds_read_b64 v[46:47], v4 offset:776
    v_mfma_f32_16x16x32_bf16 v[16:19], v[72:75], v[144:147], v[16:19]
    s_waitcnt lgkmcnt(9)
    s_min_u32 s14, s14, s52
    ds_read_b128 v[112:115], v5 offset:2816
    buffer_load_dwordx4 v224, s[40:43], s64 offen offset:0 lds
    v_mfma_f32_16x16x32_bf16 v[16:19], v[80:83], v[136:139], v[16:19]
    s_add_u32 s15, s14, 131072
    ds_read_b64 v[48:49], v4 offset:1280
    v_mfma_f32_16x16x32_bf16 v[20:23], v[76:79], v[144:147], v[20:23]
    s_sub_u32 s52, s15, 2621440
    ds_read_b64 v[50:51], v4 offset:1288
    v_mfma_f32_16x16x32_bf16 v[20:23], v[80:83], v[140:143], v[20:23]
    s_waitcnt lgkmcnt(11)
    s_min_u32 s15, s15, s52
    ds_read_b128 v[116:119], v5 offset:2304
    v_mfma_f32_16x16x32_bf16 v[20:23], v[72:75], v[148:151], v[20:23]
    s_waitcnt lgkmcnt(10)
    s_add_u32 s18, s15, 131072
    ds_read_b64 v[52:53], v4 offset:1792
    v_mfma_f32_16x16x32_bf16 v[20:23], v[84:87], v[136:139], v[20:23]
    s_waitcnt lgkmcnt(8)
    s_add_u32 m0, s61, 49664
    s_sub_u32 s52, s18, 2621440
    ds_read_b64 v[54:55], v4 offset:1800
    v_mfma_f32_16x16x32_bf16 v[8:11], v[40:43], v[104:107], v[8:11]
    s_min_u32 s18, s18, s52
    ds_read_b128 v[136:139], v5 offset:3904
    ds_read_b64 v[72:73], v4 offset:320
    buffer_load_dwordx4 v225, s[40:43], s64 offen offset:1024 lds
    s_waitcnt lgkmcnt(10)
    v_mfma_f32_16x16x32_bf16 v[12:15], v[40:43], v[108:111], v[12:15]
    s_waitcnt lgkmcnt(8)
    s_add_u32 s19, s18, 131072
    ds_read_b64 v[74:75], v4 offset:328
    ds_read_b128 v[140:143], v5 offset:3392
    v_mfma_f32_16x16x32_bf16 v[12:15], v[44:47], v[104:107], v[12:15]
    s_sub_u32 s52, s19, 2621440
    ds_read_b64 v[76:77], v4 offset:832
    v_mfma_f32_16x16x32_bf16 v[16:19], v[44:47], v[108:111], v[16:19]
    s_waitcnt lgkmcnt(10)
    s_min_u32 s19, s19, s52
    ds_read_b64 v[78:79], v4 offset:840
    v_mfma_f32_16x16x32_bf16 v[16:19], v[40:43], v[112:115], v[16:19]
    s_waitcnt lgkmcnt(9)
    s_add_u32 s20, s19, 131072
    ds_read_b128 v[144:147], v5 offset:2880
    v_mfma_f32_16x16x32_bf16 v[16:19], v[48:51], v[104:107], v[16:19]
    s_sub_u32 s52, s20, 2621440
    ds_read_b64 v[80:81], v4 offset:1344
    v_mfma_f32_16x16x32_bf16 v[20:23], v[44:47], v[112:115], v[20:23]
    s_add_u32 m0, s61, 49664
    ds_read_b64 v[82:83], v4 offset:1352
    buffer_load_dwordx2 v[232:233], v253, s[36:39], s55 offen sc1
    v_mfma_f32_16x16x32_bf16 v[20:23], v[48:51], v[108:111], v[20:23]
    s_waitcnt lgkmcnt(11)
    s_min_u32 s20, s20, s52
    ds_read_b128 v[148:151], v5 offset:2368
    buffer_load_dwordx4 v226, s[40:43], s64 offen offset:2048 lds
    v_mfma_f32_16x16x32_bf16 v[20:23], v[40:43], v[116:119], v[20:23]
    s_waitcnt lgkmcnt(10)
    s_add_u32 s64, s64, 98304
    s_add_u32 s21, s20, 131072
    ds_read_b64 v[84:85], v4 offset:1856
    v_mfma_f32_16x16x32_bf16 v[20:23], v[52:55], v[104:107], v[20:23]
    s_waitcnt lgkmcnt(8)
    s_sub_u32 s35, s64, 1966080
    s_sub_u32 s52, s21, 2621440
    ds_read_b64 v[86:87], v4 offset:1864
    v_mfma_f32_16x16x32_bf16 v[8:11], v[72:75], v[136:139], v[8:11]
    s_waitcnt lgkmcnt(8)
    s_min_u32 s64, s64, s35
    ds_read_b128 v[104:107], v5 offset:3968
    ds_read_b64 v[40:41], v4 offset:384
    v_mfma_f32_16x16x32_bf16 v[12:15], v[72:75], v[140:143], v[12:15]
    s_waitcnt lgkmcnt(8)
    s_add_u32 m0, s61, 0
    ds_read_b64 v[42:43], v4 offset:392
    ds_read_b128 v[108:111], v5 offset:3456
    v_mfma_f32_16x16x32_bf16 v[12:15], v[76:79], v[136:139], v[12:15]
    s_min_u32 s21, s21, s52
    ds_read_b64 v[44:45], v4 offset:896
    buffer_load_dwordx4 v224, s[40:43], s64 offen offset:0 lds
    v_mfma_f32_16x16x32_bf16 v[16:19], v[76:79], v[140:143], v[16:19]
    s_waitcnt lgkmcnt(10)
    s_add_u32 s22, s21, 131072
    ds_read_b64 v[46:47], v4 offset:904
    v_mfma_f32_16x16x32_bf16 v[16:19], v[72:75], v[144:147], v[16:19]
    s_waitcnt lgkmcnt(9)
    s_sub_u32 s52, s22, 2621440
    ds_read_b128 v[112:115], v5 offset:2944
    v_mfma_f32_16x16x32_bf16 v[16:19], v[80:83], v[136:139], v[16:19]
    s_min_u32 s22, s22, s52
    ds_read_b64 v[48:49], v4 offset:1408
    v_mfma_f32_16x16x32_bf16 v[20:23], v[76:79], v[144:147], v[20:23]
    s_add_u32 s23, s22, 131072
    ds_read_b64 v[50:51], v4 offset:1416
    v_mfma_f32_16x16x32_bf16 v[20:23], v[80:83], v[140:143], v[20:23]
    s_waitcnt lgkmcnt(11)
    s_add_u32 m0, s61, 0
    s_sub_u32 s52, s23, 2621440
    ds_read_b128 v[116:119], v5 offset:2432
    v_mfma_f32_16x16x32_bf16 v[20:23], v[72:75], v[148:151], v[20:23]
    s_waitcnt lgkmcnt(10)
    s_min_u32 s23, s23, s52
    ds_read_b64 v[52:53], v4 offset:1920
    buffer_load_dwordx4 v225, s[40:43], s64 offen offset:1024 lds
    v_mfma_f32_16x16x32_bf16 v[20:23], v[84:87], v[136:139], v[20:23]
    s_waitcnt lgkmcnt(8)
    s_add_u32 s24, s23, 131072
    ds_read_b64 v[54:55], v4 offset:1928
    v_mfma_f32_16x16x32_bf16 v[8:11], v[40:43], v[104:107], v[8:11]
    s_waitcnt lgkmcnt(8)
    s_sub_u32 s52, s24, 2621440
    ds_read_b128 v[136:139], v5 offset:4032
    ds_read_b64 v[72:73], v4 offset:448
    v_mfma_f32_16x16x32_bf16 v[12:15], v[40:43], v[108:111], v[12:15]
    s_waitcnt lgkmcnt(8)
    s_min_u32 s24, s24, s52
    ds_read_b64 v[74:75], v4 offset:456
    ds_read_b128 v[140:143], v5 offset:3520
    v_mfma_f32_16x16x32_bf16 v[12:15], v[44:47], v[104:107], v[12:15]
    s_add_u32 s25, s24, 131072
    ds_read_b64 v[76:77], v4 offset:960
    v_mfma_f32_16x16x32_bf16 v[16:19], v[44:47], v[108:111], v[16:19]
    s_waitcnt lgkmcnt(10)
    s_add_u32 m0, s61, 0
    s_sub_u32 s52, s25, 2621440
    ds_read_b64 v[78:79], v4 offset:968
    v_mfma_f32_16x16x32_bf16 v[16:19], v[40:43], v[112:115], v[16:19]
    s_waitcnt lgkmcnt(9)
    s_min_u32 s25, s25, s52
    ds_read_b128 v[144:147], v5 offset:3008
    buffer_load_dwordx4 v226, s[40:43], s64 offen offset:2048 lds
    v_mfma_f32_16x16x32_bf16 v[16:19], v[48:51], v[104:107], v[16:19]
    s_add_u32 s64, s64, 98304
    s_add_u32 s26, s25, 131072
    ds_read_b64 v[80:81], v4 offset:1472
    v_mfma_f32_16x16x32_bf16 v[20:23], v[44:47], v[112:115], v[20:23]
    s_sub_u32 s35, s64, 1966080
    s_sub_u32 s52, s26, 2621440
    ds_read_b64 v[82:83], v4 offset:1480
    v_mfma_f32_16x16x32_bf16 v[20:23], v[48:51], v[108:111], v[20:23]
    s_waitcnt lgkmcnt(11)
    s_min_u32 s64, s64, s35
    s_min_u32 s26, s26, s52
    ds_read_b128 v[148:151], v5 offset:2496
    v_mfma_f32_16x16x32_bf16 v[20:23], v[40:43], v[116:119], v[20:23]
    s_waitcnt lgkmcnt(10)
    s_add_u32 s27, s26, 131072
    ds_read_b64 v[84:85], v4 offset:1984
    v_mfma_f32_16x16x32_bf16 v[20:23], v[52:55], v[104:107], v[20:23]
    s_waitcnt lgkmcnt(8)
    s_add_u32 m0, s61, 12416
    s_sub_u32 s52, s27, 2621440
    ds_read_b64 v[86:87], v4 offset:1992
    v_mfma_f32_16x16x32_bf16 v[8:11], v[72:75], v[136:139], v[8:11]
    s_min_u32 s27, s27, s52
    ds_read_b128 v[112:115], v5 offset:2560
    ds_read_b64 v[48:49], v4 offset:1024
    buffer_load_dwordx4 v224, s[40:43], s64 offen offset:0 lds
    s_waitcnt lgkmcnt(10)
    v_mfma_f32_16x16x32_bf16 v[12:15], v[72:75], v[140:143], v[12:15]
    s_waitcnt lgkmcnt(8)
    s_add_u32 s44, s27, 131072
    ds_read_b64 v[50:51], v4 offset:1032
    ds_read_b128 v[116:119], v5 offset:2048
    v_mfma_f32_16x16x32_bf16 v[12:15], v[76:79], v[136:139], v[12:15]
    s_sub_u32 s52, s44, 2621440
    ds_read_b64 v[52:53], v4 offset:1536
    ds_read_b64 v[54:55], v4 offset:1544
    v_mfma_f32_16x16x32_bf16 v[16:19], v[76:79], v[140:143], v[16:19]
    s_waitcnt lgkmcnt(11)
    s_min_u32 s44, s44, s52
    ds_read_b128 v[108:111], v5 offset:3072
    ds_read_b64 v[44:45], v4 offset:512
    v_mfma_f32_16x16x32_bf16 v[16:19], v[72:75], v[144:147], v[16:19]
    s_waitcnt lgkmcnt(11)
    s_add_u32 s45, s44, 131072
    ds_read_b64 v[46:47], v4 offset:520
    ds_read_b128 v[120:123], v5 offset:1536
    v_mfma_f32_16x16x32_bf16 v[16:19], v[80:83], v[136:139], v[16:19]
    s_add_u32 m0, s61, 12416
    ds_read_b64 v[56:57], v4 offset:2048
    ds_read_b64 v[58:59], v4 offset:2056
    v_mfma_f32_16x16x32_bf16 v[20:23], v[76:79], v[144:147], v[20:23]
    s_sub_u32 s52, s45, 2621440
    ds_read_b128 v[104:107], v5 offset:3584
    ds_read_b64 v[40:41], v4 offset:0
    buffer_load_dwordx4 v225, s[40:43], s64 offen offset:1024 lds
    v_mfma_f32_16x16x32_bf16 v[20:23], v[80:83], v[140:143], v[20:23]
    s_waitcnt lgkmcnt(12)
    s_min_u32 s45, s45, s52
    ds_read_b64 v[42:43], v4 offset:8
    ds_read_b128 v[124:127], v5 offset:1024
    v_mfma_f32_16x16x32_bf16 v[20:23], v[72:75], v[148:151], v[20:23]
    s_add_u32 s46, s45, 131072
    ds_read_b64 v[60:61], v4 offset:2560
    ds_read_b64 v[62:63], v4 offset:2568
    v_mfma_f32_16x16x32_bf16 v[20:23], v[84:87], v[136:139], v[20:23]
    s_waitcnt vmcnt(11)
    s_barrier
    ds_read_b128 v[128:131], v5 offset:512
    ds_read_b64 v[64:65], v4 offset:3072
    ds_read_b64 v[66:67], v4 offset:3080
    ds_read_b128 v[132:135], v5 offset:0
    ds_read_b64 v[68:69], v4 offset:3584
    ds_read_b64 v[70:71], v4 offset:3592
    s_waitcnt lgkmcnt(14)
    v_mfma_f32_16x16x32_bf16 v[24:27], v[48:51], v[112:115], 0
    s_sub_u32 s52, s46, 2621440
    ds_read_b128 v[184:187], v249 offset:0
    v_mfma_f32_16x16x32_bf16 v[28:31], v[48:51], v[116:119], 0
    s_add_u32 m0, s61, 12416
    s_min_u32 s46, s46, s52
    ds_read_b128 v[200:203], v249 offset:8192
    v_mfma_f32_16x16x32_bf16 v[28:31], v[52:55], v[112:115], v[28:31]
    s_add_u32 s47, s46, 131072
    ds_read_b128 v[188:191], v249 offset:1024
    buffer_load_dwordx4 v226, s[40:43], s64 offen offset:2048 lds
    v_mfma_f32_16x16x32_bf16 v[32:35], v[52:55], v[116:119], 0
    s_add_u32 s64, s64, 98304
    s_sub_u32 s52, s47, 2621440
    ds_read_b128 v[204:207], v249 offset:9216
    v_mfma_f32_16x16x32_bf16 v[24:27], v[44:47], v[116:119], v[24:27]
    s_sub_u32 s35, s64, 1966080
    ds_read_b128 v[144:147], v5 offset:2624
    ds_read_b128 v[192:195], v249 offset:2048
    v_mfma_f32_16x16x32_bf16 v[24:27], v[52:55], v[108:111], v[24:27]
    s_min_u32 s64, s64, s35
    ds_read_b64 v[80:81], v4 offset:1088
    ds_read_b128 v[208:211], v249 offset:10240
    v_mfma_f32_16x16x32_bf16 v[32:35], v[48:51], v[120:123], v[32:35]
    s_waitcnt lgkmcnt(12)
    s_min_u32 s47, s47, s52
    ds_read_b64 v[82:83], v4 offset:1096
    ds_read_b128 v[196:199], v249 offset:3072
    v_mfma_f32_16x16x32_bf16 v[32:35], v[56:59], v[112:115], v[32:35]
    s_add_u32 m0, s61, 24832
    ds_read_b128 v[148:151], v5 offset:2112
    ds_read_b128 v[212:215], v249 offset:11264
    v_mfma_f32_16x16x32_bf16 v[36:39], v[52:55], v[120:123], 0
    s_lshl_b32 s62, s75, 2
    ds_read_b64 v[84:85], v4 offset:1600
    buffer_load_dwordx4 v224, s[40:43], s64 offen offset:0 lds
    v_mfma_f32_16x16x32_bf16 v[36:39], v[56:59], v[116:119], v[36:39]
    s_add_u32 s62, s62, s3
    ds_read_b64 v[86:87], v4 offset:1608
    v_mfma_f32_16x16x32_bf16 v[28:31], v[44:47], v[120:123], v[28:31]
    s_mul_i32 s62, s62, 61440
    ds_read_b128 v[140:143], v5 offset:3136
    v_mfma_f32_16x16x32_bf16 v[28:31], v[56:59], v[108:111], v[28:31]
    s_add_u32 s62, s62, 14417920
    ds_read_b64 v[76:77], v4 offset:576
    s_waitcnt vmcnt(8)
    v_cmp_ne_u32 vcc, s48, v233
    s_cbranch_vccnz L_m_slow
L_m_back:
    v_mov_b32_dpp v252, v232 quad_perm:[3,3,3,3] row_mask:0xf bank_mask:0xf
    s_nop 1
    v_mul_f32_dpp v251, v232, v252 quad_perm:[2,2,2,2] row_mask:0xf bank_mask:0xf
    s_nop 1
    v_mul_f32_dpp v250, v232, v251 quad_perm:[1,1,1,1] row_mask:0xf bank_mask:0xf
    v_mul_f32_dpp v251, v232, v251 quad_perm:[0,0,0,0] row_mask:0xf bank_mask:0xf
    v_permlane16_swap_b32 v176, v178
    v_permlane16_swap_b32 v177, v179
    v_permlane16_swap_b32 v180, v182
    v_permlane16_swap_b32 v181, v183
    v_lshlrev_b32 v232, 16, v176
    v_and_b32 v233, 0xffff0000, v176
    v_lshlrev_b32 v234, 16, v177
    v_and_b32 v235, 0xffff0000, v177
    s_waitcnt lgkmcnt(14)
    v_pk_fma_f32 v[184:185], v[232:233], v[184:185], v[200:201]
    v_pk_fma_f32 v[186:187], v[234:235], v[186:187], v[202:203]
    v_pk_mul_f32 v[200:201], v[232:233], v[252:253] op_sel_hi:[1,0]
    v_pk_mul_f32 v[202:203], v[234:235], v[252:253] op_sel_hi:[1,0]
    v_pk_fma_f32 v[184:185], v[184:185], v[250:251], v[250:251] op_sel:[0,0,1] op_sel_hi:[1,0,1]
    v_pk_fma_f32 v[186:187], v[186:187], v[250:251], v[250:251] op_sel:[0,0,1] op_sel_hi:[1,0,1]
    v_lshlrev_b32 v236, 16, v178
    v_and_b32 v237, 0xffff0000, v178
    v_lshlrev_b32 v238, 16, v179
    v_and_b32 v239, 0xffff0000, v179
    s_waitcnt lgkmcnt(12)
    v_pk_fma_f32 v[188:189], v[236:237], v[188:189], v[204:205]
    v_pk_fma_f32 v[190:191], v[238:239], v[190:191], v[206:207]
    v_pk_mul_f32 v[204:205], v[236:237], v[252:253] op_sel_hi:[1,0]
    v_pk_mul_f32 v[206:207], v[238:239], v[252:253] op_sel_hi:[1,0]
    v_pk_fma_f32 v[188:189], v[188:189], v[250:251], v[250:251] op_sel:[0,0,1] op_sel_hi:[1,0,1]
    v_pk_fma_f32 v[190:191], v[190:191], v[250:251], v[250:251] op_sel:[0,0,1] op_sel_hi:[1,0,1]
    v_lshlrev_b32 v232, 16, v180
    v_and_b32 v233, 0xffff0000, v180
    v_lshlrev_b32 v234, 16, v181
    v_and_b32 v235, 0xffff0000, v181
    s_waitcnt lgkmcnt(8)
    v_pk_fma_f32 v[192:193], v[232:233], v[192:193], v[208:209]
    v_pk_fma_f32 v[194:195], v[234:235], v[194:195], v[210:211]
    v_pk_mul_f32 v[208:209], v[232:233], v[252:253] op_sel_hi:[1,0]
    v_pk_mul_f32 v[210:211], v[234:235], v[252:253] op_sel_hi:[1,0]
    v_pk_fma_f32 v[192:193], v[192:193], v[250:251], v[250:251] op_sel:[0,0,1] op_sel_hi:[1,0,1]
    v_pk_fma_f32 v[194:195], v[194:195], v[250:251], v[250:251] op_sel:[0,0,1] op_sel_hi:[1,0,1]
    v_lshlrev_b32 v236, 16, v182
    v_and_b32 v237, 0xffff0000, v182
    v_lshlrev_b32 v238, 16, v183
    v_and_b32 v239, 0xffff0000, v183
    s_waitcnt lgkmcnt(4)
    v_pk_fma_f32 v[196:197], v[236:237], v[196:197], v[212:213]
    v_pk_fma_f32 v[198:199], v[238:239], v[198:199], v[214:215]
    v_pk_mul_f32 v[212:213], v[236:237], v[252:253] op_sel_hi:[1,0]
    v_pk_mul_f32 v[214:215], v[238:239], v[252:253] op_sel_hi:[1,0]
    v_pk_fma_f32 v[196:197], v[196:197], v[250:251], v[250:251] op_sel:[0,0,1] op_sel_hi:[1,0,1]
    v_pk_fma_f32 v[198:199], v[198:199], v[250:251], v[250:251] op_sel:[0,0,1] op_sel_hi:[1,0,1]
    v_pk_fma_f32 v[184:185], v[184:185], v[8:9], v[200:201]
    v_pk_fma_f32 v[186:187], v[186:187], v[10:11], v[202:203]
    v_cvt_pk_bf16_f32 v232, v184, v185
    v_cvt_pk_bf16_f32 v233, v186, v187
    v_pk_fma_f32 v[188:189], v[188:189], v[12:13], v[204:205]
    v_pk_fma_f32 v[190:191], v[190:191], v[14:15], v[206:207]
    v_cvt_pk_bf16_f32 v234, v188, v189
    v_cvt_pk_bf16_f32 v235, v190, v191
    s_nop 0
    v_permlane16_swap_b32 v232, v234
    v_permlane16_swap_b32 v233, v235
    buffer_store_dwordx4 v[232:235], v231, s[36:39], s68 offen offset:0 sc1
    v_pk_fma_f32 v[192:193], v[192:193], v[16:17], v[208:209]
    v_pk_fma_f32 v[194:195], v[194:195], v[18:19], v[210:211]
    v_cvt_pk_bf16_f32 v236, v192, v193
    v_cvt_pk_bf16_f32 v237, v194, v195
    v_pk_fma_f32 v[196:197], v[196:197], v[20:21], v[212:213]
    v_pk_fma_f32 v[198:199], v[198:199], v[22:23], v[214:215]
    v_cvt_pk_bf16_f32 v238, v196, v197
    v_cvt_pk_bf16_f32 v239, v198, v199
    s_nop 0
    v_permlane16_swap_b32 v236, v238
    v_permlane16_swap_b32 v237, v239
    buffer_store_dwordx4 v[236:239], v231, s[36:39], s68 offen offset:1024 sc1
    v_mfma_f32_16x16x32_bf16 v[24:27], v[40:43], v[120:123], v[24:27]
    ds_read_b64 v[78:79], v4 offset:584
    v_mfma_f32_16x16x32_bf16 v[24:27], v[244:247], v[120:123], v[24:27]
    s_add_u32 m0, s61, 24832
    ds_read_b128 v[152:155], v5 offset:1600
    ds_read_b128 v[184:187], v249 offset:4096
    v_mfma_f32_16x16x32_bf16 v[24:27], v[56:59], v[104:107], v[24:27]
    ds_read_b64 v[88:89], v4 offset:2112
    ds_read_b128 v[200:203], v249 offset:12288
    buffer_load_dwordx4 v225, s[40:43], s64 offen offset:1024 lds
    v_mfma_f32_16x16x32_bf16 v[36:39], v[48:51], v[124:127], v[36:39]
    ds_read_b64 v[90:91], v4 offset:2120
    ds_read_b128 v[188:191], v249 offset:5120
    v_mfma_f32_16x16x32_bf16 v[36:39], v[60:63], v[112:115], v[36:39]
    ds_read_b128 v[136:139], v5 offset:3648
    ds_read_b128 v[204:207], v249 offset:13312
    v_mfma_f32_16x16x32_bf16 v[32:35], v[44:47], v[124:127], v[32:35]
    ds_read_b64 v[72:73], v4 offset:64
    ds_read_b128 v[192:195], v249 offset:6144
    v_mfma_f32_16x16x32_bf16 v[32:35], v[60:63], v[108:111], v[32:35]
    s_waitcnt vmcnt(10)
    s_barrier
    ds_read_b64 v[74:75], v4 offset:72
    ds_read_b128 v[208:211], v249 offset:14336
    ds_read_b64_tr_b16 a[48:49], v227 offset:49664
    v_mfma_f32_16x16x32_bf16 v[28:31], v[40:43], v[124:127], v[28:31]
    s_add_u32 m0, s61, 24832
    ds_read_b128 v[156:159], v5 offset:1088
    ds_read_b128 v[196:199], v249 offset:7168
    ds_read_b64_tr_b16 a[50:51], v227 offset:51200
    v_mfma_f32_16x16x32_bf16 v[28:31], v[244:247], v[124:127], v[28:31]
    ds_read_b64 v[92:93], v4 offset:2624
    ds_read_b128 v[212:215], v249 offset:15360
    ds_read_b64_tr_b16 a[52:53], v227 offset:55888
    buffer_load_dwordx4 v226, s[40:43], s64 offen offset:2048 lds
    v_mfma_f32_16x16x32_bf16 v[28:31], v[60:63], v[104:107], v[28:31]
    s_add_u32 s64, s64, 98304
    ds_read_b64 v[94:95], v4 offset:2632
    buffer_load_dword v243, v241, s[36:39], s60 offen sc1
    v_mfma_f32_16x16x32_bf16 v[36:39], v[44:47], v[128:131], v[36:39]
    s_sub_u32 s35, s64, 1966080
    ds_read_b128 v[160:163], v5 offset:576
    ds_read_b64_tr_b16 a[54:55], v227 offset:57424
    v_mfma_f32_16x16x32_bf16 v[36:39], v[64:67], v[108:111], v[36:39]
    s_min_u32 s64, s64, s35
    ds_read_b64 v[96:97], v4 offset:3136
    ds_read_b64_tr_b16 a[56:57], v228 offset:49664
    v_mfma_f32_16x16x32_bf16 v[32:35], v[40:43], v[128:131], v[32:35]
    ds_read_b64 v[98:99], v4 offset:3144
    ds_read_b64_tr_b16 a[58:59], v228 offset:51200
    v_mfma_f32_16x16x32_bf16 v[32:35], v[244:247], v[128:131], v[32:35]
    ds_read_b128 v[164:167], v5 offset:64
    v_mfma_f32_16x16x32_bf16 v[32:35], v[64:67], v[104:107], v[32:35]
    ds_read_b64 v[100:101], v4 offset:3648
    buffer_load_dwordx4 v[176:179], v231, s[36:39], s65 offen offset:2048 sc1
    v_mfma_f32_16x16x32_bf16 v[36:39], v[40:43], v[132:135], v[36:39]
    ds_read_b64 v[102:103], v4 offset:3656
    v_mfma_f32_16x16x32_bf16 v[36:39], v[244:247], v[132:135], v[36:39]
    v_mfma_f32_16x16x32_bf16 v[36:39], v[68:71], v[104:107], v[36:39]
    v_mfma_f32_16x16x32_bf16 v[24:27], v[80:83], v[144:147], v[24:27]
    ds_read_b128 v[112:115], v5 offset:2688
    buffer_load_dwordx4 v[180:183], v231, s[36:39], s65 offen offset:3072 sc1
    v_mfma_f32_16x16x32_bf16 v[28:31], v[80:83], v[148:151], v[28:31]
    s_waitcnt lgkmcnt(13)
    ds_read_b64 v[48:49], v4 offset:1152
    v_mfma_f32_16x16x32_bf16 v[28:31], v[84:87], v[144:147], v[28:31]
    ds_read_b64 v[50:51], v4 offset:1160
    v_mfma_f32_16x16x32_bf16 v[32:35], v[84:87], v[148:151], v[32:35]
    s_add_u32 m0, s61, 37248
    ds_read_b128 v[116:119], v5 offset:2176
    v_mfma_f32_16x16x32_bf16 v[24:27], v[76:79], v[148:151], v[24:27]
    s_waitcnt vmcnt(11)
    s_waitcnt lgkmcnt(7)
    s_barrier
    ds_read_b64 v[52:53], v4 offset:1664
    buffer_load_dwordx4 v224, s[40:43], s64 offen offset:0 lds
    v_mfma_f32_16x16x32_bf16 v[24:27], v[84:87], v[140:143], v[24:27]
    ds_read_b64 v[54:55], v4 offset:1672
    ds_read_b64_tr_b16 a[60:61], v227 offset:0
    v_mfma_f32_16x16x32_bf16 v[32:35], v[80:83], v[152:155], v[32:35]
    ds_read_b128 v[108:111], v5 offset:3200
    ds_read_b64_tr_b16 a[62:63], v227 offset:1536
    v_mfma_f32_16x16x32_bf16 v[32:35], v[88:91], v[144:147], v[32:35]
    ds_read_b64 v[44:45], v4 offset:640
    ds_read_b64_tr_b16 a[64:65], v227 offset:6224
    v_mfma_f32_16x16x32_bf16 v[36:39], v[84:87], v[152:155], v[36:39]
    ds_read_b64 v[46:47], v4 offset:648
    ds_read_b64_tr_b16 a[66:67], v227 offset:7760
    v_mfma_f32_16x16x32_bf16 v[36:39], v[88:91], v[148:151], v[36:39]
    s_add_u32 m0, s61, 37248
    ds_read_b128 v[120:123], v5 offset:1664
    ds_read_b64_tr_b16 a[68:69], v228 offset:0
    v_mfma_f32_16x16x32_bf16 v[28:31], v[76:79], v[152:155], v[28:31]
    ds_read_b64 v[56:57], v4 offset:2176
    ds_read_b64_tr_b16 a[70:71], v228 offset:1536
    buffer_load_dwordx4 v225, s[40:43], s64 offen offset:1024 lds
    v_mfma_f32_16x16x32_bf16 v[28:31], v[88:91], v[140:143], v[28:31]
    ds_read_b64 v[58:59], v4 offset:2184
    v_mfma_f32_16x16x32_bf16 v[24:27], v[72:75], v[152:155], v[24:27]
    ds_read_b128 v[104:107], v5 offset:3712
    v_mfma_f32_16x16x32_bf16 v[24:27], v[88:91], v[136:139], v[24:27]
    ds_read_b64 v[40:41], v4 offset:128
    v_mfma_f32_16x16x32_bf16 v[36:39], v[80:83], v[156:159], v[36:39]
    ds_read_b64 v[42:43], v4 offset:136
    v_mfma_f32_16x16x32_bf16 v[36:39], v[92:95], v[144:147], v[36:39]
    s_add_u32 m0, s61, 37248
    ds_read_b128 v[124:127], v5 offset:1152
    v_mfma_f32_16x16x32_bf16 v[32:35], v[76:79], v[156:159], v[32:35]
    ds_read_b64 v[60:61], v4 offset:2688
    buffer_load_dwordx4 v226, s[40:43], s64 offen offset:2048 lds
    v_mfma_f32_16x16x32_bf16 v[32:35], v[92:95], v[140:143], v[32:35]
    s_add_u32 s64, s64, 98304
    ds_read_b64 v[62:63], v4 offset:2696
    v_mfma_f32_16x16x32_bf16 v[28:31], v[72:75], v[156:159], v[28:31]
    s_sub_u32 s35, s64, 1966080
    ds_read_b128 v[128:131], v5 offset:640
    v_mfma_f32_16x16x32_bf16 v[28:31], v[92:95], v[136:139], v[28:31]
    s_min_u32 s64, s64, s35
    ds_read_b64 v[64:65], v4 offset:3200
    v_mfma_f32_16x16x32_bf16 v[36:39], v[76:79], v[160:163], v[36:39]
    ds_read_b64 v[66:67], v4 offset:3208
    v_mfma_f32_16x16x32_bf16 v[36:39], v[96:99], v[140:143], v[36:39]
    s_waitcnt vmcnt(11)
    s_waitcnt lgkmcnt(10)
    s_barrier
    s_add_u32 m0, s61, 49664
    ds_read_b128 v[132:135], v5 offset:128
    v_mfma_f32_16x16x32_bf16 v[32:35], v[72:75], v[160:163], v[32:35]
    ds_read_b64 v[68:69], v4 offset:3712
    ds_read_b64_tr_b16 a[72:73], v227 offset:12416
    buffer_load_dwordx4 v224, s[40:43], s64 offen offset:0 lds
    v_mfma_f32_16x16x32_bf16 v[32:35], v[96:99], v[136:139], v[32:35]
    ds_read_b64 v[70:71], v4 offset:3720
    ds_read_b64_tr_b16 a[74:75], v227 offset:13952
    v_mfma_f32_16x16x32_bf16 v[36:39], v[72:75], v[164:167], v[36:39]
    ds_read_b64_tr_b16 a[76:77], v227 offset:18640
    v_mfma_f32_16x16x32_bf16 v[36:39], v[100:103], v[136:139], v[36:39]
    ds_read_b64_tr_b16 a[78:79], v227 offset:20176
    v_mfma_f32_16x16x32_bf16 v[24:27], v[48:51], v[112:115], v[24:27]
    s_waitcnt vmcnt(9)
    s_barrier
    s_cmp_eq_u32 s3, 0
    s_cbranch_scc0 L_wf5
    s_lshl_b32 s54, s70, 7
    s_add_u32 s54, s54, 23245824
    v_mov_b32 v254, 0
    v_mov_b32 v255, s48
    s_mov_b64 exec, 1
    buffer_store_dword v255, v254, s[36:39], s54 offen sc1
    s_mov_b64 exec, -1
L_wf5:
    ds_read_b128 v[144:147], v5 offset:2752
    ds_read_b64_tr_b16 a[80:81], v228 offset:12416
    v_mfma_f32_16x16x32_bf16 v[28:31], v[48:51], v[116:119], v[28:31]
    s_add_u32 m0, s61, 49664
    ds_read_b64 v[80:81], v4 offset:1216
    ds_read_b64_tr_b16 a[82:83], v228 offset:13952
    v_mfma_f32_16x16x32_bf16 v[28:31], v[52:55], v[112:115], v[28:31]
    ds_read_b64 v[82:83], v4 offset:1224
    buffer_load_dwordx4 v225, s[40:43], s64 offen offset:1024 lds
    v_mfma_f32_16x16x32_bf16 v[32:35], v[52:55], v[116:119], v[32:35]
    ds_read_b128 v[148:151], v5 offset:2240
    v_mfma_f32_16x16x32_bf16 v[24:27], v[44:47], v[116:119], v[24:27]
    ds_read_b64 v[84:85], v4 offset:1728
    v_mfma_f32_16x16x32_bf16 v[24:27], v[52:55], v[108:111], v[24:27]
    ds_read_b64 v[86:87], v4 offset:1736
    v_mfma_f32_16x16x32_bf16 v[32:35], v[48:51], v[120:123], v[32:35]
    s_waitcnt lgkmcnt(13)
    ds_read_b128 v[140:143], v5 offset:3264
    v_mfma_f32_16x16x32_bf16 v[32:35], v[56:59], v[112:115], v[32:35]
    s_add_u32 m0, s61, 49664
    ds_read_b64 v[76:77], v4 offset:704
    v_mfma_f32_16x16x32_bf16 v[36:39], v[52:55], v[120:123], v[36:39]
    ds_read_b64 v[78:79], v4 offset:712
    buffer_load_dwordx4 v226, s[40:43], s64 offen offset:2048 lds
    v_mfma_f32_16x16x32_bf16 v[36:39], v[56:59], v[116:119], v[36:39]
    s_add_u32 s64, s64, 98304
    ds_read_b128 v[152:155], v5 offset:1728
    v_mfma_f32_16x16x32_bf16 v[28:31], v[44:47], v[120:123], v[28:31]
    s_sub_u32 s35, s64, 1966080
    ds_read_b64 v[88:89], v4 offset:2240
    v_mfma_f32_16x16x32_bf16 v[28:31], v[56:59], v[108:111], v[28:31]
    s_min_u32 s64, s64, s35
    ds_read_b64 v[90:91], v4 offset:2248
    v_mfma_f32_16x16x32_bf16 v[24:27], v[40:43], v[120:123], v[24:27]
    s_waitcnt vmcnt(9)
    s_waitcnt lgkmcnt(10)
    s_barrier
    ds_read_b128 v[136:139], v5 offset:3776
    v_mfma_f32_16x16x32_bf16 v[24:27], v[56:59], v[104:107], v[24:27]
    s_add_u32 m0, s61, 0
    ds_read_b64 v[72:73], v4 offset:192
    ds_read_b64_tr_b16 a[84:85], v227 offset:24832
    v_mfma_f32_16x16x32_bf16 v[36:39], v[48:51], v[124:127], v[36:39]
    ds_read_b64 v[74:75], v4 offset:200
    ds_read_b64_tr_b16 a[86:87], v227 offset:26368
    buffer_load_dwordx4 v224, s[40:43], s64 offen offset:0 lds
    v_mfma_f32_16x16x32_bf16 v[36:39], v[60:63], v[112:115], v[36:39]
    ds_read_b128 v[156:159], v5 offset:1216
    ds_read_b64_tr_b16 a[88:89], v227 offset:31056
    s_waitcnt vmcnt(9)
    v_cmp_ne_u32 vcc, s48, v243
    s_cbranch_vccnz L_chk6_slow
L_chk6_back:
    v_mfma_f32_16x16x32_bf16 v[32:35], v[44:47], v[124:127], v[32:35]
    ds_read_b64 v[92:93], v4 offset:2752
    ds_read_b64_tr_b16 a[90:91], v227 offset:32592
    v_lshlrev_b32 v2, 2, v0
    v_mov_b32 v3, 0x80000000
    v_mfma_f32_16x16x32_bf16 v[32:35], v[60:63], v[108:111], v[32:35]
    ds_read_b64 v[94:95], v4 offset:2760
    ds_read_b64_tr_b16 a[92:93], v228 offset:24832
    v_mfma_f32_16x16x32_bf16 v[28:31], v[40:43], v[124:127], v[28:31]
    ds_read_b128 v[160:163], v5 offset:704
    ds_read_b64_tr_b16 a[94:95], v228 offset:26368
    v_mfma_f32_16x16x32_bf16 v[28:31], v[60:63], v[104:107], v[28:31]
    s_add_u32 m0, s61, 0
    ds_read_b64 v[96:97], v4 offset:3264
    v_cmp_gt_u32 vcc, 128, v0
    s_nop 1
    v_cndmask_b32 v3, v3, v2, vcc
    v_mfma_f32_16x16x32_bf16 v[36:39], v[44:47], v[128:131], v[36:39]
    s_lshl_b32 s56, s34, 7
    ds_read_b64 v[98:99], v4 offset:3272
    buffer_load_dwordx4 v225, s[40:43], s64 offen offset:1024 lds
    v_mfma_f32_16x16x32_bf16 v[36:39], v[64:67], v[108:111], v[36:39]
    s_add_u32 s56, s56, 23183360
    ds_read_b128 v[164:167], v5 offset:192
    v_mfma_f32_16x16x32_bf16 v[32:35], v[40:43], v[128:131], v[32:35]
    ds_read_b64 v[100:101], v4 offset:3776
    buffer_load_dword v220, v2, s[36:39], s56 offen sc1
    v_mfma_f32_16x16x32_bf16 v[32:35], v[64:67], v[104:107], v[32:35]
    ds_read_b64 v[102:103], v4 offset:3784
    buffer_load_dword v221, v2, s[36:39], s56 offen offset:1024 sc1
    v_mfma_f32_16x16x32_bf16 v[36:39], v[40:43], v[132:135], v[36:39]
    s_waitcnt vmcnt(11)
    v_permlane16_swap_b32 v176, v178
    buffer_load_dword v222, v3, s[36:39], s56 offen offset:2048 sc1
    v_mfma_f32_16x16x32_bf16 v[36:39], v[68:71], v[104:107], v[36:39]
    s_waitcnt lgkmcnt(14)
    s_add_u32 m0, s61, 0
    v_permlane16_swap_b32 v177, v179
    v_mfma_f32_16x16x32_bf16 v[24:27], v[80:83], v[144:147], v[24:27]
    ds_read_b128 v[112:115], v5 offset:2816
    buffer_load_dwordx4 v226, s[40:43], s64 offen offset:2048 lds
    v_mfma_f32_16x16x32_bf16 v[28:31], v[80:83], v[148:151], v[28:31]
    s_add_u32 s64, s64, 98304
    ds_read_b64 v[48:49], v4 offset:1280
    s_waitcnt vmcnt(12)
    v_permlane16_swap_b32 v180, v182
    v_mfma_f32_16x16x32_bf16 v[28:31], v[84:87], v[144:147], v[28:31]
    s_sub_u32 s35, s64, 1966080
    ds_read_b64 v[50:51], v4 offset:1288
    v_permlane16_swap_b32 v181, v183
    v_lshlrev_b32 v232, 16, v176
    v_fma_f32 v184, v232, v184, v200
    v_mul_f32 v200, v252, v232
    v_mfma_f32_16x16x32_bf16 v[32:35], v[84:87], v[148:151], v[32:35]
    s_waitcnt vmcnt(9)
    s_waitcnt lgkmcnt(8)
    s_barrier
    ds_read_b128 v[116:119], v5 offset:2304
    v_mfma_f32_16x16x32_bf16 v[24:27], v[76:79], v[148:151], v[24:27]
    s_min_u32 s64, s64, s35
    ds_read_b64 v[52:53], v4 offset:1792
    ds_read_b64_tr_b16 a[96:97], v227 offset:37248
    v_mfma_f32_16x16x32_bf16 v[24:27], v[84:87], v[140:143], v[24:27]
    s_add_u32 m0, s61, 12416
    ds_read_b64 v[54:55], v4 offset:1800
    ds_read_b64_tr_b16 a[98:99], v227 offset:38784
    v_mfma_f32_16x16x32_bf16 v[32:35], v[80:83], v[152:155], v[32:35]
    ds_read_b128 v[108:111], v5 offset:3328
    ds_read_b64_tr_b16 a[100:101], v227 offset:43472
    buffer_load_dwordx4 v224, s[40:43], s64 offen offset:0 lds
    v_mfma_f32_16x16x32_bf16 v[32:35], v[88:91], v[144:147], v[32:35]
    ds_read_b64 v[44:45], v4 offset:768
    ds_read_b64_tr_b16 a[102:103], v227 offset:45008
    v_mfma_f32_16x16x32_bf16 v[36:39], v[84:87], v[152:155], v[36:39]
    ds_read_b64 v[46:47], v4 offset:776
    ds_read_b64_tr_b16 a[104:105], v228 offset:37248
    v_mfma_f32_16x16x32_bf16 v[36:39], v[88:91], v[148:151], v[36:39]
    ds_read_b128 v[120:123], v5 offset:1792
    ds_read_b64_tr_b16 a[106:107], v228 offset:38784
    v_mfma_f32_16x16x32_bf16 v[28:31], v[76:79], v[152:155], v[28:31]
    ds_read_b64 v[56:57], v4 offset:2304
    v_fma_f32 v184, v184, v250, v251
    v_mfma_f32_16x16x32_bf16 v[28:31], v[88:91], v[140:143], v[28:31]
    s_add_u32 m0, s61, 12416
    ds_read_b64 v[58:59], v4 offset:2312
    v_and_b32 v233, 0xffff0000, v176
    v_mfma_f32_16x16x32_bf16 v[24:27], v[72:75], v[152:155], v[24:27]
    ds_read_b128 v[104:107], v5 offset:3840
    buffer_load_dwordx4 v225, s[40:43], s64 offen offset:1024 lds
    v_mfma_f32_16x16x32_bf16 v[24:27], v[88:91], v[136:139], v[24:27]
    ds_read_b64 v[40:41], v4 offset:256
    v_fma_f32 v185, v233, v185, v201
    v_mfma_f32_16x16x32_bf16 v[36:39], v[80:83], v[156:159], v[36:39]
    ds_read_b64 v[42:43], v4 offset:264
    v_mul_f32 v201, v252, v233
    v_mfma_f32_16x16x32_bf16 v[36:39], v[92:95], v[144:147], v[36:39]
    ds_read_b128 v[124:127], v5 offset:1280
    v_fma_f32 v185, v185, v250, v251
    v_mfma_f32_16x16x32_bf16 v[32:35], v[76:79], v[156:159], v[32:35]
    ds_read_b64 v[60:61], v4 offset:2816
    v_lshlrev_b32 v232, 16, v177
    v_mfma_f32_16x16x32_bf16 v[32:35], v[92:95], v[140:143], v[32:35]
    s_add_u32 m0, s61, 12416
    ds_read_b64 v[62:63], v4 offset:2824
    v_fma_f32 v186, v232, v186, v202
    v_mfma_f32_16x16x32_bf16 v[28:31], v[72:75], v[156:159], v[28:31]
    ds_read_b128 v[128:131], v5 offset:768
    buffer_load_dwordx4 v226, s[40:43], s64 offen offset:2048 lds
    v_mfma_f32_16x16x32_bf16 v[28:31], v[92:95], v[136:139], v[28:31]
    s_add_u32 s64, s64, 98304
    ds_read_b64 v[64:65], v4 offset:3328
    v_mul_f32 v202, v252, v232
    v_fma_f32 v186, v186, v250, v251
    v_and_b32 v233, 0xffff0000, v177
    v_mfma_f32_16x16x32_bf16 v[36:39], v[76:79], v[160:163], v[36:39]
    s_waitcnt vmcnt(9)
    s_waitcnt lgkmcnt(10)
    s_barrier
    ds_read_b64 v[66:67], v4 offset:3336
    v_mfma_f32_16x16x32_bf16 v[36:39], v[96:99], v[140:143], v[36:39]
    s_sub_u32 s35, s64, 1966080
    ds_read_b128 v[132:135], v5 offset:256
    ds_read_b64_tr_b16 a[108:109], v227 offset:49664
    v_mfma_f32_16x16x32_bf16 v[32:35], v[72:75], v[160:163], v[32:35]
    s_min_u32 s64, s64, s35
    ds_read_b64 v[68:69], v4 offset:3840
    ds_read_b64_tr_b16 a[110:111], v227 offset:51200
    v_mfma_f32_16x16x32_bf16 v[32:35], v[96:99], v[136:139], v[32:35]
    s_add_u32 m0, s61, 24832
    ds_read_b64 v[70:71], v4 offset:3848
    ds_read_b64_tr_b16 a[112:113], v227 offset:55888
    v_mfma_f32_16x16x32_bf16 v[36:39], v[72:75], v[164:167], v[36:39]
    ds_read_b64_tr_b16 a[114:115], v227 offset:57424
    buffer_load_dwordx4 v224, s[40:43], s64 offen offset:0 lds
    v_mfma_f32_16x16x32_bf16 v[36:39], v[100:103], v[136:139], v[36:39]
    ds_read_b64_tr_b16 a[116:117], v228 offset:49664
    v_fma_f32 v187, v233, v187, v203
    v_mfma_f32_16x16x32_bf16 v[24:27], v[48:51], v[112:115], v[24:27]
    ds_read_b128 v[144:147], v5 offset:2880
    ds_read_b64_tr_b16 a[118:119], v228 offset:51200
    v_mfma_f32_16x16x32_bf16 v[28:31], v[48:51], v[116:119], v[28:31]
    ds_read_b64 v[80:81], v4 offset:1344
    v_mul_f32 v203, v252, v233
    v_mfma_f32_16x16x32_bf16 v[28:31], v[52:55], v[112:115], v[28:31]
    ds_read_b64 v[82:83], v4 offset:1352
    v_fma_f32 v187, v187, v250, v251
    v_mfma_f32_16x16x32_bf16 v[32:35], v[52:55], v[116:119], v[32:35]
    s_add_u32 m0, s61, 24832
    ds_read_b128 v[148:151], v5 offset:2368
    v_lshlrev_b32 v232, 16, v178
    v_mfma_f32_16x16x32_bf16 v[24:27], v[44:47], v[116:119], v[24:27]
    ds_read_b64 v[84:85], v4 offset:1856
    buffer_load_dwordx4 v225, s[40:43], s64 offen offset:1024 lds
    v_mfma_f32_16x16x32_bf16 v[24:27], v[52:55], v[108:111], v[24:27]
    ds_read_b64 v[86:87], v4 offset:1864
    v_fma_f32 v188, v232, v188, v204
    v_mfma_f32_16x16x32_bf16 v[32:35], v[48:51], v[120:123], v[32:35]
    s_waitcnt lgkmcnt(13)
    ds_read_b128 v[140:143], v5 offset:3392
    v_mul_f32 v204, v252, v232
    v_mfma_f32_16x16x32_bf16 v[32:35], v[56:59], v[112:115], v[32:35]
    ds_read_b64 v[76:77], v4 offset:832
    v_fma_f32 v188, v188, v250, v251
    v_mfma_f32_16x16x32_bf16 v[36:39], v[52:55], v[120:123], v[36:39]
    ds_read_b64 v[78:79], v4 offset:840
    v_and_b32 v233, 0xffff0000, v178
    v_mfma_f32_16x16x32_bf16 v[36:39], v[56:59], v[116:119], v[36:39]
    s_add_u32 m0, s61, 24832
    ds_read_b128 v[152:155], v5 offset:1856
    v_fma_f32 v189, v233, v189, v205
    v_mul_f32 v205, v252, v233
    v_fma_f32 v189, v189, v250, v251
    v_mfma_f32_16x16x32_bf16 v[28:31], v[44:47], v[120:123], v[28:31]
    s_waitcnt vmcnt(5)
    s_waitcnt lgkmcnt(9)
    s_barrier
    ds_read_b64 v[88:89], v4 offset:2368
    buffer_load_dwordx4 v226, s[40:43], s64 offen offset:2048 lds
    v_mfma_f32_16x16x32_bf16 v[28:31], v[56:59], v[108:111], v[28:31]
    s_add_u32 s64, s64, 98304
    ds_read_b64 v[90:91], v4 offset:2376
    ds_read_b64_tr_b16 a[120:121], v227 offset:0
    v_mfma_f32_16x16x32_bf16 v[24:27], v[40:43], v[120:123], v[24:27]
    s_sub_u32 s35, s64, 1966080
    ds_read_b128 v[136:139], v5 offset:3904
    ds_read_b64_tr_b16 a[122:123], v227 offset:1536
    v_mfma_f32_16x16x32_bf16 v[24:27], v[56:59], v[104:107], v[24:27]
    s_min_u32 s64, s64, s35
    ds_read_b64 v[72:73], v4 offset:320
    ds_read_b64_tr_b16 a[124:125], v227 offset:6224
    v_mfma_f32_16x16x32_bf16 v[36:39], v[48:51], v[124:127], v[36:39]
    ds_read_b64 v[74:75], v4 offset:328
    ds_read_b64_tr_b16 a[126:127], v227 offset:7760
    v_mfma_f32_16x16x32_bf16 v[36:39], v[60:63], v[112:115], v[36:39]
    s_add_u32 m0, s61, 37248
    ds_read_b128 v[156:159], v5 offset:1344
    ds_read_b64_tr_b16 a[128:129], v228 offset:0
    v_mfma_f32_16x16x32_bf16 v[32:35], v[44:47], v[124:127], v[32:35]
    ds_read_b64 v[92:93], v4 offset:2880
    ds_read_b64_tr_b16 a[130:131], v228 offset:1536
    buffer_load_dwordx4 v224, s[40:43], s64 offen offset:0 lds
    v_mfma_f32_16x16x32_bf16 v[32:35], v[60:63], v[108:111], v[32:35]
    ds_read_b64 v[94:95], v4 offset:2888
    v_lshlrev_b32 v232, 16, v179
    v_mfma_f32_16x16x32_bf16 v[28:31], v[40:43], v[124:127], v[28:31]
    ds_read_b128 v[160:163], v5 offset:832
    v_fma_f32 v190, v232, v190, v206
    v_mfma_f32_16x16x32_bf16 v[28:31], v[60:63], v[104:107], v[28:31]
    ds_read_b64 v[96:97], v4 offset:3392
    v_mul_f32 v206, v252, v232
    v_mfma_f32_16x16x32_bf16 v[36:39], v[44:47], v[128:131], v[36:39]
    ds_read_b64 v[98:99], v4 offset:3400
    v_fma_f32 v190, v190, v250, v251
    v_mfma_f32_16x16x32_bf16 v[36:39], v[64:67], v[108:111], v[36:39]
    s_add_u32 m0, s61, 37248
    ds_read_b128 v[164:167], v5 offset:320
    v_and_b32 v233, 0xffff0000, v179
    v_mfma_f32_16x16x32_bf16 v[32:35], v[40:43], v[128:131], v[32:35]
    ds_read_b64 v[100:101], v4 offset:3904
    buffer_load_dwordx4 v225, s[40:43], s64 offen offset:1024 lds
    v_mfma_f32_16x16x32_bf16 v[32:35], v[64:67], v[104:107], v[32:35]
    ds_read_b64 v[102:103], v4 offset:3912
    v_fma_f32 v191, v233, v191, v207
    v_mfma_f32_16x16x32_bf16 v[36:39], v[40:43], v[132:135], v[36:39]
    v_mul_f32 v207, v252, v233
    v_fma_f32 v191, v191, v250, v251
    v_mfma_f32_16x16x32_bf16 v[36:39], v[68:71], v[104:107], v[36:39]
    s_waitcnt lgkmcnt(14)
    v_lshlrev_b32 v232, 16, v180
    v_fma_f32 v192, v232, v192, v208
    v_mfma_f32_16x16x32_bf16 v[24:27], v[80:83], v[144:147], v[24:27]
    ds_read_b128 v[112:115], v5 offset:2944
    v_mul_f32 v208, v252, v232
    v_fma_f32 v192, v192, v250, v251
    v_mfma_f32_16x16x32_bf16 v[28:31], v[80:83], v[148:151], v[28:31]
    s_waitcnt vmcnt(5)
    s_waitcnt lgkmcnt(8)
    s_barrier
    ds_read_b64 v[48:49], v4 offset:1408
    ds_read_b64_tr_b16 a[132:133], v227 offset:12416
    v_mfma_f32_16x16x32_bf16 v[28:31], v[84:87], v[144:147], v[28:31]
    s_add_u32 m0, s61, 37248
    ds_read_b64 v[50:51], v4 offset:1416
    buffer_load_dword v223, v219, s[36:39], s17 offen sc1
    v_mfma_f32_16x16x32_bf16 v[32:35], v[84:87], v[148:151], v[32:35]
    ds_read_b128 v[116:119], v5 offset:2432
    ds_read_b64_tr_b16 a[134:135], v227 offset:13952
    buffer_load_dwordx4 v226, s[40:43], s64 offen offset:2048 lds
    v_mfma_f32_16x16x32_bf16 v[24:27], v[76:79], v[148:151], v[24:27]
    s_add_u32 s64, s64, 98304
    ds_read_b64 v[52:53], v4 offset:1920
    ds_read_b64_tr_b16 a[136:137], v227 offset:18640
    v_mfma_f32_16x16x32_bf16 v[24:27], v[84:87], v[140:143], v[24:27]
    s_sub_u32 s35, s64, 1966080
    ds_read_b64 v[54:55], v4 offset:1928
    ds_read_b64_tr_b16 a[138:139], v227 offset:20176
    v_mfma_f32_16x16x32_bf16 v[32:35], v[80:83], v[152:155], v[32:35]
    s_min_u32 s64, s64, s35
    ds_read_b128 v[108:111], v5 offset:3456
    ds_read_b64_tr_b16 a[140:141], v228 offset:12416
    v_mfma_f32_16x16x32_bf16 v[32:35], v[88:91], v[144:147], v[32:35]
    s_add_u32 m0, s61, 49664
    ds_read_b64 v[44:45], v4 offset:896
    ds_read_b64_tr_b16 a[142:143], v228 offset:13952
    v_mfma_f32_16x16x32_bf16 v[36:39], v[84:87], v[152:155], v[36:39]
    ds_read_b64 v[46:47], v4 offset:904
    buffer_load_dwordx4 v224, s[40:43], s64 offen offset:0 lds
    v_mfma_f32_16x16x32_bf16 v[36:39], v[88:91], v[148:151], v[36:39]
    ds_read_b128 v[120:123], v5 offset:1920
    v_and_b32 v233, 0xffff0000, v180
    v_mfma_f32_16x16x32_bf16 v[28:31], v[76:79], v[152:155], v[28:31]
    ds_read_b64 v[56:57], v4 offset:2432
    v_fma_f32 v193, v233, v193, v209
    v_mfma_f32_16x16x32_bf16 v[28:31], v[88:91], v[140:143], v[28:31]
    ds_read_b64 v[58:59], v4 offset:2440
    v_mul_f32 v209, v252, v233
    v_mfma_f32_16x16x32_bf16 v[24:27], v[72:75], v[152:155], v[24:27]
    ds_read_b128 v[104:107], v5 offset:3968
    v_fma_f32 v193, v193, v250, v251
    v_mfma_f32_16x16x32_bf16 v[24:27], v[88:91], v[136:139], v[24:27]
    s_add_u32 m0, s61, 49664
    ds_read_b64 v[40:41], v4 offset:384
    v_lshlrev_b32 v232, 16, v181
    v_mfma_f32_16x16x32_bf16 v[36:39], v[80:83], v[156:159], v[36:39]
    s_waitcnt lgkmcnt(13)
    ds_read_b64 v[42:43], v4 offset:392
    buffer_load_dwordx4 v225, s[40:43], s64 offen offset:1024 lds
    v_mfma_f32_16x16x32_bf16 v[36:39], v[92:95], v[144:147], v[36:39]
    ds_read_b128 v[124:127], v5 offset:1408
    v_fma_f32 v194, v232, v194, v210
    v_mfma_f32_16x16x32_bf16 v[32:35], v[76:79], v[156:159], v[32:35]
    ds_read_b64 v[60:61], v4 offset:2944
    v_mul_f32 v210, v252, v232
    v_mfma_f32_16x16x32_bf16 v[32:35], v[92:95], v[140:143], v[32:35]
    ds_read_b64 v[62:63], v4 offset:2952
    v_fma_f32 v194, v194, v250, v251
    v_and_b32 v233, 0xffff0000, v181
    v_fma_f32 v195, v233, v195, v211
    v_mfma_f32_16x16x32_bf16 v[28:31], v[72:75], v[156:159], v[28:31]
    s_waitcnt vmcnt(6)
    s_waitcnt lgkmcnt(10)
    s_barrier
    ds_read_b128 v[128:131], v5 offset:896
    v_mfma_f32_16x16x32_bf16 v[28:31], v[92:95], v[136:139], v[28:31]
    s_add_u32 m0, s61, 49664
    ds_read_b64 v[64:65], v4 offset:3456
    ds_read_b64_tr_b16 a[144:145], v227 offset:24832
    v_mfma_f32_16x16x32_bf16 v[36:39], v[76:79], v[160:163], v[36:39]
    ds_read_b64 v[66:67], v4 offset:3464
    ds_read_b64_tr_b16 a[146:147], v227 offset:26368
    buffer_load_dwordx4 v226, s[40:43], s64 offen offset:2048 lds
    v_mfma_f32_16x16x32_bf16 v[36:39], v[96:99], v[140:143], v[36:39]
    s_add_u32 s64, s64, 98304
    ds_read_b128 v[132:135], v5 offset:384
    ds_read_b64_tr_b16 a[148:149], v227 offset:31056
    v_mfma_f32_16x16x32_bf16 v[32:35], v[72:75], v[160:163], v[32:35]
    s_sub_u32 s35, s64, 1966080
    ds_read_b64 v[68:69], v4 offset:3968
    ds_read_b64_tr_b16 a[150:151], v227 offset:32592
    v_mfma_f32_16x16x32_bf16 v[32:35], v[96:99], v[136:139], v[32:35]
    s_min_u32 s64, s64, s35
    ds_read_b64 v[70:71], v4 offset:3976
    ds_read_b64_tr_b16 a[152:153], v228 offset:24832
    v_mfma_f32_16x16x32_bf16 v[36:39], v[72:75], v[164:167], v[36:39]
    ds_read_b64_tr_b16 a[154:155], v228 offset:26368
    v_mul_f32 v211, v252, v233
    v_mfma_f32_16x16x32_bf16 v[36:39], v[100:103], v[136:139], v[36:39]
    v_fma_f32 v195, v195, v250, v251
    v_lshlrev_b32 v232, 16, v182
    v_mfma_f32_16x16x32_bf16 v[24:27], v[48:51], v[112:115], v[24:27]
    ds_read_b128 v[144:147], v5 offset:3008
    v_fma_f32 v196, v232, v196, v212
    v_mfma_f32_16x16x32_bf16 v[28:31], v[48:51], v[116:119], v[28:31]
    ds_read_b64 v[80:81], v4 offset:1472
    v_mul_f32 v212, v252, v232
    v_mfma_f32_16x16x32_bf16 v[28:31], v[52:55], v[112:115], v[28:31]
    ds_read_b64 v[82:83], v4 offset:1480
    v_fma_f32 v196, v196, v250, v251
    v_mfma_f32_16x16x32_bf16 v[32:35], v[52:55], v[116:119], v[32:35]
    s_waitcnt lgkmcnt(13)
    ds_read_b128 v[148:151], v5 offset:2496
    v_and_b32 v233, 0xffff0000, v182
    v_mfma_f32_16x16x32_bf16 v[24:27], v[44:47], v[116:119], v[24:27]
    ds_read_b64 v[84:85], v4 offset:1984
    v_fma_f32 v197, v233, v197, v213
    v_mfma_f32_16x16x32_bf16 v[24:27], v[52:55], v[108:111], v[24:27]
    ds_read_b64 v[86:87], v4 offset:1992
    v_mul_f32 v213, v252, v233
    v_mfma_f32_16x16x32_bf16 v[32:35], v[48:51], v[120:123], v[32:35]
    s_add_u32 m0, s63, 0
    ds_read_b128 v[140:143], v5 offset:3520
    s_waitcnt vmcnt(4)
    v_cmp_ne_u32 vcc, s48, v223
    s_cbranch_vccnz L_chk7_slow
L_chk7_back:
    v_mfma_f32_16x16x32_bf16 v[32:35], v[56:59], v[112:115], v[32:35]
    ds_read_b64 v[76:77], v4 offset:960
    buffer_load_dwordx4 v172, s[36:39], s10 offen sc1 lds
    v_mfma_f32_16x16x32_bf16 v[36:39], v[52:55], v[120:123], v[36:39]
    ds_read_b64 v[78:79], v4 offset:968
    v_fma_f32 v197, v197, v250, v251
    v_lshlrev_b32 v232, 16, v183
    v_mfma_f32_16x16x32_bf16 v[36:39], v[56:59], v[116:119], v[36:39]
    s_waitcnt vmcnt(4)
    s_waitcnt lgkmcnt(9)
    s_barrier
    ds_read_b128 v[152:155], v5 offset:1984
    v_mfma_f32_16x16x32_bf16 v[28:31], v[44:47], v[120:123], v[28:31]
    s_add_u32 m0, s63, 4096
    ds_read_b64 v[88:89], v4 offset:2496
    ds_read_b64_tr_b16 a[156:157], v227 offset:37248
    v_mfma_f32_16x16x32_bf16 v[28:31], v[56:59], v[108:111], v[28:31]
    ds_read_b64 v[90:91], v4 offset:2504
    ds_read_b64_tr_b16 a[158:159], v227 offset:38784
    buffer_load_dwordx4 v172, s[36:39], s11 offen sc1 lds
    v_mfma_f32_16x16x32_bf16 v[24:27], v[40:43], v[120:123], v[24:27]
    ds_read_b128 v[136:139], v5 offset:4032
    ds_read_b64_tr_b16 a[160:161], v227 offset:43472
    v_mfma_f32_16x16x32_bf16 v[24:27], v[56:59], v[104:107], v[24:27]
    ds_read_b64 v[72:73], v4 offset:448
    ds_read_b64_tr_b16 a[162:163], v227 offset:45008
    v_mfma_f32_16x16x32_bf16 v[36:39], v[48:51], v[124:127], v[36:39]
    s_add_u32 m0, s63, 8192
    ds_read_b64 v[74:75], v4 offset:456
    ds_read_b64_tr_b16 a[164:165], v228 offset:37248
    v_mfma_f32_16x16x32_bf16 v[36:39], v[60:63], v[112:115], v[36:39]
    ds_read_b128 v[156:159], v5 offset:1472
    ds_read_b64_tr_b16 a[166:167], v228 offset:38784
    buffer_load_dwordx4 v172, s[36:39], s12 offen sc1 lds
    v_mfma_f32_16x16x32_bf16 v[32:35], v[44:47], v[124:127], v[32:35]
    ds_read_b64 v[92:93], v4 offset:3008
    v_fma_f32 v198, v232, v198, v214
    v_mfma_f32_16x16x32_bf16 v[32:35], v[60:63], v[108:111], v[32:35]
    ds_read_b64 v[94:95], v4 offset:3016
    v_mul_f32 v214, v252, v232
    v_mfma_f32_16x16x32_bf16 v[28:31], v[40:43], v[124:127], v[28:31]
    s_add_u32 m0, s63, 12288
    ds_read_b128 v[160:163], v5 offset:960
    v_fma_f32 v198, v198, v250, v251
    v_mfma_f32_16x16x32_bf16 v[28:31], v[60:63], v[104:107], v[28:31]
    ds_read_b64 v[96:97], v4 offset:3520
    buffer_load_dwordx4 v172, s[36:39], s13 offen sc1 lds
    v_mfma_f32_16x16x32_bf16 v[36:39], v[44:47], v[128:131], v[36:39]
    ds_read_b64 v[98:99], v4 offset:3528
    v_and_b32 v233, 0xffff0000, v183
    v_mfma_f32_16x16x32_bf16 v[36:39], v[64:67], v[108:111], v[36:39]
    ds_read_b128 v[164:167], v5 offset:448
    v_fma_f32 v199, v233, v199, v215
    v_mfma_f32_16x16x32_bf16 v[32:35], v[40:43], v[128:131], v[32:35]
    s_add_u32 m0, s63, 16384
    ds_read_b64 v[100:101], v4 offset:4032
    v_mul_f32 v215, v252, v233
    v_mfma_f32_16x16x32_bf16 v[32:35], v[64:67], v[104:107], v[32:35]
    ds_read_b64 v[102:103], v4 offset:4040
    buffer_load_dwordx4 v172, s[36:39], s14 offen sc1 lds
    v_mfma_f32_16x16x32_bf16 v[36:39], v[40:43], v[132:135], v[36:39]
    v_fma_f32 v199, v199, v250, v251
    v_mfma_f32_16x16x32_bf16 v[36:39], v[68:71], v[104:107], v[36:39]
    s_waitcnt lgkmcnt(14)
    v_mfma_f32_16x16x32_bf16 v[24:27], v[80:83], v[144:147], v[24:27]
    s_waitcnt vmcnt(5)
    s_waitcnt lgkmcnt(8)
    s_barrier
    s_add_u32 m0, s63, 20480
    ds_read_b64_tr_b16 a[168:169], v227 offset:49664
    v_mfma_f32_16x16x32_bf16 v[28:31], v[80:83], v[148:151], v[28:31]
    ds_read_b64_tr_b16 a[170:171], v227 offset:51200
    buffer_load_dwordx4 v172, s[36:39], s15 offen sc1 lds
    v_mfma_f32_16x16x32_bf16 v[28:31], v[84:87], v[144:147], v[28:31]
    ds_read_b64_tr_b16 a[172:173], v227 offset:55888
    v_mfma_f32_16x16x32_bf16 v[32:35], v[84:87], v[148:151], v[32:35]
    ds_read_b64_tr_b16 a[174:175], v227 offset:57424
    v_mfma_f32_16x16x32_bf16 v[24:27], v[76:79], v[148:151], v[24:27]
    s_add_u32 m0, s63, 24576
    ds_read_b64_tr_b16 a[176:177], v228 offset:49664
    v_mfma_f32_16x16x32_bf16 v[24:27], v[84:87], v[140:143], v[24:27]
    ds_read_b64_tr_b16 a[178:179], v228 offset:51200
    buffer_load_dwordx4 v172, s[36:39], s18 offen sc1 lds
    v_mfma_f32_16x16x32_bf16 v[32:35], v[80:83], v[152:155], v[32:35]
    v_mfma_f32_16x16x32_bf16 v[32:35], v[88:91], v[144:147], v[32:35]
    v_mfma_f32_16x16x32_bf16 v[36:39], v[84:87], v[152:155], v[36:39]
    s_add_u32 m0, s63, 28672
    v_mfma_f32_16x16x32_bf16 v[36:39], v[88:91], v[148:151], v[36:39]
    s_waitcnt lgkmcnt(0)
    s_barrier
    buffer_load_dwordx4 v172, s[36:39], s19 offen sc1 lds
    v_mfma_f32_16x16x32_bf16 v[28:31], v[76:79], v[152:155], v[28:31]
    v_mfma_f32_16x16x32_bf16 v[28:31], v[88:91], v[140:143], v[28:31]
    v_mfma_f32_16x16x32_bf16 v[24:27], v[72:75], v[152:155], v[24:27]
    s_add_u32 m0, s63, 32768
    v_mfma_f32_16x16x32_bf16 v[24:27], v[88:91], v[136:139], v[24:27]
    buffer_load_dwordx4 v172, s[36:39], s20 offen sc1 lds
    v_mfma_f32_16x16x32_bf16 v[36:39], v[80:83], v[156:159], v[36:39]
    v_mfma_f32_16x16x32_bf16 v[36:39], v[92:95], v[144:147], v[36:39]
    v_mfma_f32_16x16x32_bf16 v[32:35], v[76:79], v[156:159], v[32:35]
    s_add_u32 m0, s63, 36864
    v_mfma_f32_16x16x32_bf16 v[32:35], v[92:95], v[140:143], v[32:35]
    buffer_load_dwordx4 v172, s[36:39], s21 offen sc1 lds
    v_mfma_f32_16x16x32_bf16 v[28:31], v[72:75], v[156:159], v[28:31]
    v_mfma_f32_16x16x32_bf16 v[28:31], v[92:95], v[136:139], v[28:31]
    v_mfma_f32_16x16x32_bf16 v[36:39], v[76:79], v[160:163], v[36:39]
    s_add_u32 m0, s63, 40960
    v_mfma_f32_16x16x32_bf16 v[36:39], v[96:99], v[140:143], v[36:39]
    buffer_load_dwordx4 v172, s[36:39], s22 offen sc1 lds
    v_mfma_f32_16x16x32_bf16 v[32:35], v[72:75], v[160:163], v[32:35]
    v_mfma_f32_16x16x32_bf16 v[32:35], v[96:99], v[136:139], v[32:35]
    v_mfma_f32_16x16x32_bf16 v[36:39], v[72:75], v[164:167], v[36:39]
    v_mfma_f32_16x16x32_bf16 v[36:39], v[100:103], v[136:139], v[36:39]
    s_waitcnt vmcnt(8)
    s_waitcnt lgkmcnt(0)
    s_barrier
    ds_read_b64_tr_b16 v[104:105], v168 offset:0
    ds_read_b64_tr_b16 v[106:107], v168 offset:2048
    ds_read_b64_tr_b16 v[108:109], v169 offset:0
    ds_read_b64_tr_b16 v[110:111], v169 offset:2048
    ds_read_b64_tr_b16 v[112:113], v170 offset:0
    ds_read_b64_tr_b16 v[114:115], v170 offset:2048
    ds_read_b64_tr_b16 v[116:117], v171 offset:0
    ds_read_b64_tr_b16 v[118:119], v171 offset:2048
    v_pk_fma_f32 v[184:185], v[184:185], v[24:25], v[200:201]
    v_pk_fma_f32 v[186:187], v[186:187], v[26:27], v[202:203]
    v_cvt_pk_bf16_f32 v232, v184, v185
    v_cvt_pk_bf16_f32 v233, v186, v187
    v_pk_fma_f32 v[188:189], v[188:189], v[28:29], v[204:205]
    v_pk_fma_f32 v[190:191], v[190:191], v[30:31], v[206:207]
    v_cvt_pk_bf16_f32 v234, v188, v189
    v_cvt_pk_bf16_f32 v235, v190, v191
    s_nop 0
    v_permlane16_swap_b32 v232, v234
    v_permlane16_swap_b32 v233, v235
    buffer_store_dwordx4 v[232:235], v231, s[36:39], s68 offen offset:2048 sc1
    v_pk_fma_f32 v[192:193], v[192:193], v[32:33], v[208:209]
    v_pk_fma_f32 v[194:195], v[194:195], v[34:35], v[210:211]
    v_cvt_pk_bf16_f32 v236, v192, v193
    v_cvt_pk_bf16_f32 v237, v194, v195
    v_pk_fma_f32 v[196:197], v[196:197], v[36:37], v[212:213]
    v_pk_fma_f32 v[198:199], v[198:199], v[38:39], v[214:215]
    v_cvt_pk_bf16_f32 v238, v196, v197
    v_cvt_pk_bf16_f32 v239, v198, v199
    s_nop 0
    v_permlane16_swap_b32 v236, v238
    v_permlane16_swap_b32 v237, v239
    buffer_store_dwordx4 v[236:239], v231, s[36:39], s68 offen offset:3072 sc1
    v_mov_b32 v200, v224
    v_mov_b32 v201, v225
    v_mov_b32 v202, v226
    v_add_u32 v203, 101760, v227
    v_add_u32 v204, 101760, v228
    s_waitcnt lgkmcnt(6)
    v_mfma_f32_16x16x32_bf16 v[56:59], a[0:3], v[104:107], 0
    ds_read_b64_tr_b16 v[120:121], v168 offset:4096
    v_mfma_f32_16x16x32_bf16 v[60:63], a[4:7], v[104:107], 0
    ds_read_b64_tr_b16 v[122:123], v168 offset:6144
    v_mfma_f32_16x16x32_bf16 v[64:67], a[8:11], v[104:107], 0
    s_waitcnt lgkmcnt(6)
    s_add_u32 m0, s61, 101760
    ds_read_b64_tr_b16 v[124:125], v169 offset:4096
    v_mfma_f32_16x16x32_bf16 v[68:71], a[0:3], v[108:111], 0
    buffer_load_dwordx4 v200, s[40:43], s64 offen offset:0 lds
    v_mfma_f32_16x16x32_bf16 v[72:75], a[4:7], v[108:111], 0
    ds_read_b64_tr_b16 v[126:127], v169 offset:6144
    v_mfma_f32_16x16x32_bf16 v[76:79], a[8:11], v[108:111], 0
    s_waitcnt lgkmcnt(6)
    ds_read_b64_tr_b16 v[128:129], v170 offset:4096
    v_mfma_f32_16x16x32_bf16 v[80:83], a[0:3], v[112:115], 0
    s_add_u32 m0, s61, 101760
    ds_read_b64_tr_b16 v[130:131], v170 offset:6144
    v_mfma_f32_16x16x32_bf16 v[84:87], a[4:7], v[112:115], 0
    buffer_load_dwordx4 v201, s[40:43], s64 offen offset:1024 lds
    v_mfma_f32_16x16x32_bf16 v[88:91], a[8:11], v[112:115], 0
    s_waitcnt lgkmcnt(6)
    ds_read_b64_tr_b16 v[132:133], v171 offset:4096
    v_mfma_f32_16x16x32_bf16 v[92:95], a[0:3], v[116:119], 0
    s_waitcnt lgkmcnt(3)
    ds_read_b64_tr_b16 v[134:135], v171 offset:6144
    v_mfma_f32_16x16x32_bf16 v[96:99], a[4:7], v[116:119], 0
    v_mfma_f32_16x16x32_bf16 v[100:103], a[8:11], v[116:119], 0
    v_mfma_f32_16x16x32_bf16 v[56:59], a[12:15], v[120:123], v[56:59]
    ds_read_b64_tr_b16 v[104:105], v168 offset:8192
    v_mfma_f32_16x16x32_bf16 v[60:63], a[16:19], v[120:123], v[60:63]
    ds_read_b64_tr_b16 v[106:107], v168 offset:10240
    v_mfma_f32_16x16x32_bf16 v[64:67], a[20:23], v[120:123], v[64:67]
    s_add_u32 m0, s61, 101760
    ds_read_b64_tr_b16 v[108:109], v169 offset:8192
    v_mfma_f32_16x16x32_bf16 v[68:71], a[12:15], v[124:127], v[68:71]
    buffer_load_dwordx4 v202, s[40:43], s64 offen offset:2048 lds
    v_mfma_f32_16x16x32_bf16 v[72:75], a[16:19], v[124:127], v[72:75]
    s_add_u32 s64, s64, 98304
    ds_read_b64_tr_b16 v[110:111], v169 offset:10240
    v_mfma_f32_16x16x32_bf16 v[76:79], a[20:23], v[124:127], v[76:79]
    s_waitcnt lgkmcnt(6)
    s_sub_u32 s35, s64, 1966080
    ds_read_b64_tr_b16 v[112:113], v170 offset:8192
    v_mfma_f32_16x16x32_bf16 v[80:83], a[12:15], v[128:131], v[80:83]
    s_min_u32 s64, s64, s35
    s_add_u32 m0, s63, 45056
    ds_read_b64_tr_b16 v[114:115], v170 offset:10240
    v_mfma_f32_16x16x32_bf16 v[84:87], a[16:19], v[128:131], v[84:87]
    buffer_load_dwordx4 v172, s[36:39], s23 offen sc1 lds
    v_mfma_f32_16x16x32_bf16 v[88:91], a[20:23], v[128:131], v[88:91]
    s_waitcnt lgkmcnt(6)
    ds_read_b64_tr_b16 v[116:117], v171 offset:8192
    v_mfma_f32_16x16x32_bf16 v[92:95], a[12:15], v[132:135], v[92:95]
    s_waitcnt lgkmcnt(3)
    ds_read_b64_tr_b16 v[118:119], v171 offset:10240
    v_mfma_f32_16x16x32_bf16 v[96:99], a[16:19], v[132:135], v[96:99]
    s_add_u32 m0, s63, 49152
    v_mfma_f32_16x16x32_bf16 v[100:103], a[20:23], v[132:135], v[100:103]
    buffer_load_dwordx4 v172, s[36:39], s24 offen sc1 lds
    v_mfma_f32_16x16x32_bf16 v[56:59], a[24:27], v[104:107], v[56:59]
    s_waitcnt vmcnt(10)
    s_barrier
    ds_read_b64_tr_b16 v[120:121], v168 offset:12288
    v_mfma_f32_16x16x32_bf16 v[60:63], a[28:31], v[104:107], v[60:63]
    ds_read_b64_tr_b16 v[122:123], v168 offset:14336
    v_mfma_f32_16x16x32_bf16 v[64:67], a[32:35], v[104:107], v[64:67]
    s_add_u32 m0, s63, 53248
    ds_read_b64_tr_b16 v[124:125], v169 offset:12288
    v_mfma_f32_16x16x32_bf16 v[68:71], a[24:27], v[108:111], v[68:71]
    buffer_load_dwordx4 v172, s[36:39], s25 offen sc1 lds
    v_mfma_f32_16x16x32_bf16 v[72:75], a[28:31], v[108:111], v[72:75]
    ds_read_b64_tr_b16 v[126:127], v169 offset:14336
    v_mfma_f32_16x16x32_bf16 v[76:79], a[32:35], v[108:111], v[76:79]
    s_waitcnt lgkmcnt(6)
    ds_read_b64_tr_b16 v[128:129], v170 offset:12288
    v_mfma_f32_16x16x32_bf16 v[80:83], a[24:27], v[112:115], v[80:83]
    s_add_u32 m0, s63, 57344
    ds_read_b64_tr_b16 v[130:131], v170 offset:14336
    v_mfma_f32_16x16x32_bf16 v[84:87], a[28:31], v[112:115], v[84:87]
    buffer_load_dwordx4 v172, s[36:39], s26 offen sc1 lds
    v_mfma_f32_16x16x32_bf16 v[88:91], a[32:35], v[112:115], v[88:91]
    s_waitcnt lgkmcnt(6)
    ds_read_b64_tr_b16 v[132:133], v171 offset:12288
    v_mfma_f32_16x16x32_bf16 v[92:95], a[24:27], v[116:119], v[92:95]
    s_waitcnt lgkmcnt(3)
    ds_read_b64_tr_b16 v[134:135], v171 offset:14336
    v_mfma_f32_16x16x32_bf16 v[96:99], a[28:31], v[116:119], v[96:99]
    s_add_u32 m0, s63, 61440
    v_mfma_f32_16x16x32_bf16 v[100:103], a[32:35], v[116:119], v[100:103]
    s_waitcnt vmcnt(7)
    s_barrier
    s_cmp_eq_u32 s3, 0
    s_cbranch_scc0 L_wf8
    s_lshl_b32 s54, s70, 7
    s_add_u32 s54, s54, 23266304
    v_mov_b32 v254, 0
    v_mov_b32 v255, s48
    s_mov_b64 exec, 1
    buffer_store_dword v255, v254, s[36:39], s54 offen sc1
    s_mov_b64 exec, -1
L_wf8:
    buffer_load_dwordx4 v172, s[36:39], s27 offen sc1 lds
    v_mfma_f32_16x16x32_bf16 v[56:59], a[36:39], v[120:123], v[56:59]
    ds_read_b64_tr_b16 v[104:105], v168 offset:16384
    v_mfma_f32_16x16x32_bf16 v[60:63], a[40:43], v[120:123], v[60:63]
    ds_read_b64_tr_b16 v[106:107], v168 offset:18432
    v_mfma_f32_16x16x32_bf16 v[64:67], a[44:47], v[120:123], v[64:67]
    s_add_u32 m0, s63, 65536
    ds_read_b64_tr_b16 v[108:109], v169 offset:16384
    v_mfma_f32_16x16x32_bf16 v[68:71], a[36:39], v[124:127], v[68:71]
    buffer_load_dwordx4 v172, s[36:39], s44 offen sc1 lds
    v_mfma_f32_16x16x32_bf16 v[72:75], a[40:43], v[124:127], v[72:75]
    ds_read_b64_tr_b16 v[110:111], v169 offset:18432
    v_mfma_f32_16x16x32_bf16 v[76:79], a[44:47], v[124:127], v[76:79]
    s_waitcnt lgkmcnt(6)
    ds_read_b64_tr_b16 v[112:113], v170 offset:16384
    v_mfma_f32_16x16x32_bf16 v[80:83], a[36:39], v[128:131], v[80:83]
    s_add_u32 m0, s63, 69632
    ds_read_b64_tr_b16 v[114:115], v170 offset:18432
    v_mfma_f32_16x16x32_bf16 v[84:87], a[40:43], v[128:131], v[84:87]
    buffer_load_dwordx4 v172, s[36:39], s45 offen sc1 lds
    v_mfma_f32_16x16x32_bf16 v[88:91], a[44:47], v[128:131], v[88:91]
    s_waitcnt lgkmcnt(6)
    ds_read_b64_tr_b16 v[116:117], v171 offset:16384
    v_mfma_f32_16x16x32_bf16 v[92:95], a[36:39], v[132:135], v[92:95]
    s_waitcnt lgkmcnt(3)
    ds_read_b64_tr_b16 v[118:119], v171 offset:18432
    v_mfma_f32_16x16x32_bf16 v[96:99], a[40:43], v[132:135], v[96:99]
    s_add_u32 m0, s63, 73728
    v_mfma_f32_16x16x32_bf16 v[100:103], a[44:47], v[132:135], v[100:103]
    buffer_load_dwordx4 v172, s[36:39], s46 offen sc1 lds
    v_mfma_f32_16x16x32_bf16 v[56:59], a[48:51], v[104:107], v[56:59]
    ds_read_b64_tr_b16 v[120:121], v168 offset:20480
    v_mfma_f32_16x16x32_bf16 v[60:63], a[52:55], v[104:107], v[60:63]
    ds_read_b64_tr_b16 v[122:123], v168 offset:22528
    v_mfma_f32_16x16x32_bf16 v[64:67], a[56:59], v[104:107], v[64:67]
    s_add_u32 m0, s63, 77824
    ds_read_b64_tr_b16 v[124:125], v169 offset:20480
    v_mfma_f32_16x16x32_bf16 v[68:71], a[48:51], v[108:111], v[68:71]
    buffer_load_dwordx4 v172, s[36:39], s47 offen sc1 lds
    v_mfma_f32_16x16x32_bf16 v[72:75], a[52:55], v[108:111], v[72:75]
    ds_read_b64_tr_b16 v[126:127], v169 offset:22528
    v_add_u32 v172, 2048, v172
    v_mfma_f32_16x16x32_bf16 v[76:79], a[56:59], v[108:111], v[76:79]
    s_waitcnt lgkmcnt(6)
    ds_read_b64_tr_b16 v[128:129], v170 offset:20480
    v_mfma_f32_16x16x32_bf16 v[80:83], a[48:51], v[112:115], v[80:83]
    s_add_u32 m0, s61, 114176
    ds_read_b64_tr_b16 v[130:131], v170 offset:22528
    v_min_u32 v243, 11, v1
    v_mfma_f32_16x16x32_bf16 v[84:87], a[52:55], v[112:115], v[84:87]
    buffer_load_dwordx4 v200, s[40:43], s64 offen offset:0 lds
    v_mfma_f32_16x16x32_bf16 v[88:91], a[56:59], v[112:115], v[88:91]
    s_waitcnt lgkmcnt(6)
    ds_read_b64_tr_b16 v[132:133], v171 offset:20480
    v_lshlrev_b32 v243, 8, v243
    v_mfma_f32_16x16x32_bf16 v[92:95], a[48:51], v[116:119], v[92:95]
    s_waitcnt lgkmcnt(3)
    ds_read_b64_tr_b16 v[134:135], v171 offset:22528
    v_mfma_f32_16x16x32_bf16 v[96:99], a[52:55], v[116:119], v[96:99]
    v_mfma_f32_16x16x32_bf16 v[100:103], a[56:59], v[116:119], v[100:103]
    v_mfma_f32_16x16x32_bf16 v[56:59], a[60:63], v[120:123], v[56:59]
    s_mul_i32 s58, s3, 24
    s_lshr_b32 s57, s75, 2
    ds_read_b64_tr_b16 v[104:105], v168 offset:24576
    v_mfma_f32_16x16x32_bf16 v[60:63], a[64:67], v[120:123], v[60:63]
    s_add_u32 s58, s58, s57
    s_lshl_b32 s58, s58, 7
    ds_read_b64_tr_b16 v[106:107], v168 offset:26624
    v_mfma_f32_16x16x32_bf16 v[64:67], a[68:71], v[120:123], v[64:67]
    s_add_u32 s58, s58, 23233536
    ds_read_b64_tr_b16 v[108:109], v169 offset:24576
    v_mfma_f32_16x16x32_bf16 v[68:71], a[60:63], v[124:127], v[68:71]
    buffer_load_dword v244, v243, s[36:39], s58 offen sc1
    v_mfma_f32_16x16x32_bf16 v[72:75], a[64:67], v[124:127], v[72:75]
    ds_read_b64_tr_b16 v[110:111], v169 offset:26624
    v_mfma_f32_16x16x32_bf16 v[76:79], a[68:71], v[124:127], v[76:79]
    s_waitcnt lgkmcnt(6)
    ds_read_b64_tr_b16 v[112:113], v170 offset:24576
    v_mfma_f32_16x16x32_bf16 v[80:83], a[60:63], v[128:131], v[80:83]
    s_add_u32 m0, s61, 114176
    ds_read_b64_tr_b16 v[114:115], v170 offset:26624
    v_mfma_f32_16x16x32_bf16 v[84:87], a[64:67], v[128:131], v[84:87]
    buffer_load_dwordx4 v201, s[40:43], s64 offen offset:1024 lds
    v_mfma_f32_16x16x32_bf16 v[88:91], a[68:71], v[128:131], v[88:91]
    s_waitcnt lgkmcnt(6)
    ds_read_b64_tr_b16 v[116:117], v171 offset:24576
    v_mfma_f32_16x16x32_bf16 v[92:95], a[60:63], v[132:135], v[92:95]
    s_waitcnt lgkmcnt(3)
    ds_read_b64_tr_b16 v[118:119], v171 offset:26624
    v_mfma_f32_16x16x32_bf16 v[96:99], a[64:67], v[132:135], v[96:99]
    s_add_u32 m0, s61, 114176
    v_mfma_f32_16x16x32_bf16 v[100:103], a[68:71], v[132:135], v[100:103]
    buffer_load_dwordx4 v202, s[40:43], s64 offen offset:2048 lds
    v_mfma_f32_16x16x32_bf16 v[56:59], a[72:75], v[104:107], v[56:59]
    s_add_u32 s64, s64, 98304
    ds_read_b64_tr_b16 v[120:121], v168 offset:28672
    v_mfma_f32_16x16x32_bf16 v[60:63], a[76:79], v[104:107], v[60:63]
    s_sub_u32 s35, s64, 1966080
    ds_read_b64_tr_b16 v[122:123], v168 offset:30720
    v_mfma_f32_16x16x32_bf16 v[64:67], a[80:83], v[104:107], v[64:67]
    s_min_u32 s64, s64, s35
    ds_read_b64_tr_b16 v[124:125], v169 offset:28672
    v_mfma_f32_16x16x32_bf16 v[68:71], a[72:75], v[108:111], v[68:71]
    v_mfma_f32_16x16x32_bf16 v[72:75], a[76:79], v[108:111], v[72:75]
    ds_read_b64_tr_b16 v[126:127], v169 offset:30720
    v_mfma_f32_16x16x32_bf16 v[76:79], a[80:83], v[108:111], v[76:79]
    s_waitcnt lgkmcnt(6)
    ds_read_b64_tr_b16 v[128:129], v170 offset:28672
    v_mfma_f32_16x16x32_bf16 v[80:83], a[72:75], v[112:115], v[80:83]
    s_add_u32 m0, s61, 126592
    ds_read_b64_tr_b16 v[130:131], v170 offset:30720
    v_mfma_f32_16x16x32_bf16 v[84:87], a[76:79], v[112:115], v[84:87]
    buffer_load_dwordx4 v200, s[40:43], s64 offen offset:0 lds
    v_mfma_f32_16x16x32_bf16 v[88:91], a[80:83], v[112:115], v[88:91]
    s_waitcnt lgkmcnt(6)
    ds_read_b64_tr_b16 v[132:133], v171 offset:28672
    v_mfma_f32_16x16x32_bf16 v[92:95], a[72:75], v[116:119], v[92:95]
    s_waitcnt lgkmcnt(3)
    ds_read_b64_tr_b16 v[134:135], v171 offset:30720
    v_mfma_f32_16x16x32_bf16 v[96:99], a[76:79], v[116:119], v[96:99]
    s_add_u32 m0, s61, 126592
    v_mfma_f32_16x16x32_bf16 v[100:103], a[80:83], v[116:119], v[100:103]
    buffer_load_dwordx4 v201, s[40:43], s64 offen offset:1024 lds
    v_mfma_f32_16x16x32_bf16 v[56:59], a[84:87], v[120:123], v[56:59]
    s_waitcnt vmcnt(6)
    s_barrier
    ds_read_b64_tr_b16 v[104:105], v168 offset:32768
    v_mfma_f32_16x16x32_bf16 v[60:63], a[88:91], v[120:123], v[60:63]
    ds_read_b64_tr_b16 v[106:107], v168 offset:34816
    ds_read_b64 v[224:225], v216
    v_mfma_f32_16x16x32_bf16 v[64:67], a[92:95], v[120:123], v[64:67]
    ds_read_b64_tr_b16 v[108:109], v169 offset:32768
    v_mfma_f32_16x16x32_bf16 v[68:71], a[84:87], v[124:127], v[68:71]
    ds_read_b64 v[226:227], v217
    v_mfma_f32_16x16x32_bf16 v[72:75], a[88:91], v[124:127], v[72:75]
    ds_read_b64_tr_b16 v[110:111], v169 offset:34816
    ds_read_b64 v[228:229], v218
    v_mfma_f32_16x16x32_bf16 v[76:79], a[92:95], v[124:127], v[76:79]
    s_waitcnt lgkmcnt(9)
    ds_read_b64_tr_b16 v[112:113], v170 offset:32768
    v_mfma_f32_16x16x32_bf16 v[80:83], a[84:87], v[128:131], v[80:83]
    s_add_u32 m0, s61, 126592
    ds_read_b64_tr_b16 v[114:115], v170 offset:34816
    v_lshrrev_b32 v238, 1, v1
    v_mfma_f32_16x16x32_bf16 v[84:87], a[88:91], v[128:131], v[84:87]
    s_barrier
    ds_read_b64_tr_b16 a[180:181], v203 offset:0
    buffer_load_dwordx4 v202, s[40:43], s64 offen offset:2048 lds
    v_mfma_f32_16x16x32_bf16 v[88:91], a[92:95], v[128:131], v[88:91]
    s_waitcnt lgkmcnt(10)
    s_add_u32 s64, s64, 98304
    ds_read_b64_tr_b16 v[116:117], v171 offset:32768
    v_lshlrev_b32 v238, 10, v238
    v_mfma_f32_16x16x32_bf16 v[92:95], a[84:87], v[132:135], v[92:95]
    s_waitcnt lgkmcnt(3)
    ds_read_b64_tr_b16 v[118:119], v171 offset:34816
    v_and_b32 v239, 1, v1
    v_mfma_f32_16x16x32_bf16 v[96:99], a[88:91], v[132:135], v[96:99]
    s_sub_u32 s35, s64, 1966080
    ds_read_b64_tr_b16 a[182:183], v203 offset:1536
    v_lshlrev_b32 v230, 16, v224
    v_and_b32 v231, 0xffff0000, v224
    v_pk_mul_f32 v[230:231], v[230:231], v[220:221] op_sel_hi:[1,0]
    v_pk_mul_f32 v[234:235], v[230:231], v[230:231]
    v_lshlrev_b32 v232, 16, v225
    v_and_b32 v233, 0xffff0000, v225
    v_pk_mul_f32 v[232:233], v[232:233], v[220:221] op_sel_hi:[1,0]
    v_pk_mul_f32 v[236:237], v[232:233], v[232:233]
    v_lshlrev_b32 v2, 16, v226
    v_and_b32 v3, 0xffff0000, v226
    v_pk_mul_f32 v[2:3], v[2:3], v[220:221] op_sel:[0,1] op_sel_hi:[1,1]
    v_pk_add_f32 v[230:231], v[230:231], v[2:3]
    v_pk_fma_f32 v[234:235], v[2:3], v[2:3], v[234:235]
    v_lshlrev_b32 v2, 16, v227
    v_and_b32 v3, 0xffff0000, v227
    v_pk_mul_f32 v[2:3], v[2:3], v[220:221] op_sel:[0,1] op_sel_hi:[1,1]
    v_pk_add_f32 v[232:233], v[232:233], v[2:3]
    v_pk_fma_f32 v[236:237], v[2:3], v[2:3], v[236:237]
    v_lshlrev_b32 v2, 16, v228
    v_and_b32 v3, 0xffff0000, v228
    v_pk_mul_f32 v[2:3], v[2:3], v[222:223] op_sel_hi:[1,0]
    v_pk_add_f32 v[230:231], v[230:231], v[2:3]
    v_pk_fma_f32 v[234:235], v[2:3], v[2:3], v[234:235]
    v_lshlrev_b32 v2, 16, v229
    v_and_b32 v3, 0xffff0000, v229
    v_pk_mul_f32 v[2:3], v[2:3], v[222:223] op_sel_hi:[1,0]
    v_pk_add_f32 v[232:233], v[232:233], v[2:3]
    v_pk_fma_f32 v[236:237], v[2:3], v[2:3], v[236:237]
    v_mfma_f32_16x16x32_bf16 v[100:103], a[92:95], v[132:135], v[100:103]
    s_min_u32 s64, s64, s35
    ds_read_b64_tr_b16 a[184:185], v203 offset:6224
    v_permlane32_swap_b32 v230, v234
    v_mfma_f32_16x16x32_bf16 v[56:59], a[96:99], v[104:107], v[56:59]
    ds_read_b64_tr_b16 v[120:121], v168 offset:36864
    ds_read_b64_tr_b16 a[186:187], v203 offset:7760
    v_lshl_add_u32 v219, v239, 7, v238
    v_permlane32_swap_b32 v231, v235
    v_permlane32_swap_b32 v232, v236
    v_permlane32_swap_b32 v233, v237
    v_add_f32 v230, v230, v234
    v_mfma_f32_16x16x32_bf16 v[60:63], a[100:103], v[104:107], v[60:63]
    s_lshl_b32 s55, s3, 8
    s_add_u32 s55, s55, 66560
    ds_read_b64_tr_b16 v[122:123], v168 offset:38912
    v_mfma_f32_16x16x32_bf16 v[64:67], a[104:107], v[104:107], v[64:67]
    s_add_u32 m0, s61, 139008
    ds_read_b64_tr_b16 v[124:125], v169 offset:36864
    v_add_u32 v219, s55, v219
    v_mfma_f32_16x16x32_bf16 v[68:71], a[96:99], v[108:111], v[68:71]
    ds_read_b64_tr_b16 a[188:189], v204 offset:0
    buffer_load_dwordx4 v200, s[40:43], s64 offen offset:0 lds
    v_mfma_f32_16x16x32_bf16 v[72:75], a[100:103], v[108:111], v[72:75]
    s_lshl_b32 s55, s73, 7
    s_add_u32 s55, s55, 87040
    ds_read_b64_tr_b16 v[126:127], v169 offset:38912
    ds_read_b64_tr_b16 a[190:191], v204 offset:1536
    v_mfma_f32_16x16x32_bf16 v[76:79], a[104:107], v[108:111], v[76:79]
    s_waitcnt lgkmcnt(12)
    ds_read_b64_tr_b16 v[128:129], v170 offset:36864
    v_mov_b32 v238, s55
    v_mfma_f32_16x16x32_bf16 v[80:83], a[96:99], v[112:115], v[80:83]
    s_add_u32 m0, s61, 139008
    ds_read_b64_tr_b16 v[130:131], v170 offset:38912
    v_add_f32 v231, v231, v235
    v_mfma_f32_16x16x32_bf16 v[84:87], a[100:103], v[112:115], v[84:87]
    v_cmp_lt_u32 vcc, 39, v1
    s_nop 1
    v_cndmask_b32 v219, v219, v238, vcc
    buffer_load_dwordx4 v201, s[40:43], s64 offen offset:1024 lds
    v_mfma_f32_16x16x32_bf16 v[88:91], a[104:107], v[112:115], v[88:91]
    s_waitcnt lgkmcnt(11)
    s_mov_b32 s17, 23199744
    ds_read_b64_tr_b16 v[132:133], v171 offset:36864
    v_add_f32 v232, v232, v236
    v_mfma_f32_16x16x32_bf16 v[92:95], a[96:99], v[116:119], v[92:95]
    s_waitcnt lgkmcnt(3)
    ds_read_b64_tr_b16 v[134:135], v171 offset:38912
    v_add_f32 v233, v233, v237
    v_mfma_f32_16x16x32_bf16 v[96:99], a[100:103], v[116:119], v[96:99]
    v_permlane16_swap_b32 v230, v232
    v_permlane16_swap_b32 v231, v233
    v_mfma_f32_16x16x32_bf16 v[100:103], a[104:107], v[116:119], v[100:103]
    v_add_f32 v230, v230, v232
    v_add_f32 v231, v231, v233
    v_mfma_f32_16x16x32_bf16 v[56:59], a[108:111], v[120:123], v[56:59]
    s_waitcnt vmcnt(5)
    s_barrier
    ds_read_b64_tr_b16 v[104:105], v168 offset:40960
    v_lshrrev_b32 v2, 4, v1
    v_lshlrev_b32 v2, 3, v2
    v_mfma_f32_16x16x32_bf16 v[60:63], a[112:115], v[120:123], v[60:63]
    s_lshl_b32 s50, s3, 5
    s_add_u32 s50, s50, 0
    ds_read_b64_tr_b16 v[106:107], v168 offset:43008
    ds_read_b64_tr_b16 a[192:193], v203 offset:12416
    v_mfma_f32_16x16x32_bf16 v[64:67], a[116:119], v[120:123], v[64:67]
    s_add_u32 m0, s61, 139008
    ds_read_b64_tr_b16 v[108:109], v169 offset:40960
    v_cmp_ne_u32 vcc, s48, v244
    s_cbranch_vccnz L_chk9_slow
L_chk9_back:
    v_mfma_f32_16x16x32_bf16 v[68:71], a[108:111], v[124:127], v[68:71]
    ds_read_b64_tr_b16 a[194:195], v203 offset:13952
    buffer_load_dwordx4 v202, s[40:43], s64 offen offset:2048 lds
    v_mfma_f32_16x16x32_bf16 v[72:75], a[112:115], v[124:127], v[72:75]
    s_add_u32 s64, s64, 98304
    ds_read_b64_tr_b16 v[110:111], v169 offset:43008
    ds_read_b64_tr_b16 a[196:197], v203 offset:18640
    v_mfma_f32_16x16x32_bf16 v[76:79], a[116:119], v[124:127], v[76:79]
    s_waitcnt lgkmcnt(9)
    s_sub_u32 s35, s64, 1966080
    ds_read_b64_tr_b16 v[112:113], v170 offset:40960
    ds_read_b64_tr_b16 a[198:199], v203 offset:20176
    v_mfma_f32_16x16x32_bf16 v[80:83], a[108:111], v[128:131], v[80:83]
    s_min_u32 s64, s64, s35
    ds_read_b64_tr_b16 v[114:115], v170 offset:43008
    v_add_u32 v2, s50, v2
    v_mfma_f32_16x16x32_bf16 v[84:87], a[112:115], v[128:131], v[84:87]
    ds_read_b64_tr_b16 a[200:201], v204 offset:12416
    buffer_load_dwordx4 a[240:243], v248, s[36:39], s62 offen offset:0 sc1
    v_mfma_f32_16x16x32_bf16 v[88:91], a[116:119], v[128:131], v[88:91]
    s_waitcnt lgkmcnt(11)
    ds_read_b64_tr_b16 v[116:117], v171 offset:40960
    v_add_f32_dpp v230, v230, v230 row_ror:8 row_mask:0xf bank_mask:0xf
    v_mfma_f32_16x16x32_bf16 v[92:95], a[108:111], v[132:135], v[92:95]
    s_waitcnt lgkmcnt(3)
    ds_read_b64_tr_b16 v[118:119], v171 offset:43008
    v_add_f32_dpp v231, v231, v231 row_ror:8 row_mask:0xf bank_mask:0xf
    v_mfma_f32_16x16x32_bf16 v[96:99], a[112:115], v[132:135], v[96:99]
    s_add_u32 m0, s61, 151424
    ds_read_b64_tr_b16 a[202:203], v204 offset:13952
    v_add_f32_dpp v230, v230, v230 row_ror:4 row_mask:0xf bank_mask:0xf
    v_mfma_f32_16x16x32_bf16 v[100:103], a[116:119], v[132:135], v[100:103]
    buffer_load_dwordx4 v200, s[40:43], s64 offen offset:0 lds
    v_mfma_f32_16x16x32_bf16 v[56:59], a[120:123], v[104:107], v[56:59]
    ds_read_b64_tr_b16 v[120:121], v168 offset:45056
    v_add_f32_dpp v231, v231, v231 row_ror:4 row_mask:0xf bank_mask:0xf
    v_mfma_f32_16x16x32_bf16 v[60:63], a[124:127], v[104:107], v[60:63]
    ds_read_b64_tr_b16 v[122:123], v168 offset:47104
    v_add_f32_dpp v230, v230, v230 row_ror:2 row_mask:0xf bank_mask:0xf
    v_mfma_f32_16x16x32_bf16 v[64:67], a[128:131], v[104:107], v[64:67]
    ds_read_b64_tr_b16 v[124:125], v169 offset:45056
    v_add_f32_dpp v231, v231, v231 row_ror:2 row_mask:0xf bank_mask:0xf
    v_mfma_f32_16x16x32_bf16 v[68:71], a[120:123], v[108:111], v[68:71]
    buffer_load_dword v240, v219, s[36:39], s17 offen sc1
    v_mfma_f32_16x16x32_bf16 v[72:75], a[124:127], v[108:111], v[72:75]
    ds_read_b64_tr_b16 v[126:127], v169 offset:47104
    v_add_f32_dpp v230, v230, v230 row_ror:1 row_mask:0xf bank_mask:0xf
    v_mfma_f32_16x16x32_bf16 v[76:79], a[128:131], v[108:111], v[76:79]
    ds_read_b64_tr_b16 v[128:129], v170 offset:45056
    v_add_f32_dpp v231, v231, v231 row_ror:1 row_mask:0xf bank_mask:0xf
    s_mov_b32 exec_lo, 0x00010001
    s_mov_b32 exec_hi, 0x00010001
    ds_write_b64 v2, v[230:231]
    s_mov_b64 exec, -1
    v_lshlrev_b32 v2, 2, v1
    s_waitcnt lgkmcnt(10)
    v_mfma_f32_16x16x32_bf16 v[80:83], a[120:123], v[112:115], v[80:83]
    s_waitcnt vmcnt(6)
    s_waitcnt lgkmcnt(6)
    s_barrier
    s_add_u32 m0, s61, 151424
    ds_read_b64_tr_b16 v[130:131], v170 offset:47104
    v_mfma_f32_16x16x32_bf16 v[84:87], a[124:127], v[112:115], v[84:87]
    ds_read_b64_tr_b16 a[204:205], v203 offset:24832
    buffer_load_dwordx4 v201, s[40:43], s64 offen offset:1024 lds
    v_mfma_f32_16x16x32_bf16 v[88:91], a[128:131], v[112:115], v[88:91]
    ds_read_b64_tr_b16 v[132:133], v171 offset:45056
    ds_read_b64_tr_b16 a[206:207], v203 offset:26368
    v_mfma_f32_16x16x32_bf16 v[92:95], a[120:123], v[116:119], v[92:95]
    s_waitcnt lgkmcnt(3)
    ds_read_b64_tr_b16 v[134:135], v171 offset:47104
    v_and_b32 v2, 12, v2
    v_mfma_f32_16x16x32_bf16 v[96:99], a[124:127], v[116:119], v[96:99]
    s_add_u32 m0, s61, 151424
    ds_read_b64_tr_b16 a[208:209], v203 offset:31056
    v_add_u32 v2, 0, v2
    v_mfma_f32_16x16x32_bf16 v[100:103], a[128:131], v[116:119], v[100:103]
    s_waitcnt lgkmcnt(0)
    s_barrier
    ds_read_b64_tr_b16 a[210:211], v203 offset:32592
    buffer_load_dwordx4 v202, s[40:43], s64 offen offset:2048 lds
    v_mfma_f32_16x16x32_bf16 v[56:59], a[132:135], v[120:123], v[56:59]
    s_add_u32 s64, s64, 98304
    ds_read_b64_tr_b16 v[104:105], v168 offset:49152
    ds_read_b64_tr_b16 a[212:213], v204 offset:24832
    ds_read2_b32 v[230:231], v2 offset0:0 offset1:4
    v_mfma_f32_16x16x32_bf16 v[60:63], a[136:139], v[120:123], v[60:63]
    s_sub_u32 s35, s64, 1966080
    ds_read_b64_tr_b16 v[106:107], v168 offset:51200
    ds_read2_b32 v[232:233], v2 offset0:8 offset1:12
    v_mfma_f32_16x16x32_bf16 v[64:67], a[140:143], v[120:123], v[64:67]
    s_min_u32 s64, s64, s35
    ds_read_b64_tr_b16 v[108:109], v169 offset:49152
    ds_read2_b32 v[234:235], v2 offset0:16 offset1:20
    v_mfma_f32_16x16x32_bf16 v[68:71], a[132:135], v[124:127], v[68:71]
    ds_read_b64_tr_b16 a[214:215], v204 offset:26368
    v_mfma_f32_16x16x32_bf16 v[72:75], a[136:139], v[124:127], v[72:75]
    ds_read_b64_tr_b16 v[110:111], v169 offset:51200
    ds_read2_b32 v[236:237], v2 offset0:24 offset1:28
    v_mfma_f32_16x16x32_bf16 v[76:79], a[140:143], v[124:127], v[76:79]
    ds_read_b64_tr_b16 v[112:113], v170 offset:49152
    v_mov_b32 v225, s48
    v_mfma_f32_16x16x32_bf16 v[80:83], a[132:135], v[128:131], v[80:83]
    ds_read_b64_tr_b16 v[114:115], v170 offset:51200
    v_mov_b32 v227, s48
    v_mfma_f32_16x16x32_bf16 v[84:87], a[136:139], v[128:131], v[84:87]
    buffer_load_dwordx4 a[244:247], v248, s[36:39], s62 offen offset:1024 sc1
    v_mfma_f32_16x16x32_bf16 v[88:91], a[140:143], v[128:131], v[88:91]
    ds_read_b64_tr_b16 v[116:117], v171 offset:49152
    s_waitcnt lgkmcnt(8)
    v_add_f32 v230, v230, v232
    v_mfma_f32_16x16x32_bf16 v[92:95], a[132:135], v[132:135], v[92:95]
    s_waitcnt lgkmcnt(3)
    ds_read_b64_tr_b16 v[118:119], v171 offset:51200
    v_add_f32 v231, v231, v233
    v_mfma_f32_16x16x32_bf16 v[96:99], a[136:139], v[132:135], v[96:99]
    v_add_f32 v234, v234, v236
    v_add_f32 v235, v235, v237
    v_mfma_f32_16x16x32_bf16 v[100:103], a[140:143], v[132:135], v[100:103]
    buffer_load_dwordx4 a[248:251], v248, s[36:39], s62 offen offset:2048 sc1
    v_mfma_f32_16x16x32_bf16 v[56:59], a[144:147], v[104:107], v[56:59]
    s_waitcnt vmcnt(7)
    s_barrier
    ds_read_b64_tr_b16 v[120:121], v168 offset:53248
    v_add_f32 v230, v230, v234
    v_mfma_f32_16x16x32_bf16 v[60:63], a[148:151], v[104:107], v[60:63]
    ds_read_b64_tr_b16 v[122:123], v168 offset:55296
    ds_read_b64_tr_b16 a[216:217], v203 offset:37248
    v_mfma_f32_16x16x32_bf16 v[64:67], a[152:155], v[104:107], v[64:67]
    ds_read_b64_tr_b16 v[124:125], v169 offset:53248
    v_add_f32 v231, v231, v235
    v_mul_f32 v230, 0x3acccccd, v230
    v_mul_f32 v234, v230, v230
    v_mfma_f32_16x16x32_bf16 v[68:71], a[144:147], v[108:111], v[68:71]
    ds_read_b64_tr_b16 a[218:219], v203 offset:38784
    buffer_load_dwordx4 a[252:255], v248, s[36:39], s62 offen offset:3072 sc1
    v_mfma_f32_16x16x32_bf16 v[72:75], a[148:151], v[108:111], v[72:75]
    ds_read_b64_tr_b16 v[126:127], v169 offset:55296
    ds_read_b64_tr_b16 a[220:221], v203 offset:43472
    v_mfma_f32_16x16x32_bf16 v[76:79], a[152:155], v[108:111], v[76:79]
    s_waitcnt lgkmcnt(9)
    ds_read_b64_tr_b16 v[128:129], v170 offset:53248
    ds_read_b64_tr_b16 a[222:223], v203 offset:45008
    v_mfma_f32_16x16x32_bf16 v[80:83], a[144:147], v[112:115], v[80:83]
    s_add_u32 s62, s62, 4096
    ds_read_b64_tr_b16 v[130:131], v170 offset:55296
    v_mov_b32 v224, 0x3acccccd
    v_fma_f32 v231, v231, v224, -v234
    v_mfma_f32_16x16x32_bf16 v[84:87], a[148:151], v[112:115], v[84:87]
    ds_read_b64_tr_b16 a[224:225], v204 offset:37248
    buffer_load_dwordx4 v[136:139], v248, s[36:39], s62 offen offset:0 sc1
    v_mfma_f32_16x16x32_bf16 v[88:91], a[152:155], v[112:115], v[88:91]
    s_waitcnt lgkmcnt(11)
    ds_read_b64_tr_b16 v[132:133], v171 offset:53248
    v_max_f32 v231, 0, v231
    v_mfma_f32_16x16x32_bf16 v[92:95], a[144:147], v[116:119], v[92:95]
    s_waitcnt lgkmcnt(3)
    ds_read_b64_tr_b16 v[134:135], v171 offset:55296
    v_add_f32 v231, 0x3727c5ac, v231
    v_mfma_f32_16x16x32_bf16 v[96:99], a[148:151], v[116:119], v[96:99]
    ds_read_b64_tr_b16 a[226:227], v204 offset:38784
    v_rsq_f32 v224, v231
    v_mfma_f32_16x16x32_bf16 v[100:103], a[152:155], v[116:119], v[100:103]
    buffer_load_dwordx4 v[140:143], v248, s[36:39], s62 offen offset:1024 sc1
    v_mfma_f32_16x16x32_bf16 v[56:59], a[156:159], v[120:123], v[56:59]
    ds_read_b64_tr_b16 v[104:105], v168 offset:57344
    v_mul_f32_e64 v226, -v230, v224
    v_mfma_f32_16x16x32_bf16 v[60:63], a[160:163], v[120:123], v[60:63]
    ds_read_b64_tr_b16 v[106:107], v168 offset:59392
    s_mov_b64 exec, 0xf
    buffer_store_dwordx4 v[224:227], v248, s[36:39], s7 offen sc1
    s_mov_b64 exec, -1
    v_mfma_f32_16x16x32_bf16 v[64:67], a[164:167], v[120:123], v[64:67]
    ds_read_b64_tr_b16 v[108:109], v169 offset:57344
    v_mfma_f32_16x16x32_bf16 v[68:71], a[156:159], v[124:127], v[68:71]
    buffer_load_dwordx4 v[144:147], v248, s[36:39], s62 offen offset:2048 sc1
    v_mfma_f32_16x16x32_bf16 v[72:75], a[160:163], v[124:127], v[72:75]
    ds_read_b64_tr_b16 v[110:111], v169 offset:59392
    s_waitcnt vmcnt(8)
    v_cmp_ne_u32 vcc, s48, v240
    s_cbranch_vccnz L_chk10_slow
L_chk10_back:
    v_mfma_f32_16x16x32_bf16 v[76:79], a[164:167], v[124:127], v[76:79]
    s_waitcnt lgkmcnt(8)
    ds_read_b64_tr_b16 v[112:113], v170 offset:57344
    v_mfma_f32_16x16x32_bf16 v[80:83], a[156:159], v[128:131], v[80:83]
    s_waitcnt vmcnt(6)
    s_waitcnt lgkmcnt(5)
    s_barrier
    s_add_u32 m0, s63, 81920
    ds_read_b64_tr_b16 v[114:115], v170 offset:59392
    v_mfma_f32_16x16x32_bf16 v[84:87], a[160:163], v[128:131], v[84:87]
    ds_read_b64_tr_b16 a[228:229], v203 offset:49664
    buffer_load_dwordx4 v172, s[36:39], s10 offen sc1 lds
    v_mfma_f32_16x16x32_bf16 v[88:91], a[164:167], v[128:131], v[88:91]
    ds_read_b64_tr_b16 v[116:117], v171 offset:57344
    ds_read_b64_tr_b16 a[230:231], v203 offset:51200
    v_mfma_f32_16x16x32_bf16 v[92:95], a[156:159], v[132:135], v[92:95]
    s_waitcnt lgkmcnt(3)
    ds_read_b64_tr_b16 v[118:119], v171 offset:59392
    v_and_b32 v247, 48, v1
    v_mfma_f32_16x16x32_bf16 v[96:99], a[160:163], v[132:135], v[96:99]
    s_add_u32 m0, s63, 86016
    buffer_load_dwordx4 v[176:179], v247, s[36:39], s9 offen offset:0 sc1
    v_mfma_f32_16x16x32_bf16 v[100:103], a[164:167], v[132:135], v[100:103]
    ds_read_b64_tr_b16 a[232:233], v203 offset:55888
    buffer_load_dwordx4 v172, s[36:39], s11 offen sc1 lds
    v_mfma_f32_16x16x32_bf16 v[56:59], a[168:171], v[104:107], v[56:59]
    ds_read_b64_tr_b16 v[120:121], v168 offset:61440
    ds_read_b64_tr_b16 a[234:235], v203 offset:57424
    v_mfma_f32_16x16x32_bf16 v[60:63], a[172:175], v[104:107], v[60:63]
    ds_read_b64_tr_b16 v[122:123], v168 offset:63488
    v_add_u32 v168, 65536, v168
    v_mfma_f32_16x16x32_bf16 v[64:67], a[176:179], v[104:107], v[64:67]
    s_add_u32 m0, s63, 90112
    ds_read_b64_tr_b16 v[124:125], v169 offset:61440
    ds_read_b64_tr_b16 a[236:237], v204 offset:49664
    v_mfma_f32_16x16x32_bf16 v[68:71], a[168:171], v[108:111], v[68:71]
    ds_read_b64_tr_b16 a[238:239], v204 offset:51200
    buffer_load_dwordx4 v172, s[36:39], s12 offen sc1 lds
    v_mfma_f32_16x16x32_bf16 v[72:75], a[172:175], v[108:111], v[72:75]
    ds_read_b64_tr_b16 v[126:127], v169 offset:63488
    v_add_u32 v169, 65536, v169
    v_mfma_f32_16x16x32_bf16 v[76:79], a[176:179], v[108:111], v[76:79]
    ds_read_b64_tr_b16 v[128:129], v170 offset:61440
    v_mfma_f32_16x16x32_bf16 v[80:83], a[168:171], v[112:115], v[80:83]
    ds_read_b64_tr_b16 v[130:131], v170 offset:63488
    v_add_u32 v170, 65536, v170
    v_mfma_f32_16x16x32_bf16 v[84:87], a[172:175], v[112:115], v[84:87]
    buffer_load_dwordx4 v[180:183], v247, s[36:39], s9 offen offset:64 sc1
    v_mfma_f32_16x16x32_bf16 v[88:91], a[176:179], v[112:115], v[88:91]
    s_waitcnt lgkmcnt(10)
    ds_read_b64_tr_b16 v[132:133], v171 offset:61440
    v_mfma_f32_16x16x32_bf16 v[92:95], a[168:171], v[116:119], v[92:95]
    s_waitcnt lgkmcnt(3)
    ds_read_b64_tr_b16 v[134:135], v171 offset:63488
    v_add_u32 v171, 65536, v171
    v_mfma_f32_16x16x32_bf16 v[96:99], a[172:175], v[116:119], v[96:99]
    s_add_u32 m0, s63, 94208
    v_mfma_f32_16x16x32_bf16 v[100:103], a[176:179], v[116:119], v[100:103]
    buffer_load_dwordx4 v172, s[36:39], s13 offen sc1 lds
    v_mfma_f32_16x16x32_bf16 v[56:59], a[180:183], v[120:123], v[56:59]
    s_barrier
    ds_read_b64_tr_b16 v[104:105], v168 offset:0
    v_mfma_f32_16x16x32_bf16 v[60:63], a[184:187], v[120:123], v[60:63]
    ds_read_b64_tr_b16 v[106:107], v168 offset:2048
    v_mfma_f32_16x16x32_bf16 v[64:67], a[188:191], v[120:123], v[64:67]
    ds_read_b64_tr_b16 v[108:109], v169 offset:0
    v_mfma_f32_16x16x32_bf16 v[68:71], a[180:183], v[124:127], v[68:71]
    buffer_load_dwordx4 v[184:187], v247, s[36:39], s9 offen offset:128 sc1
    v_mfma_f32_16x16x32_bf16 v[72:75], a[184:187], v[124:127], v[72:75]
    ds_read_b64_tr_b16 v[110:111], v169 offset:2048
    v_mfma_f32_16x16x32_bf16 v[76:79], a[188:191], v[124:127], v[76:79]
    s_waitcnt lgkmcnt(6)
    ds_read_b64_tr_b16 v[112:113], v170 offset:0
    v_mfma_f32_16x16x32_bf16 v[80:83], a[180:183], v[128:131], v[80:83]
    s_add_u32 m0, s63, 98304
    ds_read_b64_tr_b16 v[114:115], v170 offset:2048
    v_mfma_f32_16x16x32_bf16 v[84:87], a[184:187], v[128:131], v[84:87]
    buffer_load_dwordx4 v172, s[36:39], s14 offen sc1 lds
    v_mfma_f32_16x16x32_bf16 v[88:91], a[188:191], v[128:131], v[88:91]
    s_waitcnt lgkmcnt(6)
    ds_read_b64_tr_b16 v[116:117], v171 offset:0
    v_mfma_f32_16x16x32_bf16 v[92:95], a[180:183], v[132:135], v[92:95]
    s_waitcnt lgkmcnt(3)
    ds_read_b64_tr_b16 v[118:119], v171 offset:2048
    v_mfma_f32_16x16x32_bf16 v[96:99], a[184:187], v[132:135], v[96:99]
    s_add_u32 m0, s63, 102400
    buffer_load_dwordx4 v[188:191], v247, s[36:39], s9 offen offset:192 sc1
    v_mfma_f32_16x16x32_bf16 v[100:103], a[188:191], v[132:135], v[100:103]
    buffer_load_dwordx4 v172, s[36:39], s15 offen sc1 lds
    v_mfma_f32_16x16x32_bf16 v[56:59], a[192:195], v[104:107], v[56:59]
    ds_read_b64_tr_b16 v[120:121], v168 offset:4096
    v_mfma_f32_16x16x32_bf16 v[60:63], a[196:199], v[104:107], v[60:63]
    ds_read_b64_tr_b16 v[122:123], v168 offset:6144
    v_mfma_f32_16x16x32_bf16 v[64:67], a[200:203], v[104:107], v[64:67]
    s_add_u32 m0, s63, 106496
    ds_read_b64_tr_b16 v[124:125], v169 offset:4096
    v_mfma_f32_16x16x32_bf16 v[68:71], a[192:195], v[108:111], v[68:71]
    buffer_load_dwordx4 v172, s[36:39], s18 offen sc1 lds
    v_mfma_f32_16x16x32_bf16 v[72:75], a[196:199], v[108:111], v[72:75]
    ds_read_b64_tr_b16 v[126:127], v169 offset:6144
    v_mfma_f32_16x16x32_bf16 v[76:79], a[200:203], v[108:111], v[76:79]
    s_waitcnt lgkmcnt(6)
    ds_read_b64_tr_b16 v[128:129], v170 offset:4096
    v_mfma_f32_16x16x32_bf16 v[80:83], a[192:195], v[112:115], v[80:83]
    ds_read_b64_tr_b16 v[130:131], v170 offset:6144
    v_mfma_f32_16x16x32_bf16 v[84:87], a[196:199], v[112:115], v[84:87]
    buffer_load_dwordx4 v[192:195], v247, s[36:39], s9 offen offset:256 sc1
    v_mfma_f32_16x16x32_bf16 v[88:91], a[200:203], v[112:115], v[88:91]
    s_waitcnt lgkmcnt(6)
    ds_read_b64_tr_b16 v[132:133], v171 offset:4096
    v_mfma_f32_16x16x32_bf16 v[92:95], a[192:195], v[116:119], v[92:95]
    s_waitcnt lgkmcnt(3)
    ds_read_b64_tr_b16 v[134:135], v171 offset:6144
    v_mfma_f32_16x16x32_bf16 v[96:99], a[196:199], v[116:119], v[96:99]
    s_add_u32 m0, s63, 110592
    v_mfma_f32_16x16x32_bf16 v[100:103], a[200:203], v[116:119], v[100:103]
    buffer_load_dwordx4 v172, s[36:39], s19 offen sc1 lds
    v_mfma_f32_16x16x32_bf16 v[56:59], a[204:207], v[120:123], v[56:59]
    ds_read_b64_tr_b16 v[104:105], v168 offset:8192
    v_mfma_f32_16x16x32_bf16 v[60:63], a[208:211], v[120:123], v[60:63]
    ds_read_b64_tr_b16 v[106:107], v168 offset:10240
    v_mfma_f32_16x16x32_bf16 v[64:67], a[212:215], v[120:123], v[64:67]
    ds_read_b64_tr_b16 v[108:109], v169 offset:8192
    v_mfma_f32_16x16x32_bf16 v[68:71], a[204:207], v[124:127], v[68:71]
    buffer_load_dwordx4 v[196:199], v247, s[36:39], s9 offen offset:320 sc1
    v_mfma_f32_16x16x32_bf16 v[72:75], a[208:211], v[124:127], v[72:75]
    ds_read_b64_tr_b16 v[110:111], v169 offset:10240
    v_mfma_f32_16x16x32_bf16 v[76:79], a[212:215], v[124:127], v[76:79]
    s_waitcnt lgkmcnt(6)
    ds_read_b64_tr_b16 v[112:113], v170 offset:8192
    v_mfma_f32_16x16x32_bf16 v[80:83], a[204:207], v[128:131], v[80:83]
    s_add_u32 m0, s63, 114688
    ds_read_b64_tr_b16 v[114:115], v170 offset:10240
    v_mfma_f32_16x16x32_bf16 v[84:87], a[208:211], v[128:131], v[84:87]
    buffer_load_dwordx4 v172, s[36:39], s20 offen sc1 lds
    v_mfma_f32_16x16x32_bf16 v[88:91], a[212:215], v[128:131], v[88:91]
    s_waitcnt lgkmcnt(6)
    ds_read_b64_tr_b16 v[116:117], v171 offset:8192
    v_mfma_f32_16x16x32_bf16 v[92:95], a[204:207], v[132:135], v[92:95]
    s_waitcnt lgkmcnt(3)
    ds_read_b64_tr_b16 v[118:119], v171 offset:10240
    v_mfma_f32_16x16x32_bf16 v[96:99], a[208:211], v[132:135], v[96:99]
    s_add_u32 m0, s63, 118784
    v_mfma_f32_16x16x32_bf16 v[100:103], a[212:215], v[132:135], v[100:103]
    buffer_load_dwordx4 v172, s[36:39], s21 offen sc1 lds
    v_mfma_f32_16x16x32_bf16 v[56:59], a[216:219], v[104:107], v[56:59]
    ds_read_b64_tr_b16 v[120:121], v168 offset:12288
    v_mfma_f32_16x16x32_bf16 v[60:63], a[220:223], v[104:107], v[60:63]
    ds_read_b64_tr_b16 v[122:123], v168 offset:14336
    v_add_u32 v168, 16384, v168
    v_mfma_f32_16x16x32_bf16 v[64:67], a[224:227], v[104:107], v[64:67]
    s_add_u32 m0, s63, 122880
    ds_read_b64_tr_b16 v[124:125], v169 offset:12288
    v_mfma_f32_16x16x32_bf16 v[68:71], a[216:219], v[108:111], v[68:71]
    buffer_load_dwordx4 v172, s[36:39], s22 offen sc1 lds
    v_mfma_f32_16x16x32_bf16 v[72:75], a[220:223], v[108:111], v[72:75]
    ds_read_b64_tr_b16 v[126:127], v169 offset:14336
    v_add_u32 v169, 16384, v169
    v_mfma_f32_16x16x32_bf16 v[76:79], a[224:227], v[108:111], v[76:79]
    s_waitcnt lgkmcnt(6)
    ds_read_b64_tr_b16 v[128:129], v170 offset:12288
    v_mfma_f32_16x16x32_bf16 v[80:83], a[216:219], v[112:115], v[80:83]
    s_add_u32 m0, s63, 126976
    ds_read_b64_tr_b16 v[130:131], v170 offset:14336
    v_add_u32 v170, 16384, v170
    v_mfma_f32_16x16x32_bf16 v[84:87], a[220:223], v[112:115], v[84:87]
    buffer_load_dwordx4 v172, s[36:39], s23 offen sc1 lds
    v_mfma_f32_16x16x32_bf16 v[88:91], a[224:227], v[112:115], v[88:91]
    s_waitcnt lgkmcnt(6)
    ds_read_b64_tr_b16 v[132:133], v171 offset:12288
    v_mfma_f32_16x16x32_bf16 v[92:95], a[216:219], v[116:119], v[92:95]
    s_waitcnt lgkmcnt(3)
    ds_read_b64_tr_b16 v[134:135], v171 offset:14336
    v_add_u32 v171, 16384, v171
    v_mfma_f32_16x16x32_bf16 v[96:99], a[220:223], v[116:119], v[96:99]
    s_add_u32 m0, s63, 131072
    v_mfma_f32_16x16x32_bf16 v[100:103], a[224:227], v[116:119], v[100:103]
    buffer_load_dwordx4 v172, s[36:39], s24 offen sc1 lds
    v_mfma_f32_16x16x32_bf16 v[56:59], a[228:231], v[120:123], v[56:59]
    s_waitcnt vmcnt(16)
    s_barrier
    ds_read_b64_tr_b16 v[104:105], v168 offset:0
    v_mfma_f32_16x16x32_bf16 v[60:63], a[232:235], v[120:123], v[60:63]
    ds_read_b64_tr_b16 v[106:107], v168 offset:2048
    v_mfma_f32_16x16x32_bf16 v[64:67], a[236:239], v[120:123], v[64:67]
    s_add_u32 m0, s63, 135168
    ds_read_b64_tr_b16 v[108:109], v169 offset:0
    v_mfma_f32_16x16x32_bf16 v[68:71], a[228:231], v[124:127], v[68:71]
    buffer_load_dwordx4 v172, s[36:39], s25 offen sc1 lds
    v_mfma_f32_16x16x32_bf16 v[72:75], a[232:235], v[124:127], v[72:75]
    ds_read_b64_tr_b16 v[110:111], v169 offset:2048
    v_mfma_f32_16x16x32_bf16 v[76:79], a[236:239], v[124:127], v[76:79]
    s_waitcnt lgkmcnt(6)
    ds_read_b64_tr_b16 v[112:113], v170 offset:0
    v_mfma_f32_16x16x32_bf16 v[80:83], a[228:231], v[128:131], v[80:83]
    s_add_u32 m0, s63, 139264
    ds_read_b64_tr_b16 v[114:115], v170 offset:2048
    v_mfma_f32_16x16x32_bf16 v[84:87], a[232:235], v[128:131], v[84:87]
    buffer_load_dwordx4 v172, s[36:39], s26 offen sc1 lds
    v_mfma_f32_16x16x32_bf16 v[88:91], a[236:239], v[128:131], v[88:91]
    s_waitcnt lgkmcnt(6)
    ds_read_b64_tr_b16 v[116:117], v171 offset:0
    v_mfma_f32_16x16x32_bf16 v[92:95], a[228:231], v[132:135], v[92:95]
    s_waitcnt lgkmcnt(3)
    ds_read_b64_tr_b16 v[118:119], v171 offset:2048
    v_mfma_f32_16x16x32_bf16 v[96:99], a[232:235], v[132:135], v[96:99]
    v_mfma_f32_16x16x32_bf16 v[100:103], a[236:239], v[132:135], v[100:103]
    v_mfma_f32_16x16x32_bf16 v[8:11], a[0:3], v[104:107], 0
    ds_read_b64_tr_b16 v[120:121], v168 offset:4096
    v_add_u32 v216, 81920, v216
    v_mfma_f32_16x16x32_bf16 v[12:15], a[4:7], v[104:107], 0
    ds_read_b64_tr_b16 v[122:123], v168 offset:6144
    v_add_u32 v217, 81920, v217
    v_mfma_f32_16x16x32_bf16 v[16:19], a[8:11], v[104:107], 0
    ds_read_b64_tr_b16 v[124:125], v169 offset:4096
    v_add_u32 v218, 81920, v218
    v_mfma_f32_16x16x32_bf16 v[20:23], a[0:3], v[108:111], 0
    buffer_load_dwordx4 v[200:203], v175, s[36:39], s6 offen offset:0 sc1
    v_mfma_f32_16x16x32_bf16 v[24:27], a[4:7], v[108:111], 0
    ds_read_b64_tr_b16 v[126:127], v169 offset:6144
    v_mfma_f32_16x16x32_bf16 v[28:31], a[8:11], v[108:111], 0
    s_waitcnt lgkmcnt(6)
    ds_read_b64_tr_b16 v[128:129], v170 offset:4096
    v_mfma_f32_16x16x32_bf16 v[32:35], a[0:3], v[112:115], 0
    ds_read_b64_tr_b16 v[130:131], v170 offset:6144
    v_mfma_f32_16x16x32_bf16 v[36:39], a[4:7], v[112:115], 0
    buffer_load_dwordx4 v[204:207], v175, s[36:39], s6 offen offset:256 sc1
    v_mfma_f32_16x16x32_bf16 v[40:43], a[8:11], v[112:115], 0
    s_waitcnt lgkmcnt(6)
    ds_read_b64_tr_b16 v[132:133], v171 offset:4096
    v_mfma_f32_16x16x32_bf16 v[44:47], a[0:3], v[116:119], 0
    s_waitcnt lgkmcnt(3)
    ds_read_b64_tr_b16 v[134:135], v171 offset:6144
    v_mfma_f32_16x16x32_bf16 v[48:51], a[4:7], v[116:119], 0
    buffer_load_dwordx4 v[208:211], v175, s[36:39], s6 offen offset:512 sc1
    v_mfma_f32_16x16x32_bf16 v[52:55], a[8:11], v[116:119], 0
    buffer_load_dwordx4 v[212:215], v175, s[36:39], s6 offen offset:768 sc1
    v_mfma_f32_16x16x32_bf16 v[8:11], a[12:15], v[120:123], v[8:11]
    s_waitcnt vmcnt(17)
    s_barrier
    ds_read_b64_tr_b16 v[104:105], v168 offset:8192
    v_mfma_f32_16x16x32_bf16 v[12:15], a[16:19], v[120:123], v[12:15]
    ds_read_b64_tr_b16 v[106:107], v168 offset:10240
    v_mfma_f32_16x16x32_bf16 v[16:19], a[20:23], v[120:123], v[16:19]
    s_add_u32 m0, s63, 143360
    ds_read_b64_tr_b16 v[108:109], v169 offset:8192
    v_mfma_f32_16x16x32_bf16 v[20:23], a[12:15], v[124:127], v[20:23]
    buffer_load_dwordx4 v172, s[36:39], s27 offen sc1 lds
    v_mfma_f32_16x16x32_bf16 v[24:27], a[16:19], v[124:127], v[24:27]
    ds_read_b64_tr_b16 v[110:111], v169 offset:10240
    v_mfma_f32_16x16x32_bf16 v[28:31], a[20:23], v[124:127], v[28:31]
    s_waitcnt lgkmcnt(6)
    ds_read_b64_tr_b16 v[112:113], v170 offset:8192
    v_mfma_f32_16x16x32_bf16 v[32:35], a[12:15], v[128:131], v[32:35]
    s_add_u32 m0, s63, 147456
    ds_read_b64_tr_b16 v[114:115], v170 offset:10240
    v_mfma_f32_16x16x32_bf16 v[36:39], a[16:19], v[128:131], v[36:39]
    buffer_load_dwordx4 v172, s[36:39], s44 offen sc1 lds
    v_mfma_f32_16x16x32_bf16 v[40:43], a[20:23], v[128:131], v[40:43]
    s_waitcnt lgkmcnt(6)
    ds_read_b64_tr_b16 v[116:117], v171 offset:8192
    v_mfma_f32_16x16x32_bf16 v[44:47], a[12:15], v[132:135], v[44:47]
    s_waitcnt lgkmcnt(3)
    ds_read_b64_tr_b16 v[118:119], v171 offset:10240
    v_mfma_f32_16x16x32_bf16 v[48:51], a[16:19], v[132:135], v[48:51]
    s_add_u32 m0, s63, 151552
    v_mfma_f32_16x16x32_bf16 v[52:55], a[20:23], v[132:135], v[52:55]
    buffer_load_dwordx4 v172, s[36:39], s45 offen sc1 lds
    v_mfma_f32_16x16x32_bf16 v[8:11], a[24:27], v[104:107], v[8:11]
    ds_read_b64_tr_b16 v[120:121], v168 offset:12288
    v_mfma_f32_16x16x32_bf16 v[12:15], a[28:31], v[104:107], v[12:15]
    ds_read_b64_tr_b16 v[122:123], v168 offset:14336
    v_mfma_f32_16x16x32_bf16 v[16:19], a[32:35], v[104:107], v[16:19]
    s_add_u32 m0, s63, 155648
    ds_read_b64_tr_b16 v[124:125], v169 offset:12288
    v_mfma_f32_16x16x32_bf16 v[20:23], a[24:27], v[108:111], v[20:23]
    buffer_load_dwordx4 v172, s[36:39], s46 offen sc1 lds
    v_mfma_f32_16x16x32_bf16 v[24:27], a[28:31], v[108:111], v[24:27]
    ds_read_b64_tr_b16 v[126:127], v169 offset:14336
    v_mfma_f32_16x16x32_bf16 v[28:31], a[32:35], v[108:111], v[28:31]
    s_waitcnt lgkmcnt(6)
    ds_read_b64_tr_b16 v[128:129], v170 offset:12288
    v_mfma_f32_16x16x32_bf16 v[32:35], a[24:27], v[112:115], v[32:35]
    s_add_u32 m0, s63, 159744
    ds_read_b64_tr_b16 v[130:131], v170 offset:14336
    v_mfma_f32_16x16x32_bf16 v[36:39], a[28:31], v[112:115], v[36:39]
    buffer_load_dwordx4 v172, s[36:39], s47 offen sc1 lds
    v_mfma_f32_16x16x32_bf16 v[40:43], a[32:35], v[112:115], v[40:43]
    s_waitcnt lgkmcnt(6)
    ds_read_b64_tr_b16 v[132:133], v171 offset:12288
    v_mfma_f32_16x16x32_bf16 v[44:47], a[24:27], v[116:119], v[44:47]
    s_waitcnt lgkmcnt(3)
    ds_read_b64_tr_b16 v[134:135], v171 offset:14336
    v_mfma_f32_16x16x32_bf16 v[48:51], a[28:31], v[116:119], v[48:51]
    s_waitcnt vmcnt(8)
    v_xor_b32 v3, s48, v201
    v_bitop3_b32 v3, v203, s48, v3 bitop3:0xbe
    v_mfma_f32_16x16x32_bf16 v[52:55], a[32:35], v[116:119], v[52:55]
    buffer_load_dwordx4 v[148:151], v248, s[36:39], s62 offen offset:3072 sc1
    v_mfma_f32_16x16x32_bf16 v[8:11], a[36:39], v[120:123], v[8:11]
    ds_read_b64_tr_b16 v[104:105], v168 offset:16384
    s_waitcnt vmcnt(8)
    v_bitop3_b32 v3, v205, s48, v3 bitop3:0xbe
    v_mfma_f32_16x16x32_bf16 v[12:15], a[40:43], v[120:123], v[12:15]
    ds_read_b64_tr_b16 v[106:107], v168 offset:18432
    v_bitop3_b32 v3, v207, s48, v3 bitop3:0xbe
    v_mfma_f32_16x16x32_bf16 v[16:19], a[44:47], v[120:123], v[16:19]
    s_add_u32 s62, s62, 4096
    ds_read_b64_tr_b16 v[108:109], v169 offset:16384
    s_waitcnt vmcnt(7)
    v_bitop3_b32 v3, v209, s48, v3 bitop3:0xbe
    v_mfma_f32_16x16x32_bf16 v[20:23], a[36:39], v[124:127], v[20:23]
    v_bitop3_b32 v3, v211, s48, v3 bitop3:0xbe
    buffer_load_dwordx4 v[152:155], v248, s[36:39], s62 offen offset:0 sc1
    v_mfma_f32_16x16x32_bf16 v[24:27], a[40:43], v[124:127], v[24:27]
    ds_read_b64_tr_b16 v[110:111], v169 offset:18432
    s_waitcnt vmcnt(7)
    v_bitop3_b32 v3, v213, s48, v3 bitop3:0xbe
    v_mfma_f32_16x16x32_bf16 v[28:31], a[44:47], v[124:127], v[28:31]
    s_waitcnt lgkmcnt(6)
    ds_read_b64_tr_b16 v[112:113], v170 offset:16384
    v_bitop3_b32 v3, v215, s48, v3 bitop3:0xbe
    v_mfma_f32_16x16x32_bf16 v[32:35], a[36:39], v[128:131], v[32:35]
    ds_read_b64_tr_b16 v[114:115], v170 offset:18432
    v_cmp_ne_u32 vcc, 0, v3
    s_cbranch_vccnz L_stc0_slow
L_stc0_back:
    v_mfma_f32_16x16x32_bf16 v[36:39], a[40:43], v[128:131], v[36:39]
    s_add_u32 s50, s8, 98304
    v_pk_fma_f32 v[238:239], v[176:177], v[202:203], v[188:189] op_sel_hi:[1,0,1]
    v_pk_fma_f32 v[240:241], v[178:179], v[202:203], v[190:191] op_sel_hi:[1,0,1]
    v_pk_fma_f32 v[56:57], v[56:57], v[200:201], v[238:239] op_sel_hi:[1,0,1]
    v_pk_fma_f32 v[58:59], v[58:59], v[200:201], v[240:241] op_sel_hi:[1,0,1]
    v_pk_fma_f32 v[242:243], v[180:181], v[202:203], v[192:193] op_sel_hi:[1,0,1]
    v_pk_fma_f32 v[244:245], v[182:183], v[202:203], v[194:195] op_sel_hi:[1,0,1]
    v_pk_fma_f32 v[60:61], v[60:61], v[200:201], v[242:243] op_sel_hi:[1,0,1]
    v_pk_fma_f32 v[62:63], v[62:63], v[200:201], v[244:245] op_sel_hi:[1,0,1]
    v_pk_mul_f32 v[56:57], v[56:57], v[60:61]
    v_pk_mul_f32 v[58:59], v[58:59], v[62:63]
    v_cvt_pk_bf16_f32 v60, v56, v57
    v_cvt_pk_bf16_f32 v61, v58, v59
    v_pk_fma_f32 v[242:243], v[176:177], v[206:207], v[188:189] op_sel_hi:[1,0,1]
    v_pk_fma_f32 v[244:245], v[178:179], v[206:207], v[190:191] op_sel_hi:[1,0,1]
    v_pk_fma_f32 v[68:69], v[68:69], v[204:205], v[242:243] op_sel_hi:[1,0,1]
    v_pk_fma_f32 v[70:71], v[70:71], v[204:205], v[244:245] op_sel_hi:[1,0,1]
    v_pk_fma_f32 v[238:239], v[180:181], v[206:207], v[192:193] op_sel_hi:[1,0,1]
    v_pk_fma_f32 v[240:241], v[182:183], v[206:207], v[194:195] op_sel_hi:[1,0,1]
    v_pk_fma_f32 v[72:73], v[72:73], v[204:205], v[238:239] op_sel_hi:[1,0,1]
    v_pk_fma_f32 v[74:75], v[74:75], v[204:205], v[240:241] op_sel_hi:[1,0,1]
    v_pk_mul_f32 v[68:69], v[68:69], v[72:73]
    v_pk_mul_f32 v[70:71], v[70:71], v[74:75]
    v_cvt_pk_bf16_f32 v62, v68, v69
    v_cvt_pk_bf16_f32 v63, v70, v71
    s_nop 0
    v_permlane16_swap_b32 v60, v62
    v_permlane16_swap_b32 v61, v63
    buffer_store_dwordx4 v[60:63], v173, s[36:39], s8 offen sc1
    v_pk_fma_f32 v[238:239], v[176:177], v[210:211], v[188:189] op_sel_hi:[1,0,1]
    v_pk_fma_f32 v[240:241], v[178:179], v[210:211], v[190:191] op_sel_hi:[1,0,1]
    v_pk_fma_f32 v[80:81], v[80:81], v[208:209], v[238:239] op_sel_hi:[1,0,1]
    v_pk_fma_f32 v[82:83], v[82:83], v[208:209], v[240:241] op_sel_hi:[1,0,1]
    v_pk_fma_f32 v[242:243], v[180:181], v[210:211], v[192:193] op_sel_hi:[1,0,1]
    v_pk_fma_f32 v[244:245], v[182:183], v[210:211], v[194:195] op_sel_hi:[1,0,1]
    v_pk_fma_f32 v[84:85], v[84:85], v[208:209], v[242:243] op_sel_hi:[1,0,1]
    v_pk_fma_f32 v[86:87], v[86:87], v[208:209], v[244:245] op_sel_hi:[1,0,1]
    v_pk_mul_f32 v[80:81], v[80:81], v[84:85]
    v_pk_mul_f32 v[82:83], v[82:83], v[86:87]
    v_cvt_pk_bf16_f32 v84, v80, v81
    v_cvt_pk_bf16_f32 v85, v82, v83
    v_pk_fma_f32 v[242:243], v[176:177], v[214:215], v[188:189] op_sel_hi:[1,0,1]
    v_pk_fma_f32 v[244:245], v[178:179], v[214:215], v[190:191] op_sel_hi:[1,0,1]
    v_pk_fma_f32 v[92:93], v[92:93], v[212:213], v[242:243] op_sel_hi:[1,0,1]
    v_pk_fma_f32 v[94:95], v[94:95], v[212:213], v[244:245] op_sel_hi:[1,0,1]
    v_pk_fma_f32 v[238:239], v[180:181], v[214:215], v[192:193] op_sel_hi:[1,0,1]
    v_pk_fma_f32 v[240:241], v[182:183], v[214:215], v[194:195] op_sel_hi:[1,0,1]
    v_pk_fma_f32 v[96:97], v[96:97], v[212:213], v[238:239] op_sel_hi:[1,0,1]
    v_pk_fma_f32 v[98:99], v[98:99], v[212:213], v[240:241] op_sel_hi:[1,0,1]
    v_pk_mul_f32 v[92:93], v[92:93], v[96:97]
    v_pk_mul_f32 v[94:95], v[94:95], v[98:99]
    v_cvt_pk_bf16_f32 v86, v92, v93
    v_cvt_pk_bf16_f32 v87, v94, v95
    s_nop 0
    v_permlane16_swap_b32 v84, v86
    v_permlane16_swap_b32 v85, v87
    buffer_store_dwordx4 v[84:87], v173, s[36:39], s50 offen sc1
    v_pk_fma_f32 v[238:239], v[184:185], v[202:203], v[196:197] op_sel_hi:[1,0,1]
    v_pk_fma_f32 v[240:241], v[186:187], v[202:203], v[198:199] op_sel_hi:[1,0,1]
    v_pk_fma_f32 v[64:65], v[64:65], v[200:201], v[238:239] op_sel_hi:[1,0,1]
    v_pk_fma_f32 v[66:67], v[66:67], v[200:201], v[240:241] op_sel_hi:[1,0,1]
    v_pk_fma_f32 v[242:243], v[184:185], v[206:207], v[196:197] op_sel_hi:[1,0,1]
    v_pk_fma_f32 v[244:245], v[186:187], v[206:207], v[198:199] op_sel_hi:[1,0,1]
    v_pk_fma_f32 v[76:77], v[76:77], v[204:205], v[242:243] op_sel_hi:[1,0,1]
    v_pk_fma_f32 v[78:79], v[78:79], v[204:205], v[244:245] op_sel_hi:[1,0,1]
    s_nop 0
    v_permlane32_swap_b32 v64, v76
    v_permlane32_swap_b32 v65, v77
    v_permlane32_swap_b32 v66, v78
    v_permlane32_swap_b32 v67, v79
    v_pk_mul_f32 v[64:65], v[64:65], v[76:77]
    v_pk_mul_f32 v[66:67], v[66:67], v[78:79]
    v_cvt_pk_bf16_f32 v56, v64, v65
    v_cvt_pk_bf16_f32 v57, v66, v67
    v_pk_fma_f32 v[238:239], v[184:185], v[210:211], v[196:197] op_sel_hi:[1,0,1]
    v_pk_fma_f32 v[240:241], v[186:187], v[210:211], v[198:199] op_sel_hi:[1,0,1]
    v_pk_fma_f32 v[88:89], v[88:89], v[208:209], v[238:239] op_sel_hi:[1,0,1]
    v_pk_fma_f32 v[90:91], v[90:91], v[208:209], v[240:241] op_sel_hi:[1,0,1]
    v_pk_fma_f32 v[242:243], v[184:185], v[214:215], v[196:197] op_sel_hi:[1,0,1]
    v_pk_fma_f32 v[244:245], v[186:187], v[214:215], v[198:199] op_sel_hi:[1,0,1]
    v_pk_fma_f32 v[100:101], v[100:101], v[212:213], v[242:243] op_sel_hi:[1,0,1]
    v_pk_fma_f32 v[102:103], v[102:103], v[212:213], v[244:245] op_sel_hi:[1,0,1]
    s_nop 0
    v_permlane32_swap_b32 v88, v100
    v_permlane32_swap_b32 v89, v101
    v_permlane32_swap_b32 v90, v102
    v_permlane32_swap_b32 v91, v103
    v_pk_mul_f32 v[88:89], v[88:89], v[100:101]
    v_pk_mul_f32 v[90:91], v[90:91], v[102:103]
    v_cvt_pk_bf16_f32 v58, v88, v89
    v_cvt_pk_bf16_f32 v59, v90, v91
    s_nop 0
    v_permlane16_swap_b32 v56, v58
    v_permlane16_swap_b32 v57, v59
    buffer_store_dwordx4 v[56:59], v174, s[36:39], s8 offen offset:512 sc1
    s_add_u32 s6, s6, 16384
    s_lshl_b32 s76, s72, 4
    s_add_u32 s76, s76, s73
    buffer_load_dwordx4 v[156:159], v248, s[36:39], s62 offen offset:1024 sc1
    v_mfma_f32_16x16x32_bf16 v[40:43], a[44:47], v[128:131], v[40:43]
    s_waitcnt lgkmcnt(6)
    ds_read_b64_tr_b16 v[116:117], v171 offset:16384
    v_mfma_f32_16x16x32_bf16 v[44:47], a[36:39], v[132:135], v[44:47]
    s_waitcnt lgkmcnt(3)
    ds_read_b64_tr_b16 v[118:119], v171 offset:18432
    v_mfma_f32_16x16x32_bf16 v[48:51], a[40:43], v[132:135], v[48:51]
    v_mfma_f32_16x16x32_bf16 v[52:55], a[44:47], v[132:135], v[52:55]
    buffer_load_dwordx4 v[160:163], v248, s[36:39], s62 offen offset:2048 sc1
    v_mfma_f32_16x16x32_bf16 v[8:11], a[48:51], v[104:107], v[8:11]
    s_waitcnt vmcnt(7)
    s_barrier
    ds_read_b64_tr_b16 v[120:121], v168 offset:20480
    v_mfma_f32_16x16x32_bf16 v[12:15], a[52:55], v[104:107], v[12:15]
    ds_read_b64_tr_b16 v[122:123], v168 offset:22528
    ds_read_b64 v[224:225], v216
    v_mfma_f32_16x16x32_bf16 v[16:19], a[56:59], v[104:107], v[16:19]
    ds_read_b64_tr_b16 v[124:125], v169 offset:20480
    ds_read_b64 v[226:227], v217
    v_mfma_f32_16x16x32_bf16 v[20:23], a[48:51], v[108:111], v[20:23]
    buffer_load_dwordx4 v[164:167], v248, s[36:39], s62 offen offset:3072 sc1
    v_mfma_f32_16x16x32_bf16 v[24:27], a[52:55], v[108:111], v[24:27]
    ds_read_b64_tr_b16 v[126:127], v169 offset:22528
    ds_read_b64 v[228:229], v218
    v_mfma_f32_16x16x32_bf16 v[28:31], a[56:59], v[108:111], v[28:31]
    s_waitcnt lgkmcnt(9)
    ds_read_b64_tr_b16 v[128:129], v170 offset:20480
    v_mfma_f32_16x16x32_bf16 v[32:35], a[48:51], v[112:115], v[32:35]
    s_add_u32 s62, s62, 4096
    ds_read_b64_tr_b16 v[130:131], v170 offset:22528
    v_mfma_f32_16x16x32_bf16 v[36:39], a[52:55], v[112:115], v[36:39]
    buffer_load_dwordx4 a[0:3], v248, s[36:39], s62 offen offset:0 sc1
    v_mfma_f32_16x16x32_bf16 v[40:43], a[56:59], v[112:115], v[40:43]
    s_waitcnt lgkmcnt(9)
    ds_read_b64_tr_b16 v[132:133], v171 offset:20480
    v_mfma_f32_16x16x32_bf16 v[44:47], a[48:51], v[116:119], v[44:47]
    s_waitcnt lgkmcnt(3)
    ds_read_b64_tr_b16 v[134:135], v171 offset:22528
    v_mfma_f32_16x16x32_bf16 v[48:51], a[52:55], v[116:119], v[48:51]
    v_lshlrev_b32 v230, 16, v224
    v_and_b32 v231, 0xffff0000, v224
    v_pk_mul_f32 v[230:231], v[230:231], v[220:221] op_sel_hi:[1,0]
    v_pk_mul_f32 v[234:235], v[230:231], v[230:231]
    v_lshlrev_b32 v232, 16, v225
    v_and_b32 v233, 0xffff0000, v225
    v_pk_mul_f32 v[232:233], v[232:233], v[220:221] op_sel_hi:[1,0]
    v_pk_mul_f32 v[236:237], v[232:233], v[232:233]
    v_lshlrev_b32 v2, 16, v226
    v_and_b32 v3, 0xffff0000, v226
    v_pk_mul_f32 v[2:3], v[2:3], v[220:221] op_sel:[0,1] op_sel_hi:[1,1]
    v_pk_add_f32 v[230:231], v[230:231], v[2:3]
    v_pk_fma_f32 v[234:235], v[2:3], v[2:3], v[234:235]
    v_lshlrev_b32 v2, 16, v227
    v_and_b32 v3, 0xffff0000, v227
    v_pk_mul_f32 v[2:3], v[2:3], v[220:221] op_sel:[0,1] op_sel_hi:[1,1]
    v_pk_add_f32 v[232:233], v[232:233], v[2:3]
    v_pk_fma_f32 v[236:237], v[2:3], v[2:3], v[236:237]
    v_lshlrev_b32 v2, 16, v228
    v_and_b32 v3, 0xffff0000, v228
    v_pk_mul_f32 v[2:3], v[2:3], v[222:223] op_sel_hi:[1,0]
    v_pk_add_f32 v[230:231], v[230:231], v[2:3]
    v_pk_fma_f32 v[234:235], v[2:3], v[2:3], v[234:235]
    v_lshlrev_b32 v2, 16, v229
    v_and_b32 v3, 0xffff0000, v229
    v_pk_mul_f32 v[2:3], v[2:3], v[222:223] op_sel_hi:[1,0]
    v_pk_add_f32 v[232:233], v[232:233], v[2:3]
    v_pk_fma_f32 v[236:237], v[2:3], v[2:3], v[236:237]
    v_mfma_f32_16x16x32_bf16 v[52:55], a[56:59], v[116:119], v[52:55]
    buffer_load_dwordx4 a[4:7], v248, s[36:39], s62 offen offset:1024 sc1
    v_mfma_f32_16x16x32_bf16 v[8:11], a[60:63], v[120:123], v[8:11]
    ds_read_b64_tr_b16 v[104:105], v168 offset:24576
    v_permlane32_swap_b32 v230, v234
    v_mfma_f32_16x16x32_bf16 v[12:15], a[64:67], v[120:123], v[12:15]
    ds_read_b64_tr_b16 v[106:107], v168 offset:26624
    v_permlane32_swap_b32 v231, v235
    v_mfma_f32_16x16x32_bf16 v[16:19], a[68:71], v[120:123], v[16:19]
    ds_read_b64_tr_b16 v[108:109], v169 offset:24576
    v_permlane32_swap_b32 v232, v236
    v_mfma_f32_16x16x32_bf16 v[20:23], a[60:63], v[124:127], v[20:23]
    buffer_load_dwordx4 a[8:11], v248, s[36:39], s62 offen offset:2048 sc1
    v_mfma_f32_16x16x32_bf16 v[24:27], a[64:67], v[124:127], v[24:27]
    ds_read_b64_tr_b16 v[110:111], v169 offset:26624
    v_permlane32_swap_b32 v233, v237
    v_mfma_f32_16x16x32_bf16 v[28:31], a[68:71], v[124:127], v[28:31]
    s_waitcnt lgkmcnt(6)
    ds_read_b64_tr_b16 v[112:113], v170 offset:24576
    v_add_f32 v230, v230, v234
    v_mfma_f32_16x16x32_bf16 v[32:35], a[60:63], v[128:131], v[32:35]
    ds_read_b64_tr_b16 v[114:115], v170 offset:26624
    v_add_f32 v231, v231, v235
    v_add_f32 v232, v232, v236
    v_mfma_f32_16x16x32_bf16 v[36:39], a[64:67], v[128:131], v[36:39]
    buffer_load_dwordx4 a[12:15], v248, s[36:39], s62 offen offset:3072 sc1
    v_mfma_f32_16x16x32_bf16 v[40:43], a[68:71], v[128:131], v[40:43]
    s_waitcnt lgkmcnt(6)
    ds_read_b64_tr_b16 v[116:117], v171 offset:24576
    v_add_f32 v233, v233, v237
    v_mfma_f32_16x16x32_bf16 v[44:47], a[60:63], v[132:135], v[44:47]
    s_waitcnt lgkmcnt(3)
    ds_read_b64_tr_b16 v[118:119], v171 offset:26624
    v_permlane16_swap_b32 v230, v232
    v_mfma_f32_16x16x32_bf16 v[48:51], a[64:67], v[132:135], v[48:51]
    s_add_u32 s62, s62, 4096
    v_permlane16_swap_b32 v231, v233
    v_mfma_f32_16x16x32_bf16 v[52:55], a[68:71], v[132:135], v[52:55]
    buffer_load_dwordx4 a[16:19], v248, s[36:39], s62 offen offset:0 sc1
    v_mfma_f32_16x16x32_bf16 v[8:11], a[72:75], v[104:107], v[8:11]
    ds_read_b64_tr_b16 v[120:121], v168 offset:28672
    v_add_f32 v230, v230, v232
    v_mfma_f32_16x16x32_bf16 v[12:15], a[76:79], v[104:107], v[12:15]
    ds_read_b64_tr_b16 v[122:123], v168 offset:30720
    v_add_f32 v231, v231, v233
    v_mfma_f32_16x16x32_bf16 v[16:19], a[80:83], v[104:107], v[16:19]
    ds_read_b64_tr_b16 v[124:125], v169 offset:28672
    v_lshrrev_b32 v2, 4, v1
    v_mfma_f32_16x16x32_bf16 v[20:23], a[72:75], v[108:111], v[20:23]
    buffer_load_dwordx4 a[20:23], v248, s[36:39], s62 offen offset:1024 sc1
    v_mfma_f32_16x16x32_bf16 v[24:27], a[76:79], v[108:111], v[24:27]
    ds_read_b64_tr_b16 v[126:127], v169 offset:30720
    v_lshlrev_b32 v2, 3, v2
    v_mfma_f32_16x16x32_bf16 v[28:31], a[80:83], v[108:111], v[28:31]
    s_waitcnt lgkmcnt(6)
    s_lshl_b32 s50, s3, 5
    s_add_u32 s50, s50, 0
    ds_read_b64_tr_b16 v[128:129], v170 offset:28672
    v_mfma_f32_16x16x32_bf16 v[32:35], a[72:75], v[112:115], v[32:35]
    ds_read_b64_tr_b16 v[130:131], v170 offset:30720
    v_add_u32 v2, s50, v2
    v_mfma_f32_16x16x32_bf16 v[36:39], a[76:79], v[112:115], v[36:39]
    buffer_load_dwordx4 a[24:27], v248, s[36:39], s62 offen offset:2048 sc1
    v_mfma_f32_16x16x32_bf16 v[40:43], a[80:83], v[112:115], v[40:43]
    s_waitcnt lgkmcnt(6)
    ds_read_b64_tr_b16 v[132:133], v171 offset:28672
    v_add_f32_dpp v230, v230, v230 row_ror:8 row_mask:0xf bank_mask:0xf
    v_mfma_f32_16x16x32_bf16 v[44:47], a[72:75], v[116:119], v[44:47]
    s_waitcnt lgkmcnt(3)
    ds_read_b64_tr_b16 v[134:135], v171 offset:30720
    v_add_f32_dpp v231, v231, v231 row_ror:8 row_mask:0xf bank_mask:0xf
    v_mfma_f32_16x16x32_bf16 v[48:51], a[76:79], v[116:119], v[48:51]
    v_add_f32_dpp v230, v230, v230 row_ror:4 row_mask:0xf bank_mask:0xf
    v_add_f32_dpp v231, v231, v231 row_ror:4 row_mask:0xf bank_mask:0xf
    v_mfma_f32_16x16x32_bf16 v[52:55], a[80:83], v[116:119], v[52:55]
    s_waitcnt vmcnt(10)
    s_barrier
    s_cmp_eq_u32 s3, 0
    s_cbranch_scc0 L_wf11
    s_lshl_b32 s54, s76, 7
    s_add_u32 s54, s54, 23288832
    v_mov_b32 v254, 0
    v_mov_b32 v255, s48
    s_mov_b64 exec, 1
    buffer_store_dword v255, v254, s[36:39], s54 offen sc1
    s_mov_b64 exec, -1
L_wf11:
    buffer_load_dwordx4 a[28:31], v248, s[36:39], s62 offen offset:3072 sc1
    v_mfma_f32_16x16x32_bf16 v[8:11], a[84:87], v[120:123], v[8:11]
    ds_read_b64_tr_b16 v[104:105], v168 offset:32768
    v_add_f32_dpp v230, v230, v230 row_ror:2 row_mask:0xf bank_mask:0xf
    v_mfma_f32_16x16x32_bf16 v[12:15], a[88:91], v[120:123], v[12:15]
    ds_read_b64_tr_b16 v[106:107], v168 offset:34816
    v_add_f32_dpp v231, v231, v231 row_ror:2 row_mask:0xf bank_mask:0xf
    v_mfma_f32_16x16x32_bf16 v[16:19], a[92:95], v[120:123], v[16:19]
    s_add_u32 s62, s62, 4096
    ds_read_b64_tr_b16 v[108:109], v169 offset:32768
    v_add_f32_dpp v230, v230, v230 row_ror:1 row_mask:0xf bank_mask:0xf
    v_mfma_f32_16x16x32_bf16 v[20:23], a[84:87], v[124:127], v[20:23]
    buffer_load_dwordx4 a[32:35], v248, s[36:39], s62 offen offset:0 sc1
    v_mfma_f32_16x16x32_bf16 v[24:27], a[88:91], v[124:127], v[24:27]
    ds_read_b64_tr_b16 v[110:111], v169 offset:34816
    v_add_f32_dpp v231, v231, v231 row_ror:1 row_mask:0xf bank_mask:0xf
    v_mfma_f32_16x16x32_bf16 v[28:31], a[92:95], v[124:127], v[28:31]
    ds_read_b64_tr_b16 v[112:113], v170 offset:32768
    s_mov_b32 exec_lo, 0x00010001
    s_mov_b32 exec_hi, 0x00010001
    ds_write_b64 v2, v[230:231]
    s_mov_b64 exec, -1
    s_waitcnt lgkmcnt(8)
    v_mfma_f32_16x16x32_bf16 v[32:35], a[84:87], v[128:131], v[32:35]
    ds_read_b64_tr_b16 v[114:115], v170 offset:34816
    v_lshlrev_b32 v2, 2, v1
    v_mfma_f32_16x16x32_bf16 v[36:39], a[88:91], v[128:131], v[36:39]
    buffer_load_dwordx4 a[36:39], v248, s[36:39], s62 offen offset:1024 sc1
    v_mfma_f32_16x16x32_bf16 v[40:43], a[92:95], v[128:131], v[40:43]
    s_waitcnt lgkmcnt(7)
    ds_read_b64_tr_b16 v[116:117], v171 offset:32768
    v_and_b32 v2, 12, v2
    v_mfma_f32_16x16x32_bf16 v[44:47], a[84:87], v[132:135], v[44:47]
    s_waitcnt lgkmcnt(3)
    ds_read_b64_tr_b16 v[118:119], v171 offset:34816
    v_add_u32 v2, 0, v2
    v_mfma_f32_16x16x32_bf16 v[48:51], a[88:91], v[132:135], v[48:51]
    s_waitcnt lgkmcnt(0)
    s_barrier
    v_mfma_f32_16x16x32_bf16 v[52:55], a[92:95], v[132:135], v[52:55]
    buffer_load_dwordx4 a[40:43], v248, s[36:39], s62 offen offset:2048 sc1
    v_mfma_f32_16x16x32_bf16 v[8:11], a[96:99], v[104:107], v[8:11]
    ds_read_b64_tr_b16 v[120:121], v168 offset:36864
    ds_read2_b32 v[230:231], v2 offset0:0 offset1:4
    v_mfma_f32_16x16x32_bf16 v[12:15], a[100:103], v[104:107], v[12:15]
    ds_read_b64_tr_b16 v[122:123], v168 offset:38912
    ds_read2_b32 v[232:233], v2 offset0:8 offset1:12
    v_mfma_f32_16x16x32_bf16 v[16:19], a[104:107], v[104:107], v[16:19]
    ds_read_b64_tr_b16 v[124:125], v169 offset:36864
    ds_read2_b32 v[234:235], v2 offset0:16 offset1:20
    ds_read2_b32 v[236:237], v2 offset0:24 offset1:28
    v_mfma_f32_16x16x32_bf16 v[20:23], a[96:99], v[108:111], v[20:23]
    buffer_load_dwordx4 a[44:47], v248, s[36:39], s62 offen offset:3072 sc1
    v_mfma_f32_16x16x32_bf16 v[24:27], a[100:103], v[108:111], v[24:27]
    ds_read_b64_tr_b16 v[126:127], v169 offset:38912
    v_mov_b32 v225, s48
    v_mfma_f32_16x16x32_bf16 v[28:31], a[104:107], v[108:111], v[28:31]
    ds_read_b64_tr_b16 v[128:129], v170 offset:36864
    v_mov_b32 v227, s48
    v_mfma_f32_16x16x32_bf16 v[32:35], a[96:99], v[112:115], v[32:35]
    s_add_u32 s62, s62, 4096
    s_add_u32 s7, s7, 16384
    ds_read_b64_tr_b16 v[130:131], v170 offset:38912
    v_mfma_f32_16x16x32_bf16 v[36:39], a[100:103], v[112:115], v[36:39]
    buffer_load_dwordx4 a[48:51], v248, s[36:39], s62 offen offset:0 sc1
    v_mfma_f32_16x16x32_bf16 v[40:43], a[104:107], v[112:115], v[40:43]
    ds_read_b64_tr_b16 v[132:133], v171 offset:36864
    s_waitcnt lgkmcnt(7)
    v_add_f32 v230, v230, v232
    v_mfma_f32_16x16x32_bf16 v[44:47], a[96:99], v[116:119], v[44:47]
    s_waitcnt lgkmcnt(3)
    ds_read_b64_tr_b16 v[134:135], v171 offset:38912
    v_add_f32 v231, v231, v233
    v_mfma_f32_16x16x32_bf16 v[48:51], a[100:103], v[116:119], v[48:51]
    v_add_f32 v234, v234, v236
    v_mfma_f32_16x16x32_bf16 v[52:55], a[104:107], v[116:119], v[52:55]
    buffer_load_dwordx4 a[52:55], v248, s[36:39], s62 offen offset:1024 sc1
    v_mfma_f32_16x16x32_bf16 v[8:11], a[108:111], v[120:123], v[8:11]
    ds_read_b64_tr_b16 v[104:105], v168 offset:40960
    v_add_f32 v235, v235, v237
    v_mfma_f32_16x16x32_bf16 v[12:15], a[112:115], v[120:123], v[12:15]
    ds_read_b64_tr_b16 v[106:107], v168 offset:43008
    v_add_f32 v230, v230, v234
    v_mfma_f32_16x16x32_bf16 v[16:19], a[116:119], v[120:123], v[16:19]
    ds_read_b64_tr_b16 v[108:109], v169 offset:40960
    v_add_f32 v231, v231, v235
    v_mfma_f32_16x16x32_bf16 v[20:23], a[108:111], v[124:127], v[20:23]
    buffer_load_dwordx4 a[56:59], v248, s[36:39], s62 offen offset:2048 sc1
    v_mfma_f32_16x16x32_bf16 v[24:27], a[112:115], v[124:127], v[24:27]
    ds_read_b64_tr_b16 v[110:111], v169 offset:43008
    v_mul_f32 v230, 0x3acccccd, v230
    v_mfma_f32_16x16x32_bf16 v[28:31], a[116:119], v[124:127], v[28:31]
    s_waitcnt lgkmcnt(6)
    ds_read_b64_tr_b16 v[112:113], v170 offset:40960
    v_mul_f32 v234, v230, v230
    v_mfma_f32_16x16x32_bf16 v[32:35], a[108:111], v[128:131], v[32:35]
    ds_read_b64_tr_b16 v[114:115], v170 offset:43008
    v_mov_b32 v224, 0x3acccccd
    v_fma_f32 v231, v231, v224, -v234
    v_mfma_f32_16x16x32_bf16 v[36:39], a[112:115], v[128:131], v[36:39]
    buffer_load_dwordx4 a[60:63], v248, s[36:39], s62 offen offset:3072 sc1
    v_mfma_f32_16x16x32_bf16 v[40:43], a[116:119], v[128:131], v[40:43]
    s_waitcnt lgkmcnt(6)
    ds_read_b64_tr_b16 v[116:117], v171 offset:40960
    v_max_f32 v231, 0, v231
    v_mfma_f32_16x16x32_bf16 v[44:47], a[108:111], v[132:135], v[44:47]
    s_waitcnt lgkmcnt(3)
    ds_read_b64_tr_b16 v[118:119], v171 offset:43008
    v_add_f32 v231, 0x3727c5ac, v231
    v_mfma_f32_16x16x32_bf16 v[48:51], a[112:115], v[132:135], v[48:51]
    s_add_u32 s62, s62, 4096
    v_rsq_f32 v224, v231
    v_mfma_f32_16x16x32_bf16 v[52:55], a[116:119], v[132:135], v[52:55]
    buffer_load_dwordx4 a[64:67], v248, s[36:39], s62 offen offset:0 sc1
    v_mfma_f32_16x16x32_bf16 v[8:11], a[120:123], v[104:107], v[8:11]
    ds_read_b64_tr_b16 v[120:121], v168 offset:45056
    v_mul_f32_e64 v226, -v230, v224
    v_mfma_f32_16x16x32_bf16 v[12:15], a[124:127], v[104:107], v[12:15]
    ds_read_b64_tr_b16 v[122:123], v168 offset:47104
    s_mov_b64 exec, 0xf
    buffer_store_dwordx4 v[224:227], v248, s[36:39], s7 offen sc1
    s_mov_b64 exec, -1
    v_mfma_f32_16x16x32_bf16 v[16:19], a[128:131], v[104:107], v[16:19]
    s_and_b32 s50, s3, 1
    s_lshl_b32 s51, s74, 1
    ds_read_b64_tr_b16 v[124:125], v169 offset:45056
    v_mfma_f32_16x16x32_bf16 v[20:23], a[120:123], v[108:111], v[20:23]
    buffer_load_dwordx4 a[68:71], v248, s[36:39], s62 offen offset:1024 sc1
    v_mfma_f32_16x16x32_bf16 v[24:27], a[124:127], v[108:111], v[24:27]
    s_add_u32 s52, s51, s50
    s_mul_i32 s52, s52, 192
    ds_read_b64_tr_b16 v[126:127], v169 offset:47104
    v_mfma_f32_16x16x32_bf16 v[28:31], a[128:131], v[108:111], v[28:31]
    s_waitcnt lgkmcnt(6)
    s_mul_i32 s53, s3, 48
    s_add_u32 s52, s52, s53
    ds_read_b64_tr_b16 v[128:129], v170 offset:45056
    v_mfma_f32_16x16x32_bf16 v[32:35], a[120:123], v[112:115], v[32:35]
    s_lshl_b32 s52, s52, 8
    s_add_u32 s52, s52, 16777216
    ds_read_b64_tr_b16 v[130:131], v170 offset:47104
    v_mfma_f32_16x16x32_bf16 v[36:39], a[124:127], v[112:115], v[36:39]
    buffer_load_dwordx4 a[72:75], v248, s[36:39], s62 offen offset:2048 sc1
    v_mfma_f32_16x16x32_bf16 v[40:43], a[128:131], v[112:115], v[40:43]
    s_waitcnt lgkmcnt(6)
    ds_read_b64_tr_b16 v[132:133], v171 offset:45056
    v_add_u32 v216, s52, v248
    v_mfma_f32_16x16x32_bf16 v[44:47], a[120:123], v[116:119], v[44:47]
    s_waitcnt lgkmcnt(3)
    ds_read_b64_tr_b16 v[134:135], v171 offset:47104
    v_add_u32 v218, 3145728, v216
    v_mfma_f32_16x16x32_bf16 v[48:51], a[124:127], v[116:119], v[48:51]
    v_mfma_f32_16x16x32_bf16 v[52:55], a[128:131], v[116:119], v[52:55]
    buffer_load_dwordx4 a[76:79], v248, s[36:39], s62 offen offset:3072 sc1
    v_mfma_f32_16x16x32_bf16 v[8:11], a[132:135], v[120:123], v[8:11]
    s_xor_b32 s50, s50, 1
    s_add_u32 s52, s51, s50
    ds_read_b64_tr_b16 v[104:105], v168 offset:49152
    v_mfma_f32_16x16x32_bf16 v[12:15], a[136:139], v[120:123], v[12:15]
    s_mul_i32 s52, s52, 192
    s_add_u32 s52, s52, s53
    ds_read_b64_tr_b16 v[106:107], v168 offset:51200
    v_mfma_f32_16x16x32_bf16 v[16:19], a[140:143], v[120:123], v[16:19]
    s_add_u32 s62, s62, 4096
    s_lshl_b32 s52, s52, 8
    s_add_u32 s52, s52, 16777216
    ds_read_b64_tr_b16 v[108:109], v169 offset:49152
    v_mfma_f32_16x16x32_bf16 v[20:23], a[132:135], v[124:127], v[20:23]
    buffer_load_dwordx4 a[80:83], v248, s[36:39], s62 offen offset:0 sc1
    v_mfma_f32_16x16x32_bf16 v[24:27], a[136:139], v[124:127], v[24:27]
    ds_read_b64_tr_b16 v[110:111], v169 offset:51200
    v_add_u32 v217, s52, v248
    v_mfma_f32_16x16x32_bf16 v[28:31], a[140:143], v[124:127], v[28:31]
    s_waitcnt lgkmcnt(6)
    ds_read_b64_tr_b16 v[112:113], v170 offset:49152
    v_add_u32 v219, 3145728, v217
    v_mfma_f32_16x16x32_bf16 v[32:35], a[132:135], v[128:131], v[32:35]
    s_lshr_b32 s50, s74, 1
    s_lshl_b32 s50, s50, 2
    ds_read_b64_tr_b16 v[114:115], v170 offset:51200
    v_mfma_f32_16x16x32_bf16 v[36:39], a[136:139], v[128:131], v[36:39]
    buffer_load_dwordx4 a[84:87], v248, s[36:39], s62 offen offset:1024 sc1
    v_mfma_f32_16x16x32_bf16 v[40:43], a[140:143], v[128:131], v[40:43]
    s_waitcnt lgkmcnt(6)
    s_add_u32 s50, s50, s3
    s_lshl_b32 s50, s50, 9
    ds_read_b64_tr_b16 v[116:117], v171 offset:49152
    v_mfma_f32_16x16x32_bf16 v[44:47], a[132:135], v[132:135], v[44:47]
    s_waitcnt lgkmcnt(3)
    s_add_u32 s50, s50, 89088
    ds_read_b64_tr_b16 v[118:119], v171 offset:51200
    v_mfma_f32_16x16x32_bf16 v[48:51], a[136:139], v[132:135], v[48:51]
    v_mfma_f32_16x16x32_bf16 v[52:55], a[140:143], v[132:135], v[52:55]
    buffer_load_dwordx4 a[88:91], v248, s[36:39], s62 offen offset:2048 sc1
    v_mfma_f32_16x16x32_bf16 v[8:11], a[144:147], v[104:107], v[8:11]
    ds_read_b64_tr_b16 v[120:121], v168 offset:53248
    v_min_u32 v246, 13, v1
    v_mfma_f32_16x16x32_bf16 v[12:15], a[148:151], v[104:107], v[12:15]
    ds_read_b64_tr_b16 v[122:123], v168 offset:55296
    v_lshlrev_b32 v246, 7, v246
    v_mfma_f32_16x16x32_bf16 v[16:19], a[152:155], v[104:107], v[16:19]
    ds_read_b64_tr_b16 v[124:125], v169 offset:53248
    v_mov_b32 v2, s50
    v_mfma_f32_16x16x32_bf16 v[20:23], a[144:147], v[108:111], v[20:23]
    buffer_load_dwordx4 a[92:95], v248, s[36:39], s62 offen offset:3072 sc1
    v_mfma_f32_16x16x32_bf16 v[24:27], a[148:151], v[108:111], v[24:27]
    ds_read_b64_tr_b16 v[126:127], v169 offset:55296
    v_mov_b32 v3, 31488
    v_mfma_f32_16x16x32_bf16 v[28:31], a[152:155], v[108:111], v[28:31]
    ds_read_b64_tr_b16 v[128:129], v170 offset:53248
    v_cmp_lt_u32 vcc, 3, v1
    s_nop 1
    v_cndmask_b32 v2, v2, v3, vcc
    s_waitcnt lgkmcnt(7)
    v_mfma_f32_16x16x32_bf16 v[32:35], a[144:147], v[112:115], v[32:35]
    s_add_u32 s62, s62, 4096
    ds_read_b64_tr_b16 v[130:131], v170 offset:55296
    v_add_u32 v246, v246, v2
    v_mfma_f32_16x16x32_bf16 v[36:39], a[148:151], v[112:115], v[36:39]
    buffer_load_dwordx4 a[96:99], v248, s[36:39], s62 offen offset:0 sc1
    v_mfma_f32_16x16x32_bf16 v[40:43], a[152:155], v[112:115], v[40:43]
    s_waitcnt lgkmcnt(6)
    ds_read_b64_tr_b16 v[132:133], v171 offset:53248
    v_mfma_f32_16x16x32_bf16 v[44:47], a[144:147], v[116:119], v[44:47]
    s_waitcnt lgkmcnt(3)
    ds_read_b64_tr_b16 v[134:135], v171 offset:55296
    v_mfma_f32_16x16x32_bf16 v[48:51], a[148:151], v[116:119], v[48:51]
    buffer_load_dword v247, v246, s[36:39], s17 offen sc1
    v_mfma_f32_16x16x32_bf16 v[52:55], a[152:155], v[116:119], v[52:55]
    buffer_load_dwordx4 a[100:103], v248, s[36:39], s62 offen offset:1024 sc1
    v_mfma_f32_16x16x32_bf16 v[8:11], a[156:159], v[120:123], v[8:11]
    ds_read_b64_tr_b16 v[104:105], v168 offset:57344
    v_mfma_f32_16x16x32_bf16 v[12:15], a[160:163], v[120:123], v[12:15]
    ds_read_b64_tr_b16 v[106:107], v168 offset:59392
    v_mfma_f32_16x16x32_bf16 v[16:19], a[164:167], v[120:123], v[16:19]
    ds_read_b64_tr_b16 v[108:109], v169 offset:57344
    v_mfma_f32_16x16x32_bf16 v[20:23], a[156:159], v[124:127], v[20:23]
    buffer_load_dwordx4 a[104:107], v248, s[36:39], s62 offen offset:2048 sc1
    v_mfma_f32_16x16x32_bf16 v[24:27], a[160:163], v[124:127], v[24:27]
    ds_read_b64_tr_b16 v[110:111], v169 offset:59392
    v_mfma_f32_16x16x32_bf16 v[28:31], a[164:167], v[124:127], v[28:31]
    s_waitcnt lgkmcnt(6)
    ds_read_b64_tr_b16 v[112:113], v170 offset:57344
    v_mfma_f32_16x16x32_bf16 v[32:35], a[156:159], v[128:131], v[32:35]
    ds_read_b64_tr_b16 v[114:115], v170 offset:59392
    v_mfma_f32_16x16x32_bf16 v[36:39], a[160:163], v[128:131], v[36:39]
    buffer_load_dwordx4 a[108:111], v248, s[36:39], s62 offen offset:3072 sc1
    v_mfma_f32_16x16x32_bf16 v[40:43], a[164:167], v[128:131], v[40:43]
    s_waitcnt lgkmcnt(6)
    ds_read_b64_tr_b16 v[116:117], v171 offset:57344
    v_mfma_f32_16x16x32_bf16 v[44:47], a[156:159], v[132:135], v[44:47]
    s_waitcnt lgkmcnt(3)
    ds_read_b64_tr_b16 v[118:119], v171 offset:59392
    v_mfma_f32_16x16x32_bf16 v[48:51], a[160:163], v[132:135], v[48:51]
    s_add_u32 s62, s62, 4096
    v_mfma_f32_16x16x32_bf16 v[52:55], a[164:167], v[132:135], v[52:55]
    buffer_load_dwordx4 a[112:115], v248, s[36:39], s62 offen offset:0 sc1
    v_mfma_f32_16x16x32_bf16 v[8:11], a[168:171], v[104:107], v[8:11]
    ds_read_b64_tr_b16 v[120:121], v168 offset:61440
    v_mfma_f32_16x16x32_bf16 v[12:15], a[172:175], v[104:107], v[12:15]
    ds_read_b64_tr_b16 v[122:123], v168 offset:63488
    v_add_u32 v168, 65536, v168
    v_mfma_f32_16x16x32_bf16 v[16:19], a[176:179], v[104:107], v[16:19]
    ds_read_b64_tr_b16 v[124:125], v169 offset:61440
    v_mfma_f32_16x16x32_bf16 v[20:23], a[168:171], v[108:111], v[20:23]
    buffer_load_dwordx4 a[116:119], v248, s[36:39], s62 offen offset:1024 sc1
    v_mfma_f32_16x16x32_bf16 v[24:27], a[172:175], v[108:111], v[24:27]
    ds_read_b64_tr_b16 v[126:127], v169 offset:63488
    v_add_u32 v169, 65536, v169
    v_mfma_f32_16x16x32_bf16 v[28:31], a[176:179], v[108:111], v[28:31]
    s_waitcnt lgkmcnt(6)
    ds_read_b64_tr_b16 v[128:129], v170 offset:61440
    v_mfma_f32_16x16x32_bf16 v[32:35], a[168:171], v[112:115], v[32:35]
    ds_read_b64_tr_b16 v[130:131], v170 offset:63488
    v_add_u32 v170, 65536, v170
    v_mfma_f32_16x16x32_bf16 v[36:39], a[172:175], v[112:115], v[36:39]
    buffer_load_dwordx4 a[120:123], v248, s[36:39], s62 offen offset:2048 sc1
    v_mfma_f32_16x16x32_bf16 v[40:43], a[176:179], v[112:115], v[40:43]
    s_waitcnt lgkmcnt(6)
    ds_read_b64_tr_b16 v[132:133], v171 offset:61440
    v_mfma_f32_16x16x32_bf16 v[44:47], a[168:171], v[116:119], v[44:47]
    s_waitcnt lgkmcnt(3)
    ds_read_b64_tr_b16 v[134:135], v171 offset:63488
    v_add_u32 v171, 65536, v171
    v_mfma_f32_16x16x32_bf16 v[48:51], a[172:175], v[116:119], v[48:51]
    v_mfma_f32_16x16x32_bf16 v[52:55], a[176:179], v[116:119], v[52:55]
    buffer_load_dwordx4 a[124:127], v248, s[36:39], s62 offen offset:3072 sc1
    v_mfma_f32_16x16x32_bf16 v[8:11], a[180:183], v[120:123], v[8:11]
    ds_read_b64_tr_b16 v[104:105], v168 offset:0
    v_mfma_f32_16x16x32_bf16 v[12:15], a[184:187], v[120:123], v[12:15]
    ds_read_b64_tr_b16 v[106:107], v168 offset:2048
    v_mfma_f32_16x16x32_bf16 v[16:19], a[188:191], v[120:123], v[16:19]
    ds_read_b64_tr_b16 v[108:109], v169 offset:0
    v_mfma_f32_16x16x32_bf16 v[20:23], a[180:183], v[124:127], v[20:23]
    buffer_load_dwordx4 v[200:203], v175, s[36:39], s6 offen offset:0 sc1
    v_mfma_f32_16x16x32_bf16 v[24:27], a[184:187], v[124:127], v[24:27]
    ds_read_b64_tr_b16 v[110:111], v169 offset:2048
    v_mfma_f32_16x16x32_bf16 v[28:31], a[188:191], v[124:127], v[28:31]
    s_waitcnt lgkmcnt(6)
    ds_read_b64_tr_b16 v[112:113], v170 offset:0
    v_mfma_f32_16x16x32_bf16 v[32:35], a[180:183], v[128:131], v[32:35]
    ds_read_b64_tr_b16 v[114:115], v170 offset:2048
    v_mfma_f32_16x16x32_bf16 v[36:39], a[184:187], v[128:131], v[36:39]
    buffer_load_dwordx4 v[204:207], v175, s[36:39], s6 offen offset:256 sc1
    v_mfma_f32_16x16x32_bf16 v[40:43], a[188:191], v[128:131], v[40:43]
    s_waitcnt lgkmcnt(6)
    ds_read_b64_tr_b16 v[116:117], v171 offset:0
    v_mfma_f32_16x16x32_bf16 v[44:47], a[180:183], v[132:135], v[44:47]
    s_waitcnt lgkmcnt(3)
    ds_read_b64_tr_b16 v[118:119], v171 offset:2048
    v_mfma_f32_16x16x32_bf16 v[48:51], a[184:187], v[132:135], v[48:51]
    buffer_load_dwordx4 v[208:211], v175, s[36:39], s6 offen offset:512 sc1
    v_mfma_f32_16x16x32_bf16 v[52:55], a[188:191], v[132:135], v[52:55]
    buffer_load_dwordx4 v[212:215], v175, s[36:39], s6 offen offset:768 sc1
    v_mfma_f32_16x16x32_bf16 v[8:11], a[192:195], v[104:107], v[8:11]
    ds_read_b64_tr_b16 v[120:121], v168 offset:4096
    s_waitcnt vmcnt(11)
    v_cmp_ne_u32 vcc, s48, v247
    s_cbranch_vccnz L_chk12_slow
L_chk12_back:
    v_mfma_f32_16x16x32_bf16 v[12:15], a[196:199], v[104:107], v[12:15]
    ds_read_b64_tr_b16 v[122:123], v168 offset:6144
    v_mfma_f32_16x16x32_bf16 v[16:19], a[200:203], v[104:107], v[16:19]
    ds_read_b64_tr_b16 v[124:125], v169 offset:4096
    v_mfma_f32_16x16x32_bf16 v[20:23], a[192:195], v[108:111], v[20:23]
    buffer_load_dwordx4 v[56:59], v216, s[36:39], 0 offen offset:0 sc1
    v_mfma_f32_16x16x32_bf16 v[24:27], a[196:199], v[108:111], v[24:27]
    ds_read_b64_tr_b16 v[126:127], v169 offset:6144
    v_mfma_f32_16x16x32_bf16 v[28:31], a[200:203], v[108:111], v[28:31]
    s_waitcnt lgkmcnt(6)
    ds_read_b64_tr_b16 v[128:129], v170 offset:4096
    v_mfma_f32_16x16x32_bf16 v[32:35], a[192:195], v[112:115], v[32:35]
    ds_read_b64_tr_b16 v[130:131], v170 offset:6144
    v_mfma_f32_16x16x32_bf16 v[36:39], a[196:199], v[112:115], v[36:39]
    buffer_load_dwordx4 v[60:63], v216, s[36:39], 0 offen offset:1024 sc1
    v_mfma_f32_16x16x32_bf16 v[40:43], a[200:203], v[112:115], v[40:43]
    s_waitcnt lgkmcnt(6)
    ds_read_b64_tr_b16 v[132:133], v171 offset:4096
    v_mfma_f32_16x16x32_bf16 v[44:47], a[192:195], v[116:119], v[44:47]
    s_waitcnt lgkmcnt(3)
    ds_read_b64_tr_b16 v[134:135], v171 offset:6144
    v_mfma_f32_16x16x32_bf16 v[48:51], a[196:199], v[116:119], v[48:51]
    v_mfma_f32_16x16x32_bf16 v[52:55], a[200:203], v[116:119], v[52:55]
    buffer_load_dwordx4 v[64:67], v216, s[36:39], 0 offen offset:2048 sc1
    v_mfma_f32_16x16x32_bf16 v[8:11], a[204:207], v[120:123], v[8:11]
    ds_read_b64_tr_b16 v[104:105], v168 offset:8192
    v_mfma_f32_16x16x32_bf16 v[12:15], a[208:211], v[120:123], v[12:15]
    ds_read_b64_tr_b16 v[106:107], v168 offset:10240
    v_mfma_f32_16x16x32_bf16 v[16:19], a[212:215], v[120:123], v[16:19]
    ds_read_b64_tr_b16 v[108:109], v169 offset:8192
    v_mfma_f32_16x16x32_bf16 v[20:23], a[204:207], v[124:127], v[20:23]
    buffer_load_dwordx4 v[68:71], v216, s[36:39], 0 offen offset:3072 sc1
    v_mfma_f32_16x16x32_bf16 v[24:27], a[208:211], v[124:127], v[24:27]
    ds_read_b64_tr_b16 v[110:111], v169 offset:10240
    v_mfma_f32_16x16x32_bf16 v[28:31], a[212:215], v[124:127], v[28:31]
    s_waitcnt lgkmcnt(6)
    ds_read_b64_tr_b16 v[112:113], v170 offset:8192
    v_mfma_f32_16x16x32_bf16 v[32:35], a[204:207], v[128:131], v[32:35]
    ds_read_b64_tr_b16 v[114:115], v170 offset:10240
    v_mfma_f32_16x16x32_bf16 v[36:39], a[208:211], v[128:131], v[36:39]
    buffer_load_dwordx4 v[72:75], v216, s[36:39], s4 offen offset:0 sc1
    v_mfma_f32_16x16x32_bf16 v[40:43], a[212:215], v[128:131], v[40:43]
    s_waitcnt lgkmcnt(6)
    ds_read_b64_tr_b16 v[116:117], v171 offset:8192
    v_mfma_f32_16x16x32_bf16 v[44:47], a[204:207], v[132:135], v[44:47]
    s_waitcnt lgkmcnt(3)
    ds_read_b64_tr_b16 v[118:119], v171 offset:10240
    v_mfma_f32_16x16x32_bf16 v[48:51], a[208:211], v[132:135], v[48:51]
    v_mfma_f32_16x16x32_bf16 v[52:55], a[212:215], v[132:135], v[52:55]
    buffer_load_dwordx4 v[76:79], v216, s[36:39], s4 offen offset:1024 sc1
    v_mfma_f32_16x16x32_bf16 v[8:11], a[216:219], v[104:107], v[8:11]
    ds_read_b64_tr_b16 v[120:121], v168 offset:12288
    v_mfma_f32_16x16x32_bf16 v[12:15], a[220:223], v[104:107], v[12:15]
    ds_read_b64_tr_b16 v[122:123], v168 offset:14336
    v_mfma_f32_16x16x32_bf16 v[16:19], a[224:227], v[104:107], v[16:19]
    ds_read_b64_tr_b16 v[124:125], v169 offset:12288
    v_mfma_f32_16x16x32_bf16 v[20:23], a[216:219], v[108:111], v[20:23]
    buffer_load_dwordx4 v[80:83], v216, s[36:39], s4 offen offset:2048 sc1
    v_mfma_f32_16x16x32_bf16 v[24:27], a[220:223], v[108:111], v[24:27]
    ds_read_b64_tr_b16 v[126:127], v169 offset:14336
    v_mfma_f32_16x16x32_bf16 v[28:31], a[224:227], v[108:111], v[28:31]
    s_waitcnt lgkmcnt(6)
    ds_read_b64_tr_b16 v[128:129], v170 offset:12288
    v_mfma_f32_16x16x32_bf16 v[32:35], a[216:219], v[112:115], v[32:35]
    ds_read_b64_tr_b16 v[130:131], v170 offset:14336
    v_mfma_f32_16x16x32_bf16 v[36:39], a[220:223], v[112:115], v[36:39]
    buffer_load_dwordx4 v[84:87], v216, s[36:39], s4 offen offset:3072 sc1
    v_mfma_f32_16x16x32_bf16 v[40:43], a[224:227], v[112:115], v[40:43]
    s_waitcnt lgkmcnt(6)
    ds_read_b64_tr_b16 v[132:133], v171 offset:12288
    v_mfma_f32_16x16x32_bf16 v[44:47], a[216:219], v[116:119], v[44:47]
    s_waitcnt lgkmcnt(3)
    ds_read_b64_tr_b16 v[134:135], v171 offset:14336
    v_mfma_f32_16x16x32_bf16 v[48:51], a[220:223], v[116:119], v[48:51]
    v_mfma_f32_16x16x32_bf16 v[52:55], a[224:227], v[116:119], v[52:55]
    buffer_load_dwordx4 v[88:91], v216, s[36:39], s5 offen offset:0 sc1
    v_mfma_f32_16x16x32_bf16 v[8:11], a[228:231], v[120:123], v[8:11]
    s_waitcnt vmcnt(12)
    v_xor_b32 v3, s48, v201
    v_bitop3_b32 v3, v203, s48, v3 bitop3:0xbe
    v_mfma_f32_16x16x32_bf16 v[12:15], a[232:235], v[120:123], v[12:15]
    s_waitcnt vmcnt(11)
    v_bitop3_b32 v3, v205, s48, v3 bitop3:0xbe
    v_bitop3_b32 v3, v207, s48, v3 bitop3:0xbe
    v_mfma_f32_16x16x32_bf16 v[16:19], a[236:239], v[120:123], v[16:19]
    s_waitcnt vmcnt(10)
    v_bitop3_b32 v3, v209, s48, v3 bitop3:0xbe
    v_bitop3_b32 v3, v211, s48, v3 bitop3:0xbe
    v_mfma_f32_16x16x32_bf16 v[20:23], a[228:231], v[124:127], v[20:23]
    buffer_load_dwordx4 v[92:95], v216, s[36:39], s5 offen offset:1024 sc1
    v_mfma_f32_16x16x32_bf16 v[24:27], a[232:235], v[124:127], v[24:27]
    s_waitcnt vmcnt(10)
    v_bitop3_b32 v3, v213, s48, v3 bitop3:0xbe
    v_bitop3_b32 v3, v215, s48, v3 bitop3:0xbe
    v_mfma_f32_16x16x32_bf16 v[28:31], a[236:239], v[124:127], v[28:31]
    v_cmp_ne_u32 vcc, 0, v3
    s_cbranch_vccnz L_stc1_slow
L_stc1_back:
    s_waitcnt lgkmcnt(2)
    v_mfma_f32_16x16x32_bf16 v[32:35], a[228:231], v[128:131], v[32:35]
    v_mfma_f32_16x16x32_bf16 v[36:39], a[232:235], v[128:131], v[36:39]
    buffer_load_dwordx4 v[96:99], v216, s[36:39], s5 offen offset:2048 sc1
    v_mfma_f32_16x16x32_bf16 v[40:43], a[236:239], v[128:131], v[40:43]
    s_waitcnt lgkmcnt(0)
    v_mfma_f32_16x16x32_bf16 v[44:47], a[228:231], v[132:135], v[44:47]
    v_mfma_f32_16x16x32_bf16 v[48:51], a[232:235], v[132:135], v[48:51]
    v_mfma_f32_16x16x32_bf16 v[52:55], a[236:239], v[132:135], v[52:55]
    buffer_load_dwordx4 v[100:103], v216, s[36:39], s5 offen offset:3072 sc1
    s_add_u32 s62, s62, 4096
    buffer_load_dwordx4 a[128:131], v248, s[36:39], s62 offen offset:0 sc1
    buffer_load_dwordx4 a[132:135], v248, s[36:39], s62 offen offset:1024 sc1
    buffer_load_dwordx4 a[136:139], v248, s[36:39], s62 offen offset:2048 sc1
    buffer_load_dwordx4 a[140:143], v248, s[36:39], s62 offen offset:3072 sc1
    s_add_u32 s62, s62, 4096
    buffer_load_dwordx4 a[144:147], v248, s[36:39], s62 offen offset:0 sc1
    buffer_load_dwordx4 a[148:151], v248, s[36:39], s62 offen offset:1024 sc1
    buffer_load_dwordx4 a[152:155], v248, s[36:39], s62 offen offset:2048 sc1
    buffer_load_dwordx4 a[156:159], v248, s[36:39], s62 offen offset:3072 sc1
    s_add_u32 s62, s62, 4096
    buffer_load_dwordx4 a[160:163], v248, s[36:39], s62 offen offset:0 sc1
    buffer_load_dwordx4 a[164:167], v248, s[36:39], s62 offen offset:1024 sc1
    buffer_load_dwordx4 a[168:171], v248, s[36:39], s62 offen offset:2048 sc1
    buffer_load_dwordx4 a[172:175], v248, s[36:39], s62 offen offset:3072 sc1
    s_add_u32 s62, s62, 4096
    buffer_load_dwordx4 a[176:179], v248, s[36:39], s62 offen offset:0 sc1
    buffer_load_dwordx4 a[180:183], v248, s[36:39], s62 offen offset:1024 sc1
    buffer_load_dwordx4 a[184:187], v248, s[36:39], s62 offen offset:2048 sc1
    buffer_load_dwordx4 a[188:191], v248, s[36:39], s62 offen offset:3072 sc1
    s_add_u32 s8, s8, 3145728
    s_add_u32 s50, s8, 98304
    v_pk_fma_f32 v[238:239], v[176:177], v[202:203], v[188:189] op_sel_hi:[1,0,1]
    v_pk_fma_f32 v[240:241], v[178:179], v[202:203], v[190:191] op_sel_hi:[1,0,1]
    v_pk_fma_f32 v[8:9], v[8:9], v[200:201], v[238:239] op_sel_hi:[1,0,1]
    v_pk_fma_f32 v[10:11], v[10:11], v[200:201], v[240:241] op_sel_hi:[1,0,1]
    v_pk_fma_f32 v[242:243], v[180:181], v[202:203], v[192:193] op_sel_hi:[1,0,1]
    v_pk_fma_f32 v[244:245], v[182:183], v[202:203], v[194:195] op_sel_hi:[1,0,1]
    v_pk_fma_f32 v[12:13], v[12:13], v[200:201], v[242:243] op_sel_hi:[1,0,1]
    v_pk_fma_f32 v[14:15], v[14:15], v[200:201], v[244:245] op_sel_hi:[1,0,1]
    v_pk_mul_f32 v[8:9], v[8:9], v[12:13]
    v_pk_mul_f32 v[10:11], v[10:11], v[14:15]
    v_cvt_pk_bf16_f32 v12, v8, v9
    v_cvt_pk_bf16_f32 v13, v10, v11
    v_pk_fma_f32 v[242:243], v[176:177], v[206:207], v[188:189] op_sel_hi:[1,0,1]
    v_pk_fma_f32 v[244:245], v[178:179], v[206:207], v[190:191] op_sel_hi:[1,0,1]
    v_pk_fma_f32 v[20:21], v[20:21], v[204:205], v[242:243] op_sel_hi:[1,0,1]
    v_pk_fma_f32 v[22:23], v[22:23], v[204:205], v[244:245] op_sel_hi:[1,0,1]
    v_pk_fma_f32 v[238:239], v[180:181], v[206:207], v[192:193] op_sel_hi:[1,0,1]
    v_pk_fma_f32 v[240:241], v[182:183], v[206:207], v[194:195] op_sel_hi:[1,0,1]
    v_pk_fma_f32 v[24:25], v[24:25], v[204:205], v[238:239] op_sel_hi:[1,0,1]
    v_pk_fma_f32 v[26:27], v[26:27], v[204:205], v[240:241] op_sel_hi:[1,0,1]
    v_pk_mul_f32 v[20:21], v[20:21], v[24:25]
    v_pk_mul_f32 v[22:23], v[22:23], v[26:27]
    v_cvt_pk_bf16_f32 v14, v20, v21
    v_cvt_pk_bf16_f32 v15, v22, v23
    s_nop 0
    v_permlane16_swap_b32 v12, v14
    v_permlane16_swap_b32 v13, v15
    buffer_store_dwordx4 v[12:15], v173, s[36:39], s8 offen sc1
    v_pk_fma_f32 v[238:239], v[176:177], v[210:211], v[188:189] op_sel_hi:[1,0,1]
    v_pk_fma_f32 v[240:241], v[178:179], v[210:211], v[190:191] op_sel_hi:[1,0,1]
    v_pk_fma_f32 v[32:33], v[32:33], v[208:209], v[238:239] op_sel_hi:[1,0,1]
    v_pk_fma_f32 v[34:35], v[34:35], v[208:209], v[240:241] op_sel_hi:[1,0,1]
    v_pk_fma_f32 v[242:243], v[180:181], v[210:211], v[192:193] op_sel_hi:[1,0,1]
    v_pk_fma_f32 v[244:245], v[182:183], v[210:211], v[194:195] op_sel_hi:[1,0,1]
    v_pk_fma_f32 v[36:37], v[36:37], v[208:209], v[242:243] op_sel_hi:[1,0,1]
    v_pk_fma_f32 v[38:39], v[38:39], v[208:209], v[244:245] op_sel_hi:[1,0,1]
    v_pk_mul_f32 v[32:33], v[32:33], v[36:37]
    v_pk_mul_f32 v[34:35], v[34:35], v[38:39]
    v_cvt_pk_bf16_f32 v36, v32, v33
    v_cvt_pk_bf16_f32 v37, v34, v35
    v_pk_fma_f32 v[242:243], v[176:177], v[214:215], v[188:189] op_sel_hi:[1,0,1]
    v_pk_fma_f32 v[244:245], v[178:179], v[214:215], v[190:191] op_sel_hi:[1,0,1]
    v_pk_fma_f32 v[44:45], v[44:45], v[212:213], v[242:243] op_sel_hi:[1,0,1]
    v_pk_fma_f32 v[46:47], v[46:47], v[212:213], v[244:245] op_sel_hi:[1,0,1]
    v_pk_fma_f32 v[238:239], v[180:181], v[214:215], v[192:193] op_sel_hi:[1,0,1]
    v_pk_fma_f32 v[240:241], v[182:183], v[214:215], v[194:195] op_sel_hi:[1,0,1]
    v_pk_fma_f32 v[48:49], v[48:49], v[212:213], v[238:239] op_sel_hi:[1,0,1]
    v_pk_fma_f32 v[50:51], v[50:51], v[212:213], v[240:241] op_sel_hi:[1,0,1]
    v_pk_mul_f32 v[44:45], v[44:45], v[48:49]
    v_pk_mul_f32 v[46:47], v[46:47], v[50:51]
    v_cvt_pk_bf16_f32 v38, v44, v45
    v_cvt_pk_bf16_f32 v39, v46, v47
    s_nop 0
    v_permlane16_swap_b32 v36, v38
    v_permlane16_swap_b32 v37, v39
    buffer_store_dwordx4 v[36:39], v173, s[36:39], s50 offen sc1
    v_pk_fma_f32 v[238:239], v[184:185], v[202:203], v[196:197] op_sel_hi:[1,0,1]
    v_pk_fma_f32 v[240:241], v[186:187], v[202:203], v[198:199] op_sel_hi:[1,0,1]
    v_pk_fma_f32 v[16:17], v[16:17], v[200:201], v[238:239] op_sel_hi:[1,0,1]
    v_pk_fma_f32 v[18:19], v[18:19], v[200:201], v[240:241] op_sel_hi:[1,0,1]
    v_pk_fma_f32 v[242:243], v[184:185], v[206:207], v[196:197] op_sel_hi:[1,0,1]
    v_pk_fma_f32 v[244:245], v[186:187], v[206:207], v[198:199] op_sel_hi:[1,0,1]
    v_pk_fma_f32 v[28:29], v[28:29], v[204:205], v[242:243] op_sel_hi:[1,0,1]
    v_pk_fma_f32 v[30:31], v[30:31], v[204:205], v[244:245] op_sel_hi:[1,0,1]
    s_nop 0
    v_permlane32_swap_b32 v16, v28
    v_permlane32_swap_b32 v17, v29
    v_permlane32_swap_b32 v18, v30
    v_permlane32_swap_b32 v19, v31
    v_pk_mul_f32 v[16:17], v[16:17], v[28:29]
    v_pk_mul_f32 v[18:19], v[18:19], v[30:31]
    v_cvt_pk_bf16_f32 v8, v16, v17
    v_cvt_pk_bf16_f32 v9, v18, v19
    v_pk_fma_f32 v[238:239], v[184:185], v[210:211], v[196:197] op_sel_hi:[1,0,1]
    v_pk_fma_f32 v[240:241], v[186:187], v[210:211], v[198:199] op_sel_hi:[1,0,1]
    v_pk_fma_f32 v[40:41], v[40:41], v[208:209], v[238:239] op_sel_hi:[1,0,1]
    v_pk_fma_f32 v[42:43], v[42:43], v[208:209], v[240:241] op_sel_hi:[1,0,1]
    v_pk_fma_f32 v[242:243], v[184:185], v[214:215], v[196:197] op_sel_hi:[1,0,1]
    v_pk_fma_f32 v[244:245], v[186:187], v[214:215], v[198:199] op_sel_hi:[1,0,1]
    v_pk_fma_f32 v[52:53], v[52:53], v[212:213], v[242:243] op_sel_hi:[1,0,1]
    v_pk_fma_f32 v[54:55], v[54:55], v[212:213], v[244:245] op_sel_hi:[1,0,1]
    s_nop 0
    v_permlane32_swap_b32 v40, v52
    v_permlane32_swap_b32 v41, v53
    v_permlane32_swap_b32 v42, v54
    v_permlane32_swap_b32 v43, v55
    v_pk_mul_f32 v[40:41], v[40:41], v[52:53]
    v_pk_mul_f32 v[42:43], v[42:43], v[54:55]
    v_cvt_pk_bf16_f32 v10, v40, v41
    v_cvt_pk_bf16_f32 v11, v42, v43
    s_nop 0
    v_permlane16_swap_b32 v8, v10
    v_permlane16_swap_b32 v9, v11
    buffer_store_dwordx4 v[8:11], v174, s[36:39], s8 offen offset:512 sc1
    s_mov_b32 s40, s28
    s_mov_b32 s41, s29
    s_mov_b32 s42, 0x280000
    s_mov_b32 s43, 0x20000
    s_waitcnt vmcnt(30)
    v_mfma_f32_16x16x32_bf16 v[8:11], a[240:243], v[56:59], 0
    s_and_b32 s50, s3, 1
    s_lshr_b32 s51, s3, 1
    v_mfma_f32_16x16x32_bf16 v[12:15], a[244:247], v[56:59], 0
    s_mul_i32 s52, s50, 20480
    s_mul_i32 s53, s3, 5120
    s_add_u32 s52, s52, s53
    v_mfma_f32_16x16x32_bf16 v[16:19], a[248:251], v[56:59], 0
    v_add_u32 v220, s52, v248
    v_add_u32 v222, 40960, v220
    v_mfma_f32_16x16x32_bf16 v[20:23], a[252:255], v[56:59], 0
    s_xor_b32 s52, s50, 1
    s_mul_i32 s52, s52, 20480
    s_add_u32 s52, s52, s53
    v_mfma_f32_16x16x32_bf16 v[24:27], v[136:139], v[56:59], 0
    s_waitcnt vmcnt(29)
    v_add_u32 v221, s52, v248
    v_add_u32 v223, 40960, v221
    v_mfma_f32_16x16x32_bf16 v[8:11], v[140:143], v[60:63], v[8:11]
    buffer_load_dwordx4 v[56:59], v217, s[36:39], 0 offen offset:0 sc1
    v_mfma_f32_16x16x32_bf16 v[12:15], v[144:147], v[60:63], v[12:15]
    s_mul_i32 s52, s51, 20480
    s_lshl_b32 s53, s50, 11
    s_add_u32 s52, s52, s53
    v_mfma_f32_16x16x32_bf16 v[16:19], v[148:151], v[60:63], v[16:19]
    v_add_u32 v224, s52, v248
    v_mfma_f32_16x16x32_bf16 v[20:23], v[152:155], v[60:63], v[20:23]
    s_mul_i32 s53, s51, 5120
    s_add_u32 s53, s53, 40960
    v_add_u32 v225, s53, v224
    v_mfma_f32_16x16x32_bf16 v[24:27], v[156:159], v[60:63], v[24:27]
    s_waitcnt vmcnt(29)
    s_xor_b32 s53, s51, 1
    s_mul_i32 s53, s53, 5120
    s_add_u32 s53, s53, 40960
    v_mfma_f32_16x16x32_bf16 v[8:11], v[160:163], v[64:67], v[8:11]
    buffer_load_dwordx4 v[60:63], v217, s[36:39], 0 offen offset:1024 sc1
    v_mfma_f32_16x16x32_bf16 v[12:15], v[164:167], v[64:67], v[12:15]
    v_add_u32 v226, s53, v224
    v_mfma_f32_16x16x32_bf16 v[16:19], a[0:3], v[64:67], v[16:19]
    s_lshl_b32 s52, s74, 1
    s_add_u32 s52, s52, s51
    v_mfma_f32_16x16x32_bf16 v[20:23], a[4:7], v[64:67], v[20:23]
    s_mul_i32 s12, s75, 320
    s_add_u32 s15, s12, 23183360
    v_mfma_f32_16x16x32_bf16 v[24:27], a[8:11], v[64:67], v[24:27]
    s_waitcnt vmcnt(29)
    s_add_u32 s12, s12, 23147008
    s_mul_i32 s13, s52, 20480
    v_mfma_f32_16x16x32_bf16 v[8:11], a[12:15], v[68:71], v[8:11]
    buffer_load_dwordx4 v[64:67], v217, s[36:39], 0 offen offset:2048 sc1
    v_mfma_f32_16x16x32_bf16 v[12:15], a[16:19], v[68:71], v[12:15]
    s_mul_i32 s53, s75, 160
    s_add_u32 s13, s13, s53
    v_mfma_f32_16x16x32_bf16 v[16:19], a[20:23], v[68:71], v[16:19]
    s_lshl_b32 s53, s50, 6
    s_add_u32 s13, s13, s53
    s_add_u32 s14, s13, 1310720
    v_mfma_f32_16x16x32_bf16 v[20:23], a[24:27], v[68:71], v[20:23]
    s_mul_i32 s10, s75, 10
    s_add_u32 s10, s10, s3
    v_mfma_f32_16x16x32_bf16 v[24:27], a[28:31], v[68:71], v[24:27]
    s_mul_i32 s10, s10, 32768
    s_lshl_b32 s53, s74, 6
    s_add_u32 s10, s10, s53
    s_add_u32 s10, s10, 0
    s_waitcnt vmcnt(29)
    v_mfma_f32_16x16x32_bf16 v[8:11], a[32:35], v[72:75], v[8:11]
    buffer_load_dwordx4 v[68:71], v217, s[36:39], 0 offen offset:3072 sc1
    v_mfma_f32_16x16x32_bf16 v[12:15], a[36:39], v[72:75], v[12:15]
    s_lshl_b32 s11, s3, 10
    s_add_u32 s11, s11, 81920
    v_lshrrev_b32 v2, 3, v1
    v_mfma_f32_16x16x32_bf16 v[16:19], a[40:43], v[72:75], v[16:19]
    v_mul_u32_u24 v229, 4096, v2
    v_bfe_u32 v2, v1, 2, 1
    v_mfma_f32_16x16x32_bf16 v[20:23], a[44:47], v[72:75], v[20:23]
    v_lshl_add_u32 v229, v2, 11, v229
    v_and_b32 v2, 3, v1
    v_mfma_f32_16x16x32_bf16 v[24:27], a[48:51], v[72:75], v[24:27]
    s_waitcnt vmcnt(29)
    v_lshl_add_u32 v229, v2, 4, v229
    v_lshrrev_b32 v3, 2, v1
    v_mfma_f32_16x16x32_bf16 v[8:11], a[52:55], v[76:79], v[8:11]
    buffer_load_dwordx4 v[72:75], v217, s[36:39], s4 offen offset:0 sc1
    v_mfma_f32_16x16x32_bf16 v[12:15], a[56:59], v[76:79], v[12:15]
    v_lshlrev_b32 v231, 7, v3
    v_lshl_add_u32 v231, v2, 3, v231
    v_mfma_f32_16x16x32_bf16 v[16:19], a[60:63], v[76:79], v[16:19]
    s_lshl_b32 s53, s50, 12
    s_lshl_b32 s52, s51, 5
    v_mfma_f32_16x16x32_bf16 v[20:23], a[64:67], v[76:79], v[20:23]
    s_add_u32 s53, s53, s52
    s_add_u32 s53, s53, 81920
    v_add_u32 v231, s53, v231
    v_mfma_f32_16x16x32_bf16 v[24:27], a[68:71], v[76:79], v[24:27]
    s_waitcnt vmcnt(29)
    v_and_b32 v2, 15, v1
    v_lshrrev_b32 v3, 4, v1
    v_mfma_f32_16x16x32_bf16 v[8:11], a[72:75], v[80:83], v[8:11]
    buffer_load_dwordx4 v[76:79], v217, s[36:39], s4 offen offset:1024 sc1
    v_mfma_f32_16x16x32_bf16 v[12:15], a[76:79], v[80:83], v[12:15]
    v_lshlrev_b32 v230, 4, v3
    v_mfma_f32_16x16x32_bf16 v[16:19], a[80:83], v[80:83], v[16:19]
    s_lshl_b32 s53, s50, 7
    v_add_u32 v230, s53, v230
    v_mul_u32_u24 v2, 1280, v2
    v_mfma_f32_16x16x32_bf16 v[20:23], a[84:87], v[80:83], v[20:23]
    v_lshl_add_u32 v228, v3, 3, v2
    v_and_b32 v227, 1, v3
    v_mfma_f32_16x16x32_bf16 v[24:27], a[88:91], v[80:83], v[24:27]
    s_waitcnt vmcnt(29)
    v_lshl_add_u32 v2, v227, 5, v2
    v_lshrrev_b32 v3, 1, v3
    v_mfma_f32_16x16x32_bf16 v[8:11], a[92:95], v[84:87], v[8:11]
    buffer_load_dwordx4 v[80:83], v217, s[36:39], s4 offen offset:2048 sc1
    v_mfma_f32_16x16x32_bf16 v[12:15], a[96:99], v[84:87], v[12:15]
    v_lshl_add_u32 v227, v3, 4, v2
    v_mfma_f32_16x16x32_bf16 v[16:19], a[100:103], v[84:87], v[16:19]
    s_lshr_b32 s50, s74, 1
    s_lshl_b32 s50, s50, 2
    v_mfma_f32_16x16x32_bf16 v[20:23], a[104:107], v[84:87], v[20:23]
    s_add_u32 s50, s50, s3
    s_lshl_b32 s50, s50, 9
    s_add_u32 s50, s50, 121856
    v_mfma_f32_16x16x32_bf16 v[24:27], a[108:111], v[84:87], v[24:27]
    s_waitcnt vmcnt(29)
    v_min_u32 v246, 3, v1
    v_lshlrev_b32 v246, 7, v246
    v_mfma_f32_16x16x32_bf16 v[8:11], a[112:115], v[88:91], v[8:11]
    s_waitcnt vmcnt(7)
    s_barrier
    s_cmp_eq_u32 s3, 0
    s_cbranch_scc0 L_wf13
    s_lshl_b32 s54, s76, 7
    s_add_u32 s54, s54, 23321600
    v_mov_b32 v254, 0
    v_mov_b32 v255, s48
    s_mov_b64 exec, 1
    buffer_store_dword v255, v254, s[36:39], s54 offen sc1
    s_mov_b64 exec, -1
L_wf13:
    buffer_load_dwordx4 v[84:87], v217, s[36:39], s4 offen offset:3072 sc1
    v_mfma_f32_16x16x32_bf16 v[12:15], a[116:119], v[88:91], v[12:15]
    v_add_u32 v246, s50, v246
    v_mfma_f32_16x16x32_bf16 v[16:19], a[120:123], v[88:91], v[16:19]
    buffer_load_dwordx4 v[48:51], v230, s[36:39], s12 offen offset:0 sc1
    v_mfma_f32_16x16x32_bf16 v[20:23], a[124:127], v[88:91], v[20:23]
    buffer_load_dwordx4 v[52:55], v230, s[36:39], s12 offen offset:64 sc1
    v_mfma_f32_16x16x32_bf16 v[24:27], a[128:131], v[88:91], v[24:27]
    buffer_load_dwordx4 v[132:135], v230, s[36:39], s12 offen offset:128 sc1
    v_mfma_f32_16x16x32_bf16 v[8:11], a[132:135], v[92:95], v[8:11]
    buffer_load_dwordx4 v[88:91], v217, s[36:39], s5 offen offset:0 sc1
    v_mfma_f32_16x16x32_bf16 v[12:15], a[136:139], v[92:95], v[12:15]
    buffer_load_dwordx4 v[168:171], v230, s[36:39], s15 offen offset:0 sc1
    v_mfma_f32_16x16x32_bf16 v[16:19], a[140:143], v[92:95], v[16:19]
    s_add_u32 m0, s11, 0
    buffer_load_dwordx4 v[172:175], v230, s[36:39], s15 offen offset:64 sc1
    v_mfma_f32_16x16x32_bf16 v[20:23], a[144:147], v[92:95], v[20:23]
    buffer_load_dwordx4 v229, s[36:39], s10 offen sc1 lds
    v_mfma_f32_16x16x32_bf16 v[24:27], a[148:151], v[92:95], v[24:27]
    s_add_u32 s10, s10, 131072
    buffer_load_dwordx4 v[176:179], v230, s[36:39], s15 offen offset:128 sc1
    v_mfma_f32_16x16x32_bf16 v[8:11], a[152:155], v[96:99], v[8:11]
    s_add_u32 m0, s11, 4096
    v_mfma_f32_16x16x32_bf16 v[12:15], a[156:159], v[96:99], v[12:15]
    buffer_load_dwordx4 v229, s[36:39], s10 offen sc1 lds
    v_mfma_f32_16x16x32_bf16 v[16:19], a[160:163], v[96:99], v[16:19]
    s_add_u32 s10, s10, 131072
    v_mfma_f32_16x16x32_bf16 v[20:23], a[164:167], v[96:99], v[20:23]
    s_add_u32 m0, s11, 8192
    v_mfma_f32_16x16x32_bf16 v[24:27], a[168:171], v[96:99], v[24:27]
    buffer_load_dwordx4 v229, s[36:39], s10 offen sc1 lds
    v_mfma_f32_16x16x32_bf16 v[8:11], a[172:175], v[100:103], v[8:11]
    v_mfma_f32_16x16x32_bf16 v[12:15], a[176:179], v[100:103], v[12:15]
    v_mfma_f32_16x16x32_bf16 v[16:19], a[180:183], v[100:103], v[16:19]
    buffer_load_dwordx4 v[92:95], v217, s[36:39], s5 offen offset:1024 sc1
    v_mfma_f32_16x16x32_bf16 v[20:23], a[184:187], v[100:103], v[20:23]
    v_mfma_f32_16x16x32_bf16 v[24:27], a[188:191], v[100:103], v[24:27]
    s_waitcnt vmcnt(18)
    v_mfma_f32_16x16x32_bf16 v[28:31], a[240:243], v[56:59], 0
    buffer_load_dwordx4 v[96:99], v217, s[36:39], s5 offen offset:2048 sc1
    v_mfma_f32_16x16x32_bf16 v[32:35], a[244:247], v[56:59], 0
    v_mfma_f32_16x16x32_bf16 v[36:39], a[248:251], v[56:59], 0
    v_mfma_f32_16x16x32_bf16 v[40:43], a[252:255], v[56:59], 0
    buffer_load_dwordx4 v[100:103], v217, s[36:39], s5 offen offset:3072 sc1
    v_mfma_f32_16x16x32_bf16 v[44:47], v[136:139], v[56:59], 0
    s_waitcnt vmcnt(19)
    ds_write_b128 v220, v[8:11] offset:0
    v_mfma_f32_16x16x32_bf16 v[28:31], v[140:143], v[60:63], v[28:31]
    v_mfma_f32_16x16x32_bf16 v[32:35], v[144:147], v[60:63], v[32:35]
    ds_write_b128 v220, v[12:15] offset:1024
    v_mfma_f32_16x16x32_bf16 v[36:39], v[148:151], v[60:63], v[36:39]
    v_mfma_f32_16x16x32_bf16 v[40:43], v[152:155], v[60:63], v[40:43]
    ds_write_b128 v220, v[16:19] offset:2048
    v_mfma_f32_16x16x32_bf16 v[44:47], v[156:159], v[60:63], v[44:47]
    s_waitcnt vmcnt(18)
    v_mfma_f32_16x16x32_bf16 v[28:31], v[160:163], v[64:67], v[28:31]
    ds_write_b128 v220, v[20:23] offset:3072
    v_mfma_f32_16x16x32_bf16 v[32:35], v[164:167], v[64:67], v[32:35]
    v_mfma_f32_16x16x32_bf16 v[36:39], a[0:3], v[64:67], v[36:39]
    ds_write_b128 v220, v[24:27] offset:4096
    v_mfma_f32_16x16x32_bf16 v[40:43], a[4:7], v[64:67], v[40:43]
    v_mfma_f32_16x16x32_bf16 v[44:47], a[8:11], v[64:67], v[44:47]
    s_waitcnt vmcnt(17)
    v_mfma_f32_16x16x32_bf16 v[28:31], a[12:15], v[68:71], v[28:31]
    v_mfma_f32_16x16x32_bf16 v[32:35], a[16:19], v[68:71], v[32:35]
    v_mfma_f32_16x16x32_bf16 v[36:39], a[20:23], v[68:71], v[36:39]
    v_mfma_f32_16x16x32_bf16 v[40:43], a[24:27], v[68:71], v[40:43]
    v_mfma_f32_16x16x32_bf16 v[44:47], a[28:31], v[68:71], v[44:47]
    s_waitcnt vmcnt(16)
    v_mfma_f32_16x16x32_bf16 v[28:31], a[32:35], v[72:75], v[28:31]
    buffer_load_dword v247, v246, s[36:39], s17 offen sc1
    v_mfma_f32_16x16x32_bf16 v[32:35], a[36:39], v[72:75], v[32:35]
    v_mfma_f32_16x16x32_bf16 v[36:39], a[40:43], v[72:75], v[36:39]
    v_mfma_f32_16x16x32_bf16 v[40:43], a[44:47], v[72:75], v[40:43]
    v_mfma_f32_16x16x32_bf16 v[44:47], a[48:51], v[72:75], v[44:47]
    s_waitcnt vmcnt(16)
    v_mfma_f32_16x16x32_bf16 v[28:31], a[52:55], v[76:79], v[28:31]
    v_mfma_f32_16x16x32_bf16 v[32:35], a[56:59], v[76:79], v[32:35]
    v_mfma_f32_16x16x32_bf16 v[36:39], a[60:63], v[76:79], v[36:39]
    v_mfma_f32_16x16x32_bf16 v[40:43], a[64:67], v[76:79], v[40:43]
    v_mfma_f32_16x16x32_bf16 v[44:47], a[68:71], v[76:79], v[44:47]
    s_waitcnt vmcnt(15)
    v_mfma_f32_16x16x32_bf16 v[28:31], a[72:75], v[80:83], v[28:31]
    v_mfma_f32_16x16x32_bf16 v[32:35], a[76:79], v[80:83], v[32:35]
    v_mfma_f32_16x16x32_bf16 v[36:39], a[80:83], v[80:83], v[36:39]
    v_mfma_f32_16x16x32_bf16 v[40:43], a[84:87], v[80:83], v[40:43]
    v_mfma_f32_16x16x32_bf16 v[44:47], a[88:91], v[80:83], v[44:47]
    s_waitcnt vmcnt(4)
    s_barrier
    ds_read_b64_tr_b16 v[180:181], v231 offset:0
    v_mfma_f32_16x16x32_bf16 v[28:31], a[92:95], v[84:87], v[28:31]
    ds_read_b64_tr_b16 v[182:183], v231 offset:2048
    v_mfma_f32_16x16x32_bf16 v[32:35], a[96:99], v[84:87], v[32:35]
    ds_read_b64_tr_b16 v[184:185], v231 offset:4096
    v_mfma_f32_16x16x32_bf16 v[36:39], a[100:103], v[84:87], v[36:39]
    ds_read_b64_tr_b16 v[186:187], v231 offset:64
    v_mfma_f32_16x16x32_bf16 v[40:43], a[104:107], v[84:87], v[40:43]
    ds_read_b64_tr_b16 v[188:189], v231 offset:2112
    v_mfma_f32_16x16x32_bf16 v[44:47], a[108:111], v[84:87], v[44:47]
    ds_read_b64_tr_b16 v[190:191], v231 offset:4160
    v_mfma_f32_16x16x32_bf16 v[28:31], a[112:115], v[88:91], v[28:31]
    v_mfma_f32_16x16x32_bf16 v[32:35], a[116:119], v[88:91], v[32:35]
    v_mfma_f32_16x16x32_bf16 v[36:39], a[120:123], v[88:91], v[36:39]
    v_mfma_f32_16x16x32_bf16 v[40:43], a[124:127], v[88:91], v[40:43]
    s_waitcnt lgkmcnt(5)
    v_lshlrev_b32 v120, 16, v180
    v_mul_f32 v120, v120, v168
    v_mfma_f32_16x16x32_bf16 v[44:47], a[128:131], v[88:91], v[44:47]
    s_waitcnt vmcnt(3)
    v_and_b32 v121, 0xffff0000, v180
    v_mul_f32 v121, v121, v169
    v_mfma_f32_16x16x32_bf16 v[28:31], a[132:135], v[92:95], v[28:31]
    v_lshlrev_b32 v122, 16, v181
    v_mul_f32 v122, v122, v170
    v_mfma_f32_16x16x32_bf16 v[32:35], a[136:139], v[92:95], v[32:35]
    v_and_b32 v123, 0xffff0000, v181
    v_mul_f32 v123, v123, v171
    v_mfma_f32_16x16x32_bf16 v[36:39], a[140:143], v[92:95], v[36:39]
    s_waitcnt lgkmcnt(4)
    v_lshlrev_b32 v124, 16, v182
    v_mul_f32 v124, v124, v172
    v_mfma_f32_16x16x32_bf16 v[40:43], a[144:147], v[92:95], v[40:43]
    v_and_b32 v125, 0xffff0000, v182
    v_mul_f32 v125, v125, v173
    v_mfma_f32_16x16x32_bf16 v[44:47], a[148:151], v[92:95], v[44:47]
    s_waitcnt vmcnt(2)
    v_lshlrev_b32 v126, 16, v183
    v_mul_f32 v126, v126, v174
    v_mfma_f32_16x16x32_bf16 v[28:31], a[152:155], v[96:99], v[28:31]
    s_waitcnt vmcnt(0)
    v_cmp_ne_u32 vcc, s48, v247
    s_cbranch_vccnz L_chk14_slow
L_chk14_back:
    v_and_b32 v127, 0xffff0000, v183
    v_mfma_f32_16x16x32_bf16 v[32:35], a[156:159], v[96:99], v[32:35]
    buffer_load_dwordx4 v[56:59], v218, s[36:39], 0 offen offset:0 sc1
    v_mfma_f32_16x16x32_bf16 v[36:39], a[160:163], v[96:99], v[36:39]
    v_mul_f32 v127, v127, v175
    s_waitcnt lgkmcnt(3)
    v_lshlrev_b32 v128, 16, v184
    v_mfma_f32_16x16x32_bf16 v[40:43], a[164:167], v[96:99], v[40:43]
    v_mul_f32 v128, v128, v176
    v_and_b32 v129, 0xffff0000, v184
    v_mfma_f32_16x16x32_bf16 v[44:47], a[168:171], v[96:99], v[44:47]
    buffer_load_dwordx4 v[60:63], v218, s[36:39], 0 offen offset:1024 sc1
    v_mfma_f32_16x16x32_bf16 v[28:31], a[172:175], v[100:103], v[28:31]
    v_mul_f32 v129, v129, v177
    v_lshlrev_b32 v130, 16, v185
    v_mfma_f32_16x16x32_bf16 v[32:35], a[176:179], v[100:103], v[32:35]
    v_mul_f32 v130, v130, v178
    v_and_b32 v131, 0xffff0000, v185
    v_mfma_f32_16x16x32_bf16 v[36:39], a[180:183], v[100:103], v[36:39]
    buffer_load_dwordx4 v[64:67], v218, s[36:39], 0 offen offset:2048 sc1
    v_mfma_f32_16x16x32_bf16 v[40:43], a[184:187], v[100:103], v[40:43]
    v_mul_f32 v131, v131, v179
    s_waitcnt lgkmcnt(2)
    v_lshlrev_b32 v232, 16, v186
    v_mfma_f32_16x16x32_bf16 v[44:47], a[188:191], v[100:103], v[44:47]
    s_waitcnt vmcnt(2)
    v_mul_f32 v232, v232, v168
    v_and_b32 v233, 0xffff0000, v186
    v_mfma_f32_16x16x32_bf16 v[8:11], a[240:243], v[56:59], 0
    buffer_load_dwordx4 v[68:71], v218, s[36:39], 0 offen offset:3072 sc1
    v_mfma_f32_16x16x32_bf16 v[12:15], a[244:247], v[56:59], 0
    v_mul_f32 v233, v233, v169
    v_lshlrev_b32 v234, 16, v187
    v_mfma_f32_16x16x32_bf16 v[16:19], a[248:251], v[56:59], 0
    v_mul_f32 v234, v234, v170
    v_and_b32 v235, 0xffff0000, v187
    v_mfma_f32_16x16x32_bf16 v[20:23], a[252:255], v[56:59], 0
    buffer_load_dwordx4 v[72:75], v218, s[36:39], s4 offen offset:0 sc1
    v_mfma_f32_16x16x32_bf16 v[24:27], v[136:139], v[56:59], 0
    ds_write_b128 v221, v[28:31] offset:0
    v_mul_f32 v235, v235, v171
    s_waitcnt lgkmcnt(2)
    v_lshlrev_b32 v236, 16, v188
    s_waitcnt vmcnt(3)
    v_mfma_f32_16x16x32_bf16 v[8:11], v[140:143], v[60:63], v[8:11]
    v_mul_f32 v236, v236, v172
    v_and_b32 v237, 0xffff0000, v188
    v_mfma_f32_16x16x32_bf16 v[12:15], v[144:147], v[60:63], v[12:15]
    buffer_load_dwordx4 v[76:79], v218, s[36:39], s4 offen offset:1024 sc1
    v_mfma_f32_16x16x32_bf16 v[16:19], v[148:151], v[60:63], v[16:19]
    ds_write_b128 v221, v[32:35] offset:1024
    v_mul_f32 v237, v237, v173
    v_lshlrev_b32 v238, 16, v189
    v_mfma_f32_16x16x32_bf16 v[20:23], v[152:155], v[60:63], v[20:23]
    v_mul_f32 v238, v238, v174
    v_and_b32 v239, 0xffff0000, v189
    v_mul_f32 v239, v239, v175
    v_mfma_f32_16x16x32_bf16 v[24:27], v[156:159], v[60:63], v[24:27]
    s_waitcnt vmcnt(3)
    buffer_load_dwordx4 v[80:83], v218, s[36:39], s4 offen offset:2048 sc1
    v_mfma_f32_16x16x32_bf16 v[8:11], v[160:163], v[64:67], v[8:11]
    ds_write_b128 v221, v[36:39] offset:2048
    s_waitcnt lgkmcnt(3)
    v_lshlrev_b32 v240, 16, v190
    v_mul_f32 v240, v240, v176
    v_mfma_f32_16x16x32_bf16 v[12:15], v[164:167], v[64:67], v[12:15]
    v_and_b32 v241, 0xffff0000, v190
    v_mul_f32 v241, v241, v177
    v_mfma_f32_16x16x32_bf16 v[16:19], a[0:3], v[64:67], v[16:19]
    ds_write_b128 v221, v[40:43] offset:3072
    buffer_load_dwordx4 v[84:87], v218, s[36:39], s4 offen offset:3072 sc1
    v_mfma_f32_16x16x32_bf16 v[20:23], a[4:7], v[64:67], v[20:23]
    v_lshlrev_b32 v242, 16, v191
    v_mul_f32 v242, v242, v178
    v_mfma_f32_16x16x32_bf16 v[24:27], a[8:11], v[64:67], v[24:27]
    s_waitcnt vmcnt(4)
    ds_write_b128 v221, v[44:47] offset:4096
    v_and_b32 v243, 0xffff0000, v191
    v_mul_f32 v243, v243, v179
    v_mfma_f32_16x16x32_bf16 v[8:11], a[12:15], v[68:71], v[8:11]
    buffer_load_dwordx4 v[88:91], v218, s[36:39], s5 offen offset:0 sc1
    v_mfma_f32_16x16x32_bf16 v[12:15], a[16:19], v[68:71], v[12:15]
    v_mfma_f32_16x16x32_bf16 v[16:19], a[20:23], v[68:71], v[16:19]
    v_mfma_f32_16x16x32_bf16 v[20:23], a[24:27], v[68:71], v[20:23]
    buffer_load_dwordx4 v[92:95], v218, s[36:39], s5 offen offset:1024 sc1
    v_mfma_f32_16x16x32_bf16 v[24:27], a[28:31], v[68:71], v[24:27]
    s_waitcnt vmcnt(5)
    v_mfma_f32_16x16x32_bf16 v[8:11], a[32:35], v[72:75], v[8:11]
    v_mfma_f32_16x16x32_bf16 v[12:15], a[36:39], v[72:75], v[12:15]
    buffer_load_dwordx4 v[96:99], v218, s[36:39], s5 offen offset:2048 sc1
    v_mfma_f32_16x16x32_bf16 v[16:19], a[40:43], v[72:75], v[16:19]
    s_waitcnt lgkmcnt(0)
    s_barrier
    ds_read_b128 v[168:171], v224 offset:0
    v_mfma_f32_16x16x32_bf16 v[20:23], a[44:47], v[72:75], v[20:23]
    ds_read_b128 v[172:175], v224 offset:1024
    v_mfma_f32_16x16x32_bf16 v[24:27], a[48:51], v[72:75], v[24:27]
    s_waitcnt vmcnt(5)
    buffer_load_dwordx4 v[100:103], v218, s[36:39], s5 offen offset:3072 sc1
    v_mfma_f32_16x16x32_bf16 v[8:11], a[52:55], v[76:79], v[8:11]
    ds_read_b128 v[176:179], v224 offset:2048
    v_mfma_f32_16x16x32_bf16 v[12:15], a[56:59], v[76:79], v[12:15]
    ds_read_b128 v[180:183], v224 offset:5120
    ds_read_b128 v[184:187], v224 offset:6144
    v_mfma_f32_16x16x32_bf16 v[16:19], a[60:63], v[76:79], v[16:19]
    buffer_load_dwordx4 v[56:59], v219, s[36:39], 0 offen offset:0 sc1
    v_mfma_f32_16x16x32_bf16 v[20:23], a[64:67], v[76:79], v[20:23]
    ds_read_b128 v[188:191], v224 offset:7168
    v_mfma_f32_16x16x32_bf16 v[24:27], a[68:71], v[76:79], v[24:27]
    s_waitcnt vmcnt(6)
    ds_read_b128 v[192:195], v224 offset:10240
    v_mfma_f32_16x16x32_bf16 v[8:11], a[72:75], v[80:83], v[8:11]
    buffer_load_dwordx4 v[60:63], v219, s[36:39], 0 offen offset:1024 sc1
    v_mfma_f32_16x16x32_bf16 v[12:15], a[76:79], v[80:83], v[12:15]
    ds_read_b128 v[196:199], v224 offset:11264
    v_mfma_f32_16x16x32_bf16 v[16:19], a[80:83], v[80:83], v[16:19]
    ds_read_b128 v[200:203], v224 offset:12288
    ds_read_b128 v[204:207], v224 offset:15360
    v_mfma_f32_16x16x32_bf16 v[20:23], a[84:87], v[80:83], v[20:23]
    buffer_load_dwordx4 v[64:67], v219, s[36:39], 0 offen offset:2048 sc1
    v_mfma_f32_16x16x32_bf16 v[24:27], a[88:91], v[80:83], v[24:27]
    s_waitcnt vmcnt(7)
    ds_read_b128 v[208:211], v224 offset:16384
    v_mfma_f32_16x16x32_bf16 v[8:11], a[92:95], v[84:87], v[8:11]
    ds_read_b128 v[212:215], v224 offset:17408
    v_mfma_f32_16x16x32_bf16 v[12:15], a[96:99], v[84:87], v[12:15]
    buffer_load_dwordx4 v[68:71], v219, s[36:39], 0 offen offset:3072 sc1
    v_mfma_f32_16x16x32_bf16 v[16:19], a[100:103], v[84:87], v[16:19]
    s_waitcnt lgkmcnt(8)
    v_add_f32 v168, v168, v180
    v_add_f32 v169, v169, v181
    v_mfma_f32_16x16x32_bf16 v[20:23], a[104:107], v[84:87], v[20:23]
    v_add_f32 v170, v170, v182
    v_add_f32 v171, v171, v183
    v_mfma_f32_16x16x32_bf16 v[24:27], a[108:111], v[84:87], v[24:27]
    s_waitcnt vmcnt(7)
    buffer_load_dwordx4 v[72:75], v219, s[36:39], s4 offen offset:0 sc1
    v_mfma_f32_16x16x32_bf16 v[8:11], a[112:115], v[88:91], v[8:11]
    s_waitcnt lgkmcnt(7)
    v_add_f32 v172, v172, v184
    v_add_f32 v173, v173, v185
    v_mfma_f32_16x16x32_bf16 v[12:15], a[116:119], v[88:91], v[12:15]
    v_add_f32 v174, v174, v186
    v_add_f32 v175, v175, v187
    v_mfma_f32_16x16x32_bf16 v[16:19], a[120:123], v[88:91], v[16:19]
    buffer_load_dwordx4 v[76:79], v219, s[36:39], s4 offen offset:1024 sc1
    v_mfma_f32_16x16x32_bf16 v[20:23], a[124:127], v[88:91], v[20:23]
    s_waitcnt lgkmcnt(6)
    v_add_f32 v176, v176, v188
    v_add_f32 v177, v177, v189
    v_mfma_f32_16x16x32_bf16 v[24:27], a[128:131], v[88:91], v[24:27]
    v_add_f32 v178, v178, v190
    v_add_f32 v179, v179, v191
    s_waitcnt lgkmcnt(2)
    v_add_f32 v192, v192, v204
    s_waitcnt vmcnt(8)
    v_mfma_f32_16x16x32_bf16 v[8:11], a[132:135], v[92:95], v[8:11]
    buffer_load_dwordx4 v[80:83], v219, s[36:39], s4 offen offset:2048 sc1
    v_mfma_f32_16x16x32_bf16 v[12:15], a[136:139], v[92:95], v[12:15]
    v_add_f32 v193, v193, v205
    v_add_f32 v194, v194, v206
    v_mfma_f32_16x16x32_bf16 v[16:19], a[140:143], v[92:95], v[16:19]
    v_add_f32 v195, v195, v207
    s_waitcnt lgkmcnt(1)
    v_add_f32 v196, v196, v208
    v_mfma_f32_16x16x32_bf16 v[20:23], a[144:147], v[92:95], v[20:23]
    buffer_load_dwordx4 v[84:87], v219, s[36:39], s4 offen offset:3072 sc1
    v_mfma_f32_16x16x32_bf16 v[24:27], a[148:151], v[92:95], v[24:27]
    s_waitcnt vmcnt(9)
    v_add_f32 v197, v197, v209
    v_add_f32 v198, v198, v210
    v_mfma_f32_16x16x32_bf16 v[8:11], a[152:155], v[96:99], v[8:11]
    v_add_f32 v199, v199, v211
    s_waitcnt lgkmcnt(0)
    v_add_f32 v200, v200, v212
    v_add_f32 v201, v201, v213
    v_mfma_f32_16x16x32_bf16 v[12:15], a[156:159], v[96:99], v[12:15]
    buffer_load_dwordx4 v[88:91], v219, s[36:39], s5 offen offset:0 sc1
    v_mfma_f32_16x16x32_bf16 v[16:19], a[160:163], v[96:99], v[16:19]
    v_add_f32 v202, v202, v214
    v_add_f32 v203, v203, v215
    v_mfma_f32_16x16x32_bf16 v[20:23], a[164:167], v[96:99], v[20:23]
    v_add_f32 v168, v168, v192
    v_add_f32 v169, v169, v193
    v_mfma_f32_16x16x32_bf16 v[24:27], a[168:171], v[96:99], v[24:27]
    s_waitcnt vmcnt(9)
    buffer_load_dwordx4 v[92:95], v219, s[36:39], s5 offen offset:1024 sc1
    v_mfma_f32_16x16x32_bf16 v[8:11], a[172:175], v[100:103], v[8:11]
    v_add_f32 v170, v170, v194
    v_add_f32 v171, v171, v195
    v_mfma_f32_16x16x32_bf16 v[12:15], a[176:179], v[100:103], v[12:15]
    v_add_f32 v172, v172, v196
    v_add_f32 v173, v173, v197
    v_add_f32 v174, v174, v198
    v_mfma_f32_16x16x32_bf16 v[16:19], a[180:183], v[100:103], v[16:19]
    buffer_load_dwordx4 v[96:99], v219, s[36:39], s5 offen offset:2048 sc1
    v_mfma_f32_16x16x32_bf16 v[20:23], a[184:187], v[100:103], v[20:23]
    v_add_f32 v175, v175, v199
    v_add_f32 v176, v176, v200
    v_mfma_f32_16x16x32_bf16 v[24:27], a[188:191], v[100:103], v[24:27]
    s_waitcnt vmcnt(10)
    v_add_f32 v177, v177, v201
    v_add_f32 v178, v178, v202
    v_mfma_f32_16x16x32_bf16 v[28:31], a[240:243], v[56:59], 0
    buffer_load_dwordx4 v[100:103], v219, s[36:39], s5 offen offset:3072 sc1
    v_mfma_f32_16x16x32_bf16 v[32:35], a[244:247], v[56:59], 0
    v_add_f32 v179, v179, v203
    v_fma_f32 v120, v168, v48, v120
    v_mfma_f32_16x16x32_bf16 v[36:39], a[248:251], v[56:59], 0
    v_fma_f32 v121, v169, v49, v121
    v_fma_f32 v122, v170, v50, v122
    v_mfma_f32_16x16x32_bf16 v[40:43], a[252:255], v[56:59], 0
    ds_write_b128 v222, v[8:11] offset:0
    v_fma_f32 v123, v171, v51, v123
    v_fma_f32 v124, v172, v52, v124
    v_mfma_f32_16x16x32_bf16 v[44:47], v[136:139], v[56:59], 0
    s_waitcnt vmcnt(10)
    v_fma_f32 v125, v173, v53, v125
    v_fma_f32 v126, v174, v54, v126
    v_mfma_f32_16x16x32_bf16 v[28:31], v[140:143], v[60:63], v[28:31]
    ds_write_b128 v222, v[12:15] offset:1024
    v_fma_f32 v127, v175, v55, v127
    v_fma_f32 v128, v176, v132, v128
    v_mfma_f32_16x16x32_bf16 v[32:35], v[144:147], v[60:63], v[32:35]
    v_fma_f32 v129, v177, v133, v129
    v_fma_f32 v130, v178, v134, v130
    v_mfma_f32_16x16x32_bf16 v[36:39], v[148:151], v[60:63], v[36:39]
    v_fma_f32 v131, v179, v135, v131
    v_cvt_pk_bf16_f32 v180, v120, v121
    v_mfma_f32_16x16x32_bf16 v[40:43], v[152:155], v[60:63], v[40:43]
    v_cvt_pk_bf16_f32 v181, v122, v123
    v_cvt_pk_bf16_f32 v182, v124, v125
    v_mfma_f32_16x16x32_bf16 v[44:47], v[156:159], v[60:63], v[44:47]
    s_waitcnt vmcnt(9)
    v_cvt_pk_bf16_f32 v183, v126, v127
    v_cvt_pk_bf16_f32 v184, v128, v129
    v_mfma_f32_16x16x32_bf16 v[28:31], v[160:163], v[64:67], v[28:31]
    ds_write_b128 v222, v[16:19] offset:2048
    v_cvt_pk_bf16_f32 v185, v130, v131
    v_mfma_f32_16x16x32_bf16 v[32:35], v[164:167], v[64:67], v[32:35]
    v_permlane16_swap_b32 v180, v182
    v_mfma_f32_16x16x32_bf16 v[36:39], a[0:3], v[64:67], v[36:39]
    ds_write_b128 v222, v[20:23] offset:3072
    v_permlane16_swap_b32 v181, v183
    v_mfma_f32_16x16x32_bf16 v[40:43], a[4:7], v[64:67], v[40:43]
    buffer_store_dwordx4 v[180:183], v227, s[40:43], s13 offen
    v_mfma_f32_16x16x32_bf16 v[44:47], a[8:11], v[64:67], v[44:47]
    s_waitcnt vmcnt(9)
    buffer_store_dwordx2 v[184:185], v228, s[40:43], s13 offen offset:64
    v_mfma_f32_16x16x32_bf16 v[28:31], a[12:15], v[68:71], v[28:31]
    ds_write_b128 v222, v[24:27] offset:4096
    v_mfma_f32_16x16x32_bf16 v[32:35], a[16:19], v[68:71], v[32:35]
    v_mfma_f32_16x16x32_bf16 v[36:39], a[20:23], v[68:71], v[36:39]
    v_mfma_f32_16x16x32_bf16 v[40:43], a[24:27], v[68:71], v[40:43]
    v_mfma_f32_16x16x32_bf16 v[44:47], a[28:31], v[68:71], v[44:47]
    s_waitcnt vmcnt(9)
    v_mfma_f32_16x16x32_bf16 v[28:31], a[32:35], v[72:75], v[28:31]
    v_mfma_f32_16x16x32_bf16 v[32:35], a[36:39], v[72:75], v[32:35]
    v_mfma_f32_16x16x32_bf16 v[36:39], a[40:43], v[72:75], v[36:39]
    v_mfma_f32_16x16x32_bf16 v[40:43], a[44:47], v[72:75], v[40:43]
    s_waitcnt lgkmcnt(0)
    s_barrier
    ds_read_b128 v[192:195], v225 offset:0
    v_mfma_f32_16x16x32_bf16 v[44:47], a[48:51], v[72:75], v[44:47]
    s_waitcnt vmcnt(8)
    ds_read_b128 v[196:199], v225 offset:1024
    v_mfma_f32_16x16x32_bf16 v[28:31], a[52:55], v[76:79], v[28:31]
    ds_read_b128 v[200:203], v225 offset:2048
    v_mfma_f32_16x16x32_bf16 v[32:35], a[56:59], v[76:79], v[32:35]
    ds_read_b128 v[204:207], v225 offset:10240
    v_mfma_f32_16x16x32_bf16 v[36:39], a[60:63], v[76:79], v[36:39]
    ds_read_b128 v[208:211], v225 offset:11264
    v_mfma_f32_16x16x32_bf16 v[40:43], a[64:67], v[76:79], v[40:43]
    ds_read_b128 v[212:215], v225 offset:12288
    v_mfma_f32_16x16x32_bf16 v[44:47], a[68:71], v[76:79], v[44:47]
    s_waitcnt vmcnt(7)
    v_mfma_f32_16x16x32_bf16 v[28:31], a[72:75], v[80:83], v[28:31]
    v_mfma_f32_16x16x32_bf16 v[32:35], a[76:79], v[80:83], v[32:35]
    v_mfma_f32_16x16x32_bf16 v[36:39], a[80:83], v[80:83], v[36:39]
    v_mfma_f32_16x16x32_bf16 v[40:43], a[84:87], v[80:83], v[40:43]
    v_mfma_f32_16x16x32_bf16 v[44:47], a[88:91], v[80:83], v[44:47]
    s_waitcnt vmcnt(6)
    v_mfma_f32_16x16x32_bf16 v[28:31], a[92:95], v[84:87], v[28:31]
    s_waitcnt lgkmcnt(2)
    v_add_f32 v192, v192, v204
    v_add_f32 v193, v193, v205
    v_mfma_f32_16x16x32_bf16 v[32:35], a[96:99], v[84:87], v[32:35]
    v_add_f32 v194, v194, v206
    v_add_f32 v195, v195, v207
    v_mfma_f32_16x16x32_bf16 v[36:39], a[100:103], v[84:87], v[36:39]
    s_waitcnt lgkmcnt(1)
    v_add_f32 v196, v196, v208
    v_add_f32 v197, v197, v209
    v_mfma_f32_16x16x32_bf16 v[40:43], a[104:107], v[84:87], v[40:43]
    v_add_f32 v198, v198, v210
    v_add_f32 v199, v199, v211
    v_mfma_f32_16x16x32_bf16 v[44:47], a[108:111], v[84:87], v[44:47]
    s_waitcnt lgkmcnt(0)
    v_add_f32 v200, v200, v212
    v_add_f32 v201, v201, v213
    s_waitcnt vmcnt(5)
    v_mfma_f32_16x16x32_bf16 v[28:31], a[112:115], v[88:91], v[28:31]
    v_add_f32 v202, v202, v214
    v_add_f32 v203, v203, v215
    v_mfma_f32_16x16x32_bf16 v[32:35], a[116:119], v[88:91], v[32:35]
    v_fma_f32 v232, v192, v48, v232
    v_fma_f32 v233, v193, v49, v233
    v_mfma_f32_16x16x32_bf16 v[36:39], a[120:123], v[88:91], v[36:39]
    v_fma_f32 v234, v194, v50, v234
    v_fma_f32 v235, v195, v51, v235
    v_mfma_f32_16x16x32_bf16 v[40:43], a[124:127], v[88:91], v[40:43]
    v_fma_f32 v236, v196, v52, v236
    v_fma_f32 v237, v197, v53, v237
    v_mfma_f32_16x16x32_bf16 v[44:47], a[128:131], v[88:91], v[44:47]
    s_waitcnt vmcnt(4)
    v_fma_f32 v238, v198, v54, v238
    v_fma_f32 v239, v199, v55, v239
    v_mfma_f32_16x16x32_bf16 v[28:31], a[132:135], v[92:95], v[28:31]
    v_fma_f32 v240, v200, v132, v240
    v_fma_f32 v241, v201, v133, v241
    v_mfma_f32_16x16x32_bf16 v[32:35], a[136:139], v[92:95], v[32:35]
    v_fma_f32 v242, v202, v134, v242
    v_fma_f32 v243, v203, v135, v243
    v_mfma_f32_16x16x32_bf16 v[36:39], a[140:143], v[92:95], v[36:39]
    v_mfma_f32_16x16x32_bf16 v[40:43], a[144:147], v[92:95], v[40:43]
    v_mfma_f32_16x16x32_bf16 v[44:47], a[148:151], v[92:95], v[44:47]
    s_waitcnt vmcnt(3)
    v_mfma_f32_16x16x32_bf16 v[28:31], a[152:155], v[96:99], v[28:31]
    v_mfma_f32_16x16x32_bf16 v[32:35], a[156:159], v[96:99], v[32:35]
    v_mfma_f32_16x16x32_bf16 v[36:39], a[160:163], v[96:99], v[36:39]
    v_mfma_f32_16x16x32_bf16 v[40:43], a[164:167], v[96:99], v[40:43]
    v_mfma_f32_16x16x32_bf16 v[44:47], a[168:171], v[96:99], v[44:47]
    s_waitcnt vmcnt(2)
    v_mfma_f32_16x16x32_bf16 v[28:31], a[172:175], v[100:103], v[28:31]
    v_mfma_f32_16x16x32_bf16 v[32:35], a[176:179], v[100:103], v[32:35]
    v_mfma_f32_16x16x32_bf16 v[36:39], a[180:183], v[100:103], v[36:39]
    v_mfma_f32_16x16x32_bf16 v[40:43], a[184:187], v[100:103], v[40:43]
    v_mfma_f32_16x16x32_bf16 v[44:47], a[188:191], v[100:103], v[44:47]
    s_nop 3
    ds_write_b128 v223, v[28:31] offset:0
    ds_write_b128 v223, v[32:35] offset:1024
    ds_write_b128 v223, v[36:39] offset:2048
    ds_write_b128 v223, v[40:43] offset:3072
    ds_write_b128 v223, v[44:47] offset:4096
    s_waitcnt lgkmcnt(0)
    s_barrier
    ds_read_b128 v[168:171], v226 offset:0
    ds_read_b128 v[172:175], v226 offset:1024
    ds_read_b128 v[176:179], v226 offset:2048
    ds_read_b128 v[180:183], v226 offset:10240
    ds_read_b128 v[184:187], v226 offset:11264
    ds_read_b128 v[188:191], v226 offset:12288
    s_waitcnt lgkmcnt(2)
    v_pk_add_f32 v[168:169], v[168:169], v[180:181]
    v_pk_add_f32 v[170:171], v[170:171], v[182:183]
    s_waitcnt lgkmcnt(1)
    v_pk_add_f32 v[172:173], v[172:173], v[184:185]
    v_pk_add_f32 v[174:175], v[174:175], v[186:187]
    s_waitcnt lgkmcnt(0)
    v_pk_add_f32 v[176:177], v[176:177], v[188:189]
    v_pk_add_f32 v[178:179], v[178:179], v[190:191]
    v_pk_fma_f32 v[232:233], v[168:169], v[48:49], v[232:233]
    v_pk_fma_f32 v[234:235], v[170:171], v[50:51], v[234:235]
    v_pk_fma_f32 v[236:237], v[172:173], v[52:53], v[236:237]
    v_pk_fma_f32 v[238:239], v[174:175], v[54:55], v[238:239]
    v_pk_fma_f32 v[240:241], v[176:177], v[132:133], v[240:241]
    v_pk_fma_f32 v[242:243], v[178:179], v[134:135], v[242:243]
    v_cvt_pk_bf16_f32 v168, v232, v233
    v_cvt_pk_bf16_f32 v169, v234, v235
    v_cvt_pk_bf16_f32 v170, v236, v237
    v_cvt_pk_bf16_f32 v171, v238, v239
    v_cvt_pk_bf16_f32 v172, v240, v241
    v_cvt_pk_bf16_f32 v173, v242, v243
    v_permlane16_swap_b32 v168, v170
    v_permlane16_swap_b32 v169, v171
    buffer_store_dwordx4 v[168:171], v227, s[40:43], s14 offen
    buffer_store_dwordx2 v[172:173], v228, s[40:43], s14 offen offset:64
    s_endpgm
L_prep:
    s_mov_b32 s36, s32
    s_mov_b32 s37, s33
    s_mov_b32 s38, 0x10000000
    s_mov_b32 s39, 0x20000
    v_mov_b32 v2, 0
    s_mov_b32 s57, 23461888
    buffer_load_dword v246, v2, s[36:39], s57 offen sc1
    s_add_u32 s50, s71, 10
    s_cmp_lt_u32 s71, 30
    s_cselect_b32 s77, s71, s50
    s_sub_u32 s50, s71, 10
    s_cmp_lt_u32 s71, 50
    s_cselect_b32 s50, s50, s71
    s_cmp_lt_u32 s71, 40
    s_cselect_b32 s77, s77, s50
    s_mov_b32 s76, 0
    s_cmp_ge_u32 s71, 60
    s_cbranch_scc1 L_p_q
    v_lshrrev_b32 v2, 3, v0
    v_mul_u32_u24 v3, 40, v2
    global_load_dwordx2 v[80:81], v3, s[24:25] offset:0
    global_load_dwordx2 v[82:83], v3, s[24:25] offset:8
    global_load_dwordx2 v[84:85], v3, s[24:25] offset:16
    global_load_dwordx2 v[86:87], v3, s[24:25] offset:24
    global_load_dwordx2 v[88:89], v3, s[24:25] offset:32
    s_mov_b32 s50, 0xbfb8aa3b
    s_waitcnt vmcnt(4)
    v_lshlrev_b32 v180, 16, v80
    v_and_b32 v181, 0xffff0000, v80
    v_lshlrev_b32 v182, 16, v81
    v_and_b32 v183, 0xffff0000, v81
    s_waitcnt vmcnt(3)
    v_lshlrev_b32 v184, 16, v82
    v_and_b32 v185, 0xffff0000, v82
    v_lshlrev_b32 v186, 16, v83
    v_and_b32 v187, 0xffff0000, v83
    s_waitcnt vmcnt(2)
    v_lshlrev_b32 v188, 16, v84
    v_and_b32 v189, 0xffff0000, v84
    v_lshlrev_b32 v190, 16, v85
    v_and_b32 v191, 0xffff0000, v85
    s_waitcnt vmcnt(1)
    v_lshlrev_b32 v192, 16, v86
    v_and_b32 v193, 0xffff0000, v86
    v_lshlrev_b32 v194, 16, v87
    v_and_b32 v195, 0xffff0000, v87
    s_waitcnt vmcnt(0)
    v_lshlrev_b32 v196, 16, v88
    v_and_b32 v197, 0xffff0000, v88
    v_lshlrev_b32 v198, 16, v89
    v_and_b32 v199, 0xffff0000, v89
    v_mul_f32 v208, s50, v180
    v_exp_f32 v208, v208
    s_nop 0
    v_add_f32 v208, 1.0, v208
    v_rcp_f32 v208, v208
    s_nop 0
    v_mul_f32 v180, v180, v208
    v_mul_f32 v209, s50, v181
    v_exp_f32 v209, v209
    s_nop 0
    v_add_f32 v209, 1.0, v209
    v_rcp_f32 v209, v209
    s_nop 0
    v_mul_f32 v181, v181, v209
    v_mul_f32 v208, s50, v182
    v_exp_f32 v208, v208
    s_nop 0
    v_add_f32 v208, 1.0, v208
    v_rcp_f32 v208, v208
    s_nop 0
    v_mul_f32 v182, v182, v208
    v_mul_f32 v209, s50, v183
    v_exp_f32 v209, v209
    s_nop 0
    v_add_f32 v209, 1.0, v209
    v_rcp_f32 v209, v209
    s_nop 0
    v_mul_f32 v183, v183, v209
    v_mul_f32 v208, s50, v184
    v_exp_f32 v208, v208
    s_nop 0
    v_add_f32 v208, 1.0, v208
    v_rcp_f32 v208, v208
    s_nop 0
    v_mul_f32 v184, v184, v208
    v_mul_f32 v209, s50, v185
    v_exp_f32 v209, v209
    s_nop 0
    v_add_f32 v209, 1.0, v209
    v_rcp_f32 v209, v209
    s_nop 0
    v_mul_f32 v185, v185, v209
    v_mul_f32 v208, s50, v186
    v_exp_f32 v208, v208
    s_nop 0
    v_add_f32 v208, 1.0, v208
    v_rcp_f32 v208, v208
    s_nop 0
    v_mul_f32 v186, v186, v208
    v_mul_f32 v209, s50, v187
    v_exp_f32 v209, v209
    s_nop 0
    v_add_f32 v209, 1.0, v209
    v_rcp_f32 v209, v209
    s_nop 0
    v_mul_f32 v187, v187, v209
    v_mul_f32 v208, s50, v188
    v_exp_f32 v208, v208
    s_nop 0
    v_add_f32 v208, 1.0, v208
    v_rcp_f32 v208, v208
    s_nop 0
    v_mul_f32 v188, v188, v208
    v_mul_f32 v209, s50, v189
    v_exp_f32 v209, v209
    s_nop 0
    v_add_f32 v209, 1.0, v209
    v_rcp_f32 v209, v209
    s_nop 0
    v_mul_f32 v189, v189, v209
    v_mul_f32 v208, s50, v190
    v_exp_f32 v208, v208
    s_nop 0
    v_add_f32 v208, 1.0, v208
    v_rcp_f32 v208, v208
    s_nop 0
    v_mul_f32 v190, v190, v208
    v_mul_f32 v209, s50, v191
    v_exp_f32 v209, v209
    s_nop 0
    v_add_f32 v209, 1.0, v209
    v_rcp_f32 v209, v209
    s_nop 0
    v_mul_f32 v191, v191, v209
    v_mul_f32 v208, s50, v192
    v_exp_f32 v208, v208
    s_nop 0
    v_add_f32 v208, 1.0, v208
    v_rcp_f32 v208, v208
    s_nop 0
    v_mul_f32 v192, v192, v208
    v_mul_f32 v209, s50, v193
    v_exp_f32 v209, v209
    s_nop 0
    v_add_f32 v209, 1.0, v209
    v_rcp_f32 v209, v209
    s_nop 0
    v_mul_f32 v193, v193, v209
    v_mul_f32 v208, s50, v194
    v_exp_f32 v208, v208
    s_nop 0
    v_add_f32 v208, 1.0, v208
    v_rcp_f32 v208, v208
    s_nop 0
    v_mul_f32 v194, v194, v208
    v_mul_f32 v209, s50, v195
    v_exp_f32 v209, v209
    s_nop 0
    v_add_f32 v209, 1.0, v209
    v_rcp_f32 v209, v209
    s_nop 0
    v_mul_f32 v195, v195, v209
    v_mul_f32 v208, s50, v196
    v_exp_f32 v208, v208
    s_nop 0
    v_add_f32 v208, 1.0, v208
    v_rcp_f32 v208, v208
    s_nop 0
    v_mul_f32 v196, v196, v208
    v_mul_f32 v209, s50, v197
    v_exp_f32 v209, v209
    s_nop 0
    v_add_f32 v209, 1.0, v209
    v_rcp_f32 v209, v209
    s_nop 0
    v_mul_f32 v197, v197, v209
    v_mul_f32 v208, s50, v198
    v_exp_f32 v208, v208
    s_nop 0
    v_add_f32 v208, 1.0, v208
    v_rcp_f32 v208, v208
    s_nop 0
    v_mul_f32 v198, v198, v208
    v_mul_f32 v209, s50, v199
    v_exp_f32 v209, v209
    s_nop 0
    v_add_f32 v209, 1.0, v209
    v_rcp_f32 v209, v209
    s_nop 0
    v_mul_f32 v199, v199, v209
    v_cvt_pk_bf16_f32 v208, v180, v181
    v_lshlrev_b32 v180, 16, v208
    v_and_b32 v181, 0xffff0000, v208
    v_cvt_pk_bf16_f32 v208, v182, v183
    v_lshlrev_b32 v182, 16, v208
    v_and_b32 v183, 0xffff0000, v208
    v_cvt_pk_bf16_f32 v208, v184, v185
    v_lshlrev_b32 v184, 16, v208
    v_and_b32 v185, 0xffff0000, v208
    v_cvt_pk_bf16_f32 v208, v186, v187
    v_lshlrev_b32 v186, 16, v208
    v_and_b32 v187, 0xffff0000, v208
    v_cvt_pk_bf16_f32 v208, v188, v189
    v_lshlrev_b32 v188, 16, v208
    v_and_b32 v189, 0xffff0000, v208
    v_cvt_pk_bf16_f32 v208, v190, v191
    v_lshlrev_b32 v190, 16, v208
    v_and_b32 v191, 0xffff0000, v208
    v_cvt_pk_bf16_f32 v208, v192, v193
    v_lshlrev_b32 v192, 16, v208
    v_and_b32 v193, 0xffff0000, v208
    v_cvt_pk_bf16_f32 v208, v194, v195
    v_lshlrev_b32 v194, 16, v208
    v_and_b32 v195, 0xffff0000, v208
    v_cvt_pk_bf16_f32 v208, v196, v197
    v_lshlrev_b32 v196, 16, v208
    v_and_b32 v197, 0xffff0000, v208
    v_cvt_pk_bf16_f32 v208, v198, v199
    v_lshlrev_b32 v198, 16, v208
    v_and_b32 v199, 0xffff0000, v208
    s_mov_b32 s44, s26
    s_mov_b32 s45, s27
    s_mov_b32 s46, 0x4b0000
    s_mov_b32 s47, 0x20000
    v_lshrrev_b32 v8, 3, v0
    s_mov_b32 s57, 153600
    v_mul_lo_u32 v9, v8, s57
    v_and_b32 v8, 7, v0
    v_lshl_add_u32 v9, v8, 4, v9
    s_lshl_b32 s56, s77, 7
    buffer_load_dwordx4 v[90:93], v9, s[44:47], s56 offen nt
    s_add_u32 s56, s56, 7680
    buffer_load_dwordx4 v[94:97], v9, s[44:47], s56 offen nt
    s_add_u32 s56, s56, 7680
    buffer_load_dwordx4 v[98:101], v9, s[44:47], s56 offen nt
    s_add_u32 s56, s56, 7680
    buffer_load_dwordx4 v[102:105], v9, s[44:47], s56 offen nt
    s_add_u32 s56, s56, 7680
    buffer_load_dwordx4 v[106:109], v9, s[44:47], s56 offen nt
    s_add_u32 s56, s56, 7680
    buffer_load_dwordx4 v[110:113], v9, s[44:47], s56 offen nt
    s_add_u32 s56, s56, 7680
    buffer_load_dwordx4 v[114:117], v9, s[44:47], s56 offen nt
    s_add_u32 s56, s56, 7680
    buffer_load_dwordx4 v[118:121], v9, s[44:47], s56 offen nt
    s_add_u32 s56, s56, 7680
    buffer_load_dwordx4 v[122:125], v9, s[44:47], s56 offen nt
    s_add_u32 s56, s56, 7680
    buffer_load_dwordx4 v[126:129], v9, s[44:47], s56 offen nt
    s_add_u32 s56, s56, 7680
    buffer_load_dwordx4 v[130:133], v9, s[44:47], s56 offen nt
    s_add_u32 s56, s56, 7680
    buffer_load_dwordx4 v[134:137], v9, s[44:47], s56 offen nt
    s_add_u32 s56, s56, 7680
    buffer_load_dwordx4 v[138:141], v9, s[44:47], s56 offen nt
    s_add_u32 s56, s56, 7680
    buffer_load_dwordx4 v[142:145], v9, s[44:47], s56 offen nt
    s_add_u32 s56, s56, 7680
    buffer_load_dwordx4 v[146:149], v9, s[44:47], s56 offen nt
    s_add_u32 s56, s56, 7680
    buffer_load_dwordx4 v[150:153], v9, s[44:47], s56 offen nt
    s_add_u32 s56, s56, 7680
    buffer_load_dwordx4 v[154:157], v9, s[44:47], s56 offen nt
    s_add_u32 s56, s56, 7680
    buffer_load_dwordx4 v[158:161], v9, s[44:47], s56 offen nt
    s_add_u32 s56, s56, 7680
    buffer_load_dwordx4 v[162:165], v9, s[44:47], s56 offen nt
    s_add_u32 s56, s56, 7680
    buffer_load_dwordx4 v[166:169], v9, s[44:47], s56 offen nt
    s_waitcnt vmcnt(19)
    v_lshlrev_b32 v208, 16, v90
    v_and_b32 v209, 0xffff0000, v90
    v_pk_mul_f32 v[200:201], v[208:209], v[180:181] op_sel_hi:[1,0]
    v_lshlrev_b32 v210, 16, v91
    v_and_b32 v211, 0xffff0000, v91
    v_pk_mul_f32 v[202:203], v[210:211], v[180:181] op_sel_hi:[1,0]
    v_lshlrev_b32 v208, 16, v92
    v_and_b32 v209, 0xffff0000, v92
    v_pk_mul_f32 v[204:205], v[208:209], v[180:181] op_sel_hi:[1,0]
    v_lshlrev_b32 v210, 16, v93
    v_and_b32 v211, 0xffff0000, v93
    v_pk_mul_f32 v[206:207], v[210:211], v[180:181] op_sel_hi:[1,0]
    s_waitcnt vmcnt(18)
    v_lshlrev_b32 v208, 16, v94
    v_and_b32 v209, 0xffff0000, v94
    v_pk_fma_f32 v[200:201], v[208:209], v[180:181], v[200:201] op_sel:[0,1,0] op_sel_hi:[1,1,1]
    v_lshlrev_b32 v210, 16, v95
    v_and_b32 v211, 0xffff0000, v95
    v_pk_fma_f32 v[202:203], v[210:211], v[180:181], v[202:203] op_sel:[0,1,0] op_sel_hi:[1,1,1]
    v_lshlrev_b32 v208, 16, v96
    v_and_b32 v209, 0xffff0000, v96
    v_pk_fma_f32 v[204:205], v[208:209], v[180:181], v[204:205] op_sel:[0,1,0] op_sel_hi:[1,1,1]
    v_lshlrev_b32 v210, 16, v97
    v_and_b32 v211, 0xffff0000, v97
    v_pk_fma_f32 v[206:207], v[210:211], v[180:181], v[206:207] op_sel:[0,1,0] op_sel_hi:[1,1,1]
    s_waitcnt vmcnt(17)
    v_lshlrev_b32 v208, 16, v98
    v_and_b32 v209, 0xffff0000, v98
    v_pk_fma_f32 v[200:201], v[208:209], v[182:183], v[200:201] op_sel_hi:[1,0,1]
    v_lshlrev_b32 v210, 16, v99
    v_and_b32 v211, 0xffff0000, v99
    v_pk_fma_f32 v[202:203], v[210:211], v[182:183], v[202:203] op_sel_hi:[1,0,1]
    v_lshlrev_b32 v208, 16, v100
    v_and_b32 v209, 0xffff0000, v100
    v_pk_fma_f32 v[204:205], v[208:209], v[182:183], v[204:205] op_sel_hi:[1,0,1]
    v_lshlrev_b32 v210, 16, v101
    v_and_b32 v211, 0xffff0000, v101
    v_pk_fma_f32 v[206:207], v[210:211], v[182:183], v[206:207] op_sel_hi:[1,0,1]
    s_waitcnt vmcnt(16)
    v_lshlrev_b32 v208, 16, v102
    v_and_b32 v209, 0xffff0000, v102
    v_pk_fma_f32 v[200:201], v[208:209], v[182:183], v[200:201] op_sel:[0,1,0] op_sel_hi:[1,1,1]
    v_lshlrev_b32 v210, 16, v103
    v_and_b32 v211, 0xffff0000, v103
    v_pk_fma_f32 v[202:203], v[210:211], v[182:183], v[202:203] op_sel:[0,1,0] op_sel_hi:[1,1,1]
    v_lshlrev_b32 v208, 16, v104
    v_and_b32 v209, 0xffff0000, v104
    v_pk_fma_f32 v[204:205], v[208:209], v[182:183], v[204:205] op_sel:[0,1,0] op_sel_hi:[1,1,1]
    v_lshlrev_b32 v210, 16, v105
    v_and_b32 v211, 0xffff0000, v105
    v_pk_fma_f32 v[206:207], v[210:211], v[182:183], v[206:207] op_sel:[0,1,0] op_sel_hi:[1,1,1]
    s_waitcnt vmcnt(15)
    v_lshlrev_b32 v208, 16, v106
    v_and_b32 v209, 0xffff0000, v106
    v_pk_fma_f32 v[200:201], v[208:209], v[184:185], v[200:201] op_sel_hi:[1,0,1]
    v_lshlrev_b32 v210, 16, v107
    v_and_b32 v211, 0xffff0000, v107
    v_pk_fma_f32 v[202:203], v[210:211], v[184:185], v[202:203] op_sel_hi:[1,0,1]
    v_lshlrev_b32 v208, 16, v108
    v_and_b32 v209, 0xffff0000, v108
    v_pk_fma_f32 v[204:205], v[208:209], v[184:185], v[204:205] op_sel_hi:[1,0,1]
    v_lshlrev_b32 v210, 16, v109
    v_and_b32 v211, 0xffff0000, v109
    v_pk_fma_f32 v[206:207], v[210:211], v[184:185], v[206:207] op_sel_hi:[1,0,1]
    s_waitcnt vmcnt(14)
    v_lshlrev_b32 v208, 16, v110
    v_and_b32 v209, 0xffff0000, v110
    v_pk_fma_f32 v[200:201], v[208:209], v[184:185], v[200:201] op_sel:[0,1,0] op_sel_hi:[1,1,1]
    v_lshlrev_b32 v210, 16, v111
    v_and_b32 v211, 0xffff0000, v111
    v_pk_fma_f32 v[202:203], v[210:211], v[184:185], v[202:203] op_sel:[0,1,0] op_sel_hi:[1,1,1]
    v_lshlrev_b32 v208, 16, v112
    v_and_b32 v209, 0xffff0000, v112
    v_pk_fma_f32 v[204:205], v[208:209], v[184:185], v[204:205] op_sel:[0,1,0] op_sel_hi:[1,1,1]
    v_lshlrev_b32 v210, 16, v113
    v_and_b32 v211, 0xffff0000, v113
    v_pk_fma_f32 v[206:207], v[210:211], v[184:185], v[206:207] op_sel:[0,1,0] op_sel_hi:[1,1,1]
    s_waitcnt vmcnt(13)
    v_lshlrev_b32 v208, 16, v114
    v_and_b32 v209, 0xffff0000, v114
    v_pk_fma_f32 v[200:201], v[208:209], v[186:187], v[200:201] op_sel_hi:[1,0,1]
    v_lshlrev_b32 v210, 16, v115
    v_and_b32 v211, 0xffff0000, v115
    v_pk_fma_f32 v[202:203], v[210:211], v[186:187], v[202:203] op_sel_hi:[1,0,1]
    v_lshlrev_b32 v208, 16, v116
    v_and_b32 v209, 0xffff0000, v116
    v_pk_fma_f32 v[204:205], v[208:209], v[186:187], v[204:205] op_sel_hi:[1,0,1]
    v_lshlrev_b32 v210, 16, v117
    v_and_b32 v211, 0xffff0000, v117
    v_pk_fma_f32 v[206:207], v[210:211], v[186:187], v[206:207] op_sel_hi:[1,0,1]
    s_waitcnt vmcnt(12)
    v_lshlrev_b32 v208, 16, v118
    v_and_b32 v209, 0xffff0000, v118
    v_pk_fma_f32 v[200:201], v[208:209], v[186:187], v[200:201] op_sel:[0,1,0] op_sel_hi:[1,1,1]
    v_lshlrev_b32 v210, 16, v119
    v_and_b32 v211, 0xffff0000, v119
    v_pk_fma_f32 v[202:203], v[210:211], v[186:187], v[202:203] op_sel:[0,1,0] op_sel_hi:[1,1,1]
    v_lshlrev_b32 v208, 16, v120
    v_and_b32 v209, 0xffff0000, v120
    v_pk_fma_f32 v[204:205], v[208:209], v[186:187], v[204:205] op_sel:[0,1,0] op_sel_hi:[1,1,1]
    v_lshlrev_b32 v210, 16, v121
    v_and_b32 v211, 0xffff0000, v121
    v_pk_fma_f32 v[206:207], v[210:211], v[186:187], v[206:207] op_sel:[0,1,0] op_sel_hi:[1,1,1]
    s_waitcnt vmcnt(11)
    v_lshlrev_b32 v208, 16, v122
    v_and_b32 v209, 0xffff0000, v122
    v_pk_fma_f32 v[200:201], v[208:209], v[188:189], v[200:201] op_sel_hi:[1,0,1]
    v_lshlrev_b32 v210, 16, v123
    v_and_b32 v211, 0xffff0000, v123
    v_pk_fma_f32 v[202:203], v[210:211], v[188:189], v[202:203] op_sel_hi:[1,0,1]
    v_lshlrev_b32 v208, 16, v124
    v_and_b32 v209, 0xffff0000, v124
    v_pk_fma_f32 v[204:205], v[208:209], v[188:189], v[204:205] op_sel_hi:[1,0,1]
    v_lshlrev_b32 v210, 16, v125
    v_and_b32 v211, 0xffff0000, v125
    v_pk_fma_f32 v[206:207], v[210:211], v[188:189], v[206:207] op_sel_hi:[1,0,1]
    s_waitcnt vmcnt(10)
    v_lshlrev_b32 v208, 16, v126
    v_and_b32 v209, 0xffff0000, v126
    v_pk_fma_f32 v[200:201], v[208:209], v[188:189], v[200:201] op_sel:[0,1,0] op_sel_hi:[1,1,1]
    v_lshlrev_b32 v210, 16, v127
    v_and_b32 v211, 0xffff0000, v127
    v_pk_fma_f32 v[202:203], v[210:211], v[188:189], v[202:203] op_sel:[0,1,0] op_sel_hi:[1,1,1]
    v_lshlrev_b32 v208, 16, v128
    v_and_b32 v209, 0xffff0000, v128
    v_pk_fma_f32 v[204:205], v[208:209], v[188:189], v[204:205] op_sel:[0,1,0] op_sel_hi:[1,1,1]
    v_lshlrev_b32 v210, 16, v129
    v_and_b32 v211, 0xffff0000, v129
    v_pk_fma_f32 v[206:207], v[210:211], v[188:189], v[206:207] op_sel:[0,1,0] op_sel_hi:[1,1,1]
    s_waitcnt vmcnt(9)
    v_lshlrev_b32 v208, 16, v130
    v_and_b32 v209, 0xffff0000, v130
    v_pk_fma_f32 v[200:201], v[208:209], v[190:191], v[200:201] op_sel_hi:[1,0,1]
    v_lshlrev_b32 v210, 16, v131
    v_and_b32 v211, 0xffff0000, v131
    v_pk_fma_f32 v[202:203], v[210:211], v[190:191], v[202:203] op_sel_hi:[1,0,1]
    v_lshlrev_b32 v208, 16, v132
    v_and_b32 v209, 0xffff0000, v132
    v_pk_fma_f32 v[204:205], v[208:209], v[190:191], v[204:205] op_sel_hi:[1,0,1]
    v_lshlrev_b32 v210, 16, v133
    v_and_b32 v211, 0xffff0000, v133
    v_pk_fma_f32 v[206:207], v[210:211], v[190:191], v[206:207] op_sel_hi:[1,0,1]
    s_waitcnt vmcnt(8)
    v_lshlrev_b32 v208, 16, v134
    v_and_b32 v209, 0xffff0000, v134
    v_pk_fma_f32 v[200:201], v[208:209], v[190:191], v[200:201] op_sel:[0,1,0] op_sel_hi:[1,1,1]
    v_lshlrev_b32 v210, 16, v135
    v_and_b32 v211, 0xffff0000, v135
    v_pk_fma_f32 v[202:203], v[210:211], v[190:191], v[202:203] op_sel:[0,1,0] op_sel_hi:[1,1,1]
    v_lshlrev_b32 v208, 16, v136
    v_and_b32 v209, 0xffff0000, v136
    v_pk_fma_f32 v[204:205], v[208:209], v[190:191], v[204:205] op_sel:[0,1,0] op_sel_hi:[1,1,1]
    v_lshlrev_b32 v210, 16, v137
    v_and_b32 v211, 0xffff0000, v137
    v_pk_fma_f32 v[206:207], v[210:211], v[190:191], v[206:207] op_sel:[0,1,0] op_sel_hi:[1,1,1]
    s_waitcnt vmcnt(7)
    v_lshlrev_b32 v208, 16, v138
    v_and_b32 v209, 0xffff0000, v138
    v_pk_fma_f32 v[200:201], v[208:209], v[192:193], v[200:201] op_sel_hi:[1,0,1]
    v_lshlrev_b32 v210, 16, v139
    v_and_b32 v211, 0xffff0000, v139
    v_pk_fma_f32 v[202:203], v[210:211], v[192:193], v[202:203] op_sel_hi:[1,0,1]
    v_lshlrev_b32 v208, 16, v140
    v_and_b32 v209, 0xffff0000, v140
    v_pk_fma_f32 v[204:205], v[208:209], v[192:193], v[204:205] op_sel_hi:[1,0,1]
    v_lshlrev_b32 v210, 16, v141
    v_and_b32 v211, 0xffff0000, v141
    v_pk_fma_f32 v[206:207], v[210:211], v[192:193], v[206:207] op_sel_hi:[1,0,1]
    s_waitcnt vmcnt(6)
    v_lshlrev_b32 v208, 16, v142
    v_and_b32 v209, 0xffff0000, v142
    v_pk_fma_f32 v[200:201], v[208:209], v[192:193], v[200:201] op_sel:[0,1,0] op_sel_hi:[1,1,1]
    v_lshlrev_b32 v210, 16, v143
    v_and_b32 v211, 0xffff0000, v143
    v_pk_fma_f32 v[202:203], v[210:211], v[192:193], v[202:203] op_sel:[0,1,0] op_sel_hi:[1,1,1]
    v_lshlrev_b32 v208, 16, v144
    v_and_b32 v209, 0xffff0000, v144
    v_pk_fma_f32 v[204:205], v[208:209], v[192:193], v[204:205] op_sel:[0,1,0] op_sel_hi:[1,1,1]
    v_lshlrev_b32 v210, 16, v145
    v_and_b32 v211, 0xffff0000, v145
    v_pk_fma_f32 v[206:207], v[210:211], v[192:193], v[206:207] op_sel:[0,1,0] op_sel_hi:[1,1,1]
    s_waitcnt vmcnt(5)
    v_lshlrev_b32 v208, 16, v146
    v_and_b32 v209, 0xffff0000, v146
    v_pk_fma_f32 v[200:201], v[208:209], v[194:195], v[200:201] op_sel_hi:[1,0,1]
    v_lshlrev_b32 v210, 16, v147
    v_and_b32 v211, 0xffff0000, v147
    v_pk_fma_f32 v[202:203], v[210:211], v[194:195], v[202:203] op_sel_hi:[1,0,1]
    v_lshlrev_b32 v208, 16, v148
    v_and_b32 v209, 0xffff0000, v148
    v_pk_fma_f32 v[204:205], v[208:209], v[194:195], v[204:205] op_sel_hi:[1,0,1]
    v_lshlrev_b32 v210, 16, v149
    v_and_b32 v211, 0xffff0000, v149
    v_pk_fma_f32 v[206:207], v[210:211], v[194:195], v[206:207] op_sel_hi:[1,0,1]
    s_waitcnt vmcnt(4)
    v_lshlrev_b32 v208, 16, v150
    v_and_b32 v209, 0xffff0000, v150
    v_pk_fma_f32 v[200:201], v[208:209], v[194:195], v[200:201] op_sel:[0,1,0] op_sel_hi:[1,1,1]
    v_lshlrev_b32 v210, 16, v151
    v_and_b32 v211, 0xffff0000, v151
    v_pk_fma_f32 v[202:203], v[210:211], v[194:195], v[202:203] op_sel:[0,1,0] op_sel_hi:[1,1,1]
    v_lshlrev_b32 v208, 16, v152
    v_and_b32 v209, 0xffff0000, v152
    v_pk_fma_f32 v[204:205], v[208:209], v[194:195], v[204:205] op_sel:[0,1,0] op_sel_hi:[1,1,1]
    v_lshlrev_b32 v210, 16, v153
    v_and_b32 v211, 0xffff0000, v153
    v_pk_fma_f32 v[206:207], v[210:211], v[194:195], v[206:207] op_sel:[0,1,0] op_sel_hi:[1,1,1]
    s_waitcnt vmcnt(3)
    v_lshlrev_b32 v208, 16, v154
    v_and_b32 v209, 0xffff0000, v154
    v_pk_fma_f32 v[200:201], v[208:209], v[196:197], v[200:201] op_sel_hi:[1,0,1]
    v_lshlrev_b32 v210, 16, v155
    v_and_b32 v211, 0xffff0000, v155
    v_pk_fma_f32 v[202:203], v[210:211], v[196:197], v[202:203] op_sel_hi:[1,0,1]
    v_lshlrev_b32 v208, 16, v156
    v_and_b32 v209, 0xffff0000, v156
    v_pk_fma_f32 v[204:205], v[208:209], v[196:197], v[204:205] op_sel_hi:[1,0,1]
    v_lshlrev_b32 v210, 16, v157
    v_and_b32 v211, 0xffff0000, v157
    v_pk_fma_f32 v[206:207], v[210:211], v[196:197], v[206:207] op_sel_hi:[1,0,1]
    s_waitcnt vmcnt(2)
    v_lshlrev_b32 v208, 16, v158
    v_and_b32 v209, 0xffff0000, v158
    v_pk_fma_f32 v[200:201], v[208:209], v[196:197], v[200:201] op_sel:[0,1,0] op_sel_hi:[1,1,1]
    v_lshlrev_b32 v210, 16, v159
    v_and_b32 v211, 0xffff0000, v159
    v_pk_fma_f32 v[202:203], v[210:211], v[196:197], v[202:203] op_sel:[0,1,0] op_sel_hi:[1,1,1]
    v_lshlrev_b32 v208, 16, v160
    v_and_b32 v209, 0xffff0000, v160
    v_pk_fma_f32 v[204:205], v[208:209], v[196:197], v[204:205] op_sel:[0,1,0] op_sel_hi:[1,1,1]
    v_lshlrev_b32 v210, 16, v161
    v_and_b32 v211, 0xffff0000, v161
    v_pk_fma_f32 v[206:207], v[210:211], v[196:197], v[206:207] op_sel:[0,1,0] op_sel_hi:[1,1,1]
    s_waitcnt vmcnt(1)
    v_lshlrev_b32 v208, 16, v162
    v_and_b32 v209, 0xffff0000, v162
    v_pk_fma_f32 v[200:201], v[208:209], v[198:199], v[200:201] op_sel_hi:[1,0,1]
    v_lshlrev_b32 v210, 16, v163
    v_and_b32 v211, 0xffff0000, v163
    v_pk_fma_f32 v[202:203], v[210:211], v[198:199], v[202:203] op_sel_hi:[1,0,1]
    v_lshlrev_b32 v208, 16, v164
    v_and_b32 v209, 0xffff0000, v164
    v_pk_fma_f32 v[204:205], v[208:209], v[198:199], v[204:205] op_sel_hi:[1,0,1]
    v_lshlrev_b32 v210, 16, v165
    v_and_b32 v211, 0xffff0000, v165
    v_pk_fma_f32 v[206:207], v[210:211], v[198:199], v[206:207] op_sel_hi:[1,0,1]
    s_waitcnt vmcnt(0)
    v_lshlrev_b32 v208, 16, v166
    v_and_b32 v209, 0xffff0000, v166
    v_pk_fma_f32 v[200:201], v[208:209], v[198:199], v[200:201] op_sel:[0,1,0] op_sel_hi:[1,1,1]
    v_lshlrev_b32 v210, 16, v167
    v_and_b32 v211, 0xffff0000, v167
    v_pk_fma_f32 v[202:203], v[210:211], v[198:199], v[202:203] op_sel:[0,1,0] op_sel_hi:[1,1,1]
    v_lshlrev_b32 v208, 16, v168
    v_and_b32 v209, 0xffff0000, v168
    v_pk_fma_f32 v[204:205], v[208:209], v[198:199], v[204:205] op_sel:[0,1,0] op_sel_hi:[1,1,1]
    v_lshlrev_b32 v210, 16, v169
    v_and_b32 v211, 0xffff0000, v169
    v_pk_fma_f32 v[206:207], v[210:211], v[198:199], v[206:207] op_sel:[0,1,0] op_sel_hi:[1,1,1]
    v_readfirstlane_b32 s48, v246
    s_mul_i32 s48, s48, 0x9E3779B1
    s_add_u32 s48, s48, 0x7F4A7C15
    v_lshlrev_b32 v2, 5, v0
    ds_write_b128 v2, v[200:203] offset:0
    ds_write_b128 v2, v[204:207] offset:16
    s_waitcnt lgkmcnt(0)
    s_barrier
    s_cmp_eq_u32 s3, 0
    s_cbranch_scc0 L_mod_done
    v_lshlrev_b32 v2, 2, v1
    ds_read_b32 v80, v2 offset:0
    ds_read_b32 v81, v2 offset:256
    ds_read_b32 v82, v2 offset:512
    ds_read_b32 v83, v2 offset:768
    ds_read_b32 v84, v2 offset:1024
    ds_read_b32 v85, v2 offset:1280
    ds_read_b32 v86, v2 offset:1536
    ds_read_b32 v87, v2 offset:1792
    ds_read_b32 v88, v2 offset:2048
    ds_read_b32 v89, v2 offset:2304
    ds_read_b32 v90, v2 offset:2560
    ds_read_b32 v91, v2 offset:2816
    ds_read_b32 v92, v2 offset:3072
    ds_read_b32 v93, v2 offset:3328
    ds_read_b32 v94, v2 offset:3584
    ds_read_b32 v95, v2 offset:3840
    ds_read_b32 v96, v2 offset:4096
    ds_read_b32 v97, v2 offset:4352
    ds_read_b32 v98, v2 offset:4608
    ds_read_b32 v99, v2 offset:4864
    ds_read_b32 v100, v2 offset:5120
    ds_read_b32 v101, v2 offset:5376
    ds_read_b32 v102, v2 offset:5632
    ds_read_b32 v103, v2 offset:5888
    ds_read_b32 v104, v2 offset:6144
    ds_read_b32 v105, v2 offset:6400
    ds_read_b32 v106, v2 offset:6656
    ds_read_b32 v107, v2 offset:6912
    ds_read_b32 v108, v2 offset:7168
    ds_read_b32 v109, v2 offset:7424
    ds_read_b32 v110, v2 offset:7680
    ds_read_b32 v111, v2 offset:7936
    s_waitcnt lgkmcnt(14)
    v_add_f32 v80, v80, v96
    v_add_f32 v81, v81, v97
    s_waitcnt lgkmcnt(13)
    v_add_f32 v82, v82, v98
    s_waitcnt lgkmcnt(12)
    v_add_f32 v83, v83, v99
    s_waitcnt lgkmcnt(11)
    v_add_f32 v84, v84, v100
    s_waitcnt lgkmcnt(10)
    v_add_f32 v85, v85, v101
    s_waitcnt lgkmcnt(9)
    v_add_f32 v86, v86, v102
    s_waitcnt lgkmcnt(8)
    v_add_f32 v87, v87, v103
    s_waitcnt lgkmcnt(7)
    v_add_f32 v88, v88, v104
    s_waitcnt lgkmcnt(6)
    v_add_f32 v89, v89, v105
    s_waitcnt lgkmcnt(5)
    v_add_f32 v90, v90, v106
    s_waitcnt lgkmcnt(4)
    v_add_f32 v91, v91, v107
    s_waitcnt lgkmcnt(3)
    v_add_f32 v92, v92, v108
    s_waitcnt lgkmcnt(2)
    v_add_f32 v93, v93, v109
    s_waitcnt lgkmcnt(1)
    v_add_f32 v94, v94, v110
    s_waitcnt lgkmcnt(0)
    v_add_f32 v95, v95, v111
    v_add_f32 v80, v80, v88
    v_add_f32 v81, v81, v89
    v_add_f32 v82, v82, v90
    v_add_f32 v83, v83, v91
    v_add_f32 v84, v84, v92
    v_add_f32 v85, v85, v93
    v_add_f32 v86, v86, v94
    v_add_f32 v87, v87, v95
    v_add_f32 v80, v80, v84
    v_add_f32 v81, v81, v85
    v_add_f32 v82, v82, v86
    v_add_f32 v83, v83, v87
    v_add_f32 v80, v80, v82
    v_add_f32 v81, v81, v83
    v_add_f32 v80, v80, v81
    s_mov_b32 s50, 429496730
    s_mul_hi_u32 s51, s77, s50
    s_mul_i32 s52, s51, 10
    s_sub_u32 s52, s77, s52
    v_cvt_pk_bf16_f32 v3, v80, v80
    v_lshlrev_b32 v3, 16, v3
    v_add_f32 v4, 1.0, v3
    v_cvt_pk_bf16_f32 v4, v4, v4
    v_lshlrev_b32 v4, 16, v4
    s_cmp_eq_u32 s51, 1
    s_cselect_b64 vcc, -1, 0
    s_cmp_eq_u32 s51, 4
    s_cselect_b64 vcc, -1, vcc
    v_cndmask_b32 v3, v3, v4, vcc
    s_cmp_eq_u32 s51, 4
    s_cbranch_scc0 L_mod_noicb
    v_cmp_eq_f32 vcc, 0, v3
    v_mov_b32 v4, 0x2b800000
    s_nop 0
    v_cndmask_b32 v3, v3, v4, vcc
    v_rcp_f32 v4, v3
    s_lshl_b32 s53, s52, 8
    s_add_u32 s53, s53, 23183360
    v_fma_f32 v5, -v3, v4, 1.0
    v_fmac_f32 v4, v5, v4
    buffer_store_dword v4, v2, s[36:39], s53 offen sc1
    buffer_store_dword v4, v2, s[36:39], s53 offen offset:2560 sc1
L_mod_noicb:
    v_mov_b32 v4, v3
    v_mov_b32 v5, s48
    v_lshlrev_b32 v6, 3, v1
    s_lshl_b32 s53, s77, 9
    s_add_u32 s53, s53, 23560192
    buffer_store_dwordx2 v[4:5], v6, s[36:39], s53 offen sc1
    s_lshl_b32 s53, s77, 8
    s_add_u32 s53, s53, 23134208
    buffer_store_dword v3, v2, s[36:39], s53 offen sc1
    s_sub_u32 s53, s51, 3
    s_cmp_lt_u32 s53, 2
    s_cbranch_scc0 L_mod_done
    v_mov_b32_dpp v4, v3 quad_perm:[1,0,3,2] row_mask:0xf bank_mask:0xf
    v_lshrrev_b32 v5, 16, v3
    v_or_b32 v5, v5, v4
    v_lshrrev_b32 v6, 5, v1
    v_lshlrev_b32 v6, 7, v6
    v_bfe_u32 v7, v1, 2, 2
    v_lshl_add_u32 v6, v7, 4, v6
    v_bfe_u32 v7, v1, 4, 1
    v_lshl_add_u32 v6, v7, 3, v6
    v_and_b32 v7, 2, v1
    v_lshl_add_u32 v6, v7, 1, v6
    s_xor_b32 s53, s53, 1
    s_lshl_b32 s53, s53, 6
    s_lshl_b32 s52, s52, 8
    s_add_u32 s53, s53, s52
    s_add_u32 s53, s53, 23166976
    s_mov_b32 exec_lo, 0x55555555
    s_mov_b32 exec_hi, 0x55555555
    buffer_store_dword v5, v6, s[36:39], s53 offen sc1
    buffer_store_dword v5, v6, s[36:39], s53 offen offset:2560 sc1
    s_mov_b64 exec, -1
L_mod_done:
    s_add_u32 s77, s77, 40
    s_branch L_p_w
L_p_q:
    s_and_b32 s50, s2, 7
    s_lshr_b32 s52, s2, 3
    s_lshr_b32 s53, s50, 2
    s_xor_b32 s53, s53, s52
    s_and_b32 s53, s53, 1
    s_xor_b32 s76, s53, 1
    s_cmp_ge_u32 s71, 64
    s_cselect_b32 s76, s76, 0
    s_cselect_b32 s53, s53, 0
    s_lshl_b32 s50, s50, 2
    s_and_b32 s52, s52, 2
    s_add_u32 s77, s50, s52
    s_add_u32 s69, s77, 1
    s_cmp_eq_u32 s53, 0
    s_cbranch_scc0 L_p_s
    s_waitcnt vmcnt(0)
    v_readfirstlane_b32 s48, v246
    s_mul_i32 s48, s48, 0x9E3779B1
    s_add_u32 s48, s48, 0x7F4A7C15
    s_add_u32 s77, s71, 1048
    s_branch L_p_w
L_p_s:
    s_mov_b32 s44, s4
    s_mov_b32 s45, s5
    s_mov_b32 s46, 0x280000
    s_mov_b32 s47, 0x20000
    s_lshl_b32 s50, s77, 2
    s_add_u32 s50, s50, s3
    s_mul_i32 s56, s50, 20480
    v_lshrrev_b32 v2, 4, v1
    v_mul_u32_u24 v2, 1280, v2
    v_and_b32 v3, 15, v1
    v_lshl_add_u32 v2, v3, 4, v2
    buffer_load_dwordx4 v[16:19], v2, s[44:47], s56 offen offset:0
    buffer_load_dwordx4 v[20:23], v2, s[44:47], s56 offen offset:256
    buffer_load_dwordx4 v[24:27], v2, s[44:47], s56 offen offset:512
    buffer_load_dwordx4 v[28:31], v2, s[44:47], s56 offen offset:768
    buffer_load_dwordx4 v[32:35], v2, s[44:47], s56 offen offset:1024
    s_add_u32 s56, s56, 5120
    buffer_load_dwordx4 v[36:39], v2, s[44:47], s56 offen offset:0
    buffer_load_dwordx4 v[40:43], v2, s[44:47], s56 offen offset:256
    buffer_load_dwordx4 v[44:47], v2, s[44:47], s56 offen offset:512
    buffer_load_dwordx4 v[48:51], v2, s[44:47], s56 offen offset:768
    buffer_load_dwordx4 v[52:55], v2, s[44:47], s56 offen offset:1024
    s_add_u32 s56, s56, 5120
    buffer_load_dwordx4 v[56:59], v2, s[44:47], s56 offen offset:0
    buffer_load_dwordx4 v[60:63], v2, s[44:47], s56 offen offset:256
    buffer_load_dwordx4 v[64:67], v2, s[44:47], s56 offen offset:512
    buffer_load_dwordx4 v[68:71], v2, s[44:47], s56 offen offset:768
    buffer_load_dwordx4 v[72:75], v2, s[44:47], s56 offen offset:1024
    s_add_u32 s56, s56, 5120
    buffer_load_dwordx4 v[76:79], v2, s[44:47], s56 offen offset:0
    buffer_load_dwordx4 v[80:83], v2, s[44:47], s56 offen offset:256
    buffer_load_dwordx4 v[84:87], v2, s[44:47], s56 offen offset:512
    buffer_load_dwordx4 v[88:91], v2, s[44:47], s56 offen offset:768
    buffer_load_dwordx4 v[92:95], v2, s[44:47], s56 offen offset:1024
    s_mov_b32 s44, s4
    s_mov_b32 s45, s5
    s_mov_b32 s46, 0x280000
    s_mov_b32 s47, 0x20000
    s_lshl_b32 s50, s69, 2
    s_add_u32 s50, s50, s3
    s_mul_i32 s56, s50, 20480
    v_lshrrev_b32 v2, 4, v1
    v_mul_u32_u24 v2, 1280, v2
    v_and_b32 v3, 15, v1
    v_lshl_add_u32 v2, v3, 4, v2
    buffer_load_dwordx4 v[96:99], v2, s[44:47], s56 offen offset:0
    buffer_load_dwordx4 v[100:103], v2, s[44:47], s56 offen offset:256
    buffer_load_dwordx4 v[104:107], v2, s[44:47], s56 offen offset:512
    buffer_load_dwordx4 v[108:111], v2, s[44:47], s56 offen offset:768
    buffer_load_dwordx4 v[112:115], v2, s[44:47], s56 offen offset:1024
    s_add_u32 s56, s56, 5120
    buffer_load_dwordx4 v[116:119], v2, s[44:47], s56 offen offset:0
    buffer_load_dwordx4 v[120:123], v2, s[44:47], s56 offen offset:256
    buffer_load_dwordx4 v[124:127], v2, s[44:47], s56 offen offset:512
    buffer_load_dwordx4 v[128:131], v2, s[44:47], s56 offen offset:768
    buffer_load_dwordx4 v[132:135], v2, s[44:47], s56 offen offset:1024
    s_add_u32 s56, s56, 5120
    buffer_load_dwordx4 v[136:139], v2, s[44:47], s56 offen offset:0
    buffer_load_dwordx4 v[140:143], v2, s[44:47], s56 offen offset:256
    buffer_load_dwordx4 v[144:147], v2, s[44:47], s56 offen offset:512
    buffer_load_dwordx4 v[148:151], v2, s[44:47], s56 offen offset:768
    buffer_load_dwordx4 v[152:155], v2, s[44:47], s56 offen offset:1024
    s_add_u32 s56, s56, 5120
    buffer_load_dwordx4 v[156:159], v2, s[44:47], s56 offen offset:0
    buffer_load_dwordx4 v[160:163], v2, s[44:47], s56 offen offset:256
    buffer_load_dwordx4 v[164:167], v2, s[44:47], s56 offen offset:512
    buffer_load_dwordx4 v[168:171], v2, s[44:47], s56 offen offset:768
    buffer_load_dwordx4 v[172:175], v2, s[44:47], s56 offen offset:1024
    s_mov_b32 s50, 0x3f803f80
    v_mov_b32 v180, 0
    v_mov_b32 v181, 0
    v_mov_b32 v182, 0
    v_mov_b32 v183, 0
    v_mov_b32 v184, 0
    v_mov_b32 v185, 0
    v_mov_b32 v186, 0
    v_mov_b32 v187, 0
    s_waitcnt vmcnt(39)
    v_dot2_f32_bf16 v180, v16, s50, v180
    v_dot2_f32_bf16 v184, v16, v16, v184
    v_dot2_f32_bf16 v180, v17, s50, v180
    v_dot2_f32_bf16 v184, v17, v17, v184
    v_dot2_f32_bf16 v180, v18, s50, v180
    v_dot2_f32_bf16 v184, v18, v18, v184
    v_dot2_f32_bf16 v180, v19, s50, v180
    v_dot2_f32_bf16 v184, v19, v19, v184
    s_waitcnt vmcnt(38)
    v_dot2_f32_bf16 v180, v20, s50, v180
    v_dot2_f32_bf16 v184, v20, v20, v184
    v_dot2_f32_bf16 v180, v21, s50, v180
    v_dot2_f32_bf16 v184, v21, v21, v184
    v_dot2_f32_bf16 v180, v22, s50, v180
    v_dot2_f32_bf16 v184, v22, v22, v184
    v_dot2_f32_bf16 v180, v23, s50, v180
    v_dot2_f32_bf16 v184, v23, v23, v184
    s_waitcnt vmcnt(37)
    v_dot2_f32_bf16 v180, v24, s50, v180
    v_dot2_f32_bf16 v184, v24, v24, v184
    v_dot2_f32_bf16 v180, v25, s50, v180
    v_dot2_f32_bf16 v184, v25, v25, v184
    v_dot2_f32_bf16 v180, v26, s50, v180
    v_dot2_f32_bf16 v184, v26, v26, v184
    v_dot2_f32_bf16 v180, v27, s50, v180
    v_dot2_f32_bf16 v184, v27, v27, v184
    s_waitcnt vmcnt(36)
    v_dot2_f32_bf16 v180, v28, s50, v180
    v_dot2_f32_bf16 v184, v28, v28, v184
    v_dot2_f32_bf16 v180, v29, s50, v180
    v_dot2_f32_bf16 v184, v29, v29, v184
    v_dot2_f32_bf16 v180, v30, s50, v180
    v_dot2_f32_bf16 v184, v30, v30, v184
    v_dot2_f32_bf16 v180, v31, s50, v180
    v_dot2_f32_bf16 v184, v31, v31, v184
    s_waitcnt vmcnt(35)
    v_dot2_f32_bf16 v180, v32, s50, v180
    v_dot2_f32_bf16 v184, v32, v32, v184
    v_dot2_f32_bf16 v180, v33, s50, v180
    v_dot2_f32_bf16 v184, v33, v33, v184
    v_dot2_f32_bf16 v180, v34, s50, v180
    v_dot2_f32_bf16 v184, v34, v34, v184
    v_dot2_f32_bf16 v180, v35, s50, v180
    v_dot2_f32_bf16 v184, v35, v35, v184
    s_waitcnt vmcnt(34)
    v_dot2_f32_bf16 v181, v36, s50, v181
    v_dot2_f32_bf16 v185, v36, v36, v185
    v_dot2_f32_bf16 v181, v37, s50, v181
    v_dot2_f32_bf16 v185, v37, v37, v185
    v_dot2_f32_bf16 v181, v38, s50, v181
    v_dot2_f32_bf16 v185, v38, v38, v185
    v_dot2_f32_bf16 v181, v39, s50, v181
    v_dot2_f32_bf16 v185, v39, v39, v185
    s_waitcnt vmcnt(33)
    v_dot2_f32_bf16 v181, v40, s50, v181
    v_dot2_f32_bf16 v185, v40, v40, v185
    v_dot2_f32_bf16 v181, v41, s50, v181
    v_dot2_f32_bf16 v185, v41, v41, v185
    v_dot2_f32_bf16 v181, v42, s50, v181
    v_dot2_f32_bf16 v185, v42, v42, v185
    v_dot2_f32_bf16 v181, v43, s50, v181
    v_dot2_f32_bf16 v185, v43, v43, v185
    s_waitcnt vmcnt(32)
    v_dot2_f32_bf16 v181, v44, s50, v181
    v_dot2_f32_bf16 v185, v44, v44, v185
    v_dot2_f32_bf16 v181, v45, s50, v181
    v_dot2_f32_bf16 v185, v45, v45, v185
    v_dot2_f32_bf16 v181, v46, s50, v181
    v_dot2_f32_bf16 v185, v46, v46, v185
    v_dot2_f32_bf16 v181, v47, s50, v181
    v_dot2_f32_bf16 v185, v47, v47, v185
    s_waitcnt vmcnt(31)
    v_dot2_f32_bf16 v181, v48, s50, v181
    v_dot2_f32_bf16 v185, v48, v48, v185
    v_dot2_f32_bf16 v181, v49, s50, v181
    v_dot2_f32_bf16 v185, v49, v49, v185
    v_dot2_f32_bf16 v181, v50, s50, v181
    v_dot2_f32_bf16 v185, v50, v50, v185
    v_dot2_f32_bf16 v181, v51, s50, v181
    v_dot2_f32_bf16 v185, v51, v51, v185
    s_waitcnt vmcnt(30)
    v_dot2_f32_bf16 v181, v52, s50, v181
    v_dot2_f32_bf16 v185, v52, v52, v185
    v_dot2_f32_bf16 v181, v53, s50, v181
    v_dot2_f32_bf16 v185, v53, v53, v185
    v_dot2_f32_bf16 v181, v54, s50, v181
    v_dot2_f32_bf16 v185, v54, v54, v185
    v_dot2_f32_bf16 v181, v55, s50, v181
    v_dot2_f32_bf16 v185, v55, v55, v185
    s_waitcnt vmcnt(29)
    v_dot2_f32_bf16 v182, v56, s50, v182
    v_dot2_f32_bf16 v186, v56, v56, v186
    v_dot2_f32_bf16 v182, v57, s50, v182
    v_dot2_f32_bf16 v186, v57, v57, v186
    v_dot2_f32_bf16 v182, v58, s50, v182
    v_dot2_f32_bf16 v186, v58, v58, v186
    v_dot2_f32_bf16 v182, v59, s50, v182
    v_dot2_f32_bf16 v186, v59, v59, v186
    s_waitcnt vmcnt(28)
    v_dot2_f32_bf16 v182, v60, s50, v182
    v_dot2_f32_bf16 v186, v60, v60, v186
    v_dot2_f32_bf16 v182, v61, s50, v182
    v_dot2_f32_bf16 v186, v61, v61, v186
    v_dot2_f32_bf16 v182, v62, s50, v182
    v_dot2_f32_bf16 v186, v62, v62, v186
    v_dot2_f32_bf16 v182, v63, s50, v182
    v_dot2_f32_bf16 v186, v63, v63, v186
    s_waitcnt vmcnt(27)
    v_dot2_f32_bf16 v182, v64, s50, v182
    v_dot2_f32_bf16 v186, v64, v64, v186
    v_dot2_f32_bf16 v182, v65, s50, v182
    v_dot2_f32_bf16 v186, v65, v65, v186
    v_dot2_f32_bf16 v182, v66, s50, v182
    v_dot2_f32_bf16 v186, v66, v66, v186
    v_dot2_f32_bf16 v182, v67, s50, v182
    v_dot2_f32_bf16 v186, v67, v67, v186
    s_waitcnt vmcnt(26)
    v_dot2_f32_bf16 v182, v68, s50, v182
    v_dot2_f32_bf16 v186, v68, v68, v186
    v_dot2_f32_bf16 v182, v69, s50, v182
    v_dot2_f32_bf16 v186, v69, v69, v186
    v_dot2_f32_bf16 v182, v70, s50, v182
    v_dot2_f32_bf16 v186, v70, v70, v186
    v_dot2_f32_bf16 v182, v71, s50, v182
    v_dot2_f32_bf16 v186, v71, v71, v186
    s_waitcnt vmcnt(25)
    v_dot2_f32_bf16 v182, v72, s50, v182
    v_dot2_f32_bf16 v186, v72, v72, v186
    v_dot2_f32_bf16 v182, v73, s50, v182
    v_dot2_f32_bf16 v186, v73, v73, v186
    v_dot2_f32_bf16 v182, v74, s50, v182
    v_dot2_f32_bf16 v186, v74, v74, v186
    v_dot2_f32_bf16 v182, v75, s50, v182
    v_dot2_f32_bf16 v186, v75, v75, v186
    s_waitcnt vmcnt(24)
    v_dot2_f32_bf16 v183, v76, s50, v183
    v_dot2_f32_bf16 v187, v76, v76, v187
    v_dot2_f32_bf16 v183, v77, s50, v183
    v_dot2_f32_bf16 v187, v77, v77, v187
    v_dot2_f32_bf16 v183, v78, s50, v183
    v_dot2_f32_bf16 v187, v78, v78, v187
    v_dot2_f32_bf16 v183, v79, s50, v183
    v_dot2_f32_bf16 v187, v79, v79, v187
    s_waitcnt vmcnt(23)
    v_dot2_f32_bf16 v183, v80, s50, v183
    v_dot2_f32_bf16 v187, v80, v80, v187
    v_dot2_f32_bf16 v183, v81, s50, v183
    v_dot2_f32_bf16 v187, v81, v81, v187
    v_dot2_f32_bf16 v183, v82, s50, v183
    v_dot2_f32_bf16 v187, v82, v82, v187
    v_dot2_f32_bf16 v183, v83, s50, v183
    v_dot2_f32_bf16 v187, v83, v83, v187
    s_waitcnt vmcnt(22)
    v_dot2_f32_bf16 v183, v84, s50, v183
    v_dot2_f32_bf16 v187, v84, v84, v187
    v_dot2_f32_bf16 v183, v85, s50, v183
    v_dot2_f32_bf16 v187, v85, v85, v187
    v_dot2_f32_bf16 v183, v86, s50, v183
    v_dot2_f32_bf16 v187, v86, v86, v187
    v_dot2_f32_bf16 v183, v87, s50, v183
    v_dot2_f32_bf16 v187, v87, v87, v187
    s_waitcnt vmcnt(21)
    v_dot2_f32_bf16 v183, v88, s50, v183
    v_dot2_f32_bf16 v187, v88, v88, v187
    v_dot2_f32_bf16 v183, v89, s50, v183
    v_dot2_f32_bf16 v187, v89, v89, v187
    v_dot2_f32_bf16 v183, v90, s50, v183
    v_dot2_f32_bf16 v187, v90, v90, v187
    v_dot2_f32_bf16 v183, v91, s50, v183
    v_dot2_f32_bf16 v187, v91, v91, v187
    s_waitcnt vmcnt(20)
    v_dot2_f32_bf16 v183, v92, s50, v183
    v_dot2_f32_bf16 v187, v92, v92, v187
    v_dot2_f32_bf16 v183, v93, s50, v183
    v_dot2_f32_bf16 v187, v93, v93, v187
    v_dot2_f32_bf16 v183, v94, s50, v183
    v_dot2_f32_bf16 v187, v94, v94, v187
    v_dot2_f32_bf16 v183, v95, s50, v183
    v_dot2_f32_bf16 v187, v95, v95, v187
    s_nop 2
    v_add_f32_dpp v180, v180, v180 row_ror:8 row_mask:0xf bank_mask:0xf
    v_add_f32_dpp v181, v181, v181 row_ror:8 row_mask:0xf bank_mask:0xf
    v_add_f32_dpp v182, v182, v182 row_ror:8 row_mask:0xf bank_mask:0xf
    v_add_f32_dpp v183, v183, v183 row_ror:8 row_mask:0xf bank_mask:0xf
    v_add_f32_dpp v184, v184, v184 row_ror:8 row_mask:0xf bank_mask:0xf
    v_add_f32_dpp v185, v185, v185 row_ror:8 row_mask:0xf bank_mask:0xf
    v_add_f32_dpp v186, v186, v186 row_ror:8 row_mask:0xf bank_mask:0xf
    v_add_f32_dpp v187, v187, v187 row_ror:8 row_mask:0xf bank_mask:0xf
    v_add_f32_dpp v180, v180, v180 row_ror:4 row_mask:0xf bank_mask:0xf
    v_add_f32_dpp v181, v181, v181 row_ror:4 row_mask:0xf bank_mask:0xf
    v_add_f32_dpp v182, v182, v182 row_ror:4 row_mask:0xf bank_mask:0xf
    v_add_f32_dpp v183, v183, v183 row_ror:4 row_mask:0xf bank_mask:0xf
    v_add_f32_dpp v184, v184, v184 row_ror:4 row_mask:0xf bank_mask:0xf
    v_add_f32_dpp v185, v185, v185 row_ror:4 row_mask:0xf bank_mask:0xf
    v_add_f32_dpp v186, v186, v186 row_ror:4 row_mask:0xf bank_mask:0xf
    v_add_f32_dpp v187, v187, v187 row_ror:4 row_mask:0xf bank_mask:0xf
    v_add_f32_dpp v180, v180, v180 row_ror:2 row_mask:0xf bank_mask:0xf
    v_add_f32_dpp v181, v181, v181 row_ror:2 row_mask:0xf bank_mask:0xf
    v_add_f32_dpp v182, v182, v182 row_ror:2 row_mask:0xf bank_mask:0xf
    v_add_f32_dpp v183, v183, v183 row_ror:2 row_mask:0xf bank_mask:0xf
    v_add_f32_dpp v184, v184, v184 row_ror:2 row_mask:0xf bank_mask:0xf
    v_add_f32_dpp v185, v185, v185 row_ror:2 row_mask:0xf bank_mask:0xf
    v_add_f32_dpp v186, v186, v186 row_ror:2 row_mask:0xf bank_mask:0xf
    v_add_f32_dpp v187, v187, v187 row_ror:2 row_mask:0xf bank_mask:0xf
    v_add_f32_dpp v180, v180, v180 row_ror:1 row_mask:0xf bank_mask:0xf
    v_add_f32_dpp v181, v181, v181 row_ror:1 row_mask:0xf bank_mask:0xf
    v_add_f32_dpp v182, v182, v182 row_ror:1 row_mask:0xf bank_mask:0xf
    v_add_f32_dpp v183, v183, v183 row_ror:1 row_mask:0xf bank_mask:0xf
    v_add_f32_dpp v184, v184, v184 row_ror:1 row_mask:0xf bank_mask:0xf
    v_add_f32_dpp v185, v185, v185 row_ror:1 row_mask:0xf bank_mask:0xf
    v_add_f32_dpp v186, v186, v186 row_ror:1 row_mask:0xf bank_mask:0xf
    v_add_f32_dpp v187, v187, v187 row_ror:1 row_mask:0xf bank_mask:0xf
    v_and_b32 v3, 15, v1
    v_cmp_eq_u32 vcc, 1, v3
    s_nop 1
    v_cndmask_b32 v180, v180, v181, vcc
    v_cndmask_b32 v184, v184, v185, vcc
    v_cmp_eq_u32 vcc, 2, v3
    s_nop 1
    v_cndmask_b32 v180, v180, v182, vcc
    v_cndmask_b32 v184, v184, v186, vcc
    v_cmp_eq_u32 vcc, 3, v3
    s_nop 1
    v_cndmask_b32 v180, v180, v183, vcc
    v_cndmask_b32 v184, v184, v187, vcc
    v_mul_f32 v180, 0x3acccccd, v180
    v_mul_f32 v190, v180, v180
    v_mov_b32 v188, 0x3acccccd
    v_fma_f32 v184, v184, v188, -v190
    v_max_f32 v184, 0, v184
    v_add_f32 v184, 0x3727c5ac, v184
    v_rsq_f32 v188, v184
    s_nop 0
    v_mul_f32_e64 v189, -v180, v188
    v_lshrrev_b32 v2, 4, v1
    v_lshl_add_u32 v2, v3, 2, v2
    v_lshlrev_b32 v2, 2, v2
    s_lshl_b32 s50, s77, 2
    s_add_u32 s50, s50, s3
    s_lshl_b32 s50, s50, 6
    s_add_u32 s50, s50, 23068672
    s_cmp_lt_u32 s77, 32
    s_cselect_b32 s50, s50, 268435456
    s_add_u32 s51, s50, 8192
    s_mov_b32 exec_lo, 0x000f000f
    s_mov_b32 exec_hi, 0x000f000f
    buffer_store_dword v188, v2, s[36:39], s50 offen sc1
    buffer_store_dword v189, v2, s[36:39], s51 offen sc1
    s_mov_b64 exec, -1
    s_mov_b32 s50, 0x3f803f80
    v_mov_b32 v180, 0
    v_mov_b32 v181, 0
    v_mov_b32 v182, 0
    v_mov_b32 v183, 0
    v_mov_b32 v184, 0
    v_mov_b32 v185, 0
    v_mov_b32 v186, 0
    v_mov_b32 v187, 0
    s_waitcnt vmcnt(21)
    v_dot2_f32_bf16 v180, v96, s50, v180
    v_dot2_f32_bf16 v184, v96, v96, v184
    v_dot2_f32_bf16 v180, v97, s50, v180
    v_dot2_f32_bf16 v184, v97, v97, v184
    v_dot2_f32_bf16 v180, v98, s50, v180
    v_dot2_f32_bf16 v184, v98, v98, v184
    v_dot2_f32_bf16 v180, v99, s50, v180
    v_dot2_f32_bf16 v184, v99, v99, v184
    s_waitcnt vmcnt(20)
    v_dot2_f32_bf16 v180, v100, s50, v180
    v_dot2_f32_bf16 v184, v100, v100, v184
    v_dot2_f32_bf16 v180, v101, s50, v180
    v_dot2_f32_bf16 v184, v101, v101, v184
    v_dot2_f32_bf16 v180, v102, s50, v180
    v_dot2_f32_bf16 v184, v102, v102, v184
    v_dot2_f32_bf16 v180, v103, s50, v180
    v_dot2_f32_bf16 v184, v103, v103, v184
    s_waitcnt vmcnt(19)
    v_dot2_f32_bf16 v180, v104, s50, v180
    v_dot2_f32_bf16 v184, v104, v104, v184
    v_dot2_f32_bf16 v180, v105, s50, v180
    v_dot2_f32_bf16 v184, v105, v105, v184
    v_dot2_f32_bf16 v180, v106, s50, v180
    v_dot2_f32_bf16 v184, v106, v106, v184
    v_dot2_f32_bf16 v180, v107, s50, v180
    v_dot2_f32_bf16 v184, v107, v107, v184
    s_waitcnt vmcnt(18)
    v_dot2_f32_bf16 v180, v108, s50, v180
    v_dot2_f32_bf16 v184, v108, v108, v184
    v_dot2_f32_bf16 v180, v109, s50, v180
    v_dot2_f32_bf16 v184, v109, v109, v184
    v_dot2_f32_bf16 v180, v110, s50, v180
    v_dot2_f32_bf16 v184, v110, v110, v184
    v_dot2_f32_bf16 v180, v111, s50, v180
    v_dot2_f32_bf16 v184, v111, v111, v184
    s_waitcnt vmcnt(17)
    v_dot2_f32_bf16 v180, v112, s50, v180
    v_dot2_f32_bf16 v184, v112, v112, v184
    v_dot2_f32_bf16 v180, v113, s50, v180
    v_dot2_f32_bf16 v184, v113, v113, v184
    v_dot2_f32_bf16 v180, v114, s50, v180
    v_dot2_f32_bf16 v184, v114, v114, v184
    v_dot2_f32_bf16 v180, v115, s50, v180
    v_dot2_f32_bf16 v184, v115, v115, v184
    s_waitcnt vmcnt(16)
    v_dot2_f32_bf16 v181, v116, s50, v181
    v_dot2_f32_bf16 v185, v116, v116, v185
    v_dot2_f32_bf16 v181, v117, s50, v181
    v_dot2_f32_bf16 v185, v117, v117, v185
    v_dot2_f32_bf16 v181, v118, s50, v181
    v_dot2_f32_bf16 v185, v118, v118, v185
    v_dot2_f32_bf16 v181, v119, s50, v181
    v_dot2_f32_bf16 v185, v119, v119, v185
    s_waitcnt vmcnt(15)
    v_dot2_f32_bf16 v181, v120, s50, v181
    v_dot2_f32_bf16 v185, v120, v120, v185
    v_dot2_f32_bf16 v181, v121, s50, v181
    v_dot2_f32_bf16 v185, v121, v121, v185
    v_dot2_f32_bf16 v181, v122, s50, v181
    v_dot2_f32_bf16 v185, v122, v122, v185
    v_dot2_f32_bf16 v181, v123, s50, v181
    v_dot2_f32_bf16 v185, v123, v123, v185
    s_waitcnt vmcnt(14)
    v_dot2_f32_bf16 v181, v124, s50, v181
    v_dot2_f32_bf16 v185, v124, v124, v185
    v_dot2_f32_bf16 v181, v125, s50, v181
    v_dot2_f32_bf16 v185, v125, v125, v185
    v_dot2_f32_bf16 v181, v126, s50, v181
    v_dot2_f32_bf16 v185, v126, v126, v185
    v_dot2_f32_bf16 v181, v127, s50, v181
    v_dot2_f32_bf16 v185, v127, v127, v185
    s_waitcnt vmcnt(13)
    v_dot2_f32_bf16 v181, v128, s50, v181
    v_dot2_f32_bf16 v185, v128, v128, v185
    v_dot2_f32_bf16 v181, v129, s50, v181
    v_dot2_f32_bf16 v185, v129, v129, v185
    v_dot2_f32_bf16 v181, v130, s50, v181
    v_dot2_f32_bf16 v185, v130, v130, v185
    v_dot2_f32_bf16 v181, v131, s50, v181
    v_dot2_f32_bf16 v185, v131, v131, v185
    s_waitcnt vmcnt(12)
    v_dot2_f32_bf16 v181, v132, s50, v181
    v_dot2_f32_bf16 v185, v132, v132, v185
    v_dot2_f32_bf16 v181, v133, s50, v181
    v_dot2_f32_bf16 v185, v133, v133, v185
    v_dot2_f32_bf16 v181, v134, s50, v181
    v_dot2_f32_bf16 v185, v134, v134, v185
    v_dot2_f32_bf16 v181, v135, s50, v181
    v_dot2_f32_bf16 v185, v135, v135, v185
    s_waitcnt vmcnt(11)
    v_dot2_f32_bf16 v182, v136, s50, v182
    v_dot2_f32_bf16 v186, v136, v136, v186
    v_dot2_f32_bf16 v182, v137, s50, v182
    v_dot2_f32_bf16 v186, v137, v137, v186
    v_dot2_f32_bf16 v182, v138, s50, v182
    v_dot2_f32_bf16 v186, v138, v138, v186
    v_dot2_f32_bf16 v182, v139, s50, v182
    v_dot2_f32_bf16 v186, v139, v139, v186
    s_waitcnt vmcnt(10)
    v_dot2_f32_bf16 v182, v140, s50, v182
    v_dot2_f32_bf16 v186, v140, v140, v186
    v_dot2_f32_bf16 v182, v141, s50, v182
    v_dot2_f32_bf16 v186, v141, v141, v186
    v_dot2_f32_bf16 v182, v142, s50, v182
    v_dot2_f32_bf16 v186, v142, v142, v186
    v_dot2_f32_bf16 v182, v143, s50, v182
    v_dot2_f32_bf16 v186, v143, v143, v186
    s_waitcnt vmcnt(9)
    v_dot2_f32_bf16 v182, v144, s50, v182
    v_dot2_f32_bf16 v186, v144, v144, v186
    v_dot2_f32_bf16 v182, v145, s50, v182
    v_dot2_f32_bf16 v186, v145, v145, v186
    v_dot2_f32_bf16 v182, v146, s50, v182
    v_dot2_f32_bf16 v186, v146, v146, v186
    v_dot2_f32_bf16 v182, v147, s50, v182
    v_dot2_f32_bf16 v186, v147, v147, v186
    s_waitcnt vmcnt(8)
    v_dot2_f32_bf16 v182, v148, s50, v182
    v_dot2_f32_bf16 v186, v148, v148, v186
    v_dot2_f32_bf16 v182, v149, s50, v182
    v_dot2_f32_bf16 v186, v149, v149, v186
    v_dot2_f32_bf16 v182, v150, s50, v182
    v_dot2_f32_bf16 v186, v150, v150, v186
    v_dot2_f32_bf16 v182, v151, s50, v182
    v_dot2_f32_bf16 v186, v151, v151, v186
    s_waitcnt vmcnt(7)
    v_dot2_f32_bf16 v182, v152, s50, v182
    v_dot2_f32_bf16 v186, v152, v152, v186
    v_dot2_f32_bf16 v182, v153, s50, v182
    v_dot2_f32_bf16 v186, v153, v153, v186
    v_dot2_f32_bf16 v182, v154, s50, v182
    v_dot2_f32_bf16 v186, v154, v154, v186
    v_dot2_f32_bf16 v182, v155, s50, v182
    v_dot2_f32_bf16 v186, v155, v155, v186
    s_waitcnt vmcnt(6)
    v_dot2_f32_bf16 v183, v156, s50, v183
    v_dot2_f32_bf16 v187, v156, v156, v187
    v_dot2_f32_bf16 v183, v157, s50, v183
    v_dot2_f32_bf16 v187, v157, v157, v187
    v_dot2_f32_bf16 v183, v158, s50, v183
    v_dot2_f32_bf16 v187, v158, v158, v187
    v_dot2_f32_bf16 v183, v159, s50, v183
    v_dot2_f32_bf16 v187, v159, v159, v187
    s_waitcnt vmcnt(5)
    v_dot2_f32_bf16 v183, v160, s50, v183
    v_dot2_f32_bf16 v187, v160, v160, v187
    v_dot2_f32_bf16 v183, v161, s50, v183
    v_dot2_f32_bf16 v187, v161, v161, v187
    v_dot2_f32_bf16 v183, v162, s50, v183
    v_dot2_f32_bf16 v187, v162, v162, v187
    v_dot2_f32_bf16 v183, v163, s50, v183
    v_dot2_f32_bf16 v187, v163, v163, v187
    s_waitcnt vmcnt(4)
    v_dot2_f32_bf16 v183, v164, s50, v183
    v_dot2_f32_bf16 v187, v164, v164, v187
    v_dot2_f32_bf16 v183, v165, s50, v183
    v_dot2_f32_bf16 v187, v165, v165, v187
    v_dot2_f32_bf16 v183, v166, s50, v183
    v_dot2_f32_bf16 v187, v166, v166, v187
    v_dot2_f32_bf16 v183, v167, s50, v183
    v_dot2_f32_bf16 v187, v167, v167, v187
    s_waitcnt vmcnt(3)
    v_dot2_f32_bf16 v183, v168, s50, v183
    v_dot2_f32_bf16 v187, v168, v168, v187
    v_dot2_f32_bf16 v183, v169, s50, v183
    v_dot2_f32_bf16 v187, v169, v169, v187
    v_dot2_f32_bf16 v183, v170, s50, v183
    v_dot2_f32_bf16 v187, v170, v170, v187
    v_dot2_f32_bf16 v183, v171, s50, v183
    v_dot2_f32_bf16 v187, v171, v171, v187
    s_waitcnt vmcnt(2)
    v_dot2_f32_bf16 v183, v172, s50, v183
    v_dot2_f32_bf16 v187, v172, v172, v187
    v_dot2_f32_bf16 v183, v173, s50, v183
    v_dot2_f32_bf16 v187, v173, v173, v187
    v_dot2_f32_bf16 v183, v174, s50, v183
    v_dot2_f32_bf16 v187, v174, v174, v187
    v_dot2_f32_bf16 v183, v175, s50, v183
    v_dot2_f32_bf16 v187, v175, v175, v187
    s_nop 2
    v_add_f32_dpp v180, v180, v180 row_ror:8 row_mask:0xf bank_mask:0xf
    v_add_f32_dpp v181, v181, v181 row_ror:8 row_mask:0xf bank_mask:0xf
    v_add_f32_dpp v182, v182, v182 row_ror:8 row_mask:0xf bank_mask:0xf
    v_add_f32_dpp v183, v183, v183 row_ror:8 row_mask:0xf bank_mask:0xf
    v_add_f32_dpp v184, v184, v184 row_ror:8 row_mask:0xf bank_mask:0xf
    v_add_f32_dpp v185, v185, v185 row_ror:8 row_mask:0xf bank_mask:0xf
    v_add_f32_dpp v186, v186, v186 row_ror:8 row_mask:0xf bank_mask:0xf
    v_add_f32_dpp v187, v187, v187 row_ror:8 row_mask:0xf bank_mask:0xf
    v_add_f32_dpp v180, v180, v180 row_ror:4 row_mask:0xf bank_mask:0xf
    v_add_f32_dpp v181, v181, v181 row_ror:4 row_mask:0xf bank_mask:0xf
    v_add_f32_dpp v182, v182, v182 row_ror:4 row_mask:0xf bank_mask:0xf
    v_add_f32_dpp v183, v183, v183 row_ror:4 row_mask:0xf bank_mask:0xf
    v_add_f32_dpp v184, v184, v184 row_ror:4 row_mask:0xf bank_mask:0xf
    v_add_f32_dpp v185, v185, v185 row_ror:4 row_mask:0xf bank_mask:0xf
    v_add_f32_dpp v186, v186, v186 row_ror:4 row_mask:0xf bank_mask:0xf
    v_add_f32_dpp v187, v187, v187 row_ror:4 row_mask:0xf bank_mask:0xf
    v_add_f32_dpp v180, v180, v180 row_ror:2 row_mask:0xf bank_mask:0xf
    v_add_f32_dpp v181, v181, v181 row_ror:2 row_mask:0xf bank_mask:0xf
    v_add_f32_dpp v182, v182, v182 row_ror:2 row_mask:0xf bank_mask:0xf
    v_add_f32_dpp v183, v183, v183 row_ror:2 row_mask:0xf bank_mask:0xf
    v_add_f32_dpp v184, v184, v184 row_ror:2 row_mask:0xf bank_mask:0xf
    v_add_f32_dpp v185, v185, v185 row_ror:2 row_mask:0xf bank_mask:0xf
    v_add_f32_dpp v186, v186, v186 row_ror:2 row_mask:0xf bank_mask:0xf
    v_add_f32_dpp v187, v187, v187 row_ror:2 row_mask:0xf bank_mask:0xf
    v_add_f32_dpp v180, v180, v180 row_ror:1 row_mask:0xf bank_mask:0xf
    v_add_f32_dpp v181, v181, v181 row_ror:1 row_mask:0xf bank_mask:0xf
    v_add_f32_dpp v182, v182, v182 row_ror:1 row_mask:0xf bank_mask:0xf
    v_add_f32_dpp v183, v183, v183 row_ror:1 row_mask:0xf bank_mask:0xf
    v_add_f32_dpp v184, v184, v184 row_ror:1 row_mask:0xf bank_mask:0xf
    v_add_f32_dpp v185, v185, v185 row_ror:1 row_mask:0xf bank_mask:0xf
    v_add_f32_dpp v186, v186, v186 row_ror:1 row_mask:0xf bank_mask:0xf
    v_add_f32_dpp v187, v187, v187 row_ror:1 row_mask:0xf bank_mask:0xf
    v_and_b32 v3, 15, v1
    v_cmp_eq_u32 vcc, 1, v3
    s_nop 1
    v_cndmask_b32 v180, v180, v181, vcc
    v_cndmask_b32 v184, v184, v185, vcc
    v_cmp_eq_u32 vcc, 2, v3
    s_nop 1
    v_cndmask_b32 v180, v180, v182, vcc
    v_cndmask_b32 v184, v184, v186, vcc
    v_cmp_eq_u32 vcc, 3, v3
    s_nop 1
    v_cndmask_b32 v180, v180, v183, vcc
    v_cndmask_b32 v184, v184, v187, vcc
    v_mul_f32 v180, 0x3acccccd, v180
    v_mul_f32 v190, v180, v180
    v_mov_b32 v188, 0x3acccccd
    v_fma_f32 v184, v184, v188, -v190
    v_max_f32 v184, 0, v184
    v_add_f32 v184, 0x3727c5ac, v184
    v_rsq_f32 v188, v184
    s_nop 0
    v_mul_f32_e64 v189, -v180, v188
    v_lshrrev_b32 v2, 4, v1
    v_lshl_add_u32 v2, v3, 2, v2
    v_lshlrev_b32 v2, 2, v2
    s_lshl_b32 s50, s69, 2
    s_add_u32 s50, s50, s3
    s_lshl_b32 s50, s50, 6
    s_add_u32 s50, s50, 23068672
    s_cmp_lt_u32 s69, 32
    s_cselect_b32 s50, s50, 268435456
    s_add_u32 s51, s50, 8192
    s_mov_b32 exec_lo, 0x000f000f
    s_mov_b32 exec_hi, 0x000f000f
    buffer_store_dword v188, v2, s[36:39], s50 offen sc1
    buffer_store_dword v189, v2, s[36:39], s51 offen sc1
    s_mov_b64 exec, -1
    s_waitcnt vmcnt(0) lgkmcnt(0)
    s_barrier
    v_readfirstlane_b32 s48, v246
    s_mul_i32 s48, s48, 0x9E3779B1
    s_add_u32 s48, s48, 0x7F4A7C15
    s_cmp_eq_u32 s3, 0
    s_cbranch_scc0 L_wf15
    s_lshl_b32 s54, s69, 7
    s_add_u32 s54, s54, 23220224
    v_mov_b32 v2, 0
    v_mov_b32 v3, s48
    s_mov_b64 exec, 1
    buffer_store_dword v3, v2, s[36:39], s54 offen sc1
    s_mov_b64 exec, -1
L_wf15:
    s_cmp_eq_u32 s3, 0
    s_cbranch_scc0 L_wf16
    s_lshl_b32 s54, s77, 7
    s_add_u32 s54, s54, 23220224
    v_mov_b32 v2, 0
    v_mov_b32 v3, s48
    s_mov_b64 exec, 1
    buffer_store_dword v3, v2, s[36:39], s54 offen sc1
    s_mov_b64 exec, -1
L_wf16:
L_p_w:
    s_mov_b32 s56, s22
    s_mov_b32 s57, s23
    s_mov_b32 s58, 0x1e0000
    s_mov_b32 s59, 0x20000
    s_and_b32 s50, s3, 1
    s_mul_i32 s61, s50, 3104
    s_mul_i32 s50, s50, 12288
    s_mul_i32 s64, s73, 192
    s_add_u32 s64, s64, s50
    s_mul_i32 s50, s34, 98304
    s_add_u32 s64, s64, s50
    s_cmp_ge_u32 s3, 2
    s_cselect_b32 s40, s20, s18
    s_cselect_b32 s41, s21, s19
    s_cselect_b32 s50, 6224, 0
    s_add_u32 s61, s61, s50
    s_mov_b32 s42, 1966080
    s_mov_b32 s43, 0x20000
    v_add_u32 v2, 0, v1
    v_mul_u32_u24 v3, 171, v2
    v_lshrrev_b32 v3, 11, v3
    v_mul_u32_u24 v4, 12, v3
    v_sub_u32 v4, v2, v4
    v_and_b32 v2, 12, v3
    v_add_u32 v3, v3, v2
    v_mul_u32_u24 v3, 3072, v3
    v_lshl_add_u32 v230, v4, 4, v3
    v_add_u32 v2, 64, v1
    v_mul_u32_u24 v3, 171, v2
    v_lshrrev_b32 v3, 11, v3
    v_mul_u32_u24 v4, 12, v3
    v_sub_u32 v4, v2, v4
    v_and_b32 v2, 12, v3
    v_add_u32 v3, v3, v2
    v_mul_u32_u24 v3, 3072, v3
    v_lshl_add_u32 v231, v4, 4, v3
    v_subrev_u32 v231, 1024, v231
    v_add_u32 v2, 128, v1
    v_mul_u32_u24 v3, 171, v2
    v_lshrrev_b32 v3, 11, v3
    v_mul_u32_u24 v4, 12, v3
    v_sub_u32 v4, v2, v4
    v_and_b32 v2, 12, v3
    v_add_u32 v3, v3, v2
    v_mul_u32_u24 v3, 3072, v3
    v_lshl_add_u32 v232, v4, 4, v3
    v_subrev_u32 v232, 2048, v232
    s_mul_i32 s50, s3, 48
    v_lshrrev_b32 v2, 5, v1
    v_bfe_u32 v3, v1, 2, 2
    v_lshl_add_u32 v2, v2, 2, v3
    v_mul_u32_u24 v2, 192, v2
    v_bfe_u32 v3, v1, 4, 1
    v_mul_u32_u24 v3, 3104, v3
    v_add3_u32 v2, v2, v3, s50
    v_and_b32 v3, 3, v1
    v_lshl_add_u32 v233, v3, 3, v2
    v_and_b32 v3, 1, v1
    v_lshl_add_u32 v2, v3, 3, v2
    v_bfe_u32 v3, v1, 1, 1
    v_mul_u32_u24 v3, 6224, v3
    v_add3_u32 v234, v2, v3, 32
    v_add_u32 v233, 8192, v233
    v_add_u32 v234, 8192, v234
    v_add_u32 v238, 49664, v233
    v_add_u32 v239, 49664, v234
    s_add_u32 m0, s61, 8192
    s_nop 0
    buffer_load_dwordx4 v230, s[40:43], s64 offen offset:0 lds
    buffer_load_dwordx4 v231, s[40:43], s64 offen offset:1024 lds
    buffer_load_dwordx4 v232, s[40:43], s64 offen offset:2048 lds
    s_add_u32 s64, s64, 98304
    s_sub_u32 s35, s64, 1966080
    s_min_u32 s64, s64, s35
    s_add_u32 m0, s61, 20608
    s_nop 0
    buffer_load_dwordx4 v230, s[40:43], s64 offen offset:0 lds
    buffer_load_dwordx4 v231, s[40:43], s64 offen offset:1024 lds
    buffer_load_dwordx4 v232, s[40:43], s64 offen offset:2048 lds
    s_add_u32 s64, s64, 98304
    s_sub_u32 s35, s64, 1966080
    s_min_u32 s64, s64, s35
    s_add_u32 m0, s61, 33024
    s_nop 0
    buffer_load_dwordx4 v230, s[40:43], s64 offen offset:0 lds
    buffer_load_dwordx4 v231, s[40:43], s64 offen offset:1024 lds
    buffer_load_dwordx4 v232, s[40:43], s64 offen offset:2048 lds
    s_add_u32 s64, s64, 98304
    s_sub_u32 s35, s64, 1966080
    s_min_u32 s64, s64, s35
    s_add_u32 m0, s61, 45440
    s_nop 0
    buffer_load_dwordx4 v230, s[40:43], s64 offen offset:0 lds
    buffer_load_dwordx4 v231, s[40:43], s64 offen offset:1024 lds
    buffer_load_dwordx4 v232, s[40:43], s64 offen offset:2048 lds
    s_add_u32 s64, s64, 98304
    s_sub_u32 s35, s64, 1966080
    s_min_u32 s64, s64, s35
    s_add_u32 m0, s61, 57856
    s_nop 0
    buffer_load_dwordx4 v230, s[40:43], s64 offen offset:0 lds
    buffer_load_dwordx4 v231, s[40:43], s64 offen offset:1024 lds
    buffer_load_dwordx4 v232, s[40:43], s64 offen offset:2048 lds
    s_add_u32 s64, s64, 98304
    s_sub_u32 s35, s64, 1966080
    s_min_u32 s64, s64, s35
    s_add_u32 m0, s61, 70272
    s_nop 0
    buffer_load_dwordx4 v230, s[40:43], s64 offen offset:0 lds
    buffer_load_dwordx4 v231, s[40:43], s64 offen offset:1024 lds
    buffer_load_dwordx4 v232, s[40:43], s64 offen offset:2048 lds
    s_add_u32 s64, s64, 98304
    s_sub_u32 s35, s64, 1966080
    s_min_u32 s64, s64, s35
    s_movk_i32 s4, 4096
    s_movk_i32 s5, 8192
    s_lshl_b32 s6, s72, 10
    s_add_u32 s6, s6, 23101440
    s_lshl_b32 s7, s73, 6
    s_add_u32 s7, s7, s6
    s_mul_i32 s8, s72, 768
    s_mul_i32 s50, s73, 12
    s_add_u32 s8, s8, s50
    s_mul_i32 s50, s3, 3
    s_add_u32 s8, s8, s50
    s_lshl_b32 s8, s8, 8
    s_add_u32 s8, s8, 16777216
    s_lshl_b32 s9, s73, 2
    s_add_u32 s9, s9, s3
    s_mul_i32 s9, s9, 384
    s_add_u32 s9, s9, 23527424
    s_mul_i32 s62, s3, 32768
    s_lshl_b32 s50, s72, 7
    s_add_u32 s62, s62, s50
    s_mul_i32 s50, s34, 131072
    s_add_u32 s10, s62, s50
    s_lshl_b32 s63, s3, 10
    s_add_u32 s11, s10, 131072
    s_sub_u32 s35, s11, 2621440
    s_min_u32 s11, s11, s35
    s_add_u32 s12, s11, 131072
    s_sub_u32 s35, s12, 2621440
    s_min_u32 s12, s12, s35
    s_add_u32 s13, s12, 131072
    s_sub_u32 s35, s13, 2621440
    s_min_u32 s13, s13, s35
    s_add_u32 s14, s13, 131072
    s_sub_u32 s35, s14, 2621440
    s_min_u32 s14, s14, s35
    s_add_u32 s15, s14, 131072
    s_sub_u32 s35, s15, 2621440
    s_min_u32 s15, s15, s35
    s_add_u32 s18, s15, 131072
    s_sub_u32 s35, s18, 2621440
    s_min_u32 s18, s18, s35
    s_add_u32 s19, s18, 131072
    s_sub_u32 s35, s19, 2621440
    s_min_u32 s19, s19, s35
    s_add_u32 s20, s19, 131072
    s_sub_u32 s35, s20, 2621440
    s_min_u32 s20, s20, s35
    s_add_u32 s21, s20, 131072
    s_sub_u32 s35, s21, 2621440
    s_min_u32 s21, s21, s35
    s_add_u32 s22, s21, 131072
    s_sub_u32 s35, s22, 2621440
    s_min_u32 s22, s22, s35
    s_add_u32 s23, s22, 131072
    s_sub_u32 s35, s23, 2621440
    s_min_u32 s23, s23, s35
    s_add_u32 s24, s23, 131072
    s_sub_u32 s35, s24, 2621440
    s_min_u32 s24, s24, s35
    s_add_u32 s25, s24, 131072
    s_sub_u32 s35, s25, 2621440
    s_min_u32 s25, s25, s35
    s_add_u32 s26, s25, 131072
    s_sub_u32 s35, s26, 2621440
    s_min_u32 s26, s26, s35
    s_add_u32 s27, s26, 131072
    s_sub_u32 s35, s27, 2621440
    s_min_u32 s27, s27, s35
    s_add_u32 s44, s27, 131072
    s_sub_u32 s35, s44, 2621440
    s_min_u32 s44, s44, s35
    s_add_u32 s45, s44, 131072
    s_sub_u32 s35, s45, 2621440
    s_min_u32 s45, s45, s35
    s_add_u32 s46, s45, 131072
    s_sub_u32 s35, s46, 2621440
    s_min_u32 s46, s46, s35
    s_add_u32 s47, s46, 131072
    s_sub_u32 s35, s47, 2621440
    s_min_u32 s47, s47, s35
    v_lshrrev_b32 v2, 3, v1
    v_bfe_u32 v3, v1, 4, 2
    v_lshlrev_b32 v3, 1, v3
    v_xor_b32 v3, v3, v1
    v_and_b32 v3, 7, v3
    v_mul_u32_u24 v2, 4096, v2
    v_lshl_add_u32 v172, v3, 4, v2
    v_add_u32 v172, 0, v172
    v_lshrrev_b32 v2, 2, v1
    v_lshlrev_b32 v2, 7, v2
    v_and_b32 v3, 3, v1
    v_lshl_add_u32 v2, v3, 3, v2
    v_bfe_u32 v3, v1, 3, 2
    v_xor_b32 v168, 0, v3
    v_lshl_add_u32 v168, v168, 5, v2
    v_xor_b32 v169, 1, v3
    v_lshl_add_u32 v169, v169, 5, v2
    v_xor_b32 v170, 2, v3
    v_lshl_add_u32 v170, v170, 5, v2
    v_xor_b32 v171, 3, v3
    v_lshl_add_u32 v171, v171, 5, v2
    v_and_b32 v175, 15, v1
    v_lshlrev_b32 v175, 4, v175
    v_bfe_u32 v2, v1, 4, 1
    v_lshrrev_b32 v3, 5, v1
    v_mul_u32_u24 v173, 49152, v2
    v_lshl_add_u32 v173, v3, 8, v173
    v_add_u32 v173, v173, v175
    v_lshl_add_u32 v2, v2, 1, v3
    v_mul_u32_u24 v174, 49152, v2
    v_add_u32 v174, v174, v175
    v_bfe_u32 v2, v0, 1, 2
    v_lshlrev_b32 v2, 1, v2
    s_lshr_b32 s50, s73, 1
    v_xor_b32 v2, s50, v2
    v_lshlrev_b32 v2, 4, v2
    v_lshl_add_u32 v216, v0, 7, v2
    s_and_b32 s50, s73, 1
    s_lshl_b32 s50, s50, 3
    v_add_u32 v216, s50, v216
    v_add_u32 v217, 0x8000, v216
    v_add_u32 v218, 0x10000, v216
    v_cmp_gt_u32 vcc, 128, v0
    s_nop 1
    v_cndmask_b32 v218, v217, v218, vcc
    v_lshrrev_b32 v2, 1, v1
    v_lshlrev_b32 v2, 10, v2
    v_and_b32 v3, 1, v1
    v_lshl_add_u32 v219, v3, 7, v2
    s_lshl_b32 s50, s3, 8
    s_add_u32 s50, s50, 46080
    v_add_u32 v219, s50, v219
    s_add_u32 s50, s50, 19456
    v_mov_b32 v2, s50
    v_cmp_lt_u32 vcc, 39, v1
    s_nop 1
    v_cndmask_b32 v219, v219, v2, vcc
    s_mov_b32 s17, 23199744
    s_lshl_b32 s62, s75, 2
    s_add_u32 s62, s62, s3
    s_mul_i32 s62, s62, 61440
    s_add_u32 s62, s62, 14417920
    s_waitcnt vmcnt(12)
    s_barrier
    s_cmp_eq_u32 s3, 0
    s_cbranch_scc0 L_wf17
    s_lshl_b32 s54, s77, 7
    s_add_u32 s54, s54, 23220224
    v_mov_b32 v2, 0
    v_mov_b32 v3, s48
    s_mov_b64 exec, 1
    buffer_store_dword v3, v2, s[36:39], s54 offen sc1
    s_mov_b64 exec, -1
L_wf17:
    s_cmp_eq_u32 s3, 0
    s_cbranch_scc0 L_wf18
    s_lshl_b32 s54, s71, 7
    s_add_u32 s54, s54, 23354368
    v_mov_b32 v2, 0
    v_mov_b32 v3, s48
    s_mov_b64 exec, 1
    buffer_store_dword v3, v2, s[36:39], s54 offen sc1
    s_mov_b64 exec, -1
L_wf18:
    ds_read_b64_tr_b16 a[0:1], v233 offset:0
    ds_read_b64_tr_b16 a[2:3], v233 offset:1536
    ds_read_b64_tr_b16 a[4:5], v233 offset:6224
    ds_read_b64_tr_b16 a[6:7], v233 offset:7760
    ds_read_b64_tr_b16 a[8:9], v234 offset:0
    ds_read_b64_tr_b16 a[10:11], v234 offset:1536
    ds_read_b64_tr_b16 a[12:13], v233 offset:12416
    ds_read_b64_tr_b16 a[14:15], v233 offset:13952
    ds_read_b64_tr_b16 a[16:17], v233 offset:18640
    ds_read_b64_tr_b16 a[18:19], v233 offset:20176
    ds_read_b64_tr_b16 a[20:21], v234 offset:12416
    ds_read_b64_tr_b16 a[22:23], v234 offset:13952
    s_add_u32 m0, s61, 82688
    s_nop 0
    buffer_load_dwordx4 v230, s[40:43], s64 offen offset:0 lds
    buffer_load_dwordx4 v231, s[40:43], s64 offen offset:1024 lds
    buffer_load_dwordx4 v232, s[40:43], s64 offen offset:2048 lds
    s_add_u32 s64, s64, 98304
    s_sub_u32 s35, s64, 1966080
    s_min_u32 s64, s64, s35
    s_add_u32 m0, s61, 95104
    s_nop 0
    buffer_load_dwordx4 v230, s[40:43], s64 offen offset:0 lds
    buffer_load_dwordx4 v231, s[40:43], s64 offen offset:1024 lds
    buffer_load_dwordx4 v232, s[40:43], s64 offen offset:2048 lds
    s_add_u32 s64, s64, 98304
    s_sub_u32 s35, s64, 1966080
    s_min_u32 s64, s64, s35
    s_waitcnt vmcnt(12)
    s_waitcnt lgkmcnt(0)
    s_barrier
    ds_read_b64_tr_b16 a[24:25], v233 offset:24832
    ds_read_b64_tr_b16 a[26:27], v233 offset:26368
    ds_read_b64_tr_b16 a[28:29], v233 offset:31056
    ds_read_b64_tr_b16 a[30:31], v233 offset:32592
    ds_read_b64_tr_b16 a[32:33], v234 offset:24832
    ds_read_b64_tr_b16 a[34:35], v234 offset:26368
    ds_read_b64_tr_b16 a[36:37], v233 offset:37248
    ds_read_b64_tr_b16 a[38:39], v233 offset:38784
    ds_read_b64_tr_b16 a[40:41], v233 offset:43472
    ds_read_b64_tr_b16 a[42:43], v233 offset:45008
    ds_read_b64_tr_b16 a[44:45], v234 offset:37248
    ds_read_b64_tr_b16 a[46:47], v234 offset:38784
    s_add_u32 m0, s61, 8192
    s_nop 0
    buffer_load_dwordx4 v230, s[40:43], s64 offen offset:0 lds
    buffer_load_dwordx4 v231, s[40:43], s64 offen offset:1024 lds
    buffer_load_dwordx4 v232, s[40:43], s64 offen offset:2048 lds
    s_add_u32 s64, s64, 98304
    s_sub_u32 s35, s64, 1966080
    s_min_u32 s64, s64, s35
    s_add_u32 m0, s61, 20608
    s_nop 0
    buffer_load_dwordx4 v230, s[40:43], s64 offen offset:0 lds
    buffer_load_dwordx4 v231, s[40:43], s64 offen offset:1024 lds
    buffer_load_dwordx4 v232, s[40:43], s64 offen offset:2048 lds
    s_add_u32 s64, s64, 98304
    s_sub_u32 s35, s64, 1966080
    s_min_u32 s64, s64, s35
    s_waitcnt vmcnt(12)
    s_waitcnt lgkmcnt(0)
    s_barrier
    ds_read_b64_tr_b16 a[48:49], v238 offset:0
    ds_read_b64_tr_b16 a[50:51], v238 offset:1536
    ds_read_b64_tr_b16 a[52:53], v238 offset:6224
    ds_read_b64_tr_b16 a[54:55], v238 offset:7760
    ds_read_b64_tr_b16 a[56:57], v239 offset:0
    ds_read_b64_tr_b16 a[58:59], v239 offset:1536
    ds_read_b64_tr_b16 a[60:61], v238 offset:12416
    ds_read_b64_tr_b16 a[62:63], v238 offset:13952
    ds_read_b64_tr_b16 a[64:65], v238 offset:18640
    ds_read_b64_tr_b16 a[66:67], v238 offset:20176
    ds_read_b64_tr_b16 a[68:69], v239 offset:12416
    ds_read_b64_tr_b16 a[70:71], v239 offset:13952
    s_add_u32 m0, s61, 33024
    s_nop 0
    buffer_load_dwordx4 v230, s[40:43], s64 offen offset:0 lds
    buffer_load_dwordx4 v231, s[40:43], s64 offen offset:1024 lds
    buffer_load_dwordx4 v232, s[40:43], s64 offen offset:2048 lds
    s_add_u32 s64, s64, 98304
    s_sub_u32 s35, s64, 1966080
    s_min_u32 s64, s64, s35
    s_add_u32 m0, s61, 45440
    s_nop 0
    buffer_load_dwordx4 v230, s[40:43], s64 offen offset:0 lds
    buffer_load_dwordx4 v231, s[40:43], s64 offen offset:1024 lds
    buffer_load_dwordx4 v232, s[40:43], s64 offen offset:2048 lds
    s_add_u32 s64, s64, 98304
    s_sub_u32 s35, s64, 1966080
    s_min_u32 s64, s64, s35
    s_waitcnt vmcnt(12)
    s_waitcnt lgkmcnt(0)
    s_barrier
    ds_read_b64_tr_b16 a[72:73], v238 offset:24832
    ds_read_b64_tr_b16 a[74:75], v238 offset:26368
    ds_read_b64_tr_b16 a[76:77], v238 offset:31056
    ds_read_b64_tr_b16 a[78:79], v238 offset:32592
    ds_read_b64_tr_b16 a[80:81], v239 offset:24832
    ds_read_b64_tr_b16 a[82:83], v239 offset:26368
    ds_read_b64_tr_b16 a[84:85], v238 offset:37248
    ds_read_b64_tr_b16 a[86:87], v238 offset:38784
    ds_read_b64_tr_b16 a[88:89], v238 offset:43472
    ds_read_b64_tr_b16 a[90:91], v238 offset:45008
    ds_read_b64_tr_b16 a[92:93], v239 offset:37248
    ds_read_b64_tr_b16 a[94:95], v239 offset:38784
    s_add_u32 m0, s61, 57856
    s_nop 0
    buffer_load_dwordx4 v230, s[40:43], s64 offen offset:0 lds
    buffer_load_dwordx4 v231, s[40:43], s64 offen offset:1024 lds
    buffer_load_dwordx4 v232, s[40:43], s64 offen offset:2048 lds
    s_add_u32 s64, s64, 98304
    s_sub_u32 s35, s64, 1966080
    s_min_u32 s64, s64, s35
    s_add_u32 m0, s61, 70272
    s_nop 0
    buffer_load_dwordx4 v230, s[40:43], s64 offen offset:0 lds
    buffer_load_dwordx4 v231, s[40:43], s64 offen offset:1024 lds
    buffer_load_dwordx4 v232, s[40:43], s64 offen offset:2048 lds
    s_add_u32 s64, s64, 98304
    s_sub_u32 s35, s64, 1966080
    s_min_u32 s64, s64, s35
    s_waitcnt vmcnt(12)
    s_waitcnt lgkmcnt(0)
    s_barrier
    ds_read_b64_tr_b16 a[96:97], v233 offset:0
    ds_read_b64_tr_b16 a[98:99], v233 offset:1536
    ds_read_b64_tr_b16 a[100:101], v233 offset:6224
    ds_read_b64_tr_b16 a[102:103], v233 offset:7760
    ds_read_b64_tr_b16 a[104:105], v234 offset:0
    ds_read_b64_tr_b16 a[106:107], v234 offset:1536
    ds_read_b64_tr_b16 a[108:109], v233 offset:12416
    ds_read_b64_tr_b16 a[110:111], v233 offset:13952
    ds_read_b64_tr_b16 a[112:113], v233 offset:18640
    ds_read_b64_tr_b16 a[114:115], v233 offset:20176
    ds_read_b64_tr_b16 a[116:117], v234 offset:12416
    ds_read_b64_tr_b16 a[118:119], v234 offset:13952
    s_add_u32 m0, s61, 82688
    s_nop 0
    buffer_load_dwordx4 v230, s[40:43], s64 offen offset:0 lds
    buffer_load_dwordx4 v231, s[40:43], s64 offen offset:1024 lds
    buffer_load_dwordx4 v232, s[40:43], s64 offen offset:2048 lds
    s_add_u32 s64, s64, 98304
    s_sub_u32 s35, s64, 1966080
    s_min_u32 s64, s64, s35
    s_lshr_b32 s52, s71, 1
    s_lshl_b32 s52, s52, 2
    s_add_u32 s52, s52, s3
    s_mul_i32 s52, s52, 10240
    s_and_b32 s53, s71, 1
    s_mul_i32 s53, s53, 640
    s_add_u32 s52, s52, s53
    s_mul_i32 s53, s3, 5120
    v_add_u32 v5, 0, v1
    v_mul_u32_u24 v6, 205, v5
    v_lshrrev_b32 v6, 13, v6
    v_mul_u32_u24 v6, 640, v6
    v_lshl_add_u32 v5, v5, 4, v6
    s_add_u32 m0, s53, 107520
    s_nop 0
    buffer_load_dwordx4 v5, s[56:59], s52 offen nt lds
    v_add_u32 v5, 64, v1
    v_mul_u32_u24 v6, 205, v5
    v_lshrrev_b32 v6, 13, v6
    v_mul_u32_u24 v6, 640, v6
    v_lshl_add_u32 v5, v5, 4, v6
    s_add_u32 m0, s53, 108544
    s_nop 0
    buffer_load_dwordx4 v5, s[56:59], s52 offen nt lds
    v_add_u32 v5, 128, v1
    v_mul_u32_u24 v6, 205, v5
    v_lshrrev_b32 v6, 13, v6
    v_mul_u32_u24 v6, 640, v6
    v_lshl_add_u32 v5, v5, 4, v6
    s_add_u32 m0, s53, 109568
    s_nop 0
    buffer_load_dwordx4 v5, s[56:59], s52 offen nt lds
    v_add_u32 v5, 192, v1
    v_mul_u32_u24 v6, 205, v5
    v_lshrrev_b32 v6, 13, v6
    v_mul_u32_u24 v6, 640, v6
    v_lshl_add_u32 v5, v5, 4, v6
    s_add_u32 m0, s53, 110592
    s_nop 0
    buffer_load_dwordx4 v5, s[56:59], s52 offen nt lds
    v_add_u32 v5, 256, v1
    v_mul_u32_u24 v6, 205, v5
    v_lshrrev_b32 v6, 13, v6
    v_mul_u32_u24 v6, 640, v6
    v_lshl_add_u32 v5, v5, 4, v6
    s_add_u32 m0, s53, 111616
    s_nop 0
    buffer_load_dwordx4 v5, s[56:59], s52 offen nt lds
    s_waitcnt vmcnt(14)
    s_waitcnt lgkmcnt(0)
    s_barrier
    ds_read_b64_tr_b16 a[120:121], v233 offset:24832
    ds_read_b64_tr_b16 a[122:123], v233 offset:26368
    ds_read_b64_tr_b16 a[124:125], v233 offset:31056
    ds_read_b64_tr_b16 a[126:127], v233 offset:32592
    ds_read_b64_tr_b16 a[128:129], v234 offset:24832
    ds_read_b64_tr_b16 a[130:131], v234 offset:26368
    ds_read_b64_tr_b16 a[132:133], v233 offset:37248
    ds_read_b64_tr_b16 a[134:135], v233 offset:38784
    ds_read_b64_tr_b16 a[136:137], v233 offset:43472
    ds_read_b64_tr_b16 a[138:139], v233 offset:45008
    ds_read_b64_tr_b16 a[140:141], v234 offset:37248
    ds_read_b64_tr_b16 a[142:143], v234 offset:38784
    s_waitcnt vmcnt(8)
    s_waitcnt lgkmcnt(0)
    s_barrier
    ds_read_b64_tr_b16 a[144:145], v238 offset:0
    ds_read_b64_tr_b16 a[146:147], v238 offset:1536
    ds_read_b64_tr_b16 a[148:149], v238 offset:6224
    ds_read_b64_tr_b16 a[150:151], v238 offset:7760
    ds_read_b64_tr_b16 a[152:153], v239 offset:0
    ds_read_b64_tr_b16 a[154:155], v239 offset:1536
    ds_read_b64_tr_b16 a[156:157], v238 offset:12416
    ds_read_b64_tr_b16 a[158:159], v238 offset:13952
    ds_read_b64_tr_b16 a[160:161], v238 offset:18640
    ds_read_b64_tr_b16 a[162:163], v238 offset:20176
    ds_read_b64_tr_b16 a[164:165], v239 offset:12416
    ds_read_b64_tr_b16 a[166:167], v239 offset:13952
    s_waitcnt vmcnt(5)
    s_waitcnt lgkmcnt(0)
    s_barrier
    ds_read_b64_tr_b16 a[168:169], v238 offset:24832
    ds_read_b64_tr_b16 a[170:171], v238 offset:26368
    ds_read_b64_tr_b16 a[172:173], v238 offset:31056
    ds_read_b64_tr_b16 a[174:175], v238 offset:32592
    ds_read_b64_tr_b16 a[176:177], v239 offset:24832
    ds_read_b64_tr_b16 a[178:179], v239 offset:26368
    s_waitcnt vmcnt(0)
    s_waitcnt lgkmcnt(0)
    s_barrier
    v_lshrrev_b32 v2, 4, v1
    v_bfe_u32 v3, v1, 2, 2
    v_lshl_add_u32 v3, v2, 3, v3
    v_mul_u32_u24 v3, 640, v3
    v_and_b32 v2, 3, v1
    v_lshl_add_u32 v2, v2, 3, v3
    s_mul_i32 s50, s3, 160
    s_add_u32 s50, s50, 107520
    v_add_u32 v2, s50, v2
    s_lshr_b32 s53, s71, 1
    s_mov_b32 s50, 0x15555556
    s_mul_hi_u32 s51, s53, s50
    s_mul_i32 s52, s51, 12
    s_sub_u32 s52, s53, s52
    s_and_b32 s50, s71, 1
    s_lshl_b32 s50, s50, 2
    s_add_u32 s50, s50, s3
    s_lshl_b32 s50, s50, 2
    s_add_u32 s50, s50, s51
    s_mul_i32 s50, s50, 60
    s_mul_i32 s52, s52, 5
    s_add_u32 s50, s50, s52
    s_lshl_b32 s50, s50, 10
    s_add_u32 s50, s50, 14417920
    s_add_u32 s51, s50, 4096
    ds_read_b64_tr_b16 v[16:17], v2 offset:0
    ds_read_b64_tr_b16 v[18:19], v2 offset:2560
    ds_read_b64_tr_b16 v[20:21], v2 offset:32
    ds_read_b64_tr_b16 v[22:23], v2 offset:2592
    ds_read_b64_tr_b16 v[24:25], v2 offset:64
    ds_read_b64_tr_b16 v[26:27], v2 offset:2624
    ds_read_b64_tr_b16 v[28:29], v2 offset:96
    ds_read_b64_tr_b16 v[30:31], v2 offset:2656
    ds_read_b64_tr_b16 v[32:33], v2 offset:128
    ds_read_b64_tr_b16 v[34:35], v2 offset:2688
    s_waitcnt lgkmcnt(8)
    buffer_store_dwordx4 v[16:19], v248, s[36:39], s50 offen offset:0 sc1
    s_waitcnt lgkmcnt(6)
    buffer_store_dwordx4 v[20:23], v248, s[36:39], s50 offen offset:1024 sc1
    s_waitcnt lgkmcnt(4)
    buffer_store_dwordx4 v[24:27], v248, s[36:39], s50 offen offset:2048 sc1
    s_waitcnt lgkmcnt(2)
    buffer_store_dwordx4 v[28:31], v248, s[36:39], s50 offen offset:3072 sc1
    s_waitcnt lgkmcnt(0)
    buffer_store_dwordx4 v[32:35], v248, s[36:39], s51 offen offset:0 sc1
    s_cmp_eq_u32 s76, 1
    s_cbranch_scc0 L_nobias
    s_mov_b32 s69, s64
    s_add_u32 m0, s61, 95104
    s_nop 0
    buffer_load_dwordx4 v230, s[40:43], s64 offen offset:0 lds
    buffer_load_dwordx4 v231, s[40:43], s64 offen offset:1024 lds
    buffer_load_dwordx4 v232, s[40:43], s64 offen offset:2048 lds
    s_add_u32 s64, s64, 98304
    s_sub_u32 s35, s64, 1966080
    s_min_u32 s64, s64, s35
    s_add_u32 m0, s61, 8192
    s_nop 0
    buffer_load_dwordx4 v230, s[40:43], s64 offen offset:0 lds
    buffer_load_dwordx4 v231, s[40:43], s64 offen offset:1024 lds
    buffer_load_dwordx4 v232, s[40:43], s64 offen offset:2048 lds
    s_add_u32 s64, s64, 98304
    s_sub_u32 s35, s64, 1966080
    s_min_u32 s64, s64, s35
    s_add_u32 m0, s61, 20608
    s_nop 0
    buffer_load_dwordx4 v230, s[40:43], s64 offen offset:0 lds
    buffer_load_dwordx4 v231, s[40:43], s64 offen offset:1024 lds
    buffer_load_dwordx4 v232, s[40:43], s64 offen offset:2048 lds
    s_add_u32 s64, s64, 98304
    s_sub_u32 s35, s64, 1966080
    s_min_u32 s64, s64, s35
    s_add_u32 m0, s61, 33024
    s_nop 0
    buffer_load_dwordx4 v230, s[40:43], s64 offen offset:0 lds
    buffer_load_dwordx4 v231, s[40:43], s64 offen offset:1024 lds
    buffer_load_dwordx4 v232, s[40:43], s64 offen offset:2048 lds
    s_add_u32 s64, s64, 98304
    s_sub_u32 s35, s64, 1966080
    s_min_u32 s64, s64, s35
    s_add_u32 m0, s61, 45440
    s_nop 0
    buffer_load_dwordx4 v230, s[40:43], s64 offen offset:0 lds
    buffer_load_dwordx4 v231, s[40:43], s64 offen offset:1024 lds
    buffer_load_dwordx4 v232, s[40:43], s64 offen offset:2048 lds
    s_add_u32 s64, s64, 98304
    s_sub_u32 s35, s64, 1966080
    s_min_u32 s64, s64, s35
    s_mov_b32 s52, 23229184
    v_min_u32 v5, 19, v1
    v_lshlrev_b32 v5, 7, v5
L_poll19:
    buffer_load_dword v2, v5, s[36:39], s52 offen sc1
    s_waitcnt vmcnt(0)
    v_cmp_ne_u32 vcc, s48, v2
    s_cbranch_vccz L_poll19_ok
    s_cmp_eq_u32 s49, 0
    s_cbranch_scc1 L_poll19_ok
    s_sub_u32 s49, s49, 1
    s_sleep 1
    s_branch L_poll19
L_poll19_ok:
    s_mul_i32 s52, s3, 2560
    s_add_u32 m0, s52, 128000
    s_lshl_b32 s52, s34, 7
    s_add_u32 s52, s52, 23166976
    buffer_load_dwordx4 v248, s[36:39], s52 offen sc1 lds
    buffer_load_dwordx4 v248, s[36:39], s52 offen offset:1024 sc1 lds
    s_mov_b32 exec_hi, 0
    buffer_load_dwordx4 v248, s[36:39], s52 offen offset:2048 sc1 lds
    s_mov_b32 exec_hi, -1
    s_barrier
    ds_read_b64_tr_b16 a[180:181], v238 offset:37248
    ds_read_b64_tr_b16 a[182:183], v238 offset:38784
    ds_read_b64_tr_b16 a[184:185], v238 offset:43472
    ds_read_b64_tr_b16 a[186:187], v238 offset:45008
    ds_read_b64_tr_b16 a[188:189], v239 offset:37248
    ds_read_b64_tr_b16 a[190:191], v239 offset:38784
    ds_read_b64_tr_b16 a[192:193], v233 offset:0
    ds_read_b64_tr_b16 a[194:195], v233 offset:1536
    ds_read_b64_tr_b16 a[196:197], v233 offset:6224
    ds_read_b64_tr_b16 a[198:199], v233 offset:7760
    ds_read_b64_tr_b16 a[200:201], v234 offset:0
    ds_read_b64_tr_b16 a[202:203], v234 offset:1536
    s_waitcnt lgkmcnt(0)
    s_barrier
    ds_read_b64_tr_b16 a[204:205], v233 offset:12416
    ds_read_b64_tr_b16 a[206:207], v233 offset:13952
    ds_read_b64_tr_b16 a[208:209], v233 offset:18640
    ds_read_b64_tr_b16 a[210:211], v233 offset:20176
    ds_read_b64_tr_b16 a[212:213], v234 offset:12416
    ds_read_b64_tr_b16 a[214:215], v234 offset:13952
    ds_read_b64_tr_b16 a[216:217], v233 offset:24832
    ds_read_b64_tr_b16 a[218:219], v233 offset:26368
    ds_read_b64_tr_b16 a[220:221], v233 offset:31056
    ds_read_b64_tr_b16 a[222:223], v233 offset:32592
    ds_read_b64_tr_b16 a[224:225], v234 offset:24832
    ds_read_b64_tr_b16 a[226:227], v234 offset:26368
    s_waitcnt lgkmcnt(0)
    s_barrier
    ds_read_b64_tr_b16 a[228:229], v233 offset:37248
    ds_read_b64_tr_b16 a[230:231], v233 offset:38784
    ds_read_b64_tr_b16 a[232:233], v233 offset:43472
    ds_read_b64_tr_b16 a[234:235], v233 offset:45008
    ds_read_b64_tr_b16 a[236:237], v234 offset:37248
    ds_read_b64_tr_b16 a[238:239], v234 offset:38784
    s_waitcnt lgkmcnt(0)
    s_barrier
    s_mov_b32 s64, s69
    v_and_b32 v165, 1, v1
    v_lshlrev_b32 v165, 6, v165
    v_and_b32 v166, 48, v1
    s_mul_i32 s57, s3, 2560
    s_add_u32 s57, s57, 128000
    v_add3_u32 v165, v165, v166, s57
    s_waitcnt vmcnt(0)
    ds_read_b128 v[40:43], v165 offset:0
    ds_read_b128 v[44:47], v165 offset:128
    ds_read_b128 v[48:51], v165 offset:256
    ds_read_b128 v[52:55], v165 offset:384
    ds_read_b128 v[56:59], v165 offset:512
    ds_read_b128 v[60:63], v165 offset:640
    s_waitcnt lgkmcnt(5)
    v_mfma_f32_16x16x32_bf16 v[176:179], a[0:3], v[40:43], 0
    ds_read_b128 v[64:67], v165 offset:768
    v_mfma_f32_16x16x32_bf16 v[180:183], a[4:7], v[40:43], 0
    v_mfma_f32_16x16x32_bf16 v[184:187], a[8:11], v[40:43], 0
    s_waitcnt lgkmcnt(5)
    v_mfma_f32_16x16x32_bf16 v[176:179], a[12:15], v[44:47], v[176:179]
    ds_read_b128 v[68:71], v165 offset:896
    v_mfma_f32_16x16x32_bf16 v[180:183], a[16:19], v[44:47], v[180:183]
    v_mfma_f32_16x16x32_bf16 v[184:187], a[20:23], v[44:47], v[184:187]
    s_waitcnt lgkmcnt(5)
    v_mfma_f32_16x16x32_bf16 v[176:179], a[24:27], v[48:51], v[176:179]
    ds_read_b128 v[40:43], v165 offset:1024
    v_mfma_f32_16x16x32_bf16 v[180:183], a[28:31], v[48:51], v[180:183]
    v_mfma_f32_16x16x32_bf16 v[184:187], a[32:35], v[48:51], v[184:187]
    s_waitcnt lgkmcnt(5)
    v_mfma_f32_16x16x32_bf16 v[176:179], a[36:39], v[52:55], v[176:179]
    ds_read_b128 v[44:47], v165 offset:1152
    v_mfma_f32_16x16x32_bf16 v[180:183], a[40:43], v[52:55], v[180:183]
    v_mfma_f32_16x16x32_bf16 v[184:187], a[44:47], v[52:55], v[184:187]
    s_waitcnt lgkmcnt(5)
    v_mfma_f32_16x16x32_bf16 v[176:179], a[48:51], v[56:59], v[176:179]
    ds_read_b128 v[48:51], v165 offset:1280
    v_mfma_f32_16x16x32_bf16 v[180:183], a[52:55], v[56:59], v[180:183]
    v_mfma_f32_16x16x32_bf16 v[184:187], a[56:59], v[56:59], v[184:187]
    s_waitcnt lgkmcnt(5)
    v_mfma_f32_16x16x32_bf16 v[176:179], a[60:63], v[60:63], v[176:179]
    ds_read_b128 v[52:55], v165 offset:1408
    v_mfma_f32_16x16x32_bf16 v[180:183], a[64:67], v[60:63], v[180:183]
    v_mfma_f32_16x16x32_bf16 v[184:187], a[68:71], v[60:63], v[184:187]
    s_waitcnt lgkmcnt(5)
    v_mfma_f32_16x16x32_bf16 v[176:179], a[72:75], v[64:67], v[176:179]
    ds_read_b128 v[56:59], v165 offset:1536
    v_mfma_f32_16x16x32_bf16 v[180:183], a[76:79], v[64:67], v[180:183]
    v_mfma_f32_16x16x32_bf16 v[184:187], a[80:83], v[64:67], v[184:187]
    s_waitcnt lgkmcnt(5)
    v_mfma_f32_16x16x32_bf16 v[176:179], a[84:87], v[68:71], v[176:179]
    ds_read_b128 v[60:63], v165 offset:1664
    v_mfma_f32_16x16x32_bf16 v[180:183], a[88:91], v[68:71], v[180:183]
    v_mfma_f32_16x16x32_bf16 v[184:187], a[92:95], v[68:71], v[184:187]
    s_waitcnt lgkmcnt(5)
    v_mfma_f32_16x16x32_bf16 v[176:179], a[96:99], v[40:43], v[176:179]
    ds_read_b128 v[64:67], v165 offset:1792
    v_mfma_f32_16x16x32_bf16 v[180:183], a[100:103], v[40:43], v[180:183]
    v_mfma_f32_16x16x32_bf16 v[184:187], a[104:107], v[40:43], v[184:187]
    s_waitcnt lgkmcnt(5)
    v_mfma_f32_16x16x32_bf16 v[176:179], a[108:111], v[44:47], v[176:179]
    ds_read_b128 v[68:71], v165 offset:1920
    v_mfma_f32_16x16x32_bf16 v[180:183], a[112:115], v[44:47], v[180:183]
    v_mfma_f32_16x16x32_bf16 v[184:187], a[116:119], v[44:47], v[184:187]
    s_waitcnt lgkmcnt(5)
    v_mfma_f32_16x16x32_bf16 v[176:179], a[120:123], v[48:51], v[176:179]
    ds_read_b128 v[40:43], v165 offset:2048
    v_mfma_f32_16x16x32_bf16 v[180:183], a[124:127], v[48:51], v[180:183]
    v_mfma_f32_16x16x32_bf16 v[184:187], a[128:131], v[48:51], v[184:187]
    s_waitcnt lgkmcnt(5)
    v_mfma_f32_16x16x32_bf16 v[176:179], a[132:135], v[52:55], v[176:179]
    ds_read_b128 v[44:47], v165 offset:2176
    v_mfma_f32_16x16x32_bf16 v[180:183], a[136:139], v[52:55], v[180:183]
    v_mfma_f32_16x16x32_bf16 v[184:187], a[140:143], v[52:55], v[184:187]
    s_waitcnt lgkmcnt(5)
    v_mfma_f32_16x16x32_bf16 v[176:179], a[144:147], v[56:59], v[176:179]
    ds_read_b128 v[48:51], v165 offset:2304
    v_mfma_f32_16x16x32_bf16 v[180:183], a[148:151], v[56:59], v[180:183]
    v_mfma_f32_16x16x32_bf16 v[184:187], a[152:155], v[56:59], v[184:187]
    s_waitcnt lgkmcnt(5)
    v_mfma_f32_16x16x32_bf16 v[176:179], a[156:159], v[60:63], v[176:179]
    ds_read_b128 v[52:55], v165 offset:2432
    v_mfma_f32_16x16x32_bf16 v[180:183], a[160:163], v[60:63], v[180:183]
    v_mfma_f32_16x16x32_bf16 v[184:187], a[164:167], v[60:63], v[184:187]
    s_waitcnt lgkmcnt(5)
    v_mfma_f32_16x16x32_bf16 v[176:179], a[168:171], v[64:67], v[176:179]
    v_mfma_f32_16x16x32_bf16 v[180:183], a[172:175], v[64:67], v[180:183]
    v_mfma_f32_16x16x32_bf16 v[184:187], a[176:179], v[64:67], v[184:187]
    s_waitcnt lgkmcnt(4)
    v_mfma_f32_16x16x32_bf16 v[176:179], a[180:183], v[68:71], v[176:179]
    v_mfma_f32_16x16x32_bf16 v[180:183], a[184:187], v[68:71], v[180:183]
    v_mfma_f32_16x16x32_bf16 v[184:187], a[188:191], v[68:71], v[184:187]
    s_waitcnt lgkmcnt(3)
    v_mfma_f32_16x16x32_bf16 v[176:179], a[192:195], v[40:43], v[176:179]
    v_mfma_f32_16x16x32_bf16 v[180:183], a[196:199], v[40:43], v[180:183]
    v_mfma_f32_16x16x32_bf16 v[184:187], a[200:203], v[40:43], v[184:187]
    s_waitcnt lgkmcnt(2)
    v_mfma_f32_16x16x32_bf16 v[176:179], a[204:207], v[44:47], v[176:179]
    v_mfma_f32_16x16x32_bf16 v[180:183], a[208:211], v[44:47], v[180:183]
    v_mfma_f32_16x16x32_bf16 v[184:187], a[212:215], v[44:47], v[184:187]
    s_waitcnt lgkmcnt(1)
    v_mfma_f32_16x16x32_bf16 v[176:179], a[216:219], v[48:51], v[176:179]
    v_mfma_f32_16x16x32_bf16 v[180:183], a[220:223], v[48:51], v[180:183]
    v_mfma_f32_16x16x32_bf16 v[184:187], a[224:227], v[48:51], v[184:187]
    s_waitcnt lgkmcnt(0)
    v_mfma_f32_16x16x32_bf16 v[176:179], a[228:231], v[52:55], v[176:179]
    v_mfma_f32_16x16x32_bf16 v[180:183], a[232:235], v[52:55], v[180:183]
    v_mfma_f32_16x16x32_bf16 v[184:187], a[236:239], v[52:55], v[184:187]
    v_and_b32 v90, 1, v1
    v_mul_u32_u24 v90, 192, v90
    v_and_b32 v91, 48, v1
    v_add_u32 v90, v90, v91
    s_mov_b32 exec_lo, 0x00030003
    s_mov_b32 exec_hi, 0x00030003
    buffer_store_dwordx4 v[176:179], v90, s[36:39], s9 offen offset:0 sc1
    buffer_store_dwordx4 v[180:183], v90, s[36:39], s9 offen offset:64 sc1
    buffer_store_dwordx4 v[184:187], v90, s[36:39], s9 offen offset:128 sc1
    s_mov_b64 exec, -1
L_nobias:
    s_waitcnt vmcnt(0)
    s_barrier
    s_cmp_eq_u32 s3, 0
    s_cbranch_scc0 L_wf20
    s_lshl_b32 s54, s71, 7
    s_add_u32 s54, s54, 23233536
    v_mov_b32 v2, 0
    v_mov_b32 v3, s48
    s_mov_b64 exec, 1
    buffer_store_dword v3, v2, s[36:39], s54 offen sc1
    s_mov_b64 exec, -1
L_wf20:
    s_cmp_eq_u32 s76, 1
    s_cbranch_scc0 L_nobias2
    s_cmp_eq_u32 s3, 0
    s_cbranch_scc0 L_wf21
    s_lshl_b32 s54, s73, 7
    s_add_u32 s54, s54, 23286784
    v_mov_b32 v2, 0
    v_mov_b32 v3, s48
    s_mov_b64 exec, 1
    buffer_store_dword v3, v2, s[36:39], s54 offen sc1
    s_mov_b64 exec, -1
L_wf21:
L_nobias2:
    s_cmp_eq_u32 s2, 223
    s_cbranch_scc0 L_p_x
    v_lshlrev_b32 v5, 7, v0
    v_add_u32 v6, 134144, v5
    v_cmp_lt_u32 vcc, 159, v0
    s_nop 1
    v_cndmask_b32 v5, v5, v6, vcc
    s_mov_b32 s52, 23199744
L_poll22:
    buffer_load_dword v2, v5, s[36:39], s52 offen sc1
    s_waitcnt vmcnt(0)
    v_cmp_ne_u32 vcc, s48, v2
    s_cbranch_vccz L_poll22_ok
    s_cmp_eq_u32 s49, 0
    s_cbranch_scc1 L_poll22_ok
    s_sub_u32 s49, s49, 1
    s_sleep 1
    s_branch L_poll22
L_poll22_ok:
    s_barrier
    s_cmp_eq_u32 s3, 0
    s_cbranch_scc0 L_p_x
    s_mov_b32 s50, 23461888
    v_mov_b32 v2, 0
    v_mov_b32 v3, s48
    s_mov_b64 exec, 1
    buffer_store_dword v3, v2, s[36:39], s50 offen sc1
    s_mov_b64 exec, -1
L_p_x:
    v_min_u32 v2, 49, v1
    v_lshlrev_b32 v2, 7, v2
    v_add_u32 v2, 25600, v2
    v_cmp_lt_u32 vcc, 39, v1
    s_nop 1
    v_cndmask_b32 v219, v219, v2, vcc
    v_mov_b32 v200, v230
    v_mov_b32 v201, v231
    v_mov_b32 v202, v232
    v_add_u32 v203, 93568, v233
    v_add_u32 v204, 93568, v234
    s_add_u32 m0, s61, 101760
    s_nop 0
    buffer_load_dwordx4 v200, s[40:43], s64 offen offset:0 lds
    buffer_load_dwordx4 v201, s[40:43], s64 offen offset:1024 lds
    buffer_load_dwordx4 v202, s[40:43], s64 offen offset:2048 lds
    s_add_u32 s64, s64, 98304
    s_sub_u32 s35, s64, 1966080
    s_min_u32 s64, s64, s35
    s_add_u32 m0, s61, 114176
    s_nop 0
    buffer_load_dwordx4 v200, s[40:43], s64 offen offset:0 lds
    buffer_load_dwordx4 v201, s[40:43], s64 offen offset:1024 lds
    buffer_load_dwordx4 v202, s[40:43], s64 offen offset:2048 lds
    s_add_u32 s64, s64, 98304
    s_sub_u32 s35, s64, 1966080
    s_min_u32 s64, s64, s35
L_poll23:
    buffer_load_dword v223, v219, s[36:39], s17 offen sc1
    s_waitcnt vmcnt(0)
    v_cmp_ne_u32 vcc, s48, v223
    s_cbranch_vccz L_poll23_ok
    s_cmp_eq_u32 s49, 0
    s_cbranch_scc1 L_poll23_ok
    s_sub_u32 s49, s49, 1
    s_sleep 1
    s_branch L_poll23
L_poll23_ok:
    s_add_u32 m0, s63, 0
    s_nop 0
    buffer_load_dwordx4 v172, s[36:39], s10 offen sc1 lds
    s_add_u32 m0, s63, 4096
    s_nop 0
    buffer_load_dwordx4 v172, s[36:39], s11 offen sc1 lds
    s_add_u32 m0, s63, 8192
    s_nop 0
    buffer_load_dwordx4 v172, s[36:39], s12 offen sc1 lds
    s_add_u32 m0, s63, 12288
    s_nop 0
    buffer_load_dwordx4 v172, s[36:39], s13 offen sc1 lds
    s_add_u32 m0, s63, 16384
    s_nop 0
    buffer_load_dwordx4 v172, s[36:39], s14 offen sc1 lds
    s_add_u32 m0, s63, 20480
    s_nop 0
    buffer_load_dwordx4 v172, s[36:39], s15 offen sc1 lds
    s_add_u32 m0, s63, 24576
    s_nop 0
    buffer_load_dwordx4 v172, s[36:39], s18 offen sc1 lds
    s_add_u32 m0, s63, 28672
    s_nop 0
    buffer_load_dwordx4 v172, s[36:39], s19 offen sc1 lds
    s_add_u32 m0, s63, 32768
    s_nop 0
    buffer_load_dwordx4 v172, s[36:39], s20 offen sc1 lds
    s_add_u32 m0, s63, 36864
    s_nop 0
    buffer_load_dwordx4 v172, s[36:39], s21 offen sc1 lds
    s_add_u32 m0, s63, 40960
    s_nop 0
    buffer_load_dwordx4 v172, s[36:39], s22 offen sc1 lds
    s_add_u32 m0, s63, 45056
    s_nop 0
    buffer_load_dwordx4 v172, s[36:39], s23 offen sc1 lds
    v_lshlrev_b32 v2, 2, v0
    v_mov_b32 v3, 0x80000000
    v_cmp_gt_u32 vcc, 128, v0
    s_nop 1
    v_cndmask_b32 v3, v3, v2, vcc
    s_lshl_b32 s50, s34, 7
    s_add_u32 s50, s50, 23183360
    buffer_load_dword v220, v2, s[36:39], s50 offen sc1
    buffer_load_dword v221, v2, s[36:39], s50 offen offset:1024 sc1
    buffer_load_dword v222, v3, s[36:39], s50 offen offset:2048 sc1
    s_waitcnt vmcnt(12)
    s_waitcnt lgkmcnt(0)
    s_barrier
    ds_read_b64_tr_b16 v[104:105], v168 offset:0
    ds_read_b64_tr_b16 v[106:107], v168 offset:2048
    ds_read_b64_tr_b16 v[108:109], v169 offset:0
    ds_read_b64_tr_b16 v[110:111], v169 offset:2048
    ds_read_b64_tr_b16 v[112:113], v170 offset:0
    ds_read_b64_tr_b16 v[114:115], v170 offset:2048
    ds_read_b64_tr_b16 v[116:117], v171 offset:0
    ds_read_b64_tr_b16 v[118:119], v171 offset:2048
    s_waitcnt lgkmcnt(6)
    v_mfma_f32_16x16x32_bf16 v[56:59], a[0:3], v[104:107], 0
    ds_read_b64_tr_b16 v[120:121], v168 offset:4096
    v_mfma_f32_16x16x32_bf16 v[60:63], a[4:7], v[104:107], 0
    ds_read_b64_tr_b16 v[122:123], v168 offset:6144
    v_mfma_f32_16x16x32_bf16 v[64:67], a[8:11], v[104:107], 0
    s_waitcnt lgkmcnt(6)
    s_add_u32 m0, s63, 49152
    ds_read_b64_tr_b16 v[124:125], v169 offset:4096
    v_mfma_f32_16x16x32_bf16 v[68:71], a[0:3], v[108:111], 0
    buffer_load_dwordx4 v172, s[36:39], s24 offen sc1 lds
    v_mfma_f32_16x16x32_bf16 v[72:75], a[4:7], v[108:111], 0
    ds_read_b64_tr_b16 v[126:127], v169 offset:6144
    v_mfma_f32_16x16x32_bf16 v[76:79], a[8:11], v[108:111], 0
    s_waitcnt lgkmcnt(6)
    ds_read_b64_tr_b16 v[128:129], v170 offset:4096
    v_mfma_f32_16x16x32_bf16 v[80:83], a[0:3], v[112:115], 0
    s_add_u32 m0, s63, 53248
    ds_read_b64_tr_b16 v[130:131], v170 offset:6144
    v_mfma_f32_16x16x32_bf16 v[84:87], a[4:7], v[112:115], 0
    buffer_load_dwordx4 v172, s[36:39], s25 offen sc1 lds
    v_mfma_f32_16x16x32_bf16 v[88:91], a[8:11], v[112:115], 0
    s_waitcnt lgkmcnt(6)
    ds_read_b64_tr_b16 v[132:133], v171 offset:4096
    v_mfma_f32_16x16x32_bf16 v[92:95], a[0:3], v[116:119], 0
    s_waitcnt lgkmcnt(3)
    ds_read_b64_tr_b16 v[134:135], v171 offset:6144
    v_mfma_f32_16x16x32_bf16 v[96:99], a[4:7], v[116:119], 0
    s_add_u32 m0, s63, 57344
    v_mfma_f32_16x16x32_bf16 v[100:103], a[8:11], v[116:119], 0
    buffer_load_dwordx4 v172, s[36:39], s26 offen sc1 lds
    v_mfma_f32_16x16x32_bf16 v[56:59], a[12:15], v[120:123], v[56:59]
    ds_read_b64_tr_b16 v[104:105], v168 offset:8192
    v_mfma_f32_16x16x32_bf16 v[60:63], a[16:19], v[120:123], v[60:63]
    ds_read_b64_tr_b16 v[106:107], v168 offset:10240
    v_mfma_f32_16x16x32_bf16 v[64:67], a[20:23], v[120:123], v[64:67]
    s_add_u32 m0, s63, 61440
    ds_read_b64_tr_b16 v[108:109], v169 offset:8192
    v_mfma_f32_16x16x32_bf16 v[68:71], a[12:15], v[124:127], v[68:71]
    buffer_load_dwordx4 v172, s[36:39], s27 offen sc1 lds
    v_mfma_f32_16x16x32_bf16 v[72:75], a[16:19], v[124:127], v[72:75]
    ds_read_b64_tr_b16 v[110:111], v169 offset:10240
    v_mfma_f32_16x16x32_bf16 v[76:79], a[20:23], v[124:127], v[76:79]
    s_waitcnt lgkmcnt(6)
    ds_read_b64_tr_b16 v[112:113], v170 offset:8192
    v_mfma_f32_16x16x32_bf16 v[80:83], a[12:15], v[128:131], v[80:83]
    s_add_u32 m0, s63, 65536
    ds_read_b64_tr_b16 v[114:115], v170 offset:10240
    v_mfma_f32_16x16x32_bf16 v[84:87], a[16:19], v[128:131], v[84:87]
    buffer_load_dwordx4 v172, s[36:39], s44 offen sc1 lds
    v_mfma_f32_16x16x32_bf16 v[88:91], a[20:23], v[128:131], v[88:91]
    s_waitcnt lgkmcnt(6)
    ds_read_b64_tr_b16 v[116:117], v171 offset:8192
    v_mfma_f32_16x16x32_bf16 v[92:95], a[12:15], v[132:135], v[92:95]
    s_waitcnt lgkmcnt(3)
    ds_read_b64_tr_b16 v[118:119], v171 offset:10240
    v_mfma_f32_16x16x32_bf16 v[96:99], a[16:19], v[132:135], v[96:99]
    s_add_u32 m0, s63, 69632
    v_mfma_f32_16x16x32_bf16 v[100:103], a[20:23], v[132:135], v[100:103]
    buffer_load_dwordx4 v172, s[36:39], s45 offen sc1 lds
    v_mfma_f32_16x16x32_bf16 v[56:59], a[24:27], v[104:107], v[56:59]
    s_waitcnt vmcnt(13)
    s_barrier
    ds_read_b64_tr_b16 v[120:121], v168 offset:12288
    v_mfma_f32_16x16x32_bf16 v[60:63], a[28:31], v[104:107], v[60:63]
    ds_read_b64_tr_b16 v[122:123], v168 offset:14336
    v_mfma_f32_16x16x32_bf16 v[64:67], a[32:35], v[104:107], v[64:67]
    s_add_u32 m0, s63, 73728
    ds_read_b64_tr_b16 v[124:125], v169 offset:12288
    v_mfma_f32_16x16x32_bf16 v[68:71], a[24:27], v[108:111], v[68:71]
    buffer_load_dwordx4 v172, s[36:39], s46 offen sc1 lds
    v_mfma_f32_16x16x32_bf16 v[72:75], a[28:31], v[108:111], v[72:75]
    ds_read_b64_tr_b16 v[126:127], v169 offset:14336
    v_mfma_f32_16x16x32_bf16 v[76:79], a[32:35], v[108:111], v[76:79]
    s_waitcnt lgkmcnt(6)
    ds_read_b64_tr_b16 v[128:129], v170 offset:12288
    v_mfma_f32_16x16x32_bf16 v[80:83], a[24:27], v[112:115], v[80:83]
    s_add_u32 m0, s63, 77824
    ds_read_b64_tr_b16 v[130:131], v170 offset:14336
    v_mfma_f32_16x16x32_bf16 v[84:87], a[28:31], v[112:115], v[84:87]
    buffer_load_dwordx4 v172, s[36:39], s47 offen sc1 lds
    v_mfma_f32_16x16x32_bf16 v[88:91], a[32:35], v[112:115], v[88:91]
    s_waitcnt lgkmcnt(6)
    ds_read_b64_tr_b16 v[132:133], v171 offset:12288
    v_add_u32 v172, 2048, v172
    v_mfma_f32_16x16x32_bf16 v[92:95], a[24:27], v[116:119], v[92:95]
    s_waitcnt lgkmcnt(3)
    ds_read_b64_tr_b16 v[134:135], v171 offset:14336
    v_mfma_f32_16x16x32_bf16 v[96:99], a[28:31], v[116:119], v[96:99]
    s_add_u32 m0, s61, 126592
    v_mfma_f32_16x16x32_bf16 v[100:103], a[32:35], v[116:119], v[100:103]
    buffer_load_dwordx4 v200, s[40:43], s64 offen offset:0 lds
    v_mfma_f32_16x16x32_bf16 v[56:59], a[36:39], v[120:123], v[56:59]
    ds_read_b64_tr_b16 v[104:105], v168 offset:16384
    v_mfma_f32_16x16x32_bf16 v[60:63], a[40:43], v[120:123], v[60:63]
    ds_read_b64_tr_b16 v[106:107], v168 offset:18432
    v_mfma_f32_16x16x32_bf16 v[64:67], a[44:47], v[120:123], v[64:67]
    s_add_u32 m0, s61, 126592
    ds_read_b64_tr_b16 v[108:109], v169 offset:16384
    v_mfma_f32_16x16x32_bf16 v[68:71], a[36:39], v[124:127], v[68:71]
    buffer_load_dwordx4 v201, s[40:43], s64 offen offset:1024 lds
    v_mfma_f32_16x16x32_bf16 v[72:75], a[40:43], v[124:127], v[72:75]
    ds_read_b64_tr_b16 v[110:111], v169 offset:18432
    v_mfma_f32_16x16x32_bf16 v[76:79], a[44:47], v[124:127], v[76:79]
    s_waitcnt lgkmcnt(6)
    ds_read_b64_tr_b16 v[112:113], v170 offset:16384
    v_mfma_f32_16x16x32_bf16 v[80:83], a[36:39], v[128:131], v[80:83]
    ds_read_b64_tr_b16 v[114:115], v170 offset:18432
    v_mfma_f32_16x16x32_bf16 v[84:87], a[40:43], v[128:131], v[84:87]
    v_mfma_f32_16x16x32_bf16 v[88:91], a[44:47], v[128:131], v[88:91]
    s_waitcnt lgkmcnt(6)
    ds_read_b64_tr_b16 v[116:117], v171 offset:16384
    v_mfma_f32_16x16x32_bf16 v[92:95], a[36:39], v[132:135], v[92:95]
    s_waitcnt lgkmcnt(3)
    ds_read_b64_tr_b16 v[118:119], v171 offset:18432
    v_mfma_f32_16x16x32_bf16 v[96:99], a[40:43], v[132:135], v[96:99]
    s_add_u32 m0, s61, 126592
    v_mfma_f32_16x16x32_bf16 v[100:103], a[44:47], v[132:135], v[100:103]
    buffer_load_dwordx4 v202, s[40:43], s64 offen offset:2048 lds
    v_mfma_f32_16x16x32_bf16 v[56:59], a[48:51], v[104:107], v[56:59]
    s_add_u32 s64, s64, 98304
    ds_read_b64_tr_b16 v[120:121], v168 offset:20480
    v_mfma_f32_16x16x32_bf16 v[60:63], a[52:55], v[104:107], v[60:63]
    s_sub_u32 s35, s64, 1966080
    ds_read_b64_tr_b16 v[122:123], v168 offset:22528
    v_mfma_f32_16x16x32_bf16 v[64:67], a[56:59], v[104:107], v[64:67]
    s_min_u32 s64, s64, s35
    ds_read_b64_tr_b16 v[124:125], v169 offset:20480
    v_mfma_f32_16x16x32_bf16 v[68:71], a[48:51], v[108:111], v[68:71]
    v_mfma_f32_16x16x32_bf16 v[72:75], a[52:55], v[108:111], v[72:75]
    ds_read_b64_tr_b16 v[126:127], v169 offset:22528
    v_mfma_f32_16x16x32_bf16 v[76:79], a[56:59], v[108:111], v[76:79]
    s_waitcnt lgkmcnt(6)
    ds_read_b64_tr_b16 v[128:129], v170 offset:20480
    v_mfma_f32_16x16x32_bf16 v[80:83], a[48:51], v[112:115], v[80:83]
    s_add_u32 m0, s61, 139008
    ds_read_b64_tr_b16 v[130:131], v170 offset:22528
    v_min_u32 v243, 11, v1
    v_mfma_f32_16x16x32_bf16 v[84:87], a[52:55], v[112:115], v[84:87]
    buffer_load_dwordx4 v200, s[40:43], s64 offen offset:0 lds
    v_mfma_f32_16x16x32_bf16 v[88:91], a[56:59], v[112:115], v[88:91]
    s_waitcnt lgkmcnt(6)
    ds_read_b64_tr_b16 v[132:133], v171 offset:20480
    v_lshlrev_b32 v243, 8, v243
    v_mfma_f32_16x16x32_bf16 v[92:95], a[48:51], v[116:119], v[92:95]
    s_waitcnt lgkmcnt(3)
    ds_read_b64_tr_b16 v[134:135], v171 offset:22528
    v_mfma_f32_16x16x32_bf16 v[96:99], a[52:55], v[116:119], v[96:99]
    s_add_u32 m0, s61, 139008
    v_mfma_f32_16x16x32_bf16 v[100:103], a[56:59], v[116:119], v[100:103]
    buffer_load_dwordx4 v201, s[40:43], s64 offen offset:1024 lds
    v_mfma_f32_16x16x32_bf16 v[56:59], a[60:63], v[120:123], v[56:59]
    s_mul_i32 s58, s3, 24
    s_lshr_b32 s57, s75, 2
    ds_read_b64_tr_b16 v[104:105], v168 offset:24576
    v_mfma_f32_16x16x32_bf16 v[60:63], a[64:67], v[120:123], v[60:63]
    s_add_u32 s58, s58, s57
    s_lshl_b32 s58, s58, 7
    ds_read_b64_tr_b16 v[106:107], v168 offset:26624
    v_mfma_f32_16x16x32_bf16 v[64:67], a[68:71], v[120:123], v[64:67]
    s_add_u32 s58, s58, 23233536
    ds_read_b64_tr_b16 v[108:109], v169 offset:24576
    v_mfma_f32_16x16x32_bf16 v[68:71], a[60:63], v[124:127], v[68:71]
    buffer_load_dword v244, v243, s[36:39], s58 offen sc1
    v_mfma_f32_16x16x32_bf16 v[72:75], a[64:67], v[124:127], v[72:75]
    ds_read_b64_tr_b16 v[110:111], v169 offset:26624
    v_mfma_f32_16x16x32_bf16 v[76:79], a[68:71], v[124:127], v[76:79]
    s_waitcnt lgkmcnt(6)
    ds_read_b64_tr_b16 v[112:113], v170 offset:24576
    v_mfma_f32_16x16x32_bf16 v[80:83], a[60:63], v[128:131], v[80:83]
    s_add_u32 m0, s61, 139008
    ds_read_b64_tr_b16 v[114:115], v170 offset:26624
    v_mfma_f32_16x16x32_bf16 v[84:87], a[64:67], v[128:131], v[84:87]
    buffer_load_dwordx4 v202, s[40:43], s64 offen offset:2048 lds
    v_mfma_f32_16x16x32_bf16 v[88:91], a[68:71], v[128:131], v[88:91]
    s_waitcnt lgkmcnt(6)
    s_add_u32 s64, s64, 98304
    ds_read_b64_tr_b16 v[116:117], v171 offset:24576
    v_mfma_f32_16x16x32_bf16 v[92:95], a[60:63], v[132:135], v[92:95]
    s_waitcnt lgkmcnt(3)
    s_sub_u32 s35, s64, 1966080
    ds_read_b64_tr_b16 v[118:119], v171 offset:26624
    v_mfma_f32_16x16x32_bf16 v[96:99], a[64:67], v[132:135], v[96:99]
    s_min_u32 s64, s64, s35
    v_mfma_f32_16x16x32_bf16 v[100:103], a[68:71], v[132:135], v[100:103]
    v_mfma_f32_16x16x32_bf16 v[56:59], a[72:75], v[104:107], v[56:59]
    ds_read_b64_tr_b16 v[120:121], v168 offset:28672
    v_mfma_f32_16x16x32_bf16 v[60:63], a[76:79], v[104:107], v[60:63]
    ds_read_b64_tr_b16 v[122:123], v168 offset:30720
    v_mfma_f32_16x16x32_bf16 v[64:67], a[80:83], v[104:107], v[64:67]
    s_add_u32 m0, s61, 151424
    ds_read_b64_tr_b16 v[124:125], v169 offset:28672
    v_mfma_f32_16x16x32_bf16 v[68:71], a[72:75], v[108:111], v[68:71]
    buffer_load_dwordx4 v200, s[40:43], s64 offen offset:0 lds
    v_mfma_f32_16x16x32_bf16 v[72:75], a[76:79], v[108:111], v[72:75]
    ds_read_b64_tr_b16 v[126:127], v169 offset:30720
    v_mfma_f32_16x16x32_bf16 v[76:79], a[80:83], v[108:111], v[76:79]
    s_waitcnt lgkmcnt(6)
    ds_read_b64_tr_b16 v[128:129], v170 offset:28672
    v_mfma_f32_16x16x32_bf16 v[80:83], a[72:75], v[112:115], v[80:83]
    s_add_u32 m0, s61, 151424
    ds_read_b64_tr_b16 v[130:131], v170 offset:30720
    v_mfma_f32_16x16x32_bf16 v[84:87], a[76:79], v[112:115], v[84:87]
    buffer_load_dwordx4 v201, s[40:43], s64 offen offset:1024 lds
    v_mfma_f32_16x16x32_bf16 v[88:91], a[80:83], v[112:115], v[88:91]
    s_waitcnt lgkmcnt(6)
    ds_read_b64_tr_b16 v[132:133], v171 offset:28672
    v_mfma_f32_16x16x32_bf16 v[92:95], a[72:75], v[116:119], v[92:95]
    s_waitcnt lgkmcnt(3)
    ds_read_b64_tr_b16 v[134:135], v171 offset:30720
    v_mfma_f32_16x16x32_bf16 v[96:99], a[76:79], v[116:119], v[96:99]
    v_mfma_f32_16x16x32_bf16 v[100:103], a[80:83], v[116:119], v[100:103]
    v_mfma_f32_16x16x32_bf16 v[56:59], a[84:87], v[120:123], v[56:59]
    s_waitcnt vmcnt(9)
    s_barrier
    ds_read_b64_tr_b16 v[104:105], v168 offset:32768
    v_mfma_f32_16x16x32_bf16 v[60:63], a[88:91], v[120:123], v[60:63]
    ds_read_b64_tr_b16 v[106:107], v168 offset:34816
    ds_read_b64 v[224:225], v216
    v_mfma_f32_16x16x32_bf16 v[64:67], a[92:95], v[120:123], v[64:67]
    s_add_u32 m0, s61, 151424
    ds_read_b64_tr_b16 v[108:109], v169 offset:32768
    ds_read_b64 v[226:227], v217
    v_mfma_f32_16x16x32_bf16 v[68:71], a[84:87], v[124:127], v[68:71]
    buffer_load_dwordx4 v202, s[40:43], s64 offen offset:2048 lds
    v_mfma_f32_16x16x32_bf16 v[72:75], a[88:91], v[124:127], v[72:75]
    s_add_u32 s64, s64, 98304
    ds_read_b64_tr_b16 v[110:111], v169 offset:34816
    ds_read_b64 v[228:229], v218
    v_mfma_f32_16x16x32_bf16 v[76:79], a[92:95], v[124:127], v[76:79]
    s_waitcnt lgkmcnt(9)
    s_sub_u32 s35, s64, 1966080
    ds_read_b64_tr_b16 v[112:113], v170 offset:32768
    v_mfma_f32_16x16x32_bf16 v[80:83], a[84:87], v[128:131], v[80:83]
    s_min_u32 s64, s64, s35
    ds_read_b64_tr_b16 v[114:115], v170 offset:34816
    v_lshrrev_b32 v238, 1, v1
    v_mfma_f32_16x16x32_bf16 v[84:87], a[88:91], v[128:131], v[84:87]
    s_barrier
    ds_read_b64_tr_b16 a[180:181], v203 offset:0
    v_mfma_f32_16x16x32_bf16 v[88:91], a[92:95], v[128:131], v[88:91]
    s_waitcnt lgkmcnt(10)
    ds_read_b64_tr_b16 v[116:117], v171 offset:32768
    v_lshlrev_b32 v238, 10, v238
    v_mfma_f32_16x16x32_bf16 v[92:95], a[84:87], v[132:135], v[92:95]
    s_waitcnt lgkmcnt(3)
    ds_read_b64_tr_b16 v[118:119], v171 offset:34816
    v_and_b32 v239, 1, v1
    v_mfma_f32_16x16x32_bf16 v[96:99], a[88:91], v[132:135], v[96:99]
    ds_read_b64_tr_b16 a[182:183], v203 offset:1536
    v_lshlrev_b32 v230, 16, v224
    v_and_b32 v231, 0xffff0000, v224
    v_pk_mul_f32 v[230:231], v[230:231], v[220:221] op_sel_hi:[1,0]
    v_pk_mul_f32 v[234:235], v[230:231], v[230:231]
    v_lshlrev_b32 v232, 16, v225
    v_and_b32 v233, 0xffff0000, v225
    v_pk_mul_f32 v[232:233], v[232:233], v[220:221] op_sel_hi:[1,0]
    v_pk_mul_f32 v[236:237], v[232:233], v[232:233]
    v_lshlrev_b32 v2, 16, v226
    v_and_b32 v3, 0xffff0000, v226
    v_pk_mul_f32 v[2:3], v[2:3], v[220:221] op_sel:[0,1] op_sel_hi:[1,1]
    v_pk_add_f32 v[230:231], v[230:231], v[2:3]
    v_pk_fma_f32 v[234:235], v[2:3], v[2:3], v[234:235]
    v_lshlrev_b32 v2, 16, v227
    v_and_b32 v3, 0xffff0000, v227
    v_pk_mul_f32 v[2:3], v[2:3], v[220:221] op_sel:[0,1] op_sel_hi:[1,1]
    v_pk_add_f32 v[232:233], v[232:233], v[2:3]
    v_pk_fma_f32 v[236:237], v[2:3], v[2:3], v[236:237]
    v_lshlrev_b32 v2, 16, v228
    v_and_b32 v3, 0xffff0000, v228
    v_pk_mul_f32 v[2:3], v[2:3], v[222:223] op_sel_hi:[1,0]
    v_pk_add_f32 v[230:231], v[230:231], v[2:3]
    v_pk_fma_f32 v[234:235], v[2:3], v[2:3], v[234:235]
    v_lshlrev_b32 v2, 16, v229
    v_and_b32 v3, 0xffff0000, v229
    v_pk_mul_f32 v[2:3], v[2:3], v[222:223] op_sel_hi:[1,0]
    v_pk_add_f32 v[232:233], v[232:233], v[2:3]
    v_pk_fma_f32 v[236:237], v[2:3], v[2:3], v[236:237]
    v_mfma_f32_16x16x32_bf16 v[100:103], a[92:95], v[132:135], v[100:103]
    ds_read_b64_tr_b16 a[184:185], v203 offset:6224
    v_permlane32_swap_b32 v230, v234
    v_mfma_f32_16x16x32_bf16 v[56:59], a[96:99], v[104:107], v[56:59]
    ds_read_b64_tr_b16 v[120:121], v168 offset:36864
    ds_read_b64_tr_b16 a[186:187], v203 offset:7760
    v_lshl_add_u32 v219, v239, 7, v238
    v_permlane32_swap_b32 v231, v235
    v_mfma_f32_16x16x32_bf16 v[60:63], a[100:103], v[104:107], v[60:63]
    s_lshl_b32 s55, s3, 8
    s_add_u32 s55, s55, 66560
    ds_read_b64_tr_b16 v[122:123], v168 offset:38912
    v_mfma_f32_16x16x32_bf16 v[64:67], a[104:107], v[104:107], v[64:67]
    ds_read_b64_tr_b16 v[124:125], v169 offset:36864
    v_add_u32 v219, s55, v219
    v_mfma_f32_16x16x32_bf16 v[68:71], a[96:99], v[108:111], v[68:71]
    ds_read_b64_tr_b16 a[188:189], v204 offset:0
    v_permlane32_swap_b32 v232, v236
    v_mfma_f32_16x16x32_bf16 v[72:75], a[100:103], v[108:111], v[72:75]
    s_lshl_b32 s55, s73, 7
    s_add_u32 s55, s55, 87040
    ds_read_b64_tr_b16 v[126:127], v169 offset:38912
    ds_read_b64_tr_b16 a[190:191], v204 offset:1536
    v_permlane32_swap_b32 v233, v237
    v_add_f32 v230, v230, v234
    v_mfma_f32_16x16x32_bf16 v[76:79], a[104:107], v[108:111], v[76:79]
    s_waitcnt lgkmcnt(12)
    ds_read_b64_tr_b16 v[128:129], v170 offset:36864
    v_mov_b32 v238, s55
    v_mfma_f32_16x16x32_bf16 v[80:83], a[96:99], v[112:115], v[80:83]
    ds_read_b64_tr_b16 v[130:131], v170 offset:38912
    v_add_f32 v231, v231, v235
    v_mfma_f32_16x16x32_bf16 v[84:87], a[100:103], v[112:115], v[84:87]
    v_cmp_lt_u32 vcc, 39, v1
    s_nop 1
    v_cndmask_b32 v219, v219, v238, vcc
    v_mfma_f32_16x16x32_bf16 v[88:91], a[104:107], v[112:115], v[88:91]
    s_waitcnt lgkmcnt(11)
    s_mov_b32 s17, 23199744
    ds_read_b64_tr_b16 v[132:133], v171 offset:36864
    v_add_f32 v232, v232, v236
    v_mfma_f32_16x16x32_bf16 v[92:95], a[96:99], v[116:119], v[92:95]
    s_waitcnt lgkmcnt(3)
    ds_read_b64_tr_b16 v[134:135], v171 offset:38912
    v_add_f32 v233, v233, v237
    v_mfma_f32_16x16x32_bf16 v[96:99], a[100:103], v[116:119], v[96:99]
    v_permlane16_swap_b32 v230, v232
    v_permlane16_swap_b32 v231, v233
    v_mfma_f32_16x16x32_bf16 v[100:103], a[104:107], v[116:119], v[100:103]
    v_add_f32 v230, v230, v232
    v_add_f32 v231, v231, v233
    v_mfma_f32_16x16x32_bf16 v[56:59], a[108:111], v[120:123], v[56:59]
    s_barrier
    ds_read_b64_tr_b16 v[104:105], v168 offset:40960
    v_lshrrev_b32 v2, 4, v1
    v_lshlrev_b32 v2, 3, v2
    v_mfma_f32_16x16x32_bf16 v[60:63], a[112:115], v[120:123], v[60:63]
    ds_read_b64_tr_b16 v[106:107], v168 offset:43008
    ds_read_b64_tr_b16 a[192:193], v203 offset:12416
    v_mfma_f32_16x16x32_bf16 v[64:67], a[116:119], v[120:123], v[64:67]
    ds_read_b64_tr_b16 v[108:109], v169 offset:40960
    s_waitcnt vmcnt(4)
    v_cmp_ne_u32 vcc, s48, v244
    s_cbranch_vccnz L_chk24_slow
L_chk24_back:
    v_mfma_f32_16x16x32_bf16 v[68:71], a[108:111], v[124:127], v[68:71]
    ds_read_b64_tr_b16 a[194:195], v203 offset:13952
    buffer_load_dwordx4 a[240:243], v248, s[36:39], s62 offen offset:0 sc1
    v_mfma_f32_16x16x32_bf16 v[72:75], a[112:115], v[124:127], v[72:75]
    ds_read_b64_tr_b16 v[110:111], v169 offset:43008
    ds_read_b64_tr_b16 a[196:197], v203 offset:18640
    v_mfma_f32_16x16x32_bf16 v[76:79], a[116:119], v[124:127], v[76:79]
    s_waitcnt lgkmcnt(9)
    ds_read_b64_tr_b16 v[112:113], v170 offset:40960
    ds_read_b64_tr_b16 a[198:199], v203 offset:20176
    v_mfma_f32_16x16x32_bf16 v[80:83], a[108:111], v[128:131], v[80:83]
    s_lshl_b32 s50, s3, 5
    s_add_u32 s50, s50, 0
    ds_read_b64_tr_b16 v[114:115], v170 offset:43008
    v_add_u32 v2, s50, v2
    v_mfma_f32_16x16x32_bf16 v[84:87], a[112:115], v[128:131], v[84:87]
    ds_read_b64_tr_b16 a[200:201], v204 offset:12416
    buffer_load_dwordx4 a[244:247], v248, s[36:39], s62 offen offset:1024 sc1
    v_mfma_f32_16x16x32_bf16 v[88:91], a[116:119], v[128:131], v[88:91]
    s_waitcnt lgkmcnt(11)
    ds_read_b64_tr_b16 v[116:117], v171 offset:40960
    v_add_f32_dpp v230, v230, v230 row_ror:8 row_mask:0xf bank_mask:0xf
    v_mfma_f32_16x16x32_bf16 v[92:95], a[108:111], v[132:135], v[92:95]
    s_waitcnt lgkmcnt(3)
    ds_read_b64_tr_b16 v[118:119], v171 offset:43008
    v_add_f32_dpp v231, v231, v231 row_ror:8 row_mask:0xf bank_mask:0xf
    v_mfma_f32_16x16x32_bf16 v[96:99], a[112:115], v[132:135], v[96:99]
    ds_read_b64_tr_b16 a[202:203], v204 offset:13952
    v_add_f32_dpp v230, v230, v230 row_ror:4 row_mask:0xf bank_mask:0xf
    v_mfma_f32_16x16x32_bf16 v[100:103], a[116:119], v[132:135], v[100:103]
    buffer_load_dwordx4 a[248:251], v248, s[36:39], s62 offen offset:2048 sc1
    v_mfma_f32_16x16x32_bf16 v[56:59], a[120:123], v[104:107], v[56:59]
    ds_read_b64_tr_b16 v[120:121], v168 offset:45056
    v_add_f32_dpp v231, v231, v231 row_ror:4 row_mask:0xf bank_mask:0xf
    v_mfma_f32_16x16x32_bf16 v[60:63], a[124:127], v[104:107], v[60:63]
    ds_read_b64_tr_b16 v[122:123], v168 offset:47104
    v_add_f32_dpp v230, v230, v230 row_ror:2 row_mask:0xf bank_mask:0xf
    v_mfma_f32_16x16x32_bf16 v[64:67], a[128:131], v[104:107], v[64:67]
    ds_read_b64_tr_b16 v[124:125], v169 offset:45056
    v_add_f32_dpp v231, v231, v231 row_ror:2 row_mask:0xf bank_mask:0xf
    v_mfma_f32_16x16x32_bf16 v[68:71], a[120:123], v[108:111], v[68:71]
    buffer_load_dword v240, v219, s[36:39], s17 offen sc1
    v_mfma_f32_16x16x32_bf16 v[72:75], a[124:127], v[108:111], v[72:75]
    ds_read_b64_tr_b16 v[126:127], v169 offset:47104
    v_add_f32_dpp v230, v230, v230 row_ror:1 row_mask:0xf bank_mask:0xf
    v_mfma_f32_16x16x32_bf16 v[76:79], a[128:131], v[108:111], v[76:79]
    ds_read_b64_tr_b16 v[128:129], v170 offset:45056
    v_add_f32_dpp v231, v231, v231 row_ror:1 row_mask:0xf bank_mask:0xf
    s_mov_b32 exec_lo, 0x00010001
    s_mov_b32 exec_hi, 0x00010001
    ds_write_b64 v2, v[230:231]
    s_mov_b64 exec, -1
    v_lshlrev_b32 v2, 2, v1
    s_waitcnt lgkmcnt(10)
    v_mfma_f32_16x16x32_bf16 v[80:83], a[120:123], v[112:115], v[80:83]
    s_waitcnt lgkmcnt(6)
    s_barrier
    ds_read_b64_tr_b16 v[130:131], v170 offset:47104
    v_mfma_f32_16x16x32_bf16 v[84:87], a[124:127], v[112:115], v[84:87]
    ds_read_b64_tr_b16 a[204:205], v203 offset:24832
    buffer_load_dwordx4 a[252:255], v248, s[36:39], s62 offen offset:3072 sc1
    v_mfma_f32_16x16x32_bf16 v[88:91], a[128:131], v[112:115], v[88:91]
    ds_read_b64_tr_b16 v[132:133], v171 offset:45056
    ds_read_b64_tr_b16 a[206:207], v203 offset:26368
    v_mfma_f32_16x16x32_bf16 v[92:95], a[120:123], v[116:119], v[92:95]
    s_waitcnt lgkmcnt(3)
    ds_read_b64_tr_b16 v[134:135], v171 offset:47104
    v_and_b32 v2, 12, v2
    v_mfma_f32_16x16x32_bf16 v[96:99], a[124:127], v[116:119], v[96:99]
    s_add_u32 s62, s62, 4096
    ds_read_b64_tr_b16 a[208:209], v203 offset:31056
    v_add_u32 v2, 0, v2
    v_mfma_f32_16x16x32_bf16 v[100:103], a[128:131], v[116:119], v[100:103]
    s_waitcnt lgkmcnt(0)
    s_barrier
    ds_read_b64_tr_b16 a[210:211], v203 offset:32592
    buffer_load_dwordx4 v[136:139], v248, s[36:39], s62 offen offset:0 sc1
    v_mfma_f32_16x16x32_bf16 v[56:59], a[132:135], v[120:123], v[56:59]
    ds_read_b64_tr_b16 v[104:105], v168 offset:49152
    ds_read_b64_tr_b16 a[212:213], v204 offset:24832
    ds_read2_b32 v[230:231], v2 offset0:0 offset1:4
    v_mfma_f32_16x16x32_bf16 v[60:63], a[136:139], v[120:123], v[60:63]
    ds_read_b64_tr_b16 v[106:107], v168 offset:51200
    ds_read2_b32 v[232:233], v2 offset0:8 offset1:12
    v_mfma_f32_16x16x32_bf16 v[64:67], a[140:143], v[120:123], v[64:67]
    ds_read_b64_tr_b16 v[108:109], v169 offset:49152
    ds_read2_b32 v[234:235], v2 offset0:16 offset1:20
    v_mfma_f32_16x16x32_bf16 v[68:71], a[132:135], v[124:127], v[68:71]
    ds_read_b64_tr_b16 a[214:215], v204 offset:26368
    buffer_load_dwordx4 v[140:143], v248, s[36:39], s62 offen offset:1024 sc1
    v_mfma_f32_16x16x32_bf16 v[72:75], a[136:139], v[124:127], v[72:75]
    ds_read_b64_tr_b16 v[110:111], v169 offset:51200
    ds_read2_b32 v[236:237], v2 offset0:24 offset1:28
    v_mfma_f32_16x16x32_bf16 v[76:79], a[140:143], v[124:127], v[76:79]
    ds_read_b64_tr_b16 v[112:113], v170 offset:49152
    v_mov_b32 v225, s48
    v_mfma_f32_16x16x32_bf16 v[80:83], a[132:135], v[128:131], v[80:83]
    ds_read_b64_tr_b16 v[114:115], v170 offset:51200
    v_mov_b32 v227, s48
    v_mfma_f32_16x16x32_bf16 v[84:87], a[136:139], v[128:131], v[84:87]
    buffer_load_dwordx4 v[144:147], v248, s[36:39], s62 offen offset:2048 sc1
    v_mfma_f32_16x16x32_bf16 v[88:91], a[140:143], v[128:131], v[88:91]
    ds_read_b64_tr_b16 v[116:117], v171 offset:49152
    s_waitcnt lgkmcnt(8)
    v_add_f32 v230, v230, v232
    v_mfma_f32_16x16x32_bf16 v[92:95], a[132:135], v[132:135], v[92:95]
    s_waitcnt lgkmcnt(3)
    ds_read_b64_tr_b16 v[118:119], v171 offset:51200
    v_add_f32 v231, v231, v233
    v_mfma_f32_16x16x32_bf16 v[96:99], a[136:139], v[132:135], v[96:99]
    v_add_f32 v234, v234, v236
    v_add_f32 v235, v235, v237
    v_mfma_f32_16x16x32_bf16 v[100:103], a[140:143], v[132:135], v[100:103]
    buffer_load_dwordx4 v[148:151], v248, s[36:39], s62 offen offset:3072 sc1
    v_mfma_f32_16x16x32_bf16 v[56:59], a[144:147], v[104:107], v[56:59]
    s_waitcnt vmcnt(12)
    s_barrier
    ds_read_b64_tr_b16 v[120:121], v168 offset:53248
    v_add_f32 v230, v230, v234
    v_mfma_f32_16x16x32_bf16 v[60:63], a[148:151], v[104:107], v[60:63]
    ds_read_b64_tr_b16 v[122:123], v168 offset:55296
    ds_read_b64_tr_b16 a[216:217], v203 offset:37248
    v_mfma_f32_16x16x32_bf16 v[64:67], a[152:155], v[104:107], v[64:67]
    s_add_u32 s62, s62, 4096
    ds_read_b64_tr_b16 v[124:125], v169 offset:53248
    v_add_f32 v231, v231, v235
    v_mul_f32 v230, 0x3acccccd, v230
    v_mul_f32 v234, v230, v230
    v_mfma_f32_16x16x32_bf16 v[68:71], a[144:147], v[108:111], v[68:71]
    ds_read_b64_tr_b16 a[218:219], v203 offset:38784
    buffer_load_dwordx4 v[152:155], v248, s[36:39], s62 offen offset:0 sc1
    v_mfma_f32_16x16x32_bf16 v[72:75], a[148:151], v[108:111], v[72:75]
    ds_read_b64_tr_b16 v[126:127], v169 offset:55296
    ds_read_b64_tr_b16 a[220:221], v203 offset:43472
    v_mfma_f32_16x16x32_bf16 v[76:79], a[152:155], v[108:111], v[76:79]
    s_waitcnt lgkmcnt(9)
    ds_read_b64_tr_b16 v[128:129], v170 offset:53248
    ds_read_b64_tr_b16 a[222:223], v203 offset:45008
    v_mfma_f32_16x16x32_bf16 v[80:83], a[144:147], v[112:115], v[80:83]
    ds_read_b64_tr_b16 v[130:131], v170 offset:55296
    v_mov_b32 v224, 0x3acccccd
    v_fma_f32 v231, v231, v224, -v234
    v_mfma_f32_16x16x32_bf16 v[84:87], a[148:151], v[112:115], v[84:87]
    ds_read_b64_tr_b16 a[224:225], v204 offset:37248
    buffer_load_dwordx4 v[156:159], v248, s[36:39], s62 offen offset:1024 sc1
    v_mfma_f32_16x16x32_bf16 v[88:91], a[152:155], v[112:115], v[88:91]
    s_waitcnt lgkmcnt(11)
    ds_read_b64_tr_b16 v[132:133], v171 offset:53248
    v_max_f32 v231, 0, v231
    v_mfma_f32_16x16x32_bf16 v[92:95], a[144:147], v[116:119], v[92:95]
    s_waitcnt lgkmcnt(3)
    ds_read_b64_tr_b16 v[134:135], v171 offset:55296
    v_add_f32 v231, 0x3727c5ac, v231
    v_mfma_f32_16x16x32_bf16 v[96:99], a[148:151], v[116:119], v[96:99]
    ds_read_b64_tr_b16 a[226:227], v204 offset:38784
    v_rsq_f32 v224, v231
    v_mfma_f32_16x16x32_bf16 v[100:103], a[152:155], v[116:119], v[100:103]
    buffer_load_dwordx4 v[160:163], v248, s[36:39], s62 offen offset:2048 sc1
    v_mfma_f32_16x16x32_bf16 v[56:59], a[156:159], v[120:123], v[56:59]
    ds_read_b64_tr_b16 v[104:105], v168 offset:57344
    v_mul_f32_e64 v226, -v230, v224
    v_mfma_f32_16x16x32_bf16 v[60:63], a[160:163], v[120:123], v[60:63]
    ds_read_b64_tr_b16 v[106:107], v168 offset:59392
    s_mov_b64 exec, 0xf
    buffer_store_dwordx4 v[224:227], v248, s[36:39], s7 offen sc1
    s_mov_b64 exec, -1
    v_mfma_f32_16x16x32_bf16 v[64:67], a[164:167], v[120:123], v[64:67]
    ds_read_b64_tr_b16 v[108:109], v169 offset:57344
    v_mfma_f32_16x16x32_bf16 v[68:71], a[156:159], v[124:127], v[68:71]
    buffer_load_dwordx4 v[164:167], v248, s[36:39], s62 offen offset:3072 sc1
    v_mfma_f32_16x16x32_bf16 v[72:75], a[160:163], v[124:127], v[72:75]
    ds_read_b64_tr_b16 v[110:111], v169 offset:59392
    s_waitcnt vmcnt(9)
    v_cmp_ne_u32 vcc, s48, v240
    s_cbranch_vccnz L_chk25_slow
L_chk25_back:
    v_mfma_f32_16x16x32_bf16 v[76:79], a[164:167], v[124:127], v[76:79]
    s_waitcnt lgkmcnt(8)
    ds_read_b64_tr_b16 v[112:113], v170 offset:57344
    v_mfma_f32_16x16x32_bf16 v[80:83], a[156:159], v[128:131], v[80:83]
    s_waitcnt lgkmcnt(5)
    s_barrier
    s_add_u32 m0, s63, 81920
    ds_read_b64_tr_b16 v[114:115], v170 offset:59392
    v_mfma_f32_16x16x32_bf16 v[84:87], a[160:163], v[128:131], v[84:87]
    ds_read_b64_tr_b16 a[228:229], v203 offset:49664
    buffer_load_dwordx4 v172, s[36:39], s10 offen sc1 lds
    v_mfma_f32_16x16x32_bf16 v[88:91], a[164:167], v[128:131], v[88:91]
    ds_read_b64_tr_b16 v[116:117], v171 offset:57344
    ds_read_b64_tr_b16 a[230:231], v203 offset:51200
    v_mfma_f32_16x16x32_bf16 v[92:95], a[156:159], v[132:135], v[92:95]
    s_waitcnt lgkmcnt(3)
    ds_read_b64_tr_b16 v[118:119], v171 offset:59392
    v_and_b32 v247, 48, v1
    v_mfma_f32_16x16x32_bf16 v[96:99], a[160:163], v[132:135], v[96:99]
    s_add_u32 m0, s63, 86016
    buffer_load_dwordx4 v[176:179], v247, s[36:39], s9 offen offset:0 sc1
    v_mfma_f32_16x16x32_bf16 v[100:103], a[164:167], v[132:135], v[100:103]
    ds_read_b64_tr_b16 a[232:233], v203 offset:55888
    buffer_load_dwordx4 v172, s[36:39], s11 offen sc1 lds
    v_mfma_f32_16x16x32_bf16 v[56:59], a[168:171], v[104:107], v[56:59]
    ds_read_b64_tr_b16 v[120:121], v168 offset:61440
    ds_read_b64_tr_b16 a[234:235], v203 offset:57424
    v_mfma_f32_16x16x32_bf16 v[60:63], a[172:175], v[104:107], v[60:63]
    ds_read_b64_tr_b16 v[122:123], v168 offset:63488
    v_add_u32 v168, 65536, v168
    v_mfma_f32_16x16x32_bf16 v[64:67], a[176:179], v[104:107], v[64:67]
    s_add_u32 m0, s63, 90112
    ds_read_b64_tr_b16 v[124:125], v169 offset:61440
    ds_read_b64_tr_b16 a[236:237], v204 offset:49664
    v_mfma_f32_16x16x32_bf16 v[68:71], a[168:171], v[108:111], v[68:71]
    ds_read_b64_tr_b16 a[238:239], v204 offset:51200
    buffer_load_dwordx4 v172, s[36:39], s12 offen sc1 lds
    v_mfma_f32_16x16x32_bf16 v[72:75], a[172:175], v[108:111], v[72:75]
    ds_read_b64_tr_b16 v[126:127], v169 offset:63488
    v_add_u32 v169, 65536, v169
    v_mfma_f32_16x16x32_bf16 v[76:79], a[176:179], v[108:111], v[76:79]
    ds_read_b64_tr_b16 v[128:129], v170 offset:61440
    v_mfma_f32_16x16x32_bf16 v[80:83], a[168:171], v[112:115], v[80:83]
    ds_read_b64_tr_b16 v[130:131], v170 offset:63488
    v_add_u32 v170, 65536, v170
    v_mfma_f32_16x16x32_bf16 v[84:87], a[172:175], v[112:115], v[84:87]
    buffer_load_dwordx4 v[180:183], v247, s[36:39], s9 offen offset:64 sc1
    v_mfma_f32_16x16x32_bf16 v[88:91], a[176:179], v[112:115], v[88:91]
    s_waitcnt lgkmcnt(10)
    ds_read_b64_tr_b16 v[132:133], v171 offset:61440
    v_mfma_f32_16x16x32_bf16 v[92:95], a[168:171], v[116:119], v[92:95]
    s_waitcnt lgkmcnt(3)
    ds_read_b64_tr_b16 v[134:135], v171 offset:63488
    v_add_u32 v171, 65536, v171
    v_mfma_f32_16x16x32_bf16 v[96:99], a[172:175], v[116:119], v[96:99]
    s_add_u32 m0, s63, 94208
    v_mfma_f32_16x16x32_bf16 v[100:103], a[176:179], v[116:119], v[100:103]
    buffer_load_dwordx4 v172, s[36:39], s13 offen sc1 lds
    v_mfma_f32_16x16x32_bf16 v[56:59], a[180:183], v[120:123], v[56:59]
    s_barrier
    ds_read_b64_tr_b16 v[104:105], v168 offset:0
    v_mfma_f32_16x16x32_bf16 v[60:63], a[184:187], v[120:123], v[60:63]
    ds_read_b64_tr_b16 v[106:107], v168 offset:2048
    v_mfma_f32_16x16x32_bf16 v[64:67], a[188:191], v[120:123], v[64:67]
    ds_read_b64_tr_b16 v[108:109], v169 offset:0
    v_mfma_f32_16x16x32_bf16 v[68:71], a[180:183], v[124:127], v[68:71]
    buffer_load_dwordx4 v[184:187], v247, s[36:39], s9 offen offset:128 sc1
    v_mfma_f32_16x16x32_bf16 v[72:75], a[184:187], v[124:127], v[72:75]
    ds_read_b64_tr_b16 v[110:111], v169 offset:2048
    v_mfma_f32_16x16x32_bf16 v[76:79], a[188:191], v[124:127], v[76:79]
    s_waitcnt lgkmcnt(6)
    ds_read_b64_tr_b16 v[112:113], v170 offset:0
    v_mfma_f32_16x16x32_bf16 v[80:83], a[180:183], v[128:131], v[80:83]
    s_add_u32 m0, s63, 98304
    ds_read_b64_tr_b16 v[114:115], v170 offset:2048
    v_mfma_f32_16x16x32_bf16 v[84:87], a[184:187], v[128:131], v[84:87]
    buffer_load_dwordx4 v172, s[36:39], s14 offen sc1 lds
    v_mfma_f32_16x16x32_bf16 v[88:91], a[188:191], v[128:131], v[88:91]
    s_waitcnt lgkmcnt(6)
    ds_read_b64_tr_b16 v[116:117], v171 offset:0
    v_mfma_f32_16x16x32_bf16 v[92:95], a[180:183], v[132:135], v[92:95]
    s_waitcnt lgkmcnt(3)
    ds_read_b64_tr_b16 v[118:119], v171 offset:2048
    v_mfma_f32_16x16x32_bf16 v[96:99], a[184:187], v[132:135], v[96:99]
    s_add_u32 m0, s63, 102400
    buffer_load_dwordx4 v[188:191], v247, s[36:39], s9 offen offset:192 sc1
    v_mfma_f32_16x16x32_bf16 v[100:103], a[188:191], v[132:135], v[100:103]
    buffer_load_dwordx4 v172, s[36:39], s15 offen sc1 lds
    v_mfma_f32_16x16x32_bf16 v[56:59], a[192:195], v[104:107], v[56:59]
    ds_read_b64_tr_b16 v[120:121], v168 offset:4096
    v_mfma_f32_16x16x32_bf16 v[60:63], a[196:199], v[104:107], v[60:63]
    ds_read_b64_tr_b16 v[122:123], v168 offset:6144
    v_mfma_f32_16x16x32_bf16 v[64:67], a[200:203], v[104:107], v[64:67]
    s_add_u32 m0, s63, 106496
    ds_read_b64_tr_b16 v[124:125], v169 offset:4096
    v_mfma_f32_16x16x32_bf16 v[68:71], a[192:195], v[108:111], v[68:71]
    buffer_load_dwordx4 v172, s[36:39], s18 offen sc1 lds
    v_mfma_f32_16x16x32_bf16 v[72:75], a[196:199], v[108:111], v[72:75]
    ds_read_b64_tr_b16 v[126:127], v169 offset:6144
    v_mfma_f32_16x16x32_bf16 v[76:79], a[200:203], v[108:111], v[76:79]
    s_waitcnt lgkmcnt(6)
    ds_read_b64_tr_b16 v[128:129], v170 offset:4096
    v_mfma_f32_16x16x32_bf16 v[80:83], a[192:195], v[112:115], v[80:83]
    ds_read_b64_tr_b16 v[130:131], v170 offset:6144
    v_mfma_f32_16x16x32_bf16 v[84:87], a[196:199], v[112:115], v[84:87]
    buffer_load_dwordx4 v[192:195], v247, s[36:39], s9 offen offset:256 sc1
    v_mfma_f32_16x16x32_bf16 v[88:91], a[200:203], v[112:115], v[88:91]
    s_waitcnt lgkmcnt(6)
    ds_read_b64_tr_b16 v[132:133], v171 offset:4096
    v_mfma_f32_16x16x32_bf16 v[92:95], a[192:195], v[116:119], v[92:95]
    s_waitcnt lgkmcnt(3)
    ds_read_b64_tr_b16 v[134:135], v171 offset:6144
    v_mfma_f32_16x16x32_bf16 v[96:99], a[196:199], v[116:119], v[96:99]
    s_add_u32 m0, s63, 110592
    v_mfma_f32_16x16x32_bf16 v[100:103], a[200:203], v[116:119], v[100:103]
    buffer_load_dwordx4 v172, s[36:39], s19 offen sc1 lds
    v_mfma_f32_16x16x32_bf16 v[56:59], a[204:207], v[120:123], v[56:59]
    ds_read_b64_tr_b16 v[104:105], v168 offset:8192
    v_mfma_f32_16x16x32_bf16 v[60:63], a[208:211], v[120:123], v[60:63]
    ds_read_b64_tr_b16 v[106:107], v168 offset:10240
    v_mfma_f32_16x16x32_bf16 v[64:67], a[212:215], v[120:123], v[64:67]
    ds_read_b64_tr_b16 v[108:109], v169 offset:8192
    v_mfma_f32_16x16x32_bf16 v[68:71], a[204:207], v[124:127], v[68:71]
    buffer_load_dwordx4 v[196:199], v247, s[36:39], s9 offen offset:320 sc1
    v_mfma_f32_16x16x32_bf16 v[72:75], a[208:211], v[124:127], v[72:75]
    ds_read_b64_tr_b16 v[110:111], v169 offset:10240
    v_mfma_f32_16x16x32_bf16 v[76:79], a[212:215], v[124:127], v[76:79]
    s_waitcnt lgkmcnt(6)
    ds_read_b64_tr_b16 v[112:113], v170 offset:8192
    v_mfma_f32_16x16x32_bf16 v[80:83], a[204:207], v[128:131], v[80:83]
    s_add_u32 m0, s63, 114688
    ds_read_b64_tr_b16 v[114:115], v170 offset:10240
    v_mfma_f32_16x16x32_bf16 v[84:87], a[208:211], v[128:131], v[84:87]
    buffer_load_dwordx4 v172, s[36:39], s20 offen sc1 lds
    v_mfma_f32_16x16x32_bf16 v[88:91], a[212:215], v[128:131], v[88:91]
    s_waitcnt lgkmcnt(6)
    ds_read_b64_tr_b16 v[116:117], v171 offset:8192
    v_mfma_f32_16x16x32_bf16 v[92:95], a[204:207], v[132:135], v[92:95]
    s_waitcnt lgkmcnt(3)
    ds_read_b64_tr_b16 v[118:119], v171 offset:10240
    v_mfma_f32_16x16x32_bf16 v[96:99], a[208:211], v[132:135], v[96:99]
    s_add_u32 m0, s63, 118784
    v_mfma_f32_16x16x32_bf16 v[100:103], a[212:215], v[132:135], v[100:103]
    buffer_load_dwordx4 v172, s[36:39], s21 offen sc1 lds
    v_mfma_f32_16x16x32_bf16 v[56:59], a[216:219], v[104:107], v[56:59]
    ds_read_b64_tr_b16 v[120:121], v168 offset:12288
    v_mfma_f32_16x16x32_bf16 v[60:63], a[220:223], v[104:107], v[60:63]
    ds_read_b64_tr_b16 v[122:123], v168 offset:14336
    v_add_u32 v168, 16384, v168
    v_mfma_f32_16x16x32_bf16 v[64:67], a[224:227], v[104:107], v[64:67]
    s_add_u32 m0, s63, 122880
    ds_read_b64_tr_b16 v[124:125], v169 offset:12288
    v_mfma_f32_16x16x32_bf16 v[68:71], a[216:219], v[108:111], v[68:71]
    buffer_load_dwordx4 v172, s[36:39], s22 offen sc1 lds
    v_mfma_f32_16x16x32_bf16 v[72:75], a[220:223], v[108:111], v[72:75]
    ds_read_b64_tr_b16 v[126:127], v169 offset:14336
    v_add_u32 v169, 16384, v169
    v_mfma_f32_16x16x32_bf16 v[76:79], a[224:227], v[108:111], v[76:79]
    s_waitcnt lgkmcnt(6)
    ds_read_b64_tr_b16 v[128:129], v170 offset:12288
    v_mfma_f32_16x16x32_bf16 v[80:83], a[216:219], v[112:115], v[80:83]
    s_add_u32 m0, s63, 126976
    ds_read_b64_tr_b16 v[130:131], v170 offset:14336
    v_add_u32 v170, 16384, v170
    v_mfma_f32_16x16x32_bf16 v[84:87], a[220:223], v[112:115], v[84:87]
    buffer_load_dwordx4 v172, s[36:39], s23 offen sc1 lds
    v_mfma_f32_16x16x32_bf16 v[88:91], a[224:227], v[112:115], v[88:91]
    s_waitcnt lgkmcnt(6)
    ds_read_b64_tr_b16 v[132:133], v171 offset:12288
    v_mfma_f32_16x16x32_bf16 v[92:95], a[216:219], v[116:119], v[92:95]
    s_waitcnt lgkmcnt(3)
    ds_read_b64_tr_b16 v[134:135], v171 offset:14336
    v_add_u32 v171, 16384, v171
    v_mfma_f32_16x16x32_bf16 v[96:99], a[220:223], v[116:119], v[96:99]
    s_add_u32 m0, s63, 131072
    v_mfma_f32_16x16x32_bf16 v[100:103], a[224:227], v[116:119], v[100:103]
    buffer_load_dwordx4 v172, s[36:39], s24 offen sc1 lds
    v_mfma_f32_16x16x32_bf16 v[56:59], a[228:231], v[120:123], v[56:59]
    s_waitcnt vmcnt(16)
    s_barrier
    ds_read_b64_tr_b16 v[104:105], v168 offset:0
    v_mfma_f32_16x16x32_bf16 v[60:63], a[232:235], v[120:123], v[60:63]
    ds_read_b64_tr_b16 v[106:107], v168 offset:2048
    v_mfma_f32_16x16x32_bf16 v[64:67], a[236:239], v[120:123], v[64:67]
    s_add_u32 m0, s63, 135168
    ds_read_b64_tr_b16 v[108:109], v169 offset:0
    v_mfma_f32_16x16x32_bf16 v[68:71], a[228:231], v[124:127], v[68:71]
    buffer_load_dwordx4 v172, s[36:39], s25 offen sc1 lds
    v_mfma_f32_16x16x32_bf16 v[72:75], a[232:235], v[124:127], v[72:75]
    ds_read_b64_tr_b16 v[110:111], v169 offset:2048
    v_mfma_f32_16x16x32_bf16 v[76:79], a[236:239], v[124:127], v[76:79]
    s_waitcnt lgkmcnt(6)
    ds_read_b64_tr_b16 v[112:113], v170 offset:0
    v_mfma_f32_16x16x32_bf16 v[80:83], a[228:231], v[128:131], v[80:83]
    s_add_u32 m0, s63, 139264
    ds_read_b64_tr_b16 v[114:115], v170 offset:2048
    v_mfma_f32_16x16x32_bf16 v[84:87], a[232:235], v[128:131], v[84:87]
    buffer_load_dwordx4 v172, s[36:39], s26 offen sc1 lds
    v_mfma_f32_16x16x32_bf16 v[88:91], a[236:239], v[128:131], v[88:91]
    s_waitcnt lgkmcnt(6)
    ds_read_b64_tr_b16 v[116:117], v171 offset:0
    v_mfma_f32_16x16x32_bf16 v[92:95], a[228:231], v[132:135], v[92:95]
    s_waitcnt lgkmcnt(3)
    ds_read_b64_tr_b16 v[118:119], v171 offset:2048
    v_mfma_f32_16x16x32_bf16 v[96:99], a[232:235], v[132:135], v[96:99]
    v_mfma_f32_16x16x32_bf16 v[100:103], a[236:239], v[132:135], v[100:103]
    v_mfma_f32_16x16x32_bf16 v[8:11], a[0:3], v[104:107], 0
    ds_read_b64_tr_b16 v[120:121], v168 offset:4096
    v_add_u32 v216, 81920, v216
    v_mfma_f32_16x16x32_bf16 v[12:15], a[4:7], v[104:107], 0
    ds_read_b64_tr_b16 v[122:123], v168 offset:6144
    v_add_u32 v217, 81920, v217
    v_mfma_f32_16x16x32_bf16 v[16:19], a[8:11], v[104:107], 0
    ds_read_b64_tr_b16 v[124:125], v169 offset:4096
    v_add_u32 v218, 81920, v218
    v_mfma_f32_16x16x32_bf16 v[20:23], a[0:3], v[108:111], 0
    buffer_load_dwordx4 v[200:203], v175, s[36:39], s6 offen offset:0 sc1
    v_mfma_f32_16x16x32_bf16 v[24:27], a[4:7], v[108:111], 0
    ds_read_b64_tr_b16 v[126:127], v169 offset:6144
    v_mfma_f32_16x16x32_bf16 v[28:31], a[8:11], v[108:111], 0
    s_waitcnt lgkmcnt(6)
    ds_read_b64_tr_b16 v[128:129], v170 offset:4096
    v_mfma_f32_16x16x32_bf16 v[32:35], a[0:3], v[112:115], 0
    ds_read_b64_tr_b16 v[130:131], v170 offset:6144
    v_mfma_f32_16x16x32_bf16 v[36:39], a[4:7], v[112:115], 0
    buffer_load_dwordx4 v[204:207], v175, s[36:39], s6 offen offset:256 sc1
    v_mfma_f32_16x16x32_bf16 v[40:43], a[8:11], v[112:115], 0
    s_waitcnt lgkmcnt(6)
    ds_read_b64_tr_b16 v[132:133], v171 offset:4096
    v_mfma_f32_16x16x32_bf16 v[44:47], a[0:3], v[116:119], 0
    s_waitcnt lgkmcnt(3)
    ds_read_b64_tr_b16 v[134:135], v171 offset:6144
    v_mfma_f32_16x16x32_bf16 v[48:51], a[4:7], v[116:119], 0
    buffer_load_dwordx4 v[208:211], v175, s[36:39], s6 offen offset:512 sc1
    v_mfma_f32_16x16x32_bf16 v[52:55], a[8:11], v[116:119], 0
    buffer_load_dwordx4 v[212:215], v175, s[36:39], s6 offen offset:768 sc1
    v_mfma_f32_16x16x32_bf16 v[8:11], a[12:15], v[120:123], v[8:11]
    s_waitcnt vmcnt(17)
    s_barrier
    ds_read_b64_tr_b16 v[104:105], v168 offset:8192
    v_mfma_f32_16x16x32_bf16 v[12:15], a[16:19], v[120:123], v[12:15]
    ds_read_b64_tr_b16 v[106:107], v168 offset:10240
    v_mfma_f32_16x16x32_bf16 v[16:19], a[20:23], v[120:123], v[16:19]
    s_add_u32 m0, s63, 143360
    ds_read_b64_tr_b16 v[108:109], v169 offset:8192
    v_mfma_f32_16x16x32_bf16 v[20:23], a[12:15], v[124:127], v[20:23]
    buffer_load_dwordx4 v172, s[36:39], s27 offen sc1 lds
    v_mfma_f32_16x16x32_bf16 v[24:27], a[16:19], v[124:127], v[24:27]
    ds_read_b64_tr_b16 v[110:111], v169 offset:10240
    v_mfma_f32_16x16x32_bf16 v[28:31], a[20:23], v[124:127], v[28:31]
    s_waitcnt lgkmcnt(6)
    ds_read_b64_tr_b16 v[112:113], v170 offset:8192
    v_mfma_f32_16x16x32_bf16 v[32:35], a[12:15], v[128:131], v[32:35]
    s_add_u32 m0, s63, 147456
    ds_read_b64_tr_b16 v[114:115], v170 offset:10240
    v_mfma_f32_16x16x32_bf16 v[36:39], a[16:19], v[128:131], v[36:39]
    buffer_load_dwordx4 v172, s[36:39], s44 offen sc1 lds
    v_mfma_f32_16x16x32_bf16 v[40:43], a[20:23], v[128:131], v[40:43]
    s_waitcnt lgkmcnt(6)
    ds_read_b64_tr_b16 v[116:117], v171 offset:8192
    v_mfma_f32_16x16x32_bf16 v[44:47], a[12:15], v[132:135], v[44:47]
    s_waitcnt lgkmcnt(3)
    ds_read_b64_tr_b16 v[118:119], v171 offset:10240
    v_mfma_f32_16x16x32_bf16 v[48:51], a[16:19], v[132:135], v[48:51]
    s_add_u32 m0, s63, 151552
    v_mfma_f32_16x16x32_bf16 v[52:55], a[20:23], v[132:135], v[52:55]
    buffer_load_dwordx4 v172, s[36:39], s45 offen sc1 lds
    v_mfma_f32_16x16x32_bf16 v[8:11], a[24:27], v[104:107], v[8:11]
    ds_read_b64_tr_b16 v[120:121], v168 offset:12288
    v_mfma_f32_16x16x32_bf16 v[12:15], a[28:31], v[104:107], v[12:15]
    ds_read_b64_tr_b16 v[122:123], v168 offset:14336
    v_mfma_f32_16x16x32_bf16 v[16:19], a[32:35], v[104:107], v[16:19]
    s_add_u32 m0, s63, 155648
    ds_read_b64_tr_b16 v[124:125], v169 offset:12288
    v_mfma_f32_16x16x32_bf16 v[20:23], a[24:27], v[108:111], v[20:23]
    buffer_load_dwordx4 v172, s[36:39], s46 offen sc1 lds
    v_mfma_f32_16x16x32_bf16 v[24:27], a[28:31], v[108:111], v[24:27]
    ds_read_b64_tr_b16 v[126:127], v169 offset:14336
    v_mfma_f32_16x16x32_bf16 v[28:31], a[32:35], v[108:111], v[28:31]
    s_waitcnt lgkmcnt(6)
    ds_read_b64_tr_b16 v[128:129], v170 offset:12288
    v_mfma_f32_16x16x32_bf16 v[32:35], a[24:27], v[112:115], v[32:35]
    s_add_u32 m0, s63, 159744
    ds_read_b64_tr_b16 v[130:131], v170 offset:14336
    v_mfma_f32_16x16x32_bf16 v[36:39], a[28:31], v[112:115], v[36:39]
    buffer_load_dwordx4 v172, s[36:39], s47 offen sc1 lds
    v_mfma_f32_16x16x32_bf16 v[40:43], a[32:35], v[112:115], v[40:43]
    s_waitcnt lgkmcnt(6)
    ds_read_b64_tr_b16 v[132:133], v171 offset:12288
    v_mfma_f32_16x16x32_bf16 v[44:47], a[24:27], v[116:119], v[44:47]
    s_waitcnt lgkmcnt(3)
    ds_read_b64_tr_b16 v[134:135], v171 offset:14336
    v_mfma_f32_16x16x32_bf16 v[48:51], a[28:31], v[116:119], v[48:51]
    s_add_u32 s62, s62, 4096
    s_waitcnt vmcnt(8)
    v_xor_b32 v3, s48, v201
    v_bitop3_b32 v3, v203, s48, v3 bitop3:0xbe
    v_mfma_f32_16x16x32_bf16 v[52:55], a[32:35], v[116:119], v[52:55]
    buffer_load_dwordx4 a[0:3], v248, s[36:39], s62 offen offset:0 sc1
    v_mfma_f32_16x16x32_bf16 v[8:11], a[36:39], v[120:123], v[8:11]
    ds_read_b64_tr_b16 v[104:105], v168 offset:16384
    s_waitcnt vmcnt(8)
    v_bitop3_b32 v3, v205, s48, v3 bitop3:0xbe
    v_mfma_f32_16x16x32_bf16 v[12:15], a[40:43], v[120:123], v[12:15]
    ds_read_b64_tr_b16 v[106:107], v168 offset:18432
    v_bitop3_b32 v3, v207, s48, v3 bitop3:0xbe
    v_mfma_f32_16x16x32_bf16 v[16:19], a[44:47], v[120:123], v[16:19]
    ds_read_b64_tr_b16 v[108:109], v169 offset:16384
    s_waitcnt vmcnt(7)
    v_bitop3_b32 v3, v209, s48, v3 bitop3:0xbe
    v_mfma_f32_16x16x32_bf16 v[20:23], a[36:39], v[124:127], v[20:23]
    v_bitop3_b32 v3, v211, s48, v3 bitop3:0xbe
    buffer_load_dwordx4 a[4:7], v248, s[36:39], s62 offen offset:1024 sc1
    v_mfma_f32_16x16x32_bf16 v[24:27], a[40:43], v[124:127], v[24:27]
    ds_read_b64_tr_b16 v[110:111], v169 offset:18432
    s_waitcnt vmcnt(7)
    v_bitop3_b32 v3, v213, s48, v3 bitop3:0xbe
    v_mfma_f32_16x16x32_bf16 v[28:31], a[44:47], v[124:127], v[28:31]
    s_waitcnt lgkmcnt(6)
    ds_read_b64_tr_b16 v[112:113], v170 offset:16384
    v_bitop3_b32 v3, v215, s48, v3 bitop3:0xbe
    v_mfma_f32_16x16x32_bf16 v[32:35], a[36:39], v[128:131], v[32:35]
    ds_read_b64_tr_b16 v[114:115], v170 offset:18432
    v_cmp_ne_u32 vcc, 0, v3
    s_cbranch_vccnz L_stp0_slow
L_stp0_back:
    v_mfma_f32_16x16x32_bf16 v[36:39], a[40:43], v[128:131], v[36:39]
    s_add_u32 s50, s8, 98304
    v_pk_fma_f32 v[238:239], v[176:177], v[202:203], v[188:189] op_sel_hi:[1,0,1]
    v_pk_fma_f32 v[240:241], v[178:179], v[202:203], v[190:191] op_sel_hi:[1,0,1]
    v_pk_fma_f32 v[56:57], v[56:57], v[200:201], v[238:239] op_sel_hi:[1,0,1]
    v_pk_fma_f32 v[58:59], v[58:59], v[200:201], v[240:241] op_sel_hi:[1,0,1]
    v_pk_fma_f32 v[242:243], v[180:181], v[202:203], v[192:193] op_sel_hi:[1,0,1]
    v_pk_fma_f32 v[244:245], v[182:183], v[202:203], v[194:195] op_sel_hi:[1,0,1]
    v_pk_fma_f32 v[60:61], v[60:61], v[200:201], v[242:243] op_sel_hi:[1,0,1]
    v_pk_fma_f32 v[62:63], v[62:63], v[200:201], v[244:245] op_sel_hi:[1,0,1]
    v_pk_mul_f32 v[56:57], v[56:57], v[60:61]
    v_pk_mul_f32 v[58:59], v[58:59], v[62:63]
    v_cvt_pk_bf16_f32 v60, v56, v57
    v_cvt_pk_bf16_f32 v61, v58, v59
    v_pk_fma_f32 v[242:243], v[176:177], v[206:207], v[188:189] op_sel_hi:[1,0,1]
    v_pk_fma_f32 v[244:245], v[178:179], v[206:207], v[190:191] op_sel_hi:[1,0,1]
    v_pk_fma_f32 v[68:69], v[68:69], v[204:205], v[242:243] op_sel_hi:[1,0,1]
    v_pk_fma_f32 v[70:71], v[70:71], v[204:205], v[244:245] op_sel_hi:[1,0,1]
    v_pk_fma_f32 v[238:239], v[180:181], v[206:207], v[192:193] op_sel_hi:[1,0,1]
    v_pk_fma_f32 v[240:241], v[182:183], v[206:207], v[194:195] op_sel_hi:[1,0,1]
    v_pk_fma_f32 v[72:73], v[72:73], v[204:205], v[238:239] op_sel_hi:[1,0,1]
    v_pk_fma_f32 v[74:75], v[74:75], v[204:205], v[240:241] op_sel_hi:[1,0,1]
    v_pk_mul_f32 v[68:69], v[68:69], v[72:73]
    v_pk_mul_f32 v[70:71], v[70:71], v[74:75]
    v_cvt_pk_bf16_f32 v62, v68, v69
    v_cvt_pk_bf16_f32 v63, v70, v71
    s_nop 0
    v_permlane16_swap_b32 v60, v62
    v_permlane16_swap_b32 v61, v63
    buffer_store_dwordx4 v[60:63], v173, s[36:39], s8 offen sc1
    v_pk_fma_f32 v[238:239], v[176:177], v[210:211], v[188:189] op_sel_hi:[1,0,1]
    v_pk_fma_f32 v[240:241], v[178:179], v[210:211], v[190:191] op_sel_hi:[1,0,1]
    v_pk_fma_f32 v[80:81], v[80:81], v[208:209], v[238:239] op_sel_hi:[1,0,1]
    v_pk_fma_f32 v[82:83], v[82:83], v[208:209], v[240:241] op_sel_hi:[1,0,1]
    v_pk_fma_f32 v[242:243], v[180:181], v[210:211], v[192:193] op_sel_hi:[1,0,1]
    v_pk_fma_f32 v[244:245], v[182:183], v[210:211], v[194:195] op_sel_hi:[1,0,1]
    v_pk_fma_f32 v[84:85], v[84:85], v[208:209], v[242:243] op_sel_hi:[1,0,1]
    v_pk_fma_f32 v[86:87], v[86:87], v[208:209], v[244:245] op_sel_hi:[1,0,1]
    v_pk_mul_f32 v[80:81], v[80:81], v[84:85]
    v_pk_mul_f32 v[82:83], v[82:83], v[86:87]
    v_cvt_pk_bf16_f32 v84, v80, v81
    v_cvt_pk_bf16_f32 v85, v82, v83
    v_pk_fma_f32 v[242:243], v[176:177], v[214:215], v[188:189] op_sel_hi:[1,0,1]
    v_pk_fma_f32 v[244:245], v[178:179], v[214:215], v[190:191] op_sel_hi:[1,0,1]
    v_pk_fma_f32 v[92:93], v[92:93], v[212:213], v[242:243] op_sel_hi:[1,0,1]
    v_pk_fma_f32 v[94:95], v[94:95], v[212:213], v[244:245] op_sel_hi:[1,0,1]
    v_pk_fma_f32 v[238:239], v[180:181], v[214:215], v[192:193] op_sel_hi:[1,0,1]
    v_pk_fma_f32 v[240:241], v[182:183], v[214:215], v[194:195] op_sel_hi:[1,0,1]
    v_pk_fma_f32 v[96:97], v[96:97], v[212:213], v[238:239] op_sel_hi:[1,0,1]
    v_pk_fma_f32 v[98:99], v[98:99], v[212:213], v[240:241] op_sel_hi:[1,0,1]
    v_pk_mul_f32 v[92:93], v[92:93], v[96:97]
    v_pk_mul_f32 v[94:95], v[94:95], v[98:99]
    v_cvt_pk_bf16_f32 v86, v92, v93
    v_cvt_pk_bf16_f32 v87, v94, v95
    s_nop 0
    v_permlane16_swap_b32 v84, v86
    v_permlane16_swap_b32 v85, v87
    buffer_store_dwordx4 v[84:87], v173, s[36:39], s50 offen sc1
    v_pk_fma_f32 v[238:239], v[184:185], v[202:203], v[196:197] op_sel_hi:[1,0,1]
    v_pk_fma_f32 v[240:241], v[186:187], v[202:203], v[198:199] op_sel_hi:[1,0,1]
    v_pk_fma_f32 v[64:65], v[64:65], v[200:201], v[238:239] op_sel_hi:[1,0,1]
    v_pk_fma_f32 v[66:67], v[66:67], v[200:201], v[240:241] op_sel_hi:[1,0,1]
    v_pk_fma_f32 v[242:243], v[184:185], v[206:207], v[196:197] op_sel_hi:[1,0,1]
    v_pk_fma_f32 v[244:245], v[186:187], v[206:207], v[198:199] op_sel_hi:[1,0,1]
    v_pk_fma_f32 v[76:77], v[76:77], v[204:205], v[242:243] op_sel_hi:[1,0,1]
    v_pk_fma_f32 v[78:79], v[78:79], v[204:205], v[244:245] op_sel_hi:[1,0,1]
    s_nop 0
    v_permlane32_swap_b32 v64, v76
    v_permlane32_swap_b32 v65, v77
    v_permlane32_swap_b32 v66, v78
    v_permlane32_swap_b32 v67, v79
    v_pk_mul_f32 v[64:65], v[64:65], v[76:77]
    v_pk_mul_f32 v[66:67], v[66:67], v[78:79]
    v_cvt_pk_bf16_f32 v56, v64, v65
    v_cvt_pk_bf16_f32 v57, v66, v67
    v_pk_fma_f32 v[238:239], v[184:185], v[210:211], v[196:197] op_sel_hi:[1,0,1]
    v_pk_fma_f32 v[240:241], v[186:187], v[210:211], v[198:199] op_sel_hi:[1,0,1]
    v_pk_fma_f32 v[88:89], v[88:89], v[208:209], v[238:239] op_sel_hi:[1,0,1]
    v_pk_fma_f32 v[90:91], v[90:91], v[208:209], v[240:241] op_sel_hi:[1,0,1]
    v_pk_fma_f32 v[242:243], v[184:185], v[214:215], v[196:197] op_sel_hi:[1,0,1]
    v_pk_fma_f32 v[244:245], v[186:187], v[214:215], v[198:199] op_sel_hi:[1,0,1]
    v_pk_fma_f32 v[100:101], v[100:101], v[212:213], v[242:243] op_sel_hi:[1,0,1]
    v_pk_fma_f32 v[102:103], v[102:103], v[212:213], v[244:245] op_sel_hi:[1,0,1]
    s_nop 0
    v_permlane32_swap_b32 v88, v100
    v_permlane32_swap_b32 v89, v101
    v_permlane32_swap_b32 v90, v102
    v_permlane32_swap_b32 v91, v103
    v_pk_mul_f32 v[88:89], v[88:89], v[100:101]
    v_pk_mul_f32 v[90:91], v[90:91], v[102:103]
    v_cvt_pk_bf16_f32 v58, v88, v89
    v_cvt_pk_bf16_f32 v59, v90, v91
    s_nop 0
    v_permlane16_swap_b32 v56, v58
    v_permlane16_swap_b32 v57, v59
    buffer_store_dwordx4 v[56:59], v174, s[36:39], s8 offen offset:512 sc1
    s_add_u32 s6, s6, 16384
    s_lshl_b32 s76, s72, 4
    s_add_u32 s76, s76, s73
    buffer_load_dwordx4 a[8:11], v248, s[36:39], s62 offen offset:2048 sc1
    v_mfma_f32_16x16x32_bf16 v[40:43], a[44:47], v[128:131], v[40:43]
    s_waitcnt lgkmcnt(6)
    ds_read_b64_tr_b16 v[116:117], v171 offset:16384
    v_mfma_f32_16x16x32_bf16 v[44:47], a[36:39], v[132:135], v[44:47]
    s_waitcnt lgkmcnt(3)
    ds_read_b64_tr_b16 v[118:119], v171 offset:18432
    v_mfma_f32_16x16x32_bf16 v[48:51], a[40:43], v[132:135], v[48:51]
    v_mfma_f32_16x16x32_bf16 v[52:55], a[44:47], v[132:135], v[52:55]
    buffer_load_dwordx4 a[12:15], v248, s[36:39], s62 offen offset:3072 sc1
    v_mfma_f32_16x16x32_bf16 v[8:11], a[48:51], v[104:107], v[8:11]
    s_waitcnt vmcnt(7)
    s_barrier
    ds_read_b64_tr_b16 v[120:121], v168 offset:20480
    v_mfma_f32_16x16x32_bf16 v[12:15], a[52:55], v[104:107], v[12:15]
    ds_read_b64_tr_b16 v[122:123], v168 offset:22528
    ds_read_b64 v[224:225], v216
    v_mfma_f32_16x16x32_bf16 v[16:19], a[56:59], v[104:107], v[16:19]
    s_add_u32 s62, s62, 4096
    ds_read_b64_tr_b16 v[124:125], v169 offset:20480
    ds_read_b64 v[226:227], v217
    v_mfma_f32_16x16x32_bf16 v[20:23], a[48:51], v[108:111], v[20:23]
    buffer_load_dwordx4 a[16:19], v248, s[36:39], s62 offen offset:0 sc1
    v_mfma_f32_16x16x32_bf16 v[24:27], a[52:55], v[108:111], v[24:27]
    ds_read_b64_tr_b16 v[126:127], v169 offset:22528
    ds_read_b64 v[228:229], v218
    v_mfma_f32_16x16x32_bf16 v[28:31], a[56:59], v[108:111], v[28:31]
    s_waitcnt lgkmcnt(9)
    ds_read_b64_tr_b16 v[128:129], v170 offset:20480
    v_mfma_f32_16x16x32_bf16 v[32:35], a[48:51], v[112:115], v[32:35]
    ds_read_b64_tr_b16 v[130:131], v170 offset:22528
    v_mfma_f32_16x16x32_bf16 v[36:39], a[52:55], v[112:115], v[36:39]
    buffer_load_dwordx4 a[20:23], v248, s[36:39], s62 offen offset:1024 sc1
    v_mfma_f32_16x16x32_bf16 v[40:43], a[56:59], v[112:115], v[40:43]
    s_waitcnt lgkmcnt(9)
    ds_read_b64_tr_b16 v[132:133], v171 offset:20480
    v_mfma_f32_16x16x32_bf16 v[44:47], a[48:51], v[116:119], v[44:47]
    s_waitcnt lgkmcnt(3)
    ds_read_b64_tr_b16 v[134:135], v171 offset:22528
    v_mfma_f32_16x16x32_bf16 v[48:51], a[52:55], v[116:119], v[48:51]
    v_lshlrev_b32 v230, 16, v224
    v_and_b32 v231, 0xffff0000, v224
    v_pk_mul_f32 v[230:231], v[230:231], v[220:221] op_sel_hi:[1,0]
    v_pk_mul_f32 v[234:235], v[230:231], v[230:231]
    v_lshlrev_b32 v232, 16, v225
    v_and_b32 v233, 0xffff0000, v225
    v_pk_mul_f32 v[232:233], v[232:233], v[220:221] op_sel_hi:[1,0]
    v_pk_mul_f32 v[236:237], v[232:233], v[232:233]
    v_lshlrev_b32 v2, 16, v226
    v_and_b32 v3, 0xffff0000, v226
    v_pk_mul_f32 v[2:3], v[2:3], v[220:221] op_sel:[0,1] op_sel_hi:[1,1]
    v_pk_add_f32 v[230:231], v[230:231], v[2:3]
    v_pk_fma_f32 v[234:235], v[2:3], v[2:3], v[234:235]
    v_lshlrev_b32 v2, 16, v227
    v_and_b32 v3, 0xffff0000, v227
    v_pk_mul_f32 v[2:3], v[2:3], v[220:221] op_sel:[0,1] op_sel_hi:[1,1]
    v_pk_add_f32 v[232:233], v[232:233], v[2:3]
    v_pk_fma_f32 v[236:237], v[2:3], v[2:3], v[236:237]
    v_lshlrev_b32 v2, 16, v228
    v_and_b32 v3, 0xffff0000, v228
    v_pk_mul_f32 v[2:3], v[2:3], v[222:223] op_sel_hi:[1,0]
    v_pk_add_f32 v[230:231], v[230:231], v[2:3]
    v_pk_fma_f32 v[234:235], v[2:3], v[2:3], v[234:235]
    v_lshlrev_b32 v2, 16, v229
    v_and_b32 v3, 0xffff0000, v229
    v_pk_mul_f32 v[2:3], v[2:3], v[222:223] op_sel_hi:[1,0]
    v_pk_add_f32 v[232:233], v[232:233], v[2:3]
    v_pk_fma_f32 v[236:237], v[2:3], v[2:3], v[236:237]
    v_mfma_f32_16x16x32_bf16 v[52:55], a[56:59], v[116:119], v[52:55]
    buffer_load_dwordx4 a[24:27], v248, s[36:39], s62 offen offset:2048 sc1
    v_mfma_f32_16x16x32_bf16 v[8:11], a[60:63], v[120:123], v[8:11]
    ds_read_b64_tr_b16 v[104:105], v168 offset:24576
    v_permlane32_swap_b32 v230, v234
    v_mfma_f32_16x16x32_bf16 v[12:15], a[64:67], v[120:123], v[12:15]
    ds_read_b64_tr_b16 v[106:107], v168 offset:26624
    v_permlane32_swap_b32 v231, v235
    v_mfma_f32_16x16x32_bf16 v[16:19], a[68:71], v[120:123], v[16:19]
    ds_read_b64_tr_b16 v[108:109], v169 offset:24576
    v_permlane32_swap_b32 v232, v236
    v_mfma_f32_16x16x32_bf16 v[20:23], a[60:63], v[124:127], v[20:23]
    buffer_load_dwordx4 a[28:31], v248, s[36:39], s62 offen offset:3072 sc1
    v_mfma_f32_16x16x32_bf16 v[24:27], a[64:67], v[124:127], v[24:27]
    ds_read_b64_tr_b16 v[110:111], v169 offset:26624
    v_permlane32_swap_b32 v233, v237
    v_mfma_f32_16x16x32_bf16 v[28:31], a[68:71], v[124:127], v[28:31]
    s_waitcnt lgkmcnt(6)
    ds_read_b64_tr_b16 v[112:113], v170 offset:24576
    v_add_f32 v230, v230, v234
    v_mfma_f32_16x16x32_bf16 v[32:35], a[60:63], v[128:131], v[32:35]
    s_add_u32 s62, s62, 4096
    ds_read_b64_tr_b16 v[114:115], v170 offset:26624
    v_add_f32 v231, v231, v235
    v_add_f32 v232, v232, v236
    v_mfma_f32_16x16x32_bf16 v[36:39], a[64:67], v[128:131], v[36:39]
    buffer_load_dwordx4 a[32:35], v248, s[36:39], s62 offen offset:0 sc1
    v_mfma_f32_16x16x32_bf16 v[40:43], a[68:71], v[128:131], v[40:43]
    s_waitcnt lgkmcnt(6)
    ds_read_b64_tr_b16 v[116:117], v171 offset:24576
    v_add_f32 v233, v233, v237
    v_mfma_f32_16x16x32_bf16 v[44:47], a[60:63], v[132:135], v[44:47]
    s_waitcnt lgkmcnt(3)
    ds_read_b64_tr_b16 v[118:119], v171 offset:26624
    v_permlane16_swap_b32 v230, v232
    v_mfma_f32_16x16x32_bf16 v[48:51], a[64:67], v[132:135], v[48:51]
    v_permlane16_swap_b32 v231, v233
    v_mfma_f32_16x16x32_bf16 v[52:55], a[68:71], v[132:135], v[52:55]
    buffer_load_dwordx4 a[36:39], v248, s[36:39], s62 offen offset:1024 sc1
    v_mfma_f32_16x16x32_bf16 v[8:11], a[72:75], v[104:107], v[8:11]
    ds_read_b64_tr_b16 v[120:121], v168 offset:28672
    v_add_f32 v230, v230, v232
    v_mfma_f32_16x16x32_bf16 v[12:15], a[76:79], v[104:107], v[12:15]
    ds_read_b64_tr_b16 v[122:123], v168 offset:30720
    v_add_f32 v231, v231, v233
    v_mfma_f32_16x16x32_bf16 v[16:19], a[80:83], v[104:107], v[16:19]
    ds_read_b64_tr_b16 v[124:125], v169 offset:28672
    v_lshrrev_b32 v2, 4, v1
    v_mfma_f32_16x16x32_bf16 v[20:23], a[72:75], v[108:111], v[20:23]
    buffer_load_dwordx4 a[40:43], v248, s[36:39], s62 offen offset:2048 sc1
    v_mfma_f32_16x16x32_bf16 v[24:27], a[76:79], v[108:111], v[24:27]
    ds_read_b64_tr_b16 v[126:127], v169 offset:30720
    v_lshlrev_b32 v2, 3, v2
    v_mfma_f32_16x16x32_bf16 v[28:31], a[80:83], v[108:111], v[28:31]
    s_waitcnt lgkmcnt(6)
    s_lshl_b32 s50, s3, 5
    s_add_u32 s50, s50, 0
    ds_read_b64_tr_b16 v[128:129], v170 offset:28672
    v_mfma_f32_16x16x32_bf16 v[32:35], a[72:75], v[112:115], v[32:35]
    ds_read_b64_tr_b16 v[130:131], v170 offset:30720
    v_add_u32 v2, s50, v2
    v_mfma_f32_16x16x32_bf16 v[36:39], a[76:79], v[112:115], v[36:39]
    buffer_load_dwordx4 a[44:47], v248, s[36:39], s62 offen offset:3072 sc1
    v_mfma_f32_16x16x32_bf16 v[40:43], a[80:83], v[112:115], v[40:43]
    s_waitcnt lgkmcnt(6)
    ds_read_b64_tr_b16 v[132:133], v171 offset:28672
    v_add_f32_dpp v230, v230, v230 row_ror:8 row_mask:0xf bank_mask:0xf
    v_mfma_f32_16x16x32_bf16 v[44:47], a[72:75], v[116:119], v[44:47]
    s_waitcnt lgkmcnt(3)
    ds_read_b64_tr_b16 v[134:135], v171 offset:30720
    v_add_f32_dpp v231, v231, v231 row_ror:8 row_mask:0xf bank_mask:0xf
    v_mfma_f32_16x16x32_bf16 v[48:51], a[76:79], v[116:119], v[48:51]
    s_add_u32 s62, s62, 4096
    v_add_f32_dpp v230, v230, v230 row_ror:4 row_mask:0xf bank_mask:0xf
    v_add_f32_dpp v231, v231, v231 row_ror:4 row_mask:0xf bank_mask:0xf
    v_mfma_f32_16x16x32_bf16 v[52:55], a[80:83], v[116:119], v[52:55]
    s_waitcnt vmcnt(10)
    s_barrier
    s_cmp_eq_u32 s3, 0
    s_cbranch_scc0 L_wf26
    s_lshl_b32 s54, s76, 7
    s_add_u32 s54, s54, 23288832
    v_mov_b32 v254, 0
    v_mov_b32 v255, s48
    s_mov_b64 exec, 1
    buffer_store_dword v255, v254, s[36:39], s54 offen sc1
    s_mov_b64 exec, -1
L_wf26:
    buffer_load_dwordx4 a[48:51], v248, s[36:39], s62 offen offset:0 sc1
    v_mfma_f32_16x16x32_bf16 v[8:11], a[84:87], v[120:123], v[8:11]
    ds_read_b64_tr_b16 v[104:105], v168 offset:32768
    v_add_f32_dpp v230, v230, v230 row_ror:2 row_mask:0xf bank_mask:0xf
    v_mfma_f32_16x16x32_bf16 v[12:15], a[88:91], v[120:123], v[12:15]
    ds_read_b64_tr_b16 v[106:107], v168 offset:34816
    v_add_f32_dpp v231, v231, v231 row_ror:2 row_mask:0xf bank_mask:0xf
    v_mfma_f32_16x16x32_bf16 v[16:19], a[92:95], v[120:123], v[16:19]
    ds_read_b64_tr_b16 v[108:109], v169 offset:32768
    v_add_f32_dpp v230, v230, v230 row_ror:1 row_mask:0xf bank_mask:0xf
    v_mfma_f32_16x16x32_bf16 v[20:23], a[84:87], v[124:127], v[20:23]
    buffer_load_dwordx4 a[52:55], v248, s[36:39], s62 offen offset:1024 sc1
    v_mfma_f32_16x16x32_bf16 v[24:27], a[88:91], v[124:127], v[24:27]
    ds_read_b64_tr_b16 v[110:111], v169 offset:34816
    v_add_f32_dpp v231, v231, v231 row_ror:1 row_mask:0xf bank_mask:0xf
    v_mfma_f32_16x16x32_bf16 v[28:31], a[92:95], v[124:127], v[28:31]
    ds_read_b64_tr_b16 v[112:113], v170 offset:32768
    s_mov_b32 exec_lo, 0x00010001
    s_mov_b32 exec_hi, 0x00010001
    ds_write_b64 v2, v[230:231]
    s_mov_b64 exec, -1
    s_waitcnt lgkmcnt(8)
    v_mfma_f32_16x16x32_bf16 v[32:35], a[84:87], v[128:131], v[32:35]
    ds_read_b64_tr_b16 v[114:115], v170 offset:34816
    v_lshlrev_b32 v2, 2, v1
    v_mfma_f32_16x16x32_bf16 v[36:39], a[88:91], v[128:131], v[36:39]
    buffer_load_dwordx4 a[56:59], v248, s[36:39], s62 offen offset:2048 sc1
    v_mfma_f32_16x16x32_bf16 v[40:43], a[92:95], v[128:131], v[40:43]
    s_waitcnt lgkmcnt(7)
    ds_read_b64_tr_b16 v[116:117], v171 offset:32768
    v_and_b32 v2, 12, v2
    v_mfma_f32_16x16x32_bf16 v[44:47], a[84:87], v[132:135], v[44:47]
    s_waitcnt lgkmcnt(3)
    ds_read_b64_tr_b16 v[118:119], v171 offset:34816
    v_add_u32 v2, 0, v2
    v_mfma_f32_16x16x32_bf16 v[48:51], a[88:91], v[132:135], v[48:51]
    s_waitcnt lgkmcnt(0)
    s_barrier
    v_mfma_f32_16x16x32_bf16 v[52:55], a[92:95], v[132:135], v[52:55]
    buffer_load_dwordx4 a[60:63], v248, s[36:39], s62 offen offset:3072 sc1
    v_mfma_f32_16x16x32_bf16 v[8:11], a[96:99], v[104:107], v[8:11]
    ds_read_b64_tr_b16 v[120:121], v168 offset:36864
    ds_read2_b32 v[230:231], v2 offset0:0 offset1:4
    v_mfma_f32_16x16x32_bf16 v[12:15], a[100:103], v[104:107], v[12:15]
    ds_read_b64_tr_b16 v[122:123], v168 offset:38912
    ds_read2_b32 v[232:233], v2 offset0:8 offset1:12
    v_mfma_f32_16x16x32_bf16 v[16:19], a[104:107], v[104:107], v[16:19]
    s_add_u32 s62, s62, 4096
    ds_read_b64_tr_b16 v[124:125], v169 offset:36864
    ds_read2_b32 v[234:235], v2 offset0:16 offset1:20
    ds_read2_b32 v[236:237], v2 offset0:24 offset1:28
    v_mfma_f32_16x16x32_bf16 v[20:23], a[96:99], v[108:111], v[20:23]
    buffer_load_dwordx4 a[64:67], v248, s[36:39], s62 offen offset:0 sc1
    v_mfma_f32_16x16x32_bf16 v[24:27], a[100:103], v[108:111], v[24:27]
    ds_read_b64_tr_b16 v[126:127], v169 offset:38912
    v_mov_b32 v225, s48
    v_mfma_f32_16x16x32_bf16 v[28:31], a[104:107], v[108:111], v[28:31]
    ds_read_b64_tr_b16 v[128:129], v170 offset:36864
    v_mov_b32 v227, s48
    v_mfma_f32_16x16x32_bf16 v[32:35], a[96:99], v[112:115], v[32:35]
    s_add_u32 s7, s7, 16384
    ds_read_b64_tr_b16 v[130:131], v170 offset:38912
    s_waitcnt lgkmcnt(6)
    v_add_f32 v230, v230, v232
    v_mfma_f32_16x16x32_bf16 v[36:39], a[100:103], v[112:115], v[36:39]
    buffer_load_dwordx4 a[68:71], v248, s[36:39], s62 offen offset:1024 sc1
    v_mfma_f32_16x16x32_bf16 v[40:43], a[104:107], v[112:115], v[40:43]
    ds_read_b64_tr_b16 v[132:133], v171 offset:36864
    v_add_f32 v231, v231, v233
    v_mfma_f32_16x16x32_bf16 v[44:47], a[96:99], v[116:119], v[44:47]
    s_waitcnt lgkmcnt(3)
    ds_read_b64_tr_b16 v[134:135], v171 offset:38912
    v_add_f32 v234, v234, v236
    v_mfma_f32_16x16x32_bf16 v[48:51], a[100:103], v[116:119], v[48:51]
    v_mfma_f32_16x16x32_bf16 v[52:55], a[104:107], v[116:119], v[52:55]
    buffer_load_dwordx4 a[72:75], v248, s[36:39], s62 offen offset:2048 sc1
    v_mfma_f32_16x16x32_bf16 v[8:11], a[108:111], v[120:123], v[8:11]
    ds_read_b64_tr_b16 v[104:105], v168 offset:40960
    v_add_f32 v235, v235, v237
    v_mfma_f32_16x16x32_bf16 v[12:15], a[112:115], v[120:123], v[12:15]
    ds_read_b64_tr_b16 v[106:107], v168 offset:43008
    v_add_f32 v230, v230, v234
    v_mfma_f32_16x16x32_bf16 v[16:19], a[116:119], v[120:123], v[16:19]
    ds_read_b64_tr_b16 v[108:109], v169 offset:40960
    v_add_f32 v231, v231, v235
    v_mfma_f32_16x16x32_bf16 v[20:23], a[108:111], v[124:127], v[20:23]
    buffer_load_dwordx4 a[76:79], v248, s[36:39], s62 offen offset:3072 sc1
    v_mfma_f32_16x16x32_bf16 v[24:27], a[112:115], v[124:127], v[24:27]
    ds_read_b64_tr_b16 v[110:111], v169 offset:43008
    v_mul_f32 v230, 0x3acccccd, v230
    v_mfma_f32_16x16x32_bf16 v[28:31], a[116:119], v[124:127], v[28:31]
    s_waitcnt lgkmcnt(6)
    ds_read_b64_tr_b16 v[112:113], v170 offset:40960
    v_mul_f32 v234, v230, v230
    v_mfma_f32_16x16x32_bf16 v[32:35], a[108:111], v[128:131], v[32:35]
    s_add_u32 s62, s62, 4096
    ds_read_b64_tr_b16 v[114:115], v170 offset:43008
    v_mov_b32 v224, 0x3acccccd
    v_fma_f32 v231, v231, v224, -v234
    v_mfma_f32_16x16x32_bf16 v[36:39], a[112:115], v[128:131], v[36:39]
    buffer_load_dwordx4 a[80:83], v248, s[36:39], s62 offen offset:0 sc1
    v_mfma_f32_16x16x32_bf16 v[40:43], a[116:119], v[128:131], v[40:43]
    s_waitcnt lgkmcnt(6)
    ds_read_b64_tr_b16 v[116:117], v171 offset:40960
    v_max_f32 v231, 0, v231
    v_mfma_f32_16x16x32_bf16 v[44:47], a[108:111], v[132:135], v[44:47]
    s_waitcnt lgkmcnt(3)
    ds_read_b64_tr_b16 v[118:119], v171 offset:43008
    v_add_f32 v231, 0x3727c5ac, v231
    v_mfma_f32_16x16x32_bf16 v[48:51], a[112:115], v[132:135], v[48:51]
    v_rsq_f32 v224, v231
    v_mfma_f32_16x16x32_bf16 v[52:55], a[116:119], v[132:135], v[52:55]
    buffer_load_dwordx4 a[84:87], v248, s[36:39], s62 offen offset:1024 sc1
    v_mfma_f32_16x16x32_bf16 v[8:11], a[120:123], v[104:107], v[8:11]
    ds_read_b64_tr_b16 v[120:121], v168 offset:45056
    v_mul_f32_e64 v226, -v230, v224
    v_mfma_f32_16x16x32_bf16 v[12:15], a[124:127], v[104:107], v[12:15]
    ds_read_b64_tr_b16 v[122:123], v168 offset:47104
    s_mov_b64 exec, 0xf
    buffer_store_dwordx4 v[224:227], v248, s[36:39], s7 offen sc1
    s_mov_b64 exec, -1
    v_mfma_f32_16x16x32_bf16 v[16:19], a[128:131], v[104:107], v[16:19]
    s_and_b32 s50, s3, 1
    s_lshl_b32 s51, s74, 1
    ds_read_b64_tr_b16 v[124:125], v169 offset:45056
    v_mfma_f32_16x16x32_bf16 v[20:23], a[120:123], v[108:111], v[20:23]
    buffer_load_dwordx4 a[88:91], v248, s[36:39], s62 offen offset:2048 sc1
    v_mfma_f32_16x16x32_bf16 v[24:27], a[124:127], v[108:111], v[24:27]
    s_add_u32 s52, s51, s50
    s_mul_i32 s52, s52, 192
    ds_read_b64_tr_b16 v[126:127], v169 offset:47104
    v_mfma_f32_16x16x32_bf16 v[28:31], a[128:131], v[108:111], v[28:31]
    s_waitcnt lgkmcnt(6)
    s_mul_i32 s53, s3, 48
    s_add_u32 s52, s52, s53
    ds_read_b64_tr_b16 v[128:129], v170 offset:45056
    v_mfma_f32_16x16x32_bf16 v[32:35], a[120:123], v[112:115], v[32:35]
    s_lshl_b32 s52, s52, 8
    s_add_u32 s52, s52, 16777216
    ds_read_b64_tr_b16 v[130:131], v170 offset:47104
    v_mfma_f32_16x16x32_bf16 v[36:39], a[124:127], v[112:115], v[36:39]
    buffer_load_dwordx4 a[92:95], v248, s[36:39], s62 offen offset:3072 sc1
    v_mfma_f32_16x16x32_bf16 v[40:43], a[128:131], v[112:115], v[40:43]
    s_waitcnt lgkmcnt(6)
    ds_read_b64_tr_b16 v[132:133], v171 offset:45056
    v_add_u32 v216, s52, v248
    v_mfma_f32_16x16x32_bf16 v[44:47], a[120:123], v[116:119], v[44:47]
    s_waitcnt lgkmcnt(3)
    ds_read_b64_tr_b16 v[134:135], v171 offset:47104
    v_add_u32 v218, 3145728, v216
    v_mfma_f32_16x16x32_bf16 v[48:51], a[124:127], v[116:119], v[48:51]
    s_add_u32 s62, s62, 4096
    v_mfma_f32_16x16x32_bf16 v[52:55], a[128:131], v[116:119], v[52:55]
    buffer_load_dwordx4 a[96:99], v248, s[36:39], s62 offen offset:0 sc1
    v_mfma_f32_16x16x32_bf16 v[8:11], a[132:135], v[120:123], v[8:11]
    s_xor_b32 s50, s50, 1
    s_add_u32 s52, s51, s50
    ds_read_b64_tr_b16 v[104:105], v168 offset:49152
    v_mfma_f32_16x16x32_bf16 v[12:15], a[136:139], v[120:123], v[12:15]
    s_mul_i32 s52, s52, 192
    s_add_u32 s52, s52, s53
    ds_read_b64_tr_b16 v[106:107], v168 offset:51200
    v_mfma_f32_16x16x32_bf16 v[16:19], a[140:143], v[120:123], v[16:19]
    s_lshl_b32 s52, s52, 8
    s_add_u32 s52, s52, 16777216
    ds_read_b64_tr_b16 v[108:109], v169 offset:49152
    v_mfma_f32_16x16x32_bf16 v[20:23], a[132:135], v[124:127], v[20:23]
    buffer_load_dwordx4 a[100:103], v248, s[36:39], s62 offen offset:1024 sc1
    v_mfma_f32_16x16x32_bf16 v[24:27], a[136:139], v[124:127], v[24:27]
    ds_read_b64_tr_b16 v[110:111], v169 offset:51200
    v_add_u32 v217, s52, v248
    v_mfma_f32_16x16x32_bf16 v[28:31], a[140:143], v[124:127], v[28:31]
    s_waitcnt lgkmcnt(6)
    ds_read_b64_tr_b16 v[112:113], v170 offset:49152
    v_add_u32 v219, 3145728, v217
    v_mfma_f32_16x16x32_bf16 v[32:35], a[132:135], v[128:131], v[32:35]
    s_lshr_b32 s50, s74, 1
    s_lshl_b32 s50, s50, 2
    ds_read_b64_tr_b16 v[114:115], v170 offset:51200
    v_mfma_f32_16x16x32_bf16 v[36:39], a[136:139], v[128:131], v[36:39]
    buffer_load_dwordx4 a[104:107], v248, s[36:39], s62 offen offset:2048 sc1
    v_mfma_f32_16x16x32_bf16 v[40:43], a[140:143], v[128:131], v[40:43]
    s_waitcnt lgkmcnt(6)
    s_add_u32 s50, s50, s3
    s_lshl_b32 s50, s50, 9
    ds_read_b64_tr_b16 v[116:117], v171 offset:49152
    v_mfma_f32_16x16x32_bf16 v[44:47], a[132:135], v[132:135], v[44:47]
    s_waitcnt lgkmcnt(3)
    s_add_u32 s50, s50, 89088
    ds_read_b64_tr_b16 v[118:119], v171 offset:51200
    v_mfma_f32_16x16x32_bf16 v[48:51], a[136:139], v[132:135], v[48:51]
    v_mfma_f32_16x16x32_bf16 v[52:55], a[140:143], v[132:135], v[52:55]
    buffer_load_dwordx4 a[108:111], v248, s[36:39], s62 offen offset:3072 sc1
    v_mfma_f32_16x16x32_bf16 v[8:11], a[144:147], v[104:107], v[8:11]
    ds_read_b64_tr_b16 v[120:121], v168 offset:53248
    v_min_u32 v246, 13, v1
    v_mfma_f32_16x16x32_bf16 v[12:15], a[148:151], v[104:107], v[12:15]
    ds_read_b64_tr_b16 v[122:123], v168 offset:55296
    v_lshlrev_b32 v246, 7, v246
    v_mfma_f32_16x16x32_bf16 v[16:19], a[152:155], v[104:107], v[16:19]
    s_add_u32 s62, s62, 4096
    ds_read_b64_tr_b16 v[124:125], v169 offset:53248
    v_mov_b32 v2, s50
    v_mfma_f32_16x16x32_bf16 v[20:23], a[144:147], v[108:111], v[20:23]
    buffer_load_dwordx4 a[112:115], v248, s[36:39], s62 offen offset:0 sc1
    v_mfma_f32_16x16x32_bf16 v[24:27], a[148:151], v[108:111], v[24:27]
    ds_read_b64_tr_b16 v[126:127], v169 offset:55296
    v_mov_b32 v3, 31488
    v_mfma_f32_16x16x32_bf16 v[28:31], a[152:155], v[108:111], v[28:31]
    ds_read_b64_tr_b16 v[128:129], v170 offset:53248
    v_cmp_lt_u32 vcc, 3, v1
    s_nop 1
    v_cndmask_b32 v2, v2, v3, vcc
    s_waitcnt lgkmcnt(7)
    v_mfma_f32_16x16x32_bf16 v[32:35], a[144:147], v[112:115], v[32:35]
    ds_read_b64_tr_b16 v[130:131], v170 offset:55296
    v_add_u32 v246, v246, v2
    v_mfma_f32_16x16x32_bf16 v[36:39], a[148:151], v[112:115], v[36:39]
    buffer_load_dwordx4 a[116:119], v248, s[36:39], s62 offen offset:1024 sc1
    v_mfma_f32_16x16x32_bf16 v[40:43], a[152:155], v[112:115], v[40:43]
    s_waitcnt lgkmcnt(6)
    ds_read_b64_tr_b16 v[132:133], v171 offset:53248
    v_mfma_f32_16x16x32_bf16 v[44:47], a[144:147], v[116:119], v[44:47]
    s_waitcnt lgkmcnt(3)
    ds_read_b64_tr_b16 v[134:135], v171 offset:55296
    v_mfma_f32_16x16x32_bf16 v[48:51], a[148:151], v[116:119], v[48:51]
    buffer_load_dword v247, v246, s[36:39], s17 offen sc1
    v_mfma_f32_16x16x32_bf16 v[52:55], a[152:155], v[116:119], v[52:55]
    buffer_load_dwordx4 a[120:123], v248, s[36:39], s62 offen offset:2048 sc1
    v_mfma_f32_16x16x32_bf16 v[8:11], a[156:159], v[120:123], v[8:11]
    ds_read_b64_tr_b16 v[104:105], v168 offset:57344
    v_mfma_f32_16x16x32_bf16 v[12:15], a[160:163], v[120:123], v[12:15]
    ds_read_b64_tr_b16 v[106:107], v168 offset:59392
    v_mfma_f32_16x16x32_bf16 v[16:19], a[164:167], v[120:123], v[16:19]
    ds_read_b64_tr_b16 v[108:109], v169 offset:57344
    v_mfma_f32_16x16x32_bf16 v[20:23], a[156:159], v[124:127], v[20:23]
    buffer_load_dwordx4 a[124:127], v248, s[36:39], s62 offen offset:3072 sc1
    v_mfma_f32_16x16x32_bf16 v[24:27], a[160:163], v[124:127], v[24:27]
    ds_read_b64_tr_b16 v[110:111], v169 offset:59392
    v_mfma_f32_16x16x32_bf16 v[28:31], a[164:167], v[124:127], v[28:31]
    s_waitcnt lgkmcnt(6)
    ds_read_b64_tr_b16 v[112:113], v170 offset:57344
    v_mfma_f32_16x16x32_bf16 v[32:35], a[156:159], v[128:131], v[32:35]
    s_add_u32 s62, s62, 4096
    ds_read_b64_tr_b16 v[114:115], v170 offset:59392
    v_mfma_f32_16x16x32_bf16 v[36:39], a[160:163], v[128:131], v[36:39]
    buffer_load_dwordx4 a[128:131], v248, s[36:39], s62 offen offset:0 sc1
    v_mfma_f32_16x16x32_bf16 v[40:43], a[164:167], v[128:131], v[40:43]
    s_waitcnt lgkmcnt(6)
    ds_read_b64_tr_b16 v[116:117], v171 offset:57344
    v_mfma_f32_16x16x32_bf16 v[44:47], a[156:159], v[132:135], v[44:47]
    s_waitcnt lgkmcnt(3)
    ds_read_b64_tr_b16 v[118:119], v171 offset:59392
    v_mfma_f32_16x16x32_bf16 v[48:51], a[160:163], v[132:135], v[48:51]
    v_mfma_f32_16x16x32_bf16 v[52:55], a[164:167], v[132:135], v[52:55]
    buffer_load_dwordx4 a[132:135], v248, s[36:39], s62 offen offset:1024 sc1
    v_mfma_f32_16x16x32_bf16 v[8:11], a[168:171], v[104:107], v[8:11]
    ds_read_b64_tr_b16 v[120:121], v168 offset:61440
    v_mfma_f32_16x16x32_bf16 v[12:15], a[172:175], v[104:107], v[12:15]
    ds_read_b64_tr_b16 v[122:123], v168 offset:63488
    v_add_u32 v168, 65536, v168
    v_mfma_f32_16x16x32_bf16 v[16:19], a[176:179], v[104:107], v[16:19]
    ds_read_b64_tr_b16 v[124:125], v169 offset:61440
    v_mfma_f32_16x16x32_bf16 v[20:23], a[168:171], v[108:111], v[20:23]
    buffer_load_dwordx4 a[136:139], v248, s[36:39], s62 offen offset:2048 sc1
    v_mfma_f32_16x16x32_bf16 v[24:27], a[172:175], v[108:111], v[24:27]
    ds_read_b64_tr_b16 v[126:127], v169 offset:63488
    v_add_u32 v169, 65536, v169
    v_mfma_f32_16x16x32_bf16 v[28:31], a[176:179], v[108:111], v[28:31]
    s_waitcnt lgkmcnt(6)
    ds_read_b64_tr_b16 v[128:129], v170 offset:61440
    v_mfma_f32_16x16x32_bf16 v[32:35], a[168:171], v[112:115], v[32:35]
    ds_read_b64_tr_b16 v[130:131], v170 offset:63488
    v_add_u32 v170, 65536, v170
    v_mfma_f32_16x16x32_bf16 v[36:39], a[172:175], v[112:115], v[36:39]
    buffer_load_dwordx4 a[140:143], v248, s[36:39], s62 offen offset:3072 sc1
    v_mfma_f32_16x16x32_bf16 v[40:43], a[176:179], v[112:115], v[40:43]
    s_waitcnt lgkmcnt(6)
    ds_read_b64_tr_b16 v[132:133], v171 offset:61440
    v_mfma_f32_16x16x32_bf16 v[44:47], a[168:171], v[116:119], v[44:47]
    s_waitcnt lgkmcnt(3)
    ds_read_b64_tr_b16 v[134:135], v171 offset:63488
    v_add_u32 v171, 65536, v171
    v_mfma_f32_16x16x32_bf16 v[48:51], a[172:175], v[116:119], v[48:51]
    s_add_u32 s62, s62, 4096
    v_mfma_f32_16x16x32_bf16 v[52:55], a[176:179], v[116:119], v[52:55]
    buffer_load_dwordx4 a[144:147], v248, s[36:39], s62 offen offset:0 sc1
    v_mfma_f32_16x16x32_bf16 v[8:11], a[180:183], v[120:123], v[8:11]
    ds_read_b64_tr_b16 v[104:105], v168 offset:0
    v_mfma_f32_16x16x32_bf16 v[12:15], a[184:187], v[120:123], v[12:15]
    ds_read_b64_tr_b16 v[106:107], v168 offset:2048
    v_mfma_f32_16x16x32_bf16 v[16:19], a[188:191], v[120:123], v[16:19]
    ds_read_b64_tr_b16 v[108:109], v169 offset:0
    v_mfma_f32_16x16x32_bf16 v[20:23], a[180:183], v[124:127], v[20:23]
    buffer_load_dwordx4 v[200:203], v175, s[36:39], s6 offen offset:0 sc1
    v_mfma_f32_16x16x32_bf16 v[24:27], a[184:187], v[124:127], v[24:27]
    ds_read_b64_tr_b16 v[110:111], v169 offset:2048
    v_mfma_f32_16x16x32_bf16 v[28:31], a[188:191], v[124:127], v[28:31]
    s_waitcnt lgkmcnt(6)
    ds_read_b64_tr_b16 v[112:113], v170 offset:0
    v_mfma_f32_16x16x32_bf16 v[32:35], a[180:183], v[128:131], v[32:35]
    ds_read_b64_tr_b16 v[114:115], v170 offset:2048
    v_mfma_f32_16x16x32_bf16 v[36:39], a[184:187], v[128:131], v[36:39]
    buffer_load_dwordx4 v[204:207], v175, s[36:39], s6 offen offset:256 sc1
    v_mfma_f32_16x16x32_bf16 v[40:43], a[188:191], v[128:131], v[40:43]
    s_waitcnt lgkmcnt(6)
    ds_read_b64_tr_b16 v[116:117], v171 offset:0
    v_mfma_f32_16x16x32_bf16 v[44:47], a[180:183], v[132:135], v[44:47]
    s_waitcnt lgkmcnt(3)
    ds_read_b64_tr_b16 v[118:119], v171 offset:2048
    v_mfma_f32_16x16x32_bf16 v[48:51], a[184:187], v[132:135], v[48:51]
    buffer_load_dwordx4 v[208:211], v175, s[36:39], s6 offen offset:512 sc1
    v_mfma_f32_16x16x32_bf16 v[52:55], a[188:191], v[132:135], v[52:55]
    buffer_load_dwordx4 v[212:215], v175, s[36:39], s6 offen offset:768 sc1
    v_mfma_f32_16x16x32_bf16 v[8:11], a[192:195], v[104:107], v[8:11]
    ds_read_b64_tr_b16 v[120:121], v168 offset:4096
    s_waitcnt vmcnt(11)
    v_cmp_ne_u32 vcc, s48, v247
    s_cbranch_vccnz L_chk27_slow
L_chk27_back:
    v_mfma_f32_16x16x32_bf16 v[12:15], a[196:199], v[104:107], v[12:15]
    ds_read_b64_tr_b16 v[122:123], v168 offset:6144
    v_mfma_f32_16x16x32_bf16 v[16:19], a[200:203], v[104:107], v[16:19]
    ds_read_b64_tr_b16 v[124:125], v169 offset:4096
    v_mfma_f32_16x16x32_bf16 v[20:23], a[192:195], v[108:111], v[20:23]
    buffer_load_dwordx4 v[56:59], v216, s[36:39], 0 offen offset:0 sc1
    v_mfma_f32_16x16x32_bf16 v[24:27], a[196:199], v[108:111], v[24:27]
    ds_read_b64_tr_b16 v[126:127], v169 offset:6144
    v_mfma_f32_16x16x32_bf16 v[28:31], a[200:203], v[108:111], v[28:31]
    s_waitcnt lgkmcnt(6)
    ds_read_b64_tr_b16 v[128:129], v170 offset:4096
    v_mfma_f32_16x16x32_bf16 v[32:35], a[192:195], v[112:115], v[32:35]
    ds_read_b64_tr_b16 v[130:131], v170 offset:6144
    v_mfma_f32_16x16x32_bf16 v[36:39], a[196:199], v[112:115], v[36:39]
    buffer_load_dwordx4 v[60:63], v216, s[36:39], 0 offen offset:1024 sc1
    v_mfma_f32_16x16x32_bf16 v[40:43], a[200:203], v[112:115], v[40:43]
    s_waitcnt lgkmcnt(6)
    ds_read_b64_tr_b16 v[132:133], v171 offset:4096
    v_mfma_f32_16x16x32_bf16 v[44:47], a[192:195], v[116:119], v[44:47]
    s_waitcnt lgkmcnt(3)
    ds_read_b64_tr_b16 v[134:135], v171 offset:6144
    v_mfma_f32_16x16x32_bf16 v[48:51], a[196:199], v[116:119], v[48:51]
    v_mfma_f32_16x16x32_bf16 v[52:55], a[200:203], v[116:119], v[52:55]
    buffer_load_dwordx4 v[64:67], v216, s[36:39], 0 offen offset:2048 sc1
    v_mfma_f32_16x16x32_bf16 v[8:11], a[204:207], v[120:123], v[8:11]
    ds_read_b64_tr_b16 v[104:105], v168 offset:8192
    v_mfma_f32_16x16x32_bf16 v[12:15], a[208:211], v[120:123], v[12:15]
    ds_read_b64_tr_b16 v[106:107], v168 offset:10240
    v_mfma_f32_16x16x32_bf16 v[16:19], a[212:215], v[120:123], v[16:19]
    ds_read_b64_tr_b16 v[108:109], v169 offset:8192
    v_mfma_f32_16x16x32_bf16 v[20:23], a[204:207], v[124:127], v[20:23]
    buffer_load_dwordx4 v[68:71], v216, s[36:39], 0 offen offset:3072 sc1
    v_mfma_f32_16x16x32_bf16 v[24:27], a[208:211], v[124:127], v[24:27]
    ds_read_b64_tr_b16 v[110:111], v169 offset:10240
    v_mfma_f32_16x16x32_bf16 v[28:31], a[212:215], v[124:127], v[28:31]
    s_waitcnt lgkmcnt(6)
    ds_read_b64_tr_b16 v[112:113], v170 offset:8192
    v_mfma_f32_16x16x32_bf16 v[32:35], a[204:207], v[128:131], v[32:35]
    ds_read_b64_tr_b16 v[114:115], v170 offset:10240
    v_mfma_f32_16x16x32_bf16 v[36:39], a[208:211], v[128:131], v[36:39]
    buffer_load_dwordx4 v[72:75], v216, s[36:39], s4 offen offset:0 sc1
    v_mfma_f32_16x16x32_bf16 v[40:43], a[212:215], v[128:131], v[40:43]
    s_waitcnt lgkmcnt(6)
    ds_read_b64_tr_b16 v[116:117], v171 offset:8192
    v_mfma_f32_16x16x32_bf16 v[44:47], a[204:207], v[132:135], v[44:47]
    s_waitcnt lgkmcnt(3)
    ds_read_b64_tr_b16 v[118:119], v171 offset:10240
    v_mfma_f32_16x16x32_bf16 v[48:51], a[208:211], v[132:135], v[48:51]
    v_mfma_f32_16x16x32_bf16 v[52:55], a[212:215], v[132:135], v[52:55]
    buffer_load_dwordx4 v[76:79], v216, s[36:39], s4 offen offset:1024 sc1
    v_mfma_f32_16x16x32_bf16 v[8:11], a[216:219], v[104:107], v[8:11]
    ds_read_b64_tr_b16 v[120:121], v168 offset:12288
    v_mfma_f32_16x16x32_bf16 v[12:15], a[220:223], v[104:107], v[12:15]
    ds_read_b64_tr_b16 v[122:123], v168 offset:14336
    v_mfma_f32_16x16x32_bf16 v[16:19], a[224:227], v[104:107], v[16:19]
    ds_read_b64_tr_b16 v[124:125], v169 offset:12288
    v_mfma_f32_16x16x32_bf16 v[20:23], a[216:219], v[108:111], v[20:23]
    buffer_load_dwordx4 v[80:83], v216, s[36:39], s4 offen offset:2048 sc1
    v_mfma_f32_16x16x32_bf16 v[24:27], a[220:223], v[108:111], v[24:27]
    ds_read_b64_tr_b16 v[126:127], v169 offset:14336
    v_mfma_f32_16x16x32_bf16 v[28:31], a[224:227], v[108:111], v[28:31]
    s_waitcnt lgkmcnt(6)
    ds_read_b64_tr_b16 v[128:129], v170 offset:12288
    v_mfma_f32_16x16x32_bf16 v[32:35], a[216:219], v[112:115], v[32:35]
    ds_read_b64_tr_b16 v[130:131], v170 offset:14336
    v_mfma_f32_16x16x32_bf16 v[36:39], a[220:223], v[112:115], v[36:39]
    buffer_load_dwordx4 v[84:87], v216, s[36:39], s4 offen offset:3072 sc1
    v_mfma_f32_16x16x32_bf16 v[40:43], a[224:227], v[112:115], v[40:43]
    s_waitcnt lgkmcnt(6)
    ds_read_b64_tr_b16 v[132:133], v171 offset:12288
    v_mfma_f32_16x16x32_bf16 v[44:47], a[216:219], v[116:119], v[44:47]
    s_waitcnt lgkmcnt(3)
    ds_read_b64_tr_b16 v[134:135], v171 offset:14336
    v_mfma_f32_16x16x32_bf16 v[48:51], a[220:223], v[116:119], v[48:51]
    v_mfma_f32_16x16x32_bf16 v[52:55], a[224:227], v[116:119], v[52:55]
    buffer_load_dwordx4 v[88:91], v216, s[36:39], s5 offen offset:0 sc1
    v_mfma_f32_16x16x32_bf16 v[8:11], a[228:231], v[120:123], v[8:11]
    s_waitcnt vmcnt(12)
    v_xor_b32 v3, s48, v201
    v_bitop3_b32 v3, v203, s48, v3 bitop3:0xbe
    v_mfma_f32_16x16x32_bf16 v[12:15], a[232:235], v[120:123], v[12:15]
    s_waitcnt vmcnt(11)
    v_bitop3_b32 v3, v205, s48, v3 bitop3:0xbe
    v_bitop3_b32 v3, v207, s48, v3 bitop3:0xbe
    v_mfma_f32_16x16x32_bf16 v[16:19], a[236:239], v[120:123], v[16:19]
    s_waitcnt vmcnt(10)
    v_bitop3_b32 v3, v209, s48, v3 bitop3:0xbe
    v_bitop3_b32 v3, v211, s48, v3 bitop3:0xbe
    v_mfma_f32_16x16x32_bf16 v[20:23], a[228:231], v[124:127], v[20:23]
    buffer_load_dwordx4 v[92:95], v216, s[36:39], s5 offen offset:1024 sc1
    v_mfma_f32_16x16x32_bf16 v[24:27], a[232:235], v[124:127], v[24:27]
    s_waitcnt vmcnt(10)
    v_bitop3_b32 v3, v213, s48, v3 bitop3:0xbe
    v_bitop3_b32 v3, v215, s48, v3 bitop3:0xbe
    v_mfma_f32_16x16x32_bf16 v[28:31], a[236:239], v[124:127], v[28:31]
    v_cmp_ne_u32 vcc, 0, v3
    s_cbranch_vccnz L_stp1_slow
L_stp1_back:
    s_waitcnt lgkmcnt(2)
    v_mfma_f32_16x16x32_bf16 v[32:35], a[228:231], v[128:131], v[32:35]
    v_mfma_f32_16x16x32_bf16 v[36:39], a[232:235], v[128:131], v[36:39]
    buffer_load_dwordx4 v[96:99], v216, s[36:39], s5 offen offset:2048 sc1
    v_mfma_f32_16x16x32_bf16 v[40:43], a[236:239], v[128:131], v[40:43]
    s_waitcnt lgkmcnt(0)
    v_mfma_f32_16x16x32_bf16 v[44:47], a[228:231], v[132:135], v[44:47]
    v_mfma_f32_16x16x32_bf16 v[48:51], a[232:235], v[132:135], v[48:51]
    v_mfma_f32_16x16x32_bf16 v[52:55], a[236:239], v[132:135], v[52:55]
    buffer_load_dwordx4 v[100:103], v216, s[36:39], s5 offen offset:3072 sc1
    buffer_load_dwordx4 a[148:151], v248, s[36:39], s62 offen offset:1024 sc1
    buffer_load_dwordx4 a[152:155], v248, s[36:39], s62 offen offset:2048 sc1
    buffer_load_dwordx4 a[156:159], v248, s[36:39], s62 offen offset:3072 sc1
    s_add_u32 s62, s62, 4096
    buffer_load_dwordx4 a[160:163], v248, s[36:39], s62 offen offset:0 sc1
    buffer_load_dwordx4 a[164:167], v248, s[36:39], s62 offen offset:1024 sc1
    buffer_load_dwordx4 a[168:171], v248, s[36:39], s62 offen offset:2048 sc1
    buffer_load_dwordx4 a[172:175], v248, s[36:39], s62 offen offset:3072 sc1
    s_add_u32 s62, s62, 4096
    buffer_load_dwordx4 a[176:179], v248, s[36:39], s62 offen offset:0 sc1
    buffer_load_dwordx4 a[180:183], v248, s[36:39], s62 offen offset:1024 sc1
    buffer_load_dwordx4 a[184:187], v248, s[36:39], s62 offen offset:2048 sc1
    buffer_load_dwordx4 a[188:191], v248, s[36:39], s62 offen offset:3072 sc1
    s_add_u32 s8, s8, 3145728
    s_add_u32 s50, s8, 98304
    v_pk_fma_f32 v[238:239], v[176:177], v[202:203], v[188:189] op_sel_hi:[1,0,1]
    v_pk_fma_f32 v[240:241], v[178:179], v[202:203], v[190:191] op_sel_hi:[1,0,1]
    v_pk_fma_f32 v[8:9], v[8:9], v[200:201], v[238:239] op_sel_hi:[1,0,1]
    v_pk_fma_f32 v[10:11], v[10:11], v[200:201], v[240:241] op_sel_hi:[1,0,1]
    v_pk_fma_f32 v[242:243], v[180:181], v[202:203], v[192:193] op_sel_hi:[1,0,1]
    v_pk_fma_f32 v[244:245], v[182:183], v[202:203], v[194:195] op_sel_hi:[1,0,1]
    v_pk_fma_f32 v[12:13], v[12:13], v[200:201], v[242:243] op_sel_hi:[1,0,1]
    v_pk_fma_f32 v[14:15], v[14:15], v[200:201], v[244:245] op_sel_hi:[1,0,1]
    v_pk_mul_f32 v[8:9], v[8:9], v[12:13]
    v_pk_mul_f32 v[10:11], v[10:11], v[14:15]
    v_cvt_pk_bf16_f32 v12, v8, v9
    v_cvt_pk_bf16_f32 v13, v10, v11
    v_pk_fma_f32 v[242:243], v[176:177], v[206:207], v[188:189] op_sel_hi:[1,0,1]
    v_pk_fma_f32 v[244:245], v[178:179], v[206:207], v[190:191] op_sel_hi:[1,0,1]
    v_pk_fma_f32 v[20:21], v[20:21], v[204:205], v[242:243] op_sel_hi:[1,0,1]
    v_pk_fma_f32 v[22:23], v[22:23], v[204:205], v[244:245] op_sel_hi:[1,0,1]
    v_pk_fma_f32 v[238:239], v[180:181], v[206:207], v[192:193] op_sel_hi:[1,0,1]
    v_pk_fma_f32 v[240:241], v[182:183], v[206:207], v[194:195] op_sel_hi:[1,0,1]
    v_pk_fma_f32 v[24:25], v[24:25], v[204:205], v[238:239] op_sel_hi:[1,0,1]
    v_pk_fma_f32 v[26:27], v[26:27], v[204:205], v[240:241] op_sel_hi:[1,0,1]
    v_pk_mul_f32 v[20:21], v[20:21], v[24:25]
    v_pk_mul_f32 v[22:23], v[22:23], v[26:27]
    v_cvt_pk_bf16_f32 v14, v20, v21
    v_cvt_pk_bf16_f32 v15, v22, v23
    s_nop 0
    v_permlane16_swap_b32 v12, v14
    v_permlane16_swap_b32 v13, v15
    buffer_store_dwordx4 v[12:15], v173, s[36:39], s8 offen sc1
    v_pk_fma_f32 v[238:239], v[176:177], v[210:211], v[188:189] op_sel_hi:[1,0,1]
    v_pk_fma_f32 v[240:241], v[178:179], v[210:211], v[190:191] op_sel_hi:[1,0,1]
    v_pk_fma_f32 v[32:33], v[32:33], v[208:209], v[238:239] op_sel_hi:[1,0,1]
    v_pk_fma_f32 v[34:35], v[34:35], v[208:209], v[240:241] op_sel_hi:[1,0,1]
    v_pk_fma_f32 v[242:243], v[180:181], v[210:211], v[192:193] op_sel_hi:[1,0,1]
    v_pk_fma_f32 v[244:245], v[182:183], v[210:211], v[194:195] op_sel_hi:[1,0,1]
    v_pk_fma_f32 v[36:37], v[36:37], v[208:209], v[242:243] op_sel_hi:[1,0,1]
    v_pk_fma_f32 v[38:39], v[38:39], v[208:209], v[244:245] op_sel_hi:[1,0,1]
    v_pk_mul_f32 v[32:33], v[32:33], v[36:37]
    v_pk_mul_f32 v[34:35], v[34:35], v[38:39]
    v_cvt_pk_bf16_f32 v36, v32, v33
    v_cvt_pk_bf16_f32 v37, v34, v35
    v_pk_fma_f32 v[242:243], v[176:177], v[214:215], v[188:189] op_sel_hi:[1,0,1]
    v_pk_fma_f32 v[244:245], v[178:179], v[214:215], v[190:191] op_sel_hi:[1,0,1]
    v_pk_fma_f32 v[44:45], v[44:45], v[212:213], v[242:243] op_sel_hi:[1,0,1]
    v_pk_fma_f32 v[46:47], v[46:47], v[212:213], v[244:245] op_sel_hi:[1,0,1]
    v_pk_fma_f32 v[238:239], v[180:181], v[214:215], v[192:193] op_sel_hi:[1,0,1]
    v_pk_fma_f32 v[240:241], v[182:183], v[214:215], v[194:195] op_sel_hi:[1,0,1]
    v_pk_fma_f32 v[48:49], v[48:49], v[212:213], v[238:239] op_sel_hi:[1,0,1]
    v_pk_fma_f32 v[50:51], v[50:51], v[212:213], v[240:241] op_sel_hi:[1,0,1]
    v_pk_mul_f32 v[44:45], v[44:45], v[48:49]
    v_pk_mul_f32 v[46:47], v[46:47], v[50:51]
    v_cvt_pk_bf16_f32 v38, v44, v45
    v_cvt_pk_bf16_f32 v39, v46, v47
    s_nop 0
    v_permlane16_swap_b32 v36, v38
    v_permlane16_swap_b32 v37, v39
    buffer_store_dwordx4 v[36:39], v173, s[36:39], s50 offen sc1
    v_pk_fma_f32 v[238:239], v[184:185], v[202:203], v[196:197] op_sel_hi:[1,0,1]
    v_pk_fma_f32 v[240:241], v[186:187], v[202:203], v[198:199] op_sel_hi:[1,0,1]
    v_pk_fma_f32 v[16:17], v[16:17], v[200:201], v[238:239] op_sel_hi:[1,0,1]
    v_pk_fma_f32 v[18:19], v[18:19], v[200:201], v[240:241] op_sel_hi:[1,0,1]
    v_pk_fma_f32 v[242:243], v[184:185], v[206:207], v[196:197] op_sel_hi:[1,0,1]
    v_pk_fma_f32 v[244:245], v[186:187], v[206:207], v[198:199] op_sel_hi:[1,0,1]
    v_pk_fma_f32 v[28:29], v[28:29], v[204:205], v[242:243] op_sel_hi:[1,0,1]
    v_pk_fma_f32 v[30:31], v[30:31], v[204:205], v[244:245] op_sel_hi:[1,0,1]
    s_nop 0
    v_permlane32_swap_b32 v16, v28
    v_permlane32_swap_b32 v17, v29
    v_permlane32_swap_b32 v18, v30
    v_permlane32_swap_b32 v19, v31
    v_pk_mul_f32 v[16:17], v[16:17], v[28:29]
    v_pk_mul_f32 v[18:19], v[18:19], v[30:31]
    v_cvt_pk_bf16_f32 v8, v16, v17
    v_cvt_pk_bf16_f32 v9, v18, v19
    v_pk_fma_f32 v[238:239], v[184:185], v[210:211], v[196:197] op_sel_hi:[1,0,1]
    v_pk_fma_f32 v[240:241], v[186:187], v[210:211], v[198:199] op_sel_hi:[1,0,1]
    v_pk_fma_f32 v[40:41], v[40:41], v[208:209], v[238:239] op_sel_hi:[1,0,1]
    v_pk_fma_f32 v[42:43], v[42:43], v[208:209], v[240:241] op_sel_hi:[1,0,1]
    v_pk_fma_f32 v[242:243], v[184:185], v[214:215], v[196:197] op_sel_hi:[1,0,1]
    v_pk_fma_f32 v[244:245], v[186:187], v[214:215], v[198:199] op_sel_hi:[1,0,1]
    v_pk_fma_f32 v[52:53], v[52:53], v[212:213], v[242:243] op_sel_hi:[1,0,1]
    v_pk_fma_f32 v[54:55], v[54:55], v[212:213], v[244:245] op_sel_hi:[1,0,1]
    s_nop 0
    v_permlane32_swap_b32 v40, v52
    v_permlane32_swap_b32 v41, v53
    v_permlane32_swap_b32 v42, v54
    v_permlane32_swap_b32 v43, v55
    v_pk_mul_f32 v[40:41], v[40:41], v[52:53]
    v_pk_mul_f32 v[42:43], v[42:43], v[54:55]
    v_cvt_pk_bf16_f32 v10, v40, v41
    v_cvt_pk_bf16_f32 v11, v42, v43
    s_nop 0
    v_permlane16_swap_b32 v8, v10
    v_permlane16_swap_b32 v9, v11
    buffer_store_dwordx4 v[8:11], v174, s[36:39], s8 offen offset:512 sc1
    s_mov_b32 s40, s28
    s_mov_b32 s41, s29
    s_mov_b32 s42, 0x280000
    s_mov_b32 s43, 0x20000
    s_waitcnt vmcnt(25)
    v_mfma_f32_16x16x32_bf16 v[8:11], a[240:243], v[56:59], 0
    s_and_b32 s50, s3, 1
    s_lshr_b32 s51, s3, 1
    v_mfma_f32_16x16x32_bf16 v[12:15], a[244:247], v[56:59], 0
    s_mul_i32 s52, s50, 20480
    s_mul_i32 s53, s3, 5120
    s_add_u32 s52, s52, s53
    v_mfma_f32_16x16x32_bf16 v[16:19], a[248:251], v[56:59], 0
    v_add_u32 v220, s52, v248
    v_add_u32 v222, 40960, v220
    v_mfma_f32_16x16x32_bf16 v[20:23], a[252:255], v[56:59], 0
    s_xor_b32 s52, s50, 1
    s_mul_i32 s52, s52, 20480
    s_add_u32 s52, s52, s53
    v_mfma_f32_16x16x32_bf16 v[24:27], v[136:139], v[56:59], 0
    s_waitcnt vmcnt(24)
    v_add_u32 v221, s52, v248
    v_add_u32 v223, 40960, v221
    v_mfma_f32_16x16x32_bf16 v[8:11], v[140:143], v[60:63], v[8:11]
    buffer_load_dwordx4 v[56:59], v217, s[36:39], 0 offen offset:0 sc1
    v_mfma_f32_16x16x32_bf16 v[12:15], v[144:147], v[60:63], v[12:15]
    s_mul_i32 s52, s51, 20480
    s_lshl_b32 s53, s50, 11
    s_add_u32 s52, s52, s53
    v_mfma_f32_16x16x32_bf16 v[16:19], v[148:151], v[60:63], v[16:19]
    v_add_u32 v224, s52, v248
    v_mfma_f32_16x16x32_bf16 v[20:23], v[152:155], v[60:63], v[20:23]
    s_mul_i32 s53, s51, 5120
    s_add_u32 s53, s53, 40960
    v_add_u32 v225, s53, v224
    v_mfma_f32_16x16x32_bf16 v[24:27], v[156:159], v[60:63], v[24:27]
    s_waitcnt vmcnt(24)
    s_xor_b32 s53, s51, 1
    s_mul_i32 s53, s53, 5120
    s_add_u32 s53, s53, 40960
    v_mfma_f32_16x16x32_bf16 v[8:11], v[160:163], v[64:67], v[8:11]
    buffer_load_dwordx4 v[60:63], v217, s[36:39], 0 offen offset:1024 sc1
    v_mfma_f32_16x16x32_bf16 v[12:15], v[164:167], v[64:67], v[12:15]
    v_add_u32 v226, s53, v224
    v_mfma_f32_16x16x32_bf16 v[16:19], a[0:3], v[64:67], v[16:19]
    s_lshl_b32 s52, s74, 1
    s_add_u32 s52, s52, s51
    v_mfma_f32_16x16x32_bf16 v[20:23], a[4:7], v[64:67], v[20:23]
    s_mul_i32 s12, s75, 320
    s_add_u32 s15, s12, 23183360
    v_mfma_f32_16x16x32_bf16 v[24:27], a[8:11], v[64:67], v[24:27]
    s_waitcnt vmcnt(24)
    s_add_u32 s12, s12, 23147008
    s_mul_i32 s13, s52, 20480
    v_mfma_f32_16x16x32_bf16 v[8:11], a[12:15], v[68:71], v[8:11]
    buffer_load_dwordx4 v[64:67], v217, s[36:39], 0 offen offset:2048 sc1
    v_mfma_f32_16x16x32_bf16 v[12:15], a[16:19], v[68:71], v[12:15]
    s_mul_i32 s53, s75, 160
    s_add_u32 s13, s13, s53
    v_mfma_f32_16x16x32_bf16 v[16:19], a[20:23], v[68:71], v[16:19]
    s_lshl_b32 s53, s50, 6
    s_add_u32 s13, s13, s53
    s_add_u32 s14, s13, 1310720
    v_mfma_f32_16x16x32_bf16 v[20:23], a[24:27], v[68:71], v[20:23]
    s_mul_i32 s10, s75, 10
    s_add_u32 s10, s10, s3
    v_mfma_f32_16x16x32_bf16 v[24:27], a[28:31], v[68:71], v[24:27]
    s_mul_i32 s10, s10, 32768
    s_lshl_b32 s53, s74, 6
    s_add_u32 s10, s10, s53
    s_add_u32 s10, s10, 0
    s_waitcnt vmcnt(24)
    v_mfma_f32_16x16x32_bf16 v[8:11], a[32:35], v[72:75], v[8:11]
    buffer_load_dwordx4 v[68:71], v217, s[36:39], 0 offen offset:3072 sc1
    v_mfma_f32_16x16x32_bf16 v[12:15], a[36:39], v[72:75], v[12:15]
    s_lshl_b32 s11, s3, 10
    s_add_u32 s11, s11, 81920
    v_lshrrev_b32 v2, 3, v1
    v_mfma_f32_16x16x32_bf16 v[16:19], a[40:43], v[72:75], v[16:19]
    v_mul_u32_u24 v229, 4096, v2
    v_bfe_u32 v2, v1, 2, 1
    v_mfma_f32_16x16x32_bf16 v[20:23], a[44:47], v[72:75], v[20:23]
    v_lshl_add_u32 v229, v2, 11, v229
    v_and_b32 v2, 3, v1
    v_mfma_f32_16x16x32_bf16 v[24:27], a[48:51], v[72:75], v[24:27]
    s_waitcnt vmcnt(24)
    v_lshl_add_u32 v229, v2, 4, v229
    v_lshrrev_b32 v3, 2, v1
    v_mfma_f32_16x16x32_bf16 v[8:11], a[52:55], v[76:79], v[8:11]
    buffer_load_dwordx4 v[72:75], v217, s[36:39], s4 offen offset:0 sc1
    v_mfma_f32_16x16x32_bf16 v[12:15], a[56:59], v[76:79], v[12:15]
    v_lshlrev_b32 v231, 7, v3
    v_lshl_add_u32 v231, v2, 3, v231
    v_mfma_f32_16x16x32_bf16 v[16:19], a[60:63], v[76:79], v[16:19]
    s_lshl_b32 s53, s50, 12
    s_lshl_b32 s52, s51, 5
    v_mfma_f32_16x16x32_bf16 v[20:23], a[64:67], v[76:79], v[20:23]
    s_add_u32 s53, s53, s52
    s_add_u32 s53, s53, 81920
    v_add_u32 v231, s53, v231
    v_mfma_f32_16x16x32_bf16 v[24:27], a[68:71], v[76:79], v[24:27]
    s_waitcnt vmcnt(24)
    v_and_b32 v2, 15, v1
    v_lshrrev_b32 v3, 4, v1
    v_mfma_f32_16x16x32_bf16 v[8:11], a[72:75], v[80:83], v[8:11]
    buffer_load_dwordx4 v[76:79], v217, s[36:39], s4 offen offset:1024 sc1
    v_mfma_f32_16x16x32_bf16 v[12:15], a[76:79], v[80:83], v[12:15]
    v_lshlrev_b32 v230, 4, v3
    v_mfma_f32_16x16x32_bf16 v[16:19], a[80:83], v[80:83], v[16:19]
    s_lshl_b32 s53, s50, 7
    v_add_u32 v230, s53, v230
    v_mul_u32_u24 v2, 1280, v2
    v_mfma_f32_16x16x32_bf16 v[20:23], a[84:87], v[80:83], v[20:23]
    v_lshl_add_u32 v228, v3, 3, v2
    v_and_b32 v227, 1, v3
    v_mfma_f32_16x16x32_bf16 v[24:27], a[88:91], v[80:83], v[24:27]
    s_waitcnt vmcnt(24)
    v_lshl_add_u32 v2, v227, 5, v2
    v_lshrrev_b32 v3, 1, v3
    v_mfma_f32_16x16x32_bf16 v[8:11], a[92:95], v[84:87], v[8:11]
    buffer_load_dwordx4 v[80:83], v217, s[36:39], s4 offen offset:2048 sc1
    v_mfma_f32_16x16x32_bf16 v[12:15], a[96:99], v[84:87], v[12:15]
    v_lshl_add_u32 v227, v3, 4, v2
    v_mfma_f32_16x16x32_bf16 v[16:19], a[100:103], v[84:87], v[16:19]
    s_lshr_b32 s50, s74, 1
    s_lshl_b32 s50, s50, 2
    v_mfma_f32_16x16x32_bf16 v[20:23], a[104:107], v[84:87], v[20:23]
    s_add_u32 s50, s50, s3
    s_lshl_b32 s50, s50, 9
    s_add_u32 s50, s50, 121856
    v_mfma_f32_16x16x32_bf16 v[24:27], a[108:111], v[84:87], v[24:27]
    s_waitcnt vmcnt(24)
    v_min_u32 v246, 3, v1
    v_lshlrev_b32 v246, 7, v246
    v_mfma_f32_16x16x32_bf16 v[8:11], a[112:115], v[88:91], v[8:11]
    s_waitcnt vmcnt(7)
    s_barrier
    s_cmp_eq_u32 s3, 0
    s_cbranch_scc0 L_wf28
    s_lshl_b32 s54, s76, 7
    s_add_u32 s54, s54, 23321600
    v_mov_b32 v254, 0
    v_mov_b32 v255, s48
    s_mov_b64 exec, 1
    buffer_store_dword v255, v254, s[36:39], s54 offen sc1
    s_mov_b64 exec, -1
L_wf28:
    buffer_load_dwordx4 v[84:87], v217, s[36:39], s4 offen offset:3072 sc1
    v_mfma_f32_16x16x32_bf16 v[12:15], a[116:119], v[88:91], v[12:15]
    v_add_u32 v246, s50, v246
    v_mfma_f32_16x16x32_bf16 v[16:19], a[120:123], v[88:91], v[16:19]
    buffer_load_dwordx4 v[48:51], v230, s[36:39], s12 offen offset:0 sc1
    v_mfma_f32_16x16x32_bf16 v[20:23], a[124:127], v[88:91], v[20:23]
    buffer_load_dwordx4 v[52:55], v230, s[36:39], s12 offen offset:64 sc1
    v_mfma_f32_16x16x32_bf16 v[24:27], a[128:131], v[88:91], v[24:27]
    buffer_load_dwordx4 v[132:135], v230, s[36:39], s12 offen offset:128 sc1
    v_mfma_f32_16x16x32_bf16 v[8:11], a[132:135], v[92:95], v[8:11]
    buffer_load_dwordx4 v[88:91], v217, s[36:39], s5 offen offset:0 sc1
    v_mfma_f32_16x16x32_bf16 v[12:15], a[136:139], v[92:95], v[12:15]
    buffer_load_dwordx4 v[168:171], v230, s[36:39], s15 offen offset:0 sc1
    v_mfma_f32_16x16x32_bf16 v[16:19], a[140:143], v[92:95], v[16:19]
    s_add_u32 m0, s11, 0
    buffer_load_dwordx4 v[172:175], v230, s[36:39], s15 offen offset:64 sc1
    v_mfma_f32_16x16x32_bf16 v[20:23], a[144:147], v[92:95], v[20:23]
    buffer_load_dwordx4 v229, s[36:39], s10 offen sc1 lds
    v_mfma_f32_16x16x32_bf16 v[24:27], a[148:151], v[92:95], v[24:27]
    s_add_u32 s10, s10, 131072
    buffer_load_dwordx4 v[176:179], v230, s[36:39], s15 offen offset:128 sc1
    v_mfma_f32_16x16x32_bf16 v[8:11], a[152:155], v[96:99], v[8:11]
    s_add_u32 m0, s11, 4096
    v_mfma_f32_16x16x32_bf16 v[12:15], a[156:159], v[96:99], v[12:15]
    buffer_load_dwordx4 v229, s[36:39], s10 offen sc1 lds
    v_mfma_f32_16x16x32_bf16 v[16:19], a[160:163], v[96:99], v[16:19]
    s_add_u32 s10, s10, 131072
    v_mfma_f32_16x16x32_bf16 v[20:23], a[164:167], v[96:99], v[20:23]
    s_add_u32 m0, s11, 8192
    v_mfma_f32_16x16x32_bf16 v[24:27], a[168:171], v[96:99], v[24:27]
    buffer_load_dwordx4 v229, s[36:39], s10 offen sc1 lds
    v_mfma_f32_16x16x32_bf16 v[8:11], a[172:175], v[100:103], v[8:11]
    v_mfma_f32_16x16x32_bf16 v[12:15], a[176:179], v[100:103], v[12:15]
    v_mfma_f32_16x16x32_bf16 v[16:19], a[180:183], v[100:103], v[16:19]
    buffer_load_dwordx4 v[92:95], v217, s[36:39], s5 offen offset:1024 sc1
    v_mfma_f32_16x16x32_bf16 v[20:23], a[184:187], v[100:103], v[20:23]
    v_mfma_f32_16x16x32_bf16 v[24:27], a[188:191], v[100:103], v[24:27]
    s_waitcnt vmcnt(18)
    v_mfma_f32_16x16x32_bf16 v[28:31], a[240:243], v[56:59], 0
    buffer_load_dwordx4 v[96:99], v217, s[36:39], s5 offen offset:2048 sc1
    v_mfma_f32_16x16x32_bf16 v[32:35], a[244:247], v[56:59], 0
    v_mfma_f32_16x16x32_bf16 v[36:39], a[248:251], v[56:59], 0
    v_mfma_f32_16x16x32_bf16 v[40:43], a[252:255], v[56:59], 0
    buffer_load_dwordx4 v[100:103], v217, s[36:39], s5 offen offset:3072 sc1
    v_mfma_f32_16x16x32_bf16 v[44:47], v[136:139], v[56:59], 0
    s_waitcnt vmcnt(19)
    ds_write_b128 v220, v[8:11] offset:0
    v_mfma_f32_16x16x32_bf16 v[28:31], v[140:143], v[60:63], v[28:31]
    v_mfma_f32_16x16x32_bf16 v[32:35], v[144:147], v[60:63], v[32:35]
    ds_write_b128 v220, v[12:15] offset:1024
    v_mfma_f32_16x16x32_bf16 v[36:39], v[148:151], v[60:63], v[36:39]
    v_mfma_f32_16x16x32_bf16 v[40:43], v[152:155], v[60:63], v[40:43]
    ds_write_b128 v220, v[16:19] offset:2048
    v_mfma_f32_16x16x32_bf16 v[44:47], v[156:159], v[60:63], v[44:47]
    s_waitcnt vmcnt(18)
    v_mfma_f32_16x16x32_bf16 v[28:31], v[160:163], v[64:67], v[28:31]
    ds_write_b128 v220, v[20:23] offset:3072
    v_mfma_f32_16x16x32_bf16 v[32:35], v[164:167], v[64:67], v[32:35]
    v_mfma_f32_16x16x32_bf16 v[36:39], a[0:3], v[64:67], v[36:39]
    ds_write_b128 v220, v[24:27] offset:4096
    v_mfma_f32_16x16x32_bf16 v[40:43], a[4:7], v[64:67], v[40:43]
    v_mfma_f32_16x16x32_bf16 v[44:47], a[8:11], v[64:67], v[44:47]
    s_waitcnt vmcnt(17)
    v_mfma_f32_16x16x32_bf16 v[28:31], a[12:15], v[68:71], v[28:31]
    v_mfma_f32_16x16x32_bf16 v[32:35], a[16:19], v[68:71], v[32:35]
    v_mfma_f32_16x16x32_bf16 v[36:39], a[20:23], v[68:71], v[36:39]
    v_mfma_f32_16x16x32_bf16 v[40:43], a[24:27], v[68:71], v[40:43]
    v_mfma_f32_16x16x32_bf16 v[44:47], a[28:31], v[68:71], v[44:47]
    s_waitcnt vmcnt(16)
    v_mfma_f32_16x16x32_bf16 v[28:31], a[32:35], v[72:75], v[28:31]
    buffer_load_dword v247, v246, s[36:39], s17 offen sc1
    v_mfma_f32_16x16x32_bf16 v[32:35], a[36:39], v[72:75], v[32:35]
    v_mfma_f32_16x16x32_bf16 v[36:39], a[40:43], v[72:75], v[36:39]
    v_mfma_f32_16x16x32_bf16 v[40:43], a[44:47], v[72:75], v[40:43]
    v_mfma_f32_16x16x32_bf16 v[44:47], a[48:51], v[72:75], v[44:47]
    s_waitcnt vmcnt(16)
    v_mfma_f32_16x16x32_bf16 v[28:31], a[52:55], v[76:79], v[28:31]
    v_mfma_f32_16x16x32_bf16 v[32:35], a[56:59], v[76:79], v[32:35]
    v_mfma_f32_16x16x32_bf16 v[36:39], a[60:63], v[76:79], v[36:39]
    v_mfma_f32_16x16x32_bf16 v[40:43], a[64:67], v[76:79], v[40:43]
    v_mfma_f32_16x16x32_bf16 v[44:47], a[68:71], v[76:79], v[44:47]
    s_waitcnt vmcnt(15)
    v_mfma_f32_16x16x32_bf16 v[28:31], a[72:75], v[80:83], v[28:31]
    v_mfma_f32_16x16x32_bf16 v[32:35], a[76:79], v[80:83], v[32:35]
    v_mfma_f32_16x16x32_bf16 v[36:39], a[80:83], v[80:83], v[36:39]
    v_mfma_f32_16x16x32_bf16 v[40:43], a[84:87], v[80:83], v[40:43]
    v_mfma_f32_16x16x32_bf16 v[44:47], a[88:91], v[80:83], v[44:47]
    s_waitcnt vmcnt(4)
    s_barrier
    ds_read_b64_tr_b16 v[180:181], v231 offset:0
    v_mfma_f32_16x16x32_bf16 v[28:31], a[92:95], v[84:87], v[28:31]
    ds_read_b64_tr_b16 v[182:183], v231 offset:2048
    v_mfma_f32_16x16x32_bf16 v[32:35], a[96:99], v[84:87], v[32:35]
    ds_read_b64_tr_b16 v[184:185], v231 offset:4096
    v_mfma_f32_16x16x32_bf16 v[36:39], a[100:103], v[84:87], v[36:39]
    ds_read_b64_tr_b16 v[186:187], v231 offset:64
    v_mfma_f32_16x16x32_bf16 v[40:43], a[104:107], v[84:87], v[40:43]
    ds_read_b64_tr_b16 v[188:189], v231 offset:2112
    v_mfma_f32_16x16x32_bf16 v[44:47], a[108:111], v[84:87], v[44:47]
    ds_read_b64_tr_b16 v[190:191], v231 offset:4160
    v_mfma_f32_16x16x32_bf16 v[28:31], a[112:115], v[88:91], v[28:31]
    v_mfma_f32_16x16x32_bf16 v[32:35], a[116:119], v[88:91], v[32:35]
    v_mfma_f32_16x16x32_bf16 v[36:39], a[120:123], v[88:91], v[36:39]
    v_mfma_f32_16x16x32_bf16 v[40:43], a[124:127], v[88:91], v[40:43]
    s_waitcnt lgkmcnt(5)
    v_lshlrev_b32 v120, 16, v180
    v_mul_f32 v120, v120, v168
    v_mfma_f32_16x16x32_bf16 v[44:47], a[128:131], v[88:91], v[44:47]
    s_waitcnt vmcnt(3)
    v_and_b32 v121, 0xffff0000, v180
    v_mul_f32 v121, v121, v169
    v_mfma_f32_16x16x32_bf16 v[28:31], a[132:135], v[92:95], v[28:31]
    v_lshlrev_b32 v122, 16, v181
    v_mul_f32 v122, v122, v170
    v_mfma_f32_16x16x32_bf16 v[32:35], a[136:139], v[92:95], v[32:35]
    v_and_b32 v123, 0xffff0000, v181
    v_mul_f32 v123, v123, v171
    v_mfma_f32_16x16x32_bf16 v[36:39], a[140:143], v[92:95], v[36:39]
    s_waitcnt lgkmcnt(4)
    v_lshlrev_b32 v124, 16, v182
    v_mul_f32 v124, v124, v172
    v_mfma_f32_16x16x32_bf16 v[40:43], a[144:147], v[92:95], v[40:43]
    v_and_b32 v125, 0xffff0000, v182
    v_mul_f32 v125, v125, v173
    v_mfma_f32_16x16x32_bf16 v[44:47], a[148:151], v[92:95], v[44:47]
    s_waitcnt vmcnt(2)
    v_lshlrev_b32 v126, 16, v183
    v_mul_f32 v126, v126, v174
    v_mfma_f32_16x16x32_bf16 v[28:31], a[152:155], v[96:99], v[28:31]
    s_waitcnt vmcnt(0)
    v_cmp_ne_u32 vcc, s48, v247
    s_cbranch_vccnz L_chk29_slow
L_chk29_back:
    v_and_b32 v127, 0xffff0000, v183
    v_mfma_f32_16x16x32_bf16 v[32:35], a[156:159], v[96:99], v[32:35]
    buffer_load_dwordx4 v[56:59], v218, s[36:39], 0 offen offset:0 sc1
    v_mfma_f32_16x16x32_bf16 v[36:39], a[160:163], v[96:99], v[36:39]
    v_mul_f32 v127, v127, v175
    s_waitcnt lgkmcnt(3)
    v_lshlrev_b32 v128, 16, v184
    v_mfma_f32_16x16x32_bf16 v[40:43], a[164:167], v[96:99], v[40:43]
    v_mul_f32 v128, v128, v176
    v_and_b32 v129, 0xffff0000, v184
    v_mfma_f32_16x16x32_bf16 v[44:47], a[168:171], v[96:99], v[44:47]
    buffer_load_dwordx4 v[60:63], v218, s[36:39], 0 offen offset:1024 sc1
    v_mfma_f32_16x16x32_bf16 v[28:31], a[172:175], v[100:103], v[28:31]
    v_mul_f32 v129, v129, v177
    v_lshlrev_b32 v130, 16, v185
    v_mfma_f32_16x16x32_bf16 v[32:35], a[176:179], v[100:103], v[32:35]
    v_mul_f32 v130, v130, v178
    v_and_b32 v131, 0xffff0000, v185
    v_mfma_f32_16x16x32_bf16 v[36:39], a[180:183], v[100:103], v[36:39]
    buffer_load_dwordx4 v[64:67], v218, s[36:39], 0 offen offset:2048 sc1
    v_mfma_f32_16x16x32_bf16 v[40:43], a[184:187], v[100:103], v[40:43]
    v_mul_f32 v131, v131, v179
    s_waitcnt lgkmcnt(2)
    v_lshlrev_b32 v232, 16, v186
    v_mfma_f32_16x16x32_bf16 v[44:47], a[188:191], v[100:103], v[44:47]
    s_waitcnt vmcnt(2)
    v_mul_f32 v232, v232, v168
    v_and_b32 v233, 0xffff0000, v186
    v_mfma_f32_16x16x32_bf16 v[8:11], a[240:243], v[56:59], 0
    buffer_load_dwordx4 v[68:71], v218, s[36:39], 0 offen offset:3072 sc1
    v_mfma_f32_16x16x32_bf16 v[12:15], a[244:247], v[56:59], 0
    v_mul_f32 v233, v233, v169
    v_lshlrev_b32 v234, 16, v187
    v_mfma_f32_16x16x32_bf16 v[16:19], a[248:251], v[56:59], 0
    v_mul_f32 v234, v234, v170
    v_and_b32 v235, 0xffff0000, v187
    v_mfma_f32_16x16x32_bf16 v[20:23], a[252:255], v[56:59], 0
    buffer_load_dwordx4 v[72:75], v218, s[36:39], s4 offen offset:0 sc1
    v_mfma_f32_16x16x32_bf16 v[24:27], v[136:139], v[56:59], 0
    ds_write_b128 v221, v[28:31] offset:0
    v_mul_f32 v235, v235, v171
    s_waitcnt lgkmcnt(2)
    v_lshlrev_b32 v236, 16, v188
    s_waitcnt vmcnt(3)
    v_mfma_f32_16x16x32_bf16 v[8:11], v[140:143], v[60:63], v[8:11]
    v_mul_f32 v236, v236, v172
    v_and_b32 v237, 0xffff0000, v188
    v_mfma_f32_16x16x32_bf16 v[12:15], v[144:147], v[60:63], v[12:15]
    buffer_load_dwordx4 v[76:79], v218, s[36:39], s4 offen offset:1024 sc1
    v_mfma_f32_16x16x32_bf16 v[16:19], v[148:151], v[60:63], v[16:19]
    ds_write_b128 v221, v[32:35] offset:1024
    v_mul_f32 v237, v237, v173
    v_lshlrev_b32 v238, 16, v189
    v_mfma_f32_16x16x32_bf16 v[20:23], v[152:155], v[60:63], v[20:23]
    v_mul_f32 v238, v238, v174
    v_and_b32 v239, 0xffff0000, v189
    v_mul_f32 v239, v239, v175
    v_mfma_f32_16x16x32_bf16 v[24:27], v[156:159], v[60:63], v[24:27]
    s_waitcnt vmcnt(3)
    buffer_load_dwordx4 v[80:83], v218, s[36:39], s4 offen offset:2048 sc1
    v_mfma_f32_16x16x32_bf16 v[8:11], v[160:163], v[64:67], v[8:11]
    ds_write_b128 v221, v[36:39] offset:2048
    s_waitcnt lgkmcnt(3)
    v_lshlrev_b32 v240, 16, v190
    v_mul_f32 v240, v240, v176
    v_mfma_f32_16x16x32_bf16 v[12:15], v[164:167], v[64:67], v[12:15]
    v_and_b32 v241, 0xffff0000, v190
    v_mul_f32 v241, v241, v177
    v_mfma_f32_16x16x32_bf16 v[16:19], a[0:3], v[64:67], v[16:19]
    ds_write_b128 v221, v[40:43] offset:3072
    buffer_load_dwordx4 v[84:87], v218, s[36:39], s4 offen offset:3072 sc1
    v_mfma_f32_16x16x32_bf16 v[20:23], a[4:7], v[64:67], v[20:23]
    v_lshlrev_b32 v242, 16, v191
    v_mul_f32 v242, v242, v178
    v_mfma_f32_16x16x32_bf16 v[24:27], a[8:11], v[64:67], v[24:27]
    s_waitcnt vmcnt(4)
    ds_write_b128 v221, v[44:47] offset:4096
    v_and_b32 v243, 0xffff0000, v191
    v_mul_f32 v243, v243, v179
    v_mfma_f32_16x16x32_bf16 v[8:11], a[12:15], v[68:71], v[8:11]
    buffer_load_dwordx4 v[88:91], v218, s[36:39], s5 offen offset:0 sc1
    v_mfma_f32_16x16x32_bf16 v[12:15], a[16:19], v[68:71], v[12:15]
    v_mfma_f32_16x16x32_bf16 v[16:19], a[20:23], v[68:71], v[16:19]
    v_mfma_f32_16x16x32_bf16 v[20:23], a[24:27], v[68:71], v[20:23]
    buffer_load_dwordx4 v[92:95], v218, s[36:39], s5 offen offset:1024 sc1
    v_mfma_f32_16x16x32_bf16 v[24:27], a[28:31], v[68:71], v[24:27]
    s_waitcnt vmcnt(5)
    v_mfma_f32_16x16x32_bf16 v[8:11], a[32:35], v[72:75], v[8:11]
    v_mfma_f32_16x16x32_bf16 v[12:15], a[36:39], v[72:75], v[12:15]
    buffer_load_dwordx4 v[96:99], v218, s[36:39], s5 offen offset:2048 sc1
    v_mfma_f32_16x16x32_bf16 v[16:19], a[40:43], v[72:75], v[16:19]
    s_waitcnt lgkmcnt(0)
    s_barrier
    ds_read_b128 v[168:171], v224 offset:0
    v_mfma_f32_16x16x32_bf16 v[20:23], a[44:47], v[72:75], v[20:23]
    ds_read_b128 v[172:175], v224 offset:1024
    v_mfma_f32_16x16x32_bf16 v[24:27], a[48:51], v[72:75], v[24:27]
    s_waitcnt vmcnt(5)
    buffer_load_dwordx4 v[100:103], v218, s[36:39], s5 offen offset:3072 sc1
    v_mfma_f32_16x16x32_bf16 v[8:11], a[52:55], v[76:79], v[8:11]
    ds_read_b128 v[176:179], v224 offset:2048
    v_mfma_f32_16x16x32_bf16 v[12:15], a[56:59], v[76:79], v[12:15]
    ds_read_b128 v[180:183], v224 offset:5120
    ds_read_b128 v[184:187], v224 offset:6144
    v_mfma_f32_16x16x32_bf16 v[16:19], a[60:63], v[76:79], v[16:19]
    buffer_load_dwordx4 v[56:59], v219, s[36:39], 0 offen offset:0 sc1
    v_mfma_f32_16x16x32_bf16 v[20:23], a[64:67], v[76:79], v[20:23]
    ds_read_b128 v[188:191], v224 offset:7168
    v_mfma_f32_16x16x32_bf16 v[24:27], a[68:71], v[76:79], v[24:27]
    s_waitcnt vmcnt(6)
    ds_read_b128 v[192:195], v224 offset:10240
    v_mfma_f32_16x16x32_bf16 v[8:11], a[72:75], v[80:83], v[8:11]
    buffer_load_dwordx4 v[60:63], v219, s[36:39], 0 offen offset:1024 sc1
    v_mfma_f32_16x16x32_bf16 v[12:15], a[76:79], v[80:83], v[12:15]
    ds_read_b128 v[196:199], v224 offset:11264
    v_mfma_f32_16x16x32_bf16 v[16:19], a[80:83], v[80:83], v[16:19]
    ds_read_b128 v[200:203], v224 offset:12288
    ds_read_b128 v[204:207], v224 offset:15360
    v_mfma_f32_16x16x32_bf16 v[20:23], a[84:87], v[80:83], v[20:23]
    buffer_load_dwordx4 v[64:67], v219, s[36:39], 0 offen offset:2048 sc1
    v_mfma_f32_16x16x32_bf16 v[24:27], a[88:91], v[80:83], v[24:27]
    s_waitcnt vmcnt(7)
    ds_read_b128 v[208:211], v224 offset:16384
    v_mfma_f32_16x16x32_bf16 v[8:11], a[92:95], v[84:87], v[8:11]
    ds_read_b128 v[212:215], v224 offset:17408
    v_mfma_f32_16x16x32_bf16 v[12:15], a[96:99], v[84:87], v[12:15]
    buffer_load_dwordx4 v[68:71], v219, s[36:39], 0 offen offset:3072 sc1
    v_mfma_f32_16x16x32_bf16 v[16:19], a[100:103], v[84:87], v[16:19]
    s_waitcnt lgkmcnt(8)
    v_add_f32 v168, v168, v180
    v_add_f32 v169, v169, v181
    v_mfma_f32_16x16x32_bf16 v[20:23], a[104:107], v[84:87], v[20:23]
    v_add_f32 v170, v170, v182
    v_add_f32 v171, v171, v183
    v_mfma_f32_16x16x32_bf16 v[24:27], a[108:111], v[84:87], v[24:27]
    s_waitcnt vmcnt(7)
    buffer_load_dwordx4 v[72:75], v219, s[36:39], s4 offen offset:0 sc1
    v_mfma_f32_16x16x32_bf16 v[8:11], a[112:115], v[88:91], v[8:11]
    s_waitcnt lgkmcnt(7)
    v_add_f32 v172, v172, v184
    v_add_f32 v173, v173, v185
    v_mfma_f32_16x16x32_bf16 v[12:15], a[116:119], v[88:91], v[12:15]
    v_add_f32 v174, v174, v186
    v_add_f32 v175, v175, v187
    v_mfma_f32_16x16x32_bf16 v[16:19], a[120:123], v[88:91], v[16:19]
    buffer_load_dwordx4 v[76:79], v219, s[36:39], s4 offen offset:1024 sc1
    v_mfma_f32_16x16x32_bf16 v[20:23], a[124:127], v[88:91], v[20:23]
    s_waitcnt lgkmcnt(6)
    v_add_f32 v176, v176, v188
    v_add_f32 v177, v177, v189
    v_mfma_f32_16x16x32_bf16 v[24:27], a[128:131], v[88:91], v[24:27]
    v_add_f32 v178, v178, v190
    v_add_f32 v179, v179, v191
    s_waitcnt lgkmcnt(2)
    v_add_f32 v192, v192, v204
    s_waitcnt vmcnt(8)
    v_mfma_f32_16x16x32_bf16 v[8:11], a[132:135], v[92:95], v[8:11]
    buffer_load_dwordx4 v[80:83], v219, s[36:39], s4 offen offset:2048 sc1
    v_mfma_f32_16x16x32_bf16 v[12:15], a[136:139], v[92:95], v[12:15]
    v_add_f32 v193, v193, v205
    v_add_f32 v194, v194, v206
    v_mfma_f32_16x16x32_bf16 v[16:19], a[140:143], v[92:95], v[16:19]
    v_add_f32 v195, v195, v207
    s_waitcnt lgkmcnt(1)
    v_add_f32 v196, v196, v208
    v_mfma_f32_16x16x32_bf16 v[20:23], a[144:147], v[92:95], v[20:23]
    buffer_load_dwordx4 v[84:87], v219, s[36:39], s4 offen offset:3072 sc1
    v_mfma_f32_16x16x32_bf16 v[24:27], a[148:151], v[92:95], v[24:27]
    s_waitcnt vmcnt(9)
    v_add_f32 v197, v197, v209
    v_add_f32 v198, v198, v210
    v_mfma_f32_16x16x32_bf16 v[8:11], a[152:155], v[96:99], v[8:11]
    v_add_f32 v199, v199, v211
    s_waitcnt lgkmcnt(0)
    v_add_f32 v200, v200, v212
    v_add_f32 v201, v201, v213
    v_mfma_f32_16x16x32_bf16 v[12:15], a[156:159], v[96:99], v[12:15]
    buffer_load_dwordx4 v[88:91], v219, s[36:39], s5 offen offset:0 sc1
    v_mfma_f32_16x16x32_bf16 v[16:19], a[160:163], v[96:99], v[16:19]
    v_add_f32 v202, v202, v214
    v_add_f32 v203, v203, v215
    v_mfma_f32_16x16x32_bf16 v[20:23], a[164:167], v[96:99], v[20:23]
    v_add_f32 v168, v168, v192
    v_add_f32 v169, v169, v193
    v_mfma_f32_16x16x32_bf16 v[24:27], a[168:171], v[96:99], v[24:27]
    s_waitcnt vmcnt(9)
    buffer_load_dwordx4 v[92:95], v219, s[36:39], s5 offen offset:1024 sc1
    v_mfma_f32_16x16x32_bf16 v[8:11], a[172:175], v[100:103], v[8:11]
    v_add_f32 v170, v170, v194
    v_add_f32 v171, v171, v195
    v_mfma_f32_16x16x32_bf16 v[12:15], a[176:179], v[100:103], v[12:15]
    v_add_f32 v172, v172, v196
    v_add_f32 v173, v173, v197
    v_add_f32 v174, v174, v198
    v_mfma_f32_16x16x32_bf16 v[16:19], a[180:183], v[100:103], v[16:19]
    buffer_load_dwordx4 v[96:99], v219, s[36:39], s5 offen offset:2048 sc1
    v_mfma_f32_16x16x32_bf16 v[20:23], a[184:187], v[100:103], v[20:23]
    v_add_f32 v175, v175, v199
    v_add_f32 v176, v176, v200
    v_mfma_f32_16x16x32_bf16 v[24:27], a[188:191], v[100:103], v[24:27]
    s_waitcnt vmcnt(10)
    v_add_f32 v177, v177, v201
    v_add_f32 v178, v178, v202
    v_mfma_f32_16x16x32_bf16 v[28:31], a[240:243], v[56:59], 0
    buffer_load_dwordx4 v[100:103], v219, s[36:39], s5 offen offset:3072 sc1
    v_mfma_f32_16x16x32_bf16 v[32:35], a[244:247], v[56:59], 0
    v_add_f32 v179, v179, v203
    v_fma_f32 v120, v168, v48, v120
    v_mfma_f32_16x16x32_bf16 v[36:39], a[248:251], v[56:59], 0
    v_fma_f32 v121, v169, v49, v121
    v_fma_f32 v122, v170, v50, v122
    v_mfma_f32_16x16x32_bf16 v[40:43], a[252:255], v[56:59], 0
    ds_write_b128 v222, v[8:11] offset:0
    v_fma_f32 v123, v171, v51, v123
    v_fma_f32 v124, v172, v52, v124
    v_mfma_f32_16x16x32_bf16 v[44:47], v[136:139], v[56:59], 0
    s_waitcnt vmcnt(10)
    v_fma_f32 v125, v173, v53, v125
    v_fma_f32 v126, v174, v54, v126
    v_mfma_f32_16x16x32_bf16 v[28:31], v[140:143], v[60:63], v[28:31]
    ds_write_b128 v222, v[12:15] offset:1024
    v_fma_f32 v127, v175, v55, v127
    v_fma_f32 v128, v176, v132, v128
    v_mfma_f32_16x16x32_bf16 v[32:35], v[144:147], v[60:63], v[32:35]
    v_fma_f32 v129, v177, v133, v129
    v_fma_f32 v130, v178, v134, v130
    v_mfma_f32_16x16x32_bf16 v[36:39], v[148:151], v[60:63], v[36:39]
    v_fma_f32 v131, v179, v135, v131
    v_cvt_pk_bf16_f32 v180, v120, v121
    v_mfma_f32_16x16x32_bf16 v[40:43], v[152:155], v[60:63], v[40:43]
    v_cvt_pk_bf16_f32 v181, v122, v123
    v_cvt_pk_bf16_f32 v182, v124, v125
    v_mfma_f32_16x16x32_bf16 v[44:47], v[156:159], v[60:63], v[44:47]
    s_waitcnt vmcnt(9)
    v_cvt_pk_bf16_f32 v183, v126, v127
    v_cvt_pk_bf16_f32 v184, v128, v129
    v_mfma_f32_16x16x32_bf16 v[28:31], v[160:163], v[64:67], v[28:31]
    ds_write_b128 v222, v[16:19] offset:2048
    v_cvt_pk_bf16_f32 v185, v130, v131
    v_mfma_f32_16x16x32_bf16 v[32:35], v[164:167], v[64:67], v[32:35]
    v_permlane16_swap_b32 v180, v182
    v_mfma_f32_16x16x32_bf16 v[36:39], a[0:3], v[64:67], v[36:39]
    ds_write_b128 v222, v[20:23] offset:3072
    v_permlane16_swap_b32 v181, v183
    v_mfma_f32_16x16x32_bf16 v[40:43], a[4:7], v[64:67], v[40:43]
    buffer_store_dwordx4 v[180:183], v227, s[40:43], s13 offen
    v_mfma_f32_16x16x32_bf16 v[44:47], a[8:11], v[64:67], v[44:47]
    s_waitcnt vmcnt(9)
    buffer_store_dwordx2 v[184:185], v228, s[40:43], s13 offen offset:64
    v_mfma_f32_16x16x32_bf16 v[28:31], a[12:15], v[68:71], v[28:31]
    ds_write_b128 v222, v[24:27] offset:4096
    v_mfma_f32_16x16x32_bf16 v[32:35], a[16:19], v[68:71], v[32:35]
    v_mfma_f32_16x16x32_bf16 v[36:39], a[20:23], v[68:71], v[36:39]
    v_mfma_f32_16x16x32_bf16 v[40:43], a[24:27], v[68:71], v[40:43]
    v_mfma_f32_16x16x32_bf16 v[44:47], a[28:31], v[68:71], v[44:47]
    s_waitcnt vmcnt(9)
    v_mfma_f32_16x16x32_bf16 v[28:31], a[32:35], v[72:75], v[28:31]
    v_mfma_f32_16x16x32_bf16 v[32:35], a[36:39], v[72:75], v[32:35]
    v_mfma_f32_16x16x32_bf16 v[36:39], a[40:43], v[72:75], v[36:39]
    v_mfma_f32_16x16x32_bf16 v[40:43], a[44:47], v[72:75], v[40:43]
    s_waitcnt lgkmcnt(0)
    s_barrier
    ds_read_b128 v[192:195], v225 offset:0
    v_mfma_f32_16x16x32_bf16 v[44:47], a[48:51], v[72:75], v[44:47]
    s_waitcnt vmcnt(8)
    ds_read_b128 v[196:199], v225 offset:1024
    v_mfma_f32_16x16x32_bf16 v[28:31], a[52:55], v[76:79], v[28:31]
    ds_read_b128 v[200:203], v225 offset:2048
    v_mfma_f32_16x16x32_bf16 v[32:35], a[56:59], v[76:79], v[32:35]
    ds_read_b128 v[204:207], v225 offset:10240
    v_mfma_f32_16x16x32_bf16 v[36:39], a[60:63], v[76:79], v[36:39]
    ds_read_b128 v[208:211], v225 offset:11264
    v_mfma_f32_16x16x32_bf16 v[40:43], a[64:67], v[76:79], v[40:43]
    ds_read_b128 v[212:215], v225 offset:12288
    v_mfma_f32_16x16x32_bf16 v[44:47], a[68:71], v[76:79], v[44:47]
    s_waitcnt vmcnt(7)
    v_mfma_f32_16x16x32_bf16 v[28:31], a[72:75], v[80:83], v[28:31]
    v_mfma_f32_16x16x32_bf16 v[32:35], a[76:79], v[80:83], v[32:35]
    v_mfma_f32_16x16x32_bf16 v[36:39], a[80:83], v[80:83], v[36:39]
    v_mfma_f32_16x16x32_bf16 v[40:43], a[84:87], v[80:83], v[40:43]
    v_mfma_f32_16x16x32_bf16 v[44:47], a[88:91], v[80:83], v[44:47]
    s_waitcnt vmcnt(6)
    v_mfma_f32_16x16x32_bf16 v[28:31], a[92:95], v[84:87], v[28:31]
    s_waitcnt lgkmcnt(2)
    v_add_f32 v192, v192, v204
    v_add_f32 v193, v193, v205
    v_mfma_f32_16x16x32_bf16 v[32:35], a[96:99], v[84:87], v[32:35]
    v_add_f32 v194, v194, v206
    v_add_f32 v195, v195, v207
    v_mfma_f32_16x16x32_bf16 v[36:39], a[100:103], v[84:87], v[36:39]
    s_waitcnt lgkmcnt(1)
    v_add_f32 v196, v196, v208
    v_add_f32 v197, v197, v209
    v_mfma_f32_16x16x32_bf16 v[40:43], a[104:107], v[84:87], v[40:43]
    v_add_f32 v198, v198, v210
    v_add_f32 v199, v199, v211
    v_mfma_f32_16x16x32_bf16 v[44:47], a[108:111], v[84:87], v[44:47]
    s_waitcnt lgkmcnt(0)
    v_add_f32 v200, v200, v212
    v_add_f32 v201, v201, v213
    s_waitcnt vmcnt(5)
    v_mfma_f32_16x16x32_bf16 v[28:31], a[112:115], v[88:91], v[28:31]
    v_add_f32 v202, v202, v214
    v_add_f32 v203, v203, v215
    v_mfma_f32_16x16x32_bf16 v[32:35], a[116:119], v[88:91], v[32:35]
    v_fma_f32 v232, v192, v48, v232
    v_fma_f32 v233, v193, v49, v233
    v_mfma_f32_16x16x32_bf16 v[36:39], a[120:123], v[88:91], v[36:39]
    v_fma_f32 v234, v194, v50, v234
    v_fma_f32 v235, v195, v51, v235
    v_mfma_f32_16x16x32_bf16 v[40:43], a[124:127], v[88:91], v[40:43]
    v_fma_f32 v236, v196, v52, v236
    v_fma_f32 v237, v197, v53, v237
    v_mfma_f32_16x16x32_bf16 v[44:47], a[128:131], v[88:91], v[44:47]
    s_waitcnt vmcnt(4)
    v_fma_f32 v238, v198, v54, v238
    v_fma_f32 v239, v199, v55, v239
    v_mfma_f32_16x16x32_bf16 v[28:31], a[132:135], v[92:95], v[28:31]
    v_fma_f32 v240, v200, v132, v240
    v_fma_f32 v241, v201, v133, v241
    v_mfma_f32_16x16x32_bf16 v[32:35], a[136:139], v[92:95], v[32:35]
    v_fma_f32 v242, v202, v134, v242
    v_fma_f32 v243, v203, v135, v243
    v_mfma_f32_16x16x32_bf16 v[36:39], a[140:143], v[92:95], v[36:39]
    v_mfma_f32_16x16x32_bf16 v[40:43], a[144:147], v[92:95], v[40:43]
    v_mfma_f32_16x16x32_bf16 v[44:47], a[148:151], v[92:95], v[44:47]
    s_waitcnt vmcnt(3)
    v_mfma_f32_16x16x32_bf16 v[28:31], a[152:155], v[96:99], v[28:31]
    v_mfma_f32_16x16x32_bf16 v[32:35], a[156:159], v[96:99], v[32:35]
    v_mfma_f32_16x16x32_bf16 v[36:39], a[160:163], v[96:99], v[36:39]
    v_mfma_f32_16x16x32_bf16 v[40:43], a[164:167], v[96:99], v[40:43]
    v_mfma_f32_16x16x32_bf16 v[44:47], a[168:171], v[96:99], v[44:47]
    s_waitcnt vmcnt(2)
    v_mfma_f32_16x16x32_bf16 v[28:31], a[172:175], v[100:103], v[28:31]
    v_mfma_f32_16x16x32_bf16 v[32:35], a[176:179], v[100:103], v[32:35]
    v_mfma_f32_16x16x32_bf16 v[36:39], a[180:183], v[100:103], v[36:39]
    v_mfma_f32_16x16x32_bf16 v[40:43], a[184:187], v[100:103], v[40:43]
    v_mfma_f32_16x16x32_bf16 v[44:47], a[188:191], v[100:103], v[44:47]
    s_nop 3
    ds_write_b128 v223, v[28:31] offset:0
    ds_write_b128 v223, v[32:35] offset:1024
    ds_write_b128 v223, v[36:39] offset:2048
    ds_write_b128 v223, v[40:43] offset:3072
    ds_write_b128 v223, v[44:47] offset:4096
    s_waitcnt lgkmcnt(0)
    s_barrier
    ds_read_b128 v[168:171], v226 offset:0
    ds_read_b128 v[172:175], v226 offset:1024
    ds_read_b128 v[176:179], v226 offset:2048
    ds_read_b128 v[180:183], v226 offset:10240
    ds_read_b128 v[184:187], v226 offset:11264
    ds_read_b128 v[188:191], v226 offset:12288
    s_waitcnt lgkmcnt(2)
    v_pk_add_f32 v[168:169], v[168:169], v[180:181]
    v_pk_add_f32 v[170:171], v[170:171], v[182:183]
    s_waitcnt lgkmcnt(1)
    v_pk_add_f32 v[172:173], v[172:173], v[184:185]
    v_pk_add_f32 v[174:175], v[174:175], v[186:187]
    s_waitcnt lgkmcnt(0)
    v_pk_add_f32 v[176:177], v[176:177], v[188:189]
    v_pk_add_f32 v[178:179], v[178:179], v[190:191]
    v_pk_fma_f32 v[232:233], v[168:169], v[48:49], v[232:233]
    v_pk_fma_f32 v[234:235], v[170:171], v[50:51], v[234:235]
    v_pk_fma_f32 v[236:237], v[172:173], v[52:53], v[236:237]
    v_pk_fma_f32 v[238:239], v[174:175], v[54:55], v[238:239]
    v_pk_fma_f32 v[240:241], v[176:177], v[132:133], v[240:241]
    v_pk_fma_f32 v[242:243], v[178:179], v[134:135], v[242:243]
    v_cvt_pk_bf16_f32 v168, v232, v233
    v_cvt_pk_bf16_f32 v169, v234, v235
    v_cvt_pk_bf16_f32 v170, v236, v237
    v_cvt_pk_bf16_f32 v171, v238, v239
    v_cvt_pk_bf16_f32 v172, v240, v241
    v_cvt_pk_bf16_f32 v173, v242, v243
    v_permlane16_swap_b32 v168, v170
    v_permlane16_swap_b32 v169, v171
    buffer_store_dwordx4 v[168:171], v227, s[40:43], s14 offen
    buffer_store_dwordx2 v[172:173], v228, s[40:43], s14 offen offset:64
    s_endpgm
L_end:
    s_endpgm
L_m_slow:
    buffer_load_dwordx2 v[232:233], v253, s[36:39], s55 offen sc1
    s_waitcnt vmcnt(0)
    v_cmp_ne_u32 vcc, s48, v233
    s_cbranch_vccz L_m_back
    s_cmp_eq_u32 s49, 0
    s_cbranch_scc1 L_m_back
    s_sub_u32 s49, s49, 1
    s_sleep 1
    s_branch L_m_slow
L_stc0_slow:
    buffer_load_dwordx4 v[200:203], v175, s[36:39], s6 offen offset:0 sc1
    buffer_load_dwordx4 v[204:207], v175, s[36:39], s6 offen offset:256 sc1
    buffer_load_dwordx4 v[208:211], v175, s[36:39], s6 offen offset:512 sc1
    buffer_load_dwordx4 v[212:215], v175, s[36:39], s6 offen offset:768 sc1
    s_waitcnt vmcnt(3)
    v_xor_b32 v3, s48, v201
    v_bitop3_b32 v3, v203, s48, v3 bitop3:0xbe
    s_waitcnt vmcnt(2)
    v_bitop3_b32 v3, v205, s48, v3 bitop3:0xbe
    v_bitop3_b32 v3, v207, s48, v3 bitop3:0xbe
    s_waitcnt vmcnt(1)
    v_bitop3_b32 v3, v209, s48, v3 bitop3:0xbe
    v_bitop3_b32 v3, v211, s48, v3 bitop3:0xbe
    s_waitcnt vmcnt(0)
    v_bitop3_b32 v3, v213, s48, v3 bitop3:0xbe
    v_bitop3_b32 v3, v215, s48, v3 bitop3:0xbe
    v_cmp_ne_u32 vcc, 0, v3
    s_cbranch_vccz L_stc0_back
    s_cmp_eq_u32 s49, 0
    s_cbranch_scc1 L_stc0_back
    s_sub_u32 s49, s49, 1
    s_branch L_stc0_slow
L_stc1_slow:
    buffer_load_dwordx4 v[200:203], v175, s[36:39], s6 offen offset:0 sc1
    buffer_load_dwordx4 v[204:207], v175, s[36:39], s6 offen offset:256 sc1
    buffer_load_dwordx4 v[208:211], v175, s[36:39], s6 offen offset:512 sc1
    buffer_load_dwordx4 v[212:215], v175, s[36:39], s6 offen offset:768 sc1
    s_waitcnt vmcnt(3)
    v_xor_b32 v3, s48, v201
    v_bitop3_b32 v3, v203, s48, v3 bitop3:0xbe
    s_waitcnt vmcnt(2)
    v_bitop3_b32 v3, v205, s48, v3 bitop3:0xbe
    v_bitop3_b32 v3, v207, s48, v3 bitop3:0xbe
    s_waitcnt vmcnt(1)
    v_bitop3_b32 v3, v209, s48, v3 bitop3:0xbe
    v_bitop3_b32 v3, v211, s48, v3 bitop3:0xbe
    s_waitcnt vmcnt(0)
    v_bitop3_b32 v3, v213, s48, v3 bitop3:0xbe
    v_bitop3_b32 v3, v215, s48, v3 bitop3:0xbe
    v_cmp_ne_u32 vcc, 0, v3
    s_cbranch_vccz L_stc1_back
    s_cmp_eq_u32 s49, 0
    s_cbranch_scc1 L_stc1_back
    s_sub_u32 s49, s49, 1
    s_branch L_stc1_slow
L_stp0_slow:
    buffer_load_dwordx4 v[200:203], v175, s[36:39], s6 offen offset:0 sc1
    buffer_load_dwordx4 v[204:207], v175, s[36:39], s6 offen offset:256 sc1
    buffer_load_dwordx4 v[208:211], v175, s[36:39], s6 offen offset:512 sc1
    buffer_load_dwordx4 v[212:215], v175, s[36:39], s6 offen offset:768 sc1
    s_waitcnt vmcnt(3)
    v_xor_b32 v3, s48, v201
    v_bitop3_b32 v3, v203, s48, v3 bitop3:0xbe
    s_waitcnt vmcnt(2)
    v_bitop3_b32 v3, v205, s48, v3 bitop3:0xbe
    v_bitop3_b32 v3, v207, s48, v3 bitop3:0xbe
    s_waitcnt vmcnt(1)
    v_bitop3_b32 v3, v209, s48, v3 bitop3:0xbe
    v_bitop3_b32 v3, v211, s48, v3 bitop3:0xbe
    s_waitcnt vmcnt(0)
    v_bitop3_b32 v3, v213, s48, v3 bitop3:0xbe
    v_bitop3_b32 v3, v215, s48, v3 bitop3:0xbe
    v_cmp_ne_u32 vcc, 0, v3
    s_cbranch_vccz L_stp0_back
    s_cmp_eq_u32 s49, 0
    s_cbranch_scc1 L_stp0_back
    s_sub_u32 s49, s49, 1
    s_branch L_stp0_slow
L_stp1_slow:
    buffer_load_dwordx4 v[200:203], v175, s[36:39], s6 offen offset:0 sc1
    buffer_load_dwordx4 v[204:207], v175, s[36:39], s6 offen offset:256 sc1
    buffer_load_dwordx4 v[208:211], v175, s[36:39], s6 offen offset:512 sc1
    buffer_load_dwordx4 v[212:215], v175, s[36:39], s6 offen offset:768 sc1
    s_waitcnt vmcnt(3)
    v_xor_b32 v3, s48, v201
    v_bitop3_b32 v3, v203, s48, v3 bitop3:0xbe
    s_waitcnt vmcnt(2)
    v_bitop3_b32 v3, v205, s48, v3 bitop3:0xbe
    v_bitop3_b32 v3, v207, s48, v3 bitop3:0xbe
    s_waitcnt vmcnt(1)
    v_bitop3_b32 v3, v209, s48, v3 bitop3:0xbe
    v_bitop3_b32 v3, v211, s48, v3 bitop3:0xbe
    s_waitcnt vmcnt(0)
    v_bitop3_b32 v3, v213, s48, v3 bitop3:0xbe
    v_bitop3_b32 v3, v215, s48, v3 bitop3:0xbe
    v_cmp_ne_u32 vcc, 0, v3
    s_cbranch_vccz L_stp1_back
    s_cmp_eq_u32 s49, 0
    s_cbranch_scc1 L_stp1_back
    s_sub_u32 s49, s49, 1
    s_branch L_stp1_slow
L_chk4_slow:
L_poll30:
    buffer_load_dword v243, v240, s[36:39], s69 offen sc1
    s_waitcnt vmcnt(0)
    v_cmp_ne_u32 vcc, s48, v243
    s_cbranch_vccz L_poll30_ok
    s_cmp_eq_u32 s49, 0
    s_cbranch_scc1 L_poll30_ok
    s_sub_u32 s49, s49, 1
    s_sleep 1
    s_branch L_poll30
L_poll30_ok:
    s_branch L_chk4_back
L_chk6_slow:
L_poll31:
    buffer_load_dword v243, v241, s[36:39], s60 offen sc1
    s_waitcnt vmcnt(0)
    v_cmp_ne_u32 vcc, s48, v243
    s_cbranch_vccz L_poll31_ok
    s_cmp_eq_u32 s49, 0
    s_cbranch_scc1 L_poll31_ok
    s_sub_u32 s49, s49, 1
    s_sleep 1
    s_branch L_poll31
L_poll31_ok:
    s_branch L_chk6_back
L_chk7_slow:
L_poll32:
    buffer_load_dword v223, v219, s[36:39], s17 offen sc1
    s_waitcnt vmcnt(0)
    v_cmp_ne_u32 vcc, s48, v223
    s_cbranch_vccz L_poll32_ok
    s_cmp_eq_u32 s49, 0
    s_cbranch_scc1 L_poll32_ok
    s_sub_u32 s49, s49, 1
    s_sleep 1
    s_branch L_poll32
L_poll32_ok:
    s_branch L_chk7_back
L_chk9_slow:
L_poll33:
    buffer_load_dword v244, v243, s[36:39], s58 offen sc1
    s_waitcnt vmcnt(0)
    v_cmp_ne_u32 vcc, s48, v244
    s_cbranch_vccz L_poll33_ok
    s_cmp_eq_u32 s49, 0
    s_cbranch_scc1 L_poll33_ok
    s_sub_u32 s49, s49, 1
    s_sleep 1
    s_branch L_poll33
L_poll33_ok:
    s_branch L_chk9_back
L_chk10_slow:
L_poll34:
    buffer_load_dword v240, v219, s[36:39], s17 offen sc1
    s_waitcnt vmcnt(0)
    v_cmp_ne_u32 vcc, s48, v240
    s_cbranch_vccz L_poll34_ok
    s_cmp_eq_u32 s49, 0
    s_cbranch_scc1 L_poll34_ok
    s_sub_u32 s49, s49, 1
    s_sleep 1
    s_branch L_poll34
L_poll34_ok:
    s_branch L_chk10_back
L_chk12_slow:
L_poll35:
    buffer_load_dword v247, v246, s[36:39], s17 offen sc1
    s_waitcnt vmcnt(0)
    v_cmp_ne_u32 vcc, s48, v247
    s_cbranch_vccz L_poll35_ok
    s_cmp_eq_u32 s49, 0
    s_cbranch_scc1 L_poll35_ok
    s_sub_u32 s49, s49, 1
    s_sleep 1
    s_branch L_poll35
L_poll35_ok:
    s_branch L_chk12_back
L_chk14_slow:
L_poll36:
    buffer_load_dword v247, v246, s[36:39], s17 offen sc1
    s_waitcnt vmcnt(0)
    v_cmp_ne_u32 vcc, s48, v247
    s_cbranch_vccz L_poll36_ok
    s_cmp_eq_u32 s49, 0
    s_cbranch_scc1 L_poll36_ok
    s_sub_u32 s49, s49, 1
    s_sleep 1
    s_branch L_poll36
L_poll36_ok:
    s_branch L_chk14_back
L_chk24_slow:
L_poll37:
    buffer_load_dword v244, v243, s[36:39], s58 offen sc1
    s_waitcnt vmcnt(0)
    v_cmp_ne_u32 vcc, s48, v244
    s_cbranch_vccz L_poll37_ok
    s_cmp_eq_u32 s49, 0
    s_cbranch_scc1 L_poll37_ok
    s_sub_u32 s49, s49, 1
    s_sleep 1
    s_branch L_poll37
L_poll37_ok:
    s_branch L_chk24_back
L_chk25_slow:
L_poll38:
    buffer_load_dword v240, v219, s[36:39], s17 offen sc1
    s_waitcnt vmcnt(0)
    v_cmp_ne_u32 vcc, s48, v240
    s_cbranch_vccz L_poll38_ok
    s_cmp_eq_u32 s49, 0
    s_cbranch_scc1 L_poll38_ok
    s_sub_u32 s49, s49, 1
    s_sleep 1
    s_branch L_poll38
L_poll38_ok:
    s_branch L_chk25_back
L_chk27_slow:
L_poll39:
    buffer_load_dword v247, v246, s[36:39], s17 offen sc1
    s_waitcnt vmcnt(0)
    v_cmp_ne_u32 vcc, s48, v247
    s_cbranch_vccz L_poll39_ok
    s_cmp_eq_u32 s49, 0
    s_cbranch_scc1 L_poll39_ok
    s_sub_u32 s49, s49, 1
    s_sleep 1
    s_branch L_poll39
L_poll39_ok:
    s_branch L_chk27_back
L_chk29_slow:
L_poll40:
    buffer_load_dword v247, v246, s[36:39], s17 offen sc1
    s_waitcnt vmcnt(0)
    v_cmp_ne_u32 vcc, s48, v247
    s_cbranch_vccz L_poll40_ok
    s_cmp_eq_u32 s49, 0
    s_cbranch_scc1 L_poll40_ok
    s_sub_u32 s49, s49, 1
    s_sleep 1
    s_branch L_poll40
L_poll40_ok:
    s_branch L_chk29_back
L_code_end:
.section .rodata,"a"
.p2align 6
.amdhsa_kernel adaLN_cond__ssm_conv_h3__glu_gated_bilinear__prompt_kernel
  .amdhsa_next_free_vgpr 512
  .amdhsa_next_free_sgpr 102
  .amdhsa_accum_offset 256
  .amdhsa_group_segment_fixed_size 0
  .amdhsa_kernarg_size 120
  .amdhsa_user_sgpr_count 2
  .amdhsa_user_sgpr_kernarg_segment_ptr 1
  .amdhsa_system_sgpr_workgroup_id_x 1
.end_amdhsa_kernel
```

```asm
; @launch grid=(256,1,1) block=(256,1,1) lds=163840
.amdgcn_target "amdgcn-amd-amdhsa--gfx950"
.text
.globl adaLN_cond__ssm_conv_h3__glu_gated_bilinear__prompt_kernel
.p2align 8
.type adaLN_cond__ssm_conv_h3__glu_gated_bilinear__prompt_kernel,@function
adaLN_cond__ssm_conv_h3__glu_gated_bilinear__prompt_kernel:
    s_load_dwordx16 s[4:19], s[0:1], 0
    s_load_dwordx8 s[20:27], s[0:1], 64
    s_load_dwordx4 s[28:31], s[0:1], 96
    s_load_dwordx2 s[32:33], s[0:1], 112
    s_cmp_ge_u32 s2, 256
    s_cbranch_scc1 L_end
    v_lshrrev_b32 v1, 6, v0
    s_lshr_b32 s51, s2, 3
    s_mov_b32 s43, 0x20000
    v_readfirstlane_b32 s3, v1
    v_and_b32 v1, 63, v0
    s_and_b32 s50, s2, 7
    s_mov_b32 s47, s43
    s_sub_u32 s71, s2, 160
    s_cbranch_scc0 L_e_prep
    s_mul_i32 s52, s50, 327680
    s_lshl_b32 s53, s51, 7
    s_add_u32 s52, s52, s53
    s_cmp_ge_u32 s51, 10
    s_cselect_b32 s53, 162560, 0
    s_add_u32 s52, s52, s53
    v_lshrrev_b32 v3, 3, v1
    v_mul_u32_u24 v3, 1280, v3
    v_and_b32 v4, 7, v1
    v_lshl_add_u32 v3, v4, 4, v3
    s_mul_i32 s53, s3, 40960
    s_add_u32 s53, s53, s52
    s_mul_i32 s54, s3, 4352
    s_movk_i32 s55, 9152
    v_add_u32 v10, s55, v3
    v_add_u32 v11, s55, v10
    v_add_u32 v12, s55, v11
    s_add_u32 m0, s54, 26624
    s_mov_b32 s42, 2621440
    s_mov_b32 s46, s42
    s_waitcnt lgkmcnt(0)
    s_mov_b64 s[40:41], s[6:7]
    s_mov_b64 s[44:45], s[8:9]
    buffer_load_dwordx4 v3, s[40:43], s53 offen offset:0 nt lds
    buffer_load_dwordx4 v10, s[40:43], s53 offen offset:1088 nt lds
    buffer_load_dwordx4 v11, s[40:43], s53 offen offset:2176 nt lds
    buffer_load_dwordx4 v12, s[40:43], s53 offen offset:3264 nt lds
    s_add_u32 m0, s54, 44032
    s_sub_u32 s55, s52, 10240
    buffer_load_dwordx4 v3, s[44:47], s53 offen offset:0 nt lds
    buffer_load_dwordx4 v10, s[44:47], s53 offen offset:1088 nt lds
    buffer_load_dwordx4 v11, s[44:47], s53 offen offset:2176 nt lds
    buffer_load_dwordx4 v12, s[44:47], s53 offen offset:3264 nt lds
    v_add_u32 v5, s55, v3
    s_cmp_eq_u32 s3, 0
    s_cbranch_scc0 L_nohalo
    s_mov_b32 m0, 25536
    s_nop 0
    buffer_load_dwordx4 v5, s[40:43], 0 offen nt lds
L_nohalo:
    s_cmp_ge_u32 s51, 10
    s_cselect_b32 s55, 10, 0
    s_sub_u32 s55, s51, s55
    s_lshl_b32 s55, s55, 1
    s_and_b32 s56, s3, 1
    s_add_u32 s55, s55, s56
    s_lshl_b32 s55, s55, 8
    v_lshl_add_u32 v8, v4, 5, s55
    global_load_dwordx4 v[48:51], v8, s[10:11]
    global_load_dwordx4 v[52:55], v8, s[10:11] offset:16
    s_mov_b32 s36, s32
    s_mov_b32 s37, s33
    s_mov_b32 s38, 0x10000000
    s_mov_b32 s39, 0x20000
    v_mov_b32 v2, 0
    s_mov_b32 s57, 23461888
    buffer_load_dword v246, v2, s[36:39], s57 offen sc1
    s_branch L_conv
L_e_prep:
    s_getpc_b64 s[40:41]
L_pc0:
    s_sub_u32 s52, s51, 20
    s_mov_b32 s42, L_code_end-L_pc0
    v_lshrrev_b32 v2, 2, v0
    s_lshl_b32 s52, s52, 13
    v_lshlrev_b32 v2, 7, v2
    buffer_load_dword v252, v2, s[40:43], s52 offen
    s_cmp_ge_u32 s71, 60
    s_cbranch_scc1 L_e_q
    s_sub_u32 s52, s71, 30
    s_sub_u32 s77, 79, s71
    s_cmp_lt_u32 s52, 20
    s_cselect_b32 s77, s77, s71
    v_lshrrev_b32 v8, 3, v0
    v_mul_u32_u24 v9, 153600, v8
    v_and_b32 v8, 7, v0
    v_lshl_add_u32 v9, v8, 4, v9
    s_lshl_b32 s56, s77, 7
    s_movk_i32 s68, 7680
    s_mov_b32 s46, 4915200
    s_waitcnt lgkmcnt(0)
    s_mov_b64 s[44:45], s[26:27]
    v_lshrrev_b32 v2, 3, v0
    v_mul_u32_u24 v3, 40, v2
    global_load_dwordx2 v[80:81], v3, s[24:25] offset:0
    global_load_dwordx2 v[82:83], v3, s[24:25] offset:8
    global_load_dwordx2 v[84:85], v3, s[24:25] offset:16
    global_load_dwordx2 v[86:87], v3, s[24:25] offset:24
    global_load_dwordx2 v[88:89], v3, s[24:25] offset:32
    s_branch L_prep
L_e_q:
    s_lshr_b32 s53, s50, 2
    s_xor_b32 s53, s53, s51
    s_and_b32 s53, s53, 1
    s_xor_b32 s76, s53, 1
    s_cmp_ge_u32 s71, 64
    s_cselect_b32 s65, s76, 0
    s_cselect_b32 s53, s53, 0
    s_lshl_b32 s50, s50, 2
    s_lshr_b32 s51, s2, 3
    s_and_b32 s51, s51, 3
    s_add_u32 s77, s50, s51
    s_cmp_lt_u32 s71, 64
    s_waitcnt lgkmcnt(0)
    s_cbranch_scc1 L_p_b
    s_branch L_p_s
L_conv:
    s_mov_b32 s49, 400000
    s_and_b32 s50, s2, 7
    s_lshr_b32 s51, s2, 3
    s_lshr_b32 s60, s50, 2
    s_lshl_b32 s60, s60, 3
    s_lshr_b32 s61, s51, 2
    s_add_u32 s72, s60, s61
    s_lshl_b32 s61, s61, 3
    s_mov_b32 s62, 0x6040200
    s_mov_b32 s63, 0x70308
    s_lshr_b64 s[62:63], s[62:63], s61
    s_and_b32 s34, s62, 255
    s_lshr_b32 s62, s50, 2
    s_mul_i32 s62, s62, 10
    s_add_u32 s34, s34, s62
    s_sub_u32 s62, s34, 20
    s_min_u32 s34, s34, s62
    s_and_b32 s60, s50, 3
    s_lshl_b32 s60, s60, 2
    s_and_b32 s61, s51, 3
    s_add_u32 s73, s60, s61
    s_and_b32 s75, s51, 7
    s_lshr_b32 s61, s51, 3
    s_lshl_b32 s60, s50, 2
    s_add_u32 s74, s60, s61
    s_mul_i32 s70, s50, 20
    s_add_u32 s70, s70, s51
    s_lshl_b32 s60, s50, 1
    s_cmp_ge_u32 s51, 10
    s_addc_u32 s60, s60, 0
    s_cmp_ge_u32 s51, 10
    s_cselect_b32 s61, 10, 0
    s_sub_u32 s61, s51, s61
    s_lshl_b32 s61, s61, 4
    s_add_u32 s76, s60, s61
    s_lshl_b32 s58, s70, 2
    s_add_u32 s58, s58, s3
    v_lshlrev_b32 v248, 4, v1
    s_add_u32 m0, s54, 61440
    s_mov_b64 s[44:45], s[4:5]
    buffer_load_dwordx4 v3, s[44:47], s53 offen offset:0 nt lds
    buffer_load_dwordx4 v10, s[44:47], s53 offen offset:1088 nt lds
    buffer_load_dwordx4 v11, s[44:47], s53 offen offset:2176 nt lds
    buffer_load_dwordx4 v12, s[44:47], s53 offen offset:3264 nt lds
    s_lshr_b32 s50, s76, 4
    s_and_b32 s51, s76, 15
    s_lshr_b32 s55, s3, 1
    s_and_b32 s56, s3, 1
    s_lshl_b32 s51, s51, 7
    s_lshl_b32 s57, s55, 6
    s_add_u32 s51, s51, s57
    s_lshl_b32 s50, s50, 6
    s_lshl_b32 s57, s56, 5
    s_add_u32 s50, s50, s57
    v_lshrrev_b32 v5, 3, v1
    v_lshl_add_u32 v6, v5, 3, s51
    v_lshl_add_u32 v7, v4, 2, s50
    v_mul_u32_u24 v7, 4096, v7
    v_lshl_add_u32 v245, v6, 1, v7
    v_sub_u32 v6, 2040, v6
    v_lshl_add_u32 v247, v6, 1, v7
    s_mul_i32 s55, s55, 8704
    s_lshl_b32 s56, s56, 6
    s_add_u32 s55, s55, s56
    s_add_u32 s55, s55, 25536
    v_mul_u32_u24 v5, 1088, v5
    v_lshl_add_u32 v5, v4, 3, v5
    v_add_u32 v244, s55, v5
    v_mov_b32 v243, v3
    s_and_b32 s50, s3, 1
    s_mul_i32 s61, s50, 3104
    s_mul_i32 s50, s50, 12288
    s_mul_i32 s64, s73, 192
    s_add_u32 s64, s64, s50
    s_mul_i32 s50, s34, 98304
    s_add_u32 s64, s64, s50
    s_cmp_ge_u32 s3, 2
    s_cselect_b32 s40, s20, s18
    s_cselect_b32 s41, s21, s19
    s_cselect_b32 s50, 6224, 0
    s_add_u32 s61, s61, s50
    s_mov_b32 s42, 1966080
    s_mov_b32 s43, 0x20000
    v_add_u32 v2, 0, v1
    v_mul_u32_u24 v3, 171, v2
    v_lshrrev_b32 v3, 11, v3
    v_mul_u32_u24 v4, 12, v3
    v_sub_u32 v4, v2, v4
    v_and_b32 v2, 12, v3
    v_add_u32 v3, v3, v2
    v_mul_u32_u24 v3, 3072, v3
    v_lshl_add_u32 v224, v4, 4, v3
    v_add_u32 v2, 64, v1
    v_mul_u32_u24 v3, 171, v2
    v_lshrrev_b32 v3, 11, v3
    v_mul_u32_u24 v4, 12, v3
    v_sub_u32 v4, v2, v4
    v_and_b32 v2, 12, v3
    v_add_u32 v3, v3, v2
    v_mul_u32_u24 v3, 3072, v3
    v_lshl_add_u32 v225, v4, 4, v3
    v_subrev_u32 v225, 1024, v225
    v_add_u32 v2, 128, v1
    v_mul_u32_u24 v3, 171, v2
    v_lshrrev_b32 v3, 11, v3
    v_mul_u32_u24 v4, 12, v3
    v_sub_u32 v4, v2, v4
    v_and_b32 v2, 12, v3
    v_add_u32 v3, v3, v2
    v_mul_u32_u24 v3, 3072, v3
    v_lshl_add_u32 v226, v4, 4, v3
    v_subrev_u32 v226, 2048, v226
    s_mul_i32 s50, s3, 48
    v_lshrrev_b32 v2, 5, v1
    v_bfe_u32 v3, v1, 2, 2
    v_lshl_add_u32 v2, v2, 2, v3
    v_mul_u32_u24 v2, 192, v2
    v_bfe_u32 v3, v1, 4, 1
    v_mul_u32_u24 v3, 3104, v3
    v_add3_u32 v2, v2, v3, s50
    v_and_b32 v3, 3, v1
    v_lshl_add_u32 v227, v3, 3, v2
    v_and_b32 v3, 1, v1
    v_lshl_add_u32 v2, v3, 3, v2
    v_bfe_u32 v3, v1, 1, 1
    v_mul_u32_u24 v3, 6224, v3
    v_add3_u32 v228, v2, v3, 32
    s_mul_i32 s51, s3, 16640
    s_add_u32 s51, s51, 78848
    v_add_u32 v223, s51, v248
    v_lshrrev_b32 v8, 1, v1
    v_mul_u32_u24 v8, 4160, v8
    v_and_b32 v4, 1, v1
    v_lshl_add_u32 v8, v4, 4, v8
    v_add_u32 v8, s51, v8
    v_mov_b32 v4, 0
    v_mov_b32 v5, 0
    v_mov_b32 v6, 0
    v_mov_b32 v7, 0
    s_mov_b64 exec, 0xff
    ds_write_b128 v8, v[4:7]
    s_mul_i32 s52, s3, 4608
    s_add_u32 s52, s52, 149504
    s_mov_b64 exec, 0x3fffffff
    v_add_u32 v8, s52, v248
    ds_write_b128 v8, v[4:7]
    s_mov_b64 exec, -1
    v_and_b32 v2, 15, v1
    v_lshrrev_b32 v8, 4, v1
    v_lshlrev_b32 v249, 6, v2
    v_lshl_add_u32 v249, v8, 4, v249
    v_add_u32 v249, 62464, v249
    v_and_b32 v231, 1, v8
    v_lshlrev_b32 v231, 9, v231
    v_lshl_add_u32 v231, v2, 5, v231
    v_lshrrev_b32 v8, 1, v8
    v_lshl_add_u32 v231, v8, 4, v231
    s_mul_i32 s68, s58, 4096
    s_add_u32 s65, s68, 2883584
    s_add_u32 s68, s68, 0
    s_lshl_b32 s66, s3, 12
    s_add_u32 s67, s66, 23068672
    s_lshl_b32 s59, s58, 1
    v_mov_b32 v250, 0
    v_mov_b32 v251, s59
    global_load_short_d16_hi v250, v251, s[14:15]
    v_min_u32 v240, 11, v1
    v_lshlrev_b32 v240, 7, v240
    s_lshr_b32 s52, s70, 4
    s_lshl_b32 s52, s52, 11
    s_add_u32 s59, s52, 23199744
    s_lshl_b32 s69, s3, 9
    s_sub_u32 s52, s52, s69
    s_add_u32 s52, s52, 153600
    v_cmp_lt_u32 vcc, 7, v1
    v_mov_b32 v241, s52
    s_nop 0
    v_cndmask_b32 v241, 0, v241, vcc
    v_add_u32 v240, v240, v241
    s_lshl_b32 s69, s3, 10
    s_add_u32 s69, s69, 23220224
    s_lshl_b32 s55, s58, 3
    s_add_u32 s55, s55, 23560192
    v_and_b32 v253, 3, v1
    v_cmp_eq_u32 vcc, 3, v253
    s_nop 1
    v_addc_co_u32 v253, vcc, 0, v253, vcc
    v_mul_u32_u24 v253, 5120, v253
    v_min_u32 v241, 9, v1
    v_lshlrev_b32 v241, 7, v241
    s_mov_b32 s60, 23230464
    v_min_u32 v242, 15, v1
    v_lshlrev_b32 v242, 7, v242
    v_and_b32 v2, 15, v1
    v_lshrrev_b32 v8, 4, v1
    v_add_u32 v4, 1, v2
    v_and_b32 v5, 3, v4
    v_sub_u32 v4, v4, v5
    v_add_u32 v4, 24, v4
    v_lshlrev_b32 v4, 1, v4
    v_mul_u32_u24 v5, 4160, v5
    v_add_u32 v4, v4, v5
    v_lshlrev_b32 v5, 4, v8
    v_sub_u32 v4, v4, v5
    s_mul_i32 s51, s3, 16640
    s_add_u32 s51, s51, 78848
    v_add_u32 v229, s51, v4
    v_lshlrev_b32 v2, 5, v2
    v_add_u32 v2, v2, v5
    s_mul_i32 s52, s3, 4608
    s_add_u32 s52, s52, 145936
    v_sub_u32 v230, s52, v2
    v_lshrrev_b32 v2, 3, v1
    v_bfe_u32 v3, v1, 4, 2
    v_lshlrev_b32 v3, 1, v3
    v_xor_b32 v3, v3, v1
    v_and_b32 v3, 7, v3
    v_mul_u32_u24 v2, 4096, v2
    v_lshl_add_u32 v172, v3, 4, v2
    v_add_u32 v172, 0, v172
    v_lshrrev_b32 v2, 2, v1
    v_lshlrev_b32 v2, 7, v2
    v_and_b32 v3, 3, v1
    v_lshl_add_u32 v2, v3, 3, v2
    v_bfe_u32 v3, v1, 3, 2
    v_xor_b32 v168, 0, v3
    v_lshl_add_u32 v168, v168, 5, v2
    v_xor_b32 v169, 1, v3
    v_lshl_add_u32 v169, v169, 5, v2
    v_xor_b32 v170, 2, v3
    v_lshl_add_u32 v170, v170, 5, v2
    v_xor_b32 v171, 3, v3
    v_lshl_add_u32 v171, v171, 5, v2
    v_and_b32 v175, 15, v1
    v_lshlrev_b32 v175, 4, v175
    v_bfe_u32 v2, v1, 4, 1
    v_lshrrev_b32 v3, 5, v1
    v_mul_u32_u24 v173, 49152, v2
    v_lshl_add_u32 v173, v3, 8, v173
    v_add_u32 v173, v173, v175
    v_lshl_add_u32 v2, v2, 1, v3
    v_mul_u32_u24 v174, 49152, v2
    v_add_u32 v174, v174, v175
    v_bfe_u32 v2, v0, 1, 2
    v_lshlrev_b32 v2, 1, v2
    s_lshr_b32 s50, s73, 1
    v_xor_b32 v2, s50, v2
    v_lshlrev_b32 v2, 4, v2
    v_lshl_add_u32 v216, v0, 7, v2
    s_and_b32 s50, s73, 1
    s_lshl_b32 s50, s50, 3
    v_add_u32 v216, s50, v216
    v_add_u32 v217, 0x8000, v216
    v_add_u32 v218, 0x10000, v216
    v_cmp_gt_u32 vcc, 128, v0
    s_nop 1
    v_cndmask_b32 v218, v217, v218, vcc
    s_lshl_b32 s50, s3, 10
    v_add_u32 v175, s50, v175
    v_lshrrev_b32 v2, 1, v1
    v_lshlrev_b32 v2, 10, v2
    v_and_b32 v3, 1, v1
    v_lshl_add_u32 v219, v3, 7, v2
    s_lshl_b32 s50, s3, 8
    s_add_u32 s50, s50, 46080
    v_add_u32 v219, s50, v219
    s_add_u32 s50, s50, 19456
    v_mov_b32 v2, s50
    v_cmp_lt_u32 vcc, 39, v1
    s_nop 1
    v_cndmask_b32 v219, v219, v2, vcc
    v_mov_b32 v3, v243
    s_waitcnt vmcnt(7)
    v_lshlrev_b32 v104, 16, v48
    v_and_b32 v108, 0xffff0000, v48
    v_lshlrev_b32 v112, 16, v49
    v_and_b32 v116, 0xffff0000, v49
    v_lshlrev_b32 v105, 16, v50
    v_and_b32 v109, 0xffff0000, v50
    v_lshlrev_b32 v113, 16, v51
    v_and_b32 v117, 0xffff0000, v51
    s_waitcnt vmcnt(6)
    v_lshlrev_b32 v106, 16, v52
    v_and_b32 v110, 0xffff0000, v52
    v_lshlrev_b32 v114, 16, v53
    v_and_b32 v118, 0xffff0000, v53
    v_lshlrev_b32 v107, 16, v54
    v_and_b32 v111, 0xffff0000, v54
    v_lshlrev_b32 v115, 16, v55
    v_and_b32 v119, 0xffff0000, v55
    s_waitcnt vmcnt(5)
    s_barrier
    ds_read_b64 v[10:11], v244 offset:640
    ds_read_b64 v[12:13], v244 offset:768
    ds_read_b64 v[14:15], v244 offset:896
    ds_read_b64 v[16:17], v244 offset:1088
    ds_read_b64 v[18:19], v244 offset:1216
    ds_read_b64 v[20:21], v244 offset:1344
    ds_read_b64 v[22:23], v244 offset:1472
    ds_read_b64 v[24:25], v244 offset:1600
    ds_read_b64 v[26:27], v244 offset:1728
    ds_read_b64 v[28:29], v244 offset:1856
    ds_read_b64 v[30:31], v244 offset:1984
    ds_read_b64 v[32:33], v244 offset:18496
    ds_read_b64 v[34:35], v244 offset:18624
    ds_read_b64 v[36:37], v244 offset:18752
    ds_read_b64 v[38:39], v244 offset:18880
    ds_read_b64 v[40:41], v244 offset:19008
    ds_read_b64 v[42:43], v244 offset:19136
    ds_read_b64 v[44:45], v244 offset:19264
    ds_read_b64 v[46:47], v244 offset:19392
    s_lshl_b32 s50, s58, 12
    s_mul_i32 s51, s3, 16640
    s_add_u32 m0, s51, 78880
    s_mov_b32 s44, s12
    s_mov_b32 s45, s13
    s_mov_b32 s46, 0x280000
    s_mov_b32 s47, 0x20000
    buffer_load_dwordx4 v248, s[44:47], s50 offen offset:0 nt lds
    buffer_load_dwordx4 v248, s[44:47], s50 offen offset:1024 nt lds
    buffer_load_dwordx4 v248, s[44:47], s50 offen offset:2048 nt lds
    buffer_load_dwordx4 v248, s[44:47], s50 offen offset:3072 nt lds
    s_waitcnt lgkmcnt(14)
    v_lshlrev_b32 v60, 16, v10
    v_and_b32 v61, 0xffff0000, v10
    v_lshlrev_b32 v62, 16, v11
    v_and_b32 v63, 0xffff0000, v11
    v_lshlrev_b32 v64, 16, v12
    v_and_b32 v65, 0xffff0000, v12
    v_lshlrev_b32 v66, 16, v13
    v_and_b32 v67, 0xffff0000, v13
    v_lshlrev_b32 v68, 16, v14
    v_and_b32 v69, 0xffff0000, v14
    v_lshlrev_b32 v70, 16, v15
    v_and_b32 v71, 0xffff0000, v15
    v_lshlrev_b32 v72, 16, v16
    v_and_b32 v73, 0xffff0000, v16
    v_lshlrev_b32 v74, 16, v17
    v_and_b32 v75, 0xffff0000, v17
    v_lshlrev_b32 v76, 16, v18
    v_and_b32 v77, 0xffff0000, v18
    v_lshlrev_b32 v78, 16, v19
    v_and_b32 v79, 0xffff0000, v19
    s_waitcnt lgkmcnt(13)
    v_lshlrev_b32 v80, 16, v20
    v_and_b32 v81, 0xffff0000, v20
    v_lshlrev_b32 v82, 16, v21
    v_and_b32 v83, 0xffff0000, v21
    s_waitcnt lgkmcnt(12)
    v_lshlrev_b32 v84, 16, v22
    v_and_b32 v85, 0xffff0000, v22
    v_lshlrev_b32 v86, 16, v23
    v_and_b32 v87, 0xffff0000, v23
    s_waitcnt lgkmcnt(11)
    v_lshlrev_b32 v88, 16, v24
    v_and_b32 v89, 0xffff0000, v24
    v_lshlrev_b32 v90, 16, v25
    v_and_b32 v91, 0xffff0000, v25
    s_waitcnt lgkmcnt(10)
    v_lshlrev_b32 v92, 16, v26
    v_and_b32 v93, 0xffff0000, v26
    v_lshlrev_b32 v94, 16, v27
    v_and_b32 v95, 0xffff0000, v27
    s_waitcnt lgkmcnt(9)
    v_lshlrev_b32 v96, 16, v28
    v_and_b32 v97, 0xffff0000, v28
    v_lshlrev_b32 v98, 16, v29
    v_and_b32 v99, 0xffff0000, v29
    s_waitcnt lgkmcnt(8)
    v_lshlrev_b32 v100, 16, v30
    v_and_b32 v101, 0xffff0000, v30
    v_lshlrev_b32 v102, 16, v31
    v_and_b32 v103, 0xffff0000, v31
    s_movk_i32 s16, 4096
    s_movk_i32 s17, 8192
    s_movk_i32 s62, 12288
    v_pk_mul_f32 v[120:121], v[60:61], v[116:117]
    v_pk_fma_f32 v[120:121], v[64:65], v[112:113], v[120:121]
    v_pk_fma_f32 v[120:121], v[68:69], v[108:109], v[120:121]
    v_pk_fma_f32 v[120:121], v[72:73], v[104:105], v[120:121]
    s_waitcnt lgkmcnt(7)
    v_lshlrev_b32 v56, 16, v32
    v_and_b32 v57, 0xffff0000, v32
    v_pk_mul_f32 v[120:121], v[120:121], v[56:57]
    v_pk_mul_f32 v[124:125], v[64:65], v[116:117]
    v_pk_fma_f32 v[124:125], v[68:69], v[112:113], v[124:125]
    v_pk_fma_f32 v[124:125], v[72:73], v[108:109], v[124:125]
    v_pk_fma_f32 v[124:125], v[76:77], v[104:105], v[124:125]
    s_waitcnt lgkmcnt(6)
    v_lshlrev_b32 v58, 16, v34
    v_and_b32 v59, 0xffff0000, v34
    v_pk_mul_f32 v[124:125], v[124:125], v[58:59]
    v_pk_mul_f32 v[128:129], v[68:69], v[116:117]
    v_pk_fma_f32 v[128:129], v[72:73], v[112:113], v[128:129]
    v_pk_fma_f32 v[128:129], v[76:77], v[108:109], v[128:129]
    v_pk_fma_f32 v[128:129], v[80:81], v[104:105], v[128:129]
    s_waitcnt lgkmcnt(5)
    v_lshlrev_b32 v56, 16, v36
    v_and_b32 v57, 0xffff0000, v36
    v_pk_mul_f32 v[128:129], v[128:129], v[56:57]
    v_pk_mul_f32 v[132:133], v[72:73], v[116:117]
    v_pk_fma_f32 v[132:133], v[76:77], v[112:113], v[132:133]
    v_pk_fma_f32 v[132:133], v[80:81], v[108:109], v[132:133]
    v_pk_fma_f32 v[132:133], v[84:85], v[104:105], v[132:133]
    s_waitcnt lgkmcnt(4)
    v_lshlrev_b32 v58, 16, v38
    v_and_b32 v59, 0xffff0000, v38
    v_pk_mul_f32 v[132:133], v[132:133], v[58:59]
    v_pk_mul_f32 v[136:137], v[76:77], v[116:117]
    v_pk_fma_f32 v[136:137], v[80:81], v[112:113], v[136:137]
    v_pk_fma_f32 v[136:137], v[84:85], v[108:109], v[136:137]
    v_pk_fma_f32 v[136:137], v[88:89], v[104:105], v[136:137]
    s_waitcnt lgkmcnt(3)
    v_lshlrev_b32 v56, 16, v40
    v_and_b32 v57, 0xffff0000, v40
    v_pk_mul_f32 v[136:137], v[136:137], v[56:57]
    v_pk_mul_f32 v[140:141], v[80:81], v[116:117]
    v_pk_fma_f32 v[140:141], v[84:85], v[112:113], v[140:141]
    v_pk_fma_f32 v[140:141], v[88:89], v[108:109], v[140:141]
    v_pk_fma_f32 v[140:141], v[92:93], v[104:105], v[140:141]
    s_waitcnt lgkmcnt(2)
    v_lshlrev_b32 v58, 16, v42
    v_and_b32 v59, 0xffff0000, v42
    v_pk_mul_f32 v[140:141], v[140:141], v[58:59]
    v_pk_mul_f32 v[144:145], v[84:85], v[116:117]
    v_pk_fma_f32 v[144:145], v[88:89], v[112:113], v[144:145]
    v_pk_fma_f32 v[144:145], v[92:93], v[108:109], v[144:145]
    v_pk_fma_f32 v[144:145], v[96:97], v[104:105], v[144:145]
    s_waitcnt lgkmcnt(1)
    v_lshlrev_b32 v56, 16, v44
    v_and_b32 v57, 0xffff0000, v44
    v_pk_mul_f32 v[144:145], v[144:145], v[56:57]
    v_pk_mul_f32 v[148:149], v[88:89], v[116:117]
    v_pk_fma_f32 v[148:149], v[92:93], v[112:113], v[148:149]
    v_pk_fma_f32 v[148:149], v[96:97], v[108:109], v[148:149]
    v_pk_fma_f32 v[148:149], v[100:101], v[104:105], v[148:149]
    s_waitcnt lgkmcnt(0)
    v_lshlrev_b32 v58, 16, v46
    v_and_b32 v59, 0xffff0000, v46
    v_pk_mul_f32 v[148:149], v[148:149], v[58:59]
    v_cvt_pk_bf16_f32 v152, v148, v144
    v_cvt_pk_bf16_f32 v153, v140, v136
    v_cvt_pk_bf16_f32 v154, v132, v128
    v_cvt_pk_bf16_f32 v155, v124, v120
    buffer_store_dwordx4 v[152:155], v247, s[36:39], 0 offen sc1
    v_cvt_pk_bf16_f32 v156, v149, v145
    v_cvt_pk_bf16_f32 v157, v141, v137
    v_cvt_pk_bf16_f32 v158, v133, v129
    v_cvt_pk_bf16_f32 v159, v125, v121
    buffer_store_dwordx4 v[156:159], v247, s[36:39], s16 offen sc1
    v_pk_mul_f32 v[122:123], v[62:63], v[118:119]
    v_pk_fma_f32 v[122:123], v[66:67], v[114:115], v[122:123]
    v_pk_fma_f32 v[122:123], v[70:71], v[110:111], v[122:123]
    v_pk_fma_f32 v[122:123], v[74:75], v[106:107], v[122:123]
    v_lshlrev_b32 v56, 16, v33
    v_and_b32 v57, 0xffff0000, v33
    v_pk_mul_f32 v[122:123], v[122:123], v[56:57]
    v_pk_mul_f32 v[126:127], v[66:67], v[118:119]
    v_pk_fma_f32 v[126:127], v[70:71], v[114:115], v[126:127]
    v_pk_fma_f32 v[126:127], v[74:75], v[110:111], v[126:127]
    v_pk_fma_f32 v[126:127], v[78:79], v[106:107], v[126:127]
    v_lshlrev_b32 v58, 16, v35
    v_and_b32 v59, 0xffff0000, v35
    v_pk_mul_f32 v[126:127], v[126:127], v[58:59]
    v_pk_mul_f32 v[130:131], v[70:71], v[118:119]
    v_pk_fma_f32 v[130:131], v[74:75], v[114:115], v[130:131]
    v_pk_fma_f32 v[130:131], v[78:79], v[110:111], v[130:131]
    v_pk_fma_f32 v[130:131], v[82:83], v[106:107], v[130:131]
    v_lshlrev_b32 v56, 16, v37
    v_and_b32 v57, 0xffff0000, v37
    v_pk_mul_f32 v[130:131], v[130:131], v[56:57]
    v_pk_mul_f32 v[134:135], v[74:75], v[118:119]
    v_pk_fma_f32 v[134:135], v[78:79], v[114:115], v[134:135]
    v_pk_fma_f32 v[134:135], v[82:83], v[110:111], v[134:135]
    v_pk_fma_f32 v[134:135], v[86:87], v[106:107], v[134:135]
    v_lshlrev_b32 v58, 16, v39
    v_and_b32 v59, 0xffff0000, v39
    v_pk_mul_f32 v[134:135], v[134:135], v[58:59]
    v_pk_mul_f32 v[138:139], v[78:79], v[118:119]
    v_pk_fma_f32 v[138:139], v[82:83], v[114:115], v[138:139]
    v_pk_fma_f32 v[138:139], v[86:87], v[110:111], v[138:139]
    v_pk_fma_f32 v[138:139], v[90:91], v[106:107], v[138:139]
    v_lshlrev_b32 v56, 16, v41
    v_and_b32 v57, 0xffff0000, v41
    v_pk_mul_f32 v[138:139], v[138:139], v[56:57]
    v_pk_mul_f32 v[142:143], v[82:83], v[118:119]
    v_pk_fma_f32 v[142:143], v[86:87], v[114:115], v[142:143]
    v_pk_fma_f32 v[142:143], v[90:91], v[110:111], v[142:143]
    v_pk_fma_f32 v[142:143], v[94:95], v[106:107], v[142:143]
    v_lshlrev_b32 v58, 16, v43
    v_and_b32 v59, 0xffff0000, v43
    v_pk_mul_f32 v[142:143], v[142:143], v[58:59]
    v_pk_mul_f32 v[146:147], v[86:87], v[118:119]
    v_pk_fma_f32 v[146:147], v[90:91], v[114:115], v[146:147]
    v_pk_fma_f32 v[146:147], v[94:95], v[110:111], v[146:147]
    v_pk_fma_f32 v[146:147], v[98:99], v[106:107], v[146:147]
    v_lshlrev_b32 v56, 16, v45
    v_and_b32 v57, 0xffff0000, v45
    v_pk_mul_f32 v[146:147], v[146:147], v[56:57]
    v_pk_mul_f32 v[150:151], v[90:91], v[118:119]
    v_pk_fma_f32 v[150:151], v[94:95], v[114:115], v[150:151]
    v_pk_fma_f32 v[150:151], v[98:99], v[110:111], v[150:151]
    v_pk_fma_f32 v[150:151], v[102:103], v[106:107], v[150:151]
    v_lshlrev_b32 v58, 16, v47
    v_and_b32 v59, 0xffff0000, v47
    v_pk_mul_f32 v[150:151], v[150:151], v[58:59]
    v_cvt_pk_bf16_f32 v160, v150, v146
    v_cvt_pk_bf16_f32 v161, v142, v138
    v_cvt_pk_bf16_f32 v162, v134, v130
    v_cvt_pk_bf16_f32 v163, v126, v122
    buffer_store_dwordx4 v[160:163], v247, s[36:39], s17 offen sc1
    v_cvt_pk_bf16_f32 v164, v151, v147
    v_cvt_pk_bf16_f32 v165, v143, v139
    v_cvt_pk_bf16_f32 v166, v135, v131
    v_cvt_pk_bf16_f32 v167, v127, v123
    buffer_store_dwordx4 v[164:167], v247, s[36:39], s62 offen sc1
    s_waitcnt vmcnt(9)
    s_barrier
    s_mov_b32 s51, 0x05040100
    s_mov_b32 s52, 0x07060302
    s_mov_b32 s53, 2883584
    ds_read_b64 v[40:41], v244 offset:35904
    ds_read_b64 v[42:43], v244 offset:36032
    ds_read_b64 v[44:45], v244 offset:36160
    ds_read_b64 v[46:47], v244 offset:36288
    ds_read_b64 v[48:49], v244 offset:36416
    ds_read_b64 v[50:51], v244 offset:36544
    ds_read_b64 v[52:53], v244 offset:36672
    ds_read_b64 v[54:55], v244 offset:36800
    s_waitcnt lgkmcnt(6)
    v_perm_b32 v184, v42, v40, s51
    s_waitcnt lgkmcnt(4)
    v_perm_b32 v185, v46, v44, s51
    s_waitcnt lgkmcnt(2)
    v_perm_b32 v186, v50, v48, s51
    s_waitcnt lgkmcnt(0)
    v_perm_b32 v187, v54, v52, s51
    buffer_store_dwordx4 v[184:187], v245, s[36:39], s53 offen sc1
    s_add_u32 s53, s53, 4096
    v_perm_b32 v188, v42, v40, s52
    v_perm_b32 v189, v46, v44, s52
    v_perm_b32 v190, v50, v48, s52
    v_perm_b32 v191, v54, v52, s52
    buffer_store_dwordx4 v[188:191], v245, s[36:39], s53 offen sc1
    s_add_u32 s53, s53, 4096
    v_perm_b32 v192, v43, v41, s51
    v_perm_b32 v193, v47, v45, s51
    v_perm_b32 v194, v51, v49, s51
    v_perm_b32 v195, v55, v53, s51
    buffer_store_dwordx4 v[192:195], v245, s[36:39], s53 offen sc1
    s_add_u32 s53, s53, 4096
    v_perm_b32 v196, v43, v41, s52
    v_perm_b32 v197, v47, v45, s52
    v_perm_b32 v198, v51, v49, s52
    v_perm_b32 v199, v55, v53, s52
    buffer_store_dwordx4 v[196:199], v245, s[36:39], s53 offen sc1
    s_waitcnt vmcnt(8)
    ds_read_b128 v[8:11], v223 offset:32
    ds_read_b64 v[12:13], v223 offset:48
    ds_read_b128 v[14:17], v223 offset:1056
    ds_read_b64 v[18:19], v223 offset:1072
    ds_read_b128 v[20:23], v223 offset:2080
    ds_read_b64 v[24:25], v223 offset:2096
    ds_read_b128 v[26:29], v223 offset:3104
    ds_read_b64 v[30:31], v223 offset:3120
    s_mov_b64 exec, 1
    s_waitcnt lgkmcnt(7)
    v_lshlrev_b32 v80, 16, v8
    v_alignbit_b32 v81, v9, v8, 16
    ds_write_b32 v223, v80 offset:4188
    ds_write_b32 v223, v8 offset:8348
    ds_write_b32 v223, v80 offset:12504
    ds_write_b32 v223, v81 offset:12508
    s_mov_b64 exec, -1
    v_alignbit_b32 v56, v9, v8, 16
    v_alignbit_b32 v57, v10, v9, 16
    v_alignbit_b32 v58, v11, v10, 16
    s_waitcnt lgkmcnt(10)
    v_alignbit_b32 v59, v12, v11, 16
    v_pk_mov_b32 v[60:61], v[8:9], v[10:11] op_sel:[1,0]
    v_pk_mov_b32 v[62:63], v[10:11], v[12:13] op_sel:[1,0]
    v_alignbit_b32 v64, v10, v9, 16
    v_alignbit_b32 v65, v11, v10, 16
    v_alignbit_b32 v66, v12, v11, 16
    v_alignbit_b32 v67, v13, v12, 16
    ds_write_b128 v223, v[56:59] offset:4192
    ds_write_b128 v223, v[60:63] offset:8352
    ds_write_b128 v223, v[64:67] offset:12512
    s_waitcnt lgkmcnt(12)
    v_alignbit_b32 v68, v15, v14, 16
    v_alignbit_b32 v69, v16, v15, 16
    v_alignbit_b32 v70, v17, v16, 16
    s_waitcnt lgkmcnt(11)
    v_alignbit_b32 v71, v18, v17, 16
    v_pk_mov_b32 v[72:73], v[14:15], v[16:17] op_sel:[1,0]
    v_pk_mov_b32 v[74:75], v[16:17], v[18:19] op_sel:[1,0]
    v_alignbit_b32 v76, v16, v15, 16
    v_alignbit_b32 v77, v17, v16, 16
    v_alignbit_b32 v78, v18, v17, 16
    v_alignbit_b32 v79, v19, v18, 16
    ds_write_b128 v223, v[68:71] offset:5216
    ds_write_b128 v223, v[72:75] offset:9376
    ds_write_b128 v223, v[76:79] offset:13536
    s_waitcnt lgkmcnt(13)
    v_alignbit_b32 v56, v21, v20, 16
    v_alignbit_b32 v57, v22, v21, 16
    v_alignbit_b32 v58, v23, v22, 16
    s_waitcnt lgkmcnt(12)
    v_alignbit_b32 v59, v24, v23, 16
    v_pk_mov_b32 v[60:61], v[20:21], v[22:23] op_sel:[1,0]
    v_pk_mov_b32 v[62:63], v[22:23], v[24:25] op_sel:[1,0]
    v_alignbit_b32 v64, v22, v21, 16
    v_alignbit_b32 v65, v23, v22, 16
    v_alignbit_b32 v66, v24, v23, 16
    v_alignbit_b32 v67, v25, v24, 16
    ds_write_b128 v223, v[56:59] offset:6240
    ds_write_b128 v223, v[60:63] offset:10400
    ds_write_b128 v223, v[64:67] offset:14560
    s_waitcnt lgkmcnt(14)
    v_alignbit_b32 v68, v27, v26, 16
    v_alignbit_b32 v69, v28, v27, 16
    v_alignbit_b32 v70, v29, v28, 16
    s_waitcnt lgkmcnt(13)
    v_alignbit_b32 v71, v30, v29, 16
    v_pk_mov_b32 v[72:73], v[26:27], v[28:29] op_sel:[1,0]
    v_pk_mov_b32 v[74:75], v[28:29], v[30:31] op_sel:[1,0]
    v_alignbit_b32 v76, v28, v27, 16
    v_alignbit_b32 v77, v29, v28, 16
    v_alignbit_b32 v78, v30, v29, 16
    v_alignbit_b32 v79, v31, v30, 16
    ds_write_b128 v223, v[68:71] offset:7264
    ds_write_b128 v223, v[72:75] offset:11424
    ds_write_b128 v223, v[76:79] offset:15584
    s_waitcnt vmcnt(4)
    s_waitcnt lgkmcnt(0)
    s_barrier
    v_readfirstlane_b32 s48, v246
    s_mul_i32 s48, s48, 0x9E3779B1
    s_add_u32 s48, s48, 0x7F4A7C15
    s_cmp_eq_u32 s3, 0
    s_cbranch_scc0 L_wf1
    s_lshl_b32 s54, s76, 7
    s_add_u32 s54, s54, 23199744
    v_mov_b32 v2, 0
    v_mov_b32 v3, s48
    s_mov_b64 exec, 1
    buffer_store_dword v3, v2, s[36:39], s54 offen sc1
    s_mov_b64 exec, -1
L_wf1:
    s_add_u32 m0, s61, 0
    s_nop 0
    buffer_load_dwordx4 v224, s[40:43], s64 offen offset:0 lds
    buffer_load_dwordx4 v225, s[40:43], s64 offen offset:1024 lds
    buffer_load_dwordx4 v226, s[40:43], s64 offen offset:2048 lds
    s_add_u32 s64, s64, 98304
    s_sub_u32 s35, s64, 1966080
    s_min_u32 s64, s64, s35
    s_add_u32 m0, s61, 12416
    s_nop 0
    buffer_load_dwordx4 v224, s[40:43], s64 offen offset:0 lds
    buffer_load_dwordx4 v225, s[40:43], s64 offen offset:1024 lds
    buffer_load_dwordx4 v226, s[40:43], s64 offen offset:2048 lds
    s_add_u32 s64, s64, 98304
    s_sub_u32 s35, s64, 1966080
    s_min_u32 s64, s64, s35
    s_add_u32 m0, s61, 24832
    s_nop 0
    buffer_load_dwordx4 v224, s[40:43], s64 offen offset:0 lds
    buffer_load_dwordx4 v225, s[40:43], s64 offen offset:1024 lds
    buffer_load_dwordx4 v226, s[40:43], s64 offen offset:2048 lds
    s_add_u32 s64, s64, 98304
    s_sub_u32 s35, s64, 1966080
    s_min_u32 s64, s64, s35
    s_add_u32 m0, s61, 37248
    s_nop 0
    buffer_load_dwordx4 v224, s[40:43], s64 offen offset:0 lds
    buffer_load_dwordx4 v225, s[40:43], s64 offen offset:1024 lds
    buffer_load_dwordx4 v226, s[40:43], s64 offen offset:2048 lds
    s_add_u32 s64, s64, 98304
    s_sub_u32 s35, s64, 1966080
    s_min_u32 s64, s64, s35
    s_add_u32 m0, s61, 49664
    s_nop 0
    buffer_load_dwordx4 v224, s[40:43], s64 offen offset:0 lds
    buffer_load_dwordx4 v225, s[40:43], s64 offen offset:1024 lds
    buffer_load_dwordx4 v226, s[40:43], s64 offen offset:2048 lds
    s_add_u32 s64, s64, 98304
    s_sub_u32 s35, s64, 1966080
    s_min_u32 s64, s64, s35
    v_lshrrev_b32 v3, 4, v1
    v_lshlrev_b32 v2, 3, v3
    v_and_b32 v3, 15, v1
    v_sub_u32 v2, v2, v3
    v_subrev_u32 v2, 9, v2
    v_and_b32 v3, 1, v2
    v_cmp_eq_u32 vcc, 1, v3
    v_lshrrev_b32 v3, 16, v250
    s_nop 0
    v_cndmask_b32 v3, v3, v250, vcc
    v_lshrrev_b32 v2, 1, v2
    v_cmp_eq_u32 vcc, 0, v2
    s_nop 1
    v_cndmask_b32 v244, 0, v3, vcc
    v_cmp_eq_u32 vcc, 1, v2
    s_nop 1
    v_cndmask_b32 v245, 0, v3, vcc
    v_cmp_eq_u32 vcc, 2, v2
    s_nop 1
    v_cndmask_b32 v246, 0, v3, vcc
    v_cmp_eq_u32 vcc, 3, v2
    s_nop 1
    v_cndmask_b32 v247, 0, v3, vcc
    v_mov_b32 v4, v229
    v_mov_b32 v5, v230
    s_waitcnt vmcnt(0)
    s_barrier
    s_cmp_eq_u32 s3, 0
    s_cbranch_scc0 L_wf2
    s_lshl_b32 s54, s76, 7
    s_add_u32 s54, s54, 23374848
    v_mov_b32 v254, 0
    v_mov_b32 v255, s48
    s_mov_b64 exec, 1
    buffer_store_dword v255, v254, s[36:39], s54 offen sc1
    s_mov_b64 exec, -1
L_wf2:
L_poll3:
    buffer_load_dword v2, v242, s[36:39], s59 offen sc1
    s_waitcnt vmcnt(0)
    v_cmp_ne_u32 vcc, s48, v2
    s_cbranch_vccz L_poll3_ok
    s_cmp_eq_u32 s49, 0
    s_cbranch_scc1 L_poll3_ok
    s_sub_u32 s49, s49, 1
    s_sleep 1
    s_branch L_poll3
L_poll3_ok:
    s_mul_i32 s50, s58, 4096
    s_mul_i32 s52, s3, 4608
    s_add_u32 m0, s52, 145408
    s_nop 0
    buffer_load_dwordx4 v248, s[36:39], s50 offen offset:0 sc1 lds
    buffer_load_dwordx4 v248, s[36:39], s50 offen offset:1024 sc1 lds
    buffer_load_dwordx4 v248, s[36:39], s50 offen offset:2048 sc1 lds
    buffer_load_dwordx4 v248, s[36:39], s50 offen offset:3072 sc1 lds
    ds_read_b64_tr_b16 a[0:1], v227 offset:0
    ds_read_b64_tr_b16 a[2:3], v227 offset:1536
    ds_read_b64_tr_b16 a[4:5], v227 offset:6224
    ds_read_b64_tr_b16 a[6:7], v227 offset:7760
    ds_read_b64_tr_b16 a[8:9], v228 offset:0
    ds_read_b64_tr_b16 a[10:11], v228 offset:1536
    ds_read_b64_tr_b16 a[12:13], v227 offset:12416
    ds_read_b64_tr_b16 a[14:15], v227 offset:13952
    ds_read_b64_tr_b16 a[16:17], v227 offset:18640
    ds_read_b64_tr_b16 a[18:19], v227 offset:20176
    ds_read_b64_tr_b16 a[20:21], v228 offset:12416
    ds_read_b64_tr_b16 a[22:23], v228 offset:13952
    ds_read_b64_tr_b16 a[24:25], v227 offset:24832
    ds_read_b64_tr_b16 a[26:27], v227 offset:26368
    ds_read_b64_tr_b16 a[28:29], v227 offset:31056
    ds_read_b64_tr_b16 a[30:31], v227 offset:32592
    ds_read_b64_tr_b16 a[32:33], v228 offset:24832
    ds_read_b64_tr_b16 a[34:35], v228 offset:26368
    ds_read_b64_tr_b16 a[36:37], v227 offset:37248
    ds_read_b64_tr_b16 a[38:39], v227 offset:38784
    ds_read_b64_tr_b16 a[40:41], v227 offset:43472
    ds_read_b64_tr_b16 a[42:43], v227 offset:45008
    ds_read_b64_tr_b16 a[44:45], v228 offset:37248
    ds_read_b64_tr_b16 a[46:47], v228 offset:38784
    ds_read_b64_tr_b16 a[48:49], v227 offset:49664
    ds_read_b64_tr_b16 a[50:51], v227 offset:51200
    ds_read_b64_tr_b16 a[52:53], v227 offset:55888
    ds_read_b64_tr_b16 a[54:55], v227 offset:57424
    ds_read_b64_tr_b16 a[56:57], v228 offset:49664
    ds_read_b64_tr_b16 a[58:59], v228 offset:51200
    buffer_load_dword v243, v240, s[36:39], s69 offen sc1
    s_waitcnt vmcnt(1)
    ds_read_b128 v[104:107], v5 offset:3584
    ds_read_b64 v[40:41], v4 offset:0
    ds_read_b64 v[42:43], v4 offset:8
    ds_read_b128 v[108:111], v5 offset:3072
    ds_read_b64 v[44:45], v4 offset:512
    ds_read_b64 v[46:47], v4 offset:520
    ds_read_b128 v[112:115], v5 offset:2560
    ds_read_b64 v[48:49], v4 offset:1024
    ds_read_b64 v[50:51], v4 offset:1032
    ds_read_b128 v[116:119], v5 offset:2048
    ds_read_b64 v[52:53], v4 offset:1536
    ds_read_b64 v[54:55], v4 offset:1544
    s_waitcnt lgkmcnt(9)
    v_mfma_f32_16x16x32_bf16 v[8:11], v[40:43], v[104:107], 0
    v_mfma_f32_16x16x32_bf16 v[8:11], v[244:247], v[104:107], v[8:11]
    s_waitcnt lgkmcnt(8)
    s_mov_b32 s17, 23199744
    ds_read_b128 v[136:139], v5 offset:3648
    v_mfma_f32_16x16x32_bf16 v[12:15], v[40:43], v[108:111], 0
    s_movk_i32 s4, 4096
    ds_read_b64 v[72:73], v4 offset:64
    v_mfma_f32_16x16x32_bf16 v[12:15], v[244:247], v[108:111], v[12:15]
    s_waitcnt lgkmcnt(8)
    s_movk_i32 s5, 8192
    ds_read_b64 v[74:75], v4 offset:72
    v_mfma_f32_16x16x32_bf16 v[12:15], v[44:47], v[104:107], v[12:15]
    s_lshl_b32 s6, s72, 10
    ds_read_b128 v[140:143], v5 offset:3136
    v_mfma_f32_16x16x32_bf16 v[16:19], v[44:47], v[108:111], 0
    s_waitcnt lgkmcnt(9)
    s_add_u32 s6, s6, 23101440
    ds_read_b64 v[76:77], v4 offset:576
    v_mfma_f32_16x16x32_bf16 v[16:19], v[40:43], v[112:115], v[16:19]
    s_lshl_b32 s7, s73, 6
    ds_read_b64 v[78:79], v4 offset:584
    v_mfma_f32_16x16x32_bf16 v[16:19], v[244:247], v[112:115], v[16:19]
    s_waitcnt lgkmcnt(9)
    s_add_u32 s7, s7, s6
    ds_read_b128 v[144:147], v5 offset:2624
    v_mfma_f32_16x16x32_bf16 v[16:19], v[48:51], v[104:107], v[16:19]
    s_mul_i32 s8, s72, 768
    ds_read_b64 v[80:81], v4 offset:1088
    v_mfma_f32_16x16x32_bf16 v[20:23], v[44:47], v[112:115], 0
    s_mul_i32 s53, s73, 12
    ds_read_b64 v[82:83], v4 offset:1096
    v_mfma_f32_16x16x32_bf16 v[20:23], v[48:51], v[108:111], v[20:23]
    s_waitcnt lgkmcnt(11)
    s_add_u32 s8, s8, s53
    ds_read_b128 v[148:151], v5 offset:2112
    v_mfma_f32_16x16x32_bf16 v[20:23], v[40:43], v[116:119], v[20:23]
    s_mul_i32 s53, s3, 3
    ds_read_b64 v[84:85], v4 offset:1600
    v_mfma_f32_16x16x32_bf16 v[20:23], v[244:247], v[116:119], v[20:23]
    s_waitcnt lgkmcnt(11)
    s_add_u32 s8, s8, s53
    ds_read_b64 v[86:87], v4 offset:1608
    v_mfma_f32_16x16x32_bf16 v[20:23], v[52:55], v[104:107], v[20:23]
    s_add_u32 m0, s66, 62464
    s_waitcnt vmcnt(0)
    v_cmp_ne_u32 vcc, s48, v243
    s_cbranch_vccnz L_chk4_slow
L_chk4_back:
    s_barrier
    s_waitcnt lgkmcnt(9)
    v_mfma_f32_16x16x32_bf16 v[8:11], v[72:75], v[136:139], v[8:11]
    s_lshl_b32 s8, s8, 8
    ds_read_b128 v[104:107], v5 offset:3712
    ds_read_b64 v[40:41], v4 offset:128
    buffer_load_dwordx4 v248, s[36:39], s67 offen offset:0 sc1 lds
    s_waitcnt lgkmcnt(10)
    v_mfma_f32_16x16x32_bf16 v[12:15], v[72:75], v[140:143], v[12:15]
    s_waitcnt lgkmcnt(8)
    s_add_u32 s8, s8, 16777216
    ds_read_b64 v[42:43], v4 offset:136
    ds_read_b128 v[108:111], v5 offset:3200
    v_mfma_f32_16x16x32_bf16 v[12:15], v[76:79], v[136:139], v[12:15]
    s_lshl_b32 s9, s73, 2
    ds_read_b64 v[44:45], v4 offset:640
    v_mfma_f32_16x16x32_bf16 v[16:19], v[76:79], v[140:143], v[16:19]
    s_waitcnt lgkmcnt(10)
    s_add_u32 m0, s66, 62464
    s_add_u32 s9, s9, s3
    ds_read_b64 v[46:47], v4 offset:648
    v_mfma_f32_16x16x32_bf16 v[16:19], v[72:75], v[144:147], v[16:19]
    s_waitcnt lgkmcnt(9)
    s_mul_i32 s9, s9, 384
    ds_read_b128 v[112:115], v5 offset:2688
    buffer_load_dwordx4 v248, s[36:39], s67 offen offset:1024 sc1 lds
    v_mfma_f32_16x16x32_bf16 v[16:19], v[80:83], v[136:139], v[16:19]
    s_add_u32 s9, s9, 23527424
    ds_read_b64 v[48:49], v4 offset:1152
    v_mfma_f32_16x16x32_bf16 v[20:23], v[76:79], v[144:147], v[20:23]
    s_mul_i32 s16, s3, 32768
    ds_read_b64 v[50:51], v4 offset:1160
    v_mfma_f32_16x16x32_bf16 v[20:23], v[80:83], v[140:143], v[20:23]
    s_waitcnt lgkmcnt(11)
    s_add_u32 m0, s66, 62464
    s_lshl_b32 s53, s72, 7
    ds_read_b128 v[116:119], v5 offset:2176
    v_mfma_f32_16x16x32_bf16 v[20:23], v[72:75], v[148:151], v[20:23]
    s_waitcnt lgkmcnt(10)
    s_add_u32 s16, s16, s53
    ds_read_b64 v[52:53], v4 offset:1664
    buffer_load_dwordx4 v248, s[36:39], s67 offen offset:2048 sc1 lds
    v_mfma_f32_16x16x32_bf16 v[20:23], v[84:87], v[136:139], v[20:23]
    s_waitcnt lgkmcnt(8)
    s_mul_i32 s53, s34, 131072
    ds_read_b64 v[54:55], v4 offset:1672
    v_mfma_f32_16x16x32_bf16 v[8:11], v[40:43], v[104:107], v[8:11]
    s_waitcnt lgkmcnt(8)
    s_add_u32 s10, s16, s53
    ds_read_b128 v[136:139], v5 offset:3776
    ds_read_b64 v[72:73], v4 offset:192
    v_mfma_f32_16x16x32_bf16 v[12:15], v[40:43], v[108:111], v[12:15]
    s_waitcnt lgkmcnt(8)
    s_add_u32 m0, s66, 62464
    ds_read_b64 v[74:75], v4 offset:200
    ds_read_b128 v[140:143], v5 offset:3264
    v_mfma_f32_16x16x32_bf16 v[12:15], v[44:47], v[104:107], v[12:15]
    s_lshl_b32 s63, s3, 10
    ds_read_b64 v[76:77], v4 offset:704
    buffer_load_dwordx4 v248, s[36:39], s67 offen offset:3072 sc1 lds
    v_mfma_f32_16x16x32_bf16 v[16:19], v[44:47], v[108:111], v[16:19]
    s_waitcnt lgkmcnt(10)
    s_add_u32 s11, s10, 131072
    ds_read_b64 v[78:79], v4 offset:712
    v_mfma_f32_16x16x32_bf16 v[16:19], v[40:43], v[112:115], v[16:19]
    s_waitcnt lgkmcnt(9)
    s_sub_u32 s52, s11, 2621440
    ds_read_b128 v[144:147], v5 offset:2752
    v_mfma_f32_16x16x32_bf16 v[16:19], v[48:51], v[104:107], v[16:19]
    s_min_u32 s11, s11, s52
    ds_read_b64 v[80:81], v4 offset:1216
    v_mfma_f32_16x16x32_bf16 v[20:23], v[44:47], v[112:115], v[20:23]
    s_add_u32 s12, s11, 131072
    ds_read_b64 v[82:83], v4 offset:1224
    buffer_load_dwordx4 v[176:179], v231, s[36:39], s65 offen offset:0 sc1
    v_mfma_f32_16x16x32_bf16 v[20:23], v[48:51], v[108:111], v[20:23]
    s_waitcnt lgkmcnt(11)
    s_sub_u32 s52, s12, 2621440
    ds_read_b128 v[148:151], v5 offset:2240
    v_mfma_f32_16x16x32_bf16 v[20:23], v[40:43], v[116:119], v[20:23]
    s_waitcnt lgkmcnt(10)
    s_min_u32 s12, s12, s52
    ds_read_b64 v[84:85], v4 offset:1728
    v_mfma_f32_16x16x32_bf16 v[20:23], v[52:55], v[104:107], v[20:23]
    s_waitcnt lgkmcnt(8)
    s_add_u32 s13, s12, 131072
    ds_read_b64 v[86:87], v4 offset:1736
    v_mfma_f32_16x16x32_bf16 v[8:11], v[72:75], v[136:139], v[8:11]
    s_sub_u32 s52, s13, 2621440
    ds_read_b128 v[104:107], v5 offset:3840
    ds_read_b64 v[40:41], v4 offset:256
    buffer_load_dwordx4 v[180:183], v231, s[36:39], s65 offen offset:1024 sc1
    s_waitcnt lgkmcnt(10)
    v_mfma_f32_16x16x32_bf16 v[12:15], v[72:75], v[140:143], v[12:15]
    s_waitcnt lgkmcnt(8)
    s_min_u32 s13, s13, s52
    ds_read_b64 v[42:43], v4 offset:264
    ds_read_b128 v[108:111], v5 offset:3328
    v_mfma_f32_16x16x32_bf16 v[12:15], v[76:79], v[136:139], v[12:15]
    s_add_u32 s14, s13, 131072
    ds_read_b64 v[44:45], v4 offset:768
    v_mfma_f32_16x16x32_bf16 v[16:19], v[76:79], v[140:143], v[16:19]
    s_waitcnt lgkmcnt(10)
    s_add_u32 m0, s61, 0
    s_sub_u32 s52, s14, 2621440
    ds_read_b64 v[46:47], v4 offset:776
    v_mfma_f32_16x16x32_bf16 v[16:19], v[72:75], v[144:147], v[16:19]
    s_waitcnt lgkmcnt(9)
    s_min_u32 s14, s14, s52
    ds_read_b128 v[112:115], v5 offset:2816
    buffer_load_dwordx4 v224, s[40:43], s64 offen offset:0 lds
    v_mfma_f32_16x16x32_bf16 v[16:19], v[80:83], v[136:139], v[16:19]
    s_add_u32 s15, s14, 131072
    ds_read_b64 v[48:49], v4 offset:1280
    v_mfma_f32_16x16x32_bf16 v[20:23], v[76:79], v[144:147], v[20:23]
    s_sub_u32 s52, s15, 2621440
    ds_read_b64 v[50:51], v4 offset:1288
    v_mfma_f32_16x16x32_bf16 v[20:23], v[80:83], v[140:143], v[20:23]
    s_waitcnt lgkmcnt(11)
    s_min_u32 s15, s15, s52
    ds_read_b128 v[116:119], v5 offset:2304
    v_mfma_f32_16x16x32_bf16 v[20:23], v[72:75], v[148:151], v[20:23]
    s_waitcnt lgkmcnt(10)
    s_add_u32 s18, s15, 131072
    ds_read_b64 v[52:53], v4 offset:1792
    v_mfma_f32_16x16x32_bf16 v[20:23], v[84:87], v[136:139], v[20:23]
    s_waitcnt lgkmcnt(8)
    s_add_u32 m0, s61, 0
    s_sub_u32 s52, s18, 2621440
    ds_read_b64 v[54:55], v4 offset:1800
    v_mfma_f32_16x16x32_bf16 v[8:11], v[40:43], v[104:107], v[8:11]
    s_min_u32 s18, s18, s52
    ds_read_b128 v[136:139], v5 offset:3904
    ds_read_b64 v[72:73], v4 offset:320
    buffer_load_dwordx4 v225, s[40:43], s64 offen offset:1024 lds
    s_waitcnt lgkmcnt(10)
    v_mfma_f32_16x16x32_bf16 v[12:15], v[40:43], v[108:111], v[12:15]
    s_waitcnt lgkmcnt(8)
    s_add_u32 s19, s18, 131072
    ds_read_b64 v[74:75], v4 offset:328
    ds_read_b128 v[140:143], v5 offset:3392
    v_mfma_f32_16x16x32_bf16 v[12:15], v[44:47], v[104:107], v[12:15]
    s_sub_u32 s52, s19, 2621440
    ds_read_b64 v[76:77], v4 offset:832
    v_mfma_f32_16x16x32_bf16 v[16:19], v[44:47], v[108:111], v[16:19]
    s_waitcnt lgkmcnt(10)
    s_min_u32 s19, s19, s52
    ds_read_b64 v[78:79], v4 offset:840
    v_mfma_f32_16x16x32_bf16 v[16:19], v[40:43], v[112:115], v[16:19]
    s_waitcnt lgkmcnt(9)
    s_add_u32 s20, s19, 131072
    ds_read_b128 v[144:147], v5 offset:2880
    v_mfma_f32_16x16x32_bf16 v[16:19], v[48:51], v[104:107], v[16:19]
    s_sub_u32 s52, s20, 2621440
    ds_read_b64 v[80:81], v4 offset:1344
    v_mfma_f32_16x16x32_bf16 v[20:23], v[44:47], v[112:115], v[20:23]
    s_add_u32 m0, s61, 0
    ds_read_b64 v[82:83], v4 offset:1352
    buffer_load_dwordx2 v[232:233], v253, s[36:39], s55 offen sc1
    v_mfma_f32_16x16x32_bf16 v[20:23], v[48:51], v[108:111], v[20:23]
    s_waitcnt lgkmcnt(11)
    s_min_u32 s20, s20, s52
    ds_read_b128 v[148:151], v5 offset:2368
    buffer_load_dwordx4 v226, s[40:43], s64 offen offset:2048 lds
    v_mfma_f32_16x16x32_bf16 v[20:23], v[40:43], v[116:119], v[20:23]
    s_waitcnt lgkmcnt(10)
    s_add_u32 s64, s64, 98304
    s_add_u32 s21, s20, 131072
    ds_read_b64 v[84:85], v4 offset:1856
    v_mfma_f32_16x16x32_bf16 v[20:23], v[52:55], v[104:107], v[20:23]
    s_waitcnt lgkmcnt(8)
    s_sub_u32 s35, s64, 1966080
    s_sub_u32 s52, s21, 2621440
    ds_read_b64 v[86:87], v4 offset:1864
    v_mfma_f32_16x16x32_bf16 v[8:11], v[72:75], v[136:139], v[8:11]
    s_waitcnt lgkmcnt(8)
    s_min_u32 s64, s64, s35
    ds_read_b128 v[104:107], v5 offset:3968
    ds_read_b64 v[40:41], v4 offset:384
    v_mfma_f32_16x16x32_bf16 v[12:15], v[72:75], v[140:143], v[12:15]
    s_waitcnt lgkmcnt(8)
    s_add_u32 m0, s61, 12416
    ds_read_b64 v[42:43], v4 offset:392
    ds_read_b128 v[108:111], v5 offset:3456
    v_mfma_f32_16x16x32_bf16 v[12:15], v[76:79], v[136:139], v[12:15]
    s_min_u32 s21, s21, s52
    ds_read_b64 v[44:45], v4 offset:896
    buffer_load_dwordx4 v224, s[40:43], s64 offen offset:0 lds
    v_mfma_f32_16x16x32_bf16 v[16:19], v[76:79], v[140:143], v[16:19]
    s_waitcnt lgkmcnt(10)
    s_add_u32 s22, s21, 131072
    ds_read_b64 v[46:47], v4 offset:904
    v_mfma_f32_16x16x32_bf16 v[16:19], v[72:75], v[144:147], v[16:19]
    s_waitcnt lgkmcnt(9)
    s_sub_u32 s52, s22, 2621440
    ds_read_b128 v[112:115], v5 offset:2944
    v_mfma_f32_16x16x32_bf16 v[16:19], v[80:83], v[136:139], v[16:19]
    s_min_u32 s22, s22, s52
    ds_read_b64 v[48:49], v4 offset:1408
    v_mfma_f32_16x16x32_bf16 v[20:23], v[76:79], v[144:147], v[20:23]
    s_add_u32 s23, s22, 131072
    ds_read_b64 v[50:51], v4 offset:1416
    v_mfma_f32_16x16x32_bf16 v[20:23], v[80:83], v[140:143], v[20:23]
    s_waitcnt lgkmcnt(11)
    s_add_u32 m0, s61, 12416
    s_sub_u32 s52, s23, 2621440
    ds_read_b128 v[116:119], v5 offset:2432
    v_mfma_f32_16x16x32_bf16 v[20:23], v[72:75], v[148:151], v[20:23]
    s_waitcnt lgkmcnt(10)
    s_min_u32 s23, s23, s52
    ds_read_b64 v[52:53], v4 offset:1920
    buffer_load_dwordx4 v225, s[40:43], s64 offen offset:1024 lds
    v_mfma_f32_16x16x32_bf16 v[20:23], v[84:87], v[136:139], v[20:23]
    s_waitcnt lgkmcnt(8)
    s_add_u32 s24, s23, 131072
    ds_read_b64 v[54:55], v4 offset:1928
    v_mfma_f32_16x16x32_bf16 v[8:11], v[40:43], v[104:107], v[8:11]
    s_waitcnt lgkmcnt(8)
    s_sub_u32 s52, s24, 2621440
    ds_read_b128 v[136:139], v5 offset:4032
    ds_read_b64 v[72:73], v4 offset:448
    v_mfma_f32_16x16x32_bf16 v[12:15], v[40:43], v[108:111], v[12:15]
    s_waitcnt lgkmcnt(8)
    s_min_u32 s24, s24, s52
    ds_read_b64 v[74:75], v4 offset:456
    ds_read_b128 v[140:143], v5 offset:3520
    v_mfma_f32_16x16x32_bf16 v[12:15], v[44:47], v[104:107], v[12:15]
    s_add_u32 s25, s24, 131072
    ds_read_b64 v[76:77], v4 offset:960
    v_mfma_f32_16x16x32_bf16 v[16:19], v[44:47], v[108:111], v[16:19]
    s_waitcnt lgkmcnt(10)
    s_add_u32 m0, s61, 12416
    s_sub_u32 s52, s25, 2621440
    ds_read_b64 v[78:79], v4 offset:968
    v_mfma_f32_16x16x32_bf16 v[16:19], v[40:43], v[112:115], v[16:19]
    s_waitcnt lgkmcnt(9)
    s_min_u32 s25, s25, s52
    ds_read_b128 v[144:147], v5 offset:3008
    buffer_load_dwordx4 v226, s[40:43], s64 offen offset:2048 lds
    v_mfma_f32_16x16x32_bf16 v[16:19], v[48:51], v[104:107], v[16:19]
    s_add_u32 s64, s64, 98304
    s_add_u32 s26, s25, 131072
    ds_read_b64 v[80:81], v4 offset:1472
    v_mfma_f32_16x16x32_bf16 v[20:23], v[44:47], v[112:115], v[20:23]
    s_sub_u32 s35, s64, 1966080
    s_sub_u32 s52, s26, 2621440
    ds_read_b64 v[82:83], v4 offset:1480
    v_mfma_f32_16x16x32_bf16 v[20:23], v[48:51], v[108:111], v[20:23]
    s_waitcnt lgkmcnt(11)
    s_min_u32 s64, s64, s35
    s_min_u32 s26, s26, s52
    ds_read_b128 v[148:151], v5 offset:2496
    v_mfma_f32_16x16x32_bf16 v[20:23], v[40:43], v[116:119], v[20:23]
    s_waitcnt lgkmcnt(10)
    s_add_u32 s27, s26, 131072
    ds_read_b64 v[84:85], v4 offset:1984
    v_mfma_f32_16x16x32_bf16 v[20:23], v[52:55], v[104:107], v[20:23]
    s_waitcnt lgkmcnt(8)
    s_add_u32 m0, s61, 24832
    s_sub_u32 s52, s27, 2621440
    ds_read_b64 v[86:87], v4 offset:1992
    v_mfma_f32_16x16x32_bf16 v[8:11], v[72:75], v[136:139], v[8:11]
    s_min_u32 s27, s27, s52
    ds_read_b128 v[112:115], v5 offset:2560
    ds_read_b64 v[48:49], v4 offset:1024
    buffer_load_dwordx4 v224, s[40:43], s64 offen offset:0 lds
    s_waitcnt lgkmcnt(10)
    v_mfma_f32_16x16x32_bf16 v[12:15], v[72:75], v[140:143], v[12:15]
    s_waitcnt lgkmcnt(8)
    s_add_u32 s44, s27, 131072
    ds_read_b64 v[50:51], v4 offset:1032
    ds_read_b128 v[116:119], v5 offset:2048
    v_mfma_f32_16x16x32_bf16 v[12:15], v[76:79], v[136:139], v[12:15]
    s_sub_u32 s52, s44, 2621440
    ds_read_b64 v[52:53], v4 offset:1536
    ds_read_b64 v[54:55], v4 offset:1544
    v_mfma_f32_16x16x32_bf16 v[16:19], v[76:79], v[140:143], v[16:19]
    s_waitcnt lgkmcnt(11)
    s_min_u32 s44, s44, s52
    ds_read_b128 v[108:111], v5 offset:3072
    ds_read_b64 v[44:45], v4 offset:512
    v_mfma_f32_16x16x32_bf16 v[16:19], v[72:75], v[144:147], v[16:19]
    s_waitcnt lgkmcnt(11)
    s_add_u32 s45, s44, 131072
    ds_read_b64 v[46:47], v4 offset:520
    ds_read_b128 v[120:123], v5 offset:1536
    v_mfma_f32_16x16x32_bf16 v[16:19], v[80:83], v[136:139], v[16:19]
    s_add_u32 m0, s61, 24832
    ds_read_b64 v[56:57], v4 offset:2048
    ds_read_b64 v[58:59], v4 offset:2056
    v_mfma_f32_16x16x32_bf16 v[20:23], v[76:79], v[144:147], v[20:23]
    s_sub_u32 s52, s45, 2621440
    ds_read_b128 v[104:107], v5 offset:3584
    ds_read_b64 v[40:41], v4 offset:0
    buffer_load_dwordx4 v225, s[40:43], s64 offen offset:1024 lds
    v_mfma_f32_16x16x32_bf16 v[20:23], v[80:83], v[140:143], v[20:23]
    s_waitcnt lgkmcnt(12)
    s_min_u32 s45, s45, s52
    ds_read_b64 v[42:43], v4 offset:8
    ds_read_b128 v[124:127], v5 offset:1024
    v_mfma_f32_16x16x32_bf16 v[20:23], v[72:75], v[148:151], v[20:23]
    s_add_u32 s46, s45, 131072
    ds_read_b64 v[60:61], v4 offset:2560
    ds_read_b64 v[62:63], v4 offset:2568
    v_mfma_f32_16x16x32_bf16 v[20:23], v[84:87], v[136:139], v[20:23]
    s_waitcnt vmcnt(11)
    s_barrier
    ds_read_b128 v[128:131], v5 offset:512
    ds_read_b64 v[64:65], v4 offset:3072
    ds_read_b64 v[66:67], v4 offset:3080
    ds_read_b128 v[132:135], v5 offset:0
    ds_read_b64 v[68:69], v4 offset:3584
    ds_read_b64 v[70:71], v4 offset:3592
    s_waitcnt lgkmcnt(14)
    v_mfma_f32_16x16x32_bf16 v[24:27], v[48:51], v[112:115], 0
    s_sub_u32 s52, s46, 2621440
    ds_read_b128 v[184:187], v249 offset:0
    v_mfma_f32_16x16x32_bf16 v[28:31], v[48:51], v[116:119], 0
    s_add_u32 m0, s61, 24832
    s_min_u32 s46, s46, s52
    ds_read_b128 v[200:203], v249 offset:8192
    v_mfma_f32_16x16x32_bf16 v[28:31], v[52:55], v[112:115], v[28:31]
    s_add_u32 s47, s46, 131072
    ds_read_b128 v[188:191], v249 offset:1024
    buffer_load_dwordx4 v226, s[40:43], s64 offen offset:2048 lds
    v_mfma_f32_16x16x32_bf16 v[32:35], v[52:55], v[116:119], 0
    s_add_u32 s64, s64, 98304
    s_sub_u32 s52, s47, 2621440
    ds_read_b128 v[204:207], v249 offset:9216
    v_mfma_f32_16x16x32_bf16 v[24:27], v[44:47], v[116:119], v[24:27]
    s_sub_u32 s35, s64, 1966080
    ds_read_b128 v[144:147], v5 offset:2624
    ds_read_b128 v[192:195], v249 offset:2048
    v_mfma_f32_16x16x32_bf16 v[24:27], v[52:55], v[108:111], v[24:27]
    s_min_u32 s64, s64, s35
    ds_read_b64 v[80:81], v4 offset:1088
    ds_read_b128 v[208:211], v249 offset:10240
    v_mfma_f32_16x16x32_bf16 v[32:35], v[48:51], v[120:123], v[32:35]
    s_waitcnt lgkmcnt(12)
    s_min_u32 s47, s47, s52
    ds_read_b64 v[82:83], v4 offset:1096
    ds_read_b128 v[196:199], v249 offset:3072
    v_mfma_f32_16x16x32_bf16 v[32:35], v[56:59], v[112:115], v[32:35]
    s_add_u32 m0, s61, 37248
    ds_read_b128 v[148:151], v5 offset:2112
    ds_read_b128 v[212:215], v249 offset:11264
    v_mfma_f32_16x16x32_bf16 v[36:39], v[52:55], v[120:123], 0
    s_lshl_b32 s62, s75, 2
    ds_read_b64 v[84:85], v4 offset:1600
    buffer_load_dwordx4 v224, s[40:43], s64 offen offset:0 lds
    v_mfma_f32_16x16x32_bf16 v[36:39], v[56:59], v[116:119], v[36:39]
    s_add_u32 s62, s62, s3
    ds_read_b64 v[86:87], v4 offset:1608
    v_mfma_f32_16x16x32_bf16 v[28:31], v[44:47], v[120:123], v[28:31]
    s_mul_i32 s62, s62, 61440
    ds_read_b128 v[140:143], v5 offset:3136
    v_mfma_f32_16x16x32_bf16 v[28:31], v[56:59], v[108:111], v[28:31]
    s_add_u32 s62, s62, 14417920
    ds_read_b64 v[76:77], v4 offset:576
    s_waitcnt vmcnt(8)
    v_cmp_ne_u32 vcc, s48, v233
    s_cbranch_vccnz L_m_slow
L_m_back:
    v_mov_b32_dpp v252, v232 quad_perm:[3,3,3,3] row_mask:0xf bank_mask:0xf
    s_nop 1
    v_mul_f32_dpp v251, v232, v252 quad_perm:[2,2,2,2] row_mask:0xf bank_mask:0xf
    s_nop 1
    v_mul_f32_dpp v250, v232, v251 quad_perm:[1,1,1,1] row_mask:0xf bank_mask:0xf
    v_mul_f32_dpp v251, v232, v251 quad_perm:[0,0,0,0] row_mask:0xf bank_mask:0xf
    v_permlane16_swap_b32 v176, v178
    v_permlane16_swap_b32 v177, v179
    v_permlane16_swap_b32 v180, v182
    v_permlane16_swap_b32 v181, v183
    v_lshlrev_b32 v232, 16, v176
    v_and_b32 v233, 0xffff0000, v176
    v_lshlrev_b32 v234, 16, v177
    v_and_b32 v235, 0xffff0000, v177
    s_waitcnt lgkmcnt(14)
    v_pk_fma_f32 v[184:185], v[232:233], v[184:185], v[200:201]
    v_pk_fma_f32 v[186:187], v[234:235], v[186:187], v[202:203]
    v_pk_mul_f32 v[200:201], v[232:233], v[252:253] op_sel_hi:[1,0]
    v_pk_mul_f32 v[202:203], v[234:235], v[252:253] op_sel_hi:[1,0]
    v_pk_fma_f32 v[184:185], v[184:185], v[250:251], v[250:251] op_sel:[0,0,1] op_sel_hi:[1,0,1]
    v_pk_fma_f32 v[186:187], v[186:187], v[250:251], v[250:251] op_sel:[0,0,1] op_sel_hi:[1,0,1]
    v_lshlrev_b32 v236, 16, v178
    v_and_b32 v237, 0xffff0000, v178
    v_lshlrev_b32 v238, 16, v179
    v_and_b32 v239, 0xffff0000, v179
    s_waitcnt lgkmcnt(12)
    v_pk_fma_f32 v[188:189], v[236:237], v[188:189], v[204:205]
    v_pk_fma_f32 v[190:191], v[238:239], v[190:191], v[206:207]
    v_pk_mul_f32 v[204:205], v[236:237], v[252:253] op_sel_hi:[1,0]
    v_pk_mul_f32 v[206:207], v[238:239], v[252:253] op_sel_hi:[1,0]
    v_pk_fma_f32 v[188:189], v[188:189], v[250:251], v[250:251] op_sel:[0,0,1] op_sel_hi:[1,0,1]
    v_pk_fma_f32 v[190:191], v[190:191], v[250:251], v[250:251] op_sel:[0,0,1] op_sel_hi:[1,0,1]
    v_lshlrev_b32 v232, 16, v180
    v_and_b32 v233, 0xffff0000, v180
    v_lshlrev_b32 v234, 16, v181
    v_and_b32 v235, 0xffff0000, v181
    s_waitcnt lgkmcnt(8)
    v_pk_fma_f32 v[192:193], v[232:233], v[192:193], v[208:209]
    v_pk_fma_f32 v[194:195], v[234:235], v[194:195], v[210:211]
    v_pk_mul_f32 v[208:209], v[232:233], v[252:253] op_sel_hi:[1,0]
    v_pk_mul_f32 v[210:211], v[234:235], v[252:253] op_sel_hi:[1,0]
    v_pk_fma_f32 v[192:193], v[192:193], v[250:251], v[250:251] op_sel:[0,0,1] op_sel_hi:[1,0,1]
    v_pk_fma_f32 v[194:195], v[194:195], v[250:251], v[250:251] op_sel:[0,0,1] op_sel_hi:[1,0,1]
    v_lshlrev_b32 v236, 16, v182
    v_and_b32 v237, 0xffff0000, v182
    v_lshlrev_b32 v238, 16, v183
    v_and_b32 v239, 0xffff0000, v183
    s_waitcnt lgkmcnt(4)
    v_pk_fma_f32 v[196:197], v[236:237], v[196:197], v[212:213]
    v_pk_fma_f32 v[198:199], v[238:239], v[198:199], v[214:215]
    v_pk_mul_f32 v[212:213], v[236:237], v[252:253] op_sel_hi:[1,0]
    v_pk_mul_f32 v[214:215], v[238:239], v[252:253] op_sel_hi:[1,0]
    v_pk_fma_f32 v[196:197], v[196:197], v[250:251], v[250:251] op_sel:[0,0,1] op_sel_hi:[1,0,1]
    v_pk_fma_f32 v[198:199], v[198:199], v[250:251], v[250:251] op_sel:[0,0,1] op_sel_hi:[1,0,1]
    v_pk_fma_f32 v[184:185], v[184:185], v[8:9], v[200:201]
    v_pk_fma_f32 v[186:187], v[186:187], v[10:11], v[202:203]
    v_cvt_pk_bf16_f32 v232, v184, v185
    v_cvt_pk_bf16_f32 v233, v186, v187
    v_pk_fma_f32 v[188:189], v[188:189], v[12:13], v[204:205]
    v_pk_fma_f32 v[190:191], v[190:191], v[14:15], v[206:207]
    v_cvt_pk_bf16_f32 v234, v188, v189
    v_cvt_pk_bf16_f32 v235, v190, v191
    s_nop 0
    v_permlane16_swap_b32 v232, v234
    v_permlane16_swap_b32 v233, v235
    buffer_store_dwordx4 v[232:235], v231, s[36:39], s68 offen offset:0 sc1
    v_pk_fma_f32 v[192:193], v[192:193], v[16:17], v[208:209]
    v_pk_fma_f32 v[194:195], v[194:195], v[18:19], v[210:211]
    v_cvt_pk_bf16_f32 v236, v192, v193
    v_cvt_pk_bf16_f32 v237, v194, v195
    v_pk_fma_f32 v[196:197], v[196:197], v[20:21], v[212:213]
    v_pk_fma_f32 v[198:199], v[198:199], v[22:23], v[214:215]
    v_cvt_pk_bf16_f32 v238, v196, v197
    v_cvt_pk_bf16_f32 v239, v198, v199
    s_nop 0
    v_permlane16_swap_b32 v236, v238
    v_permlane16_swap_b32 v237, v239
    buffer_store_dwordx4 v[236:239], v231, s[36:39], s68 offen offset:1024 sc1
    v_mfma_f32_16x16x32_bf16 v[24:27], v[40:43], v[120:123], v[24:27]
    ds_read_b64 v[78:79], v4 offset:584
    v_mfma_f32_16x16x32_bf16 v[24:27], v[244:247], v[120:123], v[24:27]
    s_add_u32 m0, s61, 37248
    ds_read_b128 v[152:155], v5 offset:1600
    ds_read_b128 v[184:187], v249 offset:4096
    v_mfma_f32_16x16x32_bf16 v[24:27], v[56:59], v[104:107], v[24:27]
    ds_read_b64 v[88:89], v4 offset:2112
    ds_read_b128 v[200:203], v249 offset:12288
    buffer_load_dwordx4 v225, s[40:43], s64 offen offset:1024 lds
    v_mfma_f32_16x16x32_bf16 v[36:39], v[48:51], v[124:127], v[36:39]
    ds_read_b64 v[90:91], v4 offset:2120
    ds_read_b128 v[188:191], v249 offset:5120
    v_mfma_f32_16x16x32_bf16 v[36:39], v[60:63], v[112:115], v[36:39]
    ds_read_b128 v[136:139], v5 offset:3648
    ds_read_b128 v[204:207], v249 offset:13312
    v_mfma_f32_16x16x32_bf16 v[32:35], v[44:47], v[124:127], v[32:35]
    ds_read_b64 v[72:73], v4 offset:64
    ds_read_b128 v[192:195], v249 offset:6144
    v_mfma_f32_16x16x32_bf16 v[32:35], v[60:63], v[108:111], v[32:35]
    s_waitcnt vmcnt(10)
    s_barrier
    ds_read_b64 v[74:75], v4 offset:72
    ds_read_b128 v[208:211], v249 offset:14336
    ds_read_b64_tr_b16 a[60:61], v227 offset:0
    v_mfma_f32_16x16x32_bf16 v[28:31], v[40:43], v[124:127], v[28:31]
    s_add_u32 m0, s61, 37248
    ds_read_b128 v[156:159], v5 offset:1088
    ds_read_b128 v[196:199], v249 offset:7168
    ds_read_b64_tr_b16 a[62:63], v227 offset:1536
    v_mfma_f32_16x16x32_bf16 v[28:31], v[244:247], v[124:127], v[28:31]
    ds_read_b64 v[92:93], v4 offset:2624
    ds_read_b128 v[212:215], v249 offset:15360
    ds_read_b64_tr_b16 a[64:65], v227 offset:6224
    buffer_load_dwordx4 v226, s[40:43], s64 offen offset:2048 lds
    v_mfma_f32_16x16x32_bf16 v[28:31], v[60:63], v[104:107], v[28:31]
    s_add_u32 s64, s64, 98304
    ds_read_b64 v[94:95], v4 offset:2632
    buffer_load_dword v243, v241, s[36:39], s60 offen sc1
    v_mfma_f32_16x16x32_bf16 v[36:39], v[44:47], v[128:131], v[36:39]
    s_sub_u32 s35, s64, 1966080
    ds_read_b128 v[160:163], v5 offset:576
    ds_read_b64_tr_b16 a[66:67], v227 offset:7760
    v_mfma_f32_16x16x32_bf16 v[36:39], v[64:67], v[108:111], v[36:39]
    s_min_u32 s64, s64, s35
    ds_read_b64 v[96:97], v4 offset:3136
    ds_read_b64_tr_b16 a[68:69], v228 offset:0
    v_mfma_f32_16x16x32_bf16 v[32:35], v[40:43], v[128:131], v[32:35]
    ds_read_b64 v[98:99], v4 offset:3144
    ds_read_b64_tr_b16 a[70:71], v228 offset:1536
    v_mfma_f32_16x16x32_bf16 v[32:35], v[244:247], v[128:131], v[32:35]
    ds_read_b128 v[164:167], v5 offset:64
    v_mfma_f32_16x16x32_bf16 v[32:35], v[64:67], v[104:107], v[32:35]
    ds_read_b64 v[100:101], v4 offset:3648
    buffer_load_dwordx4 v[176:179], v231, s[36:39], s65 offen offset:2048 sc1
    v_mfma_f32_16x16x32_bf16 v[36:39], v[40:43], v[132:135], v[36:39]
    ds_read_b64 v[102:103], v4 offset:3656
    v_mfma_f32_16x16x32_bf16 v[36:39], v[244:247], v[132:135], v[36:39]
    v_mfma_f32_16x16x32_bf16 v[36:39], v[68:71], v[104:107], v[36:39]
    v_mfma_f32_16x16x32_bf16 v[24:27], v[80:83], v[144:147], v[24:27]
    ds_read_b128 v[112:115], v5 offset:2688
    buffer_load_dwordx4 v[180:183], v231, s[36:39], s65 offen offset:3072 sc1
    v_mfma_f32_16x16x32_bf16 v[28:31], v[80:83], v[148:151], v[28:31]
    s_waitcnt lgkmcnt(13)
    ds_read_b64 v[48:49], v4 offset:1152
    v_mfma_f32_16x16x32_bf16 v[28:31], v[84:87], v[144:147], v[28:31]
    ds_read_b64 v[50:51], v4 offset:1160
    v_mfma_f32_16x16x32_bf16 v[32:35], v[84:87], v[148:151], v[32:35]
    s_add_u32 m0, s61, 49664
    ds_read_b128 v[116:119], v5 offset:2176
    v_mfma_f32_16x16x32_bf16 v[24:27], v[76:79], v[148:151], v[24:27]
    ds_read_b64 v[52:53], v4 offset:1664
    buffer_load_dwordx4 v224, s[40:43], s64 offen offset:0 lds
    v_mfma_f32_16x16x32_bf16 v[24:27], v[84:87], v[140:143], v[24:27]
    ds_read_b64 v[54:55], v4 offset:1672
    v_mfma_f32_16x16x32_bf16 v[32:35], v[80:83], v[152:155], v[32:35]
    s_waitcnt vmcnt(12)
    s_waitcnt lgkmcnt(9)
    s_barrier
    ds_read_b128 v[108:111], v5 offset:3200
    v_mfma_f32_16x16x32_bf16 v[32:35], v[88:91], v[144:147], v[32:35]
    ds_read_b64 v[44:45], v4 offset:640
    ds_read_b64_tr_b16 a[72:73], v227 offset:12416
    v_mfma_f32_16x16x32_bf16 v[36:39], v[84:87], v[152:155], v[36:39]
    ds_read_b64 v[46:47], v4 offset:648
    ds_read_b64_tr_b16 a[74:75], v227 offset:13952
    v_mfma_f32_16x16x32_bf16 v[36:39], v[88:91], v[148:151], v[36:39]
    s_add_u32 m0, s61, 49664
    ds_read_b128 v[120:123], v5 offset:1664
    ds_read_b64_tr_b16 a[76:77], v227 offset:18640
    v_mfma_f32_16x16x32_bf16 v[28:31], v[76:79], v[152:155], v[28:31]
    ds_read_b64 v[56:57], v4 offset:2176
    ds_read_b64_tr_b16 a[78:79], v227 offset:20176
    buffer_load_dwordx4 v225, s[40:43], s64 offen offset:1024 lds
    v_mfma_f32_16x16x32_bf16 v[28:31], v[88:91], v[140:143], v[28:31]
    ds_read_b64 v[58:59], v4 offset:2184
    ds_read_b64_tr_b16 a[80:81], v228 offset:12416
    v_mfma_f32_16x16x32_bf16 v[24:27], v[72:75], v[152:155], v[24:27]
    ds_read_b128 v[104:107], v5 offset:3712
    ds_read_b64_tr_b16 a[82:83], v228 offset:13952
    v_mfma_f32_16x16x32_bf16 v[24:27], v[88:91], v[136:139], v[24:27]
    ds_read_b64 v[40:41], v4 offset:128
    v_mfma_f32_16x16x32_bf16 v[36:39], v[80:83], v[156:159], v[36:39]
    ds_read_b64 v[42:43], v4 offset:136
    v_mfma_f32_16x16x32_bf16 v[36:39], v[92:95], v[144:147], v[36:39]
    s_add_u32 m0, s61, 49664
    ds_read_b128 v[124:127], v5 offset:1152
    v_mfma_f32_16x16x32_bf16 v[32:35], v[76:79], v[156:159], v[32:35]
    ds_read_b64 v[60:61], v4 offset:2688
    buffer_load_dwordx4 v226, s[40:43], s64 offen offset:2048 lds
    v_mfma_f32_16x16x32_bf16 v[32:35], v[92:95], v[140:143], v[32:35]
    s_add_u32 s64, s64, 98304
    ds_read_b64 v[62:63], v4 offset:2696
    v_mfma_f32_16x16x32_bf16 v[28:31], v[72:75], v[156:159], v[28:31]
    s_sub_u32 s35, s64, 1966080
    ds_read_b128 v[128:131], v5 offset:640
    v_mfma_f32_16x16x32_bf16 v[28:31], v[92:95], v[136:139], v[28:31]
    s_min_u32 s64, s64, s35
    ds_read_b64 v[64:65], v4 offset:3200
    v_mfma_f32_16x16x32_bf16 v[36:39], v[76:79], v[160:163], v[36:39]
    ds_read_b64 v[66:67], v4 offset:3208
    v_mfma_f32_16x16x32_bf16 v[36:39], v[96:99], v[140:143], v[36:39]
    s_add_u32 m0, s61, 0
    ds_read_b128 v[132:135], v5 offset:128
    v_mfma_f32_16x16x32_bf16 v[32:35], v[72:75], v[160:163], v[32:35]
    ds_read_b64 v[68:69], v4 offset:3712
    buffer_load_dwordx4 v224, s[40:43], s64 offen offset:0 lds
    v_mfma_f32_16x16x32_bf16 v[32:35], v[96:99], v[136:139], v[32:35]
    s_waitcnt lgkmcnt(13)
    ds_read_b64 v[70:71], v4 offset:3720
    v_mfma_f32_16x16x32_bf16 v[36:39], v[72:75], v[164:167], v[36:39]
    v_mfma_f32_16x16x32_bf16 v[36:39], v[100:103], v[136:139], v[36:39]
    s_waitcnt vmcnt(12)
    s_waitcnt lgkmcnt(11)
    s_barrier
    ds_read_b64_tr_b16 a[84:85], v227 offset:24832
    v_mfma_f32_16x16x32_bf16 v[24:27], v[48:51], v[112:115], v[24:27]
    s_waitcnt vmcnt(9)
    s_barrier
    s_cmp_eq_u32 s3, 0
    s_cbranch_scc0 L_wf5
    s_lshl_b32 s54, s70, 7
    s_add_u32 s54, s54, 23245824
    v_mov_b32 v254, 0
    v_mov_b32 v255, s48
    s_mov_b64 exec, 1
    buffer_store_dword v255, v254, s[36:39], s54 offen sc1
    s_mov_b64 exec, -1
L_wf5:
    ds_read_b128 v[144:147], v5 offset:2752
    v_mfma_f32_16x16x32_bf16 v[28:31], v[48:51], v[116:119], v[28:31]
    s_add_u32 m0, s61, 0
    ds_read_b64 v[80:81], v4 offset:1216
    ds_read_b64_tr_b16 a[86:87], v227 offset:26368
    v_mfma_f32_16x16x32_bf16 v[28:31], v[52:55], v[112:115], v[28:31]
    ds_read_b64 v[82:83], v4 offset:1224
    ds_read_b64_tr_b16 a[88:89], v227 offset:31056
    buffer_load_dwordx4 v225, s[40:43], s64 offen offset:1024 lds
    v_mfma_f32_16x16x32_bf16 v[32:35], v[52:55], v[116:119], v[32:35]
    ds_read_b128 v[148:151], v5 offset:2240
    ds_read_b64_tr_b16 a[90:91], v227 offset:32592
    v_mfma_f32_16x16x32_bf16 v[24:27], v[44:47], v[116:119], v[24:27]
    ds_read_b64 v[84:85], v4 offset:1728
    ds_read_b64_tr_b16 a[92:93], v228 offset:24832
    v_mfma_f32_16x16x32_bf16 v[24:27], v[52:55], v[108:111], v[24:27]
    ds_read_b64 v[86:87], v4 offset:1736
    ds_read_b64_tr_b16 a[94:95], v228 offset:26368
    v_mfma_f32_16x16x32_bf16 v[32:35], v[48:51], v[120:123], v[32:35]
    ds_read_b128 v[140:143], v5 offset:3264
    v_mfma_f32_16x16x32_bf16 v[32:35], v[56:59], v[112:115], v[32:35]
    s_add_u32 m0, s61, 0
    ds_read_b64 v[76:77], v4 offset:704
    v_mfma_f32_16x16x32_bf16 v[36:39], v[52:55], v[120:123], v[36:39]
    ds_read_b64 v[78:79], v4 offset:712
    buffer_load_dwordx4 v226, s[40:43], s64 offen offset:2048 lds
    v_mfma_f32_16x16x32_bf16 v[36:39], v[56:59], v[116:119], v[36:39]
    s_add_u32 s64, s64, 98304
    ds_read_b128 v[152:155], v5 offset:1728
    v_mfma_f32_16x16x32_bf16 v[28:31], v[44:47], v[120:123], v[28:31]
    s_sub_u32 s35, s64, 1966080
    ds_read_b64 v[88:89], v4 offset:2240
    v_mfma_f32_16x16x32_bf16 v[28:31], v[56:59], v[108:111], v[28:31]
    s_waitcnt lgkmcnt(13)
    s_min_u32 s64, s64, s35
    ds_read_b64 v[90:91], v4 offset:2248
    v_mfma_f32_16x16x32_bf16 v[24:27], v[40:43], v[120:123], v[24:27]
    ds_read_b128 v[136:139], v5 offset:3776
    v_mfma_f32_16x16x32_bf16 v[24:27], v[56:59], v[104:107], v[24:27]
    s_add_u32 m0, s61, 12416
    ds_read_b64 v[72:73], v4 offset:192
    v_mfma_f32_16x16x32_bf16 v[36:39], v[48:51], v[124:127], v[36:39]
    ds_read_b64 v[74:75], v4 offset:200
    buffer_load_dwordx4 v224, s[40:43], s64 offen offset:0 lds
    v_mfma_f32_16x16x32_bf16 v[36:39], v[60:63], v[112:115], v[36:39]
    ds_read_b128 v[156:159], v5 offset:1216
    s_waitcnt vmcnt(9)
    v_cmp_ne_u32 vcc, s48, v243
    s_cbranch_vccnz L_chk6_slow
L_chk6_back:
    v_mfma_f32_16x16x32_bf16 v[32:35], v[44:47], v[124:127], v[32:35]
    ds_read_b64 v[92:93], v4 offset:2752
    v_lshlrev_b32 v2, 2, v0
    v_mfma_f32_16x16x32_bf16 v[32:35], v[60:63], v[108:111], v[32:35]
    ds_read_b64 v[94:95], v4 offset:2760
    v_mov_b32 v3, 0x80000000
    v_cmp_gt_u32 vcc, 128, v0
    s_nop 1
    v_cndmask_b32 v3, v3, v2, vcc
    v_mfma_f32_16x16x32_bf16 v[28:31], v[40:43], v[124:127], v[28:31]
    s_waitcnt lgkmcnt(12)
    s_barrier
    ds_read_b128 v[160:163], v5 offset:704
    v_mfma_f32_16x16x32_bf16 v[28:31], v[60:63], v[104:107], v[28:31]
    s_add_u32 m0, s61, 12416
    ds_read_b64 v[96:97], v4 offset:3264
    ds_read_b64_tr_b16 a[96:97], v227 offset:37248
    v_mfma_f32_16x16x32_bf16 v[36:39], v[44:47], v[128:131], v[36:39]
    s_lshl_b32 s56, s34, 7
    ds_read_b64 v[98:99], v4 offset:3272
    ds_read_b64_tr_b16 a[98:99], v227 offset:38784
    buffer_load_dwordx4 v225, s[40:43], s64 offen offset:1024 lds
    v_mfma_f32_16x16x32_bf16 v[36:39], v[64:67], v[108:111], v[36:39]
    s_add_u32 s56, s56, 23183360
    ds_read_b128 v[164:167], v5 offset:192
    ds_read_b64_tr_b16 a[100:101], v227 offset:43472
    v_mfma_f32_16x16x32_bf16 v[32:35], v[40:43], v[128:131], v[32:35]
    ds_read_b64 v[100:101], v4 offset:3776
    ds_read_b64_tr_b16 a[102:103], v227 offset:45008
    v_mfma_f32_16x16x32_bf16 v[32:35], v[64:67], v[104:107], v[32:35]
    ds_read_b64 v[102:103], v4 offset:3784
    ds_read_b64_tr_b16 a[104:105], v228 offset:37248
    v_mfma_f32_16x16x32_bf16 v[36:39], v[40:43], v[132:135], v[36:39]
    ds_read_b64_tr_b16 a[106:107], v228 offset:38784
    buffer_load_dword v220, v2, s[36:39], s56 offen sc1
    v_mfma_f32_16x16x32_bf16 v[36:39], v[68:71], v[104:107], v[36:39]
    s_add_u32 m0, s61, 12416
    s_waitcnt vmcnt(10)
    v_permlane16_swap_b32 v176, v178
    buffer_load_dword v221, v2, s[36:39], s56 offen offset:1024 sc1
    v_mfma_f32_16x16x32_bf16 v[24:27], v[80:83], v[144:147], v[24:27]
    ds_read_b128 v[112:115], v5 offset:2816
    buffer_load_dwordx4 v226, s[40:43], s64 offen offset:2048 lds
    v_mfma_f32_16x16x32_bf16 v[28:31], v[80:83], v[148:151], v[28:31]
    s_add_u32 s64, s64, 98304
    ds_read_b64 v[48:49], v4 offset:1280
    v_permlane16_swap_b32 v177, v179
    buffer_load_dword v222, v3, s[36:39], s56 offen offset:2048 sc1
    v_mfma_f32_16x16x32_bf16 v[28:31], v[84:87], v[144:147], v[28:31]
    s_sub_u32 s35, s64, 1966080
    ds_read_b64 v[50:51], v4 offset:1288
    s_waitcnt vmcnt(12)
    v_permlane16_swap_b32 v180, v182
    v_mfma_f32_16x16x32_bf16 v[32:35], v[84:87], v[148:151], v[32:35]
    s_waitcnt lgkmcnt(13)
    s_min_u32 s64, s64, s35
    ds_read_b128 v[116:119], v5 offset:2304
    v_permlane16_swap_b32 v181, v183
    v_mfma_f32_16x16x32_bf16 v[24:27], v[76:79], v[148:151], v[24:27]
    ds_read_b64 v[52:53], v4 offset:1792
    v_lshlrev_b32 v232, 16, v176
    v_mfma_f32_16x16x32_bf16 v[24:27], v[84:87], v[140:143], v[24:27]
    s_add_u32 m0, s61, 24832
    ds_read_b64 v[54:55], v4 offset:1800
    v_fma_f32 v184, v232, v184, v200
    v_mfma_f32_16x16x32_bf16 v[32:35], v[80:83], v[152:155], v[32:35]
    ds_read_b128 v[108:111], v5 offset:3328
    buffer_load_dwordx4 v224, s[40:43], s64 offen offset:0 lds
    v_mfma_f32_16x16x32_bf16 v[32:35], v[88:91], v[144:147], v[32:35]
    ds_read_b64 v[44:45], v4 offset:768
    v_mul_f32 v200, v252, v232
    v_mfma_f32_16x16x32_bf16 v[36:39], v[84:87], v[152:155], v[36:39]
    ds_read_b64 v[46:47], v4 offset:776
    v_fma_f32 v184, v184, v250, v251
    v_mfma_f32_16x16x32_bf16 v[36:39], v[88:91], v[148:151], v[36:39]
    ds_read_b128 v[120:123], v5 offset:1792
    v_and_b32 v233, 0xffff0000, v176
    v_fma_f32 v185, v233, v185, v201
    v_mul_f32 v201, v252, v233
    v_fma_f32 v185, v185, v250, v251
    v_mfma_f32_16x16x32_bf16 v[28:31], v[76:79], v[152:155], v[28:31]
    s_waitcnt vmcnt(10)
    s_waitcnt lgkmcnt(10)
    s_barrier
    ds_read_b64 v[56:57], v4 offset:2304
    v_mfma_f32_16x16x32_bf16 v[28:31], v[88:91], v[140:143], v[28:31]
    s_add_u32 m0, s61, 24832
    ds_read_b64 v[58:59], v4 offset:2312
    ds_read_b64_tr_b16 a[108:109], v227 offset:49664
    v_mfma_f32_16x16x32_bf16 v[24:27], v[72:75], v[152:155], v[24:27]
    ds_read_b128 v[104:107], v5 offset:3840
    ds_read_b64_tr_b16 a[110:111], v227 offset:51200
    buffer_load_dwordx4 v225, s[40:43], s64 offen offset:1024 lds
    v_mfma_f32_16x16x32_bf16 v[24:27], v[88:91], v[136:139], v[24:27]
    ds_read_b64 v[40:41], v4 offset:256
    ds_read_b64_tr_b16 a[112:113], v227 offset:55888
    v_mfma_f32_16x16x32_bf16 v[36:39], v[80:83], v[156:159], v[36:39]
    ds_read_b64 v[42:43], v4 offset:264
    ds_read_b64_tr_b16 a[114:115], v227 offset:57424
    v_mfma_f32_16x16x32_bf16 v[36:39], v[92:95], v[144:147], v[36:39]
    ds_read_b128 v[124:127], v5 offset:1280
    ds_read_b64_tr_b16 a[116:117], v228 offset:49664
    v_mfma_f32_16x16x32_bf16 v[32:35], v[76:79], v[156:159], v[32:35]
    ds_read_b64 v[60:61], v4 offset:2816
    ds_read_b64_tr_b16 a[118:119], v228 offset:51200
    v_mfma_f32_16x16x32_bf16 v[32:35], v[92:95], v[140:143], v[32:35]
    s_add_u32 m0, s61, 24832
    ds_read_b64 v[62:63], v4 offset:2824
    v_lshlrev_b32 v232, 16, v177
    v_mfma_f32_16x16x32_bf16 v[28:31], v[72:75], v[156:159], v[28:31]
    ds_read_b128 v[128:131], v5 offset:768
    buffer_load_dwordx4 v226, s[40:43], s64 offen offset:2048 lds
    v_mfma_f32_16x16x32_bf16 v[28:31], v[92:95], v[136:139], v[28:31]
    s_add_u32 s64, s64, 98304
    ds_read_b64 v[64:65], v4 offset:3328
    v_fma_f32 v186, v232, v186, v202
    v_mfma_f32_16x16x32_bf16 v[36:39], v[76:79], v[160:163], v[36:39]
    s_sub_u32 s35, s64, 1966080
    ds_read_b64 v[66:67], v4 offset:3336
    v_mul_f32 v202, v252, v232
    v_mfma_f32_16x16x32_bf16 v[36:39], v[96:99], v[140:143], v[36:39]
    s_min_u32 s64, s64, s35
    ds_read_b128 v[132:135], v5 offset:256
    v_fma_f32 v186, v186, v250, v251
    v_mfma_f32_16x16x32_bf16 v[32:35], v[72:75], v[160:163], v[32:35]
    ds_read_b64 v[68:69], v4 offset:3840
    v_and_b32 v233, 0xffff0000, v177
    v_mfma_f32_16x16x32_bf16 v[32:35], v[96:99], v[136:139], v[32:35]
    s_add_u32 m0, s61, 37248
    ds_read_b64 v[70:71], v4 offset:3848
    v_fma_f32 v187, v233, v187, v203
    v_mfma_f32_16x16x32_bf16 v[36:39], v[72:75], v[164:167], v[36:39]
    buffer_load_dwordx4 v224, s[40:43], s64 offen offset:0 lds
    v_mfma_f32_16x16x32_bf16 v[36:39], v[100:103], v[136:139], v[36:39]
    s_waitcnt lgkmcnt(14)
    v_mul_f32 v203, v252, v233
    v_fma_f32 v187, v187, v250, v251
    v_mfma_f32_16x16x32_bf16 v[24:27], v[48:51], v[112:115], v[24:27]
    ds_read_b128 v[144:147], v5 offset:2880
    v_lshlrev_b32 v232, 16, v178
    v_mfma_f32_16x16x32_bf16 v[28:31], v[48:51], v[116:119], v[28:31]
    ds_read_b64 v[80:81], v4 offset:1344
    v_fma_f32 v188, v232, v188, v204
    v_mfma_f32_16x16x32_bf16 v[28:31], v[52:55], v[112:115], v[28:31]
    ds_read_b64 v[82:83], v4 offset:1352
    v_mul_f32 v204, v252, v232
    v_fma_f32 v188, v188, v250, v251
    v_and_b32 v233, 0xffff0000, v178
    v_mfma_f32_16x16x32_bf16 v[32:35], v[52:55], v[116:119], v[32:35]
    s_waitcnt vmcnt(10)
    s_waitcnt lgkmcnt(10)
    s_barrier
    s_add_u32 m0, s61, 37248
    ds_read_b128 v[148:151], v5 offset:2368
    v_mfma_f32_16x16x32_bf16 v[24:27], v[44:47], v[116:119], v[24:27]
    ds_read_b64 v[84:85], v4 offset:1856
    ds_read_b64_tr_b16 a[120:121], v227 offset:0
    buffer_load_dwordx4 v225, s[40:43], s64 offen offset:1024 lds
    v_mfma_f32_16x16x32_bf16 v[24:27], v[52:55], v[108:111], v[24:27]
    ds_read_b64 v[86:87], v4 offset:1864
    ds_read_b64_tr_b16 a[122:123], v227 offset:1536
    v_mfma_f32_16x16x32_bf16 v[32:35], v[48:51], v[120:123], v[32:35]
    ds_read_b128 v[140:143], v5 offset:3392
    ds_read_b64_tr_b16 a[124:125], v227 offset:6224
    v_mfma_f32_16x16x32_bf16 v[32:35], v[56:59], v[112:115], v[32:35]
    ds_read_b64 v[76:77], v4 offset:832
    ds_read_b64_tr_b16 a[126:127], v227 offset:7760
    v_mfma_f32_16x16x32_bf16 v[36:39], v[52:55], v[120:123], v[36:39]
    ds_read_b64 v[78:79], v4 offset:840
    ds_read_b64_tr_b16 a[128:129], v228 offset:0
    v_mfma_f32_16x16x32_bf16 v[36:39], v[56:59], v[116:119], v[36:39]
    s_add_u32 m0, s61, 37248
    ds_read_b128 v[152:155], v5 offset:1856
    ds_read_b64_tr_b16 a[130:131], v228 offset:1536
    v_mfma_f32_16x16x32_bf16 v[28:31], v[44:47], v[120:123], v[28:31]
    ds_read_b64 v[88:89], v4 offset:2368
    buffer_load_dwordx4 v226, s[40:43], s64 offen offset:2048 lds
    v_mfma_f32_16x16x32_bf16 v[28:31], v[56:59], v[108:111], v[28:31]
    s_add_u32 s64, s64, 98304
    ds_read_b64 v[90:91], v4 offset:2376
    v_fma_f32 v189, v233, v189, v205
    v_mfma_f32_16x16x32_bf16 v[24:27], v[40:43], v[120:123], v[24:27]
    s_sub_u32 s35, s64, 1966080
    ds_read_b128 v[136:139], v5 offset:3904
    v_mul_f32 v205, v252, v233
    v_mfma_f32_16x16x32_bf16 v[24:27], v[56:59], v[104:107], v[24:27]
    s_min_u32 s64, s64, s35
    ds_read_b64 v[72:73], v4 offset:320
    v_fma_f32 v189, v189, v250, v251
    v_mfma_f32_16x16x32_bf16 v[36:39], v[48:51], v[124:127], v[36:39]
    s_waitcnt lgkmcnt(13)
    ds_read_b64 v[74:75], v4 offset:328
    v_lshlrev_b32 v232, 16, v179
    v_mfma_f32_16x16x32_bf16 v[36:39], v[60:63], v[112:115], v[36:39]
    s_add_u32 m0, s61, 49664
    ds_read_b128 v[156:159], v5 offset:1344
    v_fma_f32 v190, v232, v190, v206
    v_mfma_f32_16x16x32_bf16 v[32:35], v[44:47], v[124:127], v[32:35]
    ds_read_b64 v[92:93], v4 offset:2880
    buffer_load_dwordx4 v224, s[40:43], s64 offen offset:0 lds
    v_mfma_f32_16x16x32_bf16 v[32:35], v[60:63], v[108:111], v[32:35]
    ds_read_b64 v[94:95], v4 offset:2888
    v_mul_f32 v206, v252, v232
    v_mfma_f32_16x16x32_bf16 v[28:31], v[40:43], v[124:127], v[28:31]
    ds_read_b128 v[160:163], v5 offset:832
    v_fma_f32 v190, v190, v250, v251
    v_mfma_f32_16x16x32_bf16 v[28:31], v[60:63], v[104:107], v[28:31]
    ds_read_b64 v[96:97], v4 offset:3392
    v_and_b32 v233, 0xffff0000, v179
    v_mfma_f32_16x16x32_bf16 v[36:39], v[44:47], v[128:131], v[36:39]
    ds_read_b64 v[98:99], v4 offset:3400
    v_fma_f32 v191, v233, v191, v207
    v_mfma_f32_16x16x32_bf16 v[36:39], v[64:67], v[108:111], v[36:39]
    s_add_u32 m0, s61, 49664
    ds_read_b128 v[164:167], v5 offset:320
    v_mul_f32 v207, v252, v233
    v_mfma_f32_16x16x32_bf16 v[32:35], v[40:43], v[128:131], v[32:35]
    s_waitcnt vmcnt(8)
    s_waitcnt lgkmcnt(12)
    s_barrier
    ds_read_b64 v[100:101], v4 offset:3904
    buffer_load_dwordx4 v225, s[40:43], s64 offen offset:1024 lds
    v_mfma_f32_16x16x32_bf16 v[32:35], v[64:67], v[104:107], v[32:35]
    ds_read_b64 v[102:103], v4 offset:3912
    ds_read_b64_tr_b16 a[132:133], v227 offset:12416
    v_mfma_f32_16x16x32_bf16 v[36:39], v[40:43], v[132:135], v[36:39]
    ds_read_b64_tr_b16 a[134:135], v227 offset:13952
    buffer_load_dword v223, v219, s[36:39], s17 offen sc1
    v_mfma_f32_16x16x32_bf16 v[36:39], v[68:71], v[104:107], v[36:39]
    ds_read_b64_tr_b16 a[136:137], v227 offset:18640
    v_fma_f32 v191, v191, v250, v251
    v_mfma_f32_16x16x32_bf16 v[24:27], v[80:83], v[144:147], v[24:27]
    ds_read_b128 v[112:115], v5 offset:2944
    ds_read_b64_tr_b16 a[138:139], v227 offset:20176
    v_mfma_f32_16x16x32_bf16 v[28:31], v[80:83], v[148:151], v[28:31]
    s_add_u32 m0, s61, 49664
    ds_read_b64 v[48:49], v4 offset:1408
    ds_read_b64_tr_b16 a[140:141], v228 offset:12416
    v_mfma_f32_16x16x32_bf16 v[28:31], v[84:87], v[144:147], v[28:31]
    ds_read_b64 v[50:51], v4 offset:1416
    ds_read_b64_tr_b16 a[142:143], v228 offset:13952
    buffer_load_dwordx4 v226, s[40:43], s64 offen offset:2048 lds
    v_mfma_f32_16x16x32_bf16 v[32:35], v[84:87], v[148:151], v[32:35]
    s_add_u32 s64, s64, 98304
    ds_read_b128 v[116:119], v5 offset:2432
    v_lshlrev_b32 v232, 16, v180
    v_mfma_f32_16x16x32_bf16 v[24:27], v[76:79], v[148:151], v[24:27]
    s_sub_u32 s35, s64, 1966080
    ds_read_b64 v[52:53], v4 offset:1920
    v_fma_f32 v192, v232, v192, v208
    v_mfma_f32_16x16x32_bf16 v[24:27], v[84:87], v[140:143], v[24:27]
    s_min_u32 s64, s64, s35
    ds_read_b64 v[54:55], v4 offset:1928
    v_mul_f32 v208, v252, v232
    v_mfma_f32_16x16x32_bf16 v[32:35], v[80:83], v[152:155], v[32:35]
    s_waitcnt lgkmcnt(13)
    ds_read_b128 v[108:111], v5 offset:3456
    v_fma_f32 v192, v192, v250, v251
    v_mfma_f32_16x16x32_bf16 v[32:35], v[88:91], v[144:147], v[32:35]
    ds_read_b64 v[44:45], v4 offset:896
    v_and_b32 v233, 0xffff0000, v180
    v_mfma_f32_16x16x32_bf16 v[36:39], v[84:87], v[152:155], v[36:39]
    ds_read_b64 v[46:47], v4 offset:904
    v_fma_f32 v193, v233, v193, v209
    v_mfma_f32_16x16x32_bf16 v[36:39], v[88:91], v[148:151], v[36:39]
    ds_read_b128 v[120:123], v5 offset:1920
    v_mul_f32 v209, v252, v233
    v_mfma_f32_16x16x32_bf16 v[28:31], v[76:79], v[152:155], v[28:31]
    ds_read_b64 v[56:57], v4 offset:2432
    v_fma_f32 v193, v193, v250, v251
    v_mfma_f32_16x16x32_bf16 v[28:31], v[88:91], v[140:143], v[28:31]
    ds_read_b64 v[58:59], v4 offset:2440
    v_lshlrev_b32 v232, 16, v181
    v_mfma_f32_16x16x32_bf16 v[24:27], v[72:75], v[152:155], v[24:27]
    ds_read_b128 v[104:107], v5 offset:3968
    v_fma_f32 v194, v232, v194, v210
    v_mfma_f32_16x16x32_bf16 v[24:27], v[88:91], v[136:139], v[24:27]
    ds_read_b64 v[40:41], v4 offset:384
    v_mul_f32 v210, v252, v232
    v_fma_f32 v194, v194, v250, v251
    v_mfma_f32_16x16x32_bf16 v[36:39], v[80:83], v[156:159], v[36:39]
    s_waitcnt vmcnt(7)
    s_waitcnt lgkmcnt(11)
    s_barrier
    ds_read_b64 v[42:43], v4 offset:392
    v_mfma_f32_16x16x32_bf16 v[36:39], v[92:95], v[144:147], v[36:39]
    ds_read_b128 v[124:127], v5 offset:1408
    ds_read_b64_tr_b16 a[144:145], v227 offset:24832
    v_mfma_f32_16x16x32_bf16 v[32:35], v[76:79], v[156:159], v[32:35]
    ds_read_b64 v[60:61], v4 offset:2944
    ds_read_b64_tr_b16 a[146:147], v227 offset:26368
    v_mfma_f32_16x16x32_bf16 v[32:35], v[92:95], v[140:143], v[32:35]
    ds_read_b64 v[62:63], v4 offset:2952
    ds_read_b64_tr_b16 a[148:149], v227 offset:31056
    v_mfma_f32_16x16x32_bf16 v[28:31], v[72:75], v[156:159], v[28:31]
    ds_read_b128 v[128:131], v5 offset:896
    ds_read_b64_tr_b16 a[150:151], v227 offset:32592
    v_mfma_f32_16x16x32_bf16 v[28:31], v[92:95], v[136:139], v[28:31]
    ds_read_b64 v[64:65], v4 offset:3456
    ds_read_b64_tr_b16 a[152:153], v228 offset:24832
    v_mfma_f32_16x16x32_bf16 v[36:39], v[76:79], v[160:163], v[36:39]
    ds_read_b64 v[66:67], v4 offset:3464
    ds_read_b64_tr_b16 a[154:155], v228 offset:26368
    v_mfma_f32_16x16x32_bf16 v[36:39], v[96:99], v[140:143], v[36:39]
    ds_read_b128 v[132:135], v5 offset:384
    v_and_b32 v233, 0xffff0000, v181
    v_fma_f32 v195, v233, v195, v211
    v_mfma_f32_16x16x32_bf16 v[32:35], v[72:75], v[160:163], v[32:35]
    s_add_u32 m0, s63, 0
    ds_read_b64 v[68:69], v4 offset:3968
    s_waitcnt vmcnt(1)
    v_cmp_ne_u32 vcc, s48, v223
    s_cbranch_vccnz L_chk7_slow
L_chk7_back:
    v_mfma_f32_16x16x32_bf16 v[32:35], v[96:99], v[136:139], v[32:35]
    ds_read_b64 v[70:71], v4 offset:3976
    buffer_load_dwordx4 v172, s[36:39], s10 offen sc1 lds
    v_mfma_f32_16x16x32_bf16 v[36:39], v[72:75], v[164:167], v[36:39]
    v_mul_f32 v211, v252, v233
    v_fma_f32 v195, v195, v250, v251
    v_mfma_f32_16x16x32_bf16 v[36:39], v[100:103], v[136:139], v[36:39]
    v_lshlrev_b32 v232, 16, v182
    v_fma_f32 v196, v232, v196, v212
    v_mfma_f32_16x16x32_bf16 v[24:27], v[48:51], v[112:115], v[24:27]
    s_waitcnt lgkmcnt(13)
    s_add_u32 m0, s63, 4096
    ds_read_b128 v[144:147], v5 offset:3008
    v_mul_f32 v212, v252, v232
    v_mfma_f32_16x16x32_bf16 v[28:31], v[48:51], v[116:119], v[28:31]
    ds_read_b64 v[80:81], v4 offset:1472
    buffer_load_dwordx4 v172, s[36:39], s11 offen sc1 lds
    v_mfma_f32_16x16x32_bf16 v[28:31], v[52:55], v[112:115], v[28:31]
    ds_read_b64 v[82:83], v4 offset:1480
    v_fma_f32 v196, v196, v250, v251
    v_mfma_f32_16x16x32_bf16 v[32:35], v[52:55], v[116:119], v[32:35]
    ds_read_b128 v[148:151], v5 offset:2496
    v_and_b32 v233, 0xffff0000, v182
    v_mfma_f32_16x16x32_bf16 v[24:27], v[44:47], v[116:119], v[24:27]
    s_add_u32 m0, s63, 8192
    ds_read_b64 v[84:85], v4 offset:1984
    v_fma_f32 v197, v233, v197, v213
    v_mfma_f32_16x16x32_bf16 v[24:27], v[52:55], v[108:111], v[24:27]
    ds_read_b64 v[86:87], v4 offset:1992
    buffer_load_dwordx4 v172, s[36:39], s12 offen sc1 lds
    v_mfma_f32_16x16x32_bf16 v[32:35], v[48:51], v[120:123], v[32:35]
    ds_read_b128 v[140:143], v5 offset:3520
    v_mul_f32 v213, v252, v233
    v_fma_f32 v197, v197, v250, v251
    v_mfma_f32_16x16x32_bf16 v[32:35], v[56:59], v[112:115], v[32:35]
    s_waitcnt lgkmcnt(10)
    s_barrier
    ds_read_b64 v[76:77], v4 offset:960
    v_mfma_f32_16x16x32_bf16 v[36:39], v[52:55], v[120:123], v[36:39]
    s_add_u32 m0, s63, 12288
    ds_read_b64 v[78:79], v4 offset:968
    ds_read_b64_tr_b16 a[156:157], v227 offset:37248
    v_mfma_f32_16x16x32_bf16 v[36:39], v[56:59], v[116:119], v[36:39]
    ds_read_b128 v[152:155], v5 offset:1984
    ds_read_b64_tr_b16 a[158:159], v227 offset:38784
    buffer_load_dwordx4 v172, s[36:39], s13 offen sc1 lds
    v_mfma_f32_16x16x32_bf16 v[28:31], v[44:47], v[120:123], v[28:31]
    ds_read_b64 v[88:89], v4 offset:2496
    ds_read_b64_tr_b16 a[160:161], v227 offset:43472
    v_mfma_f32_16x16x32_bf16 v[28:31], v[56:59], v[108:111], v[28:31]
    ds_read_b64 v[90:91], v4 offset:2504
    ds_read_b64_tr_b16 a[162:163], v227 offset:45008
    v_mfma_f32_16x16x32_bf16 v[24:27], v[40:43], v[120:123], v[24:27]
    s_add_u32 m0, s63, 16384
    ds_read_b128 v[136:139], v5 offset:4032
    ds_read_b64_tr_b16 a[164:165], v228 offset:37248
    v_mfma_f32_16x16x32_bf16 v[24:27], v[56:59], v[104:107], v[24:27]
    ds_read_b64 v[72:73], v4 offset:448
    ds_read_b64_tr_b16 a[166:167], v228 offset:38784
    buffer_load_dwordx4 v172, s[36:39], s14 offen sc1 lds
    v_mfma_f32_16x16x32_bf16 v[36:39], v[48:51], v[124:127], v[36:39]
    ds_read_b64 v[74:75], v4 offset:456
    v_lshlrev_b32 v232, 16, v183
    v_mfma_f32_16x16x32_bf16 v[36:39], v[60:63], v[112:115], v[36:39]
    ds_read_b128 v[156:159], v5 offset:1472
    v_fma_f32 v198, v232, v198, v214
    v_mfma_f32_16x16x32_bf16 v[32:35], v[44:47], v[124:127], v[32:35]
    s_add_u32 m0, s63, 20480
    ds_read_b64 v[92:93], v4 offset:3008
    v_mul_f32 v214, v252, v232
    v_mfma_f32_16x16x32_bf16 v[32:35], v[60:63], v[108:111], v[32:35]
    ds_read_b64 v[94:95], v4 offset:3016
    buffer_load_dwordx4 v172, s[36:39], s15 offen sc1 lds
    v_mfma_f32_16x16x32_bf16 v[28:31], v[40:43], v[124:127], v[28:31]
    ds_read_b128 v[160:163], v5 offset:960
    v_fma_f32 v198, v198, v250, v251
    v_mfma_f32_16x16x32_bf16 v[28:31], v[60:63], v[104:107], v[28:31]
    ds_read_b64 v[96:97], v4 offset:3520
    v_and_b32 v233, 0xffff0000, v183
    v_mfma_f32_16x16x32_bf16 v[36:39], v[44:47], v[128:131], v[36:39]
    s_add_u32 m0, s63, 24576
    ds_read_b64 v[98:99], v4 offset:3528
    v_fma_f32 v199, v233, v199, v215
    v_mfma_f32_16x16x32_bf16 v[36:39], v[64:67], v[108:111], v[36:39]
    ds_read_b128 v[164:167], v5 offset:448
    buffer_load_dwordx4 v172, s[36:39], s18 offen sc1 lds
    v_mfma_f32_16x16x32_bf16 v[32:35], v[40:43], v[128:131], v[32:35]
    ds_read_b64 v[100:101], v4 offset:4032
    v_mul_f32 v215, v252, v233
    v_mfma_f32_16x16x32_bf16 v[32:35], v[64:67], v[104:107], v[32:35]
    s_waitcnt lgkmcnt(13)
    ds_read_b64 v[102:103], v4 offset:4040
    v_fma_f32 v199, v199, v250, v251
    v_mfma_f32_16x16x32_bf16 v[36:39], v[40:43], v[132:135], v[36:39]
    s_add_u32 m0, s63, 28672
    v_mfma_f32_16x16x32_bf16 v[36:39], v[68:71], v[104:107], v[36:39]
    buffer_load_dwordx4 v172, s[36:39], s19 offen sc1 lds
    v_mfma_f32_16x16x32_bf16 v[24:27], v[80:83], v[144:147], v[24:27]
    s_waitcnt vmcnt(8)
    s_waitcnt lgkmcnt(10)
    s_barrier
    ds_read_b64_tr_b16 a[168:169], v227 offset:49664
    v_mfma_f32_16x16x32_bf16 v[28:31], v[80:83], v[148:151], v[28:31]
    ds_read_b64_tr_b16 a[170:171], v227 offset:51200
    v_mfma_f32_16x16x32_bf16 v[28:31], v[84:87], v[144:147], v[28:31]
    s_add_u32 m0, s63, 32768
    ds_read_b64_tr_b16 a[172:173], v227 offset:55888
    v_mfma_f32_16x16x32_bf16 v[32:35], v[84:87], v[148:151], v[32:35]
    ds_read_b64_tr_b16 a[174:175], v227 offset:57424
    buffer_load_dwordx4 v172, s[36:39], s20 offen sc1 lds
    v_mfma_f32_16x16x32_bf16 v[24:27], v[76:79], v[148:151], v[24:27]
    ds_read_b64_tr_b16 a[176:177], v228 offset:49664
    v_mfma_f32_16x16x32_bf16 v[24:27], v[84:87], v[140:143], v[24:27]
    ds_read_b64_tr_b16 a[178:179], v228 offset:51200
    v_mfma_f32_16x16x32_bf16 v[32:35], v[80:83], v[152:155], v[32:35]
    s_add_u32 m0, s63, 36864
    v_mfma_f32_16x16x32_bf16 v[32:35], v[88:91], v[144:147], v[32:35]
    buffer_load_dwordx4 v172, s[36:39], s21 offen sc1 lds
    v_mfma_f32_16x16x32_bf16 v[36:39], v[84:87], v[152:155], v[36:39]
    v_mfma_f32_16x16x32_bf16 v[36:39], v[88:91], v[148:151], v[36:39]
    s_waitcnt lgkmcnt(0)
    s_barrier
    v_mfma_f32_16x16x32_bf16 v[28:31], v[76:79], v[152:155], v[28:31]
    s_add_u32 m0, s63, 40960
    v_mfma_f32_16x16x32_bf16 v[28:31], v[88:91], v[140:143], v[28:31]
    buffer_load_dwordx4 v172, s[36:39], s22 offen sc1 lds
    v_mfma_f32_16x16x32_bf16 v[24:27], v[72:75], v[152:155], v[24:27]
    v_mfma_f32_16x16x32_bf16 v[24:27], v[88:91], v[136:139], v[24:27]
    v_mfma_f32_16x16x32_bf16 v[36:39], v[80:83], v[156:159], v[36:39]
    s_add_u32 m0, s63, 45056
    v_mfma_f32_16x16x32_bf16 v[36:39], v[92:95], v[144:147], v[36:39]
    buffer_load_dwordx4 v172, s[36:39], s23 offen sc1 lds
    v_mfma_f32_16x16x32_bf16 v[32:35], v[76:79], v[156:159], v[32:35]
    v_mfma_f32_16x16x32_bf16 v[32:35], v[92:95], v[140:143], v[32:35]
    v_mfma_f32_16x16x32_bf16 v[28:31], v[72:75], v[156:159], v[28:31]
    s_add_u32 m0, s63, 49152
    v_mfma_f32_16x16x32_bf16 v[28:31], v[92:95], v[136:139], v[28:31]
    buffer_load_dwordx4 v172, s[36:39], s24 offen sc1 lds
    v_mfma_f32_16x16x32_bf16 v[36:39], v[76:79], v[160:163], v[36:39]
    v_mfma_f32_16x16x32_bf16 v[36:39], v[96:99], v[140:143], v[36:39]
    v_mfma_f32_16x16x32_bf16 v[32:35], v[72:75], v[160:163], v[32:35]
    s_add_u32 m0, s63, 53248
    v_mfma_f32_16x16x32_bf16 v[32:35], v[96:99], v[136:139], v[32:35]
    buffer_load_dwordx4 v172, s[36:39], s25 offen sc1 lds
    v_mfma_f32_16x16x32_bf16 v[36:39], v[72:75], v[164:167], v[36:39]
    v_mfma_f32_16x16x32_bf16 v[36:39], v[100:103], v[136:139], v[36:39]
    s_waitcnt vmcnt(11)
    s_waitcnt lgkmcnt(0)
    s_barrier
    ds_read_b64_tr_b16 v[104:105], v168 offset:0
    ds_read_b64_tr_b16 v[106:107], v168 offset:2048
    ds_read_b64_tr_b16 v[108:109], v169 offset:0
    ds_read_b64_tr_b16 v[110:111], v169 offset:2048
    ds_read_b64_tr_b16 v[112:113], v170 offset:0
    ds_read_b64_tr_b16 v[114:115], v170 offset:2048
    ds_read_b64_tr_b16 v[116:117], v171 offset:0
    ds_read_b64_tr_b16 v[118:119], v171 offset:2048
    v_pk_fma_f32 v[184:185], v[184:185], v[24:25], v[200:201]
    v_pk_fma_f32 v[186:187], v[186:187], v[26:27], v[202:203]
    v_cvt_pk_bf16_f32 v232, v184, v185
    v_cvt_pk_bf16_f32 v233, v186, v187
    v_pk_fma_f32 v[188:189], v[188:189], v[28:29], v[204:205]
    v_pk_fma_f32 v[190:191], v[190:191], v[30:31], v[206:207]
    v_cvt_pk_bf16_f32 v234, v188, v189
    v_cvt_pk_bf16_f32 v235, v190, v191
    s_nop 0
    v_permlane16_swap_b32 v232, v234
    v_permlane16_swap_b32 v233, v235
    buffer_store_dwordx4 v[232:235], v231, s[36:39], s68 offen offset:2048 sc1
    v_pk_fma_f32 v[192:193], v[192:193], v[32:33], v[208:209]
    v_pk_fma_f32 v[194:195], v[194:195], v[34:35], v[210:211]
    v_cvt_pk_bf16_f32 v236, v192, v193
    v_cvt_pk_bf16_f32 v237, v194, v195
    v_pk_fma_f32 v[196:197], v[196:197], v[36:37], v[212:213]
    v_pk_fma_f32 v[198:199], v[198:199], v[38:39], v[214:215]
    v_cvt_pk_bf16_f32 v238, v196, v197
    v_cvt_pk_bf16_f32 v239, v198, v199
    s_nop 0
    v_permlane16_swap_b32 v236, v238
    v_permlane16_swap_b32 v237, v239
    buffer_store_dwordx4 v[236:239], v231, s[36:39], s68 offen offset:3072 sc1
    v_mov_b32 v200, v224
    v_mov_b32 v201, v225
    v_mov_b32 v202, v226
    v_add_u32 v203, 101760, v227
    v_add_u32 v204, 101760, v228
    s_waitcnt lgkmcnt(6)
    v_mfma_f32_16x16x32_bf16 v[56:59], a[0:3], v[104:107], 0
    ds_read_b64_tr_b16 v[120:121], v168 offset:4096
    v_mfma_f32_16x16x32_bf16 v[60:63], a[4:7], v[104:107], 0
    ds_read_b64_tr_b16 v[122:123], v168 offset:6144
    v_mfma_f32_16x16x32_bf16 v[64:67], a[8:11], v[104:107], 0
    s_waitcnt lgkmcnt(6)
    s_add_u32 m0, s61, 101760
    ds_read_b64_tr_b16 v[124:125], v169 offset:4096
    v_mfma_f32_16x16x32_bf16 v[68:71], a[0:3], v[108:111], 0
    buffer_load_dwordx4 v200, s[40:43], s64 offen offset:0 lds
    v_mfma_f32_16x16x32_bf16 v[72:75], a[4:7], v[108:111], 0
    ds_read_b64_tr_b16 v[126:127], v169 offset:6144
    v_mfma_f32_16x16x32_bf16 v[76:79], a[8:11], v[108:111], 0
    s_waitcnt lgkmcnt(6)
    ds_read_b64_tr_b16 v[128:129], v170 offset:4096
    v_mfma_f32_16x16x32_bf16 v[80:83], a[0:3], v[112:115], 0
    s_add_u32 m0, s61, 101760
    ds_read_b64_tr_b16 v[130:131], v170 offset:6144
    v_mfma_f32_16x16x32_bf16 v[84:87], a[4:7], v[112:115], 0
    buffer_load_dwordx4 v201, s[40:43], s64 offen offset:1024 lds
    v_mfma_f32_16x16x32_bf16 v[88:91], a[8:11], v[112:115], 0
    s_waitcnt lgkmcnt(6)
    ds_read_b64_tr_b16 v[132:133], v171 offset:4096
    v_mfma_f32_16x16x32_bf16 v[92:95], a[0:3], v[116:119], 0
    s_waitcnt lgkmcnt(3)
    ds_read_b64_tr_b16 v[134:135], v171 offset:6144
    v_mfma_f32_16x16x32_bf16 v[96:99], a[4:7], v[116:119], 0
    v_mfma_f32_16x16x32_bf16 v[100:103], a[8:11], v[116:119], 0
    v_mfma_f32_16x16x32_bf16 v[56:59], a[12:15], v[120:123], v[56:59]
    ds_read_b64_tr_b16 v[104:105], v168 offset:8192
    v_mfma_f32_16x16x32_bf16 v[60:63], a[16:19], v[120:123], v[60:63]
    ds_read_b64_tr_b16 v[106:107], v168 offset:10240
    v_mfma_f32_16x16x32_bf16 v[64:67], a[20:23], v[120:123], v[64:67]
    s_add_u32 m0, s61, 101760
    ds_read_b64_tr_b16 v[108:109], v169 offset:8192
    v_mfma_f32_16x16x32_bf16 v[68:71], a[12:15], v[124:127], v[68:71]
    buffer_load_dwordx4 v202, s[40:43], s64 offen offset:2048 lds
    v_mfma_f32_16x16x32_bf16 v[72:75], a[16:19], v[124:127], v[72:75]
    s_add_u32 s64, s64, 98304
    ds_read_b64_tr_b16 v[110:111], v169 offset:10240
    v_mfma_f32_16x16x32_bf16 v[76:79], a[20:23], v[124:127], v[76:79]
    s_waitcnt lgkmcnt(6)
    s_sub_u32 s35, s64, 1966080
    ds_read_b64_tr_b16 v[112:113], v170 offset:8192
    v_mfma_f32_16x16x32_bf16 v[80:83], a[12:15], v[128:131], v[80:83]
    s_min_u32 s64, s64, s35
    s_add_u32 m0, s63, 57344
    ds_read_b64_tr_b16 v[114:115], v170 offset:10240
    v_mfma_f32_16x16x32_bf16 v[84:87], a[16:19], v[128:131], v[84:87]
    buffer_load_dwordx4 v172, s[36:39], s26 offen sc1 lds
    v_mfma_f32_16x16x32_bf16 v[88:91], a[20:23], v[128:131], v[88:91]
    s_waitcnt lgkmcnt(6)
    ds_read_b64_tr_b16 v[116:117], v171 offset:8192
    v_mfma_f32_16x16x32_bf16 v[92:95], a[12:15], v[132:135], v[92:95]
    s_waitcnt lgkmcnt(3)
    ds_read_b64_tr_b16 v[118:119], v171 offset:10240
    v_mfma_f32_16x16x32_bf16 v[96:99], a[16:19], v[132:135], v[96:99]
    s_add_u32 m0, s63, 61440
    v_mfma_f32_16x16x32_bf16 v[100:103], a[20:23], v[132:135], v[100:103]
    buffer_load_dwordx4 v172, s[36:39], s27 offen sc1 lds
    v_mfma_f32_16x16x32_bf16 v[56:59], a[24:27], v[104:107], v[56:59]
    s_waitcnt vmcnt(13)
    s_barrier
    ds_read_b64_tr_b16 v[120:121], v168 offset:12288
    v_mfma_f32_16x16x32_bf16 v[60:63], a[28:31], v[104:107], v[60:63]
    ds_read_b64_tr_b16 v[122:123], v168 offset:14336
    v_mfma_f32_16x16x32_bf16 v[64:67], a[32:35], v[104:107], v[64:67]
    s_add_u32 m0, s63, 65536
    ds_read_b64_tr_b16 v[124:125], v169 offset:12288
    v_mfma_f32_16x16x32_bf16 v[68:71], a[24:27], v[108:111], v[68:71]
    buffer_load_dwordx4 v172, s[36:39], s44 offen sc1 lds
    v_mfma_f32_16x16x32_bf16 v[72:75], a[28:31], v[108:111], v[72:75]
    ds_read_b64_tr_b16 v[126:127], v169 offset:14336
    v_mfma_f32_16x16x32_bf16 v[76:79], a[32:35], v[108:111], v[76:79]
    s_waitcnt lgkmcnt(6)
    ds_read_b64_tr_b16 v[128:129], v170 offset:12288
    v_mfma_f32_16x16x32_bf16 v[80:83], a[24:27], v[112:115], v[80:83]
    s_add_u32 m0, s63, 69632
    ds_read_b64_tr_b16 v[130:131], v170 offset:14336
    v_mfma_f32_16x16x32_bf16 v[84:87], a[28:31], v[112:115], v[84:87]
    buffer_load_dwordx4 v172, s[36:39], s45 offen sc1 lds
    v_mfma_f32_16x16x32_bf16 v[88:91], a[32:35], v[112:115], v[88:91]
    s_waitcnt lgkmcnt(6)
    ds_read_b64_tr_b16 v[132:133], v171 offset:12288
    v_mfma_f32_16x16x32_bf16 v[92:95], a[24:27], v[116:119], v[92:95]
    s_waitcnt lgkmcnt(3)
    ds_read_b64_tr_b16 v[134:135], v171 offset:14336
    v_mfma_f32_16x16x32_bf16 v[96:99], a[28:31], v[116:119], v[96:99]
    s_add_u32 m0, s63, 73728
    v_mfma_f32_16x16x32_bf16 v[100:103], a[32:35], v[116:119], v[100:103]
    s_waitcnt vmcnt(7)
    s_barrier
    s_cmp_eq_u32 s3, 0
    s_cbranch_scc0 L_wf8
    s_lshl_b32 s54, s70, 7
    s_add_u32 s54, s54, 23266304
    v_mov_b32 v254, 0
    v_mov_b32 v255, s48
    s_mov_b64 exec, 1
    buffer_store_dword v255, v254, s[36:39], s54 offen sc1
    s_mov_b64 exec, -1
L_wf8:
    buffer_load_dwordx4 v172, s[36:39], s46 offen sc1 lds
    v_mfma_f32_16x16x32_bf16 v[56:59], a[36:39], v[120:123], v[56:59]
    ds_read_b64_tr_b16 v[104:105], v168 offset:16384
    v_mfma_f32_16x16x32_bf16 v[60:63], a[40:43], v[120:123], v[60:63]
    ds_read_b64_tr_b16 v[106:107], v168 offset:18432
    v_mfma_f32_16x16x32_bf16 v[64:67], a[44:47], v[120:123], v[64:67]
    s_add_u32 m0, s63, 77824
    ds_read_b64_tr_b16 v[108:109], v169 offset:16384
    v_mfma_f32_16x16x32_bf16 v[68:71], a[36:39], v[124:127], v[68:71]
    buffer_load_dwordx4 v172, s[36:39], s47 offen sc1 lds
    v_mfma_f32_16x16x32_bf16 v[72:75], a[40:43], v[124:127], v[72:75]
    ds_read_b64_tr_b16 v[110:111], v169 offset:18432
    v_add_u32 v172, 2048, v172
    v_mfma_f32_16x16x32_bf16 v[76:79], a[44:47], v[124:127], v[76:79]
    s_waitcnt lgkmcnt(6)
    ds_read_b64_tr_b16 v[112:113], v170 offset:16384
    v_mfma_f32_16x16x32_bf16 v[80:83], a[36:39], v[128:131], v[80:83]
    s_add_u32 m0, s61, 114176
    ds_read_b64_tr_b16 v[114:115], v170 offset:18432
    v_mfma_f32_16x16x32_bf16 v[84:87], a[40:43], v[128:131], v[84:87]
    buffer_load_dwordx4 v200, s[40:43], s64 offen offset:0 lds
    v_mfma_f32_16x16x32_bf16 v[88:91], a[44:47], v[128:131], v[88:91]
    s_waitcnt lgkmcnt(6)
    ds_read_b64_tr_b16 v[116:117], v171 offset:16384
    v_mfma_f32_16x16x32_bf16 v[92:95], a[36:39], v[132:135], v[92:95]
    s_waitcnt lgkmcnt(3)
    ds_read_b64_tr_b16 v[118:119], v171 offset:18432
    v_mfma_f32_16x16x32_bf16 v[96:99], a[40:43], v[132:135], v[96:99]
    v_mfma_f32_16x16x32_bf16 v[100:103], a[44:47], v[132:135], v[100:103]
    v_mfma_f32_16x16x32_bf16 v[56:59], a[48:51], v[104:107], v[56:59]
    ds_read_b64_tr_b16 v[120:121], v168 offset:20480
    v_mfma_f32_16x16x32_bf16 v[60:63], a[52:55], v[104:107], v[60:63]
    ds_read_b64_tr_b16 v[122:123], v168 offset:22528
    v_mfma_f32_16x16x32_bf16 v[64:67], a[56:59], v[104:107], v[64:67]
    s_add_u32 m0, s61, 114176
    ds_read_b64_tr_b16 v[124:125], v169 offset:20480
    v_mfma_f32_16x16x32_bf16 v[68:71], a[48:51], v[108:111], v[68:71]
    buffer_load_dwordx4 v201, s[40:43], s64 offen offset:1024 lds
    v_mfma_f32_16x16x32_bf16 v[72:75], a[52:55], v[108:111], v[72:75]
    ds_read_b64_tr_b16 v[126:127], v169 offset:22528
    v_mfma_f32_16x16x32_bf16 v[76:79], a[56:59], v[108:111], v[76:79]
    s_waitcnt lgkmcnt(6)
    ds_read_b64_tr_b16 v[128:129], v170 offset:20480
    v_mfma_f32_16x16x32_bf16 v[80:83], a[48:51], v[112:115], v[80:83]
    s_add_u32 m0, s61, 114176
    ds_read_b64_tr_b16 v[130:131], v170 offset:22528
    v_min_u32 v243, 11, v1
    v_mfma_f32_16x16x32_bf16 v[84:87], a[52:55], v[112:115], v[84:87]
    buffer_load_dwordx4 v202, s[40:43], s64 offen offset:2048 lds
    v_mfma_f32_16x16x32_bf16 v[88:91], a[56:59], v[112:115], v[88:91]
    s_waitcnt lgkmcnt(6)
    s_add_u32 s64, s64, 98304
    ds_read_b64_tr_b16 v[132:133], v171 offset:20480
    v_lshlrev_b32 v243, 8, v243
    v_mfma_f32_16x16x32_bf16 v[92:95], a[48:51], v[116:119], v[92:95]
    s_waitcnt lgkmcnt(3)
    s_sub_u32 s35, s64, 1966080
    ds_read_b64_tr_b16 v[134:135], v171 offset:22528
    v_mfma_f32_16x16x32_bf16 v[96:99], a[52:55], v[116:119], v[96:99]
    s_min_u32 s64, s64, s35
    v_mfma_f32_16x16x32_bf16 v[100:103], a[56:59], v[116:119], v[100:103]
    v_mfma_f32_16x16x32_bf16 v[56:59], a[60:63], v[120:123], v[56:59]
    s_mul_i32 s58, s3, 24
    s_lshr_b32 s57, s75, 2
    ds_read_b64_tr_b16 v[104:105], v168 offset:24576
    v_mfma_f32_16x16x32_bf16 v[60:63], a[64:67], v[120:123], v[60:63]
    s_add_u32 s58, s58, s57
    s_lshl_b32 s58, s58, 7
    ds_read_b64_tr_b16 v[106:107], v168 offset:26624
    v_mfma_f32_16x16x32_bf16 v[64:67], a[68:71], v[120:123], v[64:67]
    s_add_u32 s58, s58, 23233536
    ds_read_b64_tr_b16 v[108:109], v169 offset:24576
    v_mfma_f32_16x16x32_bf16 v[68:71], a[60:63], v[124:127], v[68:71]
    buffer_load_dword v244, v243, s[36:39], s58 offen sc1
    v_mfma_f32_16x16x32_bf16 v[72:75], a[64:67], v[124:127], v[72:75]
    ds_read_b64_tr_b16 v[110:111], v169 offset:26624
    v_mfma_f32_16x16x32_bf16 v[76:79], a[68:71], v[124:127], v[76:79]
    s_waitcnt lgkmcnt(6)
    ds_read_b64_tr_b16 v[112:113], v170 offset:24576
    v_mfma_f32_16x16x32_bf16 v[80:83], a[60:63], v[128:131], v[80:83]
    s_add_u32 m0, s61, 126592
    ds_read_b64_tr_b16 v[114:115], v170 offset:26624
    v_mfma_f32_16x16x32_bf16 v[84:87], a[64:67], v[128:131], v[84:87]
    buffer_load_dwordx4 v200, s[40:43], s64 offen offset:0 lds
    v_mfma_f32_16x16x32_bf16 v[88:91], a[68:71], v[128:131], v[88:91]
    s_waitcnt lgkmcnt(6)
    ds_read_b64_tr_b16 v[116:117], v171 offset:24576
    v_mfma_f32_16x16x32_bf16 v[92:95], a[60:63], v[132:135], v[92:95]
    s_waitcnt lgkmcnt(3)
    ds_read_b64_tr_b16 v[118:119], v171 offset:26624
    v_mfma_f32_16x16x32_bf16 v[96:99], a[64:67], v[132:135], v[96:99]
    s_add_u32 m0, s61, 126592
    v_mfma_f32_16x16x32_bf16 v[100:103], a[68:71], v[132:135], v[100:103]
    buffer_load_dwordx4 v201, s[40:43], s64 offen offset:1024 lds
    v_mfma_f32_16x16x32_bf16 v[56:59], a[72:75], v[104:107], v[56:59]
    ds_read_b64_tr_b16 v[120:121], v168 offset:28672
    v_mfma_f32_16x16x32_bf16 v[60:63], a[76:79], v[104:107], v[60:63]
    ds_read_b64_tr_b16 v[122:123], v168 offset:30720
    v_mfma_f32_16x16x32_bf16 v[64:67], a[80:83], v[104:107], v[64:67]
    s_add_u32 m0, s61, 126592
    ds_read_b64_tr_b16 v[124:125], v169 offset:28672
    v_mfma_f32_16x16x32_bf16 v[68:71], a[72:75], v[108:111], v[68:71]
    buffer_load_dwordx4 v202, s[40:43], s64 offen offset:2048 lds
    v_mfma_f32_16x16x32_bf16 v[72:75], a[76:79], v[108:111], v[72:75]
    s_add_u32 s64, s64, 98304
    ds_read_b64_tr_b16 v[126:127], v169 offset:30720
    v_mfma_f32_16x16x32_bf16 v[76:79], a[80:83], v[108:111], v[76:79]
    s_waitcnt lgkmcnt(6)
    s_sub_u32 s35, s64, 1966080
    ds_read_b64_tr_b16 v[128:129], v170 offset:28672
    v_mfma_f32_16x16x32_bf16 v[80:83], a[72:75], v[112:115], v[80:83]
    s_min_u32 s64, s64, s35
    ds_read_b64_tr_b16 v[130:131], v170 offset:30720
    v_mfma_f32_16x16x32_bf16 v[84:87], a[76:79], v[112:115], v[84:87]
    v_mfma_f32_16x16x32_bf16 v[88:91], a[80:83], v[112:115], v[88:91]
    s_waitcnt lgkmcnt(6)
    ds_read_b64_tr_b16 v[132:133], v171 offset:28672
    v_mfma_f32_16x16x32_bf16 v[92:95], a[72:75], v[116:119], v[92:95]
    s_waitcnt lgkmcnt(3)
    ds_read_b64_tr_b16 v[134:135], v171 offset:30720
    v_mfma_f32_16x16x32_bf16 v[96:99], a[76:79], v[116:119], v[96:99]
    s_add_u32 m0, s61, 139008
    v_mfma_f32_16x16x32_bf16 v[100:103], a[80:83], v[116:119], v[100:103]
    buffer_load_dwordx4 v200, s[40:43], s64 offen offset:0 lds
    v_mfma_f32_16x16x32_bf16 v[56:59], a[84:87], v[120:123], v[56:59]
    s_waitcnt vmcnt(8)
    s_barrier
    ds_read_b64_tr_b16 v[104:105], v168 offset:32768
    v_mfma_f32_16x16x32_bf16 v[60:63], a[88:91], v[120:123], v[60:63]
    ds_read_b64_tr_b16 v[106:107], v168 offset:34816
    ds_read_b64 v[224:225], v216
    v_mfma_f32_16x16x32_bf16 v[64:67], a[92:95], v[120:123], v[64:67]
    s_add_u32 m0, s61, 139008
    ds_read_b64_tr_b16 v[108:109], v169 offset:32768
    ds_read_b64 v[226:227], v217
    v_mfma_f32_16x16x32_bf16 v[68:71], a[84:87], v[124:127], v[68:71]
    buffer_load_dwordx4 v201, s[40:43], s64 offen offset:1024 lds
    v_mfma_f32_16x16x32_bf16 v[72:75], a[88:91], v[124:127], v[72:75]
    ds_read_b64_tr_b16 v[110:111], v169 offset:34816
    ds_read_b64 v[228:229], v218
    v_mfma_f32_16x16x32_bf16 v[76:79], a[92:95], v[124:127], v[76:79]
    s_waitcnt lgkmcnt(9)
    ds_read_b64_tr_b16 v[112:113], v170 offset:32768
    v_mfma_f32_16x16x32_bf16 v[80:83], a[84:87], v[128:131], v[80:83]
    ds_read_b64_tr_b16 v[114:115], v170 offset:34816
    v_lshrrev_b32 v238, 1, v1
    v_mfma_f32_16x16x32_bf16 v[84:87], a[88:91], v[128:131], v[84:87]
    s_barrier
    ds_read_b64_tr_b16 a[180:181], v203 offset:0
    v_mfma_f32_16x16x32_bf16 v[88:91], a[92:95], v[128:131], v[88:91]
    s_waitcnt lgkmcnt(10)
    ds_read_b64_tr_b16 v[116:117], v171 offset:32768
    v_lshlrev_b32 v238, 10, v238
    v_mfma_f32_16x16x32_bf16 v[92:95], a[84:87], v[132:135], v[92:95]
    s_waitcnt lgkmcnt(3)
    ds_read_b64_tr_b16 v[118:119], v171 offset:34816
    v_and_b32 v239, 1, v1
    v_mfma_f32_16x16x32_bf16 v[96:99], a[88:91], v[132:135], v[96:99]
    s_add_u32 m0, s61, 139008
    ds_read_b64_tr_b16 a[182:183], v203 offset:1536
    v_lshlrev_b32 v230, 16, v224
    v_and_b32 v231, 0xffff0000, v224
    v_pk_mul_f32 v[230:231], v[230:231], v[220:221] op_sel_hi:[1,0]
    v_pk_mul_f32 v[234:235], v[230:231], v[230:231]
    v_lshlrev_b32 v232, 16, v225
    v_and_b32 v233, 0xffff0000, v225
    v_pk_mul_f32 v[232:233], v[232:233], v[220:221] op_sel_hi:[1,0]
    v_pk_mul_f32 v[236:237], v[232:233], v[232:233]
    v_lshlrev_b32 v2, 16, v226
    v_and_b32 v3, 0xffff0000, v226
    v_pk_mul_f32 v[2:3], v[2:3], v[220:221] op_sel:[0,1] op_sel_hi:[1,1]
    v_pk_add_f32 v[230:231], v[230:231], v[2:3]
    v_pk_fma_f32 v[234:235], v[2:3], v[2:3], v[234:235]
    v_lshlrev_b32 v2, 16, v227
    v_and_b32 v3, 0xffff0000, v227
    v_pk_mul_f32 v[2:3], v[2:3], v[220:221] op_sel:[0,1] op_sel_hi:[1,1]
    v_pk_add_f32 v[232:233], v[232:233], v[2:3]
    v_pk_fma_f32 v[236:237], v[2:3], v[2:3], v[236:237]
    v_lshlrev_b32 v2, 16, v228
    v_and_b32 v3, 0xffff0000, v228
    v_pk_mul_f32 v[2:3], v[2:3], v[222:223] op_sel_hi:[1,0]
    v_pk_add_f32 v[230:231], v[230:231], v[2:3]
    v_pk_fma_f32 v[234:235], v[2:3], v[2:3], v[234:235]
    v_lshlrev_b32 v2, 16, v229
    v_and_b32 v3, 0xffff0000, v229
    v_pk_mul_f32 v[2:3], v[2:3], v[222:223] op_sel_hi:[1,0]
    v_pk_add_f32 v[232:233], v[232:233], v[2:3]
    v_pk_fma_f32 v[236:237], v[2:3], v[2:3], v[236:237]
    v_mfma_f32_16x16x32_bf16 v[100:103], a[92:95], v[132:135], v[100:103]
    ds_read_b64_tr_b16 a[184:185], v203 offset:6224
    buffer_load_dwordx4 v202, s[40:43], s64 offen offset:2048 lds
    v_mfma_f32_16x16x32_bf16 v[56:59], a[96:99], v[104:107], v[56:59]
    s_add_u32 s64, s64, 98304
    ds_read_b64_tr_b16 v[120:121], v168 offset:36864
    ds_read_b64_tr_b16 a[186:187], v203 offset:7760
    v_lshl_add_u32 v219, v239, 7, v238
    v_permlane32_swap_b32 v230, v234
    v_permlane32_swap_b32 v231, v235
    v_mfma_f32_16x16x32_bf16 v[60:63], a[100:103], v[104:107], v[60:63]
    s_lshl_b32 s55, s3, 8
    s_add_u32 s55, s55, 66560
    ds_read_b64_tr_b16 v[122:123], v168 offset:38912
    v_mfma_f32_16x16x32_bf16 v[64:67], a[104:107], v[104:107], v[64:67]
    s_sub_u32 s35, s64, 1966080
    ds_read_b64_tr_b16 v[124:125], v169 offset:36864
    v_add_u32 v219, s55, v219
    v_mfma_f32_16x16x32_bf16 v[68:71], a[96:99], v[108:111], v[68:71]
    s_min_u32 s64, s64, s35
    ds_read_b64_tr_b16 a[188:189], v204 offset:0
    v_permlane32_swap_b32 v232, v236
    v_mfma_f32_16x16x32_bf16 v[72:75], a[100:103], v[108:111], v[72:75]
    s_lshl_b32 s55, s73, 7
    s_add_u32 s55, s55, 87040
    ds_read_b64_tr_b16 v[126:127], v169 offset:38912
    ds_read_b64_tr_b16 a[190:191], v204 offset:1536
    v_permlane32_swap_b32 v233, v237
    v_add_f32 v230, v230, v234
    v_mfma_f32_16x16x32_bf16 v[76:79], a[104:107], v[108:111], v[76:79]
    s_waitcnt lgkmcnt(12)
    ds_read_b64_tr_b16 v[128:129], v170 offset:36864
    v_mov_b32 v238, s55
    v_mfma_f32_16x16x32_bf16 v[80:83], a[96:99], v[112:115], v[80:83]
    s_add_u32 m0, s61, 151424
    ds_read_b64_tr_b16 v[130:131], v170 offset:38912
    v_add_f32 v231, v231, v235
    v_mfma_f32_16x16x32_bf16 v[84:87], a[100:103], v[112:115], v[84:87]
    v_cmp_lt_u32 vcc, 39, v1
    s_nop 1
    v_cndmask_b32 v219, v219, v238, vcc
    buffer_load_dwordx4 v200, s[40:43], s64 offen offset:0 lds
    v_mfma_f32_16x16x32_bf16 v[88:91], a[104:107], v[112:115], v[88:91]
    s_waitcnt lgkmcnt(11)
    s_mov_b32 s17, 23199744
    ds_read_b64_tr_b16 v[132:133], v171 offset:36864
    v_add_f32 v232, v232, v236
    v_mfma_f32_16x16x32_bf16 v[92:95], a[96:99], v[116:119], v[92:95]
    s_waitcnt lgkmcnt(3)
    ds_read_b64_tr_b16 v[134:135], v171 offset:38912
    v_add_f32 v233, v233, v237
    v_mfma_f32_16x16x32_bf16 v[96:99], a[100:103], v[116:119], v[96:99]
    s_add_u32 m0, s61, 151424
    v_permlane16_swap_b32 v230, v232
    v_permlane16_swap_b32 v231, v233
    v_mfma_f32_16x16x32_bf16 v[100:103], a[104:107], v[116:119], v[100:103]
    buffer_load_dwordx4 v201, s[40:43], s64 offen offset:1024 lds
    v_mfma_f32_16x16x32_bf16 v[56:59], a[108:111], v[120:123], v[56:59]
    s_waitcnt vmcnt(9)
    s_barrier
    ds_read_b64_tr_b16 v[104:105], v168 offset:40960
    v_add_f32 v230, v230, v232
    v_add_f32 v231, v231, v233
    v_mfma_f32_16x16x32_bf16 v[60:63], a[112:115], v[120:123], v[60:63]
    ds_read_b64_tr_b16 v[106:107], v168 offset:43008
    ds_read_b64_tr_b16 a[192:193], v203 offset:12416
    v_mfma_f32_16x16x32_bf16 v[64:67], a[116:119], v[120:123], v[64:67]
    ds_read_b64_tr_b16 v[108:109], v169 offset:40960
    s_waitcnt vmcnt(8)
    v_cmp_ne_u32 vcc, s48, v244
    s_cbranch_vccnz L_chk9_slow
L_chk9_back:
    v_mfma_f32_16x16x32_bf16 v[68:71], a[108:111], v[124:127], v[68:71]
    ds_read_b64_tr_b16 a[194:195], v203 offset:13952
    v_lshrrev_b32 v2, 4, v1
    v_mfma_f32_16x16x32_bf16 v[72:75], a[112:115], v[124:127], v[72:75]
    ds_read_b64_tr_b16 v[110:111], v169 offset:43008
    ds_read_b64_tr_b16 a[196:197], v203 offset:18640
    v_lshlrev_b32 v2, 3, v2
    v_mfma_f32_16x16x32_bf16 v[76:79], a[116:119], v[124:127], v[76:79]
    s_lshl_b32 s50, s3, 5
    s_add_u32 s50, s50, 0
    ds_read_b64_tr_b16 v[112:113], v170 offset:40960
    ds_read_b64_tr_b16 a[198:199], v203 offset:20176
    s_waitcnt lgkmcnt(11)
    v_mfma_f32_16x16x32_bf16 v[80:83], a[108:111], v[128:131], v[80:83]
    s_add_u32 m0, s61, 151424
    ds_read_b64_tr_b16 v[114:115], v170 offset:43008
    v_add_u32 v2, s50, v2
    v_mfma_f32_16x16x32_bf16 v[84:87], a[112:115], v[128:131], v[84:87]
    ds_read_b64_tr_b16 a[200:201], v204 offset:12416
    buffer_load_dwordx4 v202, s[40:43], s64 offen offset:2048 lds
    v_mfma_f32_16x16x32_bf16 v[88:91], a[116:119], v[128:131], v[88:91]
    s_add_u32 s64, s64, 98304
    ds_read_b64_tr_b16 v[116:117], v171 offset:40960
    v_add_f32_dpp v230, v230, v230 row_ror:8 row_mask:0xf bank_mask:0xf
    v_add_f32_dpp v231, v231, v231 row_ror:8 row_mask:0xf bank_mask:0xf
    s_waitcnt lgkmcnt(12)
    v_mfma_f32_16x16x32_bf16 v[92:95], a[108:111], v[132:135], v[92:95]
    s_waitcnt lgkmcnt(3)
    s_sub_u32 s35, s64, 1966080
    ds_read_b64_tr_b16 v[118:119], v171 offset:43008
    v_mfma_f32_16x16x32_bf16 v[96:99], a[112:115], v[132:135], v[96:99]
    s_min_u32 s64, s64, s35
    ds_read_b64_tr_b16 a[202:203], v204 offset:13952
    v_add_f32_dpp v230, v230, v230 row_ror:4 row_mask:0xf bank_mask:0xf
    v_mfma_f32_16x16x32_bf16 v[100:103], a[116:119], v[132:135], v[100:103]
    buffer_load_dwordx4 a[240:243], v248, s[36:39], s62 offen offset:0 sc1
    v_mfma_f32_16x16x32_bf16 v[56:59], a[120:123], v[104:107], v[56:59]
    ds_read_b64_tr_b16 v[120:121], v168 offset:45056
    v_add_f32_dpp v231, v231, v231 row_ror:4 row_mask:0xf bank_mask:0xf
    v_mfma_f32_16x16x32_bf16 v[60:63], a[124:127], v[104:107], v[60:63]
    ds_read_b64_tr_b16 v[122:123], v168 offset:47104
    v_add_f32_dpp v230, v230, v230 row_ror:2 row_mask:0xf bank_mask:0xf
    v_mfma_f32_16x16x32_bf16 v[64:67], a[128:131], v[104:107], v[64:67]
    ds_read_b64_tr_b16 v[124:125], v169 offset:45056
    v_add_f32_dpp v231, v231, v231 row_ror:2 row_mask:0xf bank_mask:0xf
    v_mfma_f32_16x16x32_bf16 v[68:71], a[120:123], v[108:111], v[68:71]
    buffer_load_dword v240, v219, s[36:39], s17 offen sc1
    v_mfma_f32_16x16x32_bf16 v[72:75], a[124:127], v[108:111], v[72:75]
    ds_read_b64_tr_b16 v[126:127], v169 offset:47104
    v_add_f32_dpp v230, v230, v230 row_ror:1 row_mask:0xf bank_mask:0xf
    v_mfma_f32_16x16x32_bf16 v[76:79], a[128:131], v[108:111], v[76:79]
    ds_read_b64_tr_b16 v[128:129], v170 offset:45056
    v_add_f32_dpp v231, v231, v231 row_ror:1 row_mask:0xf bank_mask:0xf
    s_mov_b32 exec_lo, 0x00010001
    s_mov_b32 exec_hi, 0x00010001
    ds_write_b64 v2, v[230:231]
    s_mov_b64 exec, -1
    v_lshlrev_b32 v2, 2, v1
    s_waitcnt lgkmcnt(10)
    v_mfma_f32_16x16x32_bf16 v[80:83], a[120:123], v[112:115], v[80:83]
    s_waitcnt vmcnt(8)
    s_waitcnt lgkmcnt(6)
    s_barrier
    ds_read_b64_tr_b16 v[130:131], v170 offset:47104
    v_mfma_f32_16x16x32_bf16 v[84:87], a[124:127], v[112:115], v[84:87]
    ds_read_b64_tr_b16 a[204:205], v203 offset:24832
    buffer_load_dwordx4 a[244:247], v248, s[36:39], s62 offen offset:1024 sc1
    v_mfma_f32_16x16x32_bf16 v[88:91], a[128:131], v[112:115], v[88:91]
    ds_read_b64_tr_b16 v[132:133], v171 offset:45056
    ds_read_b64_tr_b16 a[206:207], v203 offset:26368
    v_mfma_f32_16x16x32_bf16 v[92:95], a[120:123], v[116:119], v[92:95]
    s_waitcnt lgkmcnt(3)
    ds_read_b64_tr_b16 v[134:135], v171 offset:47104
    v_and_b32 v2, 12, v2
    v_mfma_f32_16x16x32_bf16 v[96:99], a[124:127], v[116:119], v[96:99]
    ds_read_b64_tr_b16 a[208:209], v203 offset:31056
    v_add_u32 v2, 0, v2
    v_mfma_f32_16x16x32_bf16 v[100:103], a[128:131], v[116:119], v[100:103]
    s_waitcnt lgkmcnt(0)
    s_barrier
    ds_read_b64_tr_b16 a[210:211], v203 offset:32592
    buffer_load_dwordx4 a[248:251], v248, s[36:39], s62 offen offset:2048 sc1
    v_mfma_f32_16x16x32_bf16 v[56:59], a[132:135], v[120:123], v[56:59]
    ds_read_b64_tr_b16 v[104:105], v168 offset:49152
    ds_read_b64_tr_b16 a[212:213], v204 offset:24832
    ds_read2_b32 v[230:231], v2 offset0:0 offset1:4
    v_mfma_f32_16x16x32_bf16 v[60:63], a[136:139], v[120:123], v[60:63]
    ds_read_b64_tr_b16 v[106:107], v168 offset:51200
    ds_read2_b32 v[232:233], v2 offset0:8 offset1:12
    v_mfma_f32_16x16x32_bf16 v[64:67], a[140:143], v[120:123], v[64:67]
    ds_read_b64_tr_b16 v[108:109], v169 offset:49152
    ds_read2_b32 v[234:235], v2 offset0:16 offset1:20
    v_mfma_f32_16x16x32_bf16 v[68:71], a[132:135], v[124:127], v[68:71]
    ds_read_b64_tr_b16 a[214:215], v204 offset:26368
    buffer_load_dwordx4 a[252:255], v248, s[36:39], s62 offen offset:3072 sc1
    v_mfma_f32_16x16x32_bf16 v[72:75], a[136:139], v[124:127], v[72:75]
    ds_read_b64_tr_b16 v[110:111], v169 offset:51200
    ds_read2_b32 v[236:237], v2 offset0:24 offset1:28
    v_mfma_f32_16x16x32_bf16 v[76:79], a[140:143], v[124:127], v[76:79]
    ds_read_b64_tr_b16 v[112:113], v170 offset:49152
    v_mov_b32 v225, s48
    v_mfma_f32_16x16x32_bf16 v[80:83], a[132:135], v[128:131], v[80:83]
    s_add_u32 s62, s62, 4096
    ds_read_b64_tr_b16 v[114:115], v170 offset:51200
    v_mov_b32 v227, s48
    v_mfma_f32_16x16x32_bf16 v[84:87], a[136:139], v[128:131], v[84:87]
    buffer_load_dwordx4 v[136:139], v248, s[36:39], s62 offen offset:0 sc1
    v_mfma_f32_16x16x32_bf16 v[88:91], a[140:143], v[128:131], v[88:91]
    ds_read_b64_tr_b16 v[116:117], v171 offset:49152
    s_waitcnt lgkmcnt(8)
    v_add_f32 v230, v230, v232
    v_mfma_f32_16x16x32_bf16 v[92:95], a[132:135], v[132:135], v[92:95]
    s_waitcnt lgkmcnt(3)
    ds_read_b64_tr_b16 v[118:119], v171 offset:51200
    v_add_f32 v231, v231, v233
    v_mfma_f32_16x16x32_bf16 v[96:99], a[136:139], v[132:135], v[96:99]
    v_add_f32 v234, v234, v236
    v_add_f32 v235, v235, v237
    v_mfma_f32_16x16x32_bf16 v[100:103], a[140:143], v[132:135], v[100:103]
    buffer_load_dwordx4 v[140:143], v248, s[36:39], s62 offen offset:1024 sc1
    v_mfma_f32_16x16x32_bf16 v[56:59], a[144:147], v[104:107], v[56:59]
    s_waitcnt vmcnt(10)
    s_barrier
    ds_read_b64_tr_b16 v[120:121], v168 offset:53248
    v_add_f32 v230, v230, v234
    v_mfma_f32_16x16x32_bf16 v[60:63], a[148:151], v[104:107], v[60:63]
    ds_read_b64_tr_b16 v[122:123], v168 offset:55296
    ds_read_b64_tr_b16 a[216:217], v203 offset:37248
    v_mfma_f32_16x16x32_bf16 v[64:67], a[152:155], v[104:107], v[64:67]
    ds_read_b64_tr_b16 v[124:125], v169 offset:53248
    v_add_f32 v231, v231, v235
    v_mul_f32 v230, 0x3acccccd, v230
    v_mul_f32 v234, v230, v230
    v_mfma_f32_16x16x32_bf16 v[68:71], a[144:147], v[108:111], v[68:71]
    ds_read_b64_tr_b16 a[218:219], v203 offset:38784
    buffer_load_dwordx4 v[144:147], v248, s[36:39], s62 offen offset:2048 sc1
    v_mfma_f32_16x16x32_bf16 v[72:75], a[148:151], v[108:111], v[72:75]
    ds_read_b64_tr_b16 v[126:127], v169 offset:55296
    ds_read_b64_tr_b16 a[220:221], v203 offset:43472
    v_mfma_f32_16x16x32_bf16 v[76:79], a[152:155], v[108:111], v[76:79]
    s_waitcnt lgkmcnt(9)
    ds_read_b64_tr_b16 v[128:129], v170 offset:53248
    ds_read_b64_tr_b16 a[222:223], v203 offset:45008
    v_mfma_f32_16x16x32_bf16 v[80:83], a[144:147], v[112:115], v[80:83]
    ds_read_b64_tr_b16 v[130:131], v170 offset:55296
    v_mov_b32 v224, 0x3acccccd
    v_fma_f32 v231, v231, v224, -v234
    v_max_f32 v231, 0, v231
    v_mfma_f32_16x16x32_bf16 v[84:87], a[148:151], v[112:115], v[84:87]
    ds_read_b64_tr_b16 a[224:225], v204 offset:37248
    buffer_load_dwordx4 v[148:151], v248, s[36:39], s62 offen offset:3072 sc1
    v_mfma_f32_16x16x32_bf16 v[88:91], a[152:155], v[112:115], v[88:91]
    s_waitcnt lgkmcnt(11)
    ds_read_b64_tr_b16 v[132:133], v171 offset:53248
    v_min_u32 v247, 23, v1
    v_mfma_f32_16x16x32_bf16 v[92:95], a[144:147], v[116:119], v[92:95]
    s_waitcnt lgkmcnt(3)
    ds_read_b64_tr_b16 v[134:135], v171 offset:55296
    v_lshlrev_b32 v247, 4, v247
    v_mfma_f32_16x16x32_bf16 v[96:99], a[148:151], v[116:119], v[96:99]
    s_add_u32 s62, s62, 4096
    ds_read_b64_tr_b16 a[226:227], v204 offset:38784
    v_add_f32 v231, 0x3727c5ac, v231
    v_rsq_f32 v224, v231
    v_mfma_f32_16x16x32_bf16 v[100:103], a[152:155], v[116:119], v[100:103]
    buffer_load_dwordx4 v[152:155], v248, s[36:39], s62 offen offset:0 sc1
    v_mfma_f32_16x16x32_bf16 v[56:59], a[156:159], v[120:123], v[56:59]
    ds_read_b64_tr_b16 v[104:105], v168 offset:57344
    v_mul_f32_e64 v226, -v230, v224
    v_mfma_f32_16x16x32_bf16 v[60:63], a[160:163], v[120:123], v[60:63]
    ds_read_b64_tr_b16 v[106:107], v168 offset:59392
    s_mov_b64 exec, 0xf
    buffer_store_dwordx4 v[224:227], v248, s[36:39], s7 offen sc1
    s_mov_b64 exec, -1
    v_mfma_f32_16x16x32_bf16 v[64:67], a[164:167], v[120:123], v[64:67]
    ds_read_b64_tr_b16 v[108:109], v169 offset:57344
    v_mfma_f32_16x16x32_bf16 v[68:71], a[156:159], v[124:127], v[68:71]
    buffer_load_dwordx4 v[156:159], v248, s[36:39], s62 offen offset:1024 sc1
    v_mfma_f32_16x16x32_bf16 v[72:75], a[160:163], v[124:127], v[72:75]
    ds_read_b64_tr_b16 v[110:111], v169 offset:59392
    s_waitcnt vmcnt(9)
    v_cmp_ne_u32 vcc, s48, v240
    s_cbranch_vccnz L_chk10_slow
L_chk10_back:
    v_mfma_f32_16x16x32_bf16 v[76:79], a[164:167], v[124:127], v[76:79]
    s_waitcnt lgkmcnt(8)
    ds_read_b64_tr_b16 v[112:113], v170 offset:57344
    v_mfma_f32_16x16x32_bf16 v[80:83], a[156:159], v[128:131], v[80:83]
    s_waitcnt lgkmcnt(5)
    s_barrier
    s_add_u32 m0, s63, 81920
    ds_read_b64_tr_b16 v[114:115], v170 offset:59392
    v_mfma_f32_16x16x32_bf16 v[84:87], a[160:163], v[128:131], v[84:87]
    ds_read_b64_tr_b16 a[228:229], v203 offset:49664
    buffer_load_dwordx4 v172, s[36:39], s10 offen sc1 lds
    v_mfma_f32_16x16x32_bf16 v[88:91], a[164:167], v[128:131], v[88:91]
    ds_read_b64_tr_b16 v[116:117], v171 offset:57344
    ds_read_b64_tr_b16 a[230:231], v203 offset:51200
    v_mfma_f32_16x16x32_bf16 v[92:95], a[156:159], v[132:135], v[92:95]
    s_waitcnt lgkmcnt(3)
    s_add_u32 m0, s63, 5120
    ds_read_b64_tr_b16 v[118:119], v171 offset:59392
    v_mfma_f32_16x16x32_bf16 v[96:99], a[160:163], v[132:135], v[96:99]
    buffer_load_dwordx4 v247, s[36:39], s9 offen sc1 lds
    v_mfma_f32_16x16x32_bf16 v[100:103], a[164:167], v[132:135], v[100:103]
    s_add_u32 m0, s63, 86016
    ds_read_b64_tr_b16 a[232:233], v203 offset:55888
    v_mfma_f32_16x16x32_bf16 v[56:59], a[168:171], v[104:107], v[56:59]
    ds_read_b64_tr_b16 v[120:121], v168 offset:61440
    ds_read_b64_tr_b16 a[234:235], v203 offset:57424
    buffer_load_dwordx4 v172, s[36:39], s11 offen sc1 lds
    v_mfma_f32_16x16x32_bf16 v[60:63], a[172:175], v[104:107], v[60:63]
    ds_read_b64_tr_b16 v[122:123], v168 offset:63488
    v_add_u32 v168, 65536, v168
    v_mfma_f32_16x16x32_bf16 v[64:67], a[176:179], v[104:107], v[64:67]
    s_add_u32 m0, s63, 90112
    ds_read_b64_tr_b16 v[124:125], v169 offset:61440
    ds_read_b64_tr_b16 a[236:237], v204 offset:49664
    v_mfma_f32_16x16x32_bf16 v[68:71], a[168:171], v[108:111], v[68:71]
    ds_read_b64_tr_b16 a[238:239], v204 offset:51200
    buffer_load_dwordx4 v172, s[36:39], s12 offen sc1 lds
    v_mfma_f32_16x16x32_bf16 v[72:75], a[172:175], v[108:111], v[72:75]
    ds_read_b64_tr_b16 v[126:127], v169 offset:63488
    v_add_u32 v169, 65536, v169
    v_mfma_f32_16x16x32_bf16 v[76:79], a[176:179], v[108:111], v[76:79]
    ds_read_b64_tr_b16 v[128:129], v170 offset:61440
    v_mfma_f32_16x16x32_bf16 v[80:83], a[168:171], v[112:115], v[80:83]
    s_add_u32 m0, s63, 94208
    ds_read_b64_tr_b16 v[130:131], v170 offset:63488
    v_add_u32 v170, 65536, v170
    v_mfma_f32_16x16x32_bf16 v[84:87], a[172:175], v[112:115], v[84:87]
    buffer_load_dwordx4 v172, s[36:39], s13 offen sc1 lds
    v_mfma_f32_16x16x32_bf16 v[88:91], a[176:179], v[112:115], v[88:91]
    s_waitcnt lgkmcnt(10)
    ds_read_b64_tr_b16 v[132:133], v171 offset:61440
    v_mfma_f32_16x16x32_bf16 v[92:95], a[168:171], v[116:119], v[92:95]
    s_waitcnt lgkmcnt(3)
    ds_read_b64_tr_b16 v[134:135], v171 offset:63488
    v_add_u32 v171, 65536, v171
    v_mfma_f32_16x16x32_bf16 v[96:99], a[172:175], v[116:119], v[96:99]
    s_add_u32 m0, s63, 98304
    v_mfma_f32_16x16x32_bf16 v[100:103], a[176:179], v[116:119], v[100:103]
    buffer_load_dwordx4 v172, s[36:39], s14 offen sc1 lds
    v_mfma_f32_16x16x32_bf16 v[56:59], a[180:183], v[120:123], v[56:59]
    s_barrier
    ds_read_b64_tr_b16 v[104:105], v168 offset:0
    v_mfma_f32_16x16x32_bf16 v[60:63], a[184:187], v[120:123], v[60:63]
    ds_read_b64_tr_b16 v[106:107], v168 offset:2048
    v_mfma_f32_16x16x32_bf16 v[64:67], a[188:191], v[120:123], v[64:67]
    s_add_u32 m0, s63, 102400
    ds_read_b64_tr_b16 v[108:109], v169 offset:0
    v_mfma_f32_16x16x32_bf16 v[68:71], a[180:183], v[124:127], v[68:71]
    buffer_load_dwordx4 v172, s[36:39], s15 offen sc1 lds
    v_mfma_f32_16x16x32_bf16 v[72:75], a[184:187], v[124:127], v[72:75]
    ds_read_b64_tr_b16 v[110:111], v169 offset:2048
    v_mfma_f32_16x16x32_bf16 v[76:79], a[188:191], v[124:127], v[76:79]
    s_waitcnt lgkmcnt(6)
    ds_read_b64_tr_b16 v[112:113], v170 offset:0
    v_mfma_f32_16x16x32_bf16 v[80:83], a[180:183], v[128:131], v[80:83]
    s_add_u32 m0, s63, 106496
    ds_read_b64_tr_b16 v[114:115], v170 offset:2048
    v_mfma_f32_16x16x32_bf16 v[84:87], a[184:187], v[128:131], v[84:87]
    buffer_load_dwordx4 v172, s[36:39], s18 offen sc1 lds
    v_mfma_f32_16x16x32_bf16 v[88:91], a[188:191], v[128:131], v[88:91]
    s_waitcnt lgkmcnt(6)
    ds_read_b64_tr_b16 v[116:117], v171 offset:0
    v_mfma_f32_16x16x32_bf16 v[92:95], a[180:183], v[132:135], v[92:95]
    s_waitcnt lgkmcnt(3)
    ds_read_b64_tr_b16 v[118:119], v171 offset:2048
    v_mfma_f32_16x16x32_bf16 v[96:99], a[184:187], v[132:135], v[96:99]
    s_add_u32 m0, s63, 110592
    v_mfma_f32_16x16x32_bf16 v[100:103], a[188:191], v[132:135], v[100:103]
    buffer_load_dwordx4 v172, s[36:39], s19 offen sc1 lds
    v_mfma_f32_16x16x32_bf16 v[56:59], a[192:195], v[104:107], v[56:59]
    ds_read_b64_tr_b16 v[120:121], v168 offset:4096
    v_mfma_f32_16x16x32_bf16 v[60:63], a[196:199], v[104:107], v[60:63]
    ds_read_b64_tr_b16 v[122:123], v168 offset:6144
    v_mfma_f32_16x16x32_bf16 v[64:67], a[200:203], v[104:107], v[64:67]
    s_add_u32 m0, s63, 114688
    ds_read_b64_tr_b16 v[124:125], v169 offset:4096
    v_mfma_f32_16x16x32_bf16 v[68:71], a[192:195], v[108:111], v[68:71]
    buffer_load_dwordx4 v172, s[36:39], s20 offen sc1 lds
    v_mfma_f32_16x16x32_bf16 v[72:75], a[196:199], v[108:111], v[72:75]
    ds_read_b64_tr_b16 v[126:127], v169 offset:6144
    v_mfma_f32_16x16x32_bf16 v[76:79], a[200:203], v[108:111], v[76:79]
    s_waitcnt lgkmcnt(6)
    ds_read_b64_tr_b16 v[128:129], v170 offset:4096
    v_mfma_f32_16x16x32_bf16 v[80:83], a[192:195], v[112:115], v[80:83]
    s_add_u32 m0, s63, 118784
    ds_read_b64_tr_b16 v[130:131], v170 offset:6144
    v_mfma_f32_16x16x32_bf16 v[84:87], a[196:199], v[112:115], v[84:87]
    buffer_load_dwordx4 v172, s[36:39], s21 offen sc1 lds
    v_mfma_f32_16x16x32_bf16 v[88:91], a[200:203], v[112:115], v[88:91]
    s_waitcnt lgkmcnt(6)
    ds_read_b64_tr_b16 v[132:133], v171 offset:4096
    v_mfma_f32_16x16x32_bf16 v[92:95], a[192:195], v[116:119], v[92:95]
    s_waitcnt lgkmcnt(3)
    ds_read_b64_tr_b16 v[134:135], v171 offset:6144
    v_mfma_f32_16x16x32_bf16 v[96:99], a[196:199], v[116:119], v[96:99]
    s_add_u32 m0, s63, 122880
    v_mfma_f32_16x16x32_bf16 v[100:103], a[200:203], v[116:119], v[100:103]
    buffer_load_dwordx4 v172, s[36:39], s22 offen sc1 lds
    v_mfma_f32_16x16x32_bf16 v[56:59], a[204:207], v[120:123], v[56:59]
    ds_read_b64_tr_b16 v[104:105], v168 offset:8192
    v_mfma_f32_16x16x32_bf16 v[60:63], a[208:211], v[120:123], v[60:63]
    ds_read_b64_tr_b16 v[106:107], v168 offset:10240
    v_mfma_f32_16x16x32_bf16 v[64:67], a[212:215], v[120:123], v[64:67]
    s_add_u32 m0, s63, 126976
    ds_read_b64_tr_b16 v[108:109], v169 offset:8192
    v_mfma_f32_16x16x32_bf16 v[68:71], a[204:207], v[124:127], v[68:71]
    buffer_load_dwordx4 v172, s[36:39], s23 offen sc1 lds
    v_mfma_f32_16x16x32_bf16 v[72:75], a[208:211], v[124:127], v[72:75]
    ds_read_b64_tr_b16 v[110:111], v169 offset:10240
    v_mfma_f32_16x16x32_bf16 v[76:79], a[212:215], v[124:127], v[76:79]
    s_waitcnt lgkmcnt(6)
    ds_read_b64_tr_b16 v[112:113], v170 offset:8192
    v_mfma_f32_16x16x32_bf16 v[80:83], a[204:207], v[128:131], v[80:83]
    s_add_u32 m0, s63, 131072
    ds_read_b64_tr_b16 v[114:115], v170 offset:10240
    v_mfma_f32_16x16x32_bf16 v[84:87], a[208:211], v[128:131], v[84:87]
    buffer_load_dwordx4 v172, s[36:39], s24 offen sc1 lds
    v_mfma_f32_16x16x32_bf16 v[88:91], a[212:215], v[128:131], v[88:91]
    s_waitcnt lgkmcnt(6)
    ds_read_b64_tr_b16 v[116:117], v171 offset:8192
    v_mfma_f32_16x16x32_bf16 v[92:95], a[204:207], v[132:135], v[92:95]
    s_waitcnt lgkmcnt(3)
    ds_read_b64_tr_b16 v[118:119], v171 offset:10240
    v_mfma_f32_16x16x32_bf16 v[96:99], a[208:211], v[132:135], v[96:99]
    s_add_u32 m0, s63, 135168
    v_mfma_f32_16x16x32_bf16 v[100:103], a[212:215], v[132:135], v[100:103]
    buffer_load_dwordx4 v172, s[36:39], s25 offen sc1 lds
    v_mfma_f32_16x16x32_bf16 v[56:59], a[216:219], v[104:107], v[56:59]
    ds_read_b64_tr_b16 v[120:121], v168 offset:12288
    v_mfma_f32_16x16x32_bf16 v[60:63], a[220:223], v[104:107], v[60:63]
    ds_read_b64_tr_b16 v[122:123], v168 offset:14336
    v_add_u32 v168, 16384, v168
    v_mfma_f32_16x16x32_bf16 v[64:67], a[224:227], v[104:107], v[64:67]
    s_add_u32 m0, s63, 139264
    ds_read_b64_tr_b16 v[124:125], v169 offset:12288
    v_and_b32 v247, 48, v1
    v_mfma_f32_16x16x32_bf16 v[68:71], a[216:219], v[108:111], v[68:71]
    v_add_u32 v247, s63, v247
    buffer_load_dwordx4 v172, s[36:39], s26 offen sc1 lds
    v_mfma_f32_16x16x32_bf16 v[72:75], a[220:223], v[108:111], v[72:75]
    s_waitcnt vmcnt(14)
    ds_read_b64_tr_b16 v[126:127], v169 offset:14336
    v_add_u32 v169, 16384, v169
    v_mfma_f32_16x16x32_bf16 v[76:79], a[224:227], v[108:111], v[76:79]
    s_waitcnt lgkmcnt(6)
    ds_read_b64_tr_b16 v[128:129], v170 offset:12288
    ds_read_b128 v[176:179], v247 offset:5120
    v_mfma_f32_16x16x32_bf16 v[80:83], a[216:219], v[112:115], v[80:83]
    s_add_u32 m0, s63, 143360
    ds_read_b64_tr_b16 v[130:131], v170 offset:14336
    v_add_u32 v170, 16384, v170
    v_mfma_f32_16x16x32_bf16 v[84:87], a[220:223], v[112:115], v[84:87]
    ds_read_b128 v[180:183], v247 offset:5184
    buffer_load_dwordx4 v172, s[36:39], s27 offen sc1 lds
    v_mfma_f32_16x16x32_bf16 v[88:91], a[224:227], v[112:115], v[88:91]
    s_waitcnt lgkmcnt(8)
    ds_read_b64_tr_b16 v[132:133], v171 offset:12288
    ds_read_b128 v[184:187], v247 offset:5248
    v_mfma_f32_16x16x32_bf16 v[92:95], a[216:219], v[116:119], v[92:95]
    s_waitcnt lgkmcnt(3)
    ds_read_b64_tr_b16 v[134:135], v171 offset:14336
    v_add_u32 v171, 16384, v171
    v_mfma_f32_16x16x32_bf16 v[96:99], a[220:223], v[116:119], v[96:99]
    s_add_u32 m0, s63, 147456
    ds_read_b128 v[188:191], v247 offset:5312
    v_mfma_f32_16x16x32_bf16 v[100:103], a[224:227], v[116:119], v[100:103]
    ds_read_b128 v[192:195], v247 offset:5376
    buffer_load_dwordx4 v172, s[36:39], s44 offen sc1 lds
    v_mfma_f32_16x16x32_bf16 v[56:59], a[228:231], v[120:123], v[56:59]
    s_waitcnt vmcnt(15)
    s_barrier
    ds_read_b64_tr_b16 v[104:105], v168 offset:0
    v_mfma_f32_16x16x32_bf16 v[60:63], a[232:235], v[120:123], v[60:63]
    ds_read_b64_tr_b16 v[106:107], v168 offset:2048
    ds_read_b128 v[196:199], v247 offset:5440
    v_mfma_f32_16x16x32_bf16 v[64:67], a[236:239], v[120:123], v[64:67]
    s_add_u32 m0, s63, 1024
    ds_read_b64_tr_b16 v[108:109], v169 offset:0
    v_mfma_f32_16x16x32_bf16 v[68:71], a[228:231], v[124:127], v[68:71]
    buffer_load_dwordx4 v248, s[36:39], s6 offen sc1 lds
    v_mfma_f32_16x16x32_bf16 v[72:75], a[232:235], v[124:127], v[72:75]
    ds_read_b64_tr_b16 v[110:111], v169 offset:2048
    v_mfma_f32_16x16x32_bf16 v[76:79], a[236:239], v[124:127], v[76:79]
    ds_read_b64_tr_b16 v[112:113], v170 offset:0
    v_mfma_f32_16x16x32_bf16 v[80:83], a[228:231], v[128:131], v[80:83]
    s_add_u32 m0, s63, 151552
    ds_read_b64_tr_b16 v[114:115], v170 offset:2048
    v_mfma_f32_16x16x32_bf16 v[84:87], a[232:235], v[128:131], v[84:87]
    buffer_load_dwordx4 v172, s[36:39], s45 offen sc1 lds
    v_mfma_f32_16x16x32_bf16 v[88:91], a[236:239], v[128:131], v[88:91]
    s_waitcnt lgkmcnt(9)
    ds_read_b64_tr_b16 v[116:117], v171 offset:0
    v_mfma_f32_16x16x32_bf16 v[92:95], a[228:231], v[132:135], v[92:95]
    s_waitcnt lgkmcnt(3)
    ds_read_b64_tr_b16 v[118:119], v171 offset:2048
    v_mfma_f32_16x16x32_bf16 v[96:99], a[232:235], v[132:135], v[96:99]
    v_mfma_f32_16x16x32_bf16 v[100:103], a[236:239], v[132:135], v[100:103]
    v_mfma_f32_16x16x32_bf16 v[8:11], a[0:3], v[104:107], 0
    ds_read_b64_tr_b16 v[120:121], v168 offset:4096
    v_add_u32 v216, 81920, v216
    v_mfma_f32_16x16x32_bf16 v[12:15], a[4:7], v[104:107], 0
    ds_read_b64_tr_b16 v[122:123], v168 offset:6144
    v_add_u32 v217, 81920, v217
    v_mfma_f32_16x16x32_bf16 v[16:19], a[8:11], v[104:107], 0
    s_add_u32 m0, s63, 155648
    ds_read_b64_tr_b16 v[124:125], v169 offset:4096
    v_add_u32 v218, 81920, v218
    v_mfma_f32_16x16x32_bf16 v[20:23], a[0:3], v[108:111], 0
    buffer_load_dwordx4 v172, s[36:39], s46 offen sc1 lds
    v_mfma_f32_16x16x32_bf16 v[24:27], a[4:7], v[108:111], 0
    ds_read_b64_tr_b16 v[126:127], v169 offset:6144
    v_mfma_f32_16x16x32_bf16 v[28:31], a[8:11], v[108:111], 0
    s_waitcnt lgkmcnt(6)
    ds_read_b64_tr_b16 v[128:129], v170 offset:4096
    v_mfma_f32_16x16x32_bf16 v[32:35], a[0:3], v[112:115], 0
    s_add_u32 m0, s63, 159744
    ds_read_b64_tr_b16 v[130:131], v170 offset:6144
    v_mfma_f32_16x16x32_bf16 v[36:39], a[4:7], v[112:115], 0
    buffer_load_dwordx4 v172, s[36:39], s47 offen sc1 lds
    v_mfma_f32_16x16x32_bf16 v[40:43], a[8:11], v[112:115], 0
    s_waitcnt lgkmcnt(6)
    ds_read_b64_tr_b16 v[132:133], v171 offset:4096
    v_mfma_f32_16x16x32_bf16 v[44:47], a[0:3], v[116:119], 0
    s_waitcnt lgkmcnt(3)
    ds_read_b64_tr_b16 v[134:135], v171 offset:6144
    v_mfma_f32_16x16x32_bf16 v[48:51], a[4:7], v[116:119], 0
    v_mfma_f32_16x16x32_bf16 v[52:55], a[8:11], v[116:119], 0
    buffer_load_dwordx4 v[160:163], v248, s[36:39], s62 offen offset:2048 sc1
    v_mfma_f32_16x16x32_bf16 v[8:11], a[12:15], v[120:123], v[8:11]
    s_waitcnt vmcnt(17)
    s_barrier
    ds_read_b64_tr_b16 v[104:105], v168 offset:8192
    v_mfma_f32_16x16x32_bf16 v[12:15], a[16:19], v[120:123], v[12:15]
    ds_read_b64_tr_b16 v[106:107], v168 offset:10240
    v_mfma_f32_16x16x32_bf16 v[16:19], a[20:23], v[120:123], v[16:19]
    ds_read_b64_tr_b16 v[108:109], v169 offset:8192
    v_mfma_f32_16x16x32_bf16 v[20:23], a[12:15], v[124:127], v[20:23]
    buffer_load_dwordx4 v[164:167], v248, s[36:39], s62 offen offset:3072 sc1
    v_mfma_f32_16x16x32_bf16 v[24:27], a[16:19], v[124:127], v[24:27]
    ds_read_b64_tr_b16 v[110:111], v169 offset:10240
    v_mfma_f32_16x16x32_bf16 v[28:31], a[20:23], v[124:127], v[28:31]
    s_waitcnt lgkmcnt(6)
    ds_read_b64_tr_b16 v[112:113], v170 offset:8192
    v_mfma_f32_16x16x32_bf16 v[32:35], a[12:15], v[128:131], v[32:35]
    s_add_u32 s62, s62, 4096
    ds_read_b64_tr_b16 v[114:115], v170 offset:10240
    v_mfma_f32_16x16x32_bf16 v[36:39], a[16:19], v[128:131], v[36:39]
    buffer_load_dwordx4 a[0:3], v248, s[36:39], s62 offen offset:0 sc1
    v_mfma_f32_16x16x32_bf16 v[40:43], a[20:23], v[128:131], v[40:43]
    s_waitcnt lgkmcnt(6)
    ds_read_b64_tr_b16 v[116:117], v171 offset:8192
    v_mfma_f32_16x16x32_bf16 v[44:47], a[12:15], v[132:135], v[44:47]
    s_waitcnt lgkmcnt(3)
    ds_read_b64_tr_b16 v[118:119], v171 offset:10240
    v_mfma_f32_16x16x32_bf16 v[48:51], a[16:19], v[132:135], v[48:51]
    v_mfma_f32_16x16x32_bf16 v[52:55], a[20:23], v[132:135], v[52:55]
    buffer_load_dwordx4 a[4:7], v248, s[36:39], s62 offen offset:1024 sc1
    v_mfma_f32_16x16x32_bf16 v[8:11], a[24:27], v[104:107], v[8:11]
    ds_read_b64_tr_b16 v[120:121], v168 offset:12288
    v_mfma_f32_16x16x32_bf16 v[12:15], a[28:31], v[104:107], v[12:15]
    ds_read_b64_tr_b16 v[122:123], v168 offset:14336
    v_mfma_f32_16x16x32_bf16 v[16:19], a[32:35], v[104:107], v[16:19]
    ds_read_b64_tr_b16 v[124:125], v169 offset:12288
    v_mfma_f32_16x16x32_bf16 v[20:23], a[24:27], v[108:111], v[20:23]
    buffer_load_dwordx4 a[8:11], v248, s[36:39], s62 offen offset:2048 sc1
    v_mfma_f32_16x16x32_bf16 v[24:27], a[28:31], v[108:111], v[24:27]
    s_waitcnt vmcnt(8)
    ds_read_b64_tr_b16 v[126:127], v169 offset:14336
    ds_read_b128 v[200:203], v175 offset:1024
    v_mfma_f32_16x16x32_bf16 v[28:31], a[32:35], v[108:111], v[28:31]
    s_waitcnt lgkmcnt(7)
    ds_read_b64_tr_b16 v[128:129], v170 offset:12288
    v_mfma_f32_16x16x32_bf16 v[32:35], a[24:27], v[112:115], v[32:35]
    ds_read_b64_tr_b16 v[130:131], v170 offset:14336
    v_mfma_f32_16x16x32_bf16 v[36:39], a[28:31], v[112:115], v[36:39]
    ds_read_b128 v[204:207], v175 offset:1280
    buffer_load_dwordx4 a[12:15], v248, s[36:39], s62 offen offset:3072 sc1
    v_mfma_f32_16x16x32_bf16 v[40:43], a[32:35], v[112:115], v[40:43]
    s_waitcnt lgkmcnt(8)
    ds_read_b64_tr_b16 v[132:133], v171 offset:12288
    ds_read_b128 v[208:211], v175 offset:1536
    v_mfma_f32_16x16x32_bf16 v[44:47], a[24:27], v[116:119], v[44:47]
    s_waitcnt lgkmcnt(3)
    ds_read_b64_tr_b16 v[134:135], v171 offset:14336
    ds_read_b128 v[212:215], v175 offset:1792
    v_mfma_f32_16x16x32_bf16 v[48:51], a[28:31], v[116:119], v[48:51]
    s_add_u32 s62, s62, 4096
    v_mfma_f32_16x16x32_bf16 v[52:55], a[32:35], v[116:119], v[52:55]
    buffer_load_dwordx4 a[16:19], v248, s[36:39], s62 offen offset:0 sc1
    v_mfma_f32_16x16x32_bf16 v[8:11], a[36:39], v[120:123], v[8:11]
    ds_read_b64_tr_b16 v[104:105], v168 offset:16384
    v_xor_b32 v3, s48, v201
    v_mfma_f32_16x16x32_bf16 v[12:15], a[40:43], v[120:123], v[12:15]
    ds_read_b64_tr_b16 v[106:107], v168 offset:18432
    v_bitop3_b32 v3, v203, s48, v3 bitop3:0xbe
    v_mfma_f32_16x16x32_bf16 v[16:19], a[44:47], v[120:123], v[16:19]
    ds_read_b64_tr_b16 v[108:109], v169 offset:16384
    s_waitcnt lgkmcnt(7)
    v_bitop3_b32 v3, v205, s48, v3 bitop3:0xbe
    v_mfma_f32_16x16x32_bf16 v[20:23], a[36:39], v[124:127], v[20:23]
    v_bitop3_b32 v3, v207, s48, v3 bitop3:0xbe
    s_waitcnt lgkmcnt(5)
    v_bitop3_b32 v3, v209, s48, v3 bitop3:0xbe
    buffer_load_dwordx4 a[20:23], v248, s[36:39], s62 offen offset:1024 sc1
    v_mfma_f32_16x16x32_bf16 v[24:27], a[40:43], v[124:127], v[24:27]
    ds_read_b64_tr_b16 v[110:111], v169 offset:18432
    v_bitop3_b32 v3, v211, s48, v3 bitop3:0xbe
    v_mfma_f32_16x16x32_bf16 v[28:31], a[44:47], v[124:127], v[28:31]
    ds_read_b64_tr_b16 v[112:113], v170 offset:16384
    s_waitcnt lgkmcnt(5)
    v_bitop3_b32 v3, v213, s48, v3 bitop3:0xbe
    v_mfma_f32_16x16x32_bf16 v[32:35], a[36:39], v[128:131], v[32:35]
    ds_read_b64_tr_b16 v[114:115], v170 offset:18432
    v_bitop3_b32 v3, v215, s48, v3 bitop3:0xbe
    v_mfma_f32_16x16x32_bf16 v[36:39], a[40:43], v[128:131], v[36:39]
    v_cmp_ne_u32 vcc, 0, v3
    s_cbranch_vccnz L_stc0_slow
L_stc0_back:
    buffer_load_dwordx4 a[24:27], v248, s[36:39], s62 offen offset:2048 sc1
    v_mfma_f32_16x16x32_bf16 v[40:43], a[44:47], v[128:131], v[40:43]
    ds_read_b64_tr_b16 v[116:117], v171 offset:16384
    s_add_u32 s50, s8, 98304
    v_pk_fma_f32 v[238:239], v[176:177], v[202:203], v[188:189] op_sel_hi:[1,0,1]
    v_pk_fma_f32 v[240:241], v[178:179], v[202:203], v[190:191] op_sel_hi:[1,0,1]
    v_pk_fma_f32 v[56:57], v[56:57], v[200:201], v[238:239] op_sel_hi:[1,0,1]
    v_pk_fma_f32 v[58:59], v[58:59], v[200:201], v[240:241] op_sel_hi:[1,0,1]
    v_pk_fma_f32 v[242:243], v[180:181], v[202:203], v[192:193] op_sel_hi:[1,0,1]
    v_pk_fma_f32 v[244:245], v[182:183], v[202:203], v[194:195] op_sel_hi:[1,0,1]
    v_pk_fma_f32 v[60:61], v[60:61], v[200:201], v[242:243] op_sel_hi:[1,0,1]
    v_pk_fma_f32 v[62:63], v[62:63], v[200:201], v[244:245] op_sel_hi:[1,0,1]
    v_pk_mul_f32 v[56:57], v[56:57], v[60:61]
    v_pk_mul_f32 v[58:59], v[58:59], v[62:63]
    v_cvt_pk_bf16_f32 v60, v56, v57
    v_cvt_pk_bf16_f32 v61, v58, v59
    v_pk_fma_f32 v[242:243], v[176:177], v[206:207], v[188:189] op_sel_hi:[1,0,1]
    v_pk_fma_f32 v[244:245], v[178:179], v[206:207], v[190:191] op_sel_hi:[1,0,1]
    v_pk_fma_f32 v[68:69], v[68:69], v[204:205], v[242:243] op_sel_hi:[1,0,1]
    v_pk_fma_f32 v[70:71], v[70:71], v[204:205], v[244:245] op_sel_hi:[1,0,1]
    v_pk_fma_f32 v[238:239], v[180:181], v[206:207], v[192:193] op_sel_hi:[1,0,1]
    v_pk_fma_f32 v[240:241], v[182:183], v[206:207], v[194:195] op_sel_hi:[1,0,1]
    v_pk_fma_f32 v[72:73], v[72:73], v[204:205], v[238:239] op_sel_hi:[1,0,1]
    v_pk_fma_f32 v[74:75], v[74:75], v[204:205], v[240:241] op_sel_hi:[1,0,1]
    v_pk_mul_f32 v[68:69], v[68:69], v[72:73]
    v_pk_mul_f32 v[70:71], v[70:71], v[74:75]
    v_cvt_pk_bf16_f32 v62, v68, v69
    v_cvt_pk_bf16_f32 v63, v70, v71
    s_nop 0
    v_permlane16_swap_b32 v60, v62
    v_permlane16_swap_b32 v61, v63
    buffer_store_dwordx4 v[60:63], v173, s[36:39], s8 offen sc1
    v_pk_fma_f32 v[238:239], v[176:177], v[210:211], v[188:189] op_sel_hi:[1,0,1]
    v_pk_fma_f32 v[240:241], v[178:179], v[210:211], v[190:191] op_sel_hi:[1,0,1]
    v_pk_fma_f32 v[80:81], v[80:81], v[208:209], v[238:239] op_sel_hi:[1,0,1]
    v_pk_fma_f32 v[82:83], v[82:83], v[208:209], v[240:241] op_sel_hi:[1,0,1]
    v_pk_fma_f32 v[242:243], v[180:181], v[210:211], v[192:193] op_sel_hi:[1,0,1]
    v_pk_fma_f32 v[244:245], v[182:183], v[210:211], v[194:195] op_sel_hi:[1,0,1]
    v_pk_fma_f32 v[84:85], v[84:85], v[208:209], v[242:243] op_sel_hi:[1,0,1]
    v_pk_fma_f32 v[86:87], v[86:87], v[208:209], v[244:245] op_sel_hi:[1,0,1]
    v_pk_mul_f32 v[80:81], v[80:81], v[84:85]
    v_pk_mul_f32 v[82:83], v[82:83], v[86:87]
    v_cvt_pk_bf16_f32 v84, v80, v81
    v_cvt_pk_bf16_f32 v85, v82, v83
    v_pk_fma_f32 v[242:243], v[176:177], v[214:215], v[188:189] op_sel_hi:[1,0,1]
    v_pk_fma_f32 v[244:245], v[178:179], v[214:215], v[190:191] op_sel_hi:[1,0,1]
    v_pk_fma_f32 v[92:93], v[92:93], v[212:213], v[242:243] op_sel_hi:[1,0,1]
    v_pk_fma_f32 v[94:95], v[94:95], v[212:213], v[244:245] op_sel_hi:[1,0,1]
    v_pk_fma_f32 v[238:239], v[180:181], v[214:215], v[192:193] op_sel_hi:[1,0,1]
    v_pk_fma_f32 v[240:241], v[182:183], v[214:215], v[194:195] op_sel_hi:[1,0,1]
    v_pk_fma_f32 v[96:97], v[96:97], v[212:213], v[238:239] op_sel_hi:[1,0,1]
    v_pk_fma_f32 v[98:99], v[98:99], v[212:213], v[240:241] op_sel_hi:[1,0,1]
    v_pk_mul_f32 v[92:93], v[92:93], v[96:97]
    v_pk_mul_f32 v[94:95], v[94:95], v[98:99]
    v_cvt_pk_bf16_f32 v86, v92, v93
    v_cvt_pk_bf16_f32 v87, v94, v95
    s_nop 0
    v_permlane16_swap_b32 v84, v86
    v_permlane16_swap_b32 v85, v87
    buffer_store_dwordx4 v[84:87], v173, s[36:39], s50 offen sc1
    v_pk_fma_f32 v[238:239], v[184:185], v[202:203], v[196:197] op_sel_hi:[1,0,1]
    v_pk_fma_f32 v[240:241], v[186:187], v[202:203], v[198:199] op_sel_hi:[1,0,1]
    v_pk_fma_f32 v[64:65], v[64:65], v[200:201], v[238:239] op_sel_hi:[1,0,1]
    v_pk_fma_f32 v[66:67], v[66:67], v[200:201], v[240:241] op_sel_hi:[1,0,1]
    v_pk_fma_f32 v[242:243], v[184:185], v[206:207], v[196:197] op_sel_hi:[1,0,1]
    v_pk_fma_f32 v[244:245], v[186:187], v[206:207], v[198:199] op_sel_hi:[1,0,1]
    v_pk_fma_f32 v[76:77], v[76:77], v[204:205], v[242:243] op_sel_hi:[1,0,1]
    v_pk_fma_f32 v[78:79], v[78:79], v[204:205], v[244:245] op_sel_hi:[1,0,1]
    s_nop 0
    v_permlane32_swap_b32 v64, v76
    v_permlane32_swap_b32 v65, v77
    v_permlane32_swap_b32 v66, v78
    v_permlane32_swap_b32 v67, v79
    v_pk_mul_f32 v[64:65], v[64:65], v[76:77]
    v_pk_mul_f32 v[66:67], v[66:67], v[78:79]
    v_cvt_pk_bf16_f32 v56, v64, v65
    v_cvt_pk_bf16_f32 v57, v66, v67
    v_pk_fma_f32 v[238:239], v[184:185], v[210:211], v[196:197] op_sel_hi:[1,0,1]
    v_pk_fma_f32 v[240:241], v[186:187], v[210:211], v[198:199] op_sel_hi:[1,0,1]
    v_pk_fma_f32 v[88:89], v[88:89], v[208:209], v[238:239] op_sel_hi:[1,0,1]
    v_pk_fma_f32 v[90:91], v[90:91], v[208:209], v[240:241] op_sel_hi:[1,0,1]
    v_pk_fma_f32 v[242:243], v[184:185], v[214:215], v[196:197] op_sel_hi:[1,0,1]
    v_pk_fma_f32 v[244:245], v[186:187], v[214:215], v[198:199] op_sel_hi:[1,0,1]
    v_pk_fma_f32 v[100:101], v[100:101], v[212:213], v[242:243] op_sel_hi:[1,0,1]
    v_pk_fma_f32 v[102:103], v[102:103], v[212:213], v[244:245] op_sel_hi:[1,0,1]
    s_nop 0
    v_permlane32_swap_b32 v88, v100
    v_permlane32_swap_b32 v89, v101
    v_permlane32_swap_b32 v90, v102
    v_permlane32_swap_b32 v91, v103
    v_pk_mul_f32 v[88:89], v[88:89], v[100:101]
    v_pk_mul_f32 v[90:91], v[90:91], v[102:103]
    v_cvt_pk_bf16_f32 v58, v88, v89
    v_cvt_pk_bf16_f32 v59, v90, v91
    s_nop 0
    v_permlane16_swap_b32 v56, v58
    v_permlane16_swap_b32 v57, v59
    buffer_store_dwordx4 v[56:59], v174, s[36:39], s8 offen offset:512 sc1
    s_add_u32 s6, s6, 16384
    s_lshl_b32 s76, s72, 4
    s_add_u32 s76, s76, s73
    v_mfma_f32_16x16x32_bf16 v[44:47], a[36:39], v[132:135], v[44:47]
    s_waitcnt lgkmcnt(3)
    ds_read_b64_tr_b16 v[118:119], v171 offset:18432
    v_mfma_f32_16x16x32_bf16 v[48:51], a[40:43], v[132:135], v[48:51]
    v_mfma_f32_16x16x32_bf16 v[52:55], a[44:47], v[132:135], v[52:55]
    buffer_load_dwordx4 a[28:31], v248, s[36:39], s62 offen offset:3072 sc1
    v_mfma_f32_16x16x32_bf16 v[8:11], a[48:51], v[104:107], v[8:11]
    s_waitcnt vmcnt(13)
    s_barrier
    ds_read_b64_tr_b16 v[120:121], v168 offset:20480
    v_mfma_f32_16x16x32_bf16 v[12:15], a[52:55], v[104:107], v[12:15]
    ds_read_b64_tr_b16 v[122:123], v168 offset:22528
    ds_read_b64 v[224:225], v216
    v_mfma_f32_16x16x32_bf16 v[16:19], a[56:59], v[104:107], v[16:19]
    s_add_u32 s62, s62, 4096
    ds_read_b64_tr_b16 v[124:125], v169 offset:20480
    ds_read_b64 v[226:227], v217
    v_mfma_f32_16x16x32_bf16 v[20:23], a[48:51], v[108:111], v[20:23]
    buffer_load_dwordx4 a[32:35], v248, s[36:39], s62 offen offset:0 sc1
    v_mfma_f32_16x16x32_bf16 v[24:27], a[52:55], v[108:111], v[24:27]
    ds_read_b64_tr_b16 v[126:127], v169 offset:22528
    ds_read_b64 v[228:229], v218
    v_mfma_f32_16x16x32_bf16 v[28:31], a[56:59], v[108:111], v[28:31]
    s_waitcnt lgkmcnt(9)
    ds_read_b64_tr_b16 v[128:129], v170 offset:20480
    v_mfma_f32_16x16x32_bf16 v[32:35], a[48:51], v[112:115], v[32:35]
    ds_read_b64_tr_b16 v[130:131], v170 offset:22528
    v_mfma_f32_16x16x32_bf16 v[36:39], a[52:55], v[112:115], v[36:39]
    buffer_load_dwordx4 a[36:39], v248, s[36:39], s62 offen offset:1024 sc1
    v_mfma_f32_16x16x32_bf16 v[40:43], a[56:59], v[112:115], v[40:43]
    s_waitcnt lgkmcnt(9)
    ds_read_b64_tr_b16 v[132:133], v171 offset:20480
    v_mfma_f32_16x16x32_bf16 v[44:47], a[48:51], v[116:119], v[44:47]
    s_waitcnt lgkmcnt(3)
    ds_read_b64_tr_b16 v[134:135], v171 offset:22528
    v_mfma_f32_16x16x32_bf16 v[48:51], a[52:55], v[116:119], v[48:51]
    v_lshlrev_b32 v230, 16, v224
    v_and_b32 v231, 0xffff0000, v224
    v_pk_mul_f32 v[230:231], v[230:231], v[220:221] op_sel_hi:[1,0]
    v_pk_mul_f32 v[234:235], v[230:231], v[230:231]
    v_lshlrev_b32 v232, 16, v225
    v_and_b32 v233, 0xffff0000, v225
    v_pk_mul_f32 v[232:233], v[232:233], v[220:221] op_sel_hi:[1,0]
    v_pk_mul_f32 v[236:237], v[232:233], v[232:233]
    v_lshlrev_b32 v2, 16, v226
    v_and_b32 v3, 0xffff0000, v226
    v_pk_mul_f32 v[2:3], v[2:3], v[220:221] op_sel:[0,1] op_sel_hi:[1,1]
    v_pk_add_f32 v[230:231], v[230:231], v[2:3]
    v_pk_fma_f32 v[234:235], v[2:3], v[2:3], v[234:235]
    v_lshlrev_b32 v2, 16, v227
    v_and_b32 v3, 0xffff0000, v227
    v_pk_mul_f32 v[2:3], v[2:3], v[220:221] op_sel:[0,1] op_sel_hi:[1,1]
    v_pk_add_f32 v[232:233], v[232:233], v[2:3]
    v_pk_fma_f32 v[236:237], v[2:3], v[2:3], v[236:237]
    v_lshlrev_b32 v2, 16, v228
    v_and_b32 v3, 0xffff0000, v228
    v_pk_mul_f32 v[2:3], v[2:3], v[222:223] op_sel_hi:[1,0]
    v_pk_add_f32 v[230:231], v[230:231], v[2:3]
    v_pk_fma_f32 v[234:235], v[2:3], v[2:3], v[234:235]
    v_lshlrev_b32 v2, 16, v229
    v_and_b32 v3, 0xffff0000, v229
    v_pk_mul_f32 v[2:3], v[2:3], v[222:223] op_sel_hi:[1,0]
    v_pk_add_f32 v[232:233], v[232:233], v[2:3]
    v_pk_fma_f32 v[236:237], v[2:3], v[2:3], v[236:237]
    v_mfma_f32_16x16x32_bf16 v[52:55], a[56:59], v[116:119], v[52:55]
    buffer_load_dwordx4 a[40:43], v248, s[36:39], s62 offen offset:2048 sc1
    v_mfma_f32_16x16x32_bf16 v[8:11], a[60:63], v[120:123], v[8:11]
    ds_read_b64_tr_b16 v[104:105], v168 offset:24576
    v_permlane32_swap_b32 v230, v234
    v_mfma_f32_16x16x32_bf16 v[12:15], a[64:67], v[120:123], v[12:15]
    ds_read_b64_tr_b16 v[106:107], v168 offset:26624
    v_permlane32_swap_b32 v231, v235
    v_mfma_f32_16x16x32_bf16 v[16:19], a[68:71], v[120:123], v[16:19]
    ds_read_b64_tr_b16 v[108:109], v169 offset:24576
    v_permlane32_swap_b32 v232, v236
    v_mfma_f32_16x16x32_bf16 v[20:23], a[60:63], v[124:127], v[20:23]
    buffer_load_dwordx4 a[44:47], v248, s[36:39], s62 offen offset:3072 sc1
    v_mfma_f32_16x16x32_bf16 v[24:27], a[64:67], v[124:127], v[24:27]
    ds_read_b64_tr_b16 v[110:111], v169 offset:26624
    v_permlane32_swap_b32 v233, v237
    v_mfma_f32_16x16x32_bf16 v[28:31], a[68:71], v[124:127], v[28:31]
    s_waitcnt lgkmcnt(6)
    ds_read_b64_tr_b16 v[112:113], v170 offset:24576
    v_add_f32 v230, v230, v234
    v_mfma_f32_16x16x32_bf16 v[32:35], a[60:63], v[128:131], v[32:35]
    s_add_u32 s62, s62, 4096
    ds_read_b64_tr_b16 v[114:115], v170 offset:26624
    v_add_f32 v231, v231, v235
    v_add_f32 v232, v232, v236
    v_mfma_f32_16x16x32_bf16 v[36:39], a[64:67], v[128:131], v[36:39]
    buffer_load_dwordx4 a[48:51], v248, s[36:39], s62 offen offset:0 sc1
    v_mfma_f32_16x16x32_bf16 v[40:43], a[68:71], v[128:131], v[40:43]
    s_waitcnt lgkmcnt(6)
    ds_read_b64_tr_b16 v[116:117], v171 offset:24576
    v_add_f32 v233, v233, v237
    v_mfma_f32_16x16x32_bf16 v[44:47], a[60:63], v[132:135], v[44:47]
    s_waitcnt lgkmcnt(3)
    ds_read_b64_tr_b16 v[118:119], v171 offset:26624
    v_permlane16_swap_b32 v230, v232
    v_mfma_f32_16x16x32_bf16 v[48:51], a[64:67], v[132:135], v[48:51]
    v_permlane16_swap_b32 v231, v233
    v_mfma_f32_16x16x32_bf16 v[52:55], a[68:71], v[132:135], v[52:55]
    buffer_load_dwordx4 a[52:55], v248, s[36:39], s62 offen offset:1024 sc1
    v_mfma_f32_16x16x32_bf16 v[8:11], a[72:75], v[104:107], v[8:11]
    ds_read_b64_tr_b16 v[120:121], v168 offset:28672
    v_add_f32 v230, v230, v232
    v_mfma_f32_16x16x32_bf16 v[12:15], a[76:79], v[104:107], v[12:15]
    ds_read_b64_tr_b16 v[122:123], v168 offset:30720
    v_add_f32 v231, v231, v233
    v_mfma_f32_16x16x32_bf16 v[16:19], a[80:83], v[104:107], v[16:19]
    ds_read_b64_tr_b16 v[124:125], v169 offset:28672
    v_lshrrev_b32 v2, 4, v1
    v_mfma_f32_16x16x32_bf16 v[20:23], a[72:75], v[108:111], v[20:23]
    buffer_load_dwordx4 a[56:59], v248, s[36:39], s62 offen offset:2048 sc1
    v_mfma_f32_16x16x32_bf16 v[24:27], a[76:79], v[108:111], v[24:27]
    ds_read_b64_tr_b16 v[126:127], v169 offset:30720
    v_lshlrev_b32 v2, 3, v2
    v_mfma_f32_16x16x32_bf16 v[28:31], a[80:83], v[108:111], v[28:31]
    s_waitcnt lgkmcnt(6)
    s_lshl_b32 s50, s3, 5
    s_add_u32 s50, s50, 0
    ds_read_b64_tr_b16 v[128:129], v170 offset:28672
    v_mfma_f32_16x16x32_bf16 v[32:35], a[72:75], v[112:115], v[32:35]
    ds_read_b64_tr_b16 v[130:131], v170 offset:30720
    v_add_u32 v2, s50, v2
    v_mfma_f32_16x16x32_bf16 v[36:39], a[76:79], v[112:115], v[36:39]
    buffer_load_dwordx4 a[60:63], v248, s[36:39], s62 offen offset:3072 sc1
    v_mfma_f32_16x16x32_bf16 v[40:43], a[80:83], v[112:115], v[40:43]
    s_waitcnt lgkmcnt(6)
    ds_read_b64_tr_b16 v[132:133], v171 offset:28672
    v_add_f32_dpp v230, v230, v230 row_ror:8 row_mask:0xf bank_mask:0xf
    v_mfma_f32_16x16x32_bf16 v[44:47], a[72:75], v[116:119], v[44:47]
    s_waitcnt lgkmcnt(3)
    ds_read_b64_tr_b16 v[134:135], v171 offset:30720
    v_add_f32_dpp v231, v231, v231 row_ror:8 row_mask:0xf bank_mask:0xf
    v_mfma_f32_16x16x32_bf16 v[48:51], a[76:79], v[116:119], v[48:51]
    s_add_u32 s62, s62, 4096
    v_add_f32_dpp v230, v230, v230 row_ror:4 row_mask:0xf bank_mask:0xf
    v_add_f32_dpp v231, v231, v231 row_ror:4 row_mask:0xf bank_mask:0xf
    v_mfma_f32_16x16x32_bf16 v[52:55], a[80:83], v[116:119], v[52:55]
    buffer_load_dwordx4 a[64:67], v248, s[36:39], s62 offen offset:0 sc1
    v_mfma_f32_16x16x32_bf16 v[8:11], a[84:87], v[120:123], v[8:11]
    ds_read_b64_tr_b16 v[104:105], v168 offset:32768
    v_add_f32_dpp v230, v230, v230 row_ror:2 row_mask:0xf bank_mask:0xf
    v_mfma_f32_16x16x32_bf16 v[12:15], a[88:91], v[120:123], v[12:15]
    ds_read_b64_tr_b16 v[106:107], v168 offset:34816
    v_add_f32_dpp v231, v231, v231 row_ror:2 row_mask:0xf bank_mask:0xf
    v_mfma_f32_16x16x32_bf16 v[16:19], a[92:95], v[120:123], v[16:19]
    ds_read_b64_tr_b16 v[108:109], v169 offset:32768
    v_add_f32_dpp v230, v230, v230 row_ror:1 row_mask:0xf bank_mask:0xf
    v_mfma_f32_16x16x32_bf16 v[20:23], a[84:87], v[124:127], v[20:23]
    s_waitcnt vmcnt(10)
    s_barrier
    s_cmp_eq_u32 s3, 0
    s_cbranch_scc0 L_wf11
    s_lshl_b32 s54, s76, 7
    s_add_u32 s54, s54, 23288832
    v_mov_b32 v254, 0
    v_mov_b32 v255, s48
    s_mov_b64 exec, 1
    buffer_store_dword v255, v254, s[36:39], s54 offen sc1
    s_mov_b64 exec, -1
L_wf11:
    buffer_load_dwordx4 a[68:71], v248, s[36:39], s62 offen offset:1024 sc1
    v_mfma_f32_16x16x32_bf16 v[24:27], a[88:91], v[124:127], v[24:27]
    ds_read_b64_tr_b16 v[110:111], v169 offset:34816
    v_add_f32_dpp v231, v231, v231 row_ror:1 row_mask:0xf bank_mask:0xf
    v_mfma_f32_16x16x32_bf16 v[28:31], a[92:95], v[124:127], v[28:31]
    ds_read_b64_tr_b16 v[112:113], v170 offset:32768
    s_mov_b32 exec_lo, 0x00010001
    s_mov_b32 exec_hi, 0x00010001
    ds_write_b64 v2, v[230:231]
    s_mov_b64 exec, -1
    s_waitcnt lgkmcnt(8)
    v_mfma_f32_16x16x32_bf16 v[32:35], a[84:87], v[128:131], v[32:35]
    ds_read_b64_tr_b16 v[114:115], v170 offset:34816
    v_lshlrev_b32 v2, 2, v1
    v_mfma_f32_16x16x32_bf16 v[36:39], a[88:91], v[128:131], v[36:39]
    buffer_load_dwordx4 a[72:75], v248, s[36:39], s62 offen offset:2048 sc1
    v_mfma_f32_16x16x32_bf16 v[40:43], a[92:95], v[128:131], v[40:43]
    s_waitcnt lgkmcnt(7)
    ds_read_b64_tr_b16 v[116:117], v171 offset:32768
    v_and_b32 v2, 12, v2
    v_mfma_f32_16x16x32_bf16 v[44:47], a[84:87], v[132:135], v[44:47]
    s_waitcnt lgkmcnt(3)
    ds_read_b64_tr_b16 v[118:119], v171 offset:34816
    v_add_u32 v2, 0, v2
    v_mfma_f32_16x16x32_bf16 v[48:51], a[88:91], v[132:135], v[48:51]
    s_waitcnt lgkmcnt(0)
    s_barrier
    v_mfma_f32_16x16x32_bf16 v[52:55], a[92:95], v[132:135], v[52:55]
    buffer_load_dwordx4 a[76:79], v248, s[36:39], s62 offen offset:3072 sc1
    v_mfma_f32_16x16x32_bf16 v[8:11], a[96:99], v[104:107], v[8:11]
    ds_read_b64_tr_b16 v[120:121], v168 offset:36864
    ds_read2_b32 v[230:231], v2 offset0:0 offset1:4
    v_mfma_f32_16x16x32_bf16 v[12:15], a[100:103], v[104:107], v[12:15]
    ds_read_b64_tr_b16 v[122:123], v168 offset:38912
    ds_read2_b32 v[232:233], v2 offset0:8 offset1:12
    v_mfma_f32_16x16x32_bf16 v[16:19], a[104:107], v[104:107], v[16:19]
    s_add_u32 s62, s62, 4096
    ds_read_b64_tr_b16 v[124:125], v169 offset:36864
    ds_read2_b32 v[234:235], v2 offset0:16 offset1:20
    ds_read2_b32 v[236:237], v2 offset0:24 offset1:28
    v_mfma_f32_16x16x32_bf16 v[20:23], a[96:99], v[108:111], v[20:23]
    buffer_load_dwordx4 a[80:83], v248, s[36:39], s62 offen offset:0 sc1
    v_mfma_f32_16x16x32_bf16 v[24:27], a[100:103], v[108:111], v[24:27]
    ds_read_b64_tr_b16 v[126:127], v169 offset:38912
    v_mov_b32 v225, s48
    v_mfma_f32_16x16x32_bf16 v[28:31], a[104:107], v[108:111], v[28:31]
    ds_read_b64_tr_b16 v[128:129], v170 offset:36864
    v_mov_b32 v227, s48
    v_mfma_f32_16x16x32_bf16 v[32:35], a[96:99], v[112:115], v[32:35]
    s_add_u32 s7, s7, 16384
    ds_read_b64_tr_b16 v[130:131], v170 offset:38912
    s_waitcnt lgkmcnt(6)
    v_add_f32 v230, v230, v232
    v_mfma_f32_16x16x32_bf16 v[36:39], a[100:103], v[112:115], v[36:39]
    buffer_load_dwordx4 a[84:87], v248, s[36:39], s62 offen offset:1024 sc1
    v_mfma_f32_16x16x32_bf16 v[40:43], a[104:107], v[112:115], v[40:43]
    ds_read_b64_tr_b16 v[132:133], v171 offset:36864
    v_add_f32 v231, v231, v233
    v_mfma_f32_16x16x32_bf16 v[44:47], a[96:99], v[116:119], v[44:47]
    s_waitcnt lgkmcnt(3)
    ds_read_b64_tr_b16 v[134:135], v171 offset:38912
    v_add_f32 v234, v234, v236
    v_mfma_f32_16x16x32_bf16 v[48:51], a[100:103], v[116:119], v[48:51]
    v_mfma_f32_16x16x32_bf16 v[52:55], a[104:107], v[116:119], v[52:55]
    buffer_load_dwordx4 a[88:91], v248, s[36:39], s62 offen offset:2048 sc1
    v_mfma_f32_16x16x32_bf16 v[8:11], a[108:111], v[120:123], v[8:11]
    ds_read_b64_tr_b16 v[104:105], v168 offset:40960
    v_add_f32 v235, v235, v237
    v_mfma_f32_16x16x32_bf16 v[12:15], a[112:115], v[120:123], v[12:15]
    ds_read_b64_tr_b16 v[106:107], v168 offset:43008
    v_add_f32 v230, v230, v234
    v_mfma_f32_16x16x32_bf16 v[16:19], a[116:119], v[120:123], v[16:19]
    ds_read_b64_tr_b16 v[108:109], v169 offset:40960
    v_add_f32 v231, v231, v235
    v_mfma_f32_16x16x32_bf16 v[20:23], a[108:111], v[124:127], v[20:23]
    buffer_load_dwordx4 a[92:95], v248, s[36:39], s62 offen offset:3072 sc1
    v_mfma_f32_16x16x32_bf16 v[24:27], a[112:115], v[124:127], v[24:27]
    ds_read_b64_tr_b16 v[110:111], v169 offset:43008
    v_mul_f32 v230, 0x3acccccd, v230
    v_mfma_f32_16x16x32_bf16 v[28:31], a[116:119], v[124:127], v[28:31]
    s_waitcnt lgkmcnt(6)
    ds_read_b64_tr_b16 v[112:113], v170 offset:40960
    v_mul_f32 v234, v230, v230
    v_mfma_f32_16x16x32_bf16 v[32:35], a[108:111], v[128:131], v[32:35]
    s_add_u32 s62, s62, 4096
    ds_read_b64_tr_b16 v[114:115], v170 offset:43008
    v_mov_b32 v224, 0x3acccccd
    v_fma_f32 v231, v231, v224, -v234
    v_mfma_f32_16x16x32_bf16 v[36:39], a[112:115], v[128:131], v[36:39]
    buffer_load_dwordx4 a[96:99], v248, s[36:39], s62 offen offset:0 sc1
    v_mfma_f32_16x16x32_bf16 v[40:43], a[116:119], v[128:131], v[40:43]
    s_waitcnt lgkmcnt(6)
    ds_read_b64_tr_b16 v[116:117], v171 offset:40960
    v_max_f32 v231, 0, v231
    v_mfma_f32_16x16x32_bf16 v[44:47], a[108:111], v[132:135], v[44:47]
    s_waitcnt lgkmcnt(3)
    ds_read_b64_tr_b16 v[118:119], v171 offset:43008
    v_add_f32 v231, 0x3727c5ac, v231
    v_mfma_f32_16x16x32_bf16 v[48:51], a[112:115], v[132:135], v[48:51]
    v_rsq_f32 v224, v231
    v_mfma_f32_16x16x32_bf16 v[52:55], a[116:119], v[132:135], v[52:55]
    buffer_load_dwordx4 a[100:103], v248, s[36:39], s62 offen offset:1024 sc1
    v_mfma_f32_16x16x32_bf16 v[8:11], a[120:123], v[104:107], v[8:11]
    ds_read_b64_tr_b16 v[120:121], v168 offset:45056
    v_mul_f32_e64 v226, -v230, v224
    v_mfma_f32_16x16x32_bf16 v[12:15], a[124:127], v[104:107], v[12:15]
    ds_read_b64_tr_b16 v[122:123], v168 offset:47104
    s_mov_b64 exec, 0xf
    buffer_store_dwordx4 v[224:227], v248, s[36:39], s7 offen sc1
    s_mov_b64 exec, -1
    v_mfma_f32_16x16x32_bf16 v[16:19], a[128:131], v[104:107], v[16:19]
    s_and_b32 s50, s3, 1
    s_lshl_b32 s51, s74, 1
    ds_read_b64_tr_b16 v[124:125], v169 offset:45056
    v_mfma_f32_16x16x32_bf16 v[20:23], a[120:123], v[108:111], v[20:23]
    buffer_load_dwordx4 a[104:107], v248, s[36:39], s62 offen offset:2048 sc1
    v_mfma_f32_16x16x32_bf16 v[24:27], a[124:127], v[108:111], v[24:27]
    s_add_u32 s52, s51, s50
    s_mul_i32 s52, s52, 192
    ds_read_b64_tr_b16 v[126:127], v169 offset:47104
    v_mfma_f32_16x16x32_bf16 v[28:31], a[128:131], v[108:111], v[28:31]
    s_waitcnt lgkmcnt(6)
    s_mul_i32 s53, s3, 48
    s_add_u32 s52, s52, s53
    ds_read_b64_tr_b16 v[128:129], v170 offset:45056
    v_mfma_f32_16x16x32_bf16 v[32:35], a[120:123], v[112:115], v[32:35]
    s_lshl_b32 s52, s52, 8
    s_add_u32 s52, s52, 16777216
    ds_read_b64_tr_b16 v[130:131], v170 offset:47104
    v_mfma_f32_16x16x32_bf16 v[36:39], a[124:127], v[112:115], v[36:39]
    buffer_load_dwordx4 a[108:111], v248, s[36:39], s62 offen offset:3072 sc1
    v_mfma_f32_16x16x32_bf16 v[40:43], a[128:131], v[112:115], v[40:43]
    s_waitcnt lgkmcnt(6)
    ds_read_b64_tr_b16 v[132:133], v171 offset:45056
    v_add_u32 v216, s52, v248
    v_mfma_f32_16x16x32_bf16 v[44:47], a[120:123], v[116:119], v[44:47]
    s_waitcnt lgkmcnt(3)
    ds_read_b64_tr_b16 v[134:135], v171 offset:47104
    v_add_u32 v218, 3145728, v216
    v_mfma_f32_16x16x32_bf16 v[48:51], a[124:127], v[116:119], v[48:51]
    s_add_u32 s62, s62, 4096
    v_mfma_f32_16x16x32_bf16 v[52:55], a[128:131], v[116:119], v[52:55]
    buffer_load_dwordx4 a[112:115], v248, s[36:39], s62 offen offset:0 sc1
    v_mfma_f32_16x16x32_bf16 v[8:11], a[132:135], v[120:123], v[8:11]
    s_xor_b32 s50, s50, 1
    s_add_u32 s52, s51, s50
    ds_read_b64_tr_b16 v[104:105], v168 offset:49152
    v_mfma_f32_16x16x32_bf16 v[12:15], a[136:139], v[120:123], v[12:15]
    s_mul_i32 s52, s52, 192
    s_add_u32 s52, s52, s53
    ds_read_b64_tr_b16 v[106:107], v168 offset:51200
    v_mfma_f32_16x16x32_bf16 v[16:19], a[140:143], v[120:123], v[16:19]
    s_lshl_b32 s52, s52, 8
    s_add_u32 s52, s52, 16777216
    ds_read_b64_tr_b16 v[108:109], v169 offset:49152
    v_mfma_f32_16x16x32_bf16 v[20:23], a[132:135], v[124:127], v[20:23]
    buffer_load_dwordx4 a[116:119], v248, s[36:39], s62 offen offset:1024 sc1
    v_mfma_f32_16x16x32_bf16 v[24:27], a[136:139], v[124:127], v[24:27]
    ds_read_b64_tr_b16 v[110:111], v169 offset:51200
    v_add_u32 v217, s52, v248
    v_mfma_f32_16x16x32_bf16 v[28:31], a[140:143], v[124:127], v[28:31]
    s_waitcnt lgkmcnt(6)
    ds_read_b64_tr_b16 v[112:113], v170 offset:49152
    v_add_u32 v219, 3145728, v217
    v_mfma_f32_16x16x32_bf16 v[32:35], a[132:135], v[128:131], v[32:35]
    s_lshr_b32 s50, s74, 1
    s_lshl_b32 s50, s50, 2
    ds_read_b64_tr_b16 v[114:115], v170 offset:51200
    v_mfma_f32_16x16x32_bf16 v[36:39], a[136:139], v[128:131], v[36:39]
    buffer_load_dwordx4 a[120:123], v248, s[36:39], s62 offen offset:2048 sc1
    v_mfma_f32_16x16x32_bf16 v[40:43], a[140:143], v[128:131], v[40:43]
    s_waitcnt lgkmcnt(6)
    s_add_u32 s50, s50, s3
    s_lshl_b32 s50, s50, 9
    ds_read_b64_tr_b16 v[116:117], v171 offset:49152
    v_mfma_f32_16x16x32_bf16 v[44:47], a[132:135], v[132:135], v[44:47]
    s_waitcnt lgkmcnt(3)
    s_add_u32 s50, s50, 89088
    ds_read_b64_tr_b16 v[118:119], v171 offset:51200
    v_mfma_f32_16x16x32_bf16 v[48:51], a[136:139], v[132:135], v[48:51]
    v_mfma_f32_16x16x32_bf16 v[52:55], a[140:143], v[132:135], v[52:55]
    buffer_load_dwordx4 a[124:127], v248, s[36:39], s62 offen offset:3072 sc1
    v_mfma_f32_16x16x32_bf16 v[8:11], a[144:147], v[104:107], v[8:11]
    ds_read_b64_tr_b16 v[120:121], v168 offset:53248
    v_min_u32 v246, 13, v1
    v_mfma_f32_16x16x32_bf16 v[12:15], a[148:151], v[104:107], v[12:15]
    ds_read_b64_tr_b16 v[122:123], v168 offset:55296
    v_lshlrev_b32 v246, 7, v246
    v_mfma_f32_16x16x32_bf16 v[16:19], a[152:155], v[104:107], v[16:19]
    s_add_u32 s62, s62, 4096
    ds_read_b64_tr_b16 v[124:125], v169 offset:53248
    v_mov_b32 v2, s50
    v_mfma_f32_16x16x32_bf16 v[20:23], a[144:147], v[108:111], v[20:23]
    buffer_load_dwordx4 a[128:131], v248, s[36:39], s62 offen offset:0 sc1
    v_mfma_f32_16x16x32_bf16 v[24:27], a[148:151], v[108:111], v[24:27]
    ds_read_b64_tr_b16 v[126:127], v169 offset:55296
    v_mov_b32 v3, 31488
    v_mfma_f32_16x16x32_bf16 v[28:31], a[152:155], v[108:111], v[28:31]
    ds_read_b64_tr_b16 v[128:129], v170 offset:53248
    v_cmp_lt_u32 vcc, 3, v1
    s_nop 1
    v_cndmask_b32 v2, v2, v3, vcc
    s_waitcnt lgkmcnt(7)
    v_mfma_f32_16x16x32_bf16 v[32:35], a[144:147], v[112:115], v[32:35]
    ds_read_b64_tr_b16 v[130:131], v170 offset:55296
    v_add_u32 v246, v246, v2
    v_mfma_f32_16x16x32_bf16 v[36:39], a[148:151], v[112:115], v[36:39]
    buffer_load_dwordx4 a[132:135], v248, s[36:39], s62 offen offset:1024 sc1
    v_mfma_f32_16x16x32_bf16 v[40:43], a[152:155], v[112:115], v[40:43]
    s_waitcnt lgkmcnt(6)
    ds_read_b64_tr_b16 v[132:133], v171 offset:53248
    v_mfma_f32_16x16x32_bf16 v[44:47], a[144:147], v[116:119], v[44:47]
    s_waitcnt lgkmcnt(3)
    ds_read_b64_tr_b16 v[134:135], v171 offset:55296
    v_mfma_f32_16x16x32_bf16 v[48:51], a[148:151], v[116:119], v[48:51]
    buffer_load_dword v247, v246, s[36:39], s17 offen sc1
    v_mfma_f32_16x16x32_bf16 v[52:55], a[152:155], v[116:119], v[52:55]
    buffer_load_dwordx4 a[136:139], v248, s[36:39], s62 offen offset:2048 sc1
    v_mfma_f32_16x16x32_bf16 v[8:11], a[156:159], v[120:123], v[8:11]
    ds_read_b64_tr_b16 v[104:105], v168 offset:57344
    v_mfma_f32_16x16x32_bf16 v[12:15], a[160:163], v[120:123], v[12:15]
    ds_read_b64_tr_b16 v[106:107], v168 offset:59392
    v_mfma_f32_16x16x32_bf16 v[16:19], a[164:167], v[120:123], v[16:19]
    ds_read_b64_tr_b16 v[108:109], v169 offset:57344
    v_mfma_f32_16x16x32_bf16 v[20:23], a[156:159], v[124:127], v[20:23]
    buffer_load_dwordx4 a[140:143], v248, s[36:39], s62 offen offset:3072 sc1
    v_mfma_f32_16x16x32_bf16 v[24:27], a[160:163], v[124:127], v[24:27]
    ds_read_b64_tr_b16 v[110:111], v169 offset:59392
    v_mfma_f32_16x16x32_bf16 v[28:31], a[164:167], v[124:127], v[28:31]
    s_waitcnt lgkmcnt(6)
    ds_read_b64_tr_b16 v[112:113], v170 offset:57344
    v_mfma_f32_16x16x32_bf16 v[32:35], a[156:159], v[128:131], v[32:35]
    s_add_u32 s62, s62, 4096
    ds_read_b64_tr_b16 v[114:115], v170 offset:59392
    v_mfma_f32_16x16x32_bf16 v[36:39], a[160:163], v[128:131], v[36:39]
    buffer_load_dwordx4 a[144:147], v248, s[36:39], s62 offen offset:0 sc1
    v_mfma_f32_16x16x32_bf16 v[40:43], a[164:167], v[128:131], v[40:43]
    s_waitcnt lgkmcnt(6)
    ds_read_b64_tr_b16 v[116:117], v171 offset:57344
    v_mfma_f32_16x16x32_bf16 v[44:47], a[156:159], v[132:135], v[44:47]
    s_waitcnt lgkmcnt(3)
    ds_read_b64_tr_b16 v[118:119], v171 offset:59392
    v_mfma_f32_16x16x32_bf16 v[48:51], a[160:163], v[132:135], v[48:51]
    v_mfma_f32_16x16x32_bf16 v[52:55], a[164:167], v[132:135], v[52:55]
    buffer_load_dwordx4 a[148:151], v248, s[36:39], s62 offen offset:1024 sc1
    v_mfma_f32_16x16x32_bf16 v[8:11], a[168:171], v[104:107], v[8:11]
    ds_read_b64_tr_b16 v[120:121], v168 offset:61440
    v_mfma_f32_16x16x32_bf16 v[12:15], a[172:175], v[104:107], v[12:15]
    ds_read_b64_tr_b16 v[122:123], v168 offset:63488
    v_add_u32 v168, 65536, v168
    v_mfma_f32_16x16x32_bf16 v[16:19], a[176:179], v[104:107], v[16:19]
    ds_read_b64_tr_b16 v[124:125], v169 offset:61440
    v_mfma_f32_16x16x32_bf16 v[20:23], a[168:171], v[108:111], v[20:23]
    buffer_load_dwordx4 a[152:155], v248, s[36:39], s62 offen offset:2048 sc1
    v_mfma_f32_16x16x32_bf16 v[24:27], a[172:175], v[108:111], v[24:27]
    ds_read_b64_tr_b16 v[126:127], v169 offset:63488
    v_add_u32 v169, 65536, v169
    v_mfma_f32_16x16x32_bf16 v[28:31], a[176:179], v[108:111], v[28:31]
    s_waitcnt lgkmcnt(6)
    ds_read_b64_tr_b16 v[128:129], v170 offset:61440
    v_mfma_f32_16x16x32_bf16 v[32:35], a[168:171], v[112:115], v[32:35]
    s_add_u32 m0, s63, 1024
    ds_read_b64_tr_b16 v[130:131], v170 offset:63488
    v_add_u32 v170, 65536, v170
    v_mfma_f32_16x16x32_bf16 v[36:39], a[172:175], v[112:115], v[36:39]
    buffer_load_dwordx4 v248, s[36:39], s6 offen sc1 lds
    v_mfma_f32_16x16x32_bf16 v[40:43], a[176:179], v[112:115], v[40:43]
    s_waitcnt lgkmcnt(6)
    ds_read_b64_tr_b16 v[132:133], v171 offset:61440
    v_mfma_f32_16x16x32_bf16 v[44:47], a[168:171], v[116:119], v[44:47]
    s_waitcnt lgkmcnt(3)
    ds_read_b64_tr_b16 v[134:135], v171 offset:63488
    v_add_u32 v171, 65536, v171
    v_mfma_f32_16x16x32_bf16 v[48:51], a[172:175], v[116:119], v[48:51]
    v_mfma_f32_16x16x32_bf16 v[52:55], a[176:179], v[116:119], v[52:55]
    buffer_load_dwordx4 a[156:159], v248, s[36:39], s62 offen offset:3072 sc1
    v_mfma_f32_16x16x32_bf16 v[8:11], a[180:183], v[120:123], v[8:11]
    ds_read_b64_tr_b16 v[104:105], v168 offset:0
    v_mfma_f32_16x16x32_bf16 v[12:15], a[184:187], v[120:123], v[12:15]
    ds_read_b64_tr_b16 v[106:107], v168 offset:2048
    v_mfma_f32_16x16x32_bf16 v[16:19], a[188:191], v[120:123], v[16:19]
    s_add_u32 s62, s62, 4096
    ds_read_b64_tr_b16 v[108:109], v169 offset:0
    v_mfma_f32_16x16x32_bf16 v[20:23], a[180:183], v[124:127], v[20:23]
    buffer_load_dwordx4 a[160:163], v248, s[36:39], s62 offen offset:0 sc1
    v_mfma_f32_16x16x32_bf16 v[24:27], a[184:187], v[124:127], v[24:27]
    ds_read_b64_tr_b16 v[110:111], v169 offset:2048
    v_mfma_f32_16x16x32_bf16 v[28:31], a[188:191], v[124:127], v[28:31]
    s_waitcnt lgkmcnt(6)
    ds_read_b64_tr_b16 v[112:113], v170 offset:0
    v_mfma_f32_16x16x32_bf16 v[32:35], a[180:183], v[128:131], v[32:35]
    ds_read_b64_tr_b16 v[114:115], v170 offset:2048
    v_mfma_f32_16x16x32_bf16 v[36:39], a[184:187], v[128:131], v[36:39]
    buffer_load_dwordx4 a[164:167], v248, s[36:39], s62 offen offset:1024 sc1
    v_mfma_f32_16x16x32_bf16 v[40:43], a[188:191], v[128:131], v[40:43]
    s_waitcnt lgkmcnt(6)
    ds_read_b64_tr_b16 v[116:117], v171 offset:0
    v_mfma_f32_16x16x32_bf16 v[44:47], a[180:183], v[132:135], v[44:47]
    s_waitcnt lgkmcnt(3)
    ds_read_b64_tr_b16 v[118:119], v171 offset:2048
    v_mfma_f32_16x16x32_bf16 v[48:51], a[184:187], v[132:135], v[48:51]
    s_waitcnt vmcnt(9)
    v_cmp_ne_u32 vcc, s48, v247
    s_cbranch_vccnz L_chk12_slow
L_chk12_back:
    v_mfma_f32_16x16x32_bf16 v[52:55], a[188:191], v[132:135], v[52:55]
    buffer_load_dwordx4 v[56:59], v216, s[36:39], 0 offen offset:0 sc1
    v_mfma_f32_16x16x32_bf16 v[8:11], a[192:195], v[104:107], v[8:11]
    ds_read_b64_tr_b16 v[120:121], v168 offset:4096
    v_mfma_f32_16x16x32_bf16 v[12:15], a[196:199], v[104:107], v[12:15]
    ds_read_b64_tr_b16 v[122:123], v168 offset:6144
    v_mfma_f32_16x16x32_bf16 v[16:19], a[200:203], v[104:107], v[16:19]
    ds_read_b64_tr_b16 v[124:125], v169 offset:4096
    v_mfma_f32_16x16x32_bf16 v[20:23], a[192:195], v[108:111], v[20:23]
    buffer_load_dwordx4 v[60:63], v217, s[36:39], 0 offen offset:0 sc1
    v_mfma_f32_16x16x32_bf16 v[24:27], a[196:199], v[108:111], v[24:27]
    ds_read_b64_tr_b16 v[126:127], v169 offset:6144
    v_mfma_f32_16x16x32_bf16 v[28:31], a[200:203], v[108:111], v[28:31]
    s_waitcnt lgkmcnt(6)
    ds_read_b64_tr_b16 v[128:129], v170 offset:4096
    v_mfma_f32_16x16x32_bf16 v[32:35], a[192:195], v[112:115], v[32:35]
    ds_read_b64_tr_b16 v[130:131], v170 offset:6144
    v_mfma_f32_16x16x32_bf16 v[36:39], a[196:199], v[112:115], v[36:39]
    buffer_load_dwordx4 v[64:67], v216, s[36:39], 0 offen offset:1024 sc1
    v_mfma_f32_16x16x32_bf16 v[40:43], a[200:203], v[112:115], v[40:43]
    s_waitcnt lgkmcnt(6)
    ds_read_b64_tr_b16 v[132:133], v171 offset:4096
    v_mfma_f32_16x16x32_bf16 v[44:47], a[192:195], v[116:119], v[44:47]
    s_waitcnt lgkmcnt(3)
    ds_read_b64_tr_b16 v[134:135], v171 offset:6144
    v_mfma_f32_16x16x32_bf16 v[48:51], a[196:199], v[116:119], v[48:51]
    v_mfma_f32_16x16x32_bf16 v[52:55], a[200:203], v[116:119], v[52:55]
    buffer_load_dwordx4 v[68:71], v217, s[36:39], 0 offen offset:1024 sc1
    v_mfma_f32_16x16x32_bf16 v[8:11], a[204:207], v[120:123], v[8:11]
    ds_read_b64_tr_b16 v[104:105], v168 offset:8192
    v_mfma_f32_16x16x32_bf16 v[12:15], a[208:211], v[120:123], v[12:15]
    ds_read_b64_tr_b16 v[106:107], v168 offset:10240
    v_mfma_f32_16x16x32_bf16 v[16:19], a[212:215], v[120:123], v[16:19]
    ds_read_b64_tr_b16 v[108:109], v169 offset:8192
    v_mfma_f32_16x16x32_bf16 v[20:23], a[204:207], v[124:127], v[20:23]
    buffer_load_dwordx4 v[72:75], v216, s[36:39], 0 offen offset:2048 sc1
    v_mfma_f32_16x16x32_bf16 v[24:27], a[208:211], v[124:127], v[24:27]
    ds_read_b64_tr_b16 v[110:111], v169 offset:10240
    v_mfma_f32_16x16x32_bf16 v[28:31], a[212:215], v[124:127], v[28:31]
    s_waitcnt lgkmcnt(6)
    ds_read_b64_tr_b16 v[112:113], v170 offset:8192
    v_mfma_f32_16x16x32_bf16 v[32:35], a[204:207], v[128:131], v[32:35]
    ds_read_b64_tr_b16 v[114:115], v170 offset:10240
    v_mfma_f32_16x16x32_bf16 v[36:39], a[208:211], v[128:131], v[36:39]
    buffer_load_dwordx4 v[76:79], v217, s[36:39], 0 offen offset:2048 sc1
    v_mfma_f32_16x16x32_bf16 v[40:43], a[212:215], v[128:131], v[40:43]
    s_waitcnt lgkmcnt(6)
    ds_read_b64_tr_b16 v[116:117], v171 offset:8192
    v_mfma_f32_16x16x32_bf16 v[44:47], a[204:207], v[132:135], v[44:47]
    s_waitcnt lgkmcnt(3)
    ds_read_b64_tr_b16 v[118:119], v171 offset:10240
    v_mfma_f32_16x16x32_bf16 v[48:51], a[208:211], v[132:135], v[48:51]
    v_mfma_f32_16x16x32_bf16 v[52:55], a[212:215], v[132:135], v[52:55]
    buffer_load_dwordx4 v[80:83], v216, s[36:39], 0 offen offset:3072 sc1
    v_mfma_f32_16x16x32_bf16 v[8:11], a[216:219], v[104:107], v[8:11]
    ds_read_b64_tr_b16 v[120:121], v168 offset:12288
    v_mfma_f32_16x16x32_bf16 v[12:15], a[220:223], v[104:107], v[12:15]
    ds_read_b64_tr_b16 v[122:123], v168 offset:14336
    v_mfma_f32_16x16x32_bf16 v[16:19], a[224:227], v[104:107], v[16:19]
    ds_read_b64_tr_b16 v[124:125], v169 offset:12288
    v_mfma_f32_16x16x32_bf16 v[20:23], a[216:219], v[108:111], v[20:23]
    buffer_load_dwordx4 v[84:87], v217, s[36:39], 0 offen offset:3072 sc1
    v_mfma_f32_16x16x32_bf16 v[24:27], a[220:223], v[108:111], v[24:27]
    ds_read_b64_tr_b16 v[126:127], v169 offset:14336
    v_mfma_f32_16x16x32_bf16 v[28:31], a[224:227], v[108:111], v[28:31]
    s_waitcnt lgkmcnt(6)
    ds_read_b64_tr_b16 v[128:129], v170 offset:12288
    v_mfma_f32_16x16x32_bf16 v[32:35], a[216:219], v[112:115], v[32:35]
    s_waitcnt vmcnt(11)
    ds_read_b64_tr_b16 v[130:131], v170 offset:14336
    ds_read_b128 v[200:203], v175 offset:1024
    v_mfma_f32_16x16x32_bf16 v[36:39], a[220:223], v[112:115], v[36:39]
    buffer_load_dwordx4 v[88:91], v216, s[36:39], s4 offen offset:0 sc1
    v_mfma_f32_16x16x32_bf16 v[40:43], a[224:227], v[112:115], v[40:43]
    s_waitcnt lgkmcnt(7)
    ds_read_b64_tr_b16 v[132:133], v171 offset:12288
    ds_read_b128 v[204:207], v175 offset:1280
    v_mfma_f32_16x16x32_bf16 v[44:47], a[216:219], v[116:119], v[44:47]
    s_waitcnt lgkmcnt(3)
    ds_read_b64_tr_b16 v[134:135], v171 offset:14336
    v_mfma_f32_16x16x32_bf16 v[48:51], a[220:223], v[116:119], v[48:51]
    ds_read_b128 v[208:211], v175 offset:1536
    ds_read_b128 v[212:215], v175 offset:1792
    v_mfma_f32_16x16x32_bf16 v[52:55], a[224:227], v[116:119], v[52:55]
    buffer_load_dwordx4 v[92:95], v217, s[36:39], s4 offen offset:0 sc1
    v_mfma_f32_16x16x32_bf16 v[8:11], a[228:231], v[120:123], v[8:11]
    v_mfma_f32_16x16x32_bf16 v[12:15], a[232:235], v[120:123], v[12:15]
    s_waitcnt lgkmcnt(5)
    v_xor_b32 v3, s48, v201
    v_bitop3_b32 v3, v203, s48, v3 bitop3:0xbe
    v_mfma_f32_16x16x32_bf16 v[16:19], a[236:239], v[120:123], v[16:19]
    s_waitcnt lgkmcnt(3)
    v_bitop3_b32 v3, v205, s48, v3 bitop3:0xbe
    v_bitop3_b32 v3, v207, s48, v3 bitop3:0xbe
    v_mfma_f32_16x16x32_bf16 v[20:23], a[228:231], v[124:127], v[20:23]
    buffer_load_dwordx4 v[96:99], v216, s[36:39], s4 offen offset:1024 sc1
    v_mfma_f32_16x16x32_bf16 v[24:27], a[232:235], v[124:127], v[24:27]
    s_waitcnt lgkmcnt(1)
    v_bitop3_b32 v3, v209, s48, v3 bitop3:0xbe
    v_bitop3_b32 v3, v211, s48, v3 bitop3:0xbe
    v_mfma_f32_16x16x32_bf16 v[28:31], a[236:239], v[124:127], v[28:31]
    s_waitcnt lgkmcnt(0)
    v_bitop3_b32 v3, v213, s48, v3 bitop3:0xbe
    v_bitop3_b32 v3, v215, s48, v3 bitop3:0xbe
    v_mfma_f32_16x16x32_bf16 v[32:35], a[228:231], v[128:131], v[32:35]
    v_cmp_ne_u32 vcc, 0, v3
    s_cbranch_vccnz L_stc1_slow
L_stc1_back:
    v_mfma_f32_16x16x32_bf16 v[36:39], a[232:235], v[128:131], v[36:39]
    buffer_load_dwordx4 v[100:103], v217, s[36:39], s4 offen offset:1024 sc1
    v_mfma_f32_16x16x32_bf16 v[40:43], a[236:239], v[128:131], v[40:43]
    v_mfma_f32_16x16x32_bf16 v[44:47], a[228:231], v[132:135], v[44:47]
    v_mfma_f32_16x16x32_bf16 v[48:51], a[232:235], v[132:135], v[48:51]
    v_mfma_f32_16x16x32_bf16 v[52:55], a[236:239], v[132:135], v[52:55]
    s_add_u32 s8, s8, 3145728
    s_add_u32 s50, s8, 98304
    v_pk_fma_f32 v[238:239], v[176:177], v[202:203], v[188:189] op_sel_hi:[1,0,1]
    v_pk_fma_f32 v[240:241], v[178:179], v[202:203], v[190:191] op_sel_hi:[1,0,1]
    v_pk_fma_f32 v[8:9], v[8:9], v[200:201], v[238:239] op_sel_hi:[1,0,1]
    v_pk_fma_f32 v[10:11], v[10:11], v[200:201], v[240:241] op_sel_hi:[1,0,1]
    v_pk_fma_f32 v[242:243], v[180:181], v[202:203], v[192:193] op_sel_hi:[1,0,1]
    v_pk_fma_f32 v[244:245], v[182:183], v[202:203], v[194:195] op_sel_hi:[1,0,1]
    v_pk_fma_f32 v[12:13], v[12:13], v[200:201], v[242:243] op_sel_hi:[1,0,1]
    v_pk_fma_f32 v[14:15], v[14:15], v[200:201], v[244:245] op_sel_hi:[1,0,1]
    v_pk_mul_f32 v[8:9], v[8:9], v[12:13]
    v_pk_mul_f32 v[10:11], v[10:11], v[14:15]
    v_cvt_pk_bf16_f32 v12, v8, v9
    v_cvt_pk_bf16_f32 v13, v10, v11
    v_pk_fma_f32 v[242:243], v[176:177], v[206:207], v[188:189] op_sel_hi:[1,0,1]
    v_pk_fma_f32 v[244:245], v[178:179], v[206:207], v[190:191] op_sel_hi:[1,0,1]
    v_pk_fma_f32 v[20:21], v[20:21], v[204:205], v[242:243] op_sel_hi:[1,0,1]
    v_pk_fma_f32 v[22:23], v[22:23], v[204:205], v[244:245] op_sel_hi:[1,0,1]
    v_pk_fma_f32 v[238:239], v[180:181], v[206:207], v[192:193] op_sel_hi:[1,0,1]
    v_pk_fma_f32 v[240:241], v[182:183], v[206:207], v[194:195] op_sel_hi:[1,0,1]
    v_pk_fma_f32 v[24:25], v[24:25], v[204:205], v[238:239] op_sel_hi:[1,0,1]
    v_pk_fma_f32 v[26:27], v[26:27], v[204:205], v[240:241] op_sel_hi:[1,0,1]
    v_pk_mul_f32 v[20:21], v[20:21], v[24:25]
    v_pk_mul_f32 v[22:23], v[22:23], v[26:27]
    v_cvt_pk_bf16_f32 v14, v20, v21
    v_cvt_pk_bf16_f32 v15, v22, v23
    s_nop 0
    v_permlane16_swap_b32 v12, v14
    v_permlane16_swap_b32 v13, v15
    buffer_store_dwordx4 v[12:15], v173, s[36:39], s8 offen sc1
    v_pk_fma_f32 v[238:239], v[176:177], v[210:211], v[188:189] op_sel_hi:[1,0,1]
    v_pk_fma_f32 v[240:241], v[178:179], v[210:211], v[190:191] op_sel_hi:[1,0,1]
    v_pk_fma_f32 v[32:33], v[32:33], v[208:209], v[238:239] op_sel_hi:[1,0,1]
    v_pk_fma_f32 v[34:35], v[34:35], v[208:209], v[240:241] op_sel_hi:[1,0,1]
    v_pk_fma_f32 v[242:243], v[180:181], v[210:211], v[192:193] op_sel_hi:[1,0,1]
    v_pk_fma_f32 v[244:245], v[182:183], v[210:211], v[194:195] op_sel_hi:[1,0,1]
    v_pk_fma_f32 v[36:37], v[36:37], v[208:209], v[242:243] op_sel_hi:[1,0,1]
    v_pk_fma_f32 v[38:39], v[38:39], v[208:209], v[244:245] op_sel_hi:[1,0,1]
    v_pk_mul_f32 v[32:33], v[32:33], v[36:37]
    v_pk_mul_f32 v[34:35], v[34:35], v[38:39]
    v_cvt_pk_bf16_f32 v36, v32, v33
    v_cvt_pk_bf16_f32 v37, v34, v35
    v_pk_fma_f32 v[242:243], v[176:177], v[214:215], v[188:189] op_sel_hi:[1,0,1]
    v_pk_fma_f32 v[244:245], v[178:179], v[214:215], v[190:191] op_sel_hi:[1,0,1]
    v_pk_fma_f32 v[44:45], v[44:45], v[212:213], v[242:243] op_sel_hi:[1,0,1]
    v_pk_fma_f32 v[46:47], v[46:47], v[212:213], v[244:245] op_sel_hi:[1,0,1]
    v_pk_fma_f32 v[238:239], v[180:181], v[214:215], v[192:193] op_sel_hi:[1,0,1]
    v_pk_fma_f32 v[240:241], v[182:183], v[214:215], v[194:195] op_sel_hi:[1,0,1]
    v_pk_fma_f32 v[48:49], v[48:49], v[212:213], v[238:239] op_sel_hi:[1,0,1]
    v_pk_fma_f32 v[50:51], v[50:51], v[212:213], v[240:241] op_sel_hi:[1,0,1]
    v_pk_mul_f32 v[44:45], v[44:45], v[48:49]
    v_pk_mul_f32 v[46:47], v[46:47], v[50:51]
    v_cvt_pk_bf16_f32 v38, v44, v45
    v_cvt_pk_bf16_f32 v39, v46, v47
    s_nop 0
    v_permlane16_swap_b32 v36, v38
    v_permlane16_swap_b32 v37, v39
    buffer_store_dwordx4 v[36:39], v173, s[36:39], s50 offen sc1
    v_pk_fma_f32 v[238:239], v[184:185], v[202:203], v[196:197] op_sel_hi:[1,0,1]
    v_pk_fma_f32 v[240:241], v[186:187], v[202:203], v[198:199] op_sel_hi:[1,0,1]
    v_pk_fma_f32 v[16:17], v[16:17], v[200:201], v[238:239] op_sel_hi:[1,0,1]
    v_pk_fma_f32 v[18:19], v[18:19], v[200:201], v[240:241] op_sel_hi:[1,0,1]
    v_pk_fma_f32 v[242:243], v[184:185], v[206:207], v[196:197] op_sel_hi:[1,0,1]
    v_pk_fma_f32 v[244:245], v[186:187], v[206:207], v[198:199] op_sel_hi:[1,0,1]
    v_pk_fma_f32 v[28:29], v[28:29], v[204:205], v[242:243] op_sel_hi:[1,0,1]
    v_pk_fma_f32 v[30:31], v[30:31], v[204:205], v[244:245] op_sel_hi:[1,0,1]
    s_nop 0
    v_permlane32_swap_b32 v16, v28
    v_permlane32_swap_b32 v17, v29
    v_permlane32_swap_b32 v18, v30
    v_permlane32_swap_b32 v19, v31
    v_pk_mul_f32 v[16:17], v[16:17], v[28:29]
    v_pk_mul_f32 v[18:19], v[18:19], v[30:31]
    v_cvt_pk_bf16_f32 v8, v16, v17
    v_cvt_pk_bf16_f32 v9, v18, v19
    v_pk_fma_f32 v[238:239], v[184:185], v[210:211], v[196:197] op_sel_hi:[1,0,1]
    v_pk_fma_f32 v[240:241], v[186:187], v[210:211], v[198:199] op_sel_hi:[1,0,1]
    v_pk_fma_f32 v[40:41], v[40:41], v[208:209], v[238:239] op_sel_hi:[1,0,1]
    v_pk_fma_f32 v[42:43], v[42:43], v[208:209], v[240:241] op_sel_hi:[1,0,1]
    v_pk_fma_f32 v[242:243], v[184:185], v[214:215], v[196:197] op_sel_hi:[1,0,1]
    v_pk_fma_f32 v[244:245], v[186:187], v[214:215], v[198:199] op_sel_hi:[1,0,1]
    v_pk_fma_f32 v[52:53], v[52:53], v[212:213], v[242:243] op_sel_hi:[1,0,1]
    v_pk_fma_f32 v[54:55], v[54:55], v[212:213], v[244:245] op_sel_hi:[1,0,1]
    s_nop 0
    v_permlane32_swap_b32 v40, v52
    v_permlane32_swap_b32 v41, v53
    v_permlane32_swap_b32 v42, v54
    v_permlane32_swap_b32 v43, v55
    v_pk_mul_f32 v[40:41], v[40:41], v[52:53]
    v_pk_mul_f32 v[42:43], v[42:43], v[54:55]
    v_cvt_pk_bf16_f32 v10, v40, v41
    v_cvt_pk_bf16_f32 v11, v42, v43
    s_nop 0
    v_permlane16_swap_b32 v8, v10
    v_permlane16_swap_b32 v9, v11
    buffer_store_dwordx4 v[8:11], v174, s[36:39], s8 offen offset:512 sc1
    s_mov_b32 s40, s28
    s_mov_b32 s41, s29
    s_mov_b32 s42, 0x280000
    s_mov_b32 s43, 0x20000
    s_waitcnt vmcnt(14)
    v_mfma_f32_16x16x32_bf16 v[8:11], a[240:243], v[56:59], 0
    s_and_b32 s50, s3, 1
    s_lshr_b32 s51, s3, 1
    buffer_load_dwordx4 a[168:171], v248, s[36:39], s62 offen offset:2048 sc1
    v_mfma_f32_16x16x32_bf16 v[12:15], a[244:247], v[56:59], 0
    s_mul_i32 s52, s50, 20480
    s_mul_i32 s53, s3, 5120
    s_add_u32 s52, s52, s53
    v_mfma_f32_16x16x32_bf16 v[16:19], a[248:251], v[56:59], 0
    v_add_u32 v220, s52, v248
    v_add_u32 v222, 40960, v220
    v_mfma_f32_16x16x32_bf16 v[20:23], a[252:255], v[56:59], 0
    s_xor_b32 s52, s50, 1
    s_mul_i32 s52, s52, 20480
    s_add_u32 s52, s52, s53
    buffer_load_dwordx4 a[172:175], v248, s[36:39], s62 offen offset:3072 sc1
    v_mfma_f32_16x16x32_bf16 v[24:27], v[136:139], v[56:59], 0
    s_waitcnt vmcnt(15)
    v_add_u32 v221, s52, v248
    v_add_u32 v223, 40960, v221
    v_mfma_f32_16x16x32_bf16 v[28:31], a[240:243], v[60:63], 0
    s_mul_i32 s52, s51, 20480
    s_lshl_b32 s53, s50, 11
    s_add_u32 s52, s52, s53
    v_add_u32 v224, s52, v248
    v_mfma_f32_16x16x32_bf16 v[32:35], a[244:247], v[60:63], 0
    buffer_load_dwordx4 v[56:59], v216, s[36:39], s4 offen offset:2048 sc1
    v_mfma_f32_16x16x32_bf16 v[36:39], a[248:251], v[60:63], 0
    s_mul_i32 s53, s51, 5120
    s_add_u32 s53, s53, 40960
    v_add_u32 v225, s53, v224
    v_mfma_f32_16x16x32_bf16 v[40:43], a[252:255], v[60:63], 0
    s_add_u32 s62, s62, 4096
    s_xor_b32 s53, s51, 1
    s_mul_i32 s53, s53, 5120
    v_mfma_f32_16x16x32_bf16 v[44:47], v[136:139], v[60:63], 0
    s_waitcnt vmcnt(15)
    s_add_u32 s53, s53, 40960
    v_add_u32 v226, s53, v224
    buffer_load_dwordx4 a[176:179], v248, s[36:39], s62 offen offset:0 sc1
    v_mfma_f32_16x16x32_bf16 v[8:11], v[140:143], v[64:67], v[8:11]
    s_lshl_b32 s52, s74, 1
    s_add_u32 s52, s52, s51
    s_mul_i32 s12, s75, 320
    v_mfma_f32_16x16x32_bf16 v[12:15], v[144:147], v[64:67], v[12:15]
    s_add_u32 s12, s12, 23147008
    s_mul_i32 s13, s52, 20480
    s_mul_i32 s53, s75, 160
    s_add_u32 s13, s13, s53
    v_mfma_f32_16x16x32_bf16 v[16:19], v[148:151], v[64:67], v[16:19]
    s_lshl_b32 s53, s50, 6
    s_add_u32 s13, s13, s53
    s_add_u32 s14, s13, 1310720
    buffer_load_dwordx4 v[60:63], v217, s[36:39], s4 offen offset:2048 sc1
    v_mfma_f32_16x16x32_bf16 v[20:23], v[152:155], v[64:67], v[20:23]
    s_mul_i32 s10, s75, 10
    s_add_u32 s10, s10, s3
    v_mfma_f32_16x16x32_bf16 v[24:27], v[156:159], v[64:67], v[24:27]
    s_mul_i32 s10, s10, 32768
    s_lshl_b32 s53, s74, 6
    s_add_u32 s10, s10, s53
    s_add_u32 s10, s10, 0
    s_waitcnt vmcnt(16)
    v_mfma_f32_16x16x32_bf16 v[28:31], v[140:143], v[68:71], v[28:31]
    s_lshl_b32 s11, s3, 10
    s_add_u32 s11, s11, 81920
    v_lshrrev_b32 v2, 3, v1
    buffer_load_dwordx4 v[64:67], v216, s[36:39], s4 offen offset:3072 sc1
    v_mfma_f32_16x16x32_bf16 v[32:35], v[144:147], v[68:71], v[32:35]
    v_mul_u32_u24 v229, 4096, v2
    v_bfe_u32 v2, v1, 2, 1
    v_mfma_f32_16x16x32_bf16 v[36:39], v[148:151], v[68:71], v[36:39]
    v_lshl_add_u32 v229, v2, 11, v229
    v_and_b32 v2, 3, v1
    v_lshl_add_u32 v229, v2, 4, v229
    v_mfma_f32_16x16x32_bf16 v[40:43], v[152:155], v[68:71], v[40:43]
    buffer_load_dwordx4 a[180:183], v248, s[36:39], s62 offen offset:1024 sc1
    v_mfma_f32_16x16x32_bf16 v[44:47], v[156:159], v[68:71], v[44:47]
    s_waitcnt vmcnt(17)
    v_lshrrev_b32 v3, 2, v1
    v_lshlrev_b32 v231, 7, v3
    v_mfma_f32_16x16x32_bf16 v[8:11], v[160:163], v[72:75], v[8:11]
    s_barrier
    v_lshl_add_u32 v231, v2, 3, v231
    v_mfma_f32_16x16x32_bf16 v[12:15], v[164:167], v[72:75], v[12:15]
    s_lshl_b32 s53, s50, 12
    s_lshl_b32 s52, s51, 5
    s_add_u32 s53, s53, s52
    s_add_u32 s53, s53, 81920
    buffer_load_dwordx4 v[68:71], v217, s[36:39], s4 offen offset:3072 sc1
    v_mfma_f32_16x16x32_bf16 v[16:19], a[0:3], v[72:75], v[16:19]
    v_add_u32 v231, s53, v231
    v_and_b32 v2, 15, v1
    v_mfma_f32_16x16x32_bf16 v[20:23], a[4:7], v[72:75], v[20:23]
    v_lshrrev_b32 v3, 4, v1
    v_mul_u32_u24 v2, 1280, v2
    v_lshl_add_u32 v228, v3, 3, v2
    v_and_b32 v227, 1, v3
    v_mfma_f32_16x16x32_bf16 v[24:27], a[8:11], v[72:75], v[24:27]
    s_waitcnt vmcnt(17)
    buffer_load_dwordx4 a[184:187], v248, s[36:39], s62 offen offset:2048 sc1
    v_mfma_f32_16x16x32_bf16 v[28:31], v[160:163], v[76:79], v[28:31]
    v_lshl_add_u32 v2, v227, 5, v2
    v_lshrrev_b32 v3, 1, v3
    v_mfma_f32_16x16x32_bf16 v[32:35], v[164:167], v[76:79], v[32:35]
    v_lshl_add_u32 v227, v3, 4, v2
    v_mfma_f32_16x16x32_bf16 v[36:39], a[0:3], v[76:79], v[36:39]
    s_lshr_b32 s50, s74, 1
    s_lshl_b32 s50, s50, 2
    s_add_u32 s50, s50, s3
    s_lshl_b32 s50, s50, 9
    buffer_load_dwordx4 v[72:75], v216, s[36:39], s5 offen offset:0 sc1
    v_mfma_f32_16x16x32_bf16 v[40:43], a[4:7], v[76:79], v[40:43]
    s_add_u32 s50, s50, 121856
    v_min_u32 v246, 3, v1
    v_lshlrev_b32 v246, 7, v246
    v_mfma_f32_16x16x32_bf16 v[44:47], a[8:11], v[76:79], v[44:47]
    s_waitcnt vmcnt(18)
    v_add_u32 v246, s50, v246
    v_min_u32 v2, 23, v1
    v_mfma_f32_16x16x32_bf16 v[8:11], a[12:15], v[80:83], v[8:11]
    buffer_load_dwordx4 v[76:79], v217, s[36:39], s5 offen offset:0 sc1
    v_mfma_f32_16x16x32_bf16 v[12:15], a[16:19], v[80:83], v[12:15]
    v_lshlrev_b32 v244, 4, v2
    v_mov_b32 v3, 36160
    v_mfma_f32_16x16x32_bf16 v[16:19], a[20:23], v[80:83], v[16:19]
    v_cmp_lt_u32 vcc, 11, v2
    s_nop 1
    v_cndmask_b32 v3, 0, v3, vcc
    v_mfma_f32_16x16x32_bf16 v[20:23], a[24:27], v[80:83], v[20:23]
    s_and_b32 s53, s3, 1
    s_lshl_b32 s53, s53, 7
    v_add3_u32 v244, v244, v3, s53
    buffer_load_dwordx4 a[188:191], v248, s[36:39], s62 offen offset:3072 sc1
    v_mfma_f32_16x16x32_bf16 v[24:27], a[28:31], v[80:83], v[24:27]
    s_waitcnt vmcnt(19)
    s_lshl_b32 s15, s3, 10
    s_add_u32 s15, s15, 94208
    v_and_b32 v230, 48, v1
    v_mfma_f32_16x16x32_bf16 v[28:31], a[12:15], v[84:87], v[28:31]
    v_add_u32 v230, s15, v230
    v_mfma_f32_16x16x32_bf16 v[32:35], a[16:19], v[84:87], v[32:35]
    s_mov_b32 m0, s15
    buffer_load_dwordx4 v[80:83], v216, s[36:39], s5 offen offset:1024 sc1
    v_mfma_f32_16x16x32_bf16 v[36:39], a[20:23], v[84:87], v[36:39]
    buffer_load_dwordx4 v244, s[36:39], s12 offen sc1 lds
    v_mfma_f32_16x16x32_bf16 v[40:43], a[24:27], v[84:87], v[40:43]
    s_add_u32 m0, s11, 0
    v_mfma_f32_16x16x32_bf16 v[44:47], a[28:31], v[84:87], v[44:47]
    s_waitcnt vmcnt(20)
    buffer_load_dwordx4 v229, s[36:39], s10 offen sc1 lds
    v_mfma_f32_16x16x32_bf16 v[8:11], a[32:35], v[88:91], v[8:11]
    s_waitcnt vmcnt(15)
    s_barrier
    s_cmp_eq_u32 s3, 0
    s_cbranch_scc0 L_wf13
    s_lshl_b32 s54, s76, 7
    s_add_u32 s54, s54, 23321600
    v_mov_b32 v254, 0
    v_mov_b32 v255, s48
    s_mov_b64 exec, 1
    buffer_store_dword v255, v254, s[36:39], s54 offen sc1
    s_mov_b64 exec, -1
L_wf13:
    v_mfma_f32_16x16x32_bf16 v[12:15], a[36:39], v[88:91], v[12:15]
    s_add_u32 s10, s10, 131072
    v_mfma_f32_16x16x32_bf16 v[16:19], a[40:43], v[88:91], v[16:19]
    buffer_load_dwordx4 v[84:87], v217, s[36:39], s5 offen offset:1024 sc1
    v_mfma_f32_16x16x32_bf16 v[20:23], a[44:47], v[88:91], v[20:23]
    v_mfma_f32_16x16x32_bf16 v[24:27], a[48:51], v[88:91], v[24:27]
    s_add_u32 m0, s11, 4096
    v_mfma_f32_16x16x32_bf16 v[28:31], a[32:35], v[92:95], v[28:31]
    buffer_load_dwordx4 v229, s[36:39], s10 offen sc1 lds
    v_mfma_f32_16x16x32_bf16 v[32:35], a[36:39], v[92:95], v[32:35]
    s_add_u32 s10, s10, 131072
    v_mfma_f32_16x16x32_bf16 v[36:39], a[40:43], v[92:95], v[36:39]
    s_add_u32 m0, s11, 8192
    v_mfma_f32_16x16x32_bf16 v[40:43], a[44:47], v[92:95], v[40:43]
    buffer_load_dwordx4 v229, s[36:39], s10 offen sc1 lds
    v_mfma_f32_16x16x32_bf16 v[44:47], a[48:51], v[92:95], v[44:47]
    v_mfma_f32_16x16x32_bf16 v[8:11], a[52:55], v[96:99], v[8:11]
    v_mfma_f32_16x16x32_bf16 v[12:15], a[56:59], v[96:99], v[12:15]
    buffer_load_dwordx4 v[88:91], v216, s[36:39], s5 offen offset:2048 sc1
    v_mfma_f32_16x16x32_bf16 v[16:19], a[60:63], v[96:99], v[16:19]
    v_mfma_f32_16x16x32_bf16 v[20:23], a[64:67], v[96:99], v[20:23]
    v_mfma_f32_16x16x32_bf16 v[24:27], a[68:71], v[96:99], v[24:27]
    buffer_load_dwordx4 v[92:95], v217, s[36:39], s5 offen offset:2048 sc1
    v_mfma_f32_16x16x32_bf16 v[28:31], a[52:55], v[100:103], v[28:31]
    v_mfma_f32_16x16x32_bf16 v[32:35], a[56:59], v[100:103], v[32:35]
    v_mfma_f32_16x16x32_bf16 v[36:39], a[60:63], v[100:103], v[36:39]
    buffer_load_dwordx4 v[96:99], v216, s[36:39], s5 offen offset:3072 sc1
    v_mfma_f32_16x16x32_bf16 v[40:43], a[64:67], v[100:103], v[40:43]
    v_mfma_f32_16x16x32_bf16 v[44:47], a[68:71], v[100:103], v[44:47]
    s_waitcnt vmcnt(18)
    v_mfma_f32_16x16x32_bf16 v[8:11], a[72:75], v[56:59], v[8:11]
    buffer_load_dwordx4 v[100:103], v217, s[36:39], s5 offen offset:3072 sc1
    v_mfma_f32_16x16x32_bf16 v[12:15], a[76:79], v[56:59], v[12:15]
    v_mfma_f32_16x16x32_bf16 v[16:19], a[80:83], v[56:59], v[16:19]
    v_mfma_f32_16x16x32_bf16 v[20:23], a[84:87], v[56:59], v[20:23]
    v_mfma_f32_16x16x32_bf16 v[24:27], a[88:91], v[56:59], v[24:27]
    s_waitcnt vmcnt(17)
    v_mfma_f32_16x16x32_bf16 v[28:31], a[72:75], v[60:63], v[28:31]
    v_mfma_f32_16x16x32_bf16 v[32:35], a[76:79], v[60:63], v[32:35]
    v_mfma_f32_16x16x32_bf16 v[36:39], a[80:83], v[60:63], v[36:39]
    v_mfma_f32_16x16x32_bf16 v[40:43], a[84:87], v[60:63], v[40:43]
    v_mfma_f32_16x16x32_bf16 v[44:47], a[88:91], v[60:63], v[44:47]
    s_waitcnt vmcnt(16)
    v_mfma_f32_16x16x32_bf16 v[8:11], a[92:95], v[64:67], v[8:11]
    v_mfma_f32_16x16x32_bf16 v[12:15], a[96:99], v[64:67], v[12:15]
    v_mfma_f32_16x16x32_bf16 v[16:19], a[100:103], v[64:67], v[16:19]
    v_mfma_f32_16x16x32_bf16 v[20:23], a[104:107], v[64:67], v[20:23]
    v_mfma_f32_16x16x32_bf16 v[24:27], a[108:111], v[64:67], v[24:27]
    s_waitcnt vmcnt(14)
    v_mfma_f32_16x16x32_bf16 v[28:31], a[92:95], v[68:71], v[28:31]
    v_mfma_f32_16x16x32_bf16 v[32:35], a[96:99], v[68:71], v[32:35]
    v_mfma_f32_16x16x32_bf16 v[36:39], a[100:103], v[68:71], v[36:39]
    v_mfma_f32_16x16x32_bf16 v[40:43], a[104:107], v[68:71], v[40:43]
    v_mfma_f32_16x16x32_bf16 v[44:47], a[108:111], v[68:71], v[44:47]
    s_waitcnt vmcnt(12)
    v_mfma_f32_16x16x32_bf16 v[8:11], a[112:115], v[72:75], v[8:11]
    buffer_load_dword v247, v246, s[36:39], s17 offen sc1
    v_mfma_f32_16x16x32_bf16 v[12:15], a[116:119], v[72:75], v[12:15]
    v_mfma_f32_16x16x32_bf16 v[16:19], a[120:123], v[72:75], v[16:19]
    v_mfma_f32_16x16x32_bf16 v[20:23], a[124:127], v[72:75], v[20:23]
    v_mfma_f32_16x16x32_bf16 v[24:27], a[128:131], v[72:75], v[24:27]
    s_waitcnt vmcnt(12)
    v_mfma_f32_16x16x32_bf16 v[28:31], a[112:115], v[76:79], v[28:31]
    v_mfma_f32_16x16x32_bf16 v[32:35], a[116:119], v[76:79], v[32:35]
    v_mfma_f32_16x16x32_bf16 v[36:39], a[120:123], v[76:79], v[36:39]
    v_mfma_f32_16x16x32_bf16 v[40:43], a[124:127], v[76:79], v[40:43]
    s_waitcnt vmcnt(5)
    s_barrier
    ds_read_b64_tr_b16 v[180:181], v231 offset:0
    v_mfma_f32_16x16x32_bf16 v[44:47], a[128:131], v[76:79], v[44:47]
    ds_read_b64_tr_b16 v[182:183], v231 offset:2048
    v_mfma_f32_16x16x32_bf16 v[8:11], a[132:135], v[80:83], v[8:11]
    ds_read_b64_tr_b16 v[184:185], v231 offset:4096
    v_mfma_f32_16x16x32_bf16 v[12:15], a[136:139], v[80:83], v[12:15]
    ds_read_b64_tr_b16 v[186:187], v231 offset:64
    v_mfma_f32_16x16x32_bf16 v[16:19], a[140:143], v[80:83], v[16:19]
    ds_read_b64_tr_b16 v[188:189], v231 offset:2112
    v_mfma_f32_16x16x32_bf16 v[20:23], a[144:147], v[80:83], v[20:23]
    ds_read_b64_tr_b16 v[190:191], v231 offset:4160
    v_mfma_f32_16x16x32_bf16 v[24:27], a[148:151], v[80:83], v[24:27]
    ds_read_b128 v[48:51], v230 offset:0
    v_mfma_f32_16x16x32_bf16 v[28:31], a[132:135], v[84:87], v[28:31]
    ds_read_b128 v[52:55], v230 offset:64
    v_mfma_f32_16x16x32_bf16 v[32:35], a[136:139], v[84:87], v[32:35]
    ds_read_b128 v[124:127], v230 offset:128
    v_mfma_f32_16x16x32_bf16 v[36:39], a[140:143], v[84:87], v[36:39]
    ds_read_b128 v[168:171], v230 offset:192
    v_mfma_f32_16x16x32_bf16 v[40:43], a[144:147], v[84:87], v[40:43]
    ds_read_b128 v[172:175], v230 offset:256
    v_mfma_f32_16x16x32_bf16 v[44:47], a[148:151], v[84:87], v[44:47]
    s_waitcnt vmcnt(4)
    ds_read_b128 v[176:179], v230 offset:320
    v_mfma_f32_16x16x32_bf16 v[8:11], a[152:155], v[88:91], v[8:11]
    v_mfma_f32_16x16x32_bf16 v[12:15], a[156:159], v[88:91], v[12:15]
    s_waitcnt lgkmcnt(11)
    v_lshlrev_b32 v204, 16, v180
    s_waitcnt lgkmcnt(2)
    v_mul_f32 v204, v204, v168
    v_mfma_f32_16x16x32_bf16 v[16:19], a[160:163], v[88:91], v[16:19]
    v_and_b32 v205, 0xffff0000, v180
    v_mul_f32 v205, v205, v169
    v_mfma_f32_16x16x32_bf16 v[20:23], a[164:167], v[88:91], v[20:23]
    v_lshlrev_b32 v206, 16, v181
    v_mul_f32 v206, v206, v170
    v_mfma_f32_16x16x32_bf16 v[24:27], a[168:171], v[88:91], v[24:27]
    s_waitcnt vmcnt(3)
    v_and_b32 v207, 0xffff0000, v181
    v_mul_f32 v207, v207, v171
    v_mfma_f32_16x16x32_bf16 v[28:31], a[152:155], v[92:95], v[28:31]
    v_lshlrev_b32 v208, 16, v182
    s_waitcnt lgkmcnt(1)
    v_mul_f32 v208, v208, v172
    v_mfma_f32_16x16x32_bf16 v[32:35], a[156:159], v[92:95], v[32:35]
    v_and_b32 v209, 0xffff0000, v182
    v_mul_f32 v209, v209, v173
    v_mfma_f32_16x16x32_bf16 v[36:39], a[160:163], v[92:95], v[36:39]
    v_lshlrev_b32 v210, 16, v183
    v_mul_f32 v210, v210, v174
    v_mfma_f32_16x16x32_bf16 v[40:43], a[164:167], v[92:95], v[40:43]
    v_and_b32 v211, 0xffff0000, v183
    v_mul_f32 v211, v211, v175
    v_mfma_f32_16x16x32_bf16 v[44:47], a[168:171], v[92:95], v[44:47]
    v_lshlrev_b32 v212, 16, v184
    s_waitcnt lgkmcnt(0)
    v_mul_f32 v212, v212, v176
    s_waitcnt vmcnt(2)
    v_mfma_f32_16x16x32_bf16 v[8:11], a[172:175], v[96:99], v[8:11]
    s_waitcnt vmcnt(0)
    v_cmp_ne_u32 vcc, s48, v247
    s_cbranch_vccnz L_chk14_slow
L_chk14_back:
    v_and_b32 v213, 0xffff0000, v184
    v_mfma_f32_16x16x32_bf16 v[12:15], a[176:179], v[96:99], v[12:15]
    buffer_load_dwordx4 v[56:59], v218, s[36:39], 0 offen offset:0 sc1
    v_mfma_f32_16x16x32_bf16 v[16:19], a[180:183], v[96:99], v[16:19]
    v_mul_f32 v213, v213, v177
    v_lshlrev_b32 v214, 16, v185
    v_mfma_f32_16x16x32_bf16 v[20:23], a[184:187], v[96:99], v[20:23]
    v_mul_f32 v214, v214, v178
    v_and_b32 v215, 0xffff0000, v185
    v_mfma_f32_16x16x32_bf16 v[24:27], a[188:191], v[96:99], v[24:27]
    buffer_load_dwordx4 v[60:63], v218, s[36:39], 0 offen offset:1024 sc1
    v_mfma_f32_16x16x32_bf16 v[28:31], a[172:175], v[100:103], v[28:31]
    v_mul_f32 v215, v215, v179
    v_lshlrev_b32 v232, 16, v186
    v_mfma_f32_16x16x32_bf16 v[32:35], a[176:179], v[100:103], v[32:35]
    v_mul_f32 v232, v232, v168
    v_and_b32 v233, 0xffff0000, v186
    v_mfma_f32_16x16x32_bf16 v[36:39], a[180:183], v[100:103], v[36:39]
    buffer_load_dwordx4 v[64:67], v218, s[36:39], 0 offen offset:2048 sc1
    v_mfma_f32_16x16x32_bf16 v[40:43], a[184:187], v[100:103], v[40:43]
    ds_write_b128 v220, v[8:11] offset:0
    v_mul_f32 v233, v233, v169
    v_lshlrev_b32 v234, 16, v187
    v_mfma_f32_16x16x32_bf16 v[44:47], a[188:191], v[100:103], v[44:47]
    s_waitcnt vmcnt(2)
    v_mul_f32 v234, v234, v170
    v_and_b32 v235, 0xffff0000, v187
    v_mfma_f32_16x16x32_bf16 v[104:107], a[240:243], v[56:59], 0
    buffer_load_dwordx4 v[68:71], v218, s[36:39], 0 offen offset:3072 sc1
    v_mfma_f32_16x16x32_bf16 v[108:111], a[244:247], v[56:59], 0
    ds_write_b128 v220, v[12:15] offset:1024
    v_mul_f32 v235, v235, v171
    v_lshlrev_b32 v236, 16, v188
    v_mfma_f32_16x16x32_bf16 v[112:115], a[248:251], v[56:59], 0
    v_mul_f32 v236, v236, v172
    v_and_b32 v237, 0xffff0000, v188
    v_mfma_f32_16x16x32_bf16 v[116:119], a[252:255], v[56:59], 0
    buffer_load_dwordx4 v[72:75], v218, s[36:39], s4 offen offset:0 sc1
    v_mfma_f32_16x16x32_bf16 v[120:123], v[136:139], v[56:59], 0
    s_waitcnt vmcnt(3)
    ds_write_b128 v220, v[16:19] offset:2048
    v_mul_f32 v237, v237, v173
    v_lshlrev_b32 v238, 16, v189
    v_mfma_f32_16x16x32_bf16 v[104:107], v[140:143], v[60:63], v[104:107]
    v_mul_f32 v238, v238, v174
    v_and_b32 v239, 0xffff0000, v189
    v_mfma_f32_16x16x32_bf16 v[108:111], v[144:147], v[60:63], v[108:111]
    buffer_load_dwordx4 v[76:79], v218, s[36:39], s4 offen offset:1024 sc1
    v_mfma_f32_16x16x32_bf16 v[112:115], v[148:151], v[60:63], v[112:115]
    ds_write_b128 v220, v[20:23] offset:3072
    v_mul_f32 v239, v239, v175
    v_lshlrev_b32 v240, 16, v190
    v_mfma_f32_16x16x32_bf16 v[116:119], v[152:155], v[60:63], v[116:119]
    v_mul_f32 v240, v240, v176
    v_and_b32 v241, 0xffff0000, v190
    v_mfma_f32_16x16x32_bf16 v[120:123], v[156:159], v[60:63], v[120:123]
    s_waitcnt vmcnt(3)
    buffer_load_dwordx4 v[80:83], v218, s[36:39], s4 offen offset:2048 sc1
    v_mfma_f32_16x16x32_bf16 v[104:107], v[160:163], v[64:67], v[104:107]
    ds_write_b128 v220, v[24:27] offset:4096
    v_mul_f32 v241, v241, v177
    v_lshlrev_b32 v242, 16, v191
    v_mfma_f32_16x16x32_bf16 v[108:111], v[164:167], v[64:67], v[108:111]
    v_mul_f32 v242, v242, v178
    v_and_b32 v243, 0xffff0000, v191
    v_mfma_f32_16x16x32_bf16 v[112:115], a[0:3], v[64:67], v[112:115]
    ds_write_b128 v221, v[28:31] offset:0
    buffer_load_dwordx4 v[84:87], v218, s[36:39], s4 offen offset:3072 sc1
    v_mfma_f32_16x16x32_bf16 v[116:119], a[4:7], v[64:67], v[116:119]
    v_mul_f32 v243, v243, v179
    v_mfma_f32_16x16x32_bf16 v[120:123], a[8:11], v[64:67], v[120:123]
    s_waitcnt vmcnt(4)
    ds_write_b128 v221, v[32:35] offset:1024
    v_mfma_f32_16x16x32_bf16 v[104:107], a[12:15], v[68:71], v[104:107]
    buffer_load_dwordx4 v[88:91], v218, s[36:39], s5 offen offset:0 sc1
    v_mfma_f32_16x16x32_bf16 v[108:111], a[16:19], v[68:71], v[108:111]
    ds_write_b128 v221, v[36:39] offset:2048
    v_mfma_f32_16x16x32_bf16 v[112:115], a[20:23], v[68:71], v[112:115]
    v_mfma_f32_16x16x32_bf16 v[116:119], a[24:27], v[68:71], v[116:119]
    buffer_load_dwordx4 v[92:95], v218, s[36:39], s5 offen offset:1024 sc1
    v_mfma_f32_16x16x32_bf16 v[120:123], a[28:31], v[68:71], v[120:123]
    s_waitcnt vmcnt(5)
    ds_write_b128 v221, v[40:43] offset:3072
    v_mfma_f32_16x16x32_bf16 v[104:107], a[32:35], v[72:75], v[104:107]
    v_mfma_f32_16x16x32_bf16 v[108:111], a[36:39], v[72:75], v[108:111]
    buffer_load_dwordx4 v[96:99], v218, s[36:39], s5 offen offset:2048 sc1
    v_mfma_f32_16x16x32_bf16 v[112:115], a[40:43], v[72:75], v[112:115]
    ds_write_b128 v221, v[44:47] offset:4096
    v_mfma_f32_16x16x32_bf16 v[116:119], a[44:47], v[72:75], v[116:119]
    v_mfma_f32_16x16x32_bf16 v[120:123], a[48:51], v[72:75], v[120:123]
    s_waitcnt vmcnt(5)
    buffer_load_dwordx4 v[100:103], v218, s[36:39], s5 offen offset:3072 sc1
    v_mfma_f32_16x16x32_bf16 v[104:107], a[52:55], v[76:79], v[104:107]
    v_mfma_f32_16x16x32_bf16 v[108:111], a[56:59], v[76:79], v[108:111]
    v_mfma_f32_16x16x32_bf16 v[112:115], a[60:63], v[76:79], v[112:115]
    buffer_load_dwordx4 v[56:59], v219, s[36:39], 0 offen offset:0 sc1
    v_mfma_f32_16x16x32_bf16 v[116:119], a[64:67], v[76:79], v[116:119]
    v_mfma_f32_16x16x32_bf16 v[120:123], a[68:71], v[76:79], v[120:123]
    s_waitcnt vmcnt(6)
    v_mfma_f32_16x16x32_bf16 v[104:107], a[72:75], v[80:83], v[104:107]
    buffer_load_dwordx4 v[60:63], v219, s[36:39], 0 offen offset:1024 sc1
    v_mfma_f32_16x16x32_bf16 v[108:111], a[76:79], v[80:83], v[108:111]
    s_waitcnt lgkmcnt(0)
    s_barrier
    ds_read_b128 v[168:171], v224 offset:0
    v_mfma_f32_16x16x32_bf16 v[112:115], a[80:83], v[80:83], v[112:115]
    ds_read_b128 v[172:175], v224 offset:1024
    v_mfma_f32_16x16x32_bf16 v[116:119], a[84:87], v[80:83], v[116:119]
    buffer_load_dwordx4 v[64:67], v219, s[36:39], 0 offen offset:2048 sc1
    v_mfma_f32_16x16x32_bf16 v[120:123], a[88:91], v[80:83], v[120:123]
    s_waitcnt vmcnt(7)
    ds_read_b128 v[176:179], v224 offset:2048
    v_mfma_f32_16x16x32_bf16 v[104:107], a[92:95], v[84:87], v[104:107]
    ds_read_b128 v[180:183], v224 offset:5120
    ds_read_b128 v[184:187], v224 offset:6144
    v_mfma_f32_16x16x32_bf16 v[108:111], a[96:99], v[84:87], v[108:111]
    buffer_load_dwordx4 v[68:71], v219, s[36:39], 0 offen offset:3072 sc1
    v_mfma_f32_16x16x32_bf16 v[112:115], a[100:103], v[84:87], v[112:115]
    ds_read_b128 v[188:191], v224 offset:7168
    v_mfma_f32_16x16x32_bf16 v[116:119], a[104:107], v[84:87], v[116:119]
    ds_read_b128 v[192:195], v224 offset:10240
    ds_read_b128 v[196:199], v224 offset:11264
    v_mfma_f32_16x16x32_bf16 v[120:123], a[108:111], v[84:87], v[120:123]
    s_waitcnt vmcnt(7)
    buffer_load_dwordx4 v[72:75], v219, s[36:39], s4 offen offset:0 sc1
    v_mfma_f32_16x16x32_bf16 v[104:107], a[112:115], v[88:91], v[104:107]
    ds_read_b128 v[200:203], v224 offset:12288
    v_mfma_f32_16x16x32_bf16 v[108:111], a[116:119], v[88:91], v[108:111]
    s_waitcnt lgkmcnt(5)
    v_add_f32 v168, v168, v180
    v_add_f32 v169, v169, v181
    v_add_f32 v170, v170, v182
    v_mfma_f32_16x16x32_bf16 v[112:115], a[120:123], v[88:91], v[112:115]
    buffer_load_dwordx4 v[76:79], v219, s[36:39], s4 offen offset:1024 sc1
    v_mfma_f32_16x16x32_bf16 v[116:119], a[124:127], v[88:91], v[116:119]
    v_add_f32 v171, v171, v183
    s_waitcnt lgkmcnt(4)
    v_add_f32 v172, v172, v184
    v_mfma_f32_16x16x32_bf16 v[120:123], a[128:131], v[88:91], v[120:123]
    s_waitcnt vmcnt(8)
    v_add_f32 v173, v173, v185
    v_add_f32 v174, v174, v186
    v_mfma_f32_16x16x32_bf16 v[104:107], a[132:135], v[92:95], v[104:107]
    buffer_load_dwordx4 v[80:83], v219, s[36:39], s4 offen offset:2048 sc1
    v_mfma_f32_16x16x32_bf16 v[108:111], a[136:139], v[92:95], v[108:111]
    v_add_f32 v175, v175, v187
    s_waitcnt lgkmcnt(3)
    v_add_f32 v176, v176, v188
    v_mfma_f32_16x16x32_bf16 v[112:115], a[140:143], v[92:95], v[112:115]
    v_add_f32 v177, v177, v189
    v_add_f32 v178, v178, v190
    v_add_f32 v179, v179, v191
    v_mfma_f32_16x16x32_bf16 v[116:119], a[144:147], v[92:95], v[116:119]
    buffer_load_dwordx4 v[84:87], v219, s[36:39], s4 offen offset:3072 sc1
    v_mfma_f32_16x16x32_bf16 v[120:123], a[148:151], v[92:95], v[120:123]
    s_waitcnt vmcnt(9)
    ds_read_b128 v[180:183], v224 offset:15360
    ds_read_b128 v[184:187], v224 offset:16384
    v_mfma_f32_16x16x32_bf16 v[104:107], a[152:155], v[96:99], v[104:107]
    ds_read_b128 v[188:191], v224 offset:17408
    s_waitcnt lgkmcnt(5)
    v_add_f32 v168, v168, v192
    v_add_f32 v169, v169, v193
    v_mfma_f32_16x16x32_bf16 v[108:111], a[156:159], v[96:99], v[108:111]
    buffer_load_dwordx4 v[88:91], v219, s[36:39], s5 offen offset:0 sc1
    v_mfma_f32_16x16x32_bf16 v[112:115], a[160:163], v[96:99], v[112:115]
    v_add_f32 v170, v170, v194
    v_add_f32 v171, v171, v195
    v_mfma_f32_16x16x32_bf16 v[116:119], a[164:167], v[96:99], v[116:119]
    s_waitcnt lgkmcnt(4)
    v_add_f32 v172, v172, v196
    v_add_f32 v173, v173, v197
    v_mfma_f32_16x16x32_bf16 v[120:123], a[168:171], v[96:99], v[120:123]
    s_waitcnt vmcnt(9)
    buffer_load_dwordx4 v[92:95], v219, s[36:39], s5 offen offset:1024 sc1
    v_mfma_f32_16x16x32_bf16 v[104:107], a[172:175], v[100:103], v[104:107]
    v_add_f32 v174, v174, v198
    v_add_f32 v175, v175, v199
    v_mfma_f32_16x16x32_bf16 v[108:111], a[176:179], v[100:103], v[108:111]
    s_waitcnt lgkmcnt(3)
    v_add_f32 v176, v176, v200
    v_add_f32 v177, v177, v201
    v_add_f32 v178, v178, v202
    v_mfma_f32_16x16x32_bf16 v[112:115], a[180:183], v[100:103], v[112:115]
    buffer_load_dwordx4 v[96:99], v219, s[36:39], s5 offen offset:2048 sc1
    v_mfma_f32_16x16x32_bf16 v[116:119], a[184:187], v[100:103], v[116:119]
    v_add_f32 v179, v179, v203
    s_waitcnt lgkmcnt(2)
    v_add_f32 v168, v168, v180
    v_mfma_f32_16x16x32_bf16 v[120:123], a[188:191], v[100:103], v[120:123]
    s_waitcnt vmcnt(10)
    v_add_f32 v169, v169, v181
    v_add_f32 v170, v170, v182
    v_add_f32 v171, v171, v183
    v_mfma_f32_16x16x32_bf16 v[8:11], a[240:243], v[56:59], 0
    buffer_load_dwordx4 v[100:103], v219, s[36:39], s5 offen offset:3072 sc1
    v_mfma_f32_16x16x32_bf16 v[12:15], a[244:247], v[56:59], 0
    s_waitcnt lgkmcnt(1)
    v_add_f32 v172, v172, v184
    v_add_f32 v173, v173, v185
    v_mfma_f32_16x16x32_bf16 v[16:19], a[248:251], v[56:59], 0
    v_add_f32 v174, v174, v186
    v_add_f32 v175, v175, v187
    v_mfma_f32_16x16x32_bf16 v[20:23], a[252:255], v[56:59], 0
    ds_write_b128 v222, v[104:107] offset:0
    s_waitcnt lgkmcnt(1)
    v_add_f32 v176, v176, v188
    v_add_f32 v177, v177, v189
    v_mfma_f32_16x16x32_bf16 v[24:27], v[136:139], v[56:59], 0
    s_waitcnt vmcnt(10)
    v_add_f32 v178, v178, v190
    v_add_f32 v179, v179, v191
    v_fma_f32 v204, v168, v48, v204
    v_mfma_f32_16x16x32_bf16 v[8:11], v[140:143], v[60:63], v[8:11]
    ds_write_b128 v222, v[108:111] offset:1024
    v_fma_f32 v205, v169, v49, v205
    v_fma_f32 v206, v170, v50, v206
    v_mfma_f32_16x16x32_bf16 v[12:15], v[144:147], v[60:63], v[12:15]
    v_fma_f32 v207, v171, v51, v207
    v_fma_f32 v208, v172, v52, v208
    v_mfma_f32_16x16x32_bf16 v[16:19], v[148:151], v[60:63], v[16:19]
    ds_write_b128 v222, v[112:115] offset:2048
    v_fma_f32 v209, v173, v53, v209
    v_fma_f32 v210, v174, v54, v210
    v_mfma_f32_16x16x32_bf16 v[20:23], v[152:155], v[60:63], v[20:23]
    v_fma_f32 v211, v175, v55, v211
    v_fma_f32 v212, v176, v124, v212
    v_mfma_f32_16x16x32_bf16 v[24:27], v[156:159], v[60:63], v[24:27]
    s_waitcnt vmcnt(9)
    ds_write_b128 v222, v[116:119] offset:3072
    v_fma_f32 v213, v177, v125, v213
    v_fma_f32 v214, v178, v126, v214
    v_mfma_f32_16x16x32_bf16 v[8:11], v[160:163], v[64:67], v[8:11]
    v_fma_f32 v215, v179, v127, v215
    v_cvt_pk_bf16_f32 v180, v204, v205
    v_mfma_f32_16x16x32_bf16 v[12:15], v[164:167], v[64:67], v[12:15]
    v_cvt_pk_bf16_f32 v181, v206, v207
    v_cvt_pk_bf16_f32 v182, v208, v209
    v_mfma_f32_16x16x32_bf16 v[16:19], a[0:3], v[64:67], v[16:19]
    v_cvt_pk_bf16_f32 v183, v210, v211
    v_cvt_pk_bf16_f32 v184, v212, v213
    v_mfma_f32_16x16x32_bf16 v[20:23], a[4:7], v[64:67], v[20:23]
    ds_write_b128 v222, v[120:123] offset:4096
    v_cvt_pk_bf16_f32 v185, v214, v215
    v_mfma_f32_16x16x32_bf16 v[24:27], a[8:11], v[64:67], v[24:27]
    s_waitcnt vmcnt(8)
    v_permlane16_swap_b32 v180, v182
    v_mfma_f32_16x16x32_bf16 v[8:11], a[12:15], v[68:71], v[8:11]
    v_permlane16_swap_b32 v181, v183
    v_mfma_f32_16x16x32_bf16 v[12:15], a[16:19], v[68:71], v[12:15]
    buffer_store_dwordx4 v[180:183], v227, s[40:43], s13 offen
    v_mfma_f32_16x16x32_bf16 v[16:19], a[20:23], v[68:71], v[16:19]
    buffer_store_dwordx2 v[184:185], v228, s[40:43], s13 offen offset:64
    v_mfma_f32_16x16x32_bf16 v[20:23], a[24:27], v[68:71], v[20:23]
    v_mfma_f32_16x16x32_bf16 v[24:27], a[28:31], v[68:71], v[24:27]
    s_waitcnt vmcnt(9)
    v_mfma_f32_16x16x32_bf16 v[8:11], a[32:35], v[72:75], v[8:11]
    v_mfma_f32_16x16x32_bf16 v[12:15], a[36:39], v[72:75], v[12:15]
    s_waitcnt lgkmcnt(0)
    s_barrier
    ds_read_b128 v[168:171], v225 offset:0
    v_mfma_f32_16x16x32_bf16 v[16:19], a[40:43], v[72:75], v[16:19]
    ds_read_b128 v[172:175], v225 offset:1024
    v_mfma_f32_16x16x32_bf16 v[20:23], a[44:47], v[72:75], v[20:23]
    ds_read_b128 v[176:179], v225 offset:2048
    v_mfma_f32_16x16x32_bf16 v[24:27], a[48:51], v[72:75], v[24:27]
    s_waitcnt vmcnt(8)
    ds_read_b128 v[192:195], v225 offset:10240
    v_mfma_f32_16x16x32_bf16 v[8:11], a[52:55], v[76:79], v[8:11]
    ds_read_b128 v[196:199], v225 offset:11264
    v_mfma_f32_16x16x32_bf16 v[12:15], a[56:59], v[76:79], v[12:15]
    ds_read_b128 v[200:203], v225 offset:12288
    v_mfma_f32_16x16x32_bf16 v[16:19], a[60:63], v[76:79], v[16:19]
    v_mfma_f32_16x16x32_bf16 v[20:23], a[64:67], v[76:79], v[20:23]
    v_mfma_f32_16x16x32_bf16 v[24:27], a[68:71], v[76:79], v[24:27]
    s_waitcnt vmcnt(7)
    v_mfma_f32_16x16x32_bf16 v[8:11], a[72:75], v[80:83], v[8:11]
    v_mfma_f32_16x16x32_bf16 v[12:15], a[76:79], v[80:83], v[12:15]
    v_mfma_f32_16x16x32_bf16 v[16:19], a[80:83], v[80:83], v[16:19]
    v_mfma_f32_16x16x32_bf16 v[20:23], a[84:87], v[80:83], v[20:23]
    s_waitcnt lgkmcnt(2)
    v_add_f32 v168, v168, v192
    v_add_f32 v169, v169, v193
    v_mfma_f32_16x16x32_bf16 v[24:27], a[88:91], v[80:83], v[24:27]
    s_waitcnt vmcnt(6)
    v_add_f32 v170, v170, v194
    v_add_f32 v171, v171, v195
    v_mfma_f32_16x16x32_bf16 v[8:11], a[92:95], v[84:87], v[8:11]
    s_waitcnt lgkmcnt(1)
    v_add_f32 v172, v172, v196
    v_add_f32 v173, v173, v197
    v_mfma_f32_16x16x32_bf16 v[12:15], a[96:99], v[84:87], v[12:15]
    v_add_f32 v174, v174, v198
    v_add_f32 v175, v175, v199
    v_mfma_f32_16x16x32_bf16 v[16:19], a[100:103], v[84:87], v[16:19]
    s_waitcnt lgkmcnt(0)
    v_add_f32 v176, v176, v200
    v_add_f32 v177, v177, v201
    v_mfma_f32_16x16x32_bf16 v[20:23], a[104:107], v[84:87], v[20:23]
    v_add_f32 v178, v178, v202
    v_add_f32 v179, v179, v203
    v_mfma_f32_16x16x32_bf16 v[24:27], a[108:111], v[84:87], v[24:27]
    s_waitcnt vmcnt(5)
    v_fma_f32 v232, v168, v48, v232
    v_fma_f32 v233, v169, v49, v233
    v_mfma_f32_16x16x32_bf16 v[8:11], a[112:115], v[88:91], v[8:11]
    s_waitcnt vmcnt(4)
    v_fma_f32 v234, v170, v50, v234
    v_fma_f32 v235, v171, v51, v235
    v_mfma_f32_16x16x32_bf16 v[8:11], a[132:135], v[92:95], v[8:11]
    s_waitcnt vmcnt(3)
    v_fma_f32 v236, v172, v52, v236
    v_fma_f32 v237, v173, v53, v237
    v_mfma_f32_16x16x32_bf16 v[8:11], a[152:155], v[96:99], v[8:11]
    s_waitcnt vmcnt(2)
    v_fma_f32 v238, v174, v54, v238
    v_fma_f32 v239, v175, v55, v239
    v_mfma_f32_16x16x32_bf16 v[8:11], a[172:175], v[100:103], v[8:11]
    v_fma_f32 v240, v176, v124, v240
    v_fma_f32 v241, v177, v125, v241
    v_mfma_f32_16x16x32_bf16 v[12:15], a[116:119], v[88:91], v[12:15]
    v_fma_f32 v242, v178, v126, v242
    v_fma_f32 v243, v179, v127, v243
    v_mfma_f32_16x16x32_bf16 v[12:15], a[136:139], v[92:95], v[12:15]
    v_mfma_f32_16x16x32_bf16 v[12:15], a[156:159], v[96:99], v[12:15]
    s_nop 0
    ds_write_b128 v223, v[8:11] offset:0
    v_mfma_f32_16x16x32_bf16 v[12:15], a[176:179], v[100:103], v[12:15]
    v_mfma_f32_16x16x32_bf16 v[16:19], a[120:123], v[88:91], v[16:19]
    v_mfma_f32_16x16x32_bf16 v[16:19], a[140:143], v[92:95], v[16:19]
    v_mfma_f32_16x16x32_bf16 v[16:19], a[160:163], v[96:99], v[16:19]
    s_nop 4
    ds_write_b128 v223, v[12:15] offset:1024
    v_mfma_f32_16x16x32_bf16 v[16:19], a[180:183], v[100:103], v[16:19]
    v_mfma_f32_16x16x32_bf16 v[20:23], a[124:127], v[88:91], v[20:23]
    v_mfma_f32_16x16x32_bf16 v[20:23], a[144:147], v[92:95], v[20:23]
    v_mfma_f32_16x16x32_bf16 v[20:23], a[164:167], v[96:99], v[20:23]
    s_nop 4
    ds_write_b128 v223, v[16:19] offset:2048
    v_mfma_f32_16x16x32_bf16 v[20:23], a[184:187], v[100:103], v[20:23]
    v_mfma_f32_16x16x32_bf16 v[24:27], a[128:131], v[88:91], v[24:27]
    v_mfma_f32_16x16x32_bf16 v[24:27], a[148:151], v[92:95], v[24:27]
    v_mfma_f32_16x16x32_bf16 v[24:27], a[168:171], v[96:99], v[24:27]
    s_nop 4
    ds_write_b128 v223, v[20:23] offset:3072
    v_mfma_f32_16x16x32_bf16 v[24:27], a[188:191], v[100:103], v[24:27]
    s_nop 7
    ds_write_b128 v223, v[24:27] offset:4096
    s_waitcnt lgkmcnt(0)
    s_barrier
    ds_read_b128 v[168:171], v226 offset:0
    ds_read_b128 v[172:175], v226 offset:1024
    ds_read_b128 v[176:179], v226 offset:2048
    ds_read_b128 v[180:183], v226 offset:10240
    ds_read_b128 v[184:187], v226 offset:11264
    ds_read_b128 v[188:191], v226 offset:12288
    s_waitcnt lgkmcnt(2)
    v_pk_add_f32 v[168:169], v[168:169], v[180:181]
    v_pk_add_f32 v[170:171], v[170:171], v[182:183]
    s_waitcnt lgkmcnt(1)
    v_pk_add_f32 v[172:173], v[172:173], v[184:185]
    v_pk_add_f32 v[174:175], v[174:175], v[186:187]
    s_waitcnt lgkmcnt(0)
    v_pk_add_f32 v[176:177], v[176:177], v[188:189]
    v_pk_add_f32 v[178:179], v[178:179], v[190:191]
    v_pk_fma_f32 v[232:233], v[168:169], v[48:49], v[232:233]
    v_pk_fma_f32 v[234:235], v[170:171], v[50:51], v[234:235]
    v_pk_fma_f32 v[236:237], v[172:173], v[52:53], v[236:237]
    v_pk_fma_f32 v[238:239], v[174:175], v[54:55], v[238:239]
    v_pk_fma_f32 v[240:241], v[176:177], v[124:125], v[240:241]
    v_pk_fma_f32 v[242:243], v[178:179], v[126:127], v[242:243]
    v_cvt_pk_bf16_f32 v168, v232, v233
    v_cvt_pk_bf16_f32 v169, v234, v235
    v_cvt_pk_bf16_f32 v170, v236, v237
    v_cvt_pk_bf16_f32 v171, v238, v239
    v_cvt_pk_bf16_f32 v172, v240, v241
    v_cvt_pk_bf16_f32 v173, v242, v243
    v_permlane16_swap_b32 v168, v170
    v_permlane16_swap_b32 v169, v171
    buffer_store_dwordx4 v[168:171], v227, s[40:43], s14 offen
    buffer_store_dwordx2 v[172:173], v228, s[40:43], s14 offen offset:64
    s_endpgm
L_prep:
    s_mov_b32 s36, s32
    s_mov_b32 s37, s33
    s_mov_b32 s38, 0x10000000
    s_mov_b32 s39, 0x20000
    v_mov_b32 v2, 0
    s_mov_b32 s57, 23461888
    buffer_load_dword v246, v2, s[36:39], s57 offen sc1
    s_mov_b32 s49, 400000
    s_and_b32 s50, s2, 7
    s_lshr_b32 s51, s2, 3
    s_lshr_b32 s60, s50, 2
    s_lshl_b32 s60, s60, 3
    s_lshr_b32 s61, s51, 2
    s_add_u32 s72, s60, s61
    s_lshl_b32 s61, s61, 3
    s_mov_b32 s62, 0x6040200
    s_mov_b32 s63, 0x70308
    s_lshr_b64 s[62:63], s[62:63], s61
    s_and_b32 s34, s62, 255
    s_lshr_b32 s62, s50, 2
    s_mul_i32 s62, s62, 10
    s_add_u32 s34, s34, s62
    s_sub_u32 s62, s34, 20
    s_min_u32 s34, s34, s62
    s_and_b32 s60, s50, 3
    s_lshl_b32 s60, s60, 2
    s_and_b32 s61, s51, 3
    s_add_u32 s73, s60, s61
    s_and_b32 s75, s51, 7
    s_lshr_b32 s61, s51, 3
    s_lshl_b32 s60, s50, 2
    s_add_u32 s74, s60, s61
    s_mul_i32 s70, s50, 20
    s_add_u32 s70, s70, s51
    s_lshl_b32 s60, s50, 1
    s_cmp_ge_u32 s51, 10
    s_addc_u32 s60, s60, 0
    s_cmp_ge_u32 s51, 10
    s_cselect_b32 s61, 10, 0
    s_sub_u32 s61, s51, s61
    s_lshl_b32 s61, s61, 4
    s_add_u32 s76, s60, s61
    s_lshl_b32 s58, s70, 2
    s_add_u32 s58, s58, s3
    v_lshlrev_b32 v248, 4, v1
    s_mov_b32 s76, 0
    s_mov_b32 s50, 0xbfb8aa3b
    s_waitcnt vmcnt(5)
    v_lshlrev_b32 v180, 16, v80
    v_and_b32 v181, 0xffff0000, v80
    v_lshlrev_b32 v182, 16, v81
    v_and_b32 v183, 0xffff0000, v81
    s_waitcnt vmcnt(4)
    v_lshlrev_b32 v184, 16, v82
    v_and_b32 v185, 0xffff0000, v82
    v_lshlrev_b32 v186, 16, v83
    v_and_b32 v187, 0xffff0000, v83
    s_waitcnt vmcnt(3)
    v_lshlrev_b32 v188, 16, v84
    v_and_b32 v189, 0xffff0000, v84
    v_lshlrev_b32 v190, 16, v85
    v_and_b32 v191, 0xffff0000, v85
    s_waitcnt vmcnt(2)
    v_lshlrev_b32 v192, 16, v86
    v_and_b32 v193, 0xffff0000, v86
    v_lshlrev_b32 v194, 16, v87
    v_and_b32 v195, 0xffff0000, v87
    s_waitcnt vmcnt(1)
    v_lshlrev_b32 v196, 16, v88
    v_and_b32 v197, 0xffff0000, v88
    v_lshlrev_b32 v198, 16, v89
    v_and_b32 v199, 0xffff0000, v89
    v_mul_f32 v208, s50, v180
    v_exp_f32 v208, v208
    s_nop 0
    v_add_f32 v208, 1.0, v208
    v_rcp_f32 v208, v208
    s_nop 0
    v_mul_f32 v180, v180, v208
    v_mul_f32 v209, s50, v181
    v_exp_f32 v209, v209
    s_nop 0
    v_add_f32 v209, 1.0, v209
    v_rcp_f32 v209, v209
    s_nop 0
    v_mul_f32 v181, v181, v209
    v_mul_f32 v208, s50, v182
    v_exp_f32 v208, v208
    s_nop 0
    v_add_f32 v208, 1.0, v208
    v_rcp_f32 v208, v208
    s_nop 0
    v_mul_f32 v182, v182, v208
    v_mul_f32 v209, s50, v183
    v_exp_f32 v209, v209
    s_nop 0
    v_add_f32 v209, 1.0, v209
    v_rcp_f32 v209, v209
    s_nop 0
    v_mul_f32 v183, v183, v209
    v_mul_f32 v208, s50, v184
    v_exp_f32 v208, v208
    s_nop 0
    v_add_f32 v208, 1.0, v208
    v_rcp_f32 v208, v208
    s_nop 0
    v_mul_f32 v184, v184, v208
    v_mul_f32 v209, s50, v185
    v_exp_f32 v209, v209
    s_nop 0
    v_add_f32 v209, 1.0, v209
    v_rcp_f32 v209, v209
    s_nop 0
    v_mul_f32 v185, v185, v209
    v_mul_f32 v208, s50, v186
    v_exp_f32 v208, v208
    s_nop 0
    v_add_f32 v208, 1.0, v208
    v_rcp_f32 v208, v208
    s_nop 0
    v_mul_f32 v186, v186, v208
    v_mul_f32 v209, s50, v187
    v_exp_f32 v209, v209
    s_nop 0
    v_add_f32 v209, 1.0, v209
    v_rcp_f32 v209, v209
    s_nop 0
    v_mul_f32 v187, v187, v209
    v_mul_f32 v208, s50, v188
    v_exp_f32 v208, v208
    s_nop 0
    v_add_f32 v208, 1.0, v208
    v_rcp_f32 v208, v208
    s_nop 0
    v_mul_f32 v188, v188, v208
    v_mul_f32 v209, s50, v189
    v_exp_f32 v209, v209
    s_nop 0
    v_add_f32 v209, 1.0, v209
    v_rcp_f32 v209, v209
    s_nop 0
    v_mul_f32 v189, v189, v209
    v_mul_f32 v208, s50, v190
    v_exp_f32 v208, v208
    s_nop 0
    v_add_f32 v208, 1.0, v208
    v_rcp_f32 v208, v208
    s_nop 0
    v_mul_f32 v190, v190, v208
    v_mul_f32 v209, s50, v191
    v_exp_f32 v209, v209
    s_nop 0
    v_add_f32 v209, 1.0, v209
    v_rcp_f32 v209, v209
    s_nop 0
    v_mul_f32 v191, v191, v209
    v_mul_f32 v208, s50, v192
    v_exp_f32 v208, v208
    s_nop 0
    v_add_f32 v208, 1.0, v208
    v_rcp_f32 v208, v208
    s_nop 0
    v_mul_f32 v192, v192, v208
    v_mul_f32 v209, s50, v193
    v_exp_f32 v209, v209
    s_nop 0
    v_add_f32 v209, 1.0, v209
    v_rcp_f32 v209, v209
    s_nop 0
    v_mul_f32 v193, v193, v209
    v_mul_f32 v208, s50, v194
    v_exp_f32 v208, v208
    s_nop 0
    v_add_f32 v208, 1.0, v208
    v_rcp_f32 v208, v208
    s_nop 0
    v_mul_f32 v194, v194, v208
    v_mul_f32 v209, s50, v195
    v_exp_f32 v209, v209
    s_nop 0
    v_add_f32 v209, 1.0, v209
    v_rcp_f32 v209, v209
    s_nop 0
    v_mul_f32 v195, v195, v209
    v_mul_f32 v208, s50, v196
    v_exp_f32 v208, v208
    s_nop 0
    v_add_f32 v208, 1.0, v208
    v_rcp_f32 v208, v208
    s_nop 0
    v_mul_f32 v196, v196, v208
    v_mul_f32 v209, s50, v197
    v_exp_f32 v209, v209
    s_nop 0
    v_add_f32 v209, 1.0, v209
    v_rcp_f32 v209, v209
    s_nop 0
    v_mul_f32 v197, v197, v209
    v_mul_f32 v208, s50, v198
    v_exp_f32 v208, v208
    s_nop 0
    v_add_f32 v208, 1.0, v208
    v_rcp_f32 v208, v208
    s_nop 0
    v_mul_f32 v198, v198, v208
    v_mul_f32 v209, s50, v199
    v_exp_f32 v209, v209
    s_nop 0
    v_add_f32 v209, 1.0, v209
    v_rcp_f32 v209, v209
    s_nop 0
    v_mul_f32 v199, v199, v209
    v_cvt_pk_bf16_f32 v208, v180, v181
    v_lshlrev_b32 v180, 16, v208
    v_and_b32 v181, 0xffff0000, v208
    v_cvt_pk_bf16_f32 v208, v182, v183
    v_lshlrev_b32 v182, 16, v208
    v_and_b32 v183, 0xffff0000, v208
    v_cvt_pk_bf16_f32 v208, v184, v185
    v_lshlrev_b32 v184, 16, v208
    v_and_b32 v185, 0xffff0000, v208
    v_cvt_pk_bf16_f32 v208, v186, v187
    v_lshlrev_b32 v186, 16, v208
    v_and_b32 v187, 0xffff0000, v208
    v_cvt_pk_bf16_f32 v208, v188, v189
    v_lshlrev_b32 v188, 16, v208
    v_and_b32 v189, 0xffff0000, v208
    v_cvt_pk_bf16_f32 v208, v190, v191
    v_lshlrev_b32 v190, 16, v208
    v_and_b32 v191, 0xffff0000, v208
    v_cvt_pk_bf16_f32 v208, v192, v193
    v_lshlrev_b32 v192, 16, v208
    v_and_b32 v193, 0xffff0000, v208
    v_cvt_pk_bf16_f32 v208, v194, v195
    v_lshlrev_b32 v194, 16, v208
    v_and_b32 v195, 0xffff0000, v208
    v_cvt_pk_bf16_f32 v208, v196, v197
    v_lshlrev_b32 v196, 16, v208
    v_and_b32 v197, 0xffff0000, v208
    v_cvt_pk_bf16_f32 v208, v198, v199
    v_lshlrev_b32 v198, 16, v208
    v_and_b32 v199, 0xffff0000, v208
    buffer_load_dwordx4 v[90:93], v9, s[44:47], s56 offen nt
    s_add_u32 s56, s56, s68
    buffer_load_dwordx4 v[94:97], v9, s[44:47], s56 offen nt
    s_add_u32 s56, s56, s68
    buffer_load_dwordx4 v[98:101], v9, s[44:47], s56 offen nt
    s_add_u32 s56, s56, s68
    buffer_load_dwordx4 v[102:105], v9, s[44:47], s56 offen nt
    s_add_u32 s56, s56, s68
    buffer_load_dwordx4 v[106:109], v9, s[44:47], s56 offen nt
    s_add_u32 s56, s56, s68
    buffer_load_dwordx4 v[110:113], v9, s[44:47], s56 offen nt
    s_add_u32 s56, s56, s68
    buffer_load_dwordx4 v[114:117], v9, s[44:47], s56 offen nt
    s_add_u32 s56, s56, s68
    buffer_load_dwordx4 v[118:121], v9, s[44:47], s56 offen nt
    s_add_u32 s56, s56, s68
    buffer_load_dwordx4 v[122:125], v9, s[44:47], s56 offen nt
    s_add_u32 s56, s56, s68
    buffer_load_dwordx4 v[126:129], v9, s[44:47], s56 offen nt
    s_add_u32 s56, s56, s68
    buffer_load_dwordx4 v[130:133], v9, s[44:47], s56 offen nt
    s_add_u32 s56, s56, s68
    buffer_load_dwordx4 v[134:137], v9, s[44:47], s56 offen nt
    s_add_u32 s56, s56, s68
    buffer_load_dwordx4 v[138:141], v9, s[44:47], s56 offen nt
    s_add_u32 s56, s56, s68
    buffer_load_dwordx4 v[142:145], v9, s[44:47], s56 offen nt
    s_add_u32 s56, s56, s68
    buffer_load_dwordx4 v[146:149], v9, s[44:47], s56 offen nt
    s_add_u32 s56, s56, s68
    buffer_load_dwordx4 v[150:153], v9, s[44:47], s56 offen nt
    s_add_u32 s56, s56, s68
    buffer_load_dwordx4 v[154:157], v9, s[44:47], s56 offen nt
    s_add_u32 s56, s56, s68
    buffer_load_dwordx4 v[158:161], v9, s[44:47], s56 offen nt
    s_add_u32 s56, s56, s68
    buffer_load_dwordx4 v[162:165], v9, s[44:47], s56 offen nt
    s_add_u32 s56, s56, s68
    buffer_load_dwordx4 v[166:169], v9, s[44:47], s56 offen nt
    s_waitcnt vmcnt(19)
    v_lshlrev_b32 v208, 16, v90
    v_and_b32 v209, 0xffff0000, v90
    v_pk_mul_f32 v[200:201], v[208:209], v[180:181] op_sel_hi:[1,0]
    v_lshlrev_b32 v210, 16, v91
    v_and_b32 v211, 0xffff0000, v91
    v_pk_mul_f32 v[202:203], v[210:211], v[180:181] op_sel_hi:[1,0]
    v_lshlrev_b32 v208, 16, v92
    v_and_b32 v209, 0xffff0000, v92
    v_pk_mul_f32 v[204:205], v[208:209], v[180:181] op_sel_hi:[1,0]
    v_lshlrev_b32 v210, 16, v93
    v_and_b32 v211, 0xffff0000, v93
    v_pk_mul_f32 v[206:207], v[210:211], v[180:181] op_sel_hi:[1,0]
    s_waitcnt vmcnt(18)
    v_lshlrev_b32 v208, 16, v94
    v_and_b32 v209, 0xffff0000, v94
    v_pk_fma_f32 v[200:201], v[208:209], v[180:181], v[200:201] op_sel:[0,1,0] op_sel_hi:[1,1,1]
    v_lshlrev_b32 v210, 16, v95
    v_and_b32 v211, 0xffff0000, v95
    v_pk_fma_f32 v[202:203], v[210:211], v[180:181], v[202:203] op_sel:[0,1,0] op_sel_hi:[1,1,1]
    v_lshlrev_b32 v208, 16, v96
    v_and_b32 v209, 0xffff0000, v96
    v_pk_fma_f32 v[204:205], v[208:209], v[180:181], v[204:205] op_sel:[0,1,0] op_sel_hi:[1,1,1]
    v_lshlrev_b32 v210, 16, v97
    v_and_b32 v211, 0xffff0000, v97
    v_pk_fma_f32 v[206:207], v[210:211], v[180:181], v[206:207] op_sel:[0,1,0] op_sel_hi:[1,1,1]
    s_waitcnt vmcnt(17)
    v_lshlrev_b32 v208, 16, v98
    v_and_b32 v209, 0xffff0000, v98
    v_pk_fma_f32 v[200:201], v[208:209], v[182:183], v[200:201] op_sel_hi:[1,0,1]
    v_lshlrev_b32 v210, 16, v99
    v_and_b32 v211, 0xffff0000, v99
    v_pk_fma_f32 v[202:203], v[210:211], v[182:183], v[202:203] op_sel_hi:[1,0,1]
    v_lshlrev_b32 v208, 16, v100
    v_and_b32 v209, 0xffff0000, v100
    v_pk_fma_f32 v[204:205], v[208:209], v[182:183], v[204:205] op_sel_hi:[1,0,1]
    v_lshlrev_b32 v210, 16, v101
    v_and_b32 v211, 0xffff0000, v101
    v_pk_fma_f32 v[206:207], v[210:211], v[182:183], v[206:207] op_sel_hi:[1,0,1]
    s_waitcnt vmcnt(16)
    v_lshlrev_b32 v208, 16, v102
    v_and_b32 v209, 0xffff0000, v102
    v_pk_fma_f32 v[200:201], v[208:209], v[182:183], v[200:201] op_sel:[0,1,0] op_sel_hi:[1,1,1]
    v_lshlrev_b32 v210, 16, v103
    v_and_b32 v211, 0xffff0000, v103
    v_pk_fma_f32 v[202:203], v[210:211], v[182:183], v[202:203] op_sel:[0,1,0] op_sel_hi:[1,1,1]
    v_lshlrev_b32 v208, 16, v104
    v_and_b32 v209, 0xffff0000, v104
    v_pk_fma_f32 v[204:205], v[208:209], v[182:183], v[204:205] op_sel:[0,1,0] op_sel_hi:[1,1,1]
    v_lshlrev_b32 v210, 16, v105
    v_and_b32 v211, 0xffff0000, v105
    v_pk_fma_f32 v[206:207], v[210:211], v[182:183], v[206:207] op_sel:[0,1,0] op_sel_hi:[1,1,1]
    s_waitcnt vmcnt(15)
    v_lshlrev_b32 v208, 16, v106
    v_and_b32 v209, 0xffff0000, v106
    v_pk_fma_f32 v[200:201], v[208:209], v[184:185], v[200:201] op_sel_hi:[1,0,1]
    v_lshlrev_b32 v210, 16, v107
    v_and_b32 v211, 0xffff0000, v107
    v_pk_fma_f32 v[202:203], v[210:211], v[184:185], v[202:203] op_sel_hi:[1,0,1]
    v_lshlrev_b32 v208, 16, v108
    v_and_b32 v209, 0xffff0000, v108
    v_pk_fma_f32 v[204:205], v[208:209], v[184:185], v[204:205] op_sel_hi:[1,0,1]
    v_lshlrev_b32 v210, 16, v109
    v_and_b32 v211, 0xffff0000, v109
    v_pk_fma_f32 v[206:207], v[210:211], v[184:185], v[206:207] op_sel_hi:[1,0,1]
    s_waitcnt vmcnt(14)
    v_lshlrev_b32 v208, 16, v110
    v_and_b32 v209, 0xffff0000, v110
    v_pk_fma_f32 v[200:201], v[208:209], v[184:185], v[200:201] op_sel:[0,1,0] op_sel_hi:[1,1,1]
    v_lshlrev_b32 v210, 16, v111
    v_and_b32 v211, 0xffff0000, v111
    v_pk_fma_f32 v[202:203], v[210:211], v[184:185], v[202:203] op_sel:[0,1,0] op_sel_hi:[1,1,1]
    v_lshlrev_b32 v208, 16, v112
    v_and_b32 v209, 0xffff0000, v112
    v_pk_fma_f32 v[204:205], v[208:209], v[184:185], v[204:205] op_sel:[0,1,0] op_sel_hi:[1,1,1]
    v_lshlrev_b32 v210, 16, v113
    v_and_b32 v211, 0xffff0000, v113
    v_pk_fma_f32 v[206:207], v[210:211], v[184:185], v[206:207] op_sel:[0,1,0] op_sel_hi:[1,1,1]
    s_waitcnt vmcnt(13)
    v_lshlrev_b32 v208, 16, v114
    v_and_b32 v209, 0xffff0000, v114
    v_pk_fma_f32 v[200:201], v[208:209], v[186:187], v[200:201] op_sel_hi:[1,0,1]
    v_lshlrev_b32 v210, 16, v115
    v_and_b32 v211, 0xffff0000, v115
    v_pk_fma_f32 v[202:203], v[210:211], v[186:187], v[202:203] op_sel_hi:[1,0,1]
    v_lshlrev_b32 v208, 16, v116
    v_and_b32 v209, 0xffff0000, v116
    v_pk_fma_f32 v[204:205], v[208:209], v[186:187], v[204:205] op_sel_hi:[1,0,1]
    v_lshlrev_b32 v210, 16, v117
    v_and_b32 v211, 0xffff0000, v117
    v_pk_fma_f32 v[206:207], v[210:211], v[186:187], v[206:207] op_sel_hi:[1,0,1]
    s_waitcnt vmcnt(12)
    v_lshlrev_b32 v208, 16, v118
    v_and_b32 v209, 0xffff0000, v118
    v_pk_fma_f32 v[200:201], v[208:209], v[186:187], v[200:201] op_sel:[0,1,0] op_sel_hi:[1,1,1]
    v_lshlrev_b32 v210, 16, v119
    v_and_b32 v211, 0xffff0000, v119
    v_pk_fma_f32 v[202:203], v[210:211], v[186:187], v[202:203] op_sel:[0,1,0] op_sel_hi:[1,1,1]
    v_lshlrev_b32 v208, 16, v120
    v_and_b32 v209, 0xffff0000, v120
    v_pk_fma_f32 v[204:205], v[208:209], v[186:187], v[204:205] op_sel:[0,1,0] op_sel_hi:[1,1,1]
    v_lshlrev_b32 v210, 16, v121
    v_and_b32 v211, 0xffff0000, v121
    v_pk_fma_f32 v[206:207], v[210:211], v[186:187], v[206:207] op_sel:[0,1,0] op_sel_hi:[1,1,1]
    s_waitcnt vmcnt(11)
    v_lshlrev_b32 v208, 16, v122
    v_and_b32 v209, 0xffff0000, v122
    v_pk_fma_f32 v[200:201], v[208:209], v[188:189], v[200:201] op_sel_hi:[1,0,1]
    v_lshlrev_b32 v210, 16, v123
    v_and_b32 v211, 0xffff0000, v123
    v_pk_fma_f32 v[202:203], v[210:211], v[188:189], v[202:203] op_sel_hi:[1,0,1]
    v_lshlrev_b32 v208, 16, v124
    v_and_b32 v209, 0xffff0000, v124
    v_pk_fma_f32 v[204:205], v[208:209], v[188:189], v[204:205] op_sel_hi:[1,0,1]
    v_lshlrev_b32 v210, 16, v125
    v_and_b32 v211, 0xffff0000, v125
    v_pk_fma_f32 v[206:207], v[210:211], v[188:189], v[206:207] op_sel_hi:[1,0,1]
    s_waitcnt vmcnt(10)
    v_lshlrev_b32 v208, 16, v126
    v_and_b32 v209, 0xffff0000, v126
    v_pk_fma_f32 v[200:201], v[208:209], v[188:189], v[200:201] op_sel:[0,1,0] op_sel_hi:[1,1,1]
    v_lshlrev_b32 v210, 16, v127
    v_and_b32 v211, 0xffff0000, v127
    v_pk_fma_f32 v[202:203], v[210:211], v[188:189], v[202:203] op_sel:[0,1,0] op_sel_hi:[1,1,1]
    v_lshlrev_b32 v208, 16, v128
    v_and_b32 v209, 0xffff0000, v128
    v_pk_fma_f32 v[204:205], v[208:209], v[188:189], v[204:205] op_sel:[0,1,0] op_sel_hi:[1,1,1]
    v_lshlrev_b32 v210, 16, v129
    v_and_b32 v211, 0xffff0000, v129
    v_pk_fma_f32 v[206:207], v[210:211], v[188:189], v[206:207] op_sel:[0,1,0] op_sel_hi:[1,1,1]
    s_waitcnt vmcnt(9)
    v_lshlrev_b32 v208, 16, v130
    v_and_b32 v209, 0xffff0000, v130
    v_pk_fma_f32 v[200:201], v[208:209], v[190:191], v[200:201] op_sel_hi:[1,0,1]
    v_lshlrev_b32 v210, 16, v131
    v_and_b32 v211, 0xffff0000, v131
    v_pk_fma_f32 v[202:203], v[210:211], v[190:191], v[202:203] op_sel_hi:[1,0,1]
    v_lshlrev_b32 v208, 16, v132
    v_and_b32 v209, 0xffff0000, v132
    v_pk_fma_f32 v[204:205], v[208:209], v[190:191], v[204:205] op_sel_hi:[1,0,1]
    v_lshlrev_b32 v210, 16, v133
    v_and_b32 v211, 0xffff0000, v133
    v_pk_fma_f32 v[206:207], v[210:211], v[190:191], v[206:207] op_sel_hi:[1,0,1]
    s_waitcnt vmcnt(8)
    v_lshlrev_b32 v208, 16, v134
    v_and_b32 v209, 0xffff0000, v134
    v_pk_fma_f32 v[200:201], v[208:209], v[190:191], v[200:201] op_sel:[0,1,0] op_sel_hi:[1,1,1]
    v_lshlrev_b32 v210, 16, v135
    v_and_b32 v211, 0xffff0000, v135
    v_pk_fma_f32 v[202:203], v[210:211], v[190:191], v[202:203] op_sel:[0,1,0] op_sel_hi:[1,1,1]
    v_lshlrev_b32 v208, 16, v136
    v_and_b32 v209, 0xffff0000, v136
    v_pk_fma_f32 v[204:205], v[208:209], v[190:191], v[204:205] op_sel:[0,1,0] op_sel_hi:[1,1,1]
    v_lshlrev_b32 v210, 16, v137
    v_and_b32 v211, 0xffff0000, v137
    v_pk_fma_f32 v[206:207], v[210:211], v[190:191], v[206:207] op_sel:[0,1,0] op_sel_hi:[1,1,1]
    s_waitcnt vmcnt(7)
    v_lshlrev_b32 v208, 16, v138
    v_and_b32 v209, 0xffff0000, v138
    v_pk_fma_f32 v[200:201], v[208:209], v[192:193], v[200:201] op_sel_hi:[1,0,1]
    v_lshlrev_b32 v210, 16, v139
    v_and_b32 v211, 0xffff0000, v139
    v_pk_fma_f32 v[202:203], v[210:211], v[192:193], v[202:203] op_sel_hi:[1,0,1]
    v_lshlrev_b32 v208, 16, v140
    v_and_b32 v209, 0xffff0000, v140
    v_pk_fma_f32 v[204:205], v[208:209], v[192:193], v[204:205] op_sel_hi:[1,0,1]
    v_lshlrev_b32 v210, 16, v141
    v_and_b32 v211, 0xffff0000, v141
    v_pk_fma_f32 v[206:207], v[210:211], v[192:193], v[206:207] op_sel_hi:[1,0,1]
    s_waitcnt vmcnt(6)
    v_lshlrev_b32 v208, 16, v142
    v_and_b32 v209, 0xffff0000, v142
    v_pk_fma_f32 v[200:201], v[208:209], v[192:193], v[200:201] op_sel:[0,1,0] op_sel_hi:[1,1,1]
    v_lshlrev_b32 v210, 16, v143
    v_and_b32 v211, 0xffff0000, v143
    v_pk_fma_f32 v[202:203], v[210:211], v[192:193], v[202:203] op_sel:[0,1,0] op_sel_hi:[1,1,1]
    v_lshlrev_b32 v208, 16, v144
    v_and_b32 v209, 0xffff0000, v144
    v_pk_fma_f32 v[204:205], v[208:209], v[192:193], v[204:205] op_sel:[0,1,0] op_sel_hi:[1,1,1]
    v_lshlrev_b32 v210, 16, v145
    v_and_b32 v211, 0xffff0000, v145
    v_pk_fma_f32 v[206:207], v[210:211], v[192:193], v[206:207] op_sel:[0,1,0] op_sel_hi:[1,1,1]
    s_waitcnt vmcnt(5)
    v_lshlrev_b32 v208, 16, v146
    v_and_b32 v209, 0xffff0000, v146
    v_pk_fma_f32 v[200:201], v[208:209], v[194:195], v[200:201] op_sel_hi:[1,0,1]
    v_lshlrev_b32 v210, 16, v147
    v_and_b32 v211, 0xffff0000, v147
    v_pk_fma_f32 v[202:203], v[210:211], v[194:195], v[202:203] op_sel_hi:[1,0,1]
    v_lshlrev_b32 v208, 16, v148
    v_and_b32 v209, 0xffff0000, v148
    v_pk_fma_f32 v[204:205], v[208:209], v[194:195], v[204:205] op_sel_hi:[1,0,1]
    v_lshlrev_b32 v210, 16, v149
    v_and_b32 v211, 0xffff0000, v149
    v_pk_fma_f32 v[206:207], v[210:211], v[194:195], v[206:207] op_sel_hi:[1,0,1]
    s_waitcnt vmcnt(4)
    v_lshlrev_b32 v208, 16, v150
    v_and_b32 v209, 0xffff0000, v150
    v_pk_fma_f32 v[200:201], v[208:209], v[194:195], v[200:201] op_sel:[0,1,0] op_sel_hi:[1,1,1]
    v_lshlrev_b32 v210, 16, v151
    v_and_b32 v211, 0xffff0000, v151
    v_pk_fma_f32 v[202:203], v[210:211], v[194:195], v[202:203] op_sel:[0,1,0] op_sel_hi:[1,1,1]
    v_lshlrev_b32 v208, 16, v152
    v_and_b32 v209, 0xffff0000, v152
    v_pk_fma_f32 v[204:205], v[208:209], v[194:195], v[204:205] op_sel:[0,1,0] op_sel_hi:[1,1,1]
    v_lshlrev_b32 v210, 16, v153
    v_and_b32 v211, 0xffff0000, v153
    v_pk_fma_f32 v[206:207], v[210:211], v[194:195], v[206:207] op_sel:[0,1,0] op_sel_hi:[1,1,1]
    s_waitcnt vmcnt(3)
    v_lshlrev_b32 v208, 16, v154
    v_and_b32 v209, 0xffff0000, v154
    v_pk_fma_f32 v[200:201], v[208:209], v[196:197], v[200:201] op_sel_hi:[1,0,1]
    v_lshlrev_b32 v210, 16, v155
    v_and_b32 v211, 0xffff0000, v155
    v_pk_fma_f32 v[202:203], v[210:211], v[196:197], v[202:203] op_sel_hi:[1,0,1]
    v_lshlrev_b32 v208, 16, v156
    v_and_b32 v209, 0xffff0000, v156
    v_pk_fma_f32 v[204:205], v[208:209], v[196:197], v[204:205] op_sel_hi:[1,0,1]
    v_lshlrev_b32 v210, 16, v157
    v_and_b32 v211, 0xffff0000, v157
    v_pk_fma_f32 v[206:207], v[210:211], v[196:197], v[206:207] op_sel_hi:[1,0,1]
    s_waitcnt vmcnt(2)
    v_lshlrev_b32 v208, 16, v158
    v_and_b32 v209, 0xffff0000, v158
    v_pk_fma_f32 v[200:201], v[208:209], v[196:197], v[200:201] op_sel:[0,1,0] op_sel_hi:[1,1,1]
    v_lshlrev_b32 v210, 16, v159
    v_and_b32 v211, 0xffff0000, v159
    v_pk_fma_f32 v[202:203], v[210:211], v[196:197], v[202:203] op_sel:[0,1,0] op_sel_hi:[1,1,1]
    v_lshlrev_b32 v208, 16, v160
    v_and_b32 v209, 0xffff0000, v160
    v_pk_fma_f32 v[204:205], v[208:209], v[196:197], v[204:205] op_sel:[0,1,0] op_sel_hi:[1,1,1]
    v_lshlrev_b32 v210, 16, v161
    v_and_b32 v211, 0xffff0000, v161
    v_pk_fma_f32 v[206:207], v[210:211], v[196:197], v[206:207] op_sel:[0,1,0] op_sel_hi:[1,1,1]
    s_waitcnt vmcnt(1)
    v_lshlrev_b32 v208, 16, v162
    v_and_b32 v209, 0xffff0000, v162
    v_pk_fma_f32 v[200:201], v[208:209], v[198:199], v[200:201] op_sel_hi:[1,0,1]
    v_lshlrev_b32 v210, 16, v163
    v_and_b32 v211, 0xffff0000, v163
    v_pk_fma_f32 v[202:203], v[210:211], v[198:199], v[202:203] op_sel_hi:[1,0,1]
    v_lshlrev_b32 v208, 16, v164
    v_and_b32 v209, 0xffff0000, v164
    v_pk_fma_f32 v[204:205], v[208:209], v[198:199], v[204:205] op_sel_hi:[1,0,1]
    v_lshlrev_b32 v210, 16, v165
    v_and_b32 v211, 0xffff0000, v165
    v_pk_fma_f32 v[206:207], v[210:211], v[198:199], v[206:207] op_sel_hi:[1,0,1]
    s_waitcnt vmcnt(0)
    v_lshlrev_b32 v208, 16, v166
    v_and_b32 v209, 0xffff0000, v166
    v_pk_fma_f32 v[200:201], v[208:209], v[198:199], v[200:201] op_sel:[0,1,0] op_sel_hi:[1,1,1]
    v_lshlrev_b32 v210, 16, v167
    v_and_b32 v211, 0xffff0000, v167
    v_pk_fma_f32 v[202:203], v[210:211], v[198:199], v[202:203] op_sel:[0,1,0] op_sel_hi:[1,1,1]
    v_lshlrev_b32 v208, 16, v168
    v_and_b32 v209, 0xffff0000, v168
    v_pk_fma_f32 v[204:205], v[208:209], v[198:199], v[204:205] op_sel:[0,1,0] op_sel_hi:[1,1,1]
    v_lshlrev_b32 v210, 16, v169
    v_and_b32 v211, 0xffff0000, v169
    v_pk_fma_f32 v[206:207], v[210:211], v[198:199], v[206:207] op_sel:[0,1,0] op_sel_hi:[1,1,1]
    v_readfirstlane_b32 s48, v246
    s_mul_i32 s48, s48, 0x9E3779B1
    s_add_u32 s48, s48, 0x7F4A7C15
    v_lshlrev_b32 v2, 5, v0
    ds_write_b128 v2, v[200:203] offset:0
    ds_write_b128 v2, v[204:207] offset:16
    s_waitcnt lgkmcnt(0)
    s_barrier
    s_cmp_eq_u32 s3, 0
    s_cbranch_scc0 L_mod_done
    v_lshlrev_b32 v2, 2, v1
    ds_read_b32 v80, v2 offset:0
    ds_read_b32 v81, v2 offset:256
    ds_read_b32 v82, v2 offset:512
    ds_read_b32 v83, v2 offset:768
    ds_read_b32 v84, v2 offset:1024
    ds_read_b32 v85, v2 offset:1280
    ds_read_b32 v86, v2 offset:1536
    ds_read_b32 v87, v2 offset:1792
    ds_read_b32 v88, v2 offset:2048
    ds_read_b32 v89, v2 offset:2304
    ds_read_b32 v90, v2 offset:2560
    ds_read_b32 v91, v2 offset:2816
    ds_read_b32 v92, v2 offset:3072
    ds_read_b32 v93, v2 offset:3328
    ds_read_b32 v94, v2 offset:3584
    ds_read_b32 v95, v2 offset:3840
    ds_read_b32 v96, v2 offset:4096
    ds_read_b32 v97, v2 offset:4352
    ds_read_b32 v98, v2 offset:4608
    ds_read_b32 v99, v2 offset:4864
    ds_read_b32 v100, v2 offset:5120
    ds_read_b32 v101, v2 offset:5376
    ds_read_b32 v102, v2 offset:5632
    ds_read_b32 v103, v2 offset:5888
    ds_read_b32 v104, v2 offset:6144
    ds_read_b32 v105, v2 offset:6400
    ds_read_b32 v106, v2 offset:6656
    ds_read_b32 v107, v2 offset:6912
    ds_read_b32 v108, v2 offset:7168
    ds_read_b32 v109, v2 offset:7424
    ds_read_b32 v110, v2 offset:7680
    ds_read_b32 v111, v2 offset:7936
    s_waitcnt lgkmcnt(14)
    v_add_f32 v80, v80, v96
    v_add_f32 v81, v81, v97
    s_waitcnt lgkmcnt(13)
    v_add_f32 v82, v82, v98
    s_waitcnt lgkmcnt(12)
    v_add_f32 v83, v83, v99
    s_waitcnt lgkmcnt(11)
    v_add_f32 v84, v84, v100
    s_waitcnt lgkmcnt(10)
    v_add_f32 v85, v85, v101
    s_waitcnt lgkmcnt(9)
    v_add_f32 v86, v86, v102
    s_waitcnt lgkmcnt(8)
    v_add_f32 v87, v87, v103
    s_waitcnt lgkmcnt(7)
    v_add_f32 v88, v88, v104
    s_waitcnt lgkmcnt(6)
    v_add_f32 v89, v89, v105
    s_waitcnt lgkmcnt(5)
    v_add_f32 v90, v90, v106
    s_waitcnt lgkmcnt(4)
    v_add_f32 v91, v91, v107
    s_waitcnt lgkmcnt(3)
    v_add_f32 v92, v92, v108
    s_waitcnt lgkmcnt(2)
    v_add_f32 v93, v93, v109
    s_waitcnt lgkmcnt(1)
    v_add_f32 v94, v94, v110
    s_waitcnt lgkmcnt(0)
    v_add_f32 v95, v95, v111
    v_add_f32 v80, v80, v88
    v_add_f32 v81, v81, v89
    v_add_f32 v82, v82, v90
    v_add_f32 v83, v83, v91
    v_add_f32 v84, v84, v92
    v_add_f32 v85, v85, v93
    v_add_f32 v86, v86, v94
    v_add_f32 v87, v87, v95
    v_add_f32 v80, v80, v84
    v_add_f32 v81, v81, v85
    v_add_f32 v82, v82, v86
    v_add_f32 v83, v83, v87
    v_add_f32 v80, v80, v82
    v_add_f32 v81, v81, v83
    v_add_f32 v80, v80, v81
    s_mov_b32 s50, 429496730
    s_mul_hi_u32 s51, s77, s50
    s_mul_i32 s52, s51, 10
    s_sub_u32 s52, s77, s52
    v_cvt_pk_bf16_f32 v3, v80, v80
    v_lshlrev_b32 v3, 16, v3
    v_add_f32 v4, 1.0, v3
    v_cvt_pk_bf16_f32 v4, v4, v4
    v_lshlrev_b32 v4, 16, v4
    s_cmp_eq_u32 s51, 1
    s_cselect_b64 vcc, -1, 0
    s_cmp_eq_u32 s51, 4
    s_cselect_b64 vcc, -1, vcc
    v_cndmask_b32 v3, v3, v4, vcc
    s_cmp_eq_u32 s51, 4
    s_cbranch_scc0 L_mod_noicb
    v_cmp_eq_f32 vcc, 0, v3
    v_mov_b32 v4, 0x2b800000
    s_nop 0
    v_cndmask_b32 v3, v3, v4, vcc
    v_rcp_f32 v4, v3
    s_lshl_b32 s53, s52, 8
    s_add_u32 s53, s53, 23183360
    v_fma_f32 v5, -v3, v4, 1.0
    v_fmac_f32 v4, v5, v4
    buffer_store_dword v4, v2, s[36:39], s53 offen sc1
    buffer_store_dword v4, v2, s[36:39], s53 offen offset:2560 sc1
L_mod_noicb:
    v_mov_b32 v4, v3
    v_mov_b32 v5, s48
    v_lshlrev_b32 v6, 3, v1
    s_lshl_b32 s53, s77, 9
    s_add_u32 s53, s53, 23560192
    buffer_store_dwordx2 v[4:5], v6, s[36:39], s53 offen sc1
    s_lshl_b32 s53, s77, 8
    s_add_u32 s53, s53, 23134208
    buffer_store_dword v3, v2, s[36:39], s53 offen sc1
    s_sub_u32 s53, s51, 3
    s_cmp_lt_u32 s53, 2
    s_cbranch_scc0 L_mod_done
    v_mov_b32_dpp v4, v3 quad_perm:[1,0,3,2] row_mask:0xf bank_mask:0xf
    v_lshrrev_b32 v5, 16, v3
    v_or_b32 v5, v5, v4
    v_lshrrev_b32 v6, 5, v1
    v_lshlrev_b32 v6, 7, v6
    v_bfe_u32 v7, v1, 2, 2
    v_lshl_add_u32 v6, v7, 4, v6
    v_bfe_u32 v7, v1, 4, 1
    v_lshl_add_u32 v6, v7, 3, v6
    v_and_b32 v7, 2, v1
    v_lshl_add_u32 v6, v7, 1, v6
    s_xor_b32 s53, s53, 1
    s_lshl_b32 s53, s53, 6
    s_lshl_b32 s52, s52, 8
    s_add_u32 s53, s53, s52
    s_add_u32 s53, s53, 23166976
    s_mov_b32 exec_lo, 0x55555555
    s_mov_b32 exec_hi, 0x55555555
    buffer_store_dword v5, v6, s[36:39], s53 offen sc1
    buffer_store_dword v5, v6, s[36:39], s53 offen offset:2560 sc1
    s_mov_b64 exec, -1
L_mod_done:
    s_add_u32 s77, s77, 40
    s_branch L_p_w
L_p_b:
    s_mov_b32 s36, s32
    s_mov_b32 s37, s33
    s_mov_b32 s38, 0x10000000
    s_mov_b32 s39, 0x20000
    v_mov_b32 v2, 0
    s_mov_b32 s57, 23461888
    buffer_load_dword v246, v2, s[36:39], s57 offen sc1
    s_mov_b32 s49, 400000
    s_and_b32 s50, s2, 7
    s_lshr_b32 s51, s2, 3
    s_lshr_b32 s60, s50, 2
    s_lshl_b32 s60, s60, 3
    s_lshr_b32 s61, s51, 2
    s_add_u32 s72, s60, s61
    s_lshl_b32 s61, s61, 3
    s_mov_b32 s62, 0x6040200
    s_mov_b32 s63, 0x70308
    s_lshr_b64 s[62:63], s[62:63], s61
    s_and_b32 s34, s62, 255
    s_lshr_b32 s62, s50, 2
    s_mul_i32 s62, s62, 10
    s_add_u32 s34, s34, s62
    s_sub_u32 s62, s34, 20
    s_min_u32 s34, s34, s62
    s_and_b32 s60, s50, 3
    s_lshl_b32 s60, s60, 2
    s_and_b32 s61, s51, 3
    s_add_u32 s73, s60, s61
    s_and_b32 s75, s51, 7
    s_lshr_b32 s61, s51, 3
    s_lshl_b32 s60, s50, 2
    s_add_u32 s74, s60, s61
    s_mul_i32 s70, s50, 20
    s_add_u32 s70, s70, s51
    s_lshl_b32 s60, s50, 1
    s_cmp_ge_u32 s51, 10
    s_addc_u32 s60, s60, 0
    s_cmp_ge_u32 s51, 10
    s_cselect_b32 s61, 10, 0
    s_sub_u32 s61, s51, s61
    s_lshl_b32 s61, s61, 4
    s_add_u32 s76, s60, s61
    s_lshl_b32 s58, s70, 2
    s_add_u32 s58, s58, s3
    v_lshlrev_b32 v248, 4, v1
    s_waitcnt vmcnt(0)
    v_readfirstlane_b32 s48, v246
    s_mul_i32 s48, s48, 0x9E3779B1
    s_add_u32 s48, s48, 0x7F4A7C15
    s_mov_b32 s76, s65
    s_add_u32 s77, s71, 1048
    s_branch L_p_w
L_p_s:
    s_mov_b32 s36, s32
    s_mov_b32 s37, s33
    s_mov_b32 s38, 0x10000000
    s_mov_b32 s39, 0x20000
    v_mov_b32 v2, 0
    s_mov_b32 s57, 23461888
    buffer_load_dword v246, v2, s[36:39], s57 offen sc1
    s_mov_b32 s49, 400000
    s_and_b32 s50, s2, 7
    s_lshr_b32 s51, s2, 3
    s_lshr_b32 s60, s50, 2
    s_lshl_b32 s60, s60, 3
    s_lshr_b32 s61, s51, 2
    s_add_u32 s72, s60, s61
    s_lshl_b32 s61, s61, 3
    s_mov_b32 s62, 0x6040200
    s_mov_b32 s63, 0x70308
    s_lshr_b64 s[62:63], s[62:63], s61
    s_and_b32 s34, s62, 255
    s_lshr_b32 s62, s50, 2
    s_mul_i32 s62, s62, 10
    s_add_u32 s34, s34, s62
    s_sub_u32 s62, s34, 20
    s_min_u32 s34, s34, s62
    s_and_b32 s60, s50, 3
    s_lshl_b32 s60, s60, 2
    s_and_b32 s61, s51, 3
    s_add_u32 s73, s60, s61
    s_and_b32 s75, s51, 7
    s_lshr_b32 s61, s51, 3
    s_lshl_b32 s60, s50, 2
    s_add_u32 s74, s60, s61
    s_mul_i32 s70, s50, 20
    s_add_u32 s70, s70, s51
    s_lshl_b32 s60, s50, 1
    s_cmp_ge_u32 s51, 10
    s_addc_u32 s60, s60, 0
    s_cmp_ge_u32 s51, 10
    s_cselect_b32 s61, 10, 0
    s_sub_u32 s61, s51, s61
    s_lshl_b32 s61, s61, 4
    s_add_u32 s76, s60, s61
    s_lshl_b32 s58, s70, 2
    s_add_u32 s58, s58, s3
    v_lshlrev_b32 v248, 4, v1
    s_mov_b32 s44, s4
    s_mov_b32 s45, s5
    s_mov_b32 s46, 0x280000
    s_mov_b32 s47, 0x20000
    s_lshl_b32 s50, s77, 2
    s_add_u32 s50, s50, s3
    s_mul_i32 s56, s50, 20480
    v_lshrrev_b32 v2, 4, v1
    v_mul_u32_u24 v2, 1280, v2
    v_and_b32 v3, 15, v1
    v_lshl_add_u32 v2, v3, 4, v2
    buffer_load_dwordx4 v[16:19], v2, s[44:47], s56 offen offset:0 nt
    buffer_load_dwordx4 v[20:23], v2, s[44:47], s56 offen offset:256 nt
    buffer_load_dwordx4 v[24:27], v2, s[44:47], s56 offen offset:512 nt
    buffer_load_dwordx4 v[28:31], v2, s[44:47], s56 offen offset:768 nt
    buffer_load_dwordx4 v[32:35], v2, s[44:47], s56 offen offset:1024 nt
    s_add_u32 s56, s56, 5120
    buffer_load_dwordx4 v[36:39], v2, s[44:47], s56 offen offset:0 nt
    buffer_load_dwordx4 v[40:43], v2, s[44:47], s56 offen offset:256 nt
    buffer_load_dwordx4 v[44:47], v2, s[44:47], s56 offen offset:512 nt
    buffer_load_dwordx4 v[48:51], v2, s[44:47], s56 offen offset:768 nt
    buffer_load_dwordx4 v[52:55], v2, s[44:47], s56 offen offset:1024 nt
    s_add_u32 s56, s56, 5120
    buffer_load_dwordx4 v[56:59], v2, s[44:47], s56 offen offset:0 nt
    buffer_load_dwordx4 v[60:63], v2, s[44:47], s56 offen offset:256 nt
    buffer_load_dwordx4 v[64:67], v2, s[44:47], s56 offen offset:512 nt
    buffer_load_dwordx4 v[68:71], v2, s[44:47], s56 offen offset:768 nt
    buffer_load_dwordx4 v[72:75], v2, s[44:47], s56 offen offset:1024 nt
    s_add_u32 s56, s56, 5120
    buffer_load_dwordx4 v[76:79], v2, s[44:47], s56 offen offset:0 nt
    buffer_load_dwordx4 v[80:83], v2, s[44:47], s56 offen offset:256 nt
    buffer_load_dwordx4 v[84:87], v2, s[44:47], s56 offen offset:512 nt
    buffer_load_dwordx4 v[88:91], v2, s[44:47], s56 offen offset:768 nt
    buffer_load_dwordx4 v[92:95], v2, s[44:47], s56 offen offset:1024 nt
    s_mov_b32 s76, s65
    s_mov_b32 s50, 0x3f803f80
    v_mov_b32 v180, 0
    v_mov_b32 v181, 0
    v_mov_b32 v182, 0
    v_mov_b32 v183, 0
    v_mov_b32 v184, 0
    v_mov_b32 v185, 0
    v_mov_b32 v186, 0
    v_mov_b32 v187, 0
    s_waitcnt vmcnt(19)
    v_dot2_f32_bf16 v180, v16, s50, v180
    v_dot2_f32_bf16 v184, v16, v16, v184
    v_dot2_f32_bf16 v180, v17, s50, v180
    v_dot2_f32_bf16 v184, v17, v17, v184
    v_dot2_f32_bf16 v180, v18, s50, v180
    v_dot2_f32_bf16 v184, v18, v18, v184
    v_dot2_f32_bf16 v180, v19, s50, v180
    v_dot2_f32_bf16 v184, v19, v19, v184
    s_waitcnt vmcnt(18)
    v_dot2_f32_bf16 v180, v20, s50, v180
    v_dot2_f32_bf16 v184, v20, v20, v184
    v_dot2_f32_bf16 v180, v21, s50, v180
    v_dot2_f32_bf16 v184, v21, v21, v184
    v_dot2_f32_bf16 v180, v22, s50, v180
    v_dot2_f32_bf16 v184, v22, v22, v184
    v_dot2_f32_bf16 v180, v23, s50, v180
    v_dot2_f32_bf16 v184, v23, v23, v184
    s_waitcnt vmcnt(17)
    v_dot2_f32_bf16 v180, v24, s50, v180
    v_dot2_f32_bf16 v184, v24, v24, v184
    v_dot2_f32_bf16 v180, v25, s50, v180
    v_dot2_f32_bf16 v184, v25, v25, v184
    v_dot2_f32_bf16 v180, v26, s50, v180
    v_dot2_f32_bf16 v184, v26, v26, v184
    v_dot2_f32_bf16 v180, v27, s50, v180
    v_dot2_f32_bf16 v184, v27, v27, v184
    s_waitcnt vmcnt(16)
    v_dot2_f32_bf16 v180, v28, s50, v180
    v_dot2_f32_bf16 v184, v28, v28, v184
    v_dot2_f32_bf16 v180, v29, s50, v180
    v_dot2_f32_bf16 v184, v29, v29, v184
    v_dot2_f32_bf16 v180, v30, s50, v180
    v_dot2_f32_bf16 v184, v30, v30, v184
    v_dot2_f32_bf16 v180, v31, s50, v180
    v_dot2_f32_bf16 v184, v31, v31, v184
    s_waitcnt vmcnt(15)
    v_dot2_f32_bf16 v180, v32, s50, v180
    v_dot2_f32_bf16 v184, v32, v32, v184
    v_dot2_f32_bf16 v180, v33, s50, v180
    v_dot2_f32_bf16 v184, v33, v33, v184
    v_dot2_f32_bf16 v180, v34, s50, v180
    v_dot2_f32_bf16 v184, v34, v34, v184
    v_dot2_f32_bf16 v180, v35, s50, v180
    v_dot2_f32_bf16 v184, v35, v35, v184
    s_waitcnt vmcnt(14)
    v_dot2_f32_bf16 v181, v36, s50, v181
    v_dot2_f32_bf16 v185, v36, v36, v185
    v_dot2_f32_bf16 v181, v37, s50, v181
    v_dot2_f32_bf16 v185, v37, v37, v185
    v_dot2_f32_bf16 v181, v38, s50, v181
    v_dot2_f32_bf16 v185, v38, v38, v185
    v_dot2_f32_bf16 v181, v39, s50, v181
    v_dot2_f32_bf16 v185, v39, v39, v185
    s_waitcnt vmcnt(13)
    v_dot2_f32_bf16 v181, v40, s50, v181
    v_dot2_f32_bf16 v185, v40, v40, v185
    v_dot2_f32_bf16 v181, v41, s50, v181
    v_dot2_f32_bf16 v185, v41, v41, v185
    v_dot2_f32_bf16 v181, v42, s50, v181
    v_dot2_f32_bf16 v185, v42, v42, v185
    v_dot2_f32_bf16 v181, v43, s50, v181
    v_dot2_f32_bf16 v185, v43, v43, v185
    s_waitcnt vmcnt(12)
    v_dot2_f32_bf16 v181, v44, s50, v181
    v_dot2_f32_bf16 v185, v44, v44, v185
    v_dot2_f32_bf16 v181, v45, s50, v181
    v_dot2_f32_bf16 v185, v45, v45, v185
    v_dot2_f32_bf16 v181, v46, s50, v181
    v_dot2_f32_bf16 v185, v46, v46, v185
    v_dot2_f32_bf16 v181, v47, s50, v181
    v_dot2_f32_bf16 v185, v47, v47, v185
    s_waitcnt vmcnt(11)
    v_dot2_f32_bf16 v181, v48, s50, v181
    v_dot2_f32_bf16 v185, v48, v48, v185
    v_dot2_f32_bf16 v181, v49, s50, v181
    v_dot2_f32_bf16 v185, v49, v49, v185
    v_dot2_f32_bf16 v181, v50, s50, v181
    v_dot2_f32_bf16 v185, v50, v50, v185
    v_dot2_f32_bf16 v181, v51, s50, v181
    v_dot2_f32_bf16 v185, v51, v51, v185
    s_waitcnt vmcnt(10)
    v_dot2_f32_bf16 v181, v52, s50, v181
    v_dot2_f32_bf16 v185, v52, v52, v185
    v_dot2_f32_bf16 v181, v53, s50, v181
    v_dot2_f32_bf16 v185, v53, v53, v185
    v_dot2_f32_bf16 v181, v54, s50, v181
    v_dot2_f32_bf16 v185, v54, v54, v185
    v_dot2_f32_bf16 v181, v55, s50, v181
    v_dot2_f32_bf16 v185, v55, v55, v185
    s_waitcnt vmcnt(9)
    v_dot2_f32_bf16 v182, v56, s50, v182
    v_dot2_f32_bf16 v186, v56, v56, v186
    v_dot2_f32_bf16 v182, v57, s50, v182
    v_dot2_f32_bf16 v186, v57, v57, v186
    v_dot2_f32_bf16 v182, v58, s50, v182
    v_dot2_f32_bf16 v186, v58, v58, v186
    v_dot2_f32_bf16 v182, v59, s50, v182
    v_dot2_f32_bf16 v186, v59, v59, v186
    s_waitcnt vmcnt(8)
    v_dot2_f32_bf16 v182, v60, s50, v182
    v_dot2_f32_bf16 v186, v60, v60, v186
    v_dot2_f32_bf16 v182, v61, s50, v182
    v_dot2_f32_bf16 v186, v61, v61, v186
    v_dot2_f32_bf16 v182, v62, s50, v182
    v_dot2_f32_bf16 v186, v62, v62, v186
    v_dot2_f32_bf16 v182, v63, s50, v182
    v_dot2_f32_bf16 v186, v63, v63, v186
    s_waitcnt vmcnt(7)
    v_dot2_f32_bf16 v182, v64, s50, v182
    v_dot2_f32_bf16 v186, v64, v64, v186
    v_dot2_f32_bf16 v182, v65, s50, v182
    v_dot2_f32_bf16 v186, v65, v65, v186
    v_dot2_f32_bf16 v182, v66, s50, v182
    v_dot2_f32_bf16 v186, v66, v66, v186
    v_dot2_f32_bf16 v182, v67, s50, v182
    v_dot2_f32_bf16 v186, v67, v67, v186
    s_waitcnt vmcnt(6)
    v_dot2_f32_bf16 v182, v68, s50, v182
    v_dot2_f32_bf16 v186, v68, v68, v186
    v_dot2_f32_bf16 v182, v69, s50, v182
    v_dot2_f32_bf16 v186, v69, v69, v186
    v_dot2_f32_bf16 v182, v70, s50, v182
    v_dot2_f32_bf16 v186, v70, v70, v186
    v_dot2_f32_bf16 v182, v71, s50, v182
    v_dot2_f32_bf16 v186, v71, v71, v186
    s_waitcnt vmcnt(5)
    v_dot2_f32_bf16 v182, v72, s50, v182
    v_dot2_f32_bf16 v186, v72, v72, v186
    v_dot2_f32_bf16 v182, v73, s50, v182
    v_dot2_f32_bf16 v186, v73, v73, v186
    v_dot2_f32_bf16 v182, v74, s50, v182
    v_dot2_f32_bf16 v186, v74, v74, v186
    v_dot2_f32_bf16 v182, v75, s50, v182
    v_dot2_f32_bf16 v186, v75, v75, v186
    s_waitcnt vmcnt(4)
    v_dot2_f32_bf16 v183, v76, s50, v183
    v_dot2_f32_bf16 v187, v76, v76, v187
    v_dot2_f32_bf16 v183, v77, s50, v183
    v_dot2_f32_bf16 v187, v77, v77, v187
    v_dot2_f32_bf16 v183, v78, s50, v183
    v_dot2_f32_bf16 v187, v78, v78, v187
    v_dot2_f32_bf16 v183, v79, s50, v183
    v_dot2_f32_bf16 v187, v79, v79, v187
    s_waitcnt vmcnt(3)
    v_dot2_f32_bf16 v183, v80, s50, v183
    v_dot2_f32_bf16 v187, v80, v80, v187
    v_dot2_f32_bf16 v183, v81, s50, v183
    v_dot2_f32_bf16 v187, v81, v81, v187
    v_dot2_f32_bf16 v183, v82, s50, v183
    v_dot2_f32_bf16 v187, v82, v82, v187
    v_dot2_f32_bf16 v183, v83, s50, v183
    v_dot2_f32_bf16 v187, v83, v83, v187
    s_waitcnt vmcnt(2)
    v_dot2_f32_bf16 v183, v84, s50, v183
    v_dot2_f32_bf16 v187, v84, v84, v187
    v_dot2_f32_bf16 v183, v85, s50, v183
    v_dot2_f32_bf16 v187, v85, v85, v187
    v_dot2_f32_bf16 v183, v86, s50, v183
    v_dot2_f32_bf16 v187, v86, v86, v187
    v_dot2_f32_bf16 v183, v87, s50, v183
    v_dot2_f32_bf16 v187, v87, v87, v187
    s_waitcnt vmcnt(1)
    v_dot2_f32_bf16 v183, v88, s50, v183
    v_dot2_f32_bf16 v187, v88, v88, v187
    v_dot2_f32_bf16 v183, v89, s50, v183
    v_dot2_f32_bf16 v187, v89, v89, v187
    v_dot2_f32_bf16 v183, v90, s50, v183
    v_dot2_f32_bf16 v187, v90, v90, v187
    v_dot2_f32_bf16 v183, v91, s50, v183
    v_dot2_f32_bf16 v187, v91, v91, v187
    s_waitcnt vmcnt(0)
    v_dot2_f32_bf16 v183, v92, s50, v183
    v_dot2_f32_bf16 v187, v92, v92, v187
    v_dot2_f32_bf16 v183, v93, s50, v183
    v_dot2_f32_bf16 v187, v93, v93, v187
    v_dot2_f32_bf16 v183, v94, s50, v183
    v_dot2_f32_bf16 v187, v94, v94, v187
    v_dot2_f32_bf16 v183, v95, s50, v183
    v_dot2_f32_bf16 v187, v95, v95, v187
    s_nop 2
    v_add_f32_dpp v180, v180, v180 row_ror:8 row_mask:0xf bank_mask:0xf
    v_add_f32_dpp v181, v181, v181 row_ror:8 row_mask:0xf bank_mask:0xf
    v_add_f32_dpp v182, v182, v182 row_ror:8 row_mask:0xf bank_mask:0xf
    v_add_f32_dpp v183, v183, v183 row_ror:8 row_mask:0xf bank_mask:0xf
    v_add_f32_dpp v184, v184, v184 row_ror:8 row_mask:0xf bank_mask:0xf
    v_add_f32_dpp v185, v185, v185 row_ror:8 row_mask:0xf bank_mask:0xf
    v_add_f32_dpp v186, v186, v186 row_ror:8 row_mask:0xf bank_mask:0xf
    v_add_f32_dpp v187, v187, v187 row_ror:8 row_mask:0xf bank_mask:0xf
    v_add_f32_dpp v180, v180, v180 row_ror:4 row_mask:0xf bank_mask:0xf
    v_add_f32_dpp v181, v181, v181 row_ror:4 row_mask:0xf bank_mask:0xf
    v_add_f32_dpp v182, v182, v182 row_ror:4 row_mask:0xf bank_mask:0xf
    v_add_f32_dpp v183, v183, v183 row_ror:4 row_mask:0xf bank_mask:0xf
    v_add_f32_dpp v184, v184, v184 row_ror:4 row_mask:0xf bank_mask:0xf
    v_add_f32_dpp v185, v185, v185 row_ror:4 row_mask:0xf bank_mask:0xf
    v_add_f32_dpp v186, v186, v186 row_ror:4 row_mask:0xf bank_mask:0xf
    v_add_f32_dpp v187, v187, v187 row_ror:4 row_mask:0xf bank_mask:0xf
    v_add_f32_dpp v180, v180, v180 row_ror:2 row_mask:0xf bank_mask:0xf
    v_add_f32_dpp v181, v181, v181 row_ror:2 row_mask:0xf bank_mask:0xf
    v_add_f32_dpp v182, v182, v182 row_ror:2 row_mask:0xf bank_mask:0xf
    v_add_f32_dpp v183, v183, v183 row_ror:2 row_mask:0xf bank_mask:0xf
    v_add_f32_dpp v184, v184, v184 row_ror:2 row_mask:0xf bank_mask:0xf
    v_add_f32_dpp v185, v185, v185 row_ror:2 row_mask:0xf bank_mask:0xf
    v_add_f32_dpp v186, v186, v186 row_ror:2 row_mask:0xf bank_mask:0xf
    v_add_f32_dpp v187, v187, v187 row_ror:2 row_mask:0xf bank_mask:0xf
    v_add_f32_dpp v180, v180, v180 row_ror:1 row_mask:0xf bank_mask:0xf
    v_add_f32_dpp v181, v181, v181 row_ror:1 row_mask:0xf bank_mask:0xf
    v_add_f32_dpp v182, v182, v182 row_ror:1 row_mask:0xf bank_mask:0xf
    v_add_f32_dpp v183, v183, v183 row_ror:1 row_mask:0xf bank_mask:0xf
    v_add_f32_dpp v184, v184, v184 row_ror:1 row_mask:0xf bank_mask:0xf
    v_add_f32_dpp v185, v185, v185 row_ror:1 row_mask:0xf bank_mask:0xf
    v_add_f32_dpp v186, v186, v186 row_ror:1 row_mask:0xf bank_mask:0xf
    v_add_f32_dpp v187, v187, v187 row_ror:1 row_mask:0xf bank_mask:0xf
    v_and_b32 v3, 15, v1
    v_cmp_eq_u32 vcc, 1, v3
    s_nop 1
    v_cndmask_b32 v180, v180, v181, vcc
    v_cndmask_b32 v184, v184, v185, vcc
    v_cmp_eq_u32 vcc, 2, v3
    s_nop 1
    v_cndmask_b32 v180, v180, v182, vcc
    v_cndmask_b32 v184, v184, v186, vcc
    v_cmp_eq_u32 vcc, 3, v3
    s_nop 1
    v_cndmask_b32 v180, v180, v183, vcc
    v_cndmask_b32 v184, v184, v187, vcc
    v_mul_f32 v180, 0x3acccccd, v180
    v_mul_f32 v190, v180, v180
    v_mov_b32 v188, 0x3acccccd
    v_fma_f32 v184, v184, v188, -v190
    v_max_f32 v184, 0, v184
    v_add_f32 v184, 0x3727c5ac, v184
    v_rsq_f32 v188, v184
    s_nop 0
    v_mul_f32_e64 v189, -v180, v188
    v_lshrrev_b32 v2, 4, v1
    v_lshl_add_u32 v2, v3, 2, v2
    v_lshlrev_b32 v2, 2, v2
    s_lshl_b32 s50, s77, 2
    s_add_u32 s50, s50, s3
    s_lshl_b32 s50, s50, 6
    s_add_u32 s50, s50, 23068672
    s_cmp_lt_u32 s77, 32
    s_cselect_b32 s50, s50, 268435456
    s_add_u32 s51, s50, 8192
    s_mov_b32 exec_lo, 0x000f000f
    s_mov_b32 exec_hi, 0x000f000f
    buffer_store_dword v188, v2, s[36:39], s50 offen sc1
    buffer_store_dword v189, v2, s[36:39], s51 offen sc1
    s_mov_b64 exec, -1
    s_waitcnt vmcnt(0) lgkmcnt(0)
    s_barrier
    v_readfirstlane_b32 s48, v246
    s_mul_i32 s48, s48, 0x9E3779B1
    s_add_u32 s48, s48, 0x7F4A7C15
    s_cmp_eq_u32 s3, 0
    s_cbranch_scc0 L_wf15
    s_lshl_b32 s54, s77, 7
    s_add_u32 s54, s54, 23220224
    v_mov_b32 v2, 0
    v_mov_b32 v3, s48
    s_mov_b64 exec, 1
    buffer_store_dword v3, v2, s[36:39], s54 offen sc1
    s_mov_b64 exec, -1
L_wf15:
L_p_w:
    s_mov_b32 s56, s22
    s_mov_b32 s57, s23
    s_mov_b32 s58, 0x1e0000
    s_mov_b32 s59, 0x20000
    s_and_b32 s50, s3, 1
    s_mul_i32 s61, s50, 3104
    s_mul_i32 s50, s50, 12288
    s_mul_i32 s64, s73, 192
    s_add_u32 s64, s64, s50
    s_mul_i32 s50, s34, 98304
    s_add_u32 s64, s64, s50
    s_cmp_ge_u32 s3, 2
    s_cselect_b32 s40, s20, s18
    s_cselect_b32 s41, s21, s19
    s_cselect_b32 s50, 6224, 0
    s_add_u32 s61, s61, s50
    s_mov_b32 s42, 1966080
    s_mov_b32 s43, 0x20000
    v_add_u32 v2, 0, v1
    v_mul_u32_u24 v3, 171, v2
    v_lshrrev_b32 v3, 11, v3
    v_mul_u32_u24 v4, 12, v3
    v_sub_u32 v4, v2, v4
    v_and_b32 v2, 12, v3
    v_add_u32 v3, v3, v2
    v_mul_u32_u24 v3, 3072, v3
    v_lshl_add_u32 v230, v4, 4, v3
    v_add_u32 v2, 64, v1
    v_mul_u32_u24 v3, 171, v2
    v_lshrrev_b32 v3, 11, v3
    v_mul_u32_u24 v4, 12, v3
    v_sub_u32 v4, v2, v4
    v_and_b32 v2, 12, v3
    v_add_u32 v3, v3, v2
    v_mul_u32_u24 v3, 3072, v3
    v_lshl_add_u32 v231, v4, 4, v3
    v_subrev_u32 v231, 1024, v231
    v_add_u32 v2, 128, v1
    v_mul_u32_u24 v3, 171, v2
    v_lshrrev_b32 v3, 11, v3
    v_mul_u32_u24 v4, 12, v3
    v_sub_u32 v4, v2, v4
    v_and_b32 v2, 12, v3
    v_add_u32 v3, v3, v2
    v_mul_u32_u24 v3, 3072, v3
    v_lshl_add_u32 v232, v4, 4, v3
    v_subrev_u32 v232, 2048, v232
    s_mul_i32 s50, s3, 48
    v_lshrrev_b32 v2, 5, v1
    v_bfe_u32 v3, v1, 2, 2
    v_lshl_add_u32 v2, v2, 2, v3
    v_mul_u32_u24 v2, 192, v2
    v_bfe_u32 v3, v1, 4, 1
    v_mul_u32_u24 v3, 3104, v3
    v_add3_u32 v2, v2, v3, s50
    v_and_b32 v3, 3, v1
    v_lshl_add_u32 v233, v3, 3, v2
    v_and_b32 v3, 1, v1
    v_lshl_add_u32 v2, v3, 3, v2
    v_bfe_u32 v3, v1, 1, 1
    v_mul_u32_u24 v3, 6224, v3
    v_add3_u32 v234, v2, v3, 32
    v_add_u32 v233, 8192, v233
    v_add_u32 v234, 8192, v234
    v_add_u32 v238, 49664, v233
    v_add_u32 v239, 49664, v234
    s_cmp_eq_u32 s76, 1
    s_cbranch_scc1 L_bias
    s_add_u32 m0, s61, 8192
    s_nop 0
    buffer_load_dwordx4 v230, s[40:43], s64 offen offset:0 lds
    buffer_load_dwordx4 v231, s[40:43], s64 offen offset:1024 lds
    buffer_load_dwordx4 v232, s[40:43], s64 offen offset:2048 lds
    s_add_u32 s64, s64, 98304
    s_sub_u32 s35, s64, 1966080
    s_min_u32 s64, s64, s35
    s_add_u32 m0, s61, 20608
    s_nop 0
    buffer_load_dwordx4 v230, s[40:43], s64 offen offset:0 lds
    buffer_load_dwordx4 v231, s[40:43], s64 offen offset:1024 lds
    buffer_load_dwordx4 v232, s[40:43], s64 offen offset:2048 lds
    s_add_u32 s64, s64, 98304
    s_sub_u32 s35, s64, 1966080
    s_min_u32 s64, s64, s35
    s_add_u32 m0, s61, 33024
    s_nop 0
    buffer_load_dwordx4 v230, s[40:43], s64 offen offset:0 lds
    buffer_load_dwordx4 v231, s[40:43], s64 offen offset:1024 lds
    buffer_load_dwordx4 v232, s[40:43], s64 offen offset:2048 lds
    s_add_u32 s64, s64, 98304
    s_sub_u32 s35, s64, 1966080
    s_min_u32 s64, s64, s35
    s_add_u32 m0, s61, 45440
    s_nop 0
    buffer_load_dwordx4 v230, s[40:43], s64 offen offset:0 lds
    buffer_load_dwordx4 v231, s[40:43], s64 offen offset:1024 lds
    buffer_load_dwordx4 v232, s[40:43], s64 offen offset:2048 lds
    s_add_u32 s64, s64, 98304
    s_sub_u32 s35, s64, 1966080
    s_min_u32 s64, s64, s35
    s_add_u32 m0, s61, 57856
    s_nop 0
    buffer_load_dwordx4 v230, s[40:43], s64 offen offset:0 lds
    buffer_load_dwordx4 v231, s[40:43], s64 offen offset:1024 lds
    buffer_load_dwordx4 v232, s[40:43], s64 offen offset:2048 lds
    s_add_u32 s64, s64, 98304
    s_sub_u32 s35, s64, 1966080
    s_min_u32 s64, s64, s35
    s_add_u32 m0, s61, 70272
    s_nop 0
    buffer_load_dwordx4 v230, s[40:43], s64 offen offset:0 lds
    buffer_load_dwordx4 v231, s[40:43], s64 offen offset:1024 lds
    buffer_load_dwordx4 v232, s[40:43], s64 offen offset:2048 lds
    s_add_u32 s64, s64, 98304
    s_sub_u32 s35, s64, 1966080
    s_min_u32 s64, s64, s35
    s_movk_i32 s4, 4096
    s_movk_i32 s5, 8192
    s_lshl_b32 s6, s72, 10
    s_add_u32 s6, s6, 23101440
    s_lshl_b32 s7, s73, 6
    s_add_u32 s7, s7, s6
    s_mul_i32 s8, s72, 768
    s_mul_i32 s50, s73, 12
    s_add_u32 s8, s8, s50
    s_mul_i32 s50, s3, 3
    s_add_u32 s8, s8, s50
    s_lshl_b32 s8, s8, 8
    s_add_u32 s8, s8, 16777216
    s_lshl_b32 s9, s73, 2
    s_add_u32 s9, s9, s3
    s_mul_i32 s9, s9, 384
    s_add_u32 s9, s9, 23527424
    s_mul_i32 s62, s3, 32768
    s_lshl_b32 s50, s72, 7
    s_add_u32 s62, s62, s50
    s_mul_i32 s50, s34, 131072
    s_add_u32 s10, s62, s50
    s_lshl_b32 s63, s3, 10
    s_add_u32 s11, s10, 131072
    s_sub_u32 s35, s11, 2621440
    s_min_u32 s11, s11, s35
    s_add_u32 s12, s11, 131072
    s_sub_u32 s35, s12, 2621440
    s_min_u32 s12, s12, s35
    s_add_u32 s13, s12, 131072
    s_sub_u32 s35, s13, 2621440
    s_min_u32 s13, s13, s35
    s_add_u32 s14, s13, 131072
    s_sub_u32 s35, s14, 2621440
    s_min_u32 s14, s14, s35
    s_add_u32 s15, s14, 131072
    s_sub_u32 s35, s15, 2621440
    s_min_u32 s15, s15, s35
    s_add_u32 s18, s15, 131072
    s_sub_u32 s35, s18, 2621440
    s_min_u32 s18, s18, s35
    s_add_u32 s19, s18, 131072
    s_sub_u32 s35, s19, 2621440
    s_min_u32 s19, s19, s35
    s_add_u32 s20, s19, 131072
    s_sub_u32 s35, s20, 2621440
    s_min_u32 s20, s20, s35
    s_add_u32 s21, s20, 131072
    s_sub_u32 s35, s21, 2621440
    s_min_u32 s21, s21, s35
    s_add_u32 s22, s21, 131072
    s_sub_u32 s35, s22, 2621440
    s_min_u32 s22, s22, s35
    s_add_u32 s23, s22, 131072
    s_sub_u32 s35, s23, 2621440
    s_min_u32 s23, s23, s35
    s_add_u32 s24, s23, 131072
    s_sub_u32 s35, s24, 2621440
    s_min_u32 s24, s24, s35
    s_add_u32 s25, s24, 131072
    s_sub_u32 s35, s25, 2621440
    s_min_u32 s25, s25, s35
    s_add_u32 s26, s25, 131072
    s_sub_u32 s35, s26, 2621440
    s_min_u32 s26, s26, s35
    s_add_u32 s27, s26, 131072
    s_sub_u32 s35, s27, 2621440
    s_min_u32 s27, s27, s35
    s_add_u32 s44, s27, 131072
    s_sub_u32 s35, s44, 2621440
    s_min_u32 s44, s44, s35
    s_add_u32 s45, s44, 131072
    s_sub_u32 s35, s45, 2621440
    s_min_u32 s45, s45, s35
    s_add_u32 s46, s45, 131072
    s_sub_u32 s35, s46, 2621440
    s_min_u32 s46, s46, s35
    s_add_u32 s47, s46, 131072
    s_sub_u32 s35, s47, 2621440
    s_min_u32 s47, s47, s35
    v_lshrrev_b32 v2, 3, v1
    v_bfe_u32 v3, v1, 4, 2
    v_lshlrev_b32 v3, 1, v3
    v_xor_b32 v3, v3, v1
    v_and_b32 v3, 7, v3
    v_mul_u32_u24 v2, 4096, v2
    v_lshl_add_u32 v172, v3, 4, v2
    v_add_u32 v172, 0, v172
    v_lshrrev_b32 v2, 2, v1
    v_lshlrev_b32 v2, 7, v2
    v_and_b32 v3, 3, v1
    v_lshl_add_u32 v2, v3, 3, v2
    v_bfe_u32 v3, v1, 3, 2
    v_xor_b32 v168, 0, v3
    v_lshl_add_u32 v168, v168, 5, v2
    v_xor_b32 v169, 1, v3
    v_lshl_add_u32 v169, v169, 5, v2
    v_xor_b32 v170, 2, v3
    v_lshl_add_u32 v170, v170, 5, v2
    v_xor_b32 v171, 3, v3
    v_lshl_add_u32 v171, v171, 5, v2
    v_and_b32 v175, 15, v1
    v_lshlrev_b32 v175, 4, v175
    v_bfe_u32 v2, v1, 4, 1
    v_lshrrev_b32 v3, 5, v1
    v_mul_u32_u24 v173, 49152, v2
    v_lshl_add_u32 v173, v3, 8, v173
    v_add_u32 v173, v173, v175
    v_lshl_add_u32 v2, v2, 1, v3
    v_mul_u32_u24 v174, 49152, v2
    v_add_u32 v174, v174, v175
    v_bfe_u32 v2, v0, 1, 2
    v_lshlrev_b32 v2, 1, v2
    s_lshr_b32 s50, s73, 1
    v_xor_b32 v2, s50, v2
    v_lshlrev_b32 v2, 4, v2
    v_lshl_add_u32 v216, v0, 7, v2
    s_and_b32 s50, s73, 1
    s_lshl_b32 s50, s50, 3
    v_add_u32 v216, s50, v216
    v_add_u32 v217, 0x8000, v216
    v_add_u32 v218, 0x10000, v216
    v_cmp_gt_u32 vcc, 128, v0
    s_nop 1
    v_cndmask_b32 v218, v217, v218, vcc
    s_lshl_b32 s50, s3, 10
    v_add_u32 v175, s50, v175
    v_lshrrev_b32 v2, 1, v1
    v_lshlrev_b32 v2, 10, v2
    v_and_b32 v3, 1, v1
    v_lshl_add_u32 v219, v3, 7, v2
    s_lshl_b32 s50, s3, 8
    s_add_u32 s50, s50, 46080
    v_add_u32 v219, s50, v219
    s_add_u32 s50, s50, 19456
    v_mov_b32 v2, s50
    v_cmp_lt_u32 vcc, 39, v1
    s_nop 1
    v_cndmask_b32 v219, v219, v2, vcc
    s_mov_b32 s17, 23199744
    s_lshl_b32 s62, s75, 2
    s_add_u32 s62, s62, s3
    s_mul_i32 s62, s62, 61440
    s_add_u32 s62, s62, 14417920
    s_waitcnt vmcnt(12)
    s_barrier
    s_cmp_eq_u32 s3, 0
    s_cbranch_scc0 L_wf16
    s_lshl_b32 s54, s77, 7
    s_add_u32 s54, s54, 23220224
    v_mov_b32 v2, 0
    v_mov_b32 v3, s48
    s_mov_b64 exec, 1
    buffer_store_dword v3, v2, s[36:39], s54 offen sc1
    s_mov_b64 exec, -1
L_wf16:
    s_cmp_eq_u32 s3, 0
    s_cbranch_scc0 L_wf17
    s_lshl_b32 s54, s71, 7
    s_add_u32 s54, s54, 23354368
    v_mov_b32 v2, 0
    v_mov_b32 v3, s48
    s_mov_b64 exec, 1
    buffer_store_dword v3, v2, s[36:39], s54 offen sc1
    s_mov_b64 exec, -1
L_wf17:
    ds_read_b64_tr_b16 a[0:1], v233 offset:0
    ds_read_b64_tr_b16 a[2:3], v233 offset:1536
    ds_read_b64_tr_b16 a[4:5], v233 offset:6224
    ds_read_b64_tr_b16 a[6:7], v233 offset:7760
    ds_read_b64_tr_b16 a[8:9], v234 offset:0
    ds_read_b64_tr_b16 a[10:11], v234 offset:1536
    ds_read_b64_tr_b16 a[12:13], v233 offset:12416
    ds_read_b64_tr_b16 a[14:15], v233 offset:13952
    ds_read_b64_tr_b16 a[16:17], v233 offset:18640
    ds_read_b64_tr_b16 a[18:19], v233 offset:20176
    ds_read_b64_tr_b16 a[20:21], v234 offset:12416
    ds_read_b64_tr_b16 a[22:23], v234 offset:13952
    s_add_u32 m0, s61, 82688
    s_nop 0
    buffer_load_dwordx4 v230, s[40:43], s64 offen offset:0 lds
    buffer_load_dwordx4 v231, s[40:43], s64 offen offset:1024 lds
    buffer_load_dwordx4 v232, s[40:43], s64 offen offset:2048 lds
    s_add_u32 s64, s64, 98304
    s_sub_u32 s35, s64, 1966080
    s_min_u32 s64, s64, s35
    s_add_u32 m0, s61, 95104
    s_nop 0
    buffer_load_dwordx4 v230, s[40:43], s64 offen offset:0 lds
    buffer_load_dwordx4 v231, s[40:43], s64 offen offset:1024 lds
    buffer_load_dwordx4 v232, s[40:43], s64 offen offset:2048 lds
    s_add_u32 s64, s64, 98304
    s_sub_u32 s35, s64, 1966080
    s_min_u32 s64, s64, s35
    s_waitcnt vmcnt(12)
    s_waitcnt lgkmcnt(0)
    s_barrier
    ds_read_b64_tr_b16 a[24:25], v233 offset:24832
    ds_read_b64_tr_b16 a[26:27], v233 offset:26368
    ds_read_b64_tr_b16 a[28:29], v233 offset:31056
    ds_read_b64_tr_b16 a[30:31], v233 offset:32592
    ds_read_b64_tr_b16 a[32:33], v234 offset:24832
    ds_read_b64_tr_b16 a[34:35], v234 offset:26368
    ds_read_b64_tr_b16 a[36:37], v233 offset:37248
    ds_read_b64_tr_b16 a[38:39], v233 offset:38784
    ds_read_b64_tr_b16 a[40:41], v233 offset:43472
    ds_read_b64_tr_b16 a[42:43], v233 offset:45008
    ds_read_b64_tr_b16 a[44:45], v234 offset:37248
    ds_read_b64_tr_b16 a[46:47], v234 offset:38784
    s_add_u32 m0, s61, 8192
    s_nop 0
    buffer_load_dwordx4 v230, s[40:43], s64 offen offset:0 lds
    buffer_load_dwordx4 v231, s[40:43], s64 offen offset:1024 lds
    buffer_load_dwordx4 v232, s[40:43], s64 offen offset:2048 lds
    s_add_u32 s64, s64, 98304
    s_sub_u32 s35, s64, 1966080
    s_min_u32 s64, s64, s35
    s_add_u32 m0, s61, 20608
    s_nop 0
    buffer_load_dwordx4 v230, s[40:43], s64 offen offset:0 lds
    buffer_load_dwordx4 v231, s[40:43], s64 offen offset:1024 lds
    buffer_load_dwordx4 v232, s[40:43], s64 offen offset:2048 lds
    s_add_u32 s64, s64, 98304
    s_sub_u32 s35, s64, 1966080
    s_min_u32 s64, s64, s35
    s_waitcnt vmcnt(12)
    s_waitcnt lgkmcnt(0)
    s_barrier
    ds_read_b64_tr_b16 a[48:49], v238 offset:0
    ds_read_b64_tr_b16 a[50:51], v238 offset:1536
    ds_read_b64_tr_b16 a[52:53], v238 offset:6224
    ds_read_b64_tr_b16 a[54:55], v238 offset:7760
    ds_read_b64_tr_b16 a[56:57], v239 offset:0
    ds_read_b64_tr_b16 a[58:59], v239 offset:1536
    ds_read_b64_tr_b16 a[60:61], v238 offset:12416
    ds_read_b64_tr_b16 a[62:63], v238 offset:13952
    ds_read_b64_tr_b16 a[64:65], v238 offset:18640
    ds_read_b64_tr_b16 a[66:67], v238 offset:20176
    ds_read_b64_tr_b16 a[68:69], v239 offset:12416
    ds_read_b64_tr_b16 a[70:71], v239 offset:13952
    s_add_u32 m0, s61, 33024
    s_nop 0
    buffer_load_dwordx4 v230, s[40:43], s64 offen offset:0 lds
    buffer_load_dwordx4 v231, s[40:43], s64 offen offset:1024 lds
    buffer_load_dwordx4 v232, s[40:43], s64 offen offset:2048 lds
    s_add_u32 s64, s64, 98304
    s_sub_u32 s35, s64, 1966080
    s_min_u32 s64, s64, s35
    s_add_u32 m0, s61, 45440
    s_nop 0
    buffer_load_dwordx4 v230, s[40:43], s64 offen offset:0 lds
    buffer_load_dwordx4 v231, s[40:43], s64 offen offset:1024 lds
    buffer_load_dwordx4 v232, s[40:43], s64 offen offset:2048 lds
    s_add_u32 s64, s64, 98304
    s_sub_u32 s35, s64, 1966080
    s_min_u32 s64, s64, s35
    s_waitcnt vmcnt(12)
    s_waitcnt lgkmcnt(0)
    s_barrier
    ds_read_b64_tr_b16 a[72:73], v238 offset:24832
    ds_read_b64_tr_b16 a[74:75], v238 offset:26368
    ds_read_b64_tr_b16 a[76:77], v238 offset:31056
    ds_read_b64_tr_b16 a[78:79], v238 offset:32592
    ds_read_b64_tr_b16 a[80:81], v239 offset:24832
    ds_read_b64_tr_b16 a[82:83], v239 offset:26368
    ds_read_b64_tr_b16 a[84:85], v238 offset:37248
    ds_read_b64_tr_b16 a[86:87], v238 offset:38784
    ds_read_b64_tr_b16 a[88:89], v238 offset:43472
    ds_read_b64_tr_b16 a[90:91], v238 offset:45008
    ds_read_b64_tr_b16 a[92:93], v239 offset:37248
    ds_read_b64_tr_b16 a[94:95], v239 offset:38784
    s_add_u32 m0, s61, 57856
    s_nop 0
    buffer_load_dwordx4 v230, s[40:43], s64 offen offset:0 lds
    buffer_load_dwordx4 v231, s[40:43], s64 offen offset:1024 lds
    buffer_load_dwordx4 v232, s[40:43], s64 offen offset:2048 lds
    s_add_u32 s64, s64, 98304
    s_sub_u32 s35, s64, 1966080
    s_min_u32 s64, s64, s35
    s_add_u32 m0, s61, 70272
    s_nop 0
    buffer_load_dwordx4 v230, s[40:43], s64 offen offset:0 lds
    buffer_load_dwordx4 v231, s[40:43], s64 offen offset:1024 lds
    buffer_load_dwordx4 v232, s[40:43], s64 offen offset:2048 lds
    s_add_u32 s64, s64, 98304
    s_sub_u32 s35, s64, 1966080
    s_min_u32 s64, s64, s35
    s_waitcnt vmcnt(12)
    s_waitcnt lgkmcnt(0)
    s_barrier
    ds_read_b64_tr_b16 a[96:97], v233 offset:0
    ds_read_b64_tr_b16 a[98:99], v233 offset:1536
    ds_read_b64_tr_b16 a[100:101], v233 offset:6224
    ds_read_b64_tr_b16 a[102:103], v233 offset:7760
    ds_read_b64_tr_b16 a[104:105], v234 offset:0
    ds_read_b64_tr_b16 a[106:107], v234 offset:1536
    ds_read_b64_tr_b16 a[108:109], v233 offset:12416
    ds_read_b64_tr_b16 a[110:111], v233 offset:13952
    ds_read_b64_tr_b16 a[112:113], v233 offset:18640
    ds_read_b64_tr_b16 a[114:115], v233 offset:20176
    ds_read_b64_tr_b16 a[116:117], v234 offset:12416
    ds_read_b64_tr_b16 a[118:119], v234 offset:13952
    s_add_u32 m0, s61, 82688
    s_nop 0
    buffer_load_dwordx4 v230, s[40:43], s64 offen offset:0 lds
    buffer_load_dwordx4 v231, s[40:43], s64 offen offset:1024 lds
    buffer_load_dwordx4 v232, s[40:43], s64 offen offset:2048 lds
    s_add_u32 s64, s64, 98304
    s_sub_u32 s35, s64, 1966080
    s_min_u32 s64, s64, s35
    s_lshr_b32 s52, s71, 1
    s_lshl_b32 s52, s52, 2
    s_add_u32 s52, s52, s3
    s_mul_i32 s52, s52, 10240
    s_and_b32 s53, s71, 1
    s_mul_i32 s53, s53, 640
    s_add_u32 s52, s52, s53
    s_mul_i32 s53, s3, 5120
    v_add_u32 v5, 0, v1
    v_mul_u32_u24 v6, 205, v5
    v_lshrrev_b32 v6, 13, v6
    v_mul_u32_u24 v6, 640, v6
    v_lshl_add_u32 v5, v5, 4, v6
    s_add_u32 m0, s53, 107520
    s_nop 0
    buffer_load_dwordx4 v5, s[56:59], s52 offen nt lds
    v_add_u32 v5, 64, v1
    v_mul_u32_u24 v6, 205, v5
    v_lshrrev_b32 v6, 13, v6
    v_mul_u32_u24 v6, 640, v6
    v_lshl_add_u32 v5, v5, 4, v6
    s_add_u32 m0, s53, 108544
    s_nop 0
    buffer_load_dwordx4 v5, s[56:59], s52 offen nt lds
    v_add_u32 v5, 128, v1
    v_mul_u32_u24 v6, 205, v5
    v_lshrrev_b32 v6, 13, v6
    v_mul_u32_u24 v6, 640, v6
    v_lshl_add_u32 v5, v5, 4, v6
    s_add_u32 m0, s53, 109568
    s_nop 0
    buffer_load_dwordx4 v5, s[56:59], s52 offen nt lds
    v_add_u32 v5, 192, v1
    v_mul_u32_u24 v6, 205, v5
    v_lshrrev_b32 v6, 13, v6
    v_mul_u32_u24 v6, 640, v6
    v_lshl_add_u32 v5, v5, 4, v6
    s_add_u32 m0, s53, 110592
    s_nop 0
    buffer_load_dwordx4 v5, s[56:59], s52 offen nt lds
    v_add_u32 v5, 256, v1
    v_mul_u32_u24 v6, 205, v5
    v_lshrrev_b32 v6, 13, v6
    v_mul_u32_u24 v6, 640, v6
    v_lshl_add_u32 v5, v5, 4, v6
    s_add_u32 m0, s53, 111616
    s_nop 0
    buffer_load_dwordx4 v5, s[56:59], s52 offen nt lds
    s_waitcnt vmcnt(14)
    s_waitcnt lgkmcnt(0)
    s_barrier
    ds_read_b64_tr_b16 a[120:121], v233 offset:24832
    ds_read_b64_tr_b16 a[122:123], v233 offset:26368
    ds_read_b64_tr_b16 a[124:125], v233 offset:31056
    ds_read_b64_tr_b16 a[126:127], v233 offset:32592
    ds_read_b64_tr_b16 a[128:129], v234 offset:24832
    ds_read_b64_tr_b16 a[130:131], v234 offset:26368
    ds_read_b64_tr_b16 a[132:133], v233 offset:37248
    ds_read_b64_tr_b16 a[134:135], v233 offset:38784
    ds_read_b64_tr_b16 a[136:137], v233 offset:43472
    ds_read_b64_tr_b16 a[138:139], v233 offset:45008
    ds_read_b64_tr_b16 a[140:141], v234 offset:37248
    ds_read_b64_tr_b16 a[142:143], v234 offset:38784
    s_waitcnt vmcnt(8)
    s_waitcnt lgkmcnt(0)
    s_barrier
    ds_read_b64_tr_b16 a[144:145], v238 offset:0
    ds_read_b64_tr_b16 a[146:147], v238 offset:1536
    ds_read_b64_tr_b16 a[148:149], v238 offset:6224
    ds_read_b64_tr_b16 a[150:151], v238 offset:7760
    ds_read_b64_tr_b16 a[152:153], v239 offset:0
    ds_read_b64_tr_b16 a[154:155], v239 offset:1536
    ds_read_b64_tr_b16 a[156:157], v238 offset:12416
    ds_read_b64_tr_b16 a[158:159], v238 offset:13952
    ds_read_b64_tr_b16 a[160:161], v238 offset:18640
    ds_read_b64_tr_b16 a[162:163], v238 offset:20176
    ds_read_b64_tr_b16 a[164:165], v239 offset:12416
    ds_read_b64_tr_b16 a[166:167], v239 offset:13952
    s_waitcnt vmcnt(5)
    s_waitcnt lgkmcnt(0)
    s_barrier
    ds_read_b64_tr_b16 a[168:169], v238 offset:24832
    ds_read_b64_tr_b16 a[170:171], v238 offset:26368
    ds_read_b64_tr_b16 a[172:173], v238 offset:31056
    ds_read_b64_tr_b16 a[174:175], v238 offset:32592
    ds_read_b64_tr_b16 a[176:177], v239 offset:24832
    ds_read_b64_tr_b16 a[178:179], v239 offset:26368
    s_waitcnt vmcnt(0)
    s_waitcnt lgkmcnt(0)
    s_barrier
    v_lshrrev_b32 v2, 4, v1
    v_bfe_u32 v3, v1, 2, 2
    v_lshl_add_u32 v3, v2, 3, v3
    v_mul_u32_u24 v3, 640, v3
    v_and_b32 v2, 3, v1
    v_lshl_add_u32 v2, v2, 3, v3
    s_mul_i32 s50, s3, 160
    s_add_u32 s50, s50, 107520
    v_add_u32 v2, s50, v2
    s_lshr_b32 s53, s71, 1
    s_mov_b32 s50, 0x15555556
    s_mul_hi_u32 s51, s53, s50
    s_mul_i32 s52, s51, 12
    s_sub_u32 s52, s53, s52
    s_and_b32 s50, s71, 1
    s_lshl_b32 s50, s50, 2
    s_add_u32 s50, s50, s3
    s_lshl_b32 s50, s50, 2
    s_add_u32 s50, s50, s51
    s_mul_i32 s50, s50, 60
    s_mul_i32 s52, s52, 5
    s_add_u32 s50, s50, s52
    s_lshl_b32 s50, s50, 10
    s_add_u32 s50, s50, 14417920
    s_add_u32 s51, s50, 4096
    ds_read_b64_tr_b16 v[16:17], v2 offset:0
    ds_read_b64_tr_b16 v[18:19], v2 offset:2560
    ds_read_b64_tr_b16 v[20:21], v2 offset:32
    ds_read_b64_tr_b16 v[22:23], v2 offset:2592
    ds_read_b64_tr_b16 v[24:25], v2 offset:64
    ds_read_b64_tr_b16 v[26:27], v2 offset:2624
    ds_read_b64_tr_b16 v[28:29], v2 offset:96
    ds_read_b64_tr_b16 v[30:31], v2 offset:2656
    ds_read_b64_tr_b16 v[32:33], v2 offset:128
    ds_read_b64_tr_b16 v[34:35], v2 offset:2688
    s_waitcnt lgkmcnt(8)
    buffer_store_dwordx4 v[16:19], v248, s[36:39], s50 offen offset:0 sc1
    s_waitcnt lgkmcnt(6)
    buffer_store_dwordx4 v[20:23], v248, s[36:39], s50 offen offset:1024 sc1
    s_waitcnt lgkmcnt(4)
    buffer_store_dwordx4 v[24:27], v248, s[36:39], s50 offen offset:2048 sc1
    s_waitcnt lgkmcnt(2)
    buffer_store_dwordx4 v[28:31], v248, s[36:39], s50 offen offset:3072 sc1
    s_waitcnt lgkmcnt(0)
    buffer_store_dwordx4 v[32:35], v248, s[36:39], s51 offen offset:0 sc1
    s_branch L_nobias
L_bias:
    s_add_u32 m0, s61, 8192
    s_nop 0
    buffer_load_dwordx4 v230, s[40:43], s64 offen offset:0 lds
    buffer_load_dwordx4 v231, s[40:43], s64 offen offset:1024 lds
    buffer_load_dwordx4 v232, s[40:43], s64 offen offset:2048 lds
    s_add_u32 s64, s64, 98304
    s_sub_u32 s35, s64, 1966080
    s_min_u32 s64, s64, s35
    s_add_u32 m0, s61, 20608
    s_nop 0
    buffer_load_dwordx4 v230, s[40:43], s64 offen offset:0 lds
    buffer_load_dwordx4 v231, s[40:43], s64 offen offset:1024 lds
    buffer_load_dwordx4 v232, s[40:43], s64 offen offset:2048 lds
    s_add_u32 s64, s64, 98304
    s_sub_u32 s35, s64, 1966080
    s_min_u32 s64, s64, s35
    s_add_u32 m0, s61, 33024
    s_nop 0
    buffer_load_dwordx4 v230, s[40:43], s64 offen offset:0 lds
    buffer_load_dwordx4 v231, s[40:43], s64 offen offset:1024 lds
    buffer_load_dwordx4 v232, s[40:43], s64 offen offset:2048 lds
    s_add_u32 s64, s64, 98304
    s_sub_u32 s35, s64, 1966080
    s_min_u32 s64, s64, s35
    s_add_u32 m0, s61, 45440
    s_nop 0
    buffer_load_dwordx4 v230, s[40:43], s64 offen offset:0 lds
    buffer_load_dwordx4 v231, s[40:43], s64 offen offset:1024 lds
    buffer_load_dwordx4 v232, s[40:43], s64 offen offset:2048 lds
    s_add_u32 s64, s64, 98304
    s_sub_u32 s35, s64, 1966080
    s_min_u32 s64, s64, s35
    s_add_u32 m0, s61, 57856
    s_nop 0
    buffer_load_dwordx4 v230, s[40:43], s64 offen offset:0 lds
    buffer_load_dwordx4 v231, s[40:43], s64 offen offset:1024 lds
    buffer_load_dwordx4 v232, s[40:43], s64 offen offset:2048 lds
    s_add_u32 s64, s64, 98304
    s_sub_u32 s35, s64, 1966080
    s_min_u32 s64, s64, s35
    s_add_u32 m0, s61, 70272
    s_nop 0
    buffer_load_dwordx4 v230, s[40:43], s64 offen offset:0 lds
    buffer_load_dwordx4 v231, s[40:43], s64 offen offset:1024 lds
    buffer_load_dwordx4 v232, s[40:43], s64 offen offset:2048 lds
    s_add_u32 s64, s64, 98304
    s_sub_u32 s35, s64, 1966080
    s_min_u32 s64, s64, s35
    s_movk_i32 s4, 4096
    s_movk_i32 s5, 8192
    s_lshl_b32 s6, s72, 10
    s_add_u32 s6, s6, 23101440
    s_lshl_b32 s7, s73, 6
    s_add_u32 s7, s7, s6
    s_mul_i32 s8, s72, 768
    s_mul_i32 s50, s73, 12
    s_add_u32 s8, s8, s50
    s_mul_i32 s50, s3, 3
    s_add_u32 s8, s8, s50
    s_lshl_b32 s8, s8, 8
    s_add_u32 s8, s8, 16777216
    s_lshl_b32 s9, s73, 2
    s_add_u32 s9, s9, s3
    s_mul_i32 s9, s9, 384
    s_add_u32 s9, s9, 23527424
    s_mul_i32 s62, s3, 32768
    s_lshl_b32 s50, s72, 7
    s_add_u32 s62, s62, s50
    s_mul_i32 s50, s34, 131072
    s_add_u32 s10, s62, s50
    s_lshl_b32 s63, s3, 10
    s_add_u32 s11, s10, 131072
    s_sub_u32 s35, s11, 2621440
    s_min_u32 s11, s11, s35
    s_add_u32 s12, s11, 131072
    s_sub_u32 s35, s12, 2621440
    s_min_u32 s12, s12, s35
    s_add_u32 s13, s12, 131072
    s_sub_u32 s35, s13, 2621440
    s_min_u32 s13, s13, s35
    s_add_u32 s14, s13, 131072
    s_sub_u32 s35, s14, 2621440
    s_min_u32 s14, s14, s35
    s_add_u32 s15, s14, 131072
    s_sub_u32 s35, s15, 2621440
    s_min_u32 s15, s15, s35
    s_add_u32 s18, s15, 131072
    s_sub_u32 s35, s18, 2621440
    s_min_u32 s18, s18, s35
    s_add_u32 s19, s18, 131072
    s_sub_u32 s35, s19, 2621440
    s_min_u32 s19, s19, s35
    s_add_u32 s20, s19, 131072
    s_sub_u32 s35, s20, 2621440
    s_min_u32 s20, s20, s35
    s_add_u32 s21, s20, 131072
    s_sub_u32 s35, s21, 2621440
    s_min_u32 s21, s21, s35
    s_add_u32 s22, s21, 131072
    s_sub_u32 s35, s22, 2621440
    s_min_u32 s22, s22, s35
    s_add_u32 s23, s22, 131072
    s_sub_u32 s35, s23, 2621440
    s_min_u32 s23, s23, s35
    s_add_u32 s24, s23, 131072
    s_sub_u32 s35, s24, 2621440
    s_min_u32 s24, s24, s35
    s_add_u32 s25, s24, 131072
    s_sub_u32 s35, s25, 2621440
    s_min_u32 s25, s25, s35
    s_add_u32 s26, s25, 131072
    s_sub_u32 s35, s26, 2621440
    s_min_u32 s26, s26, s35
    s_add_u32 s27, s26, 131072
    s_sub_u32 s35, s27, 2621440
    s_min_u32 s27, s27, s35
    s_add_u32 s44, s27, 131072
    s_sub_u32 s35, s44, 2621440
    s_min_u32 s44, s44, s35
    s_add_u32 s45, s44, 131072
    s_sub_u32 s35, s45, 2621440
    s_min_u32 s45, s45, s35
    s_add_u32 s46, s45, 131072
    s_sub_u32 s35, s46, 2621440
    s_min_u32 s46, s46, s35
    s_add_u32 s47, s46, 131072
    s_sub_u32 s35, s47, 2621440
    s_min_u32 s47, s47, s35
    v_lshrrev_b32 v2, 3, v1
    v_bfe_u32 v3, v1, 4, 2
    v_lshlrev_b32 v3, 1, v3
    v_xor_b32 v3, v3, v1
    v_and_b32 v3, 7, v3
    v_mul_u32_u24 v2, 4096, v2
    v_lshl_add_u32 v172, v3, 4, v2
    v_add_u32 v172, 0, v172
    v_lshrrev_b32 v2, 2, v1
    v_lshlrev_b32 v2, 7, v2
    v_and_b32 v3, 3, v1
    v_lshl_add_u32 v2, v3, 3, v2
    v_bfe_u32 v3, v1, 3, 2
    v_xor_b32 v168, 0, v3
    v_lshl_add_u32 v168, v168, 5, v2
    v_xor_b32 v169, 1, v3
    v_lshl_add_u32 v169, v169, 5, v2
    v_xor_b32 v170, 2, v3
    v_lshl_add_u32 v170, v170, 5, v2
    v_xor_b32 v171, 3, v3
    v_lshl_add_u32 v171, v171, 5, v2
    v_and_b32 v175, 15, v1
    v_lshlrev_b32 v175, 4, v175
    v_bfe_u32 v2, v1, 4, 1
    v_lshrrev_b32 v3, 5, v1
    v_mul_u32_u24 v173, 49152, v2
    v_lshl_add_u32 v173, v3, 8, v173
    v_add_u32 v173, v173, v175
    v_lshl_add_u32 v2, v2, 1, v3
    v_mul_u32_u24 v174, 49152, v2
    v_add_u32 v174, v174, v175
    v_bfe_u32 v2, v0, 1, 2
    v_lshlrev_b32 v2, 1, v2
    s_lshr_b32 s50, s73, 1
    v_xor_b32 v2, s50, v2
    v_lshlrev_b32 v2, 4, v2
    v_lshl_add_u32 v216, v0, 7, v2
    s_and_b32 s50, s73, 1
    s_lshl_b32 s50, s50, 3
    v_add_u32 v216, s50, v216
    v_add_u32 v217, 0x8000, v216
    v_add_u32 v218, 0x10000, v216
    v_cmp_gt_u32 vcc, 128, v0
    s_nop 1
    v_cndmask_b32 v218, v217, v218, vcc
    s_lshl_b32 s50, s3, 10
    v_add_u32 v175, s50, v175
    v_lshrrev_b32 v2, 1, v1
    v_lshlrev_b32 v2, 10, v2
    v_and_b32 v3, 1, v1
    v_lshl_add_u32 v219, v3, 7, v2
    s_lshl_b32 s50, s3, 8
    s_add_u32 s50, s50, 46080
    v_add_u32 v219, s50, v219
    s_add_u32 s50, s50, 19456
    v_mov_b32 v2, s50
    v_cmp_lt_u32 vcc, 39, v1
    s_nop 1
    v_cndmask_b32 v219, v219, v2, vcc
    s_mov_b32 s17, 23199744
    s_lshl_b32 s62, s75, 2
    s_add_u32 s62, s62, s3
    s_mul_i32 s62, s62, 61440
    s_add_u32 s62, s62, 14417920
    s_waitcnt vmcnt(12)
    s_barrier
    s_cmp_eq_u32 s3, 0
    s_cbranch_scc0 L_wf18
    s_lshl_b32 s54, s77, 7
    s_add_u32 s54, s54, 23220224
    v_mov_b32 v2, 0
    v_mov_b32 v3, s48
    s_mov_b64 exec, 1
    buffer_store_dword v3, v2, s[36:39], s54 offen sc1
    s_mov_b64 exec, -1
L_wf18:
    s_cmp_eq_u32 s3, 0
    s_cbranch_scc0 L_wf19
    s_lshl_b32 s54, s71, 7
    s_add_u32 s54, s54, 23354368
    v_mov_b32 v2, 0
    v_mov_b32 v3, s48
    s_mov_b64 exec, 1
    buffer_store_dword v3, v2, s[36:39], s54 offen sc1
    s_mov_b64 exec, -1
L_wf19:
    ds_read_b64_tr_b16 a[0:1], v233 offset:0
    ds_read_b64_tr_b16 a[2:3], v233 offset:1536
    ds_read_b64_tr_b16 a[4:5], v233 offset:6224
    ds_read_b64_tr_b16 a[6:7], v233 offset:7760
    ds_read_b64_tr_b16 a[8:9], v234 offset:0
    ds_read_b64_tr_b16 a[10:11], v234 offset:1536
    ds_read_b64_tr_b16 a[12:13], v233 offset:12416
    ds_read_b64_tr_b16 a[14:15], v233 offset:13952
    ds_read_b64_tr_b16 a[16:17], v233 offset:18640
    ds_read_b64_tr_b16 a[18:19], v233 offset:20176
    ds_read_b64_tr_b16 a[20:21], v234 offset:12416
    ds_read_b64_tr_b16 a[22:23], v234 offset:13952
    s_add_u32 m0, s61, 82688
    s_nop 0
    buffer_load_dwordx4 v230, s[40:43], s64 offen offset:0 lds
    buffer_load_dwordx4 v231, s[40:43], s64 offen offset:1024 lds
    buffer_load_dwordx4 v232, s[40:43], s64 offen offset:2048 lds
    s_add_u32 s64, s64, 98304
    s_sub_u32 s35, s64, 1966080
    s_min_u32 s64, s64, s35
    s_add_u32 m0, s61, 95104
    s_nop 0
    buffer_load_dwordx4 v230, s[40:43], s64 offen offset:0 lds
    buffer_load_dwordx4 v231, s[40:43], s64 offen offset:1024 lds
    buffer_load_dwordx4 v232, s[40:43], s64 offen offset:2048 lds
    s_add_u32 s64, s64, 98304
    s_sub_u32 s35, s64, 1966080
    s_min_u32 s64, s64, s35
    s_waitcnt vmcnt(12)
    s_waitcnt lgkmcnt(0)
    s_barrier
    ds_read_b64_tr_b16 a[24:25], v233 offset:24832
    ds_read_b64_tr_b16 a[26:27], v233 offset:26368
    ds_read_b64_tr_b16 a[28:29], v233 offset:31056
    ds_read_b64_tr_b16 a[30:31], v233 offset:32592
    ds_read_b64_tr_b16 a[32:33], v234 offset:24832
    ds_read_b64_tr_b16 a[34:35], v234 offset:26368
    ds_read_b64_tr_b16 a[36:37], v233 offset:37248
    ds_read_b64_tr_b16 a[38:39], v233 offset:38784
    ds_read_b64_tr_b16 a[40:41], v233 offset:43472
    ds_read_b64_tr_b16 a[42:43], v233 offset:45008
    ds_read_b64_tr_b16 a[44:45], v234 offset:37248
    ds_read_b64_tr_b16 a[46:47], v234 offset:38784
    s_add_u32 m0, s61, 8192
    s_nop 0
    buffer_load_dwordx4 v230, s[40:43], s64 offen offset:0 lds
    buffer_load_dwordx4 v231, s[40:43], s64 offen offset:1024 lds
    buffer_load_dwordx4 v232, s[40:43], s64 offen offset:2048 lds
    s_add_u32 s64, s64, 98304
    s_sub_u32 s35, s64, 1966080
    s_min_u32 s64, s64, s35
    s_add_u32 m0, s61, 20608
    s_nop 0
    buffer_load_dwordx4 v230, s[40:43], s64 offen offset:0 lds
    buffer_load_dwordx4 v231, s[40:43], s64 offen offset:1024 lds
    buffer_load_dwordx4 v232, s[40:43], s64 offen offset:2048 lds
    s_add_u32 s64, s64, 98304
    s_sub_u32 s35, s64, 1966080
    s_min_u32 s64, s64, s35
    s_waitcnt vmcnt(12)
    s_waitcnt lgkmcnt(0)
    s_barrier
    ds_read_b64_tr_b16 a[48:49], v238 offset:0
    ds_read_b64_tr_b16 a[50:51], v238 offset:1536
    ds_read_b64_tr_b16 a[52:53], v238 offset:6224
    ds_read_b64_tr_b16 a[54:55], v238 offset:7760
    ds_read_b64_tr_b16 a[56:57], v239 offset:0
    ds_read_b64_tr_b16 a[58:59], v239 offset:1536
    ds_read_b64_tr_b16 a[60:61], v238 offset:12416
    ds_read_b64_tr_b16 a[62:63], v238 offset:13952
    ds_read_b64_tr_b16 a[64:65], v238 offset:18640
    ds_read_b64_tr_b16 a[66:67], v238 offset:20176
    ds_read_b64_tr_b16 a[68:69], v239 offset:12416
    ds_read_b64_tr_b16 a[70:71], v239 offset:13952
    s_add_u32 m0, s61, 33024
    s_nop 0
    buffer_load_dwordx4 v230, s[40:43], s64 offen offset:0 lds
    buffer_load_dwordx4 v231, s[40:43], s64 offen offset:1024 lds
    buffer_load_dwordx4 v232, s[40:43], s64 offen offset:2048 lds
    s_add_u32 s64, s64, 98304
    s_sub_u32 s35, s64, 1966080
    s_min_u32 s64, s64, s35
    s_add_u32 m0, s61, 45440
    s_nop 0
    buffer_load_dwordx4 v230, s[40:43], s64 offen offset:0 lds
    buffer_load_dwordx4 v231, s[40:43], s64 offen offset:1024 lds
    buffer_load_dwordx4 v232, s[40:43], s64 offen offset:2048 lds
    s_add_u32 s64, s64, 98304
    s_sub_u32 s35, s64, 1966080
    s_min_u32 s64, s64, s35
    s_waitcnt vmcnt(12)
    s_waitcnt lgkmcnt(0)
    s_barrier
    ds_read_b64_tr_b16 a[72:73], v238 offset:24832
    ds_read_b64_tr_b16 a[74:75], v238 offset:26368
    ds_read_b64_tr_b16 a[76:77], v238 offset:31056
    ds_read_b64_tr_b16 a[78:79], v238 offset:32592
    ds_read_b64_tr_b16 a[80:81], v239 offset:24832
    ds_read_b64_tr_b16 a[82:83], v239 offset:26368
    ds_read_b64_tr_b16 a[84:85], v238 offset:37248
    ds_read_b64_tr_b16 a[86:87], v238 offset:38784
    ds_read_b64_tr_b16 a[88:89], v238 offset:43472
    ds_read_b64_tr_b16 a[90:91], v238 offset:45008
    ds_read_b64_tr_b16 a[92:93], v239 offset:37248
    ds_read_b64_tr_b16 a[94:95], v239 offset:38784
    s_add_u32 m0, s61, 57856
    s_nop 0
    buffer_load_dwordx4 v230, s[40:43], s64 offen offset:0 lds
    buffer_load_dwordx4 v231, s[40:43], s64 offen offset:1024 lds
    buffer_load_dwordx4 v232, s[40:43], s64 offen offset:2048 lds
    s_add_u32 s64, s64, 98304
    s_sub_u32 s35, s64, 1966080
    s_min_u32 s64, s64, s35
    s_add_u32 m0, s61, 70272
    s_nop 0
    buffer_load_dwordx4 v230, s[40:43], s64 offen offset:0 lds
    buffer_load_dwordx4 v231, s[40:43], s64 offen offset:1024 lds
    buffer_load_dwordx4 v232, s[40:43], s64 offen offset:2048 lds
    s_add_u32 s64, s64, 98304
    s_sub_u32 s35, s64, 1966080
    s_min_u32 s64, s64, s35
    s_mov_b32 s66, 23229184
    v_min_u32 v240, 19, v1
    v_lshlrev_b32 v240, 7, v240
    buffer_load_dword v241, v240, s[36:39], s66 offen sc1
    s_waitcnt vmcnt(13)
    s_waitcnt lgkmcnt(0)
    s_barrier
    ds_read_b64_tr_b16 a[96:97], v233 offset:0
    ds_read_b64_tr_b16 a[98:99], v233 offset:1536
    ds_read_b64_tr_b16 a[100:101], v233 offset:6224
    ds_read_b64_tr_b16 a[102:103], v233 offset:7760
    ds_read_b64_tr_b16 a[104:105], v234 offset:0
    ds_read_b64_tr_b16 a[106:107], v234 offset:1536
    ds_read_b64_tr_b16 a[108:109], v233 offset:12416
    ds_read_b64_tr_b16 a[110:111], v233 offset:13952
    ds_read_b64_tr_b16 a[112:113], v233 offset:18640
    ds_read_b64_tr_b16 a[114:115], v233 offset:20176
    ds_read_b64_tr_b16 a[116:117], v234 offset:12416
    ds_read_b64_tr_b16 a[118:119], v234 offset:13952
    s_add_u32 m0, s61, 82688
    s_nop 0
    buffer_load_dwordx4 v230, s[40:43], s64 offen offset:0 lds
    buffer_load_dwordx4 v231, s[40:43], s64 offen offset:1024 lds
    buffer_load_dwordx4 v232, s[40:43], s64 offen offset:2048 lds
    s_add_u32 s64, s64, 98304
    s_sub_u32 s35, s64, 1966080
    s_min_u32 s64, s64, s35
    s_mov_b32 s69, s64
    s_add_u32 m0, s61, 95104
    s_nop 0
    buffer_load_dwordx4 v230, s[40:43], s64 offen offset:0 lds
    buffer_load_dwordx4 v231, s[40:43], s64 offen offset:1024 lds
    buffer_load_dwordx4 v232, s[40:43], s64 offen offset:2048 lds
    s_add_u32 s64, s64, 98304
    s_sub_u32 s35, s64, 1966080
    s_min_u32 s64, s64, s35
    s_waitcnt vmcnt(13)
    s_waitcnt lgkmcnt(0)
    s_barrier
    ds_read_b64_tr_b16 a[120:121], v233 offset:24832
    ds_read_b64_tr_b16 a[122:123], v233 offset:26368
    ds_read_b64_tr_b16 a[124:125], v233 offset:31056
    ds_read_b64_tr_b16 a[126:127], v233 offset:32592
    ds_read_b64_tr_b16 a[128:129], v234 offset:24832
    ds_read_b64_tr_b16 a[130:131], v234 offset:26368
    ds_read_b64_tr_b16 a[132:133], v233 offset:37248
    ds_read_b64_tr_b16 a[134:135], v233 offset:38784
    ds_read_b64_tr_b16 a[136:137], v233 offset:43472
    ds_read_b64_tr_b16 a[138:139], v233 offset:45008
    ds_read_b64_tr_b16 a[140:141], v234 offset:37248
    ds_read_b64_tr_b16 a[142:143], v234 offset:38784
    s_add_u32 m0, s61, 8192
    s_nop 0
    buffer_load_dwordx4 v230, s[40:43], s64 offen offset:0 lds
    buffer_load_dwordx4 v231, s[40:43], s64 offen offset:1024 lds
    buffer_load_dwordx4 v232, s[40:43], s64 offen offset:2048 lds
    s_add_u32 s64, s64, 98304
    s_sub_u32 s35, s64, 1966080
    s_min_u32 s64, s64, s35
    s_add_u32 m0, s61, 20608
    s_nop 0
    buffer_load_dwordx4 v230, s[40:43], s64 offen offset:0 lds
    buffer_load_dwordx4 v231, s[40:43], s64 offen offset:1024 lds
    buffer_load_dwordx4 v232, s[40:43], s64 offen offset:2048 lds
    s_add_u32 s64, s64, 98304
    s_sub_u32 s35, s64, 1966080
    s_min_u32 s64, s64, s35
    s_waitcnt vmcnt(13)
    s_waitcnt lgkmcnt(0)
    s_barrier
    ds_read_b64_tr_b16 a[144:145], v238 offset:0
    ds_read_b64_tr_b16 a[146:147], v238 offset:1536
    ds_read_b64_tr_b16 a[148:149], v238 offset:6224
    ds_read_b64_tr_b16 a[150:151], v238 offset:7760
    ds_read_b64_tr_b16 a[152:153], v239 offset:0
    ds_read_b64_tr_b16 a[154:155], v239 offset:1536
    ds_read_b64_tr_b16 a[156:157], v238 offset:12416
    ds_read_b64_tr_b16 a[158:159], v238 offset:13952
    ds_read_b64_tr_b16 a[160:161], v238 offset:18640
    ds_read_b64_tr_b16 a[162:163], v238 offset:20176
    ds_read_b64_tr_b16 a[164:165], v239 offset:12416
    ds_read_b64_tr_b16 a[166:167], v239 offset:13952
    s_add_u32 m0, s61, 33024
    s_nop 0
    buffer_load_dwordx4 v230, s[40:43], s64 offen offset:0 lds
    buffer_load_dwordx4 v231, s[40:43], s64 offen offset:1024 lds
    buffer_load_dwordx4 v232, s[40:43], s64 offen offset:2048 lds
    s_add_u32 s64, s64, 98304
    s_sub_u32 s35, s64, 1966080
    s_min_u32 s64, s64, s35
    s_add_u32 m0, s61, 45440
    s_nop 0
    buffer_load_dwordx4 v230, s[40:43], s64 offen offset:0 lds
    buffer_load_dwordx4 v231, s[40:43], s64 offen offset:1024 lds
    buffer_load_dwordx4 v232, s[40:43], s64 offen offset:2048 lds
    s_add_u32 s64, s64, 98304
    s_sub_u32 s35, s64, 1966080
    s_min_u32 s64, s64, s35
    s_waitcnt vmcnt(18)
    v_cmp_ne_u32 vcc, s48, v241
    s_cbranch_vccnz L_chk20_slow
L_chk20_back:
    s_mul_i32 s52, s3, 2560
    s_add_u32 m0, s52, 128000
    s_lshl_b32 s52, s34, 7
    s_add_u32 s52, s52, 23166976
    buffer_load_dwordx4 v248, s[36:39], s52 offen sc1 lds
    buffer_load_dwordx4 v248, s[36:39], s52 offen offset:1024 sc1 lds
    s_mov_b32 exec_hi, 0
    buffer_load_dwordx4 v248, s[36:39], s52 offen offset:2048 sc1 lds
    s_mov_b32 exec_hi, -1
    s_lshr_b32 s52, s71, 1
    s_lshl_b32 s52, s52, 2
    s_add_u32 s52, s52, s3
    s_mul_i32 s52, s52, 10240
    s_and_b32 s53, s71, 1
    s_mul_i32 s53, s53, 640
    s_add_u32 s52, s52, s53
    s_mul_i32 s53, s3, 5120
    v_add_u32 v5, 0, v1
    v_mul_u32_u24 v6, 205, v5
    v_lshrrev_b32 v6, 13, v6
    v_mul_u32_u24 v6, 640, v6
    v_lshl_add_u32 v5, v5, 4, v6
    s_add_u32 m0, s53, 107520
    s_nop 0
    buffer_load_dwordx4 v5, s[56:59], s52 offen nt lds
    v_add_u32 v5, 64, v1
    v_mul_u32_u24 v6, 205, v5
    v_lshrrev_b32 v6, 13, v6
    v_mul_u32_u24 v6, 640, v6
    v_lshl_add_u32 v5, v5, 4, v6
    s_add_u32 m0, s53, 108544
    s_nop 0
    buffer_load_dwordx4 v5, s[56:59], s52 offen nt lds
    v_add_u32 v5, 128, v1
    v_mul_u32_u24 v6, 205, v5
    v_lshrrev_b32 v6, 13, v6
    v_mul_u32_u24 v6, 640, v6
    v_lshl_add_u32 v5, v5, 4, v6
    s_add_u32 m0, s53, 109568
    s_nop 0
    buffer_load_dwordx4 v5, s[56:59], s52 offen nt lds
    v_add_u32 v5, 192, v1
    v_mul_u32_u24 v6, 205, v5
    v_lshrrev_b32 v6, 13, v6
    v_mul_u32_u24 v6, 640, v6
    v_lshl_add_u32 v5, v5, 4, v6
    s_add_u32 m0, s53, 110592
    s_nop 0
    buffer_load_dwordx4 v5, s[56:59], s52 offen nt lds
    v_add_u32 v5, 256, v1
    v_mul_u32_u24 v6, 205, v5
    v_lshrrev_b32 v6, 13, v6
    v_mul_u32_u24 v6, 640, v6
    v_lshl_add_u32 v5, v5, 4, v6
    s_add_u32 m0, s53, 111616
    s_nop 0
    buffer_load_dwordx4 v5, s[56:59], s52 offen nt lds
    s_waitcnt vmcnt(20)
    s_waitcnt lgkmcnt(0)
    s_barrier
    ds_read_b64_tr_b16 a[168:169], v238 offset:24832
    ds_read_b64_tr_b16 a[170:171], v238 offset:26368
    ds_read_b64_tr_b16 a[172:173], v238 offset:31056
    ds_read_b64_tr_b16 a[174:175], v238 offset:32592
    ds_read_b64_tr_b16 a[176:177], v239 offset:24832
    ds_read_b64_tr_b16 a[178:179], v239 offset:26368
    ds_read_b64_tr_b16 a[180:181], v238 offset:37248
    ds_read_b64_tr_b16 a[182:183], v238 offset:38784
    ds_read_b64_tr_b16 a[184:185], v238 offset:43472
    ds_read_b64_tr_b16 a[186:187], v238 offset:45008
    ds_read_b64_tr_b16 a[188:189], v239 offset:37248
    ds_read_b64_tr_b16 a[190:191], v239 offset:38784
    s_waitcnt vmcnt(14)
    s_waitcnt lgkmcnt(0)
    s_barrier
    ds_read_b64_tr_b16 a[192:193], v233 offset:0
    ds_read_b64_tr_b16 a[194:195], v233 offset:1536
    ds_read_b64_tr_b16 a[196:197], v233 offset:6224
    ds_read_b64_tr_b16 a[198:199], v233 offset:7760
    ds_read_b64_tr_b16 a[200:201], v234 offset:0
    ds_read_b64_tr_b16 a[202:203], v234 offset:1536
    ds_read_b64_tr_b16 a[204:205], v233 offset:12416
    ds_read_b64_tr_b16 a[206:207], v233 offset:13952
    ds_read_b64_tr_b16 a[208:209], v233 offset:18640
    ds_read_b64_tr_b16 a[210:211], v233 offset:20176
    ds_read_b64_tr_b16 a[212:213], v234 offset:12416
    ds_read_b64_tr_b16 a[214:215], v234 offset:13952
    s_waitcnt vmcnt(8)
    s_waitcnt lgkmcnt(0)
    s_barrier
    ds_read_b64_tr_b16 a[216:217], v233 offset:24832
    ds_read_b64_tr_b16 a[218:219], v233 offset:26368
    ds_read_b64_tr_b16 a[220:221], v233 offset:31056
    ds_read_b64_tr_b16 a[222:223], v233 offset:32592
    ds_read_b64_tr_b16 a[224:225], v234 offset:24832
    ds_read_b64_tr_b16 a[226:227], v234 offset:26368
    ds_read_b64_tr_b16 a[228:229], v233 offset:37248
    ds_read_b64_tr_b16 a[230:231], v233 offset:38784
    ds_read_b64_tr_b16 a[232:233], v233 offset:43472
    ds_read_b64_tr_b16 a[234:235], v233 offset:45008
    ds_read_b64_tr_b16 a[236:237], v234 offset:37248
    ds_read_b64_tr_b16 a[238:239], v234 offset:38784
    s_waitcnt lgkmcnt(0)
    s_barrier
    s_mov_b32 s64, s69
    v_and_b32 v165, 1, v1
    v_lshlrev_b32 v165, 6, v165
    v_and_b32 v166, 48, v1
    s_mul_i32 s57, s3, 2560
    s_add_u32 s57, s57, 128000
    v_add3_u32 v165, v165, v166, s57
    s_waitcnt vmcnt(5)
    ds_read_b128 v[40:43], v165 offset:0
    ds_read_b128 v[44:47], v165 offset:128
    ds_read_b128 v[48:51], v165 offset:256
    ds_read_b128 v[52:55], v165 offset:384
    ds_read_b128 v[56:59], v165 offset:512
    ds_read_b128 v[60:63], v165 offset:640
    s_waitcnt lgkmcnt(5)
    v_mfma_f32_16x16x32_bf16 v[176:179], a[0:3], v[40:43], 0
    ds_read_b128 v[64:67], v165 offset:768
    v_mfma_f32_16x16x32_bf16 v[180:183], a[4:7], v[40:43], 0
    v_mfma_f32_16x16x32_bf16 v[184:187], a[8:11], v[40:43], 0
    s_waitcnt lgkmcnt(5)
    v_mfma_f32_16x16x32_bf16 v[176:179], a[12:15], v[44:47], v[176:179]
    ds_read_b128 v[68:71], v165 offset:896
    v_mfma_f32_16x16x32_bf16 v[180:183], a[16:19], v[44:47], v[180:183]
    v_mfma_f32_16x16x32_bf16 v[184:187], a[20:23], v[44:47], v[184:187]
    s_waitcnt lgkmcnt(5)
    v_mfma_f32_16x16x32_bf16 v[176:179], a[24:27], v[48:51], v[176:179]
    ds_read_b128 v[40:43], v165 offset:1024
    v_mfma_f32_16x16x32_bf16 v[180:183], a[28:31], v[48:51], v[180:183]
    v_mfma_f32_16x16x32_bf16 v[184:187], a[32:35], v[48:51], v[184:187]
    s_waitcnt lgkmcnt(5)
    v_mfma_f32_16x16x32_bf16 v[176:179], a[36:39], v[52:55], v[176:179]
    ds_read_b128 v[44:47], v165 offset:1152
    v_mfma_f32_16x16x32_bf16 v[180:183], a[40:43], v[52:55], v[180:183]
    v_mfma_f32_16x16x32_bf16 v[184:187], a[44:47], v[52:55], v[184:187]
    s_waitcnt lgkmcnt(5)
    v_mfma_f32_16x16x32_bf16 v[176:179], a[48:51], v[56:59], v[176:179]
    ds_read_b128 v[48:51], v165 offset:1280
    v_mfma_f32_16x16x32_bf16 v[180:183], a[52:55], v[56:59], v[180:183]
    v_mfma_f32_16x16x32_bf16 v[184:187], a[56:59], v[56:59], v[184:187]
    s_waitcnt lgkmcnt(5)
    v_mfma_f32_16x16x32_bf16 v[176:179], a[60:63], v[60:63], v[176:179]
    ds_read_b128 v[52:55], v165 offset:1408
    v_mfma_f32_16x16x32_bf16 v[180:183], a[64:67], v[60:63], v[180:183]
    v_mfma_f32_16x16x32_bf16 v[184:187], a[68:71], v[60:63], v[184:187]
    s_waitcnt lgkmcnt(5)
    v_mfma_f32_16x16x32_bf16 v[176:179], a[72:75], v[64:67], v[176:179]
    ds_read_b128 v[56:59], v165 offset:1536
    v_mfma_f32_16x16x32_bf16 v[180:183], a[76:79], v[64:67], v[180:183]
    v_mfma_f32_16x16x32_bf16 v[184:187], a[80:83], v[64:67], v[184:187]
    s_waitcnt lgkmcnt(5)
    v_mfma_f32_16x16x32_bf16 v[176:179], a[84:87], v[68:71], v[176:179]
    ds_read_b128 v[60:63], v165 offset:1664
    v_mfma_f32_16x16x32_bf16 v[180:183], a[88:91], v[68:71], v[180:183]
    v_mfma_f32_16x16x32_bf16 v[184:187], a[92:95], v[68:71], v[184:187]
    s_waitcnt lgkmcnt(5)
    v_mfma_f32_16x16x32_bf16 v[176:179], a[96:99], v[40:43], v[176:179]
    ds_read_b128 v[64:67], v165 offset:1792
    v_mfma_f32_16x16x32_bf16 v[180:183], a[100:103], v[40:43], v[180:183]
    v_mfma_f32_16x16x32_bf16 v[184:187], a[104:107], v[40:43], v[184:187]
    s_waitcnt lgkmcnt(5)
    v_mfma_f32_16x16x32_bf16 v[176:179], a[108:111], v[44:47], v[176:179]
    ds_read_b128 v[68:71], v165 offset:1920
    v_mfma_f32_16x16x32_bf16 v[180:183], a[112:115], v[44:47], v[180:183]
    v_mfma_f32_16x16x32_bf16 v[184:187], a[116:119], v[44:47], v[184:187]
    s_waitcnt lgkmcnt(5)
    v_mfma_f32_16x16x32_bf16 v[176:179], a[120:123], v[48:51], v[176:179]
    ds_read_b128 v[40:43], v165 offset:2048
    v_mfma_f32_16x16x32_bf16 v[180:183], a[124:127], v[48:51], v[180:183]
    v_mfma_f32_16x16x32_bf16 v[184:187], a[128:131], v[48:51], v[184:187]
    s_waitcnt lgkmcnt(5)
    v_mfma_f32_16x16x32_bf16 v[176:179], a[132:135], v[52:55], v[176:179]
    ds_read_b128 v[44:47], v165 offset:2176
    v_mfma_f32_16x16x32_bf16 v[180:183], a[136:139], v[52:55], v[180:183]
    v_mfma_f32_16x16x32_bf16 v[184:187], a[140:143], v[52:55], v[184:187]
    s_waitcnt lgkmcnt(5)
    v_mfma_f32_16x16x32_bf16 v[176:179], a[144:147], v[56:59], v[176:179]
    ds_read_b128 v[48:51], v165 offset:2304
    v_mfma_f32_16x16x32_bf16 v[180:183], a[148:151], v[56:59], v[180:183]
    v_mfma_f32_16x16x32_bf16 v[184:187], a[152:155], v[56:59], v[184:187]
    s_waitcnt lgkmcnt(5)
    v_mfma_f32_16x16x32_bf16 v[176:179], a[156:159], v[60:63], v[176:179]
    ds_read_b128 v[52:55], v165 offset:2432
    v_mfma_f32_16x16x32_bf16 v[180:183], a[160:163], v[60:63], v[180:183]
    v_mfma_f32_16x16x32_bf16 v[184:187], a[164:167], v[60:63], v[184:187]
    s_waitcnt lgkmcnt(5)
    v_mfma_f32_16x16x32_bf16 v[176:179], a[168:171], v[64:67], v[176:179]
    v_mfma_f32_16x16x32_bf16 v[180:183], a[172:175], v[64:67], v[180:183]
    v_mfma_f32_16x16x32_bf16 v[184:187], a[176:179], v[64:67], v[184:187]
    s_waitcnt lgkmcnt(4)
    v_mfma_f32_16x16x32_bf16 v[176:179], a[180:183], v[68:71], v[176:179]
    v_mfma_f32_16x16x32_bf16 v[180:183], a[184:187], v[68:71], v[180:183]
    v_mfma_f32_16x16x32_bf16 v[184:187], a[188:191], v[68:71], v[184:187]
    s_waitcnt lgkmcnt(3)
    v_mfma_f32_16x16x32_bf16 v[176:179], a[192:195], v[40:43], v[176:179]
    v_mfma_f32_16x16x32_bf16 v[180:183], a[196:199], v[40:43], v[180:183]
    v_mfma_f32_16x16x32_bf16 v[184:187], a[200:203], v[40:43], v[184:187]
    s_waitcnt lgkmcnt(2)
    v_mfma_f32_16x16x32_bf16 v[176:179], a[204:207], v[44:47], v[176:179]
    v_mfma_f32_16x16x32_bf16 v[180:183], a[208:211], v[44:47], v[180:183]
    v_mfma_f32_16x16x32_bf16 v[184:187], a[212:215], v[44:47], v[184:187]
    s_waitcnt lgkmcnt(1)
    v_mfma_f32_16x16x32_bf16 v[176:179], a[216:219], v[48:51], v[176:179]
    v_mfma_f32_16x16x32_bf16 v[180:183], a[220:223], v[48:51], v[180:183]
    v_mfma_f32_16x16x32_bf16 v[184:187], a[224:227], v[48:51], v[184:187]
    s_waitcnt lgkmcnt(0)
    v_mfma_f32_16x16x32_bf16 v[176:179], a[228:231], v[52:55], v[176:179]
    v_mfma_f32_16x16x32_bf16 v[180:183], a[232:235], v[52:55], v[180:183]
    v_mfma_f32_16x16x32_bf16 v[184:187], a[236:239], v[52:55], v[184:187]
    v_and_b32 v90, 1, v1
    v_mul_u32_u24 v90, 192, v90
    v_and_b32 v91, 48, v1
    v_add_u32 v90, v90, v91
    s_mov_b32 exec_lo, 0x00030003
    s_mov_b32 exec_hi, 0x00030003
    buffer_store_dwordx4 v[176:179], v90, s[36:39], s9 offen offset:0 sc1
    buffer_store_dwordx4 v[180:183], v90, s[36:39], s9 offen offset:64 sc1
    buffer_store_dwordx4 v[184:187], v90, s[36:39], s9 offen offset:128 sc1
    s_mov_b64 exec, -1
    s_waitcnt vmcnt(0)
    s_barrier
    v_lshrrev_b32 v2, 4, v1
    v_bfe_u32 v3, v1, 2, 2
    v_lshl_add_u32 v3, v2, 3, v3
    v_mul_u32_u24 v3, 640, v3
    v_and_b32 v2, 3, v1
    v_lshl_add_u32 v2, v2, 3, v3
    s_mul_i32 s50, s3, 160
    s_add_u32 s50, s50, 107520
    v_add_u32 v2, s50, v2
    s_lshr_b32 s53, s71, 1
    s_mov_b32 s50, 0x15555556
    s_mul_hi_u32 s51, s53, s50
    s_mul_i32 s52, s51, 12
    s_sub_u32 s52, s53, s52
    s_and_b32 s50, s71, 1
    s_lshl_b32 s50, s50, 2
    s_add_u32 s50, s50, s3
    s_lshl_b32 s50, s50, 2
    s_add_u32 s50, s50, s51
    s_mul_i32 s50, s50, 60
    s_mul_i32 s52, s52, 5
    s_add_u32 s50, s50, s52
    s_lshl_b32 s50, s50, 10
    s_add_u32 s50, s50, 14417920
    s_add_u32 s51, s50, 4096
    ds_read_b64_tr_b16 v[16:17], v2 offset:0
    ds_read_b64_tr_b16 v[18:19], v2 offset:2560
    ds_read_b64_tr_b16 v[20:21], v2 offset:32
    ds_read_b64_tr_b16 v[22:23], v2 offset:2592
    ds_read_b64_tr_b16 v[24:25], v2 offset:64
    ds_read_b64_tr_b16 v[26:27], v2 offset:2624
    ds_read_b64_tr_b16 v[28:29], v2 offset:96
    ds_read_b64_tr_b16 v[30:31], v2 offset:2656
    ds_read_b64_tr_b16 v[32:33], v2 offset:128
    ds_read_b64_tr_b16 v[34:35], v2 offset:2688
    s_waitcnt lgkmcnt(8)
    buffer_store_dwordx4 v[16:19], v248, s[36:39], s50 offen offset:0 sc1
    s_waitcnt lgkmcnt(6)
    buffer_store_dwordx4 v[20:23], v248, s[36:39], s50 offen offset:1024 sc1
    s_waitcnt lgkmcnt(4)
    buffer_store_dwordx4 v[24:27], v248, s[36:39], s50 offen offset:2048 sc1
    s_waitcnt lgkmcnt(2)
    buffer_store_dwordx4 v[28:31], v248, s[36:39], s50 offen offset:3072 sc1
    s_waitcnt lgkmcnt(0)
    buffer_store_dwordx4 v[32:35], v248, s[36:39], s51 offen offset:0 sc1
L_nobias:
    s_waitcnt vmcnt(0)
    s_barrier
    s_cmp_eq_u32 s3, 0
    s_cbranch_scc0 L_wf21
    s_lshl_b32 s54, s71, 7
    s_add_u32 s54, s54, 23233536
    v_mov_b32 v2, 0
    v_mov_b32 v3, s48
    s_mov_b64 exec, 1
    buffer_store_dword v3, v2, s[36:39], s54 offen sc1
    s_mov_b64 exec, -1
L_wf21:
    s_cmp_eq_u32 s76, 1
    s_cbranch_scc0 L_nobias2
    s_cmp_eq_u32 s3, 0
    s_cbranch_scc0 L_wf22
    s_lshl_b32 s54, s73, 7
    s_add_u32 s54, s54, 23286784
    v_mov_b32 v2, 0
    v_mov_b32 v3, s48
    s_mov_b64 exec, 1
    buffer_store_dword v3, v2, s[36:39], s54 offen sc1
    s_mov_b64 exec, -1
L_wf22:
L_nobias2:
    s_cmp_eq_u32 s2, 223
    s_cbranch_scc0 L_p_x
    v_lshlrev_b32 v5, 7, v0
    v_add_u32 v6, 134144, v5
    v_cmp_lt_u32 vcc, 159, v0
    s_nop 1
    v_cndmask_b32 v5, v5, v6, vcc
    s_mov_b32 s52, 23199744
L_poll23:
    buffer_load_dword v2, v5, s[36:39], s52 offen sc1
    s_waitcnt vmcnt(0)
    v_cmp_ne_u32 vcc, s48, v2
    s_cbranch_vccz L_poll23_ok
    s_cmp_eq_u32 s49, 0
    s_cbranch_scc1 L_poll23_ok
    s_sub_u32 s49, s49, 1
    s_sleep 1
    s_branch L_poll23
L_poll23_ok:
    s_barrier
    s_cmp_eq_u32 s3, 0
    s_cbranch_scc0 L_p_x
    s_mov_b32 s50, 23461888
    v_mov_b32 v2, 0
    v_mov_b32 v3, s48
    s_mov_b64 exec, 1
    buffer_store_dword v3, v2, s[36:39], s50 offen sc1
    s_mov_b64 exec, -1
L_p_x:
    v_min_u32 v2, 49, v1
    v_lshlrev_b32 v2, 7, v2
    v_add_u32 v2, 25600, v2
    v_cmp_lt_u32 vcc, 39, v1
    s_nop 1
    v_cndmask_b32 v219, v219, v2, vcc
    v_mov_b32 v200, v230
    v_mov_b32 v201, v231
    v_mov_b32 v202, v232
    v_add_u32 v203, 93568, v233
    v_add_u32 v204, 93568, v234
    s_add_u32 m0, s61, 101760
    s_nop 0
    buffer_load_dwordx4 v200, s[40:43], s64 offen offset:0 lds
    buffer_load_dwordx4 v201, s[40:43], s64 offen offset:1024 lds
    buffer_load_dwordx4 v202, s[40:43], s64 offen offset:2048 lds
    s_add_u32 s64, s64, 98304
    s_sub_u32 s35, s64, 1966080
    s_min_u32 s64, s64, s35
    s_add_u32 m0, s61, 114176
    s_nop 0
    buffer_load_dwordx4 v200, s[40:43], s64 offen offset:0 lds
    buffer_load_dwordx4 v201, s[40:43], s64 offen offset:1024 lds
    buffer_load_dwordx4 v202, s[40:43], s64 offen offset:2048 lds
    s_add_u32 s64, s64, 98304
    s_sub_u32 s35, s64, 1966080
    s_min_u32 s64, s64, s35
L_poll24:
    buffer_load_dword v223, v219, s[36:39], s17 offen sc1
    s_waitcnt vmcnt(0)
    v_cmp_ne_u32 vcc, s48, v223
    s_cbranch_vccz L_poll24_ok
    s_cmp_eq_u32 s49, 0
    s_cbranch_scc1 L_poll24_ok
    s_sub_u32 s49, s49, 1
    s_sleep 1
    s_branch L_poll24
L_poll24_ok:
    s_add_u32 m0, s63, 0
    s_nop 0
    buffer_load_dwordx4 v172, s[36:39], s10 offen sc1 lds
    s_add_u32 m0, s63, 4096
    s_nop 0
    buffer_load_dwordx4 v172, s[36:39], s11 offen sc1 lds
    s_add_u32 m0, s63, 8192
    s_nop 0
    buffer_load_dwordx4 v172, s[36:39], s12 offen sc1 lds
    s_add_u32 m0, s63, 12288
    s_nop 0
    buffer_load_dwordx4 v172, s[36:39], s13 offen sc1 lds
    s_add_u32 m0, s63, 16384
    s_nop 0
    buffer_load_dwordx4 v172, s[36:39], s14 offen sc1 lds
    s_add_u32 m0, s63, 20480
    s_nop 0
    buffer_load_dwordx4 v172, s[36:39], s15 offen sc1 lds
    s_add_u32 m0, s63, 24576
    s_nop 0
    buffer_load_dwordx4 v172, s[36:39], s18 offen sc1 lds
    s_add_u32 m0, s63, 28672
    s_nop 0
    buffer_load_dwordx4 v172, s[36:39], s19 offen sc1 lds
    s_add_u32 m0, s63, 32768
    s_nop 0
    buffer_load_dwordx4 v172, s[36:39], s20 offen sc1 lds
    s_add_u32 m0, s63, 36864
    s_nop 0
    buffer_load_dwordx4 v172, s[36:39], s21 offen sc1 lds
    s_add_u32 m0, s63, 40960
    s_nop 0
    buffer_load_dwordx4 v172, s[36:39], s22 offen sc1 lds
    s_add_u32 m0, s63, 45056
    s_nop 0
    buffer_load_dwordx4 v172, s[36:39], s23 offen sc1 lds
    v_lshlrev_b32 v2, 2, v0
    v_mov_b32 v3, 0x80000000
    v_cmp_gt_u32 vcc, 128, v0
    s_nop 1
    v_cndmask_b32 v3, v3, v2, vcc
    s_lshl_b32 s50, s34, 7
    s_add_u32 s50, s50, 23183360
    buffer_load_dword v220, v2, s[36:39], s50 offen sc1
    buffer_load_dword v221, v2, s[36:39], s50 offen offset:1024 sc1
    buffer_load_dword v222, v3, s[36:39], s50 offen offset:2048 sc1
    s_waitcnt vmcnt(12)
    s_waitcnt lgkmcnt(0)
    s_barrier
    ds_read_b64_tr_b16 v[104:105], v168 offset:0
    ds_read_b64_tr_b16 v[106:107], v168 offset:2048
    ds_read_b64_tr_b16 v[108:109], v169 offset:0
    ds_read_b64_tr_b16 v[110:111], v169 offset:2048
    ds_read_b64_tr_b16 v[112:113], v170 offset:0
    ds_read_b64_tr_b16 v[114:115], v170 offset:2048
    ds_read_b64_tr_b16 v[116:117], v171 offset:0
    ds_read_b64_tr_b16 v[118:119], v171 offset:2048
    s_waitcnt lgkmcnt(6)
    v_mfma_f32_16x16x32_bf16 v[56:59], a[0:3], v[104:107], 0
    ds_read_b64_tr_b16 v[120:121], v168 offset:4096
    v_mfma_f32_16x16x32_bf16 v[60:63], a[4:7], v[104:107], 0
    ds_read_b64_tr_b16 v[122:123], v168 offset:6144
    v_mfma_f32_16x16x32_bf16 v[64:67], a[8:11], v[104:107], 0
    s_waitcnt lgkmcnt(6)
    s_add_u32 m0, s63, 49152
    ds_read_b64_tr_b16 v[124:125], v169 offset:4096
    v_mfma_f32_16x16x32_bf16 v[68:71], a[0:3], v[108:111], 0
    buffer_load_dwordx4 v172, s[36:39], s24 offen sc1 lds
    v_mfma_f32_16x16x32_bf16 v[72:75], a[4:7], v[108:111], 0
    ds_read_b64_tr_b16 v[126:127], v169 offset:6144
    v_mfma_f32_16x16x32_bf16 v[76:79], a[8:11], v[108:111], 0
    s_waitcnt lgkmcnt(6)
    ds_read_b64_tr_b16 v[128:129], v170 offset:4096
    v_mfma_f32_16x16x32_bf16 v[80:83], a[0:3], v[112:115], 0
    s_add_u32 m0, s63, 53248
    ds_read_b64_tr_b16 v[130:131], v170 offset:6144
    v_mfma_f32_16x16x32_bf16 v[84:87], a[4:7], v[112:115], 0
    buffer_load_dwordx4 v172, s[36:39], s25 offen sc1 lds
    v_mfma_f32_16x16x32_bf16 v[88:91], a[8:11], v[112:115], 0
    s_waitcnt lgkmcnt(6)
    ds_read_b64_tr_b16 v[132:133], v171 offset:4096
    v_mfma_f32_16x16x32_bf16 v[92:95], a[0:3], v[116:119], 0
    s_waitcnt lgkmcnt(3)
    ds_read_b64_tr_b16 v[134:135], v171 offset:6144
    v_mfma_f32_16x16x32_bf16 v[96:99], a[4:7], v[116:119], 0
    s_add_u32 m0, s63, 57344
    v_mfma_f32_16x16x32_bf16 v[100:103], a[8:11], v[116:119], 0
    buffer_load_dwordx4 v172, s[36:39], s26 offen sc1 lds
    v_mfma_f32_16x16x32_bf16 v[56:59], a[12:15], v[120:123], v[56:59]
    ds_read_b64_tr_b16 v[104:105], v168 offset:8192
    v_mfma_f32_16x16x32_bf16 v[60:63], a[16:19], v[120:123], v[60:63]
    ds_read_b64_tr_b16 v[106:107], v168 offset:10240
    v_mfma_f32_16x16x32_bf16 v[64:67], a[20:23], v[120:123], v[64:67]
    s_add_u32 m0, s63, 61440
    ds_read_b64_tr_b16 v[108:109], v169 offset:8192
    v_mfma_f32_16x16x32_bf16 v[68:71], a[12:15], v[124:127], v[68:71]
    buffer_load_dwordx4 v172, s[36:39], s27 offen sc1 lds
    v_mfma_f32_16x16x32_bf16 v[72:75], a[16:19], v[124:127], v[72:75]
    ds_read_b64_tr_b16 v[110:111], v169 offset:10240
    v_mfma_f32_16x16x32_bf16 v[76:79], a[20:23], v[124:127], v[76:79]
    s_waitcnt lgkmcnt(6)
    ds_read_b64_tr_b16 v[112:113], v170 offset:8192
    v_mfma_f32_16x16x32_bf16 v[80:83], a[12:15], v[128:131], v[80:83]
    s_add_u32 m0, s63, 65536
    ds_read_b64_tr_b16 v[114:115], v170 offset:10240
    v_mfma_f32_16x16x32_bf16 v[84:87], a[16:19], v[128:131], v[84:87]
    buffer_load_dwordx4 v172, s[36:39], s44 offen sc1 lds
    v_mfma_f32_16x16x32_bf16 v[88:91], a[20:23], v[128:131], v[88:91]
    s_waitcnt lgkmcnt(6)
    ds_read_b64_tr_b16 v[116:117], v171 offset:8192
    v_mfma_f32_16x16x32_bf16 v[92:95], a[12:15], v[132:135], v[92:95]
    s_waitcnt lgkmcnt(3)
    ds_read_b64_tr_b16 v[118:119], v171 offset:10240
    v_mfma_f32_16x16x32_bf16 v[96:99], a[16:19], v[132:135], v[96:99]
    s_add_u32 m0, s63, 69632
    v_mfma_f32_16x16x32_bf16 v[100:103], a[20:23], v[132:135], v[100:103]
    buffer_load_dwordx4 v172, s[36:39], s45 offen sc1 lds
    v_mfma_f32_16x16x32_bf16 v[56:59], a[24:27], v[104:107], v[56:59]
    s_waitcnt vmcnt(13)
    s_barrier
    ds_read_b64_tr_b16 v[120:121], v168 offset:12288
    v_mfma_f32_16x16x32_bf16 v[60:63], a[28:31], v[104:107], v[60:63]
    ds_read_b64_tr_b16 v[122:123], v168 offset:14336
    v_mfma_f32_16x16x32_bf16 v[64:67], a[32:35], v[104:107], v[64:67]
    s_add_u32 m0, s63, 73728
    ds_read_b64_tr_b16 v[124:125], v169 offset:12288
    v_mfma_f32_16x16x32_bf16 v[68:71], a[24:27], v[108:111], v[68:71]
    buffer_load_dwordx4 v172, s[36:39], s46 offen sc1 lds
    v_mfma_f32_16x16x32_bf16 v[72:75], a[28:31], v[108:111], v[72:75]
    ds_read_b64_tr_b16 v[126:127], v169 offset:14336
    v_mfma_f32_16x16x32_bf16 v[76:79], a[32:35], v[108:111], v[76:79]
    s_waitcnt lgkmcnt(6)
    ds_read_b64_tr_b16 v[128:129], v170 offset:12288
    v_mfma_f32_16x16x32_bf16 v[80:83], a[24:27], v[112:115], v[80:83]
    s_add_u32 m0, s63, 77824
    ds_read_b64_tr_b16 v[130:131], v170 offset:14336
    v_mfma_f32_16x16x32_bf16 v[84:87], a[28:31], v[112:115], v[84:87]
    buffer_load_dwordx4 v172, s[36:39], s47 offen sc1 lds
    v_mfma_f32_16x16x32_bf16 v[88:91], a[32:35], v[112:115], v[88:91]
    s_waitcnt lgkmcnt(6)
    ds_read_b64_tr_b16 v[132:133], v171 offset:12288
    v_add_u32 v172, 2048, v172
    v_mfma_f32_16x16x32_bf16 v[92:95], a[24:27], v[116:119], v[92:95]
    s_waitcnt lgkmcnt(3)
    ds_read_b64_tr_b16 v[134:135], v171 offset:14336
    v_mfma_f32_16x16x32_bf16 v[96:99], a[28:31], v[116:119], v[96:99]
    s_add_u32 m0, s61, 126592
    v_mfma_f32_16x16x32_bf16 v[100:103], a[32:35], v[116:119], v[100:103]
    buffer_load_dwordx4 v200, s[40:43], s64 offen offset:0 lds
    v_mfma_f32_16x16x32_bf16 v[56:59], a[36:39], v[120:123], v[56:59]
    ds_read_b64_tr_b16 v[104:105], v168 offset:16384
    v_mfma_f32_16x16x32_bf16 v[60:63], a[40:43], v[120:123], v[60:63]
    ds_read_b64_tr_b16 v[106:107], v168 offset:18432
    v_mfma_f32_16x16x32_bf16 v[64:67], a[44:47], v[120:123], v[64:67]
    s_add_u32 m0, s61, 126592
    ds_read_b64_tr_b16 v[108:109], v169 offset:16384
    v_mfma_f32_16x16x32_bf16 v[68:71], a[36:39], v[124:127], v[68:71]
    buffer_load_dwordx4 v201, s[40:43], s64 offen offset:1024 lds
    v_mfma_f32_16x16x32_bf16 v[72:75], a[40:43], v[124:127], v[72:75]
    ds_read_b64_tr_b16 v[110:111], v169 offset:18432
    v_mfma_f32_16x16x32_bf16 v[76:79], a[44:47], v[124:127], v[76:79]
    s_waitcnt lgkmcnt(6)
    ds_read_b64_tr_b16 v[112:113], v170 offset:16384
    v_mfma_f32_16x16x32_bf16 v[80:83], a[36:39], v[128:131], v[80:83]
    ds_read_b64_tr_b16 v[114:115], v170 offset:18432
    v_mfma_f32_16x16x32_bf16 v[84:87], a[40:43], v[128:131], v[84:87]
    v_mfma_f32_16x16x32_bf16 v[88:91], a[44:47], v[128:131], v[88:91]
    s_waitcnt lgkmcnt(6)
    ds_read_b64_tr_b16 v[116:117], v171 offset:16384
    v_mfma_f32_16x16x32_bf16 v[92:95], a[36:39], v[132:135], v[92:95]
    s_waitcnt lgkmcnt(3)
    ds_read_b64_tr_b16 v[118:119], v171 offset:18432
    v_mfma_f32_16x16x32_bf16 v[96:99], a[40:43], v[132:135], v[96:99]
    s_add_u32 m0, s61, 126592
    v_mfma_f32_16x16x32_bf16 v[100:103], a[44:47], v[132:135], v[100:103]
    buffer_load_dwordx4 v202, s[40:43], s64 offen offset:2048 lds
    v_mfma_f32_16x16x32_bf16 v[56:59], a[48:51], v[104:107], v[56:59]
    s_add_u32 s64, s64, 98304
    ds_read_b64_tr_b16 v[120:121], v168 offset:20480
    v_mfma_f32_16x16x32_bf16 v[60:63], a[52:55], v[104:107], v[60:63]
    s_sub_u32 s35, s64, 1966080
    ds_read_b64_tr_b16 v[122:123], v168 offset:22528
    v_mfma_f32_16x16x32_bf16 v[64:67], a[56:59], v[104:107], v[64:67]
    s_min_u32 s64, s64, s35
    ds_read_b64_tr_b16 v[124:125], v169 offset:20480
    v_mfma_f32_16x16x32_bf16 v[68:71], a[48:51], v[108:111], v[68:71]
    v_mfma_f32_16x16x32_bf16 v[72:75], a[52:55], v[108:111], v[72:75]
    ds_read_b64_tr_b16 v[126:127], v169 offset:22528
    v_mfma_f32_16x16x32_bf16 v[76:79], a[56:59], v[108:111], v[76:79]
    s_waitcnt lgkmcnt(6)
    ds_read_b64_tr_b16 v[128:129], v170 offset:20480
    v_mfma_f32_16x16x32_bf16 v[80:83], a[48:51], v[112:115], v[80:83]
    s_add_u32 m0, s61, 139008
    ds_read_b64_tr_b16 v[130:131], v170 offset:22528
    v_min_u32 v243, 11, v1
    v_mfma_f32_16x16x32_bf16 v[84:87], a[52:55], v[112:115], v[84:87]
    buffer_load_dwordx4 v200, s[40:43], s64 offen offset:0 lds
    v_mfma_f32_16x16x32_bf16 v[88:91], a[56:59], v[112:115], v[88:91]
    s_waitcnt lgkmcnt(6)
    ds_read_b64_tr_b16 v[132:133], v171 offset:20480
    v_lshlrev_b32 v243, 8, v243
    v_mfma_f32_16x16x32_bf16 v[92:95], a[48:51], v[116:119], v[92:95]
    s_waitcnt lgkmcnt(3)
    ds_read_b64_tr_b16 v[134:135], v171 offset:22528
    v_mfma_f32_16x16x32_bf16 v[96:99], a[52:55], v[116:119], v[96:99]
    s_add_u32 m0, s61, 139008
    v_mfma_f32_16x16x32_bf16 v[100:103], a[56:59], v[116:119], v[100:103]
    buffer_load_dwordx4 v201, s[40:43], s64 offen offset:1024 lds
    v_mfma_f32_16x16x32_bf16 v[56:59], a[60:63], v[120:123], v[56:59]
    s_mul_i32 s58, s3, 24
    s_lshr_b32 s57, s75, 2
    ds_read_b64_tr_b16 v[104:105], v168 offset:24576
    v_mfma_f32_16x16x32_bf16 v[60:63], a[64:67], v[120:123], v[60:63]
    s_add_u32 s58, s58, s57
    s_lshl_b32 s58, s58, 7
    ds_read_b64_tr_b16 v[106:107], v168 offset:26624
    v_mfma_f32_16x16x32_bf16 v[64:67], a[68:71], v[120:123], v[64:67]
    s_add_u32 s58, s58, 23233536
    ds_read_b64_tr_b16 v[108:109], v169 offset:24576
    v_mfma_f32_16x16x32_bf16 v[68:71], a[60:63], v[124:127], v[68:71]
    buffer_load_dword v244, v243, s[36:39], s58 offen sc1
    v_mfma_f32_16x16x32_bf16 v[72:75], a[64:67], v[124:127], v[72:75]
    ds_read_b64_tr_b16 v[110:111], v169 offset:26624
    v_mfma_f32_16x16x32_bf16 v[76:79], a[68:71], v[124:127], v[76:79]
    s_waitcnt lgkmcnt(6)
    ds_read_b64_tr_b16 v[112:113], v170 offset:24576
    v_mfma_f32_16x16x32_bf16 v[80:83], a[60:63], v[128:131], v[80:83]
    s_add_u32 m0, s61, 139008
    ds_read_b64_tr_b16 v[114:115], v170 offset:26624
    v_mfma_f32_16x16x32_bf16 v[84:87], a[64:67], v[128:131], v[84:87]
    buffer_load_dwordx4 v202, s[40:43], s64 offen offset:2048 lds
    v_mfma_f32_16x16x32_bf16 v[88:91], a[68:71], v[128:131], v[88:91]
    s_waitcnt lgkmcnt(6)
    s_add_u32 s64, s64, 98304
    ds_read_b64_tr_b16 v[116:117], v171 offset:24576
    v_mfma_f32_16x16x32_bf16 v[92:95], a[60:63], v[132:135], v[92:95]
    s_waitcnt lgkmcnt(3)
    s_sub_u32 s35, s64, 1966080
    ds_read_b64_tr_b16 v[118:119], v171 offset:26624
    v_mfma_f32_16x16x32_bf16 v[96:99], a[64:67], v[132:135], v[96:99]
    s_min_u32 s64, s64, s35
    v_mfma_f32_16x16x32_bf16 v[100:103], a[68:71], v[132:135], v[100:103]
    v_mfma_f32_16x16x32_bf16 v[56:59], a[72:75], v[104:107], v[56:59]
    ds_read_b64_tr_b16 v[120:121], v168 offset:28672
    v_mfma_f32_16x16x32_bf16 v[60:63], a[76:79], v[104:107], v[60:63]
    ds_read_b64_tr_b16 v[122:123], v168 offset:30720
    v_mfma_f32_16x16x32_bf16 v[64:67], a[80:83], v[104:107], v[64:67]
    s_add_u32 m0, s61, 151424
    ds_read_b64_tr_b16 v[124:125], v169 offset:28672
    v_mfma_f32_16x16x32_bf16 v[68:71], a[72:75], v[108:111], v[68:71]
    buffer_load_dwordx4 v200, s[40:43], s64 offen offset:0 lds
    v_mfma_f32_16x16x32_bf16 v[72:75], a[76:79], v[108:111], v[72:75]
    ds_read_b64_tr_b16 v[126:127], v169 offset:30720
    v_mfma_f32_16x16x32_bf16 v[76:79], a[80:83], v[108:111], v[76:79]
    s_waitcnt lgkmcnt(6)
    ds_read_b64_tr_b16 v[128:129], v170 offset:28672
    v_mfma_f32_16x16x32_bf16 v[80:83], a[72:75], v[112:115], v[80:83]
    s_add_u32 m0, s61, 151424
    ds_read_b64_tr_b16 v[130:131], v170 offset:30720
    v_mfma_f32_16x16x32_bf16 v[84:87], a[76:79], v[112:115], v[84:87]
    buffer_load_dwordx4 v201, s[40:43], s64 offen offset:1024 lds
    v_mfma_f32_16x16x32_bf16 v[88:91], a[80:83], v[112:115], v[88:91]
    s_waitcnt lgkmcnt(6)
    ds_read_b64_tr_b16 v[132:133], v171 offset:28672
    v_mfma_f32_16x16x32_bf16 v[92:95], a[72:75], v[116:119], v[92:95]
    s_waitcnt lgkmcnt(3)
    ds_read_b64_tr_b16 v[134:135], v171 offset:30720
    v_mfma_f32_16x16x32_bf16 v[96:99], a[76:79], v[116:119], v[96:99]
    v_mfma_f32_16x16x32_bf16 v[100:103], a[80:83], v[116:119], v[100:103]
    v_mfma_f32_16x16x32_bf16 v[56:59], a[84:87], v[120:123], v[56:59]
    s_waitcnt vmcnt(9)
    s_barrier
    ds_read_b64_tr_b16 v[104:105], v168 offset:32768
    v_mfma_f32_16x16x32_bf16 v[60:63], a[88:91], v[120:123], v[60:63]
    ds_read_b64_tr_b16 v[106:107], v168 offset:34816
    ds_read_b64 v[224:225], v216
    v_mfma_f32_16x16x32_bf16 v[64:67], a[92:95], v[120:123], v[64:67]
    s_add_u32 m0, s61, 151424
    ds_read_b64_tr_b16 v[108:109], v169 offset:32768
    ds_read_b64 v[226:227], v217
    v_mfma_f32_16x16x32_bf16 v[68:71], a[84:87], v[124:127], v[68:71]
    buffer_load_dwordx4 v202, s[40:43], s64 offen offset:2048 lds
    v_mfma_f32_16x16x32_bf16 v[72:75], a[88:91], v[124:127], v[72:75]
    s_add_u32 s64, s64, 98304
    ds_read_b64_tr_b16 v[110:111], v169 offset:34816
    ds_read_b64 v[228:229], v218
    v_mfma_f32_16x16x32_bf16 v[76:79], a[92:95], v[124:127], v[76:79]
    s_waitcnt lgkmcnt(9)
    s_sub_u32 s35, s64, 1966080
    ds_read_b64_tr_b16 v[112:113], v170 offset:32768
    v_mfma_f32_16x16x32_bf16 v[80:83], a[84:87], v[128:131], v[80:83]
    s_min_u32 s64, s64, s35
    ds_read_b64_tr_b16 v[114:115], v170 offset:34816
    v_lshrrev_b32 v238, 1, v1
    v_mfma_f32_16x16x32_bf16 v[84:87], a[88:91], v[128:131], v[84:87]
    s_barrier
    ds_read_b64_tr_b16 a[180:181], v203 offset:0
    v_mfma_f32_16x16x32_bf16 v[88:91], a[92:95], v[128:131], v[88:91]
    s_waitcnt lgkmcnt(10)
    ds_read_b64_tr_b16 v[116:117], v171 offset:32768
    v_lshlrev_b32 v238, 10, v238
    v_mfma_f32_16x16x32_bf16 v[92:95], a[84:87], v[132:135], v[92:95]
    s_waitcnt lgkmcnt(3)
    ds_read_b64_tr_b16 v[118:119], v171 offset:34816
    v_and_b32 v239, 1, v1
    v_mfma_f32_16x16x32_bf16 v[96:99], a[88:91], v[132:135], v[96:99]
    ds_read_b64_tr_b16 a[182:183], v203 offset:1536
    v_lshlrev_b32 v230, 16, v224
    v_and_b32 v231, 0xffff0000, v224
    v_pk_mul_f32 v[230:231], v[230:231], v[220:221] op_sel_hi:[1,0]
    v_pk_mul_f32 v[234:235], v[230:231], v[230:231]
    v_lshlrev_b32 v232, 16, v225
    v_and_b32 v233, 0xffff0000, v225
    v_pk_mul_f32 v[232:233], v[232:233], v[220:221] op_sel_hi:[1,0]
    v_pk_mul_f32 v[236:237], v[232:233], v[232:233]
    v_lshlrev_b32 v2, 16, v226
    v_and_b32 v3, 0xffff0000, v226
    v_pk_mul_f32 v[2:3], v[2:3], v[220:221] op_sel:[0,1] op_sel_hi:[1,1]
    v_pk_add_f32 v[230:231], v[230:231], v[2:3]
    v_pk_fma_f32 v[234:235], v[2:3], v[2:3], v[234:235]
    v_lshlrev_b32 v2, 16, v227
    v_and_b32 v3, 0xffff0000, v227
    v_pk_mul_f32 v[2:3], v[2:3], v[220:221] op_sel:[0,1] op_sel_hi:[1,1]
    v_pk_add_f32 v[232:233], v[232:233], v[2:3]
    v_pk_fma_f32 v[236:237], v[2:3], v[2:3], v[236:237]
    v_lshlrev_b32 v2, 16, v228
    v_and_b32 v3, 0xffff0000, v228
    v_pk_mul_f32 v[2:3], v[2:3], v[222:223] op_sel_hi:[1,0]
    v_pk_add_f32 v[230:231], v[230:231], v[2:3]
    v_pk_fma_f32 v[234:235], v[2:3], v[2:3], v[234:235]
    v_lshlrev_b32 v2, 16, v229
    v_and_b32 v3, 0xffff0000, v229
    v_pk_mul_f32 v[2:3], v[2:3], v[222:223] op_sel_hi:[1,0]
    v_pk_add_f32 v[232:233], v[232:233], v[2:3]
    v_pk_fma_f32 v[236:237], v[2:3], v[2:3], v[236:237]
    v_mfma_f32_16x16x32_bf16 v[100:103], a[92:95], v[132:135], v[100:103]
    ds_read_b64_tr_b16 a[184:185], v203 offset:6224
    v_permlane32_swap_b32 v230, v234
    v_mfma_f32_16x16x32_bf16 v[56:59], a[96:99], v[104:107], v[56:59]
    ds_read_b64_tr_b16 v[120:121], v168 offset:36864
    ds_read_b64_tr_b16 a[186:187], v203 offset:7760
    v_lshl_add_u32 v219, v239, 7, v238
    v_permlane32_swap_b32 v231, v235
    v_mfma_f32_16x16x32_bf16 v[60:63], a[100:103], v[104:107], v[60:63]
    s_lshl_b32 s55, s3, 8
    s_add_u32 s55, s55, 66560
    ds_read_b64_tr_b16 v[122:123], v168 offset:38912
    v_mfma_f32_16x16x32_bf16 v[64:67], a[104:107], v[104:107], v[64:67]
    ds_read_b64_tr_b16 v[124:125], v169 offset:36864
    v_add_u32 v219, s55, v219
    v_mfma_f32_16x16x32_bf16 v[68:71], a[96:99], v[108:111], v[68:71]
    ds_read_b64_tr_b16 a[188:189], v204 offset:0
    v_permlane32_swap_b32 v232, v236
    v_mfma_f32_16x16x32_bf16 v[72:75], a[100:103], v[108:111], v[72:75]
    s_lshl_b32 s55, s73, 7
    s_add_u32 s55, s55, 87040
    ds_read_b64_tr_b16 v[126:127], v169 offset:38912
    ds_read_b64_tr_b16 a[190:191], v204 offset:1536
    v_permlane32_swap_b32 v233, v237
    v_add_f32 v230, v230, v234
    v_mfma_f32_16x16x32_bf16 v[76:79], a[104:107], v[108:111], v[76:79]
    s_waitcnt lgkmcnt(12)
    ds_read_b64_tr_b16 v[128:129], v170 offset:36864
    v_mov_b32 v238, s55
    v_mfma_f32_16x16x32_bf16 v[80:83], a[96:99], v[112:115], v[80:83]
    ds_read_b64_tr_b16 v[130:131], v170 offset:38912
    v_add_f32 v231, v231, v235
    v_mfma_f32_16x16x32_bf16 v[84:87], a[100:103], v[112:115], v[84:87]
    v_cmp_lt_u32 vcc, 39, v1
    s_nop 1
    v_cndmask_b32 v219, v219, v238, vcc
    v_mfma_f32_16x16x32_bf16 v[88:91], a[104:107], v[112:115], v[88:91]
    s_waitcnt lgkmcnt(11)
    s_mov_b32 s17, 23199744
    ds_read_b64_tr_b16 v[132:133], v171 offset:36864
    v_add_f32 v232, v232, v236
    v_mfma_f32_16x16x32_bf16 v[92:95], a[96:99], v[116:119], v[92:95]
    s_waitcnt lgkmcnt(3)
    ds_read_b64_tr_b16 v[134:135], v171 offset:38912
    v_add_f32 v233, v233, v237
    v_mfma_f32_16x16x32_bf16 v[96:99], a[100:103], v[116:119], v[96:99]
    v_permlane16_swap_b32 v230, v232
    v_permlane16_swap_b32 v231, v233
    v_mfma_f32_16x16x32_bf16 v[100:103], a[104:107], v[116:119], v[100:103]
    v_add_f32 v230, v230, v232
    v_add_f32 v231, v231, v233
    v_mfma_f32_16x16x32_bf16 v[56:59], a[108:111], v[120:123], v[56:59]
    s_barrier
    ds_read_b64_tr_b16 v[104:105], v168 offset:40960
    v_lshrrev_b32 v2, 4, v1
    v_lshlrev_b32 v2, 3, v2
    v_mfma_f32_16x16x32_bf16 v[60:63], a[112:115], v[120:123], v[60:63]
    ds_read_b64_tr_b16 v[106:107], v168 offset:43008
    ds_read_b64_tr_b16 a[192:193], v203 offset:12416
    v_mfma_f32_16x16x32_bf16 v[64:67], a[116:119], v[120:123], v[64:67]
    ds_read_b64_tr_b16 v[108:109], v169 offset:40960
    s_waitcnt vmcnt(4)
    v_cmp_ne_u32 vcc, s48, v244
    s_cbranch_vccnz L_chk25_slow
L_chk25_back:
    v_mfma_f32_16x16x32_bf16 v[68:71], a[108:111], v[124:127], v[68:71]
    ds_read_b64_tr_b16 a[194:195], v203 offset:13952
    buffer_load_dwordx4 a[240:243], v248, s[36:39], s62 offen offset:0 sc1
    v_mfma_f32_16x16x32_bf16 v[72:75], a[112:115], v[124:127], v[72:75]
    ds_read_b64_tr_b16 v[110:111], v169 offset:43008
    ds_read_b64_tr_b16 a[196:197], v203 offset:18640
    v_mfma_f32_16x16x32_bf16 v[76:79], a[116:119], v[124:127], v[76:79]
    s_waitcnt lgkmcnt(9)
    ds_read_b64_tr_b16 v[112:113], v170 offset:40960
    ds_read_b64_tr_b16 a[198:199], v203 offset:20176
    v_mfma_f32_16x16x32_bf16 v[80:83], a[108:111], v[128:131], v[80:83]
    s_lshl_b32 s50, s3, 5
    s_add_u32 s50, s50, 0
    ds_read_b64_tr_b16 v[114:115], v170 offset:43008
    v_add_u32 v2, s50, v2
    v_mfma_f32_16x16x32_bf16 v[84:87], a[112:115], v[128:131], v[84:87]
    ds_read_b64_tr_b16 a[200:201], v204 offset:12416
    buffer_load_dwordx4 a[244:247], v248, s[36:39], s62 offen offset:1024 sc1
    v_mfma_f32_16x16x32_bf16 v[88:91], a[116:119], v[128:131], v[88:91]
    s_waitcnt lgkmcnt(11)
    ds_read_b64_tr_b16 v[116:117], v171 offset:40960
    v_add_f32_dpp v230, v230, v230 row_ror:8 row_mask:0xf bank_mask:0xf
    v_mfma_f32_16x16x32_bf16 v[92:95], a[108:111], v[132:135], v[92:95]
    s_waitcnt lgkmcnt(3)
    ds_read_b64_tr_b16 v[118:119], v171 offset:43008
    v_add_f32_dpp v231, v231, v231 row_ror:8 row_mask:0xf bank_mask:0xf
    v_mfma_f32_16x16x32_bf16 v[96:99], a[112:115], v[132:135], v[96:99]
    ds_read_b64_tr_b16 a[202:203], v204 offset:13952
    v_add_f32_dpp v230, v230, v230 row_ror:4 row_mask:0xf bank_mask:0xf
    v_mfma_f32_16x16x32_bf16 v[100:103], a[116:119], v[132:135], v[100:103]
    buffer_load_dwordx4 a[248:251], v248, s[36:39], s62 offen offset:2048 sc1
    v_mfma_f32_16x16x32_bf16 v[56:59], a[120:123], v[104:107], v[56:59]
    ds_read_b64_tr_b16 v[120:121], v168 offset:45056
    v_add_f32_dpp v231, v231, v231 row_ror:4 row_mask:0xf bank_mask:0xf
    v_mfma_f32_16x16x32_bf16 v[60:63], a[124:127], v[104:107], v[60:63]
    ds_read_b64_tr_b16 v[122:123], v168 offset:47104
    v_add_f32_dpp v230, v230, v230 row_ror:2 row_mask:0xf bank_mask:0xf
    v_mfma_f32_16x16x32_bf16 v[64:67], a[128:131], v[104:107], v[64:67]
    ds_read_b64_tr_b16 v[124:125], v169 offset:45056
    v_add_f32_dpp v231, v231, v231 row_ror:2 row_mask:0xf bank_mask:0xf
    v_mfma_f32_16x16x32_bf16 v[68:71], a[120:123], v[108:111], v[68:71]
    buffer_load_dword v240, v219, s[36:39], s17 offen sc1
    v_mfma_f32_16x16x32_bf16 v[72:75], a[124:127], v[108:111], v[72:75]
    ds_read_b64_tr_b16 v[126:127], v169 offset:47104
    v_add_f32_dpp v230, v230, v230 row_ror:1 row_mask:0xf bank_mask:0xf
    v_mfma_f32_16x16x32_bf16 v[76:79], a[128:131], v[108:111], v[76:79]
    ds_read_b64_tr_b16 v[128:129], v170 offset:45056
    v_add_f32_dpp v231, v231, v231 row_ror:1 row_mask:0xf bank_mask:0xf
    s_mov_b32 exec_lo, 0x00010001
    s_mov_b32 exec_hi, 0x00010001
    ds_write_b64 v2, v[230:231]
    s_mov_b64 exec, -1
    v_lshlrev_b32 v2, 2, v1
    s_waitcnt lgkmcnt(10)
    v_mfma_f32_16x16x32_bf16 v[80:83], a[120:123], v[112:115], v[80:83]
    s_waitcnt lgkmcnt(6)
    s_barrier
    ds_read_b64_tr_b16 v[130:131], v170 offset:47104
    v_mfma_f32_16x16x32_bf16 v[84:87], a[124:127], v[112:115], v[84:87]
    ds_read_b64_tr_b16 a[204:205], v203 offset:24832
    buffer_load_dwordx4 a[252:255], v248, s[36:39], s62 offen offset:3072 sc1
    v_mfma_f32_16x16x32_bf16 v[88:91], a[128:131], v[112:115], v[88:91]
    ds_read_b64_tr_b16 v[132:133], v171 offset:45056
    ds_read_b64_tr_b16 a[206:207], v203 offset:26368
    v_mfma_f32_16x16x32_bf16 v[92:95], a[120:123], v[116:119], v[92:95]
    s_waitcnt lgkmcnt(3)
    ds_read_b64_tr_b16 v[134:135], v171 offset:47104
    v_and_b32 v2, 12, v2
    v_mfma_f32_16x16x32_bf16 v[96:99], a[124:127], v[116:119], v[96:99]
    s_add_u32 s62, s62, 4096
    ds_read_b64_tr_b16 a[208:209], v203 offset:31056
    v_add_u32 v2, 0, v2
    v_mfma_f32_16x16x32_bf16 v[100:103], a[128:131], v[116:119], v[100:103]
    s_waitcnt lgkmcnt(0)
    s_barrier
    ds_read_b64_tr_b16 a[210:211], v203 offset:32592
    buffer_load_dwordx4 v[136:139], v248, s[36:39], s62 offen offset:0 sc1
    v_mfma_f32_16x16x32_bf16 v[56:59], a[132:135], v[120:123], v[56:59]
    ds_read_b64_tr_b16 v[104:105], v168 offset:49152
    ds_read_b64_tr_b16 a[212:213], v204 offset:24832
    ds_read2_b32 v[230:231], v2 offset0:0 offset1:4
    v_mfma_f32_16x16x32_bf16 v[60:63], a[136:139], v[120:123], v[60:63]
    ds_read_b64_tr_b16 v[106:107], v168 offset:51200
    ds_read2_b32 v[232:233], v2 offset0:8 offset1:12
    v_mfma_f32_16x16x32_bf16 v[64:67], a[140:143], v[120:123], v[64:67]
    ds_read_b64_tr_b16 v[108:109], v169 offset:49152
    ds_read2_b32 v[234:235], v2 offset0:16 offset1:20
    v_mfma_f32_16x16x32_bf16 v[68:71], a[132:135], v[124:127], v[68:71]
    ds_read_b64_tr_b16 a[214:215], v204 offset:26368
    buffer_load_dwordx4 v[140:143], v248, s[36:39], s62 offen offset:1024 sc1
    v_mfma_f32_16x16x32_bf16 v[72:75], a[136:139], v[124:127], v[72:75]
    ds_read_b64_tr_b16 v[110:111], v169 offset:51200
    ds_read2_b32 v[236:237], v2 offset0:24 offset1:28
    v_mfma_f32_16x16x32_bf16 v[76:79], a[140:143], v[124:127], v[76:79]
    ds_read_b64_tr_b16 v[112:113], v170 offset:49152
    v_mov_b32 v225, s48
    v_mfma_f32_16x16x32_bf16 v[80:83], a[132:135], v[128:131], v[80:83]
    ds_read_b64_tr_b16 v[114:115], v170 offset:51200
    v_mov_b32 v227, s48
    v_mfma_f32_16x16x32_bf16 v[84:87], a[136:139], v[128:131], v[84:87]
    buffer_load_dwordx4 v[144:147], v248, s[36:39], s62 offen offset:2048 sc1
    v_mfma_f32_16x16x32_bf16 v[88:91], a[140:143], v[128:131], v[88:91]
    ds_read_b64_tr_b16 v[116:117], v171 offset:49152
    s_waitcnt lgkmcnt(8)
    v_add_f32 v230, v230, v232
    v_mfma_f32_16x16x32_bf16 v[92:95], a[132:135], v[132:135], v[92:95]
    s_waitcnt lgkmcnt(3)
    ds_read_b64_tr_b16 v[118:119], v171 offset:51200
    v_add_f32 v231, v231, v233
    v_mfma_f32_16x16x32_bf16 v[96:99], a[136:139], v[132:135], v[96:99]
    v_add_f32 v234, v234, v236
    v_add_f32 v235, v235, v237
    v_mfma_f32_16x16x32_bf16 v[100:103], a[140:143], v[132:135], v[100:103]
    buffer_load_dwordx4 v[148:151], v248, s[36:39], s62 offen offset:3072 sc1
    v_mfma_f32_16x16x32_bf16 v[56:59], a[144:147], v[104:107], v[56:59]
    s_waitcnt vmcnt(12)
    s_barrier
    ds_read_b64_tr_b16 v[120:121], v168 offset:53248
    v_add_f32 v230, v230, v234
    v_mfma_f32_16x16x32_bf16 v[60:63], a[148:151], v[104:107], v[60:63]
    ds_read_b64_tr_b16 v[122:123], v168 offset:55296
    ds_read_b64_tr_b16 a[216:217], v203 offset:37248
    v_mfma_f32_16x16x32_bf16 v[64:67], a[152:155], v[104:107], v[64:67]
    s_add_u32 s62, s62, 4096
    ds_read_b64_tr_b16 v[124:125], v169 offset:53248
    v_add_f32 v231, v231, v235
    v_mul_f32 v230, 0x3acccccd, v230
    v_mul_f32 v234, v230, v230
    v_mfma_f32_16x16x32_bf16 v[68:71], a[144:147], v[108:111], v[68:71]
    ds_read_b64_tr_b16 a[218:219], v203 offset:38784
    buffer_load_dwordx4 v[152:155], v248, s[36:39], s62 offen offset:0 sc1
    v_mfma_f32_16x16x32_bf16 v[72:75], a[148:151], v[108:111], v[72:75]
    ds_read_b64_tr_b16 v[126:127], v169 offset:55296
    ds_read_b64_tr_b16 a[220:221], v203 offset:43472
    v_mfma_f32_16x16x32_bf16 v[76:79], a[152:155], v[108:111], v[76:79]
    s_waitcnt lgkmcnt(9)
    ds_read_b64_tr_b16 v[128:129], v170 offset:53248
    ds_read_b64_tr_b16 a[222:223], v203 offset:45008
    v_mfma_f32_16x16x32_bf16 v[80:83], a[144:147], v[112:115], v[80:83]
    ds_read_b64_tr_b16 v[130:131], v170 offset:55296
    v_mov_b32 v224, 0x3acccccd
    v_fma_f32 v231, v231, v224, -v234
    v_max_f32 v231, 0, v231
    v_mfma_f32_16x16x32_bf16 v[84:87], a[148:151], v[112:115], v[84:87]
    ds_read_b64_tr_b16 a[224:225], v204 offset:37248
    buffer_load_dwordx4 v[156:159], v248, s[36:39], s62 offen offset:1024 sc1
    v_mfma_f32_16x16x32_bf16 v[88:91], a[152:155], v[112:115], v[88:91]
    s_waitcnt lgkmcnt(11)
    ds_read_b64_tr_b16 v[132:133], v171 offset:53248
    v_min_u32 v247, 23, v1
    v_mfma_f32_16x16x32_bf16 v[92:95], a[144:147], v[116:119], v[92:95]
    s_waitcnt lgkmcnt(3)
    ds_read_b64_tr_b16 v[134:135], v171 offset:55296
    v_lshlrev_b32 v247, 4, v247
    v_mfma_f32_16x16x32_bf16 v[96:99], a[148:151], v[116:119], v[96:99]
    ds_read_b64_tr_b16 a[226:227], v204 offset:38784
    v_add_f32 v231, 0x3727c5ac, v231
    v_rsq_f32 v224, v231
    v_mfma_f32_16x16x32_bf16 v[100:103], a[152:155], v[116:119], v[100:103]
    buffer_load_dwordx4 v[160:163], v248, s[36:39], s62 offen offset:2048 sc1
    v_mfma_f32_16x16x32_bf16 v[56:59], a[156:159], v[120:123], v[56:59]
    ds_read_b64_tr_b16 v[104:105], v168 offset:57344
    v_mul_f32_e64 v226, -v230, v224
    v_mfma_f32_16x16x32_bf16 v[60:63], a[160:163], v[120:123], v[60:63]
    ds_read_b64_tr_b16 v[106:107], v168 offset:59392
    s_mov_b64 exec, 0xf
    buffer_store_dwordx4 v[224:227], v248, s[36:39], s7 offen sc1
    s_mov_b64 exec, -1
    v_mfma_f32_16x16x32_bf16 v[64:67], a[164:167], v[120:123], v[64:67]
    ds_read_b64_tr_b16 v[108:109], v169 offset:57344
    v_mfma_f32_16x16x32_bf16 v[68:71], a[156:159], v[124:127], v[68:71]
    buffer_load_dwordx4 v[164:167], v248, s[36:39], s62 offen offset:3072 sc1
    v_mfma_f32_16x16x32_bf16 v[72:75], a[160:163], v[124:127], v[72:75]
    ds_read_b64_tr_b16 v[110:111], v169 offset:59392
    s_waitcnt vmcnt(9)
    v_cmp_ne_u32 vcc, s48, v240
    s_cbranch_vccnz L_chk26_slow
L_chk26_back:
    v_mfma_f32_16x16x32_bf16 v[76:79], a[164:167], v[124:127], v[76:79]
    s_waitcnt lgkmcnt(8)
    ds_read_b64_tr_b16 v[112:113], v170 offset:57344
    v_mfma_f32_16x16x32_bf16 v[80:83], a[156:159], v[128:131], v[80:83]
    s_waitcnt lgkmcnt(5)
    s_barrier
    s_add_u32 m0, s63, 81920
    ds_read_b64_tr_b16 v[114:115], v170 offset:59392
    v_mfma_f32_16x16x32_bf16 v[84:87], a[160:163], v[128:131], v[84:87]
    ds_read_b64_tr_b16 a[228:229], v203 offset:49664
    buffer_load_dwordx4 v172, s[36:39], s10 offen sc1 lds
    v_mfma_f32_16x16x32_bf16 v[88:91], a[164:167], v[128:131], v[88:91]
    ds_read_b64_tr_b16 v[116:117], v171 offset:57344
    ds_read_b64_tr_b16 a[230:231], v203 offset:51200
    v_mfma_f32_16x16x32_bf16 v[92:95], a[156:159], v[132:135], v[92:95]
    s_waitcnt lgkmcnt(3)
    s_add_u32 m0, s63, 5120
    ds_read_b64_tr_b16 v[118:119], v171 offset:59392
    v_mfma_f32_16x16x32_bf16 v[96:99], a[160:163], v[132:135], v[96:99]
    buffer_load_dwordx4 v247, s[36:39], s9 offen sc1 lds
    v_mfma_f32_16x16x32_bf16 v[100:103], a[164:167], v[132:135], v[100:103]
    s_add_u32 m0, s63, 86016
    ds_read_b64_tr_b16 a[232:233], v203 offset:55888
    v_mfma_f32_16x16x32_bf16 v[56:59], a[168:171], v[104:107], v[56:59]
    ds_read_b64_tr_b16 v[120:121], v168 offset:61440
    ds_read_b64_tr_b16 a[234:235], v203 offset:57424
    buffer_load_dwordx4 v172, s[36:39], s11 offen sc1 lds
    v_mfma_f32_16x16x32_bf16 v[60:63], a[172:175], v[104:107], v[60:63]
    ds_read_b64_tr_b16 v[122:123], v168 offset:63488
    v_add_u32 v168, 65536, v168
    v_mfma_f32_16x16x32_bf16 v[64:67], a[176:179], v[104:107], v[64:67]
    s_add_u32 m0, s63, 90112
    ds_read_b64_tr_b16 v[124:125], v169 offset:61440
    ds_read_b64_tr_b16 a[236:237], v204 offset:49664
    v_mfma_f32_16x16x32_bf16 v[68:71], a[168:171], v[108:111], v[68:71]
    ds_read_b64_tr_b16 a[238:239], v204 offset:51200
    buffer_load_dwordx4 v172, s[36:39], s12 offen sc1 lds
    v_mfma_f32_16x16x32_bf16 v[72:75], a[172:175], v[108:111], v[72:75]
    ds_read_b64_tr_b16 v[126:127], v169 offset:63488
    v_add_u32 v169, 65536, v169
    v_mfma_f32_16x16x32_bf16 v[76:79], a[176:179], v[108:111], v[76:79]
    ds_read_b64_tr_b16 v[128:129], v170 offset:61440
    v_mfma_f32_16x16x32_bf16 v[80:83], a[168:171], v[112:115], v[80:83]
    s_add_u32 m0, s63, 94208
    ds_read_b64_tr_b16 v[130:131], v170 offset:63488
    v_add_u32 v170, 65536, v170
    v_mfma_f32_16x16x32_bf16 v[84:87], a[172:175], v[112:115], v[84:87]
    buffer_load_dwordx4 v172, s[36:39], s13 offen sc1 lds
    v_mfma_f32_16x16x32_bf16 v[88:91], a[176:179], v[112:115], v[88:91]
    s_waitcnt lgkmcnt(10)
    ds_read_b64_tr_b16 v[132:133], v171 offset:61440
    v_mfma_f32_16x16x32_bf16 v[92:95], a[168:171], v[116:119], v[92:95]
    s_waitcnt lgkmcnt(3)
    ds_read_b64_tr_b16 v[134:135], v171 offset:63488
    v_add_u32 v171, 65536, v171
    v_mfma_f32_16x16x32_bf16 v[96:99], a[172:175], v[116:119], v[96:99]
    s_add_u32 m0, s63, 98304
    v_mfma_f32_16x16x32_bf16 v[100:103], a[176:179], v[116:119], v[100:103]
    buffer_load_dwordx4 v172, s[36:39], s14 offen sc1 lds
    v_mfma_f32_16x16x32_bf16 v[56:59], a[180:183], v[120:123], v[56:59]
    s_barrier
    ds_read_b64_tr_b16 v[104:105], v168 offset:0
    v_mfma_f32_16x16x32_bf16 v[60:63], a[184:187], v[120:123], v[60:63]
    ds_read_b64_tr_b16 v[106:107], v168 offset:2048
    v_mfma_f32_16x16x32_bf16 v[64:67], a[188:191], v[120:123], v[64:67]
    s_add_u32 m0, s63, 102400
    ds_read_b64_tr_b16 v[108:109], v169 offset:0
    v_mfma_f32_16x16x32_bf16 v[68:71], a[180:183], v[124:127], v[68:71]
    buffer_load_dwordx4 v172, s[36:39], s15 offen sc1 lds
    v_mfma_f32_16x16x32_bf16 v[72:75], a[184:187], v[124:127], v[72:75]
    ds_read_b64_tr_b16 v[110:111], v169 offset:2048
    v_mfma_f32_16x16x32_bf16 v[76:79], a[188:191], v[124:127], v[76:79]
    s_waitcnt lgkmcnt(6)
    ds_read_b64_tr_b16 v[112:113], v170 offset:0
    v_mfma_f32_16x16x32_bf16 v[80:83], a[180:183], v[128:131], v[80:83]
    s_add_u32 m0, s63, 106496
    ds_read_b64_tr_b16 v[114:115], v170 offset:2048
    v_mfma_f32_16x16x32_bf16 v[84:87], a[184:187], v[128:131], v[84:87]
    buffer_load_dwordx4 v172, s[36:39], s18 offen sc1 lds
    v_mfma_f32_16x16x32_bf16 v[88:91], a[188:191], v[128:131], v[88:91]
    s_waitcnt lgkmcnt(6)
    ds_read_b64_tr_b16 v[116:117], v171 offset:0
    v_mfma_f32_16x16x32_bf16 v[92:95], a[180:183], v[132:135], v[92:95]
    s_waitcnt lgkmcnt(3)
    ds_read_b64_tr_b16 v[118:119], v171 offset:2048
    v_mfma_f32_16x16x32_bf16 v[96:99], a[184:187], v[132:135], v[96:99]
    s_add_u32 m0, s63, 110592
    v_mfma_f32_16x16x32_bf16 v[100:103], a[188:191], v[132:135], v[100:103]
    buffer_load_dwordx4 v172, s[36:39], s19 offen sc1 lds
    v_mfma_f32_16x16x32_bf16 v[56:59], a[192:195], v[104:107], v[56:59]
    ds_read_b64_tr_b16 v[120:121], v168 offset:4096
    v_mfma_f32_16x16x32_bf16 v[60:63], a[196:199], v[104:107], v[60:63]
    ds_read_b64_tr_b16 v[122:123], v168 offset:6144
    v_mfma_f32_16x16x32_bf16 v[64:67], a[200:203], v[104:107], v[64:67]
    s_add_u32 m0, s63, 114688
    ds_read_b64_tr_b16 v[124:125], v169 offset:4096
    v_mfma_f32_16x16x32_bf16 v[68:71], a[192:195], v[108:111], v[68:71]
    buffer_load_dwordx4 v172, s[36:39], s20 offen sc1 lds
    v_mfma_f32_16x16x32_bf16 v[72:75], a[196:199], v[108:111], v[72:75]
    ds_read_b64_tr_b16 v[126:127], v169 offset:6144
    v_mfma_f32_16x16x32_bf16 v[76:79], a[200:203], v[108:111], v[76:79]
    s_waitcnt lgkmcnt(6)
    ds_read_b64_tr_b16 v[128:129], v170 offset:4096
    v_mfma_f32_16x16x32_bf16 v[80:83], a[192:195], v[112:115], v[80:83]
    s_add_u32 m0, s63, 118784
    ds_read_b64_tr_b16 v[130:131], v170 offset:6144
    v_mfma_f32_16x16x32_bf16 v[84:87], a[196:199], v[112:115], v[84:87]
    buffer_load_dwordx4 v172, s[36:39], s21 offen sc1 lds
    v_mfma_f32_16x16x32_bf16 v[88:91], a[200:203], v[112:115], v[88:91]
    s_waitcnt lgkmcnt(6)
    ds_read_b64_tr_b16 v[132:133], v171 offset:4096
    v_mfma_f32_16x16x32_bf16 v[92:95], a[192:195], v[116:119], v[92:95]
    s_waitcnt lgkmcnt(3)
    ds_read_b64_tr_b16 v[134:135], v171 offset:6144
    v_mfma_f32_16x16x32_bf16 v[96:99], a[196:199], v[116:119], v[96:99]
    s_add_u32 m0, s63, 122880
    v_mfma_f32_16x16x32_bf16 v[100:103], a[200:203], v[116:119], v[100:103]
    buffer_load_dwordx4 v172, s[36:39], s22 offen sc1 lds
    v_mfma_f32_16x16x32_bf16 v[56:59], a[204:207], v[120:123], v[56:59]
    ds_read_b64_tr_b16 v[104:105], v168 offset:8192
    v_mfma_f32_16x16x32_bf16 v[60:63], a[208:211], v[120:123], v[60:63]
    ds_read_b64_tr_b16 v[106:107], v168 offset:10240
    v_mfma_f32_16x16x32_bf16 v[64:67], a[212:215], v[120:123], v[64:67]
    s_add_u32 m0, s63, 126976
    ds_read_b64_tr_b16 v[108:109], v169 offset:8192
    v_mfma_f32_16x16x32_bf16 v[68:71], a[204:207], v[124:127], v[68:71]
    buffer_load_dwordx4 v172, s[36:39], s23 offen sc1 lds
    v_mfma_f32_16x16x32_bf16 v[72:75], a[208:211], v[124:127], v[72:75]
    ds_read_b64_tr_b16 v[110:111], v169 offset:10240
    v_mfma_f32_16x16x32_bf16 v[76:79], a[212:215], v[124:127], v[76:79]
    s_waitcnt lgkmcnt(6)
    ds_read_b64_tr_b16 v[112:113], v170 offset:8192
    v_mfma_f32_16x16x32_bf16 v[80:83], a[204:207], v[128:131], v[80:83]
    s_add_u32 m0, s63, 131072
    ds_read_b64_tr_b16 v[114:115], v170 offset:10240
    v_mfma_f32_16x16x32_bf16 v[84:87], a[208:211], v[128:131], v[84:87]
    buffer_load_dwordx4 v172, s[36:39], s24 offen sc1 lds
    v_mfma_f32_16x16x32_bf16 v[88:91], a[212:215], v[128:131], v[88:91]
    s_waitcnt lgkmcnt(6)
    ds_read_b64_tr_b16 v[116:117], v171 offset:8192
    v_mfma_f32_16x16x32_bf16 v[92:95], a[204:207], v[132:135], v[92:95]
    s_waitcnt lgkmcnt(3)
    ds_read_b64_tr_b16 v[118:119], v171 offset:10240
    v_mfma_f32_16x16x32_bf16 v[96:99], a[208:211], v[132:135], v[96:99]
    s_add_u32 m0, s63, 135168
    v_mfma_f32_16x16x32_bf16 v[100:103], a[212:215], v[132:135], v[100:103]
    buffer_load_dwordx4 v172, s[36:39], s25 offen sc1 lds
    v_mfma_f32_16x16x32_bf16 v[56:59], a[216:219], v[104:107], v[56:59]
    ds_read_b64_tr_b16 v[120:121], v168 offset:12288
    v_mfma_f32_16x16x32_bf16 v[60:63], a[220:223], v[104:107], v[60:63]
    ds_read_b64_tr_b16 v[122:123], v168 offset:14336
    v_add_u32 v168, 16384, v168
    v_mfma_f32_16x16x32_bf16 v[64:67], a[224:227], v[104:107], v[64:67]
    s_add_u32 m0, s63, 139264
    ds_read_b64_tr_b16 v[124:125], v169 offset:12288
    v_and_b32 v247, 48, v1
    v_mfma_f32_16x16x32_bf16 v[68:71], a[216:219], v[108:111], v[68:71]
    v_add_u32 v247, s63, v247
    buffer_load_dwordx4 v172, s[36:39], s26 offen sc1 lds
    v_mfma_f32_16x16x32_bf16 v[72:75], a[220:223], v[108:111], v[72:75]
    s_waitcnt vmcnt(14)
    ds_read_b64_tr_b16 v[126:127], v169 offset:14336
    v_add_u32 v169, 16384, v169
    v_mfma_f32_16x16x32_bf16 v[76:79], a[224:227], v[108:111], v[76:79]
    s_waitcnt lgkmcnt(6)
    ds_read_b64_tr_b16 v[128:129], v170 offset:12288
    ds_read_b128 v[176:179], v247 offset:5120
    v_mfma_f32_16x16x32_bf16 v[80:83], a[216:219], v[112:115], v[80:83]
    s_add_u32 m0, s63, 143360
    ds_read_b64_tr_b16 v[130:131], v170 offset:14336
    v_add_u32 v170, 16384, v170
    v_mfma_f32_16x16x32_bf16 v[84:87], a[220:223], v[112:115], v[84:87]
    ds_read_b128 v[180:183], v247 offset:5184
    buffer_load_dwordx4 v172, s[36:39], s27 offen sc1 lds
    v_mfma_f32_16x16x32_bf16 v[88:91], a[224:227], v[112:115], v[88:91]
    s_waitcnt lgkmcnt(8)
    ds_read_b64_tr_b16 v[132:133], v171 offset:12288
    ds_read_b128 v[184:187], v247 offset:5248
    v_mfma_f32_16x16x32_bf16 v[92:95], a[216:219], v[116:119], v[92:95]
    s_waitcnt lgkmcnt(3)
    ds_read_b64_tr_b16 v[134:135], v171 offset:14336
    v_add_u32 v171, 16384, v171
    v_mfma_f32_16x16x32_bf16 v[96:99], a[220:223], v[116:119], v[96:99]
    s_add_u32 m0, s63, 147456
    ds_read_b128 v[188:191], v247 offset:5312
    v_mfma_f32_16x16x32_bf16 v[100:103], a[224:227], v[116:119], v[100:103]
    ds_read_b128 v[192:195], v247 offset:5376
    buffer_load_dwordx4 v172, s[36:39], s44 offen sc1 lds
    v_mfma_f32_16x16x32_bf16 v[56:59], a[228:231], v[120:123], v[56:59]
    s_waitcnt vmcnt(15)
    s_barrier
    ds_read_b64_tr_b16 v[104:105], v168 offset:0
    v_mfma_f32_16x16x32_bf16 v[60:63], a[232:235], v[120:123], v[60:63]
    ds_read_b64_tr_b16 v[106:107], v168 offset:2048
    ds_read_b128 v[196:199], v247 offset:5440
    v_mfma_f32_16x16x32_bf16 v[64:67], a[236:239], v[120:123], v[64:67]
    s_add_u32 m0, s63, 1024
    ds_read_b64_tr_b16 v[108:109], v169 offset:0
    v_mfma_f32_16x16x32_bf16 v[68:71], a[228:231], v[124:127], v[68:71]
    buffer_load_dwordx4 v248, s[36:39], s6 offen sc1 lds
    v_mfma_f32_16x16x32_bf16 v[72:75], a[232:235], v[124:127], v[72:75]
    ds_read_b64_tr_b16 v[110:111], v169 offset:2048
    v_mfma_f32_16x16x32_bf16 v[76:79], a[236:239], v[124:127], v[76:79]
    ds_read_b64_tr_b16 v[112:113], v170 offset:0
    v_mfma_f32_16x16x32_bf16 v[80:83], a[228:231], v[128:131], v[80:83]
    s_add_u32 m0, s63, 151552
    ds_read_b64_tr_b16 v[114:115], v170 offset:2048
    v_mfma_f32_16x16x32_bf16 v[84:87], a[232:235], v[128:131], v[84:87]
    buffer_load_dwordx4 v172, s[36:39], s45 offen sc1 lds
    v_mfma_f32_16x16x32_bf16 v[88:91], a[236:239], v[128:131], v[88:91]
    s_waitcnt lgkmcnt(9)
    ds_read_b64_tr_b16 v[116:117], v171 offset:0
    v_mfma_f32_16x16x32_bf16 v[92:95], a[228:231], v[132:135], v[92:95]
    s_waitcnt lgkmcnt(3)
    ds_read_b64_tr_b16 v[118:119], v171 offset:2048
    v_mfma_f32_16x16x32_bf16 v[96:99], a[232:235], v[132:135], v[96:99]
    v_mfma_f32_16x16x32_bf16 v[100:103], a[236:239], v[132:135], v[100:103]
    v_mfma_f32_16x16x32_bf16 v[8:11], a[0:3], v[104:107], 0
    ds_read_b64_tr_b16 v[120:121], v168 offset:4096
    v_add_u32 v216, 81920, v216
    v_mfma_f32_16x16x32_bf16 v[12:15], a[4:7], v[104:107], 0
    ds_read_b64_tr_b16 v[122:123], v168 offset:6144
    v_add_u32 v217, 81920, v217
    v_mfma_f32_16x16x32_bf16 v[16:19], a[8:11], v[104:107], 0
    s_add_u32 m0, s63, 155648
    ds_read_b64_tr_b16 v[124:125], v169 offset:4096
    v_add_u32 v218, 81920, v218
    v_mfma_f32_16x16x32_bf16 v[20:23], a[0:3], v[108:111], 0
    buffer_load_dwordx4 v172, s[36:39], s46 offen sc1 lds
    v_mfma_f32_16x16x32_bf16 v[24:27], a[4:7], v[108:111], 0
    ds_read_b64_tr_b16 v[126:127], v169 offset:6144
    v_mfma_f32_16x16x32_bf16 v[28:31], a[8:11], v[108:111], 0
    s_waitcnt lgkmcnt(6)
    ds_read_b64_tr_b16 v[128:129], v170 offset:4096
    v_mfma_f32_16x16x32_bf16 v[32:35], a[0:3], v[112:115], 0
    s_add_u32 m0, s63, 159744
    ds_read_b64_tr_b16 v[130:131], v170 offset:6144
    v_mfma_f32_16x16x32_bf16 v[36:39], a[4:7], v[112:115], 0
    buffer_load_dwordx4 v172, s[36:39], s47 offen sc1 lds
    v_mfma_f32_16x16x32_bf16 v[40:43], a[8:11], v[112:115], 0
    s_waitcnt lgkmcnt(6)
    ds_read_b64_tr_b16 v[132:133], v171 offset:4096
    v_mfma_f32_16x16x32_bf16 v[44:47], a[0:3], v[116:119], 0
    s_waitcnt lgkmcnt(3)
    ds_read_b64_tr_b16 v[134:135], v171 offset:6144
    v_mfma_f32_16x16x32_bf16 v[48:51], a[4:7], v[116:119], 0
    v_mfma_f32_16x16x32_bf16 v[52:55], a[8:11], v[116:119], 0
    v_mfma_f32_16x16x32_bf16 v[8:11], a[12:15], v[120:123], v[8:11]
    s_waitcnt vmcnt(16)
    s_barrier
    ds_read_b64_tr_b16 v[104:105], v168 offset:8192
    v_mfma_f32_16x16x32_bf16 v[12:15], a[16:19], v[120:123], v[12:15]
    ds_read_b64_tr_b16 v[106:107], v168 offset:10240
    v_mfma_f32_16x16x32_bf16 v[16:19], a[20:23], v[120:123], v[16:19]
    s_add_u32 s62, s62, 4096
    ds_read_b64_tr_b16 v[108:109], v169 offset:8192
    v_mfma_f32_16x16x32_bf16 v[20:23], a[12:15], v[124:127], v[20:23]
    buffer_load_dwordx4 a[0:3], v248, s[36:39], s62 offen offset:0 sc1
    v_mfma_f32_16x16x32_bf16 v[24:27], a[16:19], v[124:127], v[24:27]
    ds_read_b64_tr_b16 v[110:111], v169 offset:10240
    v_mfma_f32_16x16x32_bf16 v[28:31], a[20:23], v[124:127], v[28:31]
    s_waitcnt lgkmcnt(6)
    ds_read_b64_tr_b16 v[112:113], v170 offset:8192
    v_mfma_f32_16x16x32_bf16 v[32:35], a[12:15], v[128:131], v[32:35]
    ds_read_b64_tr_b16 v[114:115], v170 offset:10240
    v_mfma_f32_16x16x32_bf16 v[36:39], a[16:19], v[128:131], v[36:39]
    buffer_load_dwordx4 a[4:7], v248, s[36:39], s62 offen offset:1024 sc1
    v_mfma_f32_16x16x32_bf16 v[40:43], a[20:23], v[128:131], v[40:43]
    s_waitcnt lgkmcnt(6)
    ds_read_b64_tr_b16 v[116:117], v171 offset:8192
    v_mfma_f32_16x16x32_bf16 v[44:47], a[12:15], v[132:135], v[44:47]
    s_waitcnt lgkmcnt(3)
    ds_read_b64_tr_b16 v[118:119], v171 offset:10240
    v_mfma_f32_16x16x32_bf16 v[48:51], a[16:19], v[132:135], v[48:51]
    v_mfma_f32_16x16x32_bf16 v[52:55], a[20:23], v[132:135], v[52:55]
    buffer_load_dwordx4 a[8:11], v248, s[36:39], s62 offen offset:2048 sc1
    v_mfma_f32_16x16x32_bf16 v[8:11], a[24:27], v[104:107], v[8:11]
    ds_read_b64_tr_b16 v[120:121], v168 offset:12288
    v_mfma_f32_16x16x32_bf16 v[12:15], a[28:31], v[104:107], v[12:15]
    ds_read_b64_tr_b16 v[122:123], v168 offset:14336
    v_mfma_f32_16x16x32_bf16 v[16:19], a[32:35], v[104:107], v[16:19]
    ds_read_b64_tr_b16 v[124:125], v169 offset:12288
    v_mfma_f32_16x16x32_bf16 v[20:23], a[24:27], v[108:111], v[20:23]
    buffer_load_dwordx4 a[12:15], v248, s[36:39], s62 offen offset:3072 sc1
    v_mfma_f32_16x16x32_bf16 v[24:27], a[28:31], v[108:111], v[24:27]
    s_waitcnt vmcnt(7)
    ds_read_b64_tr_b16 v[126:127], v169 offset:14336
    ds_read_b128 v[200:203], v175 offset:1024
    v_mfma_f32_16x16x32_bf16 v[28:31], a[32:35], v[108:111], v[28:31]
    s_waitcnt lgkmcnt(7)
    ds_read_b64_tr_b16 v[128:129], v170 offset:12288
    v_mfma_f32_16x16x32_bf16 v[32:35], a[24:27], v[112:115], v[32:35]
    s_add_u32 s62, s62, 4096
    ds_read_b64_tr_b16 v[130:131], v170 offset:14336
    v_mfma_f32_16x16x32_bf16 v[36:39], a[28:31], v[112:115], v[36:39]
    ds_read_b128 v[204:207], v175 offset:1280
    buffer_load_dwordx4 a[16:19], v248, s[36:39], s62 offen offset:0 sc1
    v_mfma_f32_16x16x32_bf16 v[40:43], a[32:35], v[112:115], v[40:43]
    s_waitcnt lgkmcnt(8)
    ds_read_b64_tr_b16 v[132:133], v171 offset:12288
    ds_read_b128 v[208:211], v175 offset:1536
    v_mfma_f32_16x16x32_bf16 v[44:47], a[24:27], v[116:119], v[44:47]
    s_waitcnt lgkmcnt(3)
    ds_read_b64_tr_b16 v[134:135], v171 offset:14336
    ds_read_b128 v[212:215], v175 offset:1792
    v_mfma_f32_16x16x32_bf16 v[48:51], a[28:31], v[116:119], v[48:51]
    v_mfma_f32_16x16x32_bf16 v[52:55], a[32:35], v[116:119], v[52:55]
    buffer_load_dwordx4 a[20:23], v248, s[36:39], s62 offen offset:1024 sc1
    v_mfma_f32_16x16x32_bf16 v[8:11], a[36:39], v[120:123], v[8:11]
    ds_read_b64_tr_b16 v[104:105], v168 offset:16384
    v_xor_b32 v3, s48, v201
    v_mfma_f32_16x16x32_bf16 v[12:15], a[40:43], v[120:123], v[12:15]
    ds_read_b64_tr_b16 v[106:107], v168 offset:18432
    v_bitop3_b32 v3, v203, s48, v3 bitop3:0xbe
    v_mfma_f32_16x16x32_bf16 v[16:19], a[44:47], v[120:123], v[16:19]
    ds_read_b64_tr_b16 v[108:109], v169 offset:16384
    s_waitcnt lgkmcnt(7)
    v_bitop3_b32 v3, v205, s48, v3 bitop3:0xbe
    v_mfma_f32_16x16x32_bf16 v[20:23], a[36:39], v[124:127], v[20:23]
    v_bitop3_b32 v3, v207, s48, v3 bitop3:0xbe
    s_waitcnt lgkmcnt(5)
    v_bitop3_b32 v3, v209, s48, v3 bitop3:0xbe
    buffer_load_dwordx4 a[24:27], v248, s[36:39], s62 offen offset:2048 sc1
    v_mfma_f32_16x16x32_bf16 v[24:27], a[40:43], v[124:127], v[24:27]
    ds_read_b64_tr_b16 v[110:111], v169 offset:18432
    v_bitop3_b32 v3, v211, s48, v3 bitop3:0xbe
    v_mfma_f32_16x16x32_bf16 v[28:31], a[44:47], v[124:127], v[28:31]
    ds_read_b64_tr_b16 v[112:113], v170 offset:16384
    s_waitcnt lgkmcnt(5)
    v_bitop3_b32 v3, v213, s48, v3 bitop3:0xbe
    v_mfma_f32_16x16x32_bf16 v[32:35], a[36:39], v[128:131], v[32:35]
    ds_read_b64_tr_b16 v[114:115], v170 offset:18432
    v_bitop3_b32 v3, v215, s48, v3 bitop3:0xbe
    v_mfma_f32_16x16x32_bf16 v[36:39], a[40:43], v[128:131], v[36:39]
    v_cmp_ne_u32 vcc, 0, v3
    s_cbranch_vccnz L_stp0_slow
L_stp0_back:
    buffer_load_dwordx4 a[28:31], v248, s[36:39], s62 offen offset:3072 sc1
    v_mfma_f32_16x16x32_bf16 v[40:43], a[44:47], v[128:131], v[40:43]
    ds_read_b64_tr_b16 v[116:117], v171 offset:16384
    s_add_u32 s50, s8, 98304
    v_pk_fma_f32 v[238:239], v[176:177], v[202:203], v[188:189] op_sel_hi:[1,0,1]
    v_pk_fma_f32 v[240:241], v[178:179], v[202:203], v[190:191] op_sel_hi:[1,0,1]
    v_pk_fma_f32 v[56:57], v[56:57], v[200:201], v[238:239] op_sel_hi:[1,0,1]
    v_pk_fma_f32 v[58:59], v[58:59], v[200:201], v[240:241] op_sel_hi:[1,0,1]
    v_pk_fma_f32 v[242:243], v[180:181], v[202:203], v[192:193] op_sel_hi:[1,0,1]
    v_pk_fma_f32 v[244:245], v[182:183], v[202:203], v[194:195] op_sel_hi:[1,0,1]
    v_pk_fma_f32 v[60:61], v[60:61], v[200:201], v[242:243] op_sel_hi:[1,0,1]
    v_pk_fma_f32 v[62:63], v[62:63], v[200:201], v[244:245] op_sel_hi:[1,0,1]
    v_pk_mul_f32 v[56:57], v[56:57], v[60:61]
    v_pk_mul_f32 v[58:59], v[58:59], v[62:63]
    v_cvt_pk_bf16_f32 v60, v56, v57
    v_cvt_pk_bf16_f32 v61, v58, v59
    v_pk_fma_f32 v[242:243], v[176:177], v[206:207], v[188:189] op_sel_hi:[1,0,1]
    v_pk_fma_f32 v[244:245], v[178:179], v[206:207], v[190:191] op_sel_hi:[1,0,1]
    v_pk_fma_f32 v[68:69], v[68:69], v[204:205], v[242:243] op_sel_hi:[1,0,1]
    v_pk_fma_f32 v[70:71], v[70:71], v[204:205], v[244:245] op_sel_hi:[1,0,1]
    v_pk_fma_f32 v[238:239], v[180:181], v[206:207], v[192:193] op_sel_hi:[1,0,1]
    v_pk_fma_f32 v[240:241], v[182:183], v[206:207], v[194:195] op_sel_hi:[1,0,1]
    v_pk_fma_f32 v[72:73], v[72:73], v[204:205], v[238:239] op_sel_hi:[1,0,1]
    v_pk_fma_f32 v[74:75], v[74:75], v[204:205], v[240:241] op_sel_hi:[1,0,1]
    v_pk_mul_f32 v[68:69], v[68:69], v[72:73]
    v_pk_mul_f32 v[70:71], v[70:71], v[74:75]
    v_cvt_pk_bf16_f32 v62, v68, v69
    v_cvt_pk_bf16_f32 v63, v70, v71
    s_nop 0
    v_permlane16_swap_b32 v60, v62
    v_permlane16_swap_b32 v61, v63
    buffer_store_dwordx4 v[60:63], v173, s[36:39], s8 offen sc1
    v_pk_fma_f32 v[238:239], v[176:177], v[210:211], v[188:189] op_sel_hi:[1,0,1]
    v_pk_fma_f32 v[240:241], v[178:179], v[210:211], v[190:191] op_sel_hi:[1,0,1]
    v_pk_fma_f32 v[80:81], v[80:81], v[208:209], v[238:239] op_sel_hi:[1,0,1]
    v_pk_fma_f32 v[82:83], v[82:83], v[208:209], v[240:241] op_sel_hi:[1,0,1]
    v_pk_fma_f32 v[242:243], v[180:181], v[210:211], v[192:193] op_sel_hi:[1,0,1]
    v_pk_fma_f32 v[244:245], v[182:183], v[210:211], v[194:195] op_sel_hi:[1,0,1]
    v_pk_fma_f32 v[84:85], v[84:85], v[208:209], v[242:243] op_sel_hi:[1,0,1]
    v_pk_fma_f32 v[86:87], v[86:87], v[208:209], v[244:245] op_sel_hi:[1,0,1]
    v_pk_mul_f32 v[80:81], v[80:81], v[84:85]
    v_pk_mul_f32 v[82:83], v[82:83], v[86:87]
    v_cvt_pk_bf16_f32 v84, v80, v81
    v_cvt_pk_bf16_f32 v85, v82, v83
    v_pk_fma_f32 v[242:243], v[176:177], v[214:215], v[188:189] op_sel_hi:[1,0,1]
    v_pk_fma_f32 v[244:245], v[178:179], v[214:215], v[190:191] op_sel_hi:[1,0,1]
    v_pk_fma_f32 v[92:93], v[92:93], v[212:213], v[242:243] op_sel_hi:[1,0,1]
    v_pk_fma_f32 v[94:95], v[94:95], v[212:213], v[244:245] op_sel_hi:[1,0,1]
    v_pk_fma_f32 v[238:239], v[180:181], v[214:215], v[192:193] op_sel_hi:[1,0,1]
    v_pk_fma_f32 v[240:241], v[182:183], v[214:215], v[194:195] op_sel_hi:[1,0,1]
    v_pk_fma_f32 v[96:97], v[96:97], v[212:213], v[238:239] op_sel_hi:[1,0,1]
    v_pk_fma_f32 v[98:99], v[98:99], v[212:213], v[240:241] op_sel_hi:[1,0,1]
    v_pk_mul_f32 v[92:93], v[92:93], v[96:97]
    v_pk_mul_f32 v[94:95], v[94:95], v[98:99]
    v_cvt_pk_bf16_f32 v86, v92, v93
    v_cvt_pk_bf16_f32 v87, v94, v95
    s_nop 0
    v_permlane16_swap_b32 v84, v86
    v_permlane16_swap_b32 v85, v87
    buffer_store_dwordx4 v[84:87], v173, s[36:39], s50 offen sc1
    v_pk_fma_f32 v[238:239], v[184:185], v[202:203], v[196:197] op_sel_hi:[1,0,1]
    v_pk_fma_f32 v[240:241], v[186:187], v[202:203], v[198:199] op_sel_hi:[1,0,1]
    v_pk_fma_f32 v[64:65], v[64:65], v[200:201], v[238:239] op_sel_hi:[1,0,1]
    v_pk_fma_f32 v[66:67], v[66:67], v[200:201], v[240:241] op_sel_hi:[1,0,1]
    v_pk_fma_f32 v[242:243], v[184:185], v[206:207], v[196:197] op_sel_hi:[1,0,1]
    v_pk_fma_f32 v[244:245], v[186:187], v[206:207], v[198:199] op_sel_hi:[1,0,1]
    v_pk_fma_f32 v[76:77], v[76:77], v[204:205], v[242:243] op_sel_hi:[1,0,1]
    v_pk_fma_f32 v[78:79], v[78:79], v[204:205], v[244:245] op_sel_hi:[1,0,1]
    s_nop 0
    v_permlane32_swap_b32 v64, v76
    v_permlane32_swap_b32 v65, v77
    v_permlane32_swap_b32 v66, v78
    v_permlane32_swap_b32 v67, v79
    v_pk_mul_f32 v[64:65], v[64:65], v[76:77]
    v_pk_mul_f32 v[66:67], v[66:67], v[78:79]
    v_cvt_pk_bf16_f32 v56, v64, v65
    v_cvt_pk_bf16_f32 v57, v66, v67
    v_pk_fma_f32 v[238:239], v[184:185], v[210:211], v[196:197] op_sel_hi:[1,0,1]
    v_pk_fma_f32 v[240:241], v[186:187], v[210:211], v[198:199] op_sel_hi:[1,0,1]
    v_pk_fma_f32 v[88:89], v[88:89], v[208:209], v[238:239] op_sel_hi:[1,0,1]
    v_pk_fma_f32 v[90:91], v[90:91], v[208:209], v[240:241] op_sel_hi:[1,0,1]
    v_pk_fma_f32 v[242:243], v[184:185], v[214:215], v[196:197] op_sel_hi:[1,0,1]
    v_pk_fma_f32 v[244:245], v[186:187], v[214:215], v[198:199] op_sel_hi:[1,0,1]
    v_pk_fma_f32 v[100:101], v[100:101], v[212:213], v[242:243] op_sel_hi:[1,0,1]
    v_pk_fma_f32 v[102:103], v[102:103], v[212:213], v[244:245] op_sel_hi:[1,0,1]
    s_nop 0
    v_permlane32_swap_b32 v88, v100
    v_permlane32_swap_b32 v89, v101
    v_permlane32_swap_b32 v90, v102
    v_permlane32_swap_b32 v91, v103
    v_pk_mul_f32 v[88:89], v[88:89], v[100:101]
    v_pk_mul_f32 v[90:91], v[90:91], v[102:103]
    v_cvt_pk_bf16_f32 v58, v88, v89
    v_cvt_pk_bf16_f32 v59, v90, v91
    s_nop 0
    v_permlane16_swap_b32 v56, v58
    v_permlane16_swap_b32 v57, v59
    buffer_store_dwordx4 v[56:59], v174, s[36:39], s8 offen offset:512 sc1
    s_add_u32 s6, s6, 16384
    s_lshl_b32 s76, s72, 4
    s_add_u32 s76, s76, s73
    v_mfma_f32_16x16x32_bf16 v[44:47], a[36:39], v[132:135], v[44:47]
    s_waitcnt lgkmcnt(3)
    ds_read_b64_tr_b16 v[118:119], v171 offset:18432
    v_mfma_f32_16x16x32_bf16 v[48:51], a[40:43], v[132:135], v[48:51]
    s_add_u32 s62, s62, 4096
    v_mfma_f32_16x16x32_bf16 v[52:55], a[44:47], v[132:135], v[52:55]
    buffer_load_dwordx4 a[32:35], v248, s[36:39], s62 offen offset:0 sc1
    v_mfma_f32_16x16x32_bf16 v[8:11], a[48:51], v[104:107], v[8:11]
    s_waitcnt vmcnt(12)
    s_barrier
    ds_read_b64_tr_b16 v[120:121], v168 offset:20480
    v_mfma_f32_16x16x32_bf16 v[12:15], a[52:55], v[104:107], v[12:15]
    ds_read_b64_tr_b16 v[122:123], v168 offset:22528
    ds_read_b64 v[224:225], v216
    v_mfma_f32_16x16x32_bf16 v[16:19], a[56:59], v[104:107], v[16:19]
    ds_read_b64_tr_b16 v[124:125], v169 offset:20480
    ds_read_b64 v[226:227], v217
    v_mfma_f32_16x16x32_bf16 v[20:23], a[48:51], v[108:111], v[20:23]
    buffer_load_dwordx4 a[36:39], v248, s[36:39], s62 offen offset:1024 sc1
    v_mfma_f32_16x16x32_bf16 v[24:27], a[52:55], v[108:111], v[24:27]
    ds_read_b64_tr_b16 v[126:127], v169 offset:22528
    ds_read_b64 v[228:229], v218
    v_mfma_f32_16x16x32_bf16 v[28:31], a[56:59], v[108:111], v[28:31]
    s_waitcnt lgkmcnt(9)
    ds_read_b64_tr_b16 v[128:129], v170 offset:20480
    v_mfma_f32_16x16x32_bf16 v[32:35], a[48:51], v[112:115], v[32:35]
    ds_read_b64_tr_b16 v[130:131], v170 offset:22528
    v_mfma_f32_16x16x32_bf16 v[36:39], a[52:55], v[112:115], v[36:39]
    buffer_load_dwordx4 a[40:43], v248, s[36:39], s62 offen offset:2048 sc1
    v_mfma_f32_16x16x32_bf16 v[40:43], a[56:59], v[112:115], v[40:43]
    s_waitcnt lgkmcnt(9)
    ds_read_b64_tr_b16 v[132:133], v171 offset:20480
    v_mfma_f32_16x16x32_bf16 v[44:47], a[48:51], v[116:119], v[44:47]
    s_waitcnt lgkmcnt(3)
    ds_read_b64_tr_b16 v[134:135], v171 offset:22528
    v_mfma_f32_16x16x32_bf16 v[48:51], a[52:55], v[116:119], v[48:51]
    v_lshlrev_b32 v230, 16, v224
    v_and_b32 v231, 0xffff0000, v224
    v_pk_mul_f32 v[230:231], v[230:231], v[220:221] op_sel_hi:[1,0]
    v_pk_mul_f32 v[234:235], v[230:231], v[230:231]
    v_lshlrev_b32 v232, 16, v225
    v_and_b32 v233, 0xffff0000, v225
    v_pk_mul_f32 v[232:233], v[232:233], v[220:221] op_sel_hi:[1,0]
    v_pk_mul_f32 v[236:237], v[232:233], v[232:233]
    v_lshlrev_b32 v2, 16, v226
    v_and_b32 v3, 0xffff0000, v226
    v_pk_mul_f32 v[2:3], v[2:3], v[220:221] op_sel:[0,1] op_sel_hi:[1,1]
    v_pk_add_f32 v[230:231], v[230:231], v[2:3]
    v_pk_fma_f32 v[234:235], v[2:3], v[2:3], v[234:235]
    v_lshlrev_b32 v2, 16, v227
    v_and_b32 v3, 0xffff0000, v227
    v_pk_mul_f32 v[2:3], v[2:3], v[220:221] op_sel:[0,1] op_sel_hi:[1,1]
    v_pk_add_f32 v[232:233], v[232:233], v[2:3]
    v_pk_fma_f32 v[236:237], v[2:3], v[2:3], v[236:237]
    v_lshlrev_b32 v2, 16, v228
    v_and_b32 v3, 0xffff0000, v228
    v_pk_mul_f32 v[2:3], v[2:3], v[222:223] op_sel_hi:[1,0]
    v_pk_add_f32 v[230:231], v[230:231], v[2:3]
    v_pk_fma_f32 v[234:235], v[2:3], v[2:3], v[234:235]
    v_lshlrev_b32 v2, 16, v229
    v_and_b32 v3, 0xffff0000, v229
    v_pk_mul_f32 v[2:3], v[2:3], v[222:223] op_sel_hi:[1,0]
    v_pk_add_f32 v[232:233], v[232:233], v[2:3]
    v_pk_fma_f32 v[236:237], v[2:3], v[2:3], v[236:237]
    v_mfma_f32_16x16x32_bf16 v[52:55], a[56:59], v[116:119], v[52:55]
    buffer_load_dwordx4 a[44:47], v248, s[36:39], s62 offen offset:3072 sc1
    v_mfma_f32_16x16x32_bf16 v[8:11], a[60:63], v[120:123], v[8:11]
    ds_read_b64_tr_b16 v[104:105], v168 offset:24576
    v_permlane32_swap_b32 v230, v234
    v_mfma_f32_16x16x32_bf16 v[12:15], a[64:67], v[120:123], v[12:15]
    ds_read_b64_tr_b16 v[106:107], v168 offset:26624
    v_permlane32_swap_b32 v231, v235
    v_mfma_f32_16x16x32_bf16 v[16:19], a[68:71], v[120:123], v[16:19]
    s_add_u32 s62, s62, 4096
    ds_read_b64_tr_b16 v[108:109], v169 offset:24576
    v_permlane32_swap_b32 v232, v236
    v_mfma_f32_16x16x32_bf16 v[20:23], a[60:63], v[124:127], v[20:23]
    buffer_load_dwordx4 a[48:51], v248, s[36:39], s62 offen offset:0 sc1
    v_mfma_f32_16x16x32_bf16 v[24:27], a[64:67], v[124:127], v[24:27]
    ds_read_b64_tr_b16 v[110:111], v169 offset:26624
    v_permlane32_swap_b32 v233, v237
    v_mfma_f32_16x16x32_bf16 v[28:31], a[68:71], v[124:127], v[28:31]
    s_waitcnt lgkmcnt(6)
    ds_read_b64_tr_b16 v[112:113], v170 offset:24576
    v_add_f32 v230, v230, v234
    v_mfma_f32_16x16x32_bf16 v[32:35], a[60:63], v[128:131], v[32:35]
    ds_read_b64_tr_b16 v[114:115], v170 offset:26624
    v_add_f32 v231, v231, v235
    v_add_f32 v232, v232, v236
    v_mfma_f32_16x16x32_bf16 v[36:39], a[64:67], v[128:131], v[36:39]
    buffer_load_dwordx4 a[52:55], v248, s[36:39], s62 offen offset:1024 sc1
    v_mfma_f32_16x16x32_bf16 v[40:43], a[68:71], v[128:131], v[40:43]
    s_waitcnt lgkmcnt(6)
    ds_read_b64_tr_b16 v[116:117], v171 offset:24576
    v_add_f32 v233, v233, v237
    v_mfma_f32_16x16x32_bf16 v[44:47], a[60:63], v[132:135], v[44:47]
    s_waitcnt lgkmcnt(3)
    ds_read_b64_tr_b16 v[118:119], v171 offset:26624
    v_permlane16_swap_b32 v230, v232
    v_mfma_f32_16x16x32_bf16 v[48:51], a[64:67], v[132:135], v[48:51]
    v_permlane16_swap_b32 v231, v233
    v_mfma_f32_16x16x32_bf16 v[52:55], a[68:71], v[132:135], v[52:55]
    buffer_load_dwordx4 a[56:59], v248, s[36:39], s62 offen offset:2048 sc1
    v_mfma_f32_16x16x32_bf16 v[8:11], a[72:75], v[104:107], v[8:11]
    ds_read_b64_tr_b16 v[120:121], v168 offset:28672
    v_add_f32 v230, v230, v232
    v_mfma_f32_16x16x32_bf16 v[12:15], a[76:79], v[104:107], v[12:15]
    ds_read_b64_tr_b16 v[122:123], v168 offset:30720
    v_add_f32 v231, v231, v233
    v_mfma_f32_16x16x32_bf16 v[16:19], a[80:83], v[104:107], v[16:19]
    ds_read_b64_tr_b16 v[124:125], v169 offset:28672
    v_lshrrev_b32 v2, 4, v1
    v_mfma_f32_16x16x32_bf16 v[20:23], a[72:75], v[108:111], v[20:23]
    buffer_load_dwordx4 a[60:63], v248, s[36:39], s62 offen offset:3072 sc1
    v_mfma_f32_16x16x32_bf16 v[24:27], a[76:79], v[108:111], v[24:27]
    ds_read_b64_tr_b16 v[126:127], v169 offset:30720
    v_lshlrev_b32 v2, 3, v2
    v_mfma_f32_16x16x32_bf16 v[28:31], a[80:83], v[108:111], v[28:31]
    s_waitcnt lgkmcnt(6)
    s_lshl_b32 s50, s3, 5
    s_add_u32 s50, s50, 0
    ds_read_b64_tr_b16 v[128:129], v170 offset:28672
    v_mfma_f32_16x16x32_bf16 v[32:35], a[72:75], v[112:115], v[32:35]
    s_add_u32 s62, s62, 4096
    ds_read_b64_tr_b16 v[130:131], v170 offset:30720
    v_add_u32 v2, s50, v2
    v_mfma_f32_16x16x32_bf16 v[36:39], a[76:79], v[112:115], v[36:39]
    buffer_load_dwordx4 a[64:67], v248, s[36:39], s62 offen offset:0 sc1
    v_mfma_f32_16x16x32_bf16 v[40:43], a[80:83], v[112:115], v[40:43]
    s_waitcnt lgkmcnt(6)
    ds_read_b64_tr_b16 v[132:133], v171 offset:28672
    v_add_f32_dpp v230, v230, v230 row_ror:8 row_mask:0xf bank_mask:0xf
    v_mfma_f32_16x16x32_bf16 v[44:47], a[72:75], v[116:119], v[44:47]
    s_waitcnt lgkmcnt(3)
    ds_read_b64_tr_b16 v[134:135], v171 offset:30720
    v_add_f32_dpp v231, v231, v231 row_ror:8 row_mask:0xf bank_mask:0xf
    v_mfma_f32_16x16x32_bf16 v[48:51], a[76:79], v[116:119], v[48:51]
    v_add_f32_dpp v230, v230, v230 row_ror:4 row_mask:0xf bank_mask:0xf
    v_add_f32_dpp v231, v231, v231 row_ror:4 row_mask:0xf bank_mask:0xf
    v_mfma_f32_16x16x32_bf16 v[52:55], a[80:83], v[116:119], v[52:55]
    buffer_load_dwordx4 a[68:71], v248, s[36:39], s62 offen offset:1024 sc1
    v_mfma_f32_16x16x32_bf16 v[8:11], a[84:87], v[120:123], v[8:11]
    ds_read_b64_tr_b16 v[104:105], v168 offset:32768
    v_add_f32_dpp v230, v230, v230 row_ror:2 row_mask:0xf bank_mask:0xf
    v_mfma_f32_16x16x32_bf16 v[12:15], a[88:91], v[120:123], v[12:15]
    ds_read_b64_tr_b16 v[106:107], v168 offset:34816
    v_add_f32_dpp v231, v231, v231 row_ror:2 row_mask:0xf bank_mask:0xf
    v_mfma_f32_16x16x32_bf16 v[16:19], a[92:95], v[120:123], v[16:19]
    ds_read_b64_tr_b16 v[108:109], v169 offset:32768
    v_add_f32_dpp v230, v230, v230 row_ror:1 row_mask:0xf bank_mask:0xf
    v_mfma_f32_16x16x32_bf16 v[20:23], a[84:87], v[124:127], v[20:23]
    s_waitcnt vmcnt(10)
    s_barrier
    s_cmp_eq_u32 s3, 0
    s_cbranch_scc0 L_wf27
    s_lshl_b32 s54, s76, 7
    s_add_u32 s54, s54, 23288832
    v_mov_b32 v254, 0
    v_mov_b32 v255, s48
    s_mov_b64 exec, 1
    buffer_store_dword v255, v254, s[36:39], s54 offen sc1
    s_mov_b64 exec, -1
L_wf27:
    buffer_load_dwordx4 a[72:75], v248, s[36:39], s62 offen offset:2048 sc1
    v_mfma_f32_16x16x32_bf16 v[24:27], a[88:91], v[124:127], v[24:27]
    ds_read_b64_tr_b16 v[110:111], v169 offset:34816
    v_add_f32_dpp v231, v231, v231 row_ror:1 row_mask:0xf bank_mask:0xf
    v_mfma_f32_16x16x32_bf16 v[28:31], a[92:95], v[124:127], v[28:31]
    ds_read_b64_tr_b16 v[112:113], v170 offset:32768
    s_mov_b32 exec_lo, 0x00010001
    s_mov_b32 exec_hi, 0x00010001
    ds_write_b64 v2, v[230:231]
    s_mov_b64 exec, -1
    s_waitcnt lgkmcnt(8)
    v_mfma_f32_16x16x32_bf16 v[32:35], a[84:87], v[128:131], v[32:35]
    ds_read_b64_tr_b16 v[114:115], v170 offset:34816
    v_lshlrev_b32 v2, 2, v1
    v_mfma_f32_16x16x32_bf16 v[36:39], a[88:91], v[128:131], v[36:39]
    buffer_load_dwordx4 a[76:79], v248, s[36:39], s62 offen offset:3072 sc1
    v_mfma_f32_16x16x32_bf16 v[40:43], a[92:95], v[128:131], v[40:43]
    s_waitcnt lgkmcnt(7)
    ds_read_b64_tr_b16 v[116:117], v171 offset:32768
    v_and_b32 v2, 12, v2
    v_mfma_f32_16x16x32_bf16 v[44:47], a[84:87], v[132:135], v[44:47]
    s_waitcnt lgkmcnt(3)
    ds_read_b64_tr_b16 v[118:119], v171 offset:34816
    v_add_u32 v2, 0, v2
    v_mfma_f32_16x16x32_bf16 v[48:51], a[88:91], v[132:135], v[48:51]
    s_add_u32 s62, s62, 4096
    s_waitcnt lgkmcnt(0)
    s_barrier
    v_mfma_f32_16x16x32_bf16 v[52:55], a[92:95], v[132:135], v[52:55]
    buffer_load_dwordx4 a[80:83], v248, s[36:39], s62 offen offset:0 sc1
    v_mfma_f32_16x16x32_bf16 v[8:11], a[96:99], v[104:107], v[8:11]
    ds_read_b64_tr_b16 v[120:121], v168 offset:36864
    ds_read2_b32 v[230:231], v2 offset0:0 offset1:4
    v_mfma_f32_16x16x32_bf16 v[12:15], a[100:103], v[104:107], v[12:15]
    ds_read_b64_tr_b16 v[122:123], v168 offset:38912
    ds_read2_b32 v[232:233], v2 offset0:8 offset1:12
    v_mfma_f32_16x16x32_bf16 v[16:19], a[104:107], v[104:107], v[16:19]
    ds_read_b64_tr_b16 v[124:125], v169 offset:36864
    ds_read2_b32 v[234:235], v2 offset0:16 offset1:20
    ds_read2_b32 v[236:237], v2 offset0:24 offset1:28
    v_mfma_f32_16x16x32_bf16 v[20:23], a[96:99], v[108:111], v[20:23]
    buffer_load_dwordx4 a[84:87], v248, s[36:39], s62 offen offset:1024 sc1
    v_mfma_f32_16x16x32_bf16 v[24:27], a[100:103], v[108:111], v[24:27]
    ds_read_b64_tr_b16 v[126:127], v169 offset:38912
    v_mov_b32 v225, s48
    v_mfma_f32_16x16x32_bf16 v[28:31], a[104:107], v[108:111], v[28:31]
    ds_read_b64_tr_b16 v[128:129], v170 offset:36864
    v_mov_b32 v227, s48
    v_mfma_f32_16x16x32_bf16 v[32:35], a[96:99], v[112:115], v[32:35]
    s_add_u32 s7, s7, 16384
    ds_read_b64_tr_b16 v[130:131], v170 offset:38912
    s_waitcnt lgkmcnt(6)
    v_add_f32 v230, v230, v232
    v_mfma_f32_16x16x32_bf16 v[36:39], a[100:103], v[112:115], v[36:39]
    buffer_load_dwordx4 a[88:91], v248, s[36:39], s62 offen offset:2048 sc1
    v_mfma_f32_16x16x32_bf16 v[40:43], a[104:107], v[112:115], v[40:43]
    ds_read_b64_tr_b16 v[132:133], v171 offset:36864
    v_add_f32 v231, v231, v233
    v_mfma_f32_16x16x32_bf16 v[44:47], a[96:99], v[116:119], v[44:47]
    s_waitcnt lgkmcnt(3)
    ds_read_b64_tr_b16 v[134:135], v171 offset:38912
    v_add_f32 v234, v234, v236
    v_mfma_f32_16x16x32_bf16 v[48:51], a[100:103], v[116:119], v[48:51]
    v_mfma_f32_16x16x32_bf16 v[52:55], a[104:107], v[116:119], v[52:55]
    buffer_load_dwordx4 a[92:95], v248, s[36:39], s62 offen offset:3072 sc1
    v_mfma_f32_16x16x32_bf16 v[8:11], a[108:111], v[120:123], v[8:11]
    ds_read_b64_tr_b16 v[104:105], v168 offset:40960
    v_add_f32 v235, v235, v237
    v_mfma_f32_16x16x32_bf16 v[12:15], a[112:115], v[120:123], v[12:15]
    ds_read_b64_tr_b16 v[106:107], v168 offset:43008
    v_add_f32 v230, v230, v234
    v_mfma_f32_16x16x32_bf16 v[16:19], a[116:119], v[120:123], v[16:19]
    s_add_u32 s62, s62, 4096
    ds_read_b64_tr_b16 v[108:109], v169 offset:40960
    v_add_f32 v231, v231, v235
    v_mfma_f32_16x16x32_bf16 v[20:23], a[108:111], v[124:127], v[20:23]
    buffer_load_dwordx4 a[96:99], v248, s[36:39], s62 offen offset:0 sc1
    v_mfma_f32_16x16x32_bf16 v[24:27], a[112:115], v[124:127], v[24:27]
    ds_read_b64_tr_b16 v[110:111], v169 offset:43008
    v_mul_f32 v230, 0x3acccccd, v230
    v_mfma_f32_16x16x32_bf16 v[28:31], a[116:119], v[124:127], v[28:31]
    s_waitcnt lgkmcnt(6)
    ds_read_b64_tr_b16 v[112:113], v170 offset:40960
    v_mul_f32 v234, v230, v230
    v_mfma_f32_16x16x32_bf16 v[32:35], a[108:111], v[128:131], v[32:35]
    ds_read_b64_tr_b16 v[114:115], v170 offset:43008
    v_mov_b32 v224, 0x3acccccd
    v_fma_f32 v231, v231, v224, -v234
    v_mfma_f32_16x16x32_bf16 v[36:39], a[112:115], v[128:131], v[36:39]
    buffer_load_dwordx4 a[100:103], v248, s[36:39], s62 offen offset:1024 sc1
    v_mfma_f32_16x16x32_bf16 v[40:43], a[116:119], v[128:131], v[40:43]
    s_waitcnt lgkmcnt(6)
    ds_read_b64_tr_b16 v[116:117], v171 offset:40960
    v_max_f32 v231, 0, v231
    v_mfma_f32_16x16x32_bf16 v[44:47], a[108:111], v[132:135], v[44:47]
    s_waitcnt lgkmcnt(3)
    ds_read_b64_tr_b16 v[118:119], v171 offset:43008
    v_add_f32 v231, 0x3727c5ac, v231
    v_mfma_f32_16x16x32_bf16 v[48:51], a[112:115], v[132:135], v[48:51]
    v_rsq_f32 v224, v231
    v_mfma_f32_16x16x32_bf16 v[52:55], a[116:119], v[132:135], v[52:55]
    buffer_load_dwordx4 a[104:107], v248, s[36:39], s62 offen offset:2048 sc1
    v_mfma_f32_16x16x32_bf16 v[8:11], a[120:123], v[104:107], v[8:11]
    ds_read_b64_tr_b16 v[120:121], v168 offset:45056
    v_mul_f32_e64 v226, -v230, v224
    v_mfma_f32_16x16x32_bf16 v[12:15], a[124:127], v[104:107], v[12:15]
    ds_read_b64_tr_b16 v[122:123], v168 offset:47104
    s_mov_b64 exec, 0xf
    buffer_store_dwordx4 v[224:227], v248, s[36:39], s7 offen sc1
    s_mov_b64 exec, -1
    v_mfma_f32_16x16x32_bf16 v[16:19], a[128:131], v[104:107], v[16:19]
    s_and_b32 s50, s3, 1
    s_lshl_b32 s51, s74, 1
    ds_read_b64_tr_b16 v[124:125], v169 offset:45056
    v_mfma_f32_16x16x32_bf16 v[20:23], a[120:123], v[108:111], v[20:23]
    buffer_load_dwordx4 a[108:111], v248, s[36:39], s62 offen offset:3072 sc1
    v_mfma_f32_16x16x32_bf16 v[24:27], a[124:127], v[108:111], v[24:27]
    s_add_u32 s52, s51, s50
    s_mul_i32 s52, s52, 192
    ds_read_b64_tr_b16 v[126:127], v169 offset:47104
    v_mfma_f32_16x16x32_bf16 v[28:31], a[128:131], v[108:111], v[28:31]
    s_waitcnt lgkmcnt(6)
    s_mul_i32 s53, s3, 48
    s_add_u32 s52, s52, s53
    ds_read_b64_tr_b16 v[128:129], v170 offset:45056
    v_mfma_f32_16x16x32_bf16 v[32:35], a[120:123], v[112:115], v[32:35]
    s_add_u32 s62, s62, 4096
    ds_read_b64_tr_b16 v[130:131], v170 offset:47104
    v_mfma_f32_16x16x32_bf16 v[36:39], a[124:127], v[112:115], v[36:39]
    buffer_load_dwordx4 a[112:115], v248, s[36:39], s62 offen offset:0 sc1
    v_mfma_f32_16x16x32_bf16 v[40:43], a[128:131], v[112:115], v[40:43]
    s_waitcnt lgkmcnt(6)
    s_lshl_b32 s52, s52, 8
    s_add_u32 s52, s52, 16777216
    ds_read_b64_tr_b16 v[132:133], v171 offset:45056
    v_mfma_f32_16x16x32_bf16 v[44:47], a[120:123], v[116:119], v[44:47]
    s_waitcnt lgkmcnt(3)
    ds_read_b64_tr_b16 v[134:135], v171 offset:47104
    v_add_u32 v216, s52, v248
    v_mfma_f32_16x16x32_bf16 v[48:51], a[124:127], v[116:119], v[48:51]
    v_add_u32 v218, 3145728, v216
    v_mfma_f32_16x16x32_bf16 v[52:55], a[128:131], v[116:119], v[52:55]
    buffer_load_dwordx4 a[116:119], v248, s[36:39], s62 offen offset:1024 sc1
    v_mfma_f32_16x16x32_bf16 v[8:11], a[132:135], v[120:123], v[8:11]
    s_xor_b32 s50, s50, 1
    s_add_u32 s52, s51, s50
    ds_read_b64_tr_b16 v[104:105], v168 offset:49152
    v_mfma_f32_16x16x32_bf16 v[12:15], a[136:139], v[120:123], v[12:15]
    s_mul_i32 s52, s52, 192
    s_add_u32 s52, s52, s53
    ds_read_b64_tr_b16 v[106:107], v168 offset:51200
    v_mfma_f32_16x16x32_bf16 v[16:19], a[140:143], v[120:123], v[16:19]
    s_lshl_b32 s52, s52, 8
    s_add_u32 s52, s52, 16777216
    ds_read_b64_tr_b16 v[108:109], v169 offset:49152
    v_mfma_f32_16x16x32_bf16 v[20:23], a[132:135], v[124:127], v[20:23]
    buffer_load_dwordx4 a[120:123], v248, s[36:39], s62 offen offset:2048 sc1
    v_mfma_f32_16x16x32_bf16 v[24:27], a[136:139], v[124:127], v[24:27]
    ds_read_b64_tr_b16 v[110:111], v169 offset:51200
    v_add_u32 v217, s52, v248
    v_mfma_f32_16x16x32_bf16 v[28:31], a[140:143], v[124:127], v[28:31]
    s_waitcnt lgkmcnt(6)
    ds_read_b64_tr_b16 v[112:113], v170 offset:49152
    v_add_u32 v219, 3145728, v217
    v_mfma_f32_16x16x32_bf16 v[32:35], a[132:135], v[128:131], v[32:35]
    s_lshr_b32 s50, s74, 1
    s_lshl_b32 s50, s50, 2
    ds_read_b64_tr_b16 v[114:115], v170 offset:51200
    v_mfma_f32_16x16x32_bf16 v[36:39], a[136:139], v[128:131], v[36:39]
    buffer_load_dwordx4 a[124:127], v248, s[36:39], s62 offen offset:3072 sc1
    v_mfma_f32_16x16x32_bf16 v[40:43], a[140:143], v[128:131], v[40:43]
    s_waitcnt lgkmcnt(6)
    s_add_u32 s50, s50, s3
    s_lshl_b32 s50, s50, 9
    ds_read_b64_tr_b16 v[116:117], v171 offset:49152
    v_mfma_f32_16x16x32_bf16 v[44:47], a[132:135], v[132:135], v[44:47]
    s_waitcnt lgkmcnt(3)
    s_add_u32 s50, s50, 89088
    ds_read_b64_tr_b16 v[118:119], v171 offset:51200
    v_mfma_f32_16x16x32_bf16 v[48:51], a[136:139], v[132:135], v[48:51]
    s_add_u32 s62, s62, 4096
    v_mfma_f32_16x16x32_bf16 v[52:55], a[140:143], v[132:135], v[52:55]
    buffer_load_dwordx4 a[128:131], v248, s[36:39], s62 offen offset:0 sc1
    v_mfma_f32_16x16x32_bf16 v[8:11], a[144:147], v[104:107], v[8:11]
    ds_read_b64_tr_b16 v[120:121], v168 offset:53248
    v_min_u32 v246, 13, v1
    v_mfma_f32_16x16x32_bf16 v[12:15], a[148:151], v[104:107], v[12:15]
    ds_read_b64_tr_b16 v[122:123], v168 offset:55296
    v_lshlrev_b32 v246, 7, v246
    v_mfma_f32_16x16x32_bf16 v[16:19], a[152:155], v[104:107], v[16:19]
    ds_read_b64_tr_b16 v[124:125], v169 offset:53248
    v_mov_b32 v2, s50
    v_mfma_f32_16x16x32_bf16 v[20:23], a[144:147], v[108:111], v[20:23]
    buffer_load_dwordx4 a[132:135], v248, s[36:39], s62 offen offset:1024 sc1
    v_mfma_f32_16x16x32_bf16 v[24:27], a[148:151], v[108:111], v[24:27]
    ds_read_b64_tr_b16 v[126:127], v169 offset:55296
    v_mov_b32 v3, 31488
    v_mfma_f32_16x16x32_bf16 v[28:31], a[152:155], v[108:111], v[28:31]
    ds_read_b64_tr_b16 v[128:129], v170 offset:53248
    v_cmp_lt_u32 vcc, 3, v1
    s_nop 1
    v_cndmask_b32 v2, v2, v3, vcc
    s_waitcnt lgkmcnt(7)
    v_mfma_f32_16x16x32_bf16 v[32:35], a[144:147], v[112:115], v[32:35]
    ds_read_b64_tr_b16 v[130:131], v170 offset:55296
    v_add_u32 v246, v246, v2
    v_mfma_f32_16x16x32_bf16 v[36:39], a[148:151], v[112:115], v[36:39]
    buffer_load_dwordx4 a[136:139], v248, s[36:39], s62 offen offset:2048 sc1
    v_mfma_f32_16x16x32_bf16 v[40:43], a[152:155], v[112:115], v[40:43]
    s_waitcnt lgkmcnt(6)
    ds_read_b64_tr_b16 v[132:133], v171 offset:53248
    v_mfma_f32_16x16x32_bf16 v[44:47], a[144:147], v[116:119], v[44:47]
    s_waitcnt lgkmcnt(3)
    ds_read_b64_tr_b16 v[134:135], v171 offset:55296
    v_mfma_f32_16x16x32_bf16 v[48:51], a[148:151], v[116:119], v[48:51]
    buffer_load_dword v247, v246, s[36:39], s17 offen sc1
    v_mfma_f32_16x16x32_bf16 v[52:55], a[152:155], v[116:119], v[52:55]
    buffer_load_dwordx4 a[140:143], v248, s[36:39], s62 offen offset:3072 sc1
    v_mfma_f32_16x16x32_bf16 v[8:11], a[156:159], v[120:123], v[8:11]
    ds_read_b64_tr_b16 v[104:105], v168 offset:57344
    v_mfma_f32_16x16x32_bf16 v[12:15], a[160:163], v[120:123], v[12:15]
    ds_read_b64_tr_b16 v[106:107], v168 offset:59392
    v_mfma_f32_16x16x32_bf16 v[16:19], a[164:167], v[120:123], v[16:19]
    s_add_u32 s62, s62, 4096
    ds_read_b64_tr_b16 v[108:109], v169 offset:57344
    v_mfma_f32_16x16x32_bf16 v[20:23], a[156:159], v[124:127], v[20:23]
    buffer_load_dwordx4 a[144:147], v248, s[36:39], s62 offen offset:0 sc1
    v_mfma_f32_16x16x32_bf16 v[24:27], a[160:163], v[124:127], v[24:27]
    ds_read_b64_tr_b16 v[110:111], v169 offset:59392
    v_mfma_f32_16x16x32_bf16 v[28:31], a[164:167], v[124:127], v[28:31]
    s_waitcnt lgkmcnt(6)
    ds_read_b64_tr_b16 v[112:113], v170 offset:57344
    v_mfma_f32_16x16x32_bf16 v[32:35], a[156:159], v[128:131], v[32:35]
    ds_read_b64_tr_b16 v[114:115], v170 offset:59392
    v_mfma_f32_16x16x32_bf16 v[36:39], a[160:163], v[128:131], v[36:39]
    buffer_load_dwordx4 a[148:151], v248, s[36:39], s62 offen offset:1024 sc1
    v_mfma_f32_16x16x32_bf16 v[40:43], a[164:167], v[128:131], v[40:43]
    s_waitcnt lgkmcnt(6)
    ds_read_b64_tr_b16 v[116:117], v171 offset:57344
    v_mfma_f32_16x16x32_bf16 v[44:47], a[156:159], v[132:135], v[44:47]
    s_waitcnt lgkmcnt(3)
    ds_read_b64_tr_b16 v[118:119], v171 offset:59392
    v_mfma_f32_16x16x32_bf16 v[48:51], a[160:163], v[132:135], v[48:51]
    v_mfma_f32_16x16x32_bf16 v[52:55], a[164:167], v[132:135], v[52:55]
    buffer_load_dwordx4 a[152:155], v248, s[36:39], s62 offen offset:2048 sc1
    v_mfma_f32_16x16x32_bf16 v[8:11], a[168:171], v[104:107], v[8:11]
    ds_read_b64_tr_b16 v[120:121], v168 offset:61440
    v_mfma_f32_16x16x32_bf16 v[12:15], a[172:175], v[104:107], v[12:15]
    ds_read_b64_tr_b16 v[122:123], v168 offset:63488
    v_add_u32 v168, 65536, v168
    v_mfma_f32_16x16x32_bf16 v[16:19], a[176:179], v[104:107], v[16:19]
    ds_read_b64_tr_b16 v[124:125], v169 offset:61440
    v_mfma_f32_16x16x32_bf16 v[20:23], a[168:171], v[108:111], v[20:23]
    buffer_load_dwordx4 a[156:159], v248, s[36:39], s62 offen offset:3072 sc1
    v_mfma_f32_16x16x32_bf16 v[24:27], a[172:175], v[108:111], v[24:27]
    ds_read_b64_tr_b16 v[126:127], v169 offset:63488
    v_add_u32 v169, 65536, v169
    v_mfma_f32_16x16x32_bf16 v[28:31], a[176:179], v[108:111], v[28:31]
    s_waitcnt lgkmcnt(6)
    ds_read_b64_tr_b16 v[128:129], v170 offset:61440
    v_mfma_f32_16x16x32_bf16 v[32:35], a[168:171], v[112:115], v[32:35]
    s_add_u32 m0, s63, 1024
    ds_read_b64_tr_b16 v[130:131], v170 offset:63488
    v_add_u32 v170, 65536, v170
    v_mfma_f32_16x16x32_bf16 v[36:39], a[172:175], v[112:115], v[36:39]
    buffer_load_dwordx4 v248, s[36:39], s6 offen sc1 lds
    v_mfma_f32_16x16x32_bf16 v[40:43], a[176:179], v[112:115], v[40:43]
    s_waitcnt lgkmcnt(6)
    ds_read_b64_tr_b16 v[132:133], v171 offset:61440
    v_mfma_f32_16x16x32_bf16 v[44:47], a[168:171], v[116:119], v[44:47]
    s_waitcnt lgkmcnt(3)
    ds_read_b64_tr_b16 v[134:135], v171 offset:63488
    v_add_u32 v171, 65536, v171
    v_mfma_f32_16x16x32_bf16 v[48:51], a[172:175], v[116:119], v[48:51]
    s_add_u32 s62, s62, 4096
    v_mfma_f32_16x16x32_bf16 v[52:55], a[176:179], v[116:119], v[52:55]
    buffer_load_dwordx4 a[160:163], v248, s[36:39], s62 offen offset:0 sc1
    v_mfma_f32_16x16x32_bf16 v[8:11], a[180:183], v[120:123], v[8:11]
    ds_read_b64_tr_b16 v[104:105], v168 offset:0
    v_mfma_f32_16x16x32_bf16 v[12:15], a[184:187], v[120:123], v[12:15]
    ds_read_b64_tr_b16 v[106:107], v168 offset:2048
    v_mfma_f32_16x16x32_bf16 v[16:19], a[188:191], v[120:123], v[16:19]
    ds_read_b64_tr_b16 v[108:109], v169 offset:0
    v_mfma_f32_16x16x32_bf16 v[20:23], a[180:183], v[124:127], v[20:23]
    buffer_load_dwordx4 a[164:167], v248, s[36:39], s62 offen offset:1024 sc1
    v_mfma_f32_16x16x32_bf16 v[24:27], a[184:187], v[124:127], v[24:27]
    ds_read_b64_tr_b16 v[110:111], v169 offset:2048
    v_mfma_f32_16x16x32_bf16 v[28:31], a[188:191], v[124:127], v[28:31]
    s_waitcnt lgkmcnt(6)
    ds_read_b64_tr_b16 v[112:113], v170 offset:0
    v_mfma_f32_16x16x32_bf16 v[32:35], a[180:183], v[128:131], v[32:35]
    ds_read_b64_tr_b16 v[114:115], v170 offset:2048
    v_mfma_f32_16x16x32_bf16 v[36:39], a[184:187], v[128:131], v[36:39]
    buffer_load_dwordx4 a[168:171], v248, s[36:39], s62 offen offset:2048 sc1
    v_mfma_f32_16x16x32_bf16 v[40:43], a[188:191], v[128:131], v[40:43]
    s_waitcnt lgkmcnt(6)
    ds_read_b64_tr_b16 v[116:117], v171 offset:0
    v_mfma_f32_16x16x32_bf16 v[44:47], a[180:183], v[132:135], v[44:47]
    s_waitcnt lgkmcnt(3)
    ds_read_b64_tr_b16 v[118:119], v171 offset:2048
    v_mfma_f32_16x16x32_bf16 v[48:51], a[184:187], v[132:135], v[48:51]
    s_waitcnt vmcnt(9)
    v_cmp_ne_u32 vcc, s48, v247
    s_cbranch_vccnz L_chk28_slow
L_chk28_back:
    v_mfma_f32_16x16x32_bf16 v[52:55], a[188:191], v[132:135], v[52:55]
    buffer_load_dwordx4 v[56:59], v216, s[36:39], 0 offen offset:0 sc1
    v_mfma_f32_16x16x32_bf16 v[8:11], a[192:195], v[104:107], v[8:11]
    ds_read_b64_tr_b16 v[120:121], v168 offset:4096
    v_mfma_f32_16x16x32_bf16 v[12:15], a[196:199], v[104:107], v[12:15]
    ds_read_b64_tr_b16 v[122:123], v168 offset:6144
    v_mfma_f32_16x16x32_bf16 v[16:19], a[200:203], v[104:107], v[16:19]
    ds_read_b64_tr_b16 v[124:125], v169 offset:4096
    v_mfma_f32_16x16x32_bf16 v[20:23], a[192:195], v[108:111], v[20:23]
    buffer_load_dwordx4 v[60:63], v217, s[36:39], 0 offen offset:0 sc1
    v_mfma_f32_16x16x32_bf16 v[24:27], a[196:199], v[108:111], v[24:27]
    ds_read_b64_tr_b16 v[126:127], v169 offset:6144
    v_mfma_f32_16x16x32_bf16 v[28:31], a[200:203], v[108:111], v[28:31]
    s_waitcnt lgkmcnt(6)
    ds_read_b64_tr_b16 v[128:129], v170 offset:4096
    v_mfma_f32_16x16x32_bf16 v[32:35], a[192:195], v[112:115], v[32:35]
    ds_read_b64_tr_b16 v[130:131], v170 offset:6144
    v_mfma_f32_16x16x32_bf16 v[36:39], a[196:199], v[112:115], v[36:39]
    buffer_load_dwordx4 v[64:67], v216, s[36:39], 0 offen offset:1024 sc1
    v_mfma_f32_16x16x32_bf16 v[40:43], a[200:203], v[112:115], v[40:43]
    s_waitcnt lgkmcnt(6)
    ds_read_b64_tr_b16 v[132:133], v171 offset:4096
    v_mfma_f32_16x16x32_bf16 v[44:47], a[192:195], v[116:119], v[44:47]
    s_waitcnt lgkmcnt(3)
    ds_read_b64_tr_b16 v[134:135], v171 offset:6144
    v_mfma_f32_16x16x32_bf16 v[48:51], a[196:199], v[116:119], v[48:51]
    v_mfma_f32_16x16x32_bf16 v[52:55], a[200:203], v[116:119], v[52:55]
    buffer_load_dwordx4 v[68:71], v217, s[36:39], 0 offen offset:1024 sc1
    v_mfma_f32_16x16x32_bf16 v[8:11], a[204:207], v[120:123], v[8:11]
    ds_read_b64_tr_b16 v[104:105], v168 offset:8192
    v_mfma_f32_16x16x32_bf16 v[12:15], a[208:211], v[120:123], v[12:15]
    ds_read_b64_tr_b16 v[106:107], v168 offset:10240
    v_mfma_f32_16x16x32_bf16 v[16:19], a[212:215], v[120:123], v[16:19]
    ds_read_b64_tr_b16 v[108:109], v169 offset:8192
    v_mfma_f32_16x16x32_bf16 v[20:23], a[204:207], v[124:127], v[20:23]
    buffer_load_dwordx4 v[72:75], v216, s[36:39], 0 offen offset:2048 sc1
    v_mfma_f32_16x16x32_bf16 v[24:27], a[208:211], v[124:127], v[24:27]
    ds_read_b64_tr_b16 v[110:111], v169 offset:10240
    v_mfma_f32_16x16x32_bf16 v[28:31], a[212:215], v[124:127], v[28:31]
    s_waitcnt lgkmcnt(6)
    ds_read_b64_tr_b16 v[112:113], v170 offset:8192
    v_mfma_f32_16x16x32_bf16 v[32:35], a[204:207], v[128:131], v[32:35]
    ds_read_b64_tr_b16 v[114:115], v170 offset:10240
    v_mfma_f32_16x16x32_bf16 v[36:39], a[208:211], v[128:131], v[36:39]
    buffer_load_dwordx4 v[76:79], v217, s[36:39], 0 offen offset:2048 sc1
    v_mfma_f32_16x16x32_bf16 v[40:43], a[212:215], v[128:131], v[40:43]
    s_waitcnt lgkmcnt(6)
    ds_read_b64_tr_b16 v[116:117], v171 offset:8192
    v_mfma_f32_16x16x32_bf16 v[44:47], a[204:207], v[132:135], v[44:47]
    s_waitcnt lgkmcnt(3)
    ds_read_b64_tr_b16 v[118:119], v171 offset:10240
    v_mfma_f32_16x16x32_bf16 v[48:51], a[208:211], v[132:135], v[48:51]
    v_mfma_f32_16x16x32_bf16 v[52:55], a[212:215], v[132:135], v[52:55]
    buffer_load_dwordx4 v[80:83], v216, s[36:39], 0 offen offset:3072 sc1
    v_mfma_f32_16x16x32_bf16 v[8:11], a[216:219], v[104:107], v[8:11]
    ds_read_b64_tr_b16 v[120:121], v168 offset:12288
    v_mfma_f32_16x16x32_bf16 v[12:15], a[220:223], v[104:107], v[12:15]
    ds_read_b64_tr_b16 v[122:123], v168 offset:14336
    v_mfma_f32_16x16x32_bf16 v[16:19], a[224:227], v[104:107], v[16:19]
    ds_read_b64_tr_b16 v[124:125], v169 offset:12288
    v_mfma_f32_16x16x32_bf16 v[20:23], a[216:219], v[108:111], v[20:23]
    buffer_load_dwordx4 v[84:87], v217, s[36:39], 0 offen offset:3072 sc1
    v_mfma_f32_16x16x32_bf16 v[24:27], a[220:223], v[108:111], v[24:27]
    ds_read_b64_tr_b16 v[126:127], v169 offset:14336
    v_mfma_f32_16x16x32_bf16 v[28:31], a[224:227], v[108:111], v[28:31]
    s_waitcnt lgkmcnt(6)
    ds_read_b64_tr_b16 v[128:129], v170 offset:12288
    v_mfma_f32_16x16x32_bf16 v[32:35], a[216:219], v[112:115], v[32:35]
    s_waitcnt vmcnt(11)
    ds_read_b64_tr_b16 v[130:131], v170 offset:14336
    ds_read_b128 v[200:203], v175 offset:1024
    v_mfma_f32_16x16x32_bf16 v[36:39], a[220:223], v[112:115], v[36:39]
    buffer_load_dwordx4 v[88:91], v216, s[36:39], s4 offen offset:0 sc1
    v_mfma_f32_16x16x32_bf16 v[40:43], a[224:227], v[112:115], v[40:43]
    s_waitcnt lgkmcnt(7)
    ds_read_b64_tr_b16 v[132:133], v171 offset:12288
    ds_read_b128 v[204:207], v175 offset:1280
    v_mfma_f32_16x16x32_bf16 v[44:47], a[216:219], v[116:119], v[44:47]
    s_waitcnt lgkmcnt(3)
    ds_read_b64_tr_b16 v[134:135], v171 offset:14336
    v_mfma_f32_16x16x32_bf16 v[48:51], a[220:223], v[116:119], v[48:51]
    ds_read_b128 v[208:211], v175 offset:1536
    ds_read_b128 v[212:215], v175 offset:1792
    v_mfma_f32_16x16x32_bf16 v[52:55], a[224:227], v[116:119], v[52:55]
    buffer_load_dwordx4 v[92:95], v217, s[36:39], s4 offen offset:0 sc1
    v_mfma_f32_16x16x32_bf16 v[8:11], a[228:231], v[120:123], v[8:11]
    v_mfma_f32_16x16x32_bf16 v[12:15], a[232:235], v[120:123], v[12:15]
    s_waitcnt lgkmcnt(5)
    v_xor_b32 v3, s48, v201
    v_bitop3_b32 v3, v203, s48, v3 bitop3:0xbe
    v_mfma_f32_16x16x32_bf16 v[16:19], a[236:239], v[120:123], v[16:19]
    s_waitcnt lgkmcnt(3)
    v_bitop3_b32 v3, v205, s48, v3 bitop3:0xbe
    v_bitop3_b32 v3, v207, s48, v3 bitop3:0xbe
    v_mfma_f32_16x16x32_bf16 v[20:23], a[228:231], v[124:127], v[20:23]
    buffer_load_dwordx4 v[96:99], v216, s[36:39], s4 offen offset:1024 sc1
    v_mfma_f32_16x16x32_bf16 v[24:27], a[232:235], v[124:127], v[24:27]
    s_waitcnt lgkmcnt(1)
    v_bitop3_b32 v3, v209, s48, v3 bitop3:0xbe
    v_bitop3_b32 v3, v211, s48, v3 bitop3:0xbe
    v_mfma_f32_16x16x32_bf16 v[28:31], a[236:239], v[124:127], v[28:31]
    s_waitcnt lgkmcnt(0)
    v_bitop3_b32 v3, v213, s48, v3 bitop3:0xbe
    v_bitop3_b32 v3, v215, s48, v3 bitop3:0xbe
    v_mfma_f32_16x16x32_bf16 v[32:35], a[228:231], v[128:131], v[32:35]
    v_cmp_ne_u32 vcc, 0, v3
    s_cbranch_vccnz L_stp1_slow
L_stp1_back:
    v_mfma_f32_16x16x32_bf16 v[36:39], a[232:235], v[128:131], v[36:39]
    buffer_load_dwordx4 v[100:103], v217, s[36:39], s4 offen offset:1024 sc1
    v_mfma_f32_16x16x32_bf16 v[40:43], a[236:239], v[128:131], v[40:43]
    v_mfma_f32_16x16x32_bf16 v[44:47], a[228:231], v[132:135], v[44:47]
    v_mfma_f32_16x16x32_bf16 v[48:51], a[232:235], v[132:135], v[48:51]
    v_mfma_f32_16x16x32_bf16 v[52:55], a[236:239], v[132:135], v[52:55]
    s_add_u32 s8, s8, 3145728
    s_add_u32 s50, s8, 98304
    v_pk_fma_f32 v[238:239], v[176:177], v[202:203], v[188:189] op_sel_hi:[1,0,1]
    v_pk_fma_f32 v[240:241], v[178:179], v[202:203], v[190:191] op_sel_hi:[1,0,1]
    v_pk_fma_f32 v[8:9], v[8:9], v[200:201], v[238:239] op_sel_hi:[1,0,1]
    v_pk_fma_f32 v[10:11], v[10:11], v[200:201], v[240:241] op_sel_hi:[1,0,1]
    v_pk_fma_f32 v[242:243], v[180:181], v[202:203], v[192:193] op_sel_hi:[1,0,1]
    v_pk_fma_f32 v[244:245], v[182:183], v[202:203], v[194:195] op_sel_hi:[1,0,1]
    v_pk_fma_f32 v[12:13], v[12:13], v[200:201], v[242:243] op_sel_hi:[1,0,1]
    v_pk_fma_f32 v[14:15], v[14:15], v[200:201], v[244:245] op_sel_hi:[1,0,1]
    v_pk_mul_f32 v[8:9], v[8:9], v[12:13]
    v_pk_mul_f32 v[10:11], v[10:11], v[14:15]
    v_cvt_pk_bf16_f32 v12, v8, v9
    v_cvt_pk_bf16_f32 v13, v10, v11
    v_pk_fma_f32 v[242:243], v[176:177], v[206:207], v[188:189] op_sel_hi:[1,0,1]
    v_pk_fma_f32 v[244:245], v[178:179], v[206:207], v[190:191] op_sel_hi:[1,0,1]
    v_pk_fma_f32 v[20:21], v[20:21], v[204:205], v[242:243] op_sel_hi:[1,0,1]
    v_pk_fma_f32 v[22:23], v[22:23], v[204:205], v[244:245] op_sel_hi:[1,0,1]
    v_pk_fma_f32 v[238:239], v[180:181], v[206:207], v[192:193] op_sel_hi:[1,0,1]
    v_pk_fma_f32 v[240:241], v[182:183], v[206:207], v[194:195] op_sel_hi:[1,0,1]
    v_pk_fma_f32 v[24:25], v[24:25], v[204:205], v[238:239] op_sel_hi:[1,0,1]
    v_pk_fma_f32 v[26:27], v[26:27], v[204:205], v[240:241] op_sel_hi:[1,0,1]
    v_pk_mul_f32 v[20:21], v[20:21], v[24:25]
    v_pk_mul_f32 v[22:23], v[22:23], v[26:27]
    v_cvt_pk_bf16_f32 v14, v20, v21
    v_cvt_pk_bf16_f32 v15, v22, v23
    s_nop 0
    v_permlane16_swap_b32 v12, v14
    v_permlane16_swap_b32 v13, v15
    buffer_store_dwordx4 v[12:15], v173, s[36:39], s8 offen sc1
    v_pk_fma_f32 v[238:239], v[176:177], v[210:211], v[188:189] op_sel_hi:[1,0,1]
    v_pk_fma_f32 v[240:241], v[178:179], v[210:211], v[190:191] op_sel_hi:[1,0,1]
    v_pk_fma_f32 v[32:33], v[32:33], v[208:209], v[238:239] op_sel_hi:[1,0,1]
    v_pk_fma_f32 v[34:35], v[34:35], v[208:209], v[240:241] op_sel_hi:[1,0,1]
    v_pk_fma_f32 v[242:243], v[180:181], v[210:211], v[192:193] op_sel_hi:[1,0,1]
    v_pk_fma_f32 v[244:245], v[182:183], v[210:211], v[194:195] op_sel_hi:[1,0,1]
    v_pk_fma_f32 v[36:37], v[36:37], v[208:209], v[242:243] op_sel_hi:[1,0,1]
    v_pk_fma_f32 v[38:39], v[38:39], v[208:209], v[244:245] op_sel_hi:[1,0,1]
    v_pk_mul_f32 v[32:33], v[32:33], v[36:37]
    v_pk_mul_f32 v[34:35], v[34:35], v[38:39]
    v_cvt_pk_bf16_f32 v36, v32, v33
    v_cvt_pk_bf16_f32 v37, v34, v35
    v_pk_fma_f32 v[242:243], v[176:177], v[214:215], v[188:189] op_sel_hi:[1,0,1]
    v_pk_fma_f32 v[244:245], v[178:179], v[214:215], v[190:191] op_sel_hi:[1,0,1]
    v_pk_fma_f32 v[44:45], v[44:45], v[212:213], v[242:243] op_sel_hi:[1,0,1]
    v_pk_fma_f32 v[46:47], v[46:47], v[212:213], v[244:245] op_sel_hi:[1,0,1]
    v_pk_fma_f32 v[238:239], v[180:181], v[214:215], v[192:193] op_sel_hi:[1,0,1]
    v_pk_fma_f32 v[240:241], v[182:183], v[214:215], v[194:195] op_sel_hi:[1,0,1]
    v_pk_fma_f32 v[48:49], v[48:49], v[212:213], v[238:239] op_sel_hi:[1,0,1]
    v_pk_fma_f32 v[50:51], v[50:51], v[212:213], v[240:241] op_sel_hi:[1,0,1]
    v_pk_mul_f32 v[44:45], v[44:45], v[48:49]
    v_pk_mul_f32 v[46:47], v[46:47], v[50:51]
    v_cvt_pk_bf16_f32 v38, v44, v45
    v_cvt_pk_bf16_f32 v39, v46, v47
    s_nop 0
    v_permlane16_swap_b32 v36, v38
    v_permlane16_swap_b32 v37, v39
    buffer_store_dwordx4 v[36:39], v173, s[36:39], s50 offen sc1
    v_pk_fma_f32 v[238:239], v[184:185], v[202:203], v[196:197] op_sel_hi:[1,0,1]
    v_pk_fma_f32 v[240:241], v[186:187], v[202:203], v[198:199] op_sel_hi:[1,0,1]
    v_pk_fma_f32 v[16:17], v[16:17], v[200:201], v[238:239] op_sel_hi:[1,0,1]
    v_pk_fma_f32 v[18:19], v[18:19], v[200:201], v[240:241] op_sel_hi:[1,0,1]
    v_pk_fma_f32 v[242:243], v[184:185], v[206:207], v[196:197] op_sel_hi:[1,0,1]
    v_pk_fma_f32 v[244:245], v[186:187], v[206:207], v[198:199] op_sel_hi:[1,0,1]
    v_pk_fma_f32 v[28:29], v[28:29], v[204:205], v[242:243] op_sel_hi:[1,0,1]
    v_pk_fma_f32 v[30:31], v[30:31], v[204:205], v[244:245] op_sel_hi:[1,0,1]
    s_nop 0
    v_permlane32_swap_b32 v16, v28
    v_permlane32_swap_b32 v17, v29
    v_permlane32_swap_b32 v18, v30
    v_permlane32_swap_b32 v19, v31
    v_pk_mul_f32 v[16:17], v[16:17], v[28:29]
    v_pk_mul_f32 v[18:19], v[18:19], v[30:31]
    v_cvt_pk_bf16_f32 v8, v16, v17
    v_cvt_pk_bf16_f32 v9, v18, v19
    v_pk_fma_f32 v[238:239], v[184:185], v[210:211], v[196:197] op_sel_hi:[1,0,1]
    v_pk_fma_f32 v[240:241], v[186:187], v[210:211], v[198:199] op_sel_hi:[1,0,1]
    v_pk_fma_f32 v[40:41], v[40:41], v[208:209], v[238:239] op_sel_hi:[1,0,1]
    v_pk_fma_f32 v[42:43], v[42:43], v[208:209], v[240:241] op_sel_hi:[1,0,1]
    v_pk_fma_f32 v[242:243], v[184:185], v[214:215], v[196:197] op_sel_hi:[1,0,1]
    v_pk_fma_f32 v[244:245], v[186:187], v[214:215], v[198:199] op_sel_hi:[1,0,1]
    v_pk_fma_f32 v[52:53], v[52:53], v[212:213], v[242:243] op_sel_hi:[1,0,1]
    v_pk_fma_f32 v[54:55], v[54:55], v[212:213], v[244:245] op_sel_hi:[1,0,1]
    s_nop 0
    v_permlane32_swap_b32 v40, v52
    v_permlane32_swap_b32 v41, v53
    v_permlane32_swap_b32 v42, v54
    v_permlane32_swap_b32 v43, v55
    v_pk_mul_f32 v[40:41], v[40:41], v[52:53]
    v_pk_mul_f32 v[42:43], v[42:43], v[54:55]
    v_cvt_pk_bf16_f32 v10, v40, v41
    v_cvt_pk_bf16_f32 v11, v42, v43
    s_nop 0
    v_permlane16_swap_b32 v8, v10
    v_permlane16_swap_b32 v9, v11
    buffer_store_dwordx4 v[8:11], v174, s[36:39], s8 offen offset:512 sc1
    s_mov_b32 s40, s28
    s_mov_b32 s41, s29
    s_mov_b32 s42, 0x280000
    s_mov_b32 s43, 0x20000
    s_waitcnt vmcnt(14)
    v_mfma_f32_16x16x32_bf16 v[8:11], a[240:243], v[56:59], 0
    s_and_b32 s50, s3, 1
    s_lshr_b32 s51, s3, 1
    buffer_load_dwordx4 a[172:175], v248, s[36:39], s62 offen offset:3072 sc1
    v_mfma_f32_16x16x32_bf16 v[12:15], a[244:247], v[56:59], 0
    s_mul_i32 s52, s50, 20480
    s_mul_i32 s53, s3, 5120
    s_add_u32 s52, s52, s53
    v_mfma_f32_16x16x32_bf16 v[16:19], a[248:251], v[56:59], 0
    s_add_u32 s62, s62, 4096
    v_add_u32 v220, s52, v248
    v_add_u32 v222, 40960, v220
    v_mfma_f32_16x16x32_bf16 v[20:23], a[252:255], v[56:59], 0
    s_xor_b32 s52, s50, 1
    s_mul_i32 s52, s52, 20480
    s_add_u32 s52, s52, s53
    buffer_load_dwordx4 a[176:179], v248, s[36:39], s62 offen offset:0 sc1
    v_mfma_f32_16x16x32_bf16 v[24:27], v[136:139], v[56:59], 0
    s_waitcnt vmcnt(15)
    v_add_u32 v221, s52, v248
    v_add_u32 v223, 40960, v221
    v_mfma_f32_16x16x32_bf16 v[28:31], a[240:243], v[60:63], 0
    s_mul_i32 s52, s51, 20480
    s_lshl_b32 s53, s50, 11
    s_add_u32 s52, s52, s53
    v_add_u32 v224, s52, v248
    v_mfma_f32_16x16x32_bf16 v[32:35], a[244:247], v[60:63], 0
    buffer_load_dwordx4 v[56:59], v216, s[36:39], s4 offen offset:2048 sc1
    v_mfma_f32_16x16x32_bf16 v[36:39], a[248:251], v[60:63], 0
    s_mul_i32 s53, s51, 5120
    s_add_u32 s53, s53, 40960
    v_add_u32 v225, s53, v224
    v_mfma_f32_16x16x32_bf16 v[40:43], a[252:255], v[60:63], 0
    s_xor_b32 s53, s51, 1
    s_mul_i32 s53, s53, 5120
    s_add_u32 s53, s53, 40960
    v_add_u32 v226, s53, v224
    v_mfma_f32_16x16x32_bf16 v[44:47], v[136:139], v[60:63], 0
    s_waitcnt vmcnt(15)
    buffer_load_dwordx4 a[180:183], v248, s[36:39], s62 offen offset:1024 sc1
    v_mfma_f32_16x16x32_bf16 v[8:11], v[140:143], v[64:67], v[8:11]
    s_lshl_b32 s52, s74, 1
    s_add_u32 s52, s52, s51
    s_mul_i32 s12, s75, 320
    v_mfma_f32_16x16x32_bf16 v[12:15], v[144:147], v[64:67], v[12:15]
    s_add_u32 s12, s12, 23147008
    s_mul_i32 s13, s52, 20480
    s_mul_i32 s53, s75, 160
    s_add_u32 s13, s13, s53
    v_mfma_f32_16x16x32_bf16 v[16:19], v[148:151], v[64:67], v[16:19]
    s_lshl_b32 s53, s50, 6
    s_add_u32 s13, s13, s53
    s_add_u32 s14, s13, 1310720
    buffer_load_dwordx4 v[60:63], v217, s[36:39], s4 offen offset:2048 sc1
    v_mfma_f32_16x16x32_bf16 v[20:23], v[152:155], v[64:67], v[20:23]
    s_mul_i32 s10, s75, 10
    s_add_u32 s10, s10, s3
    v_mfma_f32_16x16x32_bf16 v[24:27], v[156:159], v[64:67], v[24:27]
    s_mul_i32 s10, s10, 32768
    s_lshl_b32 s53, s74, 6
    s_add_u32 s10, s10, s53
    s_add_u32 s10, s10, 0
    s_waitcnt vmcnt(16)
    v_mfma_f32_16x16x32_bf16 v[28:31], v[140:143], v[68:71], v[28:31]
    s_lshl_b32 s11, s3, 10
    s_add_u32 s11, s11, 81920
    v_lshrrev_b32 v2, 3, v1
    buffer_load_dwordx4 v[64:67], v216, s[36:39], s4 offen offset:3072 sc1
    v_mfma_f32_16x16x32_bf16 v[32:35], v[144:147], v[68:71], v[32:35]
    v_mul_u32_u24 v229, 4096, v2
    v_bfe_u32 v2, v1, 2, 1
    v_mfma_f32_16x16x32_bf16 v[36:39], v[148:151], v[68:71], v[36:39]
    v_lshl_add_u32 v229, v2, 11, v229
    v_and_b32 v2, 3, v1
    v_lshl_add_u32 v229, v2, 4, v229
    v_mfma_f32_16x16x32_bf16 v[40:43], v[152:155], v[68:71], v[40:43]
    buffer_load_dwordx4 a[184:187], v248, s[36:39], s62 offen offset:2048 sc1
    v_mfma_f32_16x16x32_bf16 v[44:47], v[156:159], v[68:71], v[44:47]
    s_waitcnt vmcnt(17)
    v_lshrrev_b32 v3, 2, v1
    v_lshlrev_b32 v231, 7, v3
    v_mfma_f32_16x16x32_bf16 v[8:11], v[160:163], v[72:75], v[8:11]
    s_barrier
    v_lshl_add_u32 v231, v2, 3, v231
    v_mfma_f32_16x16x32_bf16 v[12:15], v[164:167], v[72:75], v[12:15]
    s_lshl_b32 s53, s50, 12
    s_lshl_b32 s52, s51, 5
    s_add_u32 s53, s53, s52
    s_add_u32 s53, s53, 81920
    buffer_load_dwordx4 v[68:71], v217, s[36:39], s4 offen offset:3072 sc1
    v_mfma_f32_16x16x32_bf16 v[16:19], a[0:3], v[72:75], v[16:19]
    v_add_u32 v231, s53, v231
    v_and_b32 v2, 15, v1
    v_mfma_f32_16x16x32_bf16 v[20:23], a[4:7], v[72:75], v[20:23]
    v_lshrrev_b32 v3, 4, v1
    v_mul_u32_u24 v2, 1280, v2
    v_lshl_add_u32 v228, v3, 3, v2
    v_and_b32 v227, 1, v3
    v_mfma_f32_16x16x32_bf16 v[24:27], a[8:11], v[72:75], v[24:27]
    s_waitcnt vmcnt(17)
    buffer_load_dwordx4 a[188:191], v248, s[36:39], s62 offen offset:3072 sc1
    v_mfma_f32_16x16x32_bf16 v[28:31], v[160:163], v[76:79], v[28:31]
    v_lshl_add_u32 v2, v227, 5, v2
    v_lshrrev_b32 v3, 1, v3
    v_mfma_f32_16x16x32_bf16 v[32:35], v[164:167], v[76:79], v[32:35]
    v_lshl_add_u32 v227, v3, 4, v2
    v_mfma_f32_16x16x32_bf16 v[36:39], a[0:3], v[76:79], v[36:39]
    s_lshr_b32 s50, s74, 1
    s_lshl_b32 s50, s50, 2
    s_add_u32 s50, s50, s3
    s_lshl_b32 s50, s50, 9
    buffer_load_dwordx4 v[72:75], v216, s[36:39], s5 offen offset:0 sc1
    v_mfma_f32_16x16x32_bf16 v[40:43], a[4:7], v[76:79], v[40:43]
    s_add_u32 s50, s50, 121856
    v_min_u32 v246, 3, v1
    v_lshlrev_b32 v246, 7, v246
    v_mfma_f32_16x16x32_bf16 v[44:47], a[8:11], v[76:79], v[44:47]
    s_waitcnt vmcnt(18)
    v_add_u32 v246, s50, v246
    v_min_u32 v2, 23, v1
    v_mfma_f32_16x16x32_bf16 v[8:11], a[12:15], v[80:83], v[8:11]
    buffer_load_dwordx4 v[76:79], v217, s[36:39], s5 offen offset:0 sc1
    v_mfma_f32_16x16x32_bf16 v[12:15], a[16:19], v[80:83], v[12:15]
    v_lshlrev_b32 v244, 4, v2
    v_mov_b32 v3, 36160
    v_mfma_f32_16x16x32_bf16 v[16:19], a[20:23], v[80:83], v[16:19]
    v_cmp_lt_u32 vcc, 11, v2
    s_nop 1
    v_cndmask_b32 v3, 0, v3, vcc
    v_mfma_f32_16x16x32_bf16 v[20:23], a[24:27], v[80:83], v[20:23]
    s_and_b32 s53, s3, 1
    s_lshl_b32 s53, s53, 7
    v_add3_u32 v244, v244, v3, s53
    v_mfma_f32_16x16x32_bf16 v[24:27], a[28:31], v[80:83], v[24:27]
    s_lshl_b32 s15, s3, 10
    s_add_u32 s15, s15, 94208
    v_and_b32 v230, 48, v1
    v_add_u32 v230, s15, v230
    s_waitcnt vmcnt(18)
    v_mfma_f32_16x16x32_bf16 v[28:31], a[12:15], v[84:87], v[28:31]
    s_mov_b32 m0, s15
    buffer_load_dwordx4 v[80:83], v216, s[36:39], s5 offen offset:1024 sc1
    v_mfma_f32_16x16x32_bf16 v[32:35], a[16:19], v[84:87], v[32:35]
    buffer_load_dwordx4 v244, s[36:39], s12 offen sc1 lds
    v_mfma_f32_16x16x32_bf16 v[36:39], a[20:23], v[84:87], v[36:39]
    s_add_u32 m0, s11, 0
    v_mfma_f32_16x16x32_bf16 v[40:43], a[24:27], v[84:87], v[40:43]
    buffer_load_dwordx4 v229, s[36:39], s10 offen sc1 lds
    v_mfma_f32_16x16x32_bf16 v[44:47], a[28:31], v[84:87], v[44:47]
    s_waitcnt vmcnt(20)
    s_add_u32 s10, s10, 131072
    v_mfma_f32_16x16x32_bf16 v[8:11], a[32:35], v[88:91], v[8:11]
    s_waitcnt vmcnt(14)
    s_barrier
    s_cmp_eq_u32 s3, 0
    s_cbranch_scc0 L_wf29
    s_lshl_b32 s54, s76, 7
    s_add_u32 s54, s54, 23321600
    v_mov_b32 v254, 0
    v_mov_b32 v255, s48
    s_mov_b64 exec, 1
    buffer_store_dword v255, v254, s[36:39], s54 offen sc1
    s_mov_b64 exec, -1
L_wf29:
    s_add_u32 m0, s11, 4096
    v_mfma_f32_16x16x32_bf16 v[12:15], a[36:39], v[88:91], v[12:15]
    buffer_load_dwordx4 v229, s[36:39], s10 offen sc1 lds
    v_mfma_f32_16x16x32_bf16 v[16:19], a[40:43], v[88:91], v[16:19]
    s_add_u32 s10, s10, 131072
    v_mfma_f32_16x16x32_bf16 v[20:23], a[44:47], v[88:91], v[20:23]
    s_add_u32 m0, s11, 8192
    v_mfma_f32_16x16x32_bf16 v[24:27], a[48:51], v[88:91], v[24:27]
    buffer_load_dwordx4 v229, s[36:39], s10 offen sc1 lds
    v_mfma_f32_16x16x32_bf16 v[28:31], a[32:35], v[92:95], v[28:31]
    v_mfma_f32_16x16x32_bf16 v[32:35], a[36:39], v[92:95], v[32:35]
    v_mfma_f32_16x16x32_bf16 v[36:39], a[40:43], v[92:95], v[36:39]
    buffer_load_dwordx4 v[84:87], v217, s[36:39], s5 offen offset:1024 sc1
    v_mfma_f32_16x16x32_bf16 v[40:43], a[44:47], v[92:95], v[40:43]
    v_mfma_f32_16x16x32_bf16 v[44:47], a[48:51], v[92:95], v[44:47]
    v_mfma_f32_16x16x32_bf16 v[8:11], a[52:55], v[96:99], v[8:11]
    buffer_load_dwordx4 v[88:91], v216, s[36:39], s5 offen offset:2048 sc1
    v_mfma_f32_16x16x32_bf16 v[12:15], a[56:59], v[96:99], v[12:15]
    v_mfma_f32_16x16x32_bf16 v[16:19], a[60:63], v[96:99], v[16:19]
    v_mfma_f32_16x16x32_bf16 v[20:23], a[64:67], v[96:99], v[20:23]
    buffer_load_dwordx4 v[92:95], v217, s[36:39], s5 offen offset:2048 sc1
    v_mfma_f32_16x16x32_bf16 v[24:27], a[68:71], v[96:99], v[24:27]
    v_mfma_f32_16x16x32_bf16 v[28:31], a[52:55], v[100:103], v[28:31]
    v_mfma_f32_16x16x32_bf16 v[32:35], a[56:59], v[100:103], v[32:35]
    buffer_load_dwordx4 v[96:99], v216, s[36:39], s5 offen offset:3072 sc1
    v_mfma_f32_16x16x32_bf16 v[36:39], a[60:63], v[100:103], v[36:39]
    v_mfma_f32_16x16x32_bf16 v[40:43], a[64:67], v[100:103], v[40:43]
    v_mfma_f32_16x16x32_bf16 v[44:47], a[68:71], v[100:103], v[44:47]
    s_waitcnt vmcnt(17)
    v_mfma_f32_16x16x32_bf16 v[8:11], a[72:75], v[56:59], v[8:11]
    buffer_load_dwordx4 v[100:103], v217, s[36:39], s5 offen offset:3072 sc1
    v_mfma_f32_16x16x32_bf16 v[12:15], a[76:79], v[56:59], v[12:15]
    v_mfma_f32_16x16x32_bf16 v[16:19], a[80:83], v[56:59], v[16:19]
    v_mfma_f32_16x16x32_bf16 v[20:23], a[84:87], v[56:59], v[20:23]
    v_mfma_f32_16x16x32_bf16 v[24:27], a[88:91], v[56:59], v[24:27]
    s_waitcnt vmcnt(16)
    v_mfma_f32_16x16x32_bf16 v[28:31], a[72:75], v[60:63], v[28:31]
    v_mfma_f32_16x16x32_bf16 v[32:35], a[76:79], v[60:63], v[32:35]
    v_mfma_f32_16x16x32_bf16 v[36:39], a[80:83], v[60:63], v[36:39]
    v_mfma_f32_16x16x32_bf16 v[40:43], a[84:87], v[60:63], v[40:43]
    v_mfma_f32_16x16x32_bf16 v[44:47], a[88:91], v[60:63], v[44:47]
    s_waitcnt vmcnt(15)
    v_mfma_f32_16x16x32_bf16 v[8:11], a[92:95], v[64:67], v[8:11]
    v_mfma_f32_16x16x32_bf16 v[12:15], a[96:99], v[64:67], v[12:15]
    v_mfma_f32_16x16x32_bf16 v[16:19], a[100:103], v[64:67], v[16:19]
    v_mfma_f32_16x16x32_bf16 v[20:23], a[104:107], v[64:67], v[20:23]
    v_mfma_f32_16x16x32_bf16 v[24:27], a[108:111], v[64:67], v[24:27]
    s_waitcnt vmcnt(13)
    v_mfma_f32_16x16x32_bf16 v[28:31], a[92:95], v[68:71], v[28:31]
    v_mfma_f32_16x16x32_bf16 v[32:35], a[96:99], v[68:71], v[32:35]
    v_mfma_f32_16x16x32_bf16 v[36:39], a[100:103], v[68:71], v[36:39]
    v_mfma_f32_16x16x32_bf16 v[40:43], a[104:107], v[68:71], v[40:43]
    v_mfma_f32_16x16x32_bf16 v[44:47], a[108:111], v[68:71], v[44:47]
    s_waitcnt vmcnt(11)
    v_mfma_f32_16x16x32_bf16 v[8:11], a[112:115], v[72:75], v[8:11]
    buffer_load_dword v247, v246, s[36:39], s17 offen sc1
    v_mfma_f32_16x16x32_bf16 v[12:15], a[116:119], v[72:75], v[12:15]
    v_mfma_f32_16x16x32_bf16 v[16:19], a[120:123], v[72:75], v[16:19]
    v_mfma_f32_16x16x32_bf16 v[20:23], a[124:127], v[72:75], v[20:23]
    v_mfma_f32_16x16x32_bf16 v[24:27], a[128:131], v[72:75], v[24:27]
    s_waitcnt vmcnt(6)
    s_barrier
    ds_read_b64_tr_b16 v[180:181], v231 offset:0
    v_mfma_f32_16x16x32_bf16 v[28:31], a[112:115], v[76:79], v[28:31]
    ds_read_b64_tr_b16 v[182:183], v231 offset:2048
    v_mfma_f32_16x16x32_bf16 v[32:35], a[116:119], v[76:79], v[32:35]
    ds_read_b64_tr_b16 v[184:185], v231 offset:4096
    v_mfma_f32_16x16x32_bf16 v[36:39], a[120:123], v[76:79], v[36:39]
    ds_read_b64_tr_b16 v[186:187], v231 offset:64
    v_mfma_f32_16x16x32_bf16 v[40:43], a[124:127], v[76:79], v[40:43]
    ds_read_b64_tr_b16 v[188:189], v231 offset:2112
    v_mfma_f32_16x16x32_bf16 v[44:47], a[128:131], v[76:79], v[44:47]
    ds_read_b64_tr_b16 v[190:191], v231 offset:4160
    v_mfma_f32_16x16x32_bf16 v[8:11], a[132:135], v[80:83], v[8:11]
    ds_read_b128 v[48:51], v230 offset:0
    v_mfma_f32_16x16x32_bf16 v[12:15], a[136:139], v[80:83], v[12:15]
    ds_read_b128 v[52:55], v230 offset:64
    v_mfma_f32_16x16x32_bf16 v[16:19], a[140:143], v[80:83], v[16:19]
    ds_read_b128 v[124:127], v230 offset:128
    v_mfma_f32_16x16x32_bf16 v[20:23], a[144:147], v[80:83], v[20:23]
    ds_read_b128 v[168:171], v230 offset:192
    v_mfma_f32_16x16x32_bf16 v[24:27], a[148:151], v[80:83], v[24:27]
    s_waitcnt vmcnt(5)
    ds_read_b128 v[172:175], v230 offset:256
    v_mfma_f32_16x16x32_bf16 v[28:31], a[132:135], v[84:87], v[28:31]
    ds_read_b128 v[176:179], v230 offset:320
    v_mfma_f32_16x16x32_bf16 v[32:35], a[136:139], v[84:87], v[32:35]
    v_mfma_f32_16x16x32_bf16 v[36:39], a[140:143], v[84:87], v[36:39]
    s_waitcnt lgkmcnt(11)
    v_lshlrev_b32 v204, 16, v180
    s_waitcnt lgkmcnt(2)
    v_mul_f32 v204, v204, v168
    v_mfma_f32_16x16x32_bf16 v[40:43], a[144:147], v[84:87], v[40:43]
    v_and_b32 v205, 0xffff0000, v180
    v_mul_f32 v205, v205, v169
    v_mfma_f32_16x16x32_bf16 v[44:47], a[148:151], v[84:87], v[44:47]
    s_waitcnt vmcnt(4)
    v_lshlrev_b32 v206, 16, v181
    v_mul_f32 v206, v206, v170
    v_mfma_f32_16x16x32_bf16 v[8:11], a[152:155], v[88:91], v[8:11]
    v_and_b32 v207, 0xffff0000, v181
    v_mul_f32 v207, v207, v171
    v_mfma_f32_16x16x32_bf16 v[12:15], a[156:159], v[88:91], v[12:15]
    v_lshlrev_b32 v208, 16, v182
    s_waitcnt lgkmcnt(1)
    v_mul_f32 v208, v208, v172
    v_mfma_f32_16x16x32_bf16 v[16:19], a[160:163], v[88:91], v[16:19]
    v_and_b32 v209, 0xffff0000, v182
    v_mul_f32 v209, v209, v173
    v_mfma_f32_16x16x32_bf16 v[20:23], a[164:167], v[88:91], v[20:23]
    v_lshlrev_b32 v210, 16, v183
    v_mul_f32 v210, v210, v174
    v_mfma_f32_16x16x32_bf16 v[24:27], a[168:171], v[88:91], v[24:27]
    s_waitcnt vmcnt(3)
    v_and_b32 v211, 0xffff0000, v183
    v_mul_f32 v211, v211, v175
    v_mfma_f32_16x16x32_bf16 v[28:31], a[152:155], v[92:95], v[28:31]
    v_lshlrev_b32 v212, 16, v184
    s_waitcnt lgkmcnt(0)
    v_mul_f32 v212, v212, v176
    v_mfma_f32_16x16x32_bf16 v[32:35], a[156:159], v[92:95], v[32:35]
    v_and_b32 v213, 0xffff0000, v184
    v_mul_f32 v213, v213, v177
    v_mfma_f32_16x16x32_bf16 v[36:39], a[160:163], v[92:95], v[36:39]
    v_lshlrev_b32 v214, 16, v185
    v_mul_f32 v214, v214, v178
    v_mfma_f32_16x16x32_bf16 v[40:43], a[164:167], v[92:95], v[40:43]
    v_and_b32 v215, 0xffff0000, v185
    v_mul_f32 v215, v215, v179
    v_mfma_f32_16x16x32_bf16 v[44:47], a[168:171], v[92:95], v[44:47]
    s_waitcnt vmcnt(2)
    v_lshlrev_b32 v232, 16, v186
    v_mul_f32 v232, v232, v168
    v_mfma_f32_16x16x32_bf16 v[8:11], a[172:175], v[96:99], v[8:11]
    s_waitcnt vmcnt(0)
    v_cmp_ne_u32 vcc, s48, v247
    s_cbranch_vccnz L_chk30_slow
L_chk30_back:
    v_and_b32 v233, 0xffff0000, v186
    v_mfma_f32_16x16x32_bf16 v[12:15], a[176:179], v[96:99], v[12:15]
    buffer_load_dwordx4 v[56:59], v218, s[36:39], 0 offen offset:0 sc1
    v_mfma_f32_16x16x32_bf16 v[16:19], a[180:183], v[96:99], v[16:19]
    v_mul_f32 v233, v233, v169
    v_lshlrev_b32 v234, 16, v187
    v_mfma_f32_16x16x32_bf16 v[20:23], a[184:187], v[96:99], v[20:23]
    v_mul_f32 v234, v234, v170
    v_and_b32 v235, 0xffff0000, v187
    v_mfma_f32_16x16x32_bf16 v[24:27], a[188:191], v[96:99], v[24:27]
    buffer_load_dwordx4 v[60:63], v218, s[36:39], 0 offen offset:1024 sc1
    v_mfma_f32_16x16x32_bf16 v[28:31], a[172:175], v[100:103], v[28:31]
    v_mul_f32 v235, v235, v171
    v_lshlrev_b32 v236, 16, v188
    v_mfma_f32_16x16x32_bf16 v[32:35], a[176:179], v[100:103], v[32:35]
    v_mul_f32 v236, v236, v172
    v_and_b32 v237, 0xffff0000, v188
    v_mfma_f32_16x16x32_bf16 v[36:39], a[180:183], v[100:103], v[36:39]
    buffer_load_dwordx4 v[64:67], v218, s[36:39], 0 offen offset:2048 sc1
    v_mfma_f32_16x16x32_bf16 v[40:43], a[184:187], v[100:103], v[40:43]
    ds_write_b128 v220, v[8:11] offset:0
    v_mul_f32 v237, v237, v173
    v_lshlrev_b32 v238, 16, v189
    v_mfma_f32_16x16x32_bf16 v[44:47], a[188:191], v[100:103], v[44:47]
    s_waitcnt vmcnt(2)
    v_mul_f32 v238, v238, v174
    v_and_b32 v239, 0xffff0000, v189
    v_mfma_f32_16x16x32_bf16 v[104:107], a[240:243], v[56:59], 0
    buffer_load_dwordx4 v[68:71], v218, s[36:39], 0 offen offset:3072 sc1
    v_mfma_f32_16x16x32_bf16 v[108:111], a[244:247], v[56:59], 0
    ds_write_b128 v220, v[12:15] offset:1024
    v_mul_f32 v239, v239, v175
    v_lshlrev_b32 v240, 16, v190
    v_mfma_f32_16x16x32_bf16 v[112:115], a[248:251], v[56:59], 0
    v_mul_f32 v240, v240, v176
    v_and_b32 v241, 0xffff0000, v190
    v_mfma_f32_16x16x32_bf16 v[116:119], a[252:255], v[56:59], 0
    buffer_load_dwordx4 v[72:75], v218, s[36:39], s4 offen offset:0 sc1
    v_mfma_f32_16x16x32_bf16 v[120:123], v[136:139], v[56:59], 0
    s_waitcnt vmcnt(3)
    ds_write_b128 v220, v[16:19] offset:2048
    v_mul_f32 v241, v241, v177
    v_lshlrev_b32 v242, 16, v191
    v_mfma_f32_16x16x32_bf16 v[104:107], v[140:143], v[60:63], v[104:107]
    v_mul_f32 v242, v242, v178
    v_and_b32 v243, 0xffff0000, v191
    v_mfma_f32_16x16x32_bf16 v[108:111], v[144:147], v[60:63], v[108:111]
    buffer_load_dwordx4 v[76:79], v218, s[36:39], s4 offen offset:1024 sc1
    v_mfma_f32_16x16x32_bf16 v[112:115], v[148:151], v[60:63], v[112:115]
    ds_write_b128 v220, v[20:23] offset:3072
    v_mul_f32 v243, v243, v179
    v_mfma_f32_16x16x32_bf16 v[116:119], v[152:155], v[60:63], v[116:119]
    v_mfma_f32_16x16x32_bf16 v[120:123], v[156:159], v[60:63], v[120:123]
    s_waitcnt vmcnt(3)
    buffer_load_dwordx4 v[80:83], v218, s[36:39], s4 offen offset:2048 sc1
    v_mfma_f32_16x16x32_bf16 v[104:107], v[160:163], v[64:67], v[104:107]
    ds_write_b128 v220, v[24:27] offset:4096
    v_mfma_f32_16x16x32_bf16 v[108:111], v[164:167], v[64:67], v[108:111]
    v_mfma_f32_16x16x32_bf16 v[112:115], a[0:3], v[64:67], v[112:115]
    ds_write_b128 v221, v[28:31] offset:0
    buffer_load_dwordx4 v[84:87], v218, s[36:39], s4 offen offset:3072 sc1
    v_mfma_f32_16x16x32_bf16 v[116:119], a[4:7], v[64:67], v[116:119]
    v_mfma_f32_16x16x32_bf16 v[120:123], a[8:11], v[64:67], v[120:123]
    s_waitcnt vmcnt(4)
    ds_write_b128 v221, v[32:35] offset:1024
    v_mfma_f32_16x16x32_bf16 v[104:107], a[12:15], v[68:71], v[104:107]
    buffer_load_dwordx4 v[88:91], v218, s[36:39], s5 offen offset:0 sc1
    v_mfma_f32_16x16x32_bf16 v[108:111], a[16:19], v[68:71], v[108:111]
    ds_write_b128 v221, v[36:39] offset:2048
    v_mfma_f32_16x16x32_bf16 v[112:115], a[20:23], v[68:71], v[112:115]
    v_mfma_f32_16x16x32_bf16 v[116:119], a[24:27], v[68:71], v[116:119]
    buffer_load_dwordx4 v[92:95], v218, s[36:39], s5 offen offset:1024 sc1
    v_mfma_f32_16x16x32_bf16 v[120:123], a[28:31], v[68:71], v[120:123]
    s_waitcnt vmcnt(5)
    ds_write_b128 v221, v[40:43] offset:3072
    v_mfma_f32_16x16x32_bf16 v[104:107], a[32:35], v[72:75], v[104:107]
    v_mfma_f32_16x16x32_bf16 v[108:111], a[36:39], v[72:75], v[108:111]
    buffer_load_dwordx4 v[96:99], v218, s[36:39], s5 offen offset:2048 sc1
    v_mfma_f32_16x16x32_bf16 v[112:115], a[40:43], v[72:75], v[112:115]
    ds_write_b128 v221, v[44:47] offset:4096
    v_mfma_f32_16x16x32_bf16 v[116:119], a[44:47], v[72:75], v[116:119]
    v_mfma_f32_16x16x32_bf16 v[120:123], a[48:51], v[72:75], v[120:123]
    s_waitcnt vmcnt(5)
    buffer_load_dwordx4 v[100:103], v218, s[36:39], s5 offen offset:3072 sc1
    v_mfma_f32_16x16x32_bf16 v[104:107], a[52:55], v[76:79], v[104:107]
    v_mfma_f32_16x16x32_bf16 v[108:111], a[56:59], v[76:79], v[108:111]
    v_mfma_f32_16x16x32_bf16 v[112:115], a[60:63], v[76:79], v[112:115]
    buffer_load_dwordx4 v[56:59], v219, s[36:39], 0 offen offset:0 sc1
    v_mfma_f32_16x16x32_bf16 v[116:119], a[64:67], v[76:79], v[116:119]
    v_mfma_f32_16x16x32_bf16 v[120:123], a[68:71], v[76:79], v[120:123]
    s_waitcnt vmcnt(6)
    v_mfma_f32_16x16x32_bf16 v[104:107], a[72:75], v[80:83], v[104:107]
    buffer_load_dwordx4 v[60:63], v219, s[36:39], 0 offen offset:1024 sc1
    v_mfma_f32_16x16x32_bf16 v[108:111], a[76:79], v[80:83], v[108:111]
    s_waitcnt lgkmcnt(0)
    s_barrier
    ds_read_b128 v[168:171], v224 offset:0
    v_mfma_f32_16x16x32_bf16 v[112:115], a[80:83], v[80:83], v[112:115]
    ds_read_b128 v[172:175], v224 offset:1024
    v_mfma_f32_16x16x32_bf16 v[116:119], a[84:87], v[80:83], v[116:119]
    buffer_load_dwordx4 v[64:67], v219, s[36:39], 0 offen offset:2048 sc1
    v_mfma_f32_16x16x32_bf16 v[120:123], a[88:91], v[80:83], v[120:123]
    s_waitcnt vmcnt(7)
    ds_read_b128 v[176:179], v224 offset:2048
    v_mfma_f32_16x16x32_bf16 v[104:107], a[92:95], v[84:87], v[104:107]
    ds_read_b128 v[180:183], v224 offset:5120
    ds_read_b128 v[184:187], v224 offset:6144
    v_mfma_f32_16x16x32_bf16 v[108:111], a[96:99], v[84:87], v[108:111]
    buffer_load_dwordx4 v[68:71], v219, s[36:39], 0 offen offset:3072 sc1
    v_mfma_f32_16x16x32_bf16 v[112:115], a[100:103], v[84:87], v[112:115]
    ds_read_b128 v[188:191], v224 offset:7168
    v_mfma_f32_16x16x32_bf16 v[116:119], a[104:107], v[84:87], v[116:119]
    ds_read_b128 v[192:195], v224 offset:10240
    ds_read_b128 v[196:199], v224 offset:11264
    v_mfma_f32_16x16x32_bf16 v[120:123], a[108:111], v[84:87], v[120:123]
    s_waitcnt vmcnt(7)
    buffer_load_dwordx4 v[72:75], v219, s[36:39], s4 offen offset:0 sc1
    v_mfma_f32_16x16x32_bf16 v[104:107], a[112:115], v[88:91], v[104:107]
    ds_read_b128 v[200:203], v224 offset:12288
    v_mfma_f32_16x16x32_bf16 v[108:111], a[116:119], v[88:91], v[108:111]
    s_waitcnt lgkmcnt(5)
    v_add_f32 v168, v168, v180
    v_add_f32 v169, v169, v181
    v_add_f32 v170, v170, v182
    v_mfma_f32_16x16x32_bf16 v[112:115], a[120:123], v[88:91], v[112:115]
    buffer_load_dwordx4 v[76:79], v219, s[36:39], s4 offen offset:1024 sc1
    v_mfma_f32_16x16x32_bf16 v[116:119], a[124:127], v[88:91], v[116:119]
    v_add_f32 v171, v171, v183
    s_waitcnt lgkmcnt(4)
    v_add_f32 v172, v172, v184
    v_mfma_f32_16x16x32_bf16 v[120:123], a[128:131], v[88:91], v[120:123]
    s_waitcnt vmcnt(8)
    v_add_f32 v173, v173, v185
    v_add_f32 v174, v174, v186
    v_mfma_f32_16x16x32_bf16 v[104:107], a[132:135], v[92:95], v[104:107]
    buffer_load_dwordx4 v[80:83], v219, s[36:39], s4 offen offset:2048 sc1
    v_mfma_f32_16x16x32_bf16 v[108:111], a[136:139], v[92:95], v[108:111]
    v_add_f32 v175, v175, v187
    s_waitcnt lgkmcnt(3)
    v_add_f32 v176, v176, v188
    v_mfma_f32_16x16x32_bf16 v[112:115], a[140:143], v[92:95], v[112:115]
    v_add_f32 v177, v177, v189
    v_add_f32 v178, v178, v190
    v_add_f32 v179, v179, v191
    v_mfma_f32_16x16x32_bf16 v[116:119], a[144:147], v[92:95], v[116:119]
    buffer_load_dwordx4 v[84:87], v219, s[36:39], s4 offen offset:3072 sc1
    v_mfma_f32_16x16x32_bf16 v[120:123], a[148:151], v[92:95], v[120:123]
    s_waitcnt vmcnt(9)
    ds_read_b128 v[180:183], v224 offset:15360
    ds_read_b128 v[184:187], v224 offset:16384
    v_mfma_f32_16x16x32_bf16 v[104:107], a[152:155], v[96:99], v[104:107]
    ds_read_b128 v[188:191], v224 offset:17408
    s_waitcnt lgkmcnt(5)
    v_add_f32 v168, v168, v192
    v_add_f32 v169, v169, v193
    v_mfma_f32_16x16x32_bf16 v[108:111], a[156:159], v[96:99], v[108:111]
    buffer_load_dwordx4 v[88:91], v219, s[36:39], s5 offen offset:0 sc1
    v_mfma_f32_16x16x32_bf16 v[112:115], a[160:163], v[96:99], v[112:115]
    v_add_f32 v170, v170, v194
    v_add_f32 v171, v171, v195
    v_mfma_f32_16x16x32_bf16 v[116:119], a[164:167], v[96:99], v[116:119]
    s_waitcnt lgkmcnt(4)
    v_add_f32 v172, v172, v196
    v_add_f32 v173, v173, v197
    v_mfma_f32_16x16x32_bf16 v[120:123], a[168:171], v[96:99], v[120:123]
    s_waitcnt vmcnt(9)
    buffer_load_dwordx4 v[92:95], v219, s[36:39], s5 offen offset:1024 sc1
    v_mfma_f32_16x16x32_bf16 v[104:107], a[172:175], v[100:103], v[104:107]
    v_add_f32 v174, v174, v198
    v_add_f32 v175, v175, v199
    v_mfma_f32_16x16x32_bf16 v[108:111], a[176:179], v[100:103], v[108:111]
    s_waitcnt lgkmcnt(3)
    v_add_f32 v176, v176, v200
    v_add_f32 v177, v177, v201
    v_add_f32 v178, v178, v202
    v_mfma_f32_16x16x32_bf16 v[112:115], a[180:183], v[100:103], v[112:115]
    buffer_load_dwordx4 v[96:99], v219, s[36:39], s5 offen offset:2048 sc1
    v_mfma_f32_16x16x32_bf16 v[116:119], a[184:187], v[100:103], v[116:119]
    v_add_f32 v179, v179, v203
    s_waitcnt lgkmcnt(2)
    v_add_f32 v168, v168, v180
    v_mfma_f32_16x16x32_bf16 v[120:123], a[188:191], v[100:103], v[120:123]
    s_waitcnt vmcnt(10)
    v_add_f32 v169, v169, v181
    v_add_f32 v170, v170, v182
    v_add_f32 v171, v171, v183
    v_mfma_f32_16x16x32_bf16 v[8:11], a[240:243], v[56:59], 0
    buffer_load_dwordx4 v[100:103], v219, s[36:39], s5 offen offset:3072 sc1
    v_mfma_f32_16x16x32_bf16 v[12:15], a[244:247], v[56:59], 0
    s_waitcnt lgkmcnt(1)
    v_add_f32 v172, v172, v184
    v_add_f32 v173, v173, v185
    v_mfma_f32_16x16x32_bf16 v[16:19], a[248:251], v[56:59], 0
    v_add_f32 v174, v174, v186
    v_add_f32 v175, v175, v187
    v_mfma_f32_16x16x32_bf16 v[20:23], a[252:255], v[56:59], 0
    ds_write_b128 v222, v[104:107] offset:0
    s_waitcnt lgkmcnt(1)
    v_add_f32 v176, v176, v188
    v_add_f32 v177, v177, v189
    v_mfma_f32_16x16x32_bf16 v[24:27], v[136:139], v[56:59], 0
    s_waitcnt vmcnt(10)
    v_add_f32 v178, v178, v190
    v_add_f32 v179, v179, v191
    v_fma_f32 v204, v168, v48, v204
    v_mfma_f32_16x16x32_bf16 v[8:11], v[140:143], v[60:63], v[8:11]
    ds_write_b128 v222, v[108:111] offset:1024
    v_fma_f32 v205, v169, v49, v205
    v_fma_f32 v206, v170, v50, v206
    v_mfma_f32_16x16x32_bf16 v[12:15], v[144:147], v[60:63], v[12:15]
    v_fma_f32 v207, v171, v51, v207
    v_fma_f32 v208, v172, v52, v208
    v_mfma_f32_16x16x32_bf16 v[16:19], v[148:151], v[60:63], v[16:19]
    ds_write_b128 v222, v[112:115] offset:2048
    v_fma_f32 v209, v173, v53, v209
    v_fma_f32 v210, v174, v54, v210
    v_mfma_f32_16x16x32_bf16 v[20:23], v[152:155], v[60:63], v[20:23]
    v_fma_f32 v211, v175, v55, v211
    v_fma_f32 v212, v176, v124, v212
    v_mfma_f32_16x16x32_bf16 v[24:27], v[156:159], v[60:63], v[24:27]
    s_waitcnt vmcnt(9)
    ds_write_b128 v222, v[116:119] offset:3072
    v_fma_f32 v213, v177, v125, v213
    v_fma_f32 v214, v178, v126, v214
    v_mfma_f32_16x16x32_bf16 v[8:11], v[160:163], v[64:67], v[8:11]
    v_fma_f32 v215, v179, v127, v215
    v_cvt_pk_bf16_f32 v180, v204, v205
    v_mfma_f32_16x16x32_bf16 v[12:15], v[164:167], v[64:67], v[12:15]
    v_cvt_pk_bf16_f32 v181, v206, v207
    v_cvt_pk_bf16_f32 v182, v208, v209
    v_mfma_f32_16x16x32_bf16 v[16:19], a[0:3], v[64:67], v[16:19]
    v_cvt_pk_bf16_f32 v183, v210, v211
    v_cvt_pk_bf16_f32 v184, v212, v213
    v_mfma_f32_16x16x32_bf16 v[20:23], a[4:7], v[64:67], v[20:23]
    ds_write_b128 v222, v[120:123] offset:4096
    v_cvt_pk_bf16_f32 v185, v214, v215
    v_mfma_f32_16x16x32_bf16 v[24:27], a[8:11], v[64:67], v[24:27]
    s_waitcnt vmcnt(8)
    v_permlane16_swap_b32 v180, v182
    v_mfma_f32_16x16x32_bf16 v[8:11], a[12:15], v[68:71], v[8:11]
    v_permlane16_swap_b32 v181, v183
    v_mfma_f32_16x16x32_bf16 v[12:15], a[16:19], v[68:71], v[12:15]
    buffer_store_dwordx4 v[180:183], v227, s[40:43], s13 offen
    v_mfma_f32_16x16x32_bf16 v[16:19], a[20:23], v[68:71], v[16:19]
    buffer_store_dwordx2 v[184:185], v228, s[40:43], s13 offen offset:64
    v_mfma_f32_16x16x32_bf16 v[20:23], a[24:27], v[68:71], v[20:23]
    v_mfma_f32_16x16x32_bf16 v[24:27], a[28:31], v[68:71], v[24:27]
    s_waitcnt vmcnt(9)
    v_mfma_f32_16x16x32_bf16 v[8:11], a[32:35], v[72:75], v[8:11]
    v_mfma_f32_16x16x32_bf16 v[12:15], a[36:39], v[72:75], v[12:15]
    s_waitcnt lgkmcnt(0)
    s_barrier
    ds_read_b128 v[168:171], v225 offset:0
    v_mfma_f32_16x16x32_bf16 v[16:19], a[40:43], v[72:75], v[16:19]
    ds_read_b128 v[172:175], v225 offset:1024
    v_mfma_f32_16x16x32_bf16 v[20:23], a[44:47], v[72:75], v[20:23]
    ds_read_b128 v[176:179], v225 offset:2048
    v_mfma_f32_16x16x32_bf16 v[24:27], a[48:51], v[72:75], v[24:27]
    s_waitcnt vmcnt(8)
    ds_read_b128 v[192:195], v225 offset:10240
    v_mfma_f32_16x16x32_bf16 v[8:11], a[52:55], v[76:79], v[8:11]
    ds_read_b128 v[196:199], v225 offset:11264
    v_mfma_f32_16x16x32_bf16 v[12:15], a[56:59], v[76:79], v[12:15]
    ds_read_b128 v[200:203], v225 offset:12288
    v_mfma_f32_16x16x32_bf16 v[16:19], a[60:63], v[76:79], v[16:19]
    v_mfma_f32_16x16x32_bf16 v[20:23], a[64:67], v[76:79], v[20:23]
    v_mfma_f32_16x16x32_bf16 v[24:27], a[68:71], v[76:79], v[24:27]
    s_waitcnt vmcnt(7)
    v_mfma_f32_16x16x32_bf16 v[8:11], a[72:75], v[80:83], v[8:11]
    v_mfma_f32_16x16x32_bf16 v[12:15], a[76:79], v[80:83], v[12:15]
    v_mfma_f32_16x16x32_bf16 v[16:19], a[80:83], v[80:83], v[16:19]
    v_mfma_f32_16x16x32_bf16 v[20:23], a[84:87], v[80:83], v[20:23]
    s_waitcnt lgkmcnt(2)
    v_add_f32 v168, v168, v192
    v_add_f32 v169, v169, v193
    v_mfma_f32_16x16x32_bf16 v[24:27], a[88:91], v[80:83], v[24:27]
    s_waitcnt vmcnt(6)
    v_add_f32 v170, v170, v194
    v_add_f32 v171, v171, v195
    v_mfma_f32_16x16x32_bf16 v[8:11], a[92:95], v[84:87], v[8:11]
    s_waitcnt lgkmcnt(1)
    v_add_f32 v172, v172, v196
    v_add_f32 v173, v173, v197
    v_mfma_f32_16x16x32_bf16 v[12:15], a[96:99], v[84:87], v[12:15]
    v_add_f32 v174, v174, v198
    v_add_f32 v175, v175, v199
    v_mfma_f32_16x16x32_bf16 v[16:19], a[100:103], v[84:87], v[16:19]
    s_waitcnt lgkmcnt(0)
    v_add_f32 v176, v176, v200
    v_add_f32 v177, v177, v201
    v_mfma_f32_16x16x32_bf16 v[20:23], a[104:107], v[84:87], v[20:23]
    v_add_f32 v178, v178, v202
    v_add_f32 v179, v179, v203
    v_mfma_f32_16x16x32_bf16 v[24:27], a[108:111], v[84:87], v[24:27]
    s_waitcnt vmcnt(5)
    v_fma_f32 v232, v168, v48, v232
    v_fma_f32 v233, v169, v49, v233
    v_mfma_f32_16x16x32_bf16 v[8:11], a[112:115], v[88:91], v[8:11]
    s_waitcnt vmcnt(4)
    v_fma_f32 v234, v170, v50, v234
    v_fma_f32 v235, v171, v51, v235
    v_mfma_f32_16x16x32_bf16 v[8:11], a[132:135], v[92:95], v[8:11]
    s_waitcnt vmcnt(3)
    v_fma_f32 v236, v172, v52, v236
    v_fma_f32 v237, v173, v53, v237
    v_mfma_f32_16x16x32_bf16 v[8:11], a[152:155], v[96:99], v[8:11]
    s_waitcnt vmcnt(2)
    v_fma_f32 v238, v174, v54, v238
    v_fma_f32 v239, v175, v55, v239
    v_mfma_f32_16x16x32_bf16 v[8:11], a[172:175], v[100:103], v[8:11]
    v_fma_f32 v240, v176, v124, v240
    v_fma_f32 v241, v177, v125, v241
    v_mfma_f32_16x16x32_bf16 v[12:15], a[116:119], v[88:91], v[12:15]
    v_fma_f32 v242, v178, v126, v242
    v_fma_f32 v243, v179, v127, v243
    v_mfma_f32_16x16x32_bf16 v[12:15], a[136:139], v[92:95], v[12:15]
    v_mfma_f32_16x16x32_bf16 v[12:15], a[156:159], v[96:99], v[12:15]
    s_nop 0
    ds_write_b128 v223, v[8:11] offset:0
    v_mfma_f32_16x16x32_bf16 v[12:15], a[176:179], v[100:103], v[12:15]
    v_mfma_f32_16x16x32_bf16 v[16:19], a[120:123], v[88:91], v[16:19]
    v_mfma_f32_16x16x32_bf16 v[16:19], a[140:143], v[92:95], v[16:19]
    v_mfma_f32_16x16x32_bf16 v[16:19], a[160:163], v[96:99], v[16:19]
    s_nop 4
    ds_write_b128 v223, v[12:15] offset:1024
    v_mfma_f32_16x16x32_bf16 v[16:19], a[180:183], v[100:103], v[16:19]
    v_mfma_f32_16x16x32_bf16 v[20:23], a[124:127], v[88:91], v[20:23]
    v_mfma_f32_16x16x32_bf16 v[20:23], a[144:147], v[92:95], v[20:23]
    v_mfma_f32_16x16x32_bf16 v[20:23], a[164:167], v[96:99], v[20:23]
    s_nop 4
    ds_write_b128 v223, v[16:19] offset:2048
    v_mfma_f32_16x16x32_bf16 v[20:23], a[184:187], v[100:103], v[20:23]
    v_mfma_f32_16x16x32_bf16 v[24:27], a[128:131], v[88:91], v[24:27]
    v_mfma_f32_16x16x32_bf16 v[24:27], a[148:151], v[92:95], v[24:27]
    v_mfma_f32_16x16x32_bf16 v[24:27], a[168:171], v[96:99], v[24:27]
    s_nop 4
    ds_write_b128 v223, v[20:23] offset:3072
    v_mfma_f32_16x16x32_bf16 v[24:27], a[188:191], v[100:103], v[24:27]
    s_nop 7
    ds_write_b128 v223, v[24:27] offset:4096
    s_waitcnt lgkmcnt(0)
    s_barrier
    ds_read_b128 v[168:171], v226 offset:0
    ds_read_b128 v[172:175], v226 offset:1024
    ds_read_b128 v[176:179], v226 offset:2048
    ds_read_b128 v[180:183], v226 offset:10240
    ds_read_b128 v[184:187], v226 offset:11264
    ds_read_b128 v[188:191], v226 offset:12288
    s_waitcnt lgkmcnt(2)
    v_pk_add_f32 v[168:169], v[168:169], v[180:181]
    v_pk_add_f32 v[170:171], v[170:171], v[182:183]
    s_waitcnt lgkmcnt(1)
    v_pk_add_f32 v[172:173], v[172:173], v[184:185]
    v_pk_add_f32 v[174:175], v[174:175], v[186:187]
    s_waitcnt lgkmcnt(0)
    v_pk_add_f32 v[176:177], v[176:177], v[188:189]
    v_pk_add_f32 v[178:179], v[178:179], v[190:191]
    v_pk_fma_f32 v[232:233], v[168:169], v[48:49], v[232:233]
    v_pk_fma_f32 v[234:235], v[170:171], v[50:51], v[234:235]
    v_pk_fma_f32 v[236:237], v[172:173], v[52:53], v[236:237]
    v_pk_fma_f32 v[238:239], v[174:175], v[54:55], v[238:239]
    v_pk_fma_f32 v[240:241], v[176:177], v[124:125], v[240:241]
    v_pk_fma_f32 v[242:243], v[178:179], v[126:127], v[242:243]
    v_cvt_pk_bf16_f32 v168, v232, v233
    v_cvt_pk_bf16_f32 v169, v234, v235
    v_cvt_pk_bf16_f32 v170, v236, v237
    v_cvt_pk_bf16_f32 v171, v238, v239
    v_cvt_pk_bf16_f32 v172, v240, v241
    v_cvt_pk_bf16_f32 v173, v242, v243
    v_permlane16_swap_b32 v168, v170
    v_permlane16_swap_b32 v169, v171
    buffer_store_dwordx4 v[168:171], v227, s[40:43], s14 offen
    buffer_store_dwordx2 v[172:173], v228, s[40:43], s14 offen offset:64
    s_endpgm
L_end:
    s_endpgm
L_m_slow:
    buffer_load_dwordx2 v[232:233], v253, s[36:39], s55 offen sc1
    s_waitcnt vmcnt(0)
    v_cmp_ne_u32 vcc, s48, v233
    s_cbranch_vccz L_m_back
    s_cmp_eq_u32 s49, 0
    s_cbranch_scc1 L_m_back
    s_sub_u32 s49, s49, 1
    s_sleep 1
    s_branch L_m_slow
L_stc0_slow:
    s_add_u32 m0, s63, 1024
    s_nop 0
    buffer_load_dwordx4 v248, s[36:39], s6 offen sc1 lds
    s_waitcnt vmcnt(0)
    ds_read_b128 v[200:203], v175 offset:1024
    ds_read_b128 v[204:207], v175 offset:1280
    ds_read_b128 v[208:211], v175 offset:1536
    ds_read_b128 v[212:215], v175 offset:1792
    s_waitcnt lgkmcnt(3)
    v_xor_b32 v3, s48, v201
    v_bitop3_b32 v3, v203, s48, v3 bitop3:0xbe
    s_waitcnt lgkmcnt(2)
    v_bitop3_b32 v3, v205, s48, v3 bitop3:0xbe
    v_bitop3_b32 v3, v207, s48, v3 bitop3:0xbe
    s_waitcnt lgkmcnt(1)
    v_bitop3_b32 v3, v209, s48, v3 bitop3:0xbe
    v_bitop3_b32 v3, v211, s48, v3 bitop3:0xbe
    s_waitcnt lgkmcnt(0)
    v_bitop3_b32 v3, v213, s48, v3 bitop3:0xbe
    v_bitop3_b32 v3, v215, s48, v3 bitop3:0xbe
    v_cmp_ne_u32 vcc, 0, v3
    s_cbranch_vccz L_stc0_back
    s_cmp_eq_u32 s49, 0
    s_cbranch_scc1 L_stc0_back
    s_sub_u32 s49, s49, 1
    s_branch L_stc0_slow
L_stc1_slow:
    s_add_u32 m0, s63, 1024
    s_nop 0
    buffer_load_dwordx4 v248, s[36:39], s6 offen sc1 lds
    s_waitcnt vmcnt(0)
    ds_read_b128 v[200:203], v175 offset:1024
    ds_read_b128 v[204:207], v175 offset:1280
    ds_read_b128 v[208:211], v175 offset:1536
    ds_read_b128 v[212:215], v175 offset:1792
    s_waitcnt lgkmcnt(3)
    v_xor_b32 v3, s48, v201
    v_bitop3_b32 v3, v203, s48, v3 bitop3:0xbe
    s_waitcnt lgkmcnt(2)
    v_bitop3_b32 v3, v205, s48, v3 bitop3:0xbe
    v_bitop3_b32 v3, v207, s48, v3 bitop3:0xbe
    s_waitcnt lgkmcnt(1)
    v_bitop3_b32 v3, v209, s48, v3 bitop3:0xbe
    v_bitop3_b32 v3, v211, s48, v3 bitop3:0xbe
    s_waitcnt lgkmcnt(0)
    v_bitop3_b32 v3, v213, s48, v3 bitop3:0xbe
    v_bitop3_b32 v3, v215, s48, v3 bitop3:0xbe
    v_cmp_ne_u32 vcc, 0, v3
    s_cbranch_vccz L_stc1_back
    s_cmp_eq_u32 s49, 0
    s_cbranch_scc1 L_stc1_back
    s_sub_u32 s49, s49, 1
    s_branch L_stc1_slow
L_stp0_slow:
    s_add_u32 m0, s63, 1024
    s_nop 0
    buffer_load_dwordx4 v248, s[36:39], s6 offen sc1 lds
    s_waitcnt vmcnt(0)
    ds_read_b128 v[200:203], v175 offset:1024
    ds_read_b128 v[204:207], v175 offset:1280
    ds_read_b128 v[208:211], v175 offset:1536
    ds_read_b128 v[212:215], v175 offset:1792
    s_waitcnt lgkmcnt(3)
    v_xor_b32 v3, s48, v201
    v_bitop3_b32 v3, v203, s48, v3 bitop3:0xbe
    s_waitcnt lgkmcnt(2)
    v_bitop3_b32 v3, v205, s48, v3 bitop3:0xbe
    v_bitop3_b32 v3, v207, s48, v3 bitop3:0xbe
    s_waitcnt lgkmcnt(1)
    v_bitop3_b32 v3, v209, s48, v3 bitop3:0xbe
    v_bitop3_b32 v3, v211, s48, v3 bitop3:0xbe
    s_waitcnt lgkmcnt(0)
    v_bitop3_b32 v3, v213, s48, v3 bitop3:0xbe
    v_bitop3_b32 v3, v215, s48, v3 bitop3:0xbe
    v_cmp_ne_u32 vcc, 0, v3
    s_cbranch_vccz L_stp0_back
    s_cmp_eq_u32 s49, 0
    s_cbranch_scc1 L_stp0_back
    s_sub_u32 s49, s49, 1
    s_branch L_stp0_slow
L_stp1_slow:
    s_add_u32 m0, s63, 1024
    s_nop 0
    buffer_load_dwordx4 v248, s[36:39], s6 offen sc1 lds
    s_waitcnt vmcnt(0)
    ds_read_b128 v[200:203], v175 offset:1024
    ds_read_b128 v[204:207], v175 offset:1280
    ds_read_b128 v[208:211], v175 offset:1536
    ds_read_b128 v[212:215], v175 offset:1792
    s_waitcnt lgkmcnt(3)
    v_xor_b32 v3, s48, v201
    v_bitop3_b32 v3, v203, s48, v3 bitop3:0xbe
    s_waitcnt lgkmcnt(2)
    v_bitop3_b32 v3, v205, s48, v3 bitop3:0xbe
    v_bitop3_b32 v3, v207, s48, v3 bitop3:0xbe
    s_waitcnt lgkmcnt(1)
    v_bitop3_b32 v3, v209, s48, v3 bitop3:0xbe
    v_bitop3_b32 v3, v211, s48, v3 bitop3:0xbe
    s_waitcnt lgkmcnt(0)
    v_bitop3_b32 v3, v213, s48, v3 bitop3:0xbe
    v_bitop3_b32 v3, v215, s48, v3 bitop3:0xbe
    v_cmp_ne_u32 vcc, 0, v3
    s_cbranch_vccz L_stp1_back
    s_cmp_eq_u32 s49, 0
    s_cbranch_scc1 L_stp1_back
    s_sub_u32 s49, s49, 1
    s_branch L_stp1_slow
L_chk4_slow:
L_poll31:
    buffer_load_dword v243, v240, s[36:39], s69 offen sc1
    s_waitcnt vmcnt(0)
    v_cmp_ne_u32 vcc, s48, v243
    s_cbranch_vccz L_poll31_ok
    s_cmp_eq_u32 s49, 0
    s_cbranch_scc1 L_poll31_ok
    s_sub_u32 s49, s49, 1
    s_sleep 1
    s_branch L_poll31
L_poll31_ok:
    s_branch L_chk4_back
L_chk6_slow:
L_poll32:
    buffer_load_dword v243, v241, s[36:39], s60 offen sc1
    s_waitcnt vmcnt(0)
    v_cmp_ne_u32 vcc, s48, v243
    s_cbranch_vccz L_poll32_ok
    s_cmp_eq_u32 s49, 0
    s_cbranch_scc1 L_poll32_ok
    s_sub_u32 s49, s49, 1
    s_sleep 1
    s_branch L_poll32
L_poll32_ok:
    s_branch L_chk6_back
L_chk7_slow:
L_poll33:
    buffer_load_dword v223, v219, s[36:39], s17 offen sc1
    s_waitcnt vmcnt(0)
    v_cmp_ne_u32 vcc, s48, v223
    s_cbranch_vccz L_poll33_ok
    s_cmp_eq_u32 s49, 0
    s_cbranch_scc1 L_poll33_ok
    s_sub_u32 s49, s49, 1
    s_sleep 1
    s_branch L_poll33
L_poll33_ok:
    s_branch L_chk7_back
L_chk9_slow:
L_poll34:
    buffer_load_dword v244, v243, s[36:39], s58 offen sc1
    s_waitcnt vmcnt(0)
    v_cmp_ne_u32 vcc, s48, v244
    s_cbranch_vccz L_poll34_ok
    s_cmp_eq_u32 s49, 0
    s_cbranch_scc1 L_poll34_ok
    s_sub_u32 s49, s49, 1
    s_sleep 1
    s_branch L_poll34
L_poll34_ok:
    s_branch L_chk9_back
L_chk10_slow:
L_poll35:
    buffer_load_dword v240, v219, s[36:39], s17 offen sc1
    s_waitcnt vmcnt(0)
    v_cmp_ne_u32 vcc, s48, v240
    s_cbranch_vccz L_poll35_ok
    s_cmp_eq_u32 s49, 0
    s_cbranch_scc1 L_poll35_ok
    s_sub_u32 s49, s49, 1
    s_sleep 1
    s_branch L_poll35
L_poll35_ok:
    s_branch L_chk10_back
L_chk12_slow:
L_poll36:
    buffer_load_dword v247, v246, s[36:39], s17 offen sc1
    s_waitcnt vmcnt(0)
    v_cmp_ne_u32 vcc, s48, v247
    s_cbranch_vccz L_poll36_ok
    s_cmp_eq_u32 s49, 0
    s_cbranch_scc1 L_poll36_ok
    s_sub_u32 s49, s49, 1
    s_sleep 1
    s_branch L_poll36
L_poll36_ok:
    s_branch L_chk12_back
L_chk14_slow:
L_poll37:
    buffer_load_dword v247, v246, s[36:39], s17 offen sc1
    s_waitcnt vmcnt(0)
    v_cmp_ne_u32 vcc, s48, v247
    s_cbranch_vccz L_poll37_ok
    s_cmp_eq_u32 s49, 0
    s_cbranch_scc1 L_poll37_ok
    s_sub_u32 s49, s49, 1
    s_sleep 1
    s_branch L_poll37
L_poll37_ok:
    s_branch L_chk14_back
L_chk20_slow:
L_poll38:
    buffer_load_dword v241, v240, s[36:39], s66 offen sc1
    s_waitcnt vmcnt(0)
    v_cmp_ne_u32 vcc, s48, v241
    s_cbranch_vccz L_poll38_ok
    s_cmp_eq_u32 s49, 0
    s_cbranch_scc1 L_poll38_ok
    s_sub_u32 s49, s49, 1
    s_sleep 1
    s_branch L_poll38
L_poll38_ok:
    s_branch L_chk20_back
L_chk25_slow:
L_poll39:
    buffer_load_dword v244, v243, s[36:39], s58 offen sc1
    s_waitcnt vmcnt(0)
    v_cmp_ne_u32 vcc, s48, v244
    s_cbranch_vccz L_poll39_ok
    s_cmp_eq_u32 s49, 0
    s_cbranch_scc1 L_poll39_ok
    s_sub_u32 s49, s49, 1
    s_sleep 1
    s_branch L_poll39
L_poll39_ok:
    s_branch L_chk25_back
L_chk26_slow:
L_poll40:
    buffer_load_dword v240, v219, s[36:39], s17 offen sc1
    s_waitcnt vmcnt(0)
    v_cmp_ne_u32 vcc, s48, v240
    s_cbranch_vccz L_poll40_ok
    s_cmp_eq_u32 s49, 0
    s_cbranch_scc1 L_poll40_ok
    s_sub_u32 s49, s49, 1
    s_sleep 1
    s_branch L_poll40
L_poll40_ok:
    s_branch L_chk26_back
L_chk28_slow:
L_poll41:
    buffer_load_dword v247, v246, s[36:39], s17 offen sc1
    s_waitcnt vmcnt(0)
    v_cmp_ne_u32 vcc, s48, v247
    s_cbranch_vccz L_poll41_ok
    s_cmp_eq_u32 s49, 0
    s_cbranch_scc1 L_poll41_ok
    s_sub_u32 s49, s49, 1
    s_sleep 1
    s_branch L_poll41
L_poll41_ok:
    s_branch L_chk28_back
L_chk30_slow:
L_poll42:
    buffer_load_dword v247, v246, s[36:39], s17 offen sc1
    s_waitcnt vmcnt(0)
    v_cmp_ne_u32 vcc, s48, v247
    s_cbranch_vccz L_poll42_ok
    s_cmp_eq_u32 s49, 0
    s_cbranch_scc1 L_poll42_ok
    s_sub_u32 s49, s49, 1
    s_sleep 1
    s_branch L_poll42
L_poll42_ok:
    s_branch L_chk30_back
L_code_end:
.if L_code_end-L_pc0 > 98304
.error "the code prefetch does not cover the kernel"
.endif
.section .rodata,"a"
.p2align 6
.amdhsa_kernel adaLN_cond__ssm_conv_h3__glu_gated_bilinear__prompt_kernel
  .amdhsa_next_free_vgpr 512
  .amdhsa_next_free_sgpr 102
  .amdhsa_accum_offset 256
  .amdhsa_group_segment_fixed_size 0
  .amdhsa_kernarg_size 120
  .amdhsa_user_sgpr_count 2
  .amdhsa_user_sgpr_kernarg_segment_ptr 1
  .amdhsa_system_sgpr_workgroup_id_x 1
.end_amdhsa_kernel
```

```asm
; @launch grid=(256,1,1) block=(256,1,1) lds=163840
.amdgcn_target "amdgcn-amd-amdhsa--gfx950"
.text
.globl adaLN_cond__ssm_conv_h3__glu_gated_bilinear__prompt_kernel
.p2align 8
.type adaLN_cond__ssm_conv_h3__glu_gated_bilinear__prompt_kernel,@function
adaLN_cond__ssm_conv_h3__glu_gated_bilinear__prompt_kernel:
    s_load_dwordx16 s[4:19], s[0:1], 0
    s_load_dwordx8 s[20:27], s[0:1], 64
    s_load_dwordx4 s[28:31], s[0:1], 96
    s_load_dwordx2 s[32:33], s[0:1], 112
    s_cmp_ge_u32 s2, 256
    s_cbranch_scc1 L_end
    v_lshrrev_b32 v1, 6, v0
    s_lshr_b32 s51, s2, 3
    s_mov_b32 s43, 0x20000
    v_readfirstlane_b32 s3, v1
    v_and_b32 v1, 63, v0
    s_and_b32 s50, s2, 7
    s_mov_b32 s47, s43
    s_sub_u32 s71, s2, 160
    s_cbranch_scc0 L_e_prep
    s_mul_i32 s52, s50, 327680
    s_lshl_b32 s53, s51, 7
    s_add_u32 s52, s52, s53
    s_cmp_ge_u32 s51, 10
    s_cselect_b32 s53, 162560, 0
    s_add_u32 s52, s52, s53
    v_lshrrev_b32 v3, 3, v1
    v_mul_u32_u24 v3, 1280, v3
    v_and_b32 v4, 7, v1
    v_lshl_add_u32 v3, v4, 4, v3
    s_mul_i32 s53, s3, 40960
    s_add_u32 s53, s53, s52
    s_mul_i32 s54, s3, 4352
    s_movk_i32 s55, 9152
    v_add_u32 v10, s55, v3
    v_add_u32 v11, s55, v10
    v_add_u32 v12, s55, v11
    s_add_u32 m0, s54, 26624
    s_mov_b32 s42, 2621440
    s_mov_b32 s46, s42
    s_waitcnt lgkmcnt(0)
    s_mov_b64 s[40:41], s[6:7]
    s_mov_b64 s[44:45], s[8:9]
    buffer_load_dwordx4 v3, s[40:43], s53 offen offset:0 nt lds
    buffer_load_dwordx4 v10, s[40:43], s53 offen offset:1088 nt lds
    buffer_load_dwordx4 v11, s[40:43], s53 offen offset:2176 nt lds
    buffer_load_dwordx4 v12, s[40:43], s53 offen offset:3264 nt lds
    s_add_u32 m0, s54, 44032
    s_sub_u32 s55, s52, 10240
    buffer_load_dwordx4 v3, s[44:47], s53 offen offset:0 nt lds
    buffer_load_dwordx4 v10, s[44:47], s53 offen offset:1088 nt lds
    buffer_load_dwordx4 v11, s[44:47], s53 offen offset:2176 nt lds
    buffer_load_dwordx4 v12, s[44:47], s53 offen offset:3264 nt lds
    v_add_u32 v5, s55, v3
    s_cmp_eq_u32 s3, 0
    s_cbranch_scc0 L_nohalo
    s_mov_b32 m0, 25536
    s_nop 0
    buffer_load_dwordx4 v5, s[40:43], 0 offen nt lds
L_nohalo:
    s_cmp_ge_u32 s51, 10
    s_cselect_b32 s55, 10, 0
    s_sub_u32 s55, s51, s55
    s_lshl_b32 s55, s55, 1
    s_and_b32 s56, s3, 1
    s_add_u32 s55, s55, s56
    s_lshl_b32 s55, s55, 8
    v_lshl_add_u32 v8, v4, 5, s55
    global_load_dwordx4 v[48:51], v8, s[10:11]
    global_load_dwordx4 v[52:55], v8, s[10:11] offset:16
    s_mov_b32 s36, s32
    s_mov_b32 s37, s33
    s_mov_b32 s38, 0x10000000
    s_mov_b32 s39, 0x20000
    v_mov_b32 v2, 0
    s_mov_b32 s57, 23461888
    buffer_load_dword v246, v2, s[36:39], s57 offen sc1
    s_branch L_conv
L_e_prep:
    s_getpc_b64 s[40:41]
L_pc0:
    s_sub_u32 s52, s51, 20
    s_mov_b32 s42, L_code_end-L_pc0
    v_lshrrev_b32 v2, 2, v0
    s_lshl_b32 s52, s52, 13
    v_lshlrev_b32 v2, 7, v2
    buffer_load_dword v252, v2, s[40:43], s52 offen
    s_cmp_ge_u32 s71, 60
    s_cbranch_scc1 L_e_q
    s_sub_u32 s52, s71, 30
    s_sub_u32 s77, 79, s71
    s_cmp_lt_u32 s52, 20
    s_cselect_b32 s77, s77, s71
    v_lshrrev_b32 v8, 3, v0
    v_mul_u32_u24 v9, 153600, v8
    v_and_b32 v8, 7, v0
    v_lshl_add_u32 v9, v8, 4, v9
    s_lshl_b32 s56, s77, 7
    s_movk_i32 s68, 7680
    s_mov_b32 s46, 4915200
    s_waitcnt lgkmcnt(0)
    s_mov_b64 s[44:45], s[26:27]
    v_lshrrev_b32 v2, 3, v0
    v_mul_u32_u24 v3, 40, v2
    global_load_dwordx2 v[80:81], v3, s[24:25] offset:0
    global_load_dwordx2 v[82:83], v3, s[24:25] offset:8
    global_load_dwordx2 v[84:85], v3, s[24:25] offset:16
    global_load_dwordx2 v[86:87], v3, s[24:25] offset:24
    global_load_dwordx2 v[88:89], v3, s[24:25] offset:32
    s_branch L_prep
L_e_q:
    s_lshr_b32 s53, s50, 2
    s_xor_b32 s53, s53, s51
    s_and_b32 s53, s53, 1
    s_xor_b32 s76, s53, 1
    s_cmp_ge_u32 s71, 64
    s_cselect_b32 s65, s76, 0
    s_cselect_b32 s53, s53, 0
    s_lshl_b32 s50, s50, 2
    s_lshr_b32 s51, s2, 3
    s_and_b32 s51, s51, 3
    s_add_u32 s77, s50, s51
    s_cmp_lt_u32 s71, 64
    s_waitcnt lgkmcnt(0)
    s_cbranch_scc1 L_p_b
    s_branch L_p_s
L_conv:
    s_mov_b32 s49, 400000
    s_and_b32 s50, s2, 7
    s_lshr_b32 s51, s2, 3
    s_lshr_b32 s60, s50, 2
    s_lshl_b32 s60, s60, 3
    s_lshr_b32 s61, s51, 2
    s_add_u32 s72, s60, s61
    s_lshl_b32 s61, s61, 3
    s_mov_b32 s62, 0x6040200
    s_mov_b32 s63, 0x70308
    s_lshr_b64 s[62:63], s[62:63], s61
    s_and_b32 s34, s62, 255
    s_lshr_b32 s62, s50, 2
    s_mul_i32 s62, s62, 10
    s_add_u32 s34, s34, s62
    s_sub_u32 s62, s34, 20
    s_min_u32 s34, s34, s62
    s_and_b32 s60, s50, 3
    s_lshl_b32 s60, s60, 2
    s_and_b32 s61, s51, 3
    s_add_u32 s73, s60, s61
    s_and_b32 s75, s51, 7
    s_lshr_b32 s61, s51, 3
    s_lshl_b32 s60, s50, 2
    s_add_u32 s74, s60, s61
    s_mul_i32 s70, s50, 20
    s_add_u32 s70, s70, s51
    s_lshl_b32 s60, s50, 1
    s_cmp_ge_u32 s51, 10
    s_addc_u32 s60, s60, 0
    s_cmp_ge_u32 s51, 10
    s_cselect_b32 s61, 10, 0
    s_sub_u32 s61, s51, s61
    s_lshl_b32 s61, s61, 4
    s_add_u32 s76, s60, s61
    s_lshl_b32 s58, s70, 2
    s_add_u32 s58, s58, s3
    v_lshlrev_b32 v248, 4, v1
    s_add_u32 m0, s54, 61440
    s_mov_b64 s[44:45], s[4:5]
    buffer_load_dwordx4 v3, s[44:47], s53 offen offset:0 nt lds
    buffer_load_dwordx4 v10, s[44:47], s53 offen offset:1088 nt lds
    buffer_load_dwordx4 v11, s[44:47], s53 offen offset:2176 nt lds
    buffer_load_dwordx4 v12, s[44:47], s53 offen offset:3264 nt lds
    s_lshr_b32 s50, s76, 4
    s_and_b32 s51, s76, 15
    s_lshr_b32 s55, s3, 1
    s_and_b32 s56, s3, 1
    s_lshl_b32 s51, s51, 7
    s_lshl_b32 s57, s55, 6
    s_add_u32 s51, s51, s57
    s_lshl_b32 s50, s50, 6
    s_lshl_b32 s57, s56, 5
    s_add_u32 s50, s50, s57
    v_lshrrev_b32 v5, 3, v1
    v_lshl_add_u32 v6, v5, 3, s51
    v_lshl_add_u32 v7, v4, 2, s50
    v_mul_u32_u24 v7, 4096, v7
    v_lshl_add_u32 v245, v6, 1, v7
    v_sub_u32 v6, 2040, v6
    v_lshl_add_u32 v247, v6, 1, v7
    s_mul_i32 s55, s55, 8704
    s_lshl_b32 s56, s56, 6
    s_add_u32 s55, s55, s56
    s_add_u32 s55, s55, 25536
    v_mul_u32_u24 v5, 1088, v5
    v_lshl_add_u32 v5, v4, 3, v5
    v_add_u32 v244, s55, v5
    v_mov_b32 v243, v3
    s_and_b32 s50, s3, 1
    s_mul_i32 s61, s50, 3104
    s_mul_i32 s50, s50, 12288
    s_mul_i32 s64, s73, 192
    s_add_u32 s64, s64, s50
    s_mul_i32 s50, s34, 98304
    s_add_u32 s64, s64, s50
    s_cmp_ge_u32 s3, 2
    s_cselect_b32 s40, s20, s18
    s_cselect_b32 s41, s21, s19
    s_cselect_b32 s50, 6224, 0
    s_add_u32 s61, s61, s50
    s_mov_b32 s42, 1966080
    s_mov_b32 s43, 0x20000
    v_add_u32 v2, 0, v1
    v_mul_u32_u24 v3, 171, v2
    v_lshrrev_b32 v3, 11, v3
    v_mul_u32_u24 v4, 12, v3
    v_sub_u32 v4, v2, v4
    v_and_b32 v2, 12, v3
    v_add_u32 v3, v3, v2
    v_mul_u32_u24 v3, 3072, v3
    v_lshl_add_u32 v224, v4, 4, v3
    v_add_u32 v2, 64, v1
    v_mul_u32_u24 v3, 171, v2
    v_lshrrev_b32 v3, 11, v3
    v_mul_u32_u24 v4, 12, v3
    v_sub_u32 v4, v2, v4
    v_and_b32 v2, 12, v3
    v_add_u32 v3, v3, v2
    v_mul_u32_u24 v3, 3072, v3
    v_lshl_add_u32 v225, v4, 4, v3
    v_subrev_u32 v225, 1024, v225
    v_add_u32 v2, 128, v1
    v_mul_u32_u24 v3, 171, v2
    v_lshrrev_b32 v3, 11, v3
    v_mul_u32_u24 v4, 12, v3
    v_sub_u32 v4, v2, v4
    v_and_b32 v2, 12, v3
    v_add_u32 v3, v3, v2
    v_mul_u32_u24 v3, 3072, v3
    v_lshl_add_u32 v226, v4, 4, v3
    v_subrev_u32 v226, 2048, v226
    s_mul_i32 s50, s3, 48
    v_lshrrev_b32 v2, 5, v1
    v_bfe_u32 v3, v1, 2, 2
    v_lshl_add_u32 v2, v2, 2, v3
    v_mul_u32_u24 v2, 192, v2
    v_bfe_u32 v3, v1, 4, 1
    v_mul_u32_u24 v3, 3104, v3
    v_add3_u32 v2, v2, v3, s50
    v_and_b32 v3, 3, v1
    v_lshl_add_u32 v227, v3, 3, v2
    v_and_b32 v3, 1, v1
    v_lshl_add_u32 v2, v3, 3, v2
    v_bfe_u32 v3, v1, 1, 1
    v_mul_u32_u24 v3, 6224, v3
    v_add3_u32 v228, v2, v3, 32
    s_mul_i32 s51, s3, 16640
    s_add_u32 s51, s51, 78848
    v_add_u32 v223, s51, v248
    v_lshrrev_b32 v8, 1, v1
    v_mul_u32_u24 v8, 4160, v8
    v_and_b32 v4, 1, v1
    v_lshl_add_u32 v8, v4, 4, v8
    v_add_u32 v8, s51, v8
    v_mov_b32 v4, 0
    v_mov_b32 v5, 0
    v_mov_b32 v6, 0
    v_mov_b32 v7, 0
    s_mov_b64 exec, 0xff
    ds_write_b128 v8, v[4:7]
    s_mul_i32 s52, s3, 4608
    s_add_u32 s52, s52, 149504
    s_mov_b64 exec, 0x3fffffff
    v_add_u32 v8, s52, v248
    ds_write_b128 v8, v[4:7]
    s_mov_b64 exec, -1
    v_and_b32 v2, 15, v1
    v_lshrrev_b32 v8, 4, v1
    v_lshlrev_b32 v249, 6, v2
    v_lshl_add_u32 v249, v8, 4, v249
    v_add_u32 v249, 62464, v249
    v_and_b32 v231, 1, v8
    v_lshlrev_b32 v231, 9, v231
    v_lshl_add_u32 v231, v2, 5, v231
    v_lshrrev_b32 v8, 1, v8
    v_lshl_add_u32 v231, v8, 4, v231
    s_mul_i32 s68, s58, 4096
    s_add_u32 s65, s68, 2883584
    s_add_u32 s68, s68, 0
    s_lshl_b32 s66, s3, 12
    s_add_u32 s67, s66, 23068672
    s_lshl_b32 s59, s58, 1
    v_mov_b32 v250, 0
    v_mov_b32 v251, s59
    global_load_short_d16_hi v250, v251, s[14:15]
    v_min_u32 v240, 11, v1
    v_lshlrev_b32 v240, 7, v240
    s_lshr_b32 s52, s70, 4
    s_lshl_b32 s52, s52, 11
    s_add_u32 s59, s52, 23199744
    s_lshl_b32 s69, s3, 9
    s_sub_u32 s52, s52, s69
    s_add_u32 s52, s52, 153600
    v_cmp_lt_u32 vcc, 7, v1
    v_mov_b32 v241, s52
    s_nop 0
    v_cndmask_b32 v241, 0, v241, vcc
    v_add_u32 v240, v240, v241
    s_lshl_b32 s69, s3, 10
    s_add_u32 s69, s69, 23220224
    s_lshl_b32 s55, s58, 3
    s_add_u32 s55, s55, 23560192
    v_and_b32 v253, 3, v1
    v_cmp_eq_u32 vcc, 3, v253
    s_nop 1
    v_addc_co_u32 v253, vcc, 0, v253, vcc
    v_mul_u32_u24 v253, 5120, v253
    v_min_u32 v241, 9, v1
    v_lshlrev_b32 v241, 7, v241
    s_mov_b32 s60, 23230464
    v_min_u32 v242, 15, v1
    v_lshlrev_b32 v242, 7, v242
    v_and_b32 v2, 15, v1
    v_lshrrev_b32 v8, 4, v1
    v_add_u32 v4, 1, v2
    v_and_b32 v5, 3, v4
    v_sub_u32 v4, v4, v5
    v_add_u32 v4, 24, v4
    v_lshlrev_b32 v4, 1, v4
    v_mul_u32_u24 v5, 4160, v5
    v_add_u32 v4, v4, v5
    v_lshlrev_b32 v5, 4, v8
    v_sub_u32 v4, v4, v5
    s_mul_i32 s51, s3, 16640
    s_add_u32 s51, s51, 78848
    v_add_u32 v229, s51, v4
    v_lshlrev_b32 v2, 5, v2
    v_add_u32 v2, v2, v5
    s_mul_i32 s52, s3, 4608
    s_add_u32 s52, s52, 145936
    v_sub_u32 v230, s52, v2
    v_lshrrev_b32 v2, 3, v1
    v_bfe_u32 v3, v1, 4, 2
    v_lshlrev_b32 v3, 1, v3
    v_xor_b32 v3, v3, v1
    v_and_b32 v3, 7, v3
    v_mul_u32_u24 v2, 4096, v2
    v_lshl_add_u32 v172, v3, 4, v2
    v_add_u32 v172, 0, v172
    v_lshrrev_b32 v2, 2, v1
    v_lshlrev_b32 v2, 7, v2
    v_and_b32 v3, 3, v1
    v_lshl_add_u32 v2, v3, 3, v2
    v_bfe_u32 v3, v1, 3, 2
    v_xor_b32 v168, 0, v3
    v_lshl_add_u32 v168, v168, 5, v2
    v_xor_b32 v169, 1, v3
    v_lshl_add_u32 v169, v169, 5, v2
    v_xor_b32 v170, 2, v3
    v_lshl_add_u32 v170, v170, 5, v2
    v_xor_b32 v171, 3, v3
    v_lshl_add_u32 v171, v171, 5, v2
    v_and_b32 v175, 15, v1
    v_lshlrev_b32 v175, 4, v175
    v_bfe_u32 v2, v1, 4, 1
    v_lshrrev_b32 v3, 5, v1
    v_mul_u32_u24 v173, 49152, v2
    v_lshl_add_u32 v173, v3, 8, v173
    v_add_u32 v173, v173, v175
    v_lshl_add_u32 v2, v2, 1, v3
    v_mul_u32_u24 v174, 49152, v2
    v_add_u32 v174, v174, v175
    v_bfe_u32 v2, v0, 1, 2
    v_lshlrev_b32 v2, 1, v2
    s_lshr_b32 s50, s73, 1
    v_xor_b32 v2, s50, v2
    v_lshlrev_b32 v2, 4, v2
    v_lshl_add_u32 v216, v0, 7, v2
    s_and_b32 s50, s73, 1
    s_lshl_b32 s50, s50, 3
    v_add_u32 v216, s50, v216
    v_add_u32 v217, 0x8000, v216
    v_add_u32 v218, 0x10000, v216
    v_cmp_gt_u32 vcc, 128, v0
    s_nop 1
    v_cndmask_b32 v218, v217, v218, vcc
    s_lshl_b32 s50, s3, 10
    v_add_u32 v175, s50, v175
    v_lshrrev_b32 v2, 1, v1
    v_lshlrev_b32 v2, 10, v2
    v_and_b32 v3, 1, v1
    v_lshl_add_u32 v219, v3, 7, v2
    s_lshl_b32 s50, s3, 8
    s_add_u32 s50, s50, 46080
    v_add_u32 v219, s50, v219
    s_add_u32 s50, s50, 19456
    v_mov_b32 v2, s50
    v_cmp_lt_u32 vcc, 39, v1
    s_nop 1
    v_cndmask_b32 v219, v219, v2, vcc
    v_mov_b32 v3, v243
    s_lshl_b32 s50, s58, 12
    s_mul_i32 s51, s3, 16640
    s_add_u32 m0, s51, 78880
    s_mov_b32 s44, s12
    s_mov_b32 s45, s13
    s_mov_b32 s46, 0x280000
    s_mov_b32 s47, 0x20000
    buffer_load_dwordx4 v248, s[44:47], s50 offen offset:0 nt lds
    buffer_load_dwordx4 v248, s[44:47], s50 offen offset:1024 nt lds
    buffer_load_dwordx4 v248, s[44:47], s50 offen offset:2048 nt lds
    buffer_load_dwordx4 v248, s[44:47], s50 offen offset:3072 nt lds
    s_waitcnt vmcnt(11)
    v_lshlrev_b32 v104, 16, v48
    v_and_b32 v108, 0xffff0000, v48
    v_lshlrev_b32 v112, 16, v49
    v_and_b32 v116, 0xffff0000, v49
    v_lshlrev_b32 v105, 16, v50
    v_and_b32 v109, 0xffff0000, v50
    v_lshlrev_b32 v113, 16, v51
    v_and_b32 v117, 0xffff0000, v51
    s_waitcnt vmcnt(10)
    v_lshlrev_b32 v106, 16, v52
    v_and_b32 v110, 0xffff0000, v52
    v_lshlrev_b32 v114, 16, v53
    v_and_b32 v118, 0xffff0000, v53
    v_lshlrev_b32 v107, 16, v54
    v_and_b32 v111, 0xffff0000, v54
    v_lshlrev_b32 v115, 16, v55
    v_and_b32 v119, 0xffff0000, v55
    s_waitcnt vmcnt(9)
    s_barrier
    ds_read_b64 v[10:11], v244 offset:640
    ds_read_b64 v[12:13], v244 offset:768
    ds_read_b64 v[14:15], v244 offset:896
    ds_read_b64 v[16:17], v244 offset:1088
    ds_read_b64 v[18:19], v244 offset:1216
    ds_read_b64 v[20:21], v244 offset:1344
    ds_read_b64 v[22:23], v244 offset:1472
    ds_read_b64 v[24:25], v244 offset:1600
    ds_read_b64 v[26:27], v244 offset:1728
    ds_read_b64 v[28:29], v244 offset:1856
    ds_read_b64 v[30:31], v244 offset:1984
    ds_read_b64 v[32:33], v244 offset:18496
    ds_read_b64 v[34:35], v244 offset:18624
    ds_read_b64 v[36:37], v244 offset:18752
    ds_read_b64 v[38:39], v244 offset:18880
    ds_read_b64 v[40:41], v244 offset:19008
    ds_read_b64 v[42:43], v244 offset:19136
    ds_read_b64 v[44:45], v244 offset:19264
    ds_read_b64 v[46:47], v244 offset:19392
    s_waitcnt lgkmcnt(14)
    v_lshlrev_b32 v60, 16, v10
    v_and_b32 v61, 0xffff0000, v10
    v_lshlrev_b32 v62, 16, v11
    v_and_b32 v63, 0xffff0000, v11
    v_lshlrev_b32 v64, 16, v12
    v_and_b32 v65, 0xffff0000, v12
    v_lshlrev_b32 v66, 16, v13
    v_and_b32 v67, 0xffff0000, v13
    v_lshlrev_b32 v68, 16, v14
    v_and_b32 v69, 0xffff0000, v14
    v_lshlrev_b32 v70, 16, v15
    v_and_b32 v71, 0xffff0000, v15
    v_lshlrev_b32 v72, 16, v16
    v_and_b32 v73, 0xffff0000, v16
    v_lshlrev_b32 v74, 16, v17
    v_and_b32 v75, 0xffff0000, v17
    v_lshlrev_b32 v76, 16, v18
    v_and_b32 v77, 0xffff0000, v18
    v_lshlrev_b32 v78, 16, v19
    v_and_b32 v79, 0xffff0000, v19
    s_waitcnt lgkmcnt(13)
    v_lshlrev_b32 v80, 16, v20
    v_and_b32 v81, 0xffff0000, v20
    v_lshlrev_b32 v82, 16, v21
    v_and_b32 v83, 0xffff0000, v21
    s_waitcnt lgkmcnt(12)
    v_lshlrev_b32 v84, 16, v22
    v_and_b32 v85, 0xffff0000, v22
    v_lshlrev_b32 v86, 16, v23
    v_and_b32 v87, 0xffff0000, v23
    s_waitcnt lgkmcnt(11)
    v_lshlrev_b32 v88, 16, v24
    v_and_b32 v89, 0xffff0000, v24
    v_lshlrev_b32 v90, 16, v25
    v_and_b32 v91, 0xffff0000, v25
    s_waitcnt lgkmcnt(10)
    v_lshlrev_b32 v92, 16, v26
    v_and_b32 v93, 0xffff0000, v26
    v_lshlrev_b32 v94, 16, v27
    v_and_b32 v95, 0xffff0000, v27
    s_waitcnt lgkmcnt(9)
    v_lshlrev_b32 v96, 16, v28
    v_and_b32 v97, 0xffff0000, v28
    v_lshlrev_b32 v98, 16, v29
    v_and_b32 v99, 0xffff0000, v29
    s_waitcnt lgkmcnt(8)
    v_lshlrev_b32 v100, 16, v30
    v_and_b32 v101, 0xffff0000, v30
    v_lshlrev_b32 v102, 16, v31
    v_and_b32 v103, 0xffff0000, v31
    s_movk_i32 s16, 4096
    s_movk_i32 s17, 8192
    s_movk_i32 s62, 12288
    v_pk_mul_f32 v[120:121], v[60:61], v[116:117]
    v_pk_fma_f32 v[120:121], v[64:65], v[112:113], v[120:121]
    v_pk_fma_f32 v[120:121], v[68:69], v[108:109], v[120:121]
    v_pk_fma_f32 v[120:121], v[72:73], v[104:105], v[120:121]
    s_waitcnt lgkmcnt(7)
    v_lshlrev_b32 v56, 16, v32
    v_and_b32 v57, 0xffff0000, v32
    v_pk_mul_f32 v[120:121], v[120:121], v[56:57]
    v_pk_mul_f32 v[124:125], v[64:65], v[116:117]
    v_pk_fma_f32 v[124:125], v[68:69], v[112:113], v[124:125]
    v_pk_fma_f32 v[124:125], v[72:73], v[108:109], v[124:125]
    v_pk_fma_f32 v[124:125], v[76:77], v[104:105], v[124:125]
    s_waitcnt lgkmcnt(6)
    v_lshlrev_b32 v58, 16, v34
    v_and_b32 v59, 0xffff0000, v34
    v_pk_mul_f32 v[124:125], v[124:125], v[58:59]
    v_pk_mul_f32 v[128:129], v[68:69], v[116:117]
    v_pk_fma_f32 v[128:129], v[72:73], v[112:113], v[128:129]
    v_pk_fma_f32 v[128:129], v[76:77], v[108:109], v[128:129]
    v_pk_fma_f32 v[128:129], v[80:81], v[104:105], v[128:129]
    s_waitcnt lgkmcnt(5)
    v_lshlrev_b32 v56, 16, v36
    v_and_b32 v57, 0xffff0000, v36
    v_pk_mul_f32 v[128:129], v[128:129], v[56:57]
    v_pk_mul_f32 v[132:133], v[72:73], v[116:117]
    v_pk_fma_f32 v[132:133], v[76:77], v[112:113], v[132:133]
    v_pk_fma_f32 v[132:133], v[80:81], v[108:109], v[132:133]
    v_pk_fma_f32 v[132:133], v[84:85], v[104:105], v[132:133]
    s_waitcnt lgkmcnt(4)
    v_lshlrev_b32 v58, 16, v38
    v_and_b32 v59, 0xffff0000, v38
    v_pk_mul_f32 v[132:133], v[132:133], v[58:59]
    v_pk_mul_f32 v[136:137], v[76:77], v[116:117]
    v_pk_fma_f32 v[136:137], v[80:81], v[112:113], v[136:137]
    v_pk_fma_f32 v[136:137], v[84:85], v[108:109], v[136:137]
    v_pk_fma_f32 v[136:137], v[88:89], v[104:105], v[136:137]
    s_waitcnt lgkmcnt(3)
    v_lshlrev_b32 v56, 16, v40
    v_and_b32 v57, 0xffff0000, v40
    v_pk_mul_f32 v[136:137], v[136:137], v[56:57]
    v_pk_mul_f32 v[140:141], v[80:81], v[116:117]
    v_pk_fma_f32 v[140:141], v[84:85], v[112:113], v[140:141]
    v_pk_fma_f32 v[140:141], v[88:89], v[108:109], v[140:141]
    v_pk_fma_f32 v[140:141], v[92:93], v[104:105], v[140:141]
    s_waitcnt lgkmcnt(2)
    v_lshlrev_b32 v58, 16, v42
    v_and_b32 v59, 0xffff0000, v42
    v_pk_mul_f32 v[140:141], v[140:141], v[58:59]
    v_pk_mul_f32 v[144:145], v[84:85], v[116:117]
    v_pk_fma_f32 v[144:145], v[88:89], v[112:113], v[144:145]
    v_pk_fma_f32 v[144:145], v[92:93], v[108:109], v[144:145]
    v_pk_fma_f32 v[144:145], v[96:97], v[104:105], v[144:145]
    s_waitcnt lgkmcnt(1)
    v_lshlrev_b32 v56, 16, v44
    v_and_b32 v57, 0xffff0000, v44
    v_pk_mul_f32 v[144:145], v[144:145], v[56:57]
    v_pk_mul_f32 v[148:149], v[88:89], v[116:117]
    v_pk_fma_f32 v[148:149], v[92:93], v[112:113], v[148:149]
    v_pk_fma_f32 v[148:149], v[96:97], v[108:109], v[148:149]
    v_pk_fma_f32 v[148:149], v[100:101], v[104:105], v[148:149]
    s_waitcnt lgkmcnt(0)
    v_lshlrev_b32 v58, 16, v46
    v_and_b32 v59, 0xffff0000, v46
    v_pk_mul_f32 v[148:149], v[148:149], v[58:59]
    v_cvt_pk_bf16_f32 v152, v148, v144
    v_cvt_pk_bf16_f32 v153, v140, v136
    v_cvt_pk_bf16_f32 v154, v132, v128
    v_cvt_pk_bf16_f32 v155, v124, v120
    buffer_store_dwordx4 v[152:155], v247, s[36:39], 0 offen sc1
    v_cvt_pk_bf16_f32 v156, v149, v145
    v_cvt_pk_bf16_f32 v157, v141, v137
    v_cvt_pk_bf16_f32 v158, v133, v129
    v_cvt_pk_bf16_f32 v159, v125, v121
    buffer_store_dwordx4 v[156:159], v247, s[36:39], s16 offen sc1
    v_pk_mul_f32 v[122:123], v[62:63], v[118:119]
    v_pk_fma_f32 v[122:123], v[66:67], v[114:115], v[122:123]
    v_pk_fma_f32 v[122:123], v[70:71], v[110:111], v[122:123]
    v_pk_fma_f32 v[122:123], v[74:75], v[106:107], v[122:123]
    v_lshlrev_b32 v56, 16, v33
    v_and_b32 v57, 0xffff0000, v33
    v_pk_mul_f32 v[122:123], v[122:123], v[56:57]
    v_pk_mul_f32 v[126:127], v[66:67], v[118:119]
    v_pk_fma_f32 v[126:127], v[70:71], v[114:115], v[126:127]
    v_pk_fma_f32 v[126:127], v[74:75], v[110:111], v[126:127]
    v_pk_fma_f32 v[126:127], v[78:79], v[106:107], v[126:127]
    v_lshlrev_b32 v58, 16, v35
    v_and_b32 v59, 0xffff0000, v35
    v_pk_mul_f32 v[126:127], v[126:127], v[58:59]
    v_pk_mul_f32 v[130:131], v[70:71], v[118:119]
    v_pk_fma_f32 v[130:131], v[74:75], v[114:115], v[130:131]
    v_pk_fma_f32 v[130:131], v[78:79], v[110:111], v[130:131]
    v_pk_fma_f32 v[130:131], v[82:83], v[106:107], v[130:131]
    v_lshlrev_b32 v56, 16, v37
    v_and_b32 v57, 0xffff0000, v37
    v_pk_mul_f32 v[130:131], v[130:131], v[56:57]
    v_pk_mul_f32 v[134:135], v[74:75], v[118:119]
    v_pk_fma_f32 v[134:135], v[78:79], v[114:115], v[134:135]
    v_pk_fma_f32 v[134:135], v[82:83], v[110:111], v[134:135]
    v_pk_fma_f32 v[134:135], v[86:87], v[106:107], v[134:135]
    v_lshlrev_b32 v58, 16, v39
    v_and_b32 v59, 0xffff0000, v39
    v_pk_mul_f32 v[134:135], v[134:135], v[58:59]
    v_pk_mul_f32 v[138:139], v[78:79], v[118:119]
    v_pk_fma_f32 v[138:139], v[82:83], v[114:115], v[138:139]
    v_pk_fma_f32 v[138:139], v[86:87], v[110:111], v[138:139]
    v_pk_fma_f32 v[138:139], v[90:91], v[106:107], v[138:139]
    v_lshlrev_b32 v56, 16, v41
    v_and_b32 v57, 0xffff0000, v41
    v_pk_mul_f32 v[138:139], v[138:139], v[56:57]
    v_pk_mul_f32 v[142:143], v[82:83], v[118:119]
    v_pk_fma_f32 v[142:143], v[86:87], v[114:115], v[142:143]
    v_pk_fma_f32 v[142:143], v[90:91], v[110:111], v[142:143]
    v_pk_fma_f32 v[142:143], v[94:95], v[106:107], v[142:143]
    v_lshlrev_b32 v58, 16, v43
    v_and_b32 v59, 0xffff0000, v43
    v_pk_mul_f32 v[142:143], v[142:143], v[58:59]
    v_pk_mul_f32 v[146:147], v[86:87], v[118:119]
    v_pk_fma_f32 v[146:147], v[90:91], v[114:115], v[146:147]
    v_pk_fma_f32 v[146:147], v[94:95], v[110:111], v[146:147]
    v_pk_fma_f32 v[146:147], v[98:99], v[106:107], v[146:147]
    v_lshlrev_b32 v56, 16, v45
    v_and_b32 v57, 0xffff0000, v45
    v_pk_mul_f32 v[146:147], v[146:147], v[56:57]
    v_pk_mul_f32 v[150:151], v[90:91], v[118:119]
    v_pk_fma_f32 v[150:151], v[94:95], v[114:115], v[150:151]
    v_pk_fma_f32 v[150:151], v[98:99], v[110:111], v[150:151]
    v_pk_fma_f32 v[150:151], v[102:103], v[106:107], v[150:151]
    v_lshlrev_b32 v58, 16, v47
    v_and_b32 v59, 0xffff0000, v47
    v_pk_mul_f32 v[150:151], v[150:151], v[58:59]
    v_cvt_pk_bf16_f32 v160, v150, v146
    v_cvt_pk_bf16_f32 v161, v142, v138
    v_cvt_pk_bf16_f32 v162, v134, v130
    v_cvt_pk_bf16_f32 v163, v126, v122
    buffer_store_dwordx4 v[160:163], v247, s[36:39], s17 offen sc1
    v_cvt_pk_bf16_f32 v164, v151, v147
    v_cvt_pk_bf16_f32 v165, v143, v139
    v_cvt_pk_bf16_f32 v166, v135, v131
    v_cvt_pk_bf16_f32 v167, v127, v123
    buffer_store_dwordx4 v[164:167], v247, s[36:39], s62 offen sc1
    s_waitcnt vmcnt(9)
    s_barrier
    s_mov_b32 s51, 0x05040100
    s_mov_b32 s52, 0x07060302
    s_mov_b32 s53, 2883584
    ds_read_b64 v[40:41], v244 offset:35904
    ds_read_b64 v[42:43], v244 offset:36032
    ds_read_b64 v[44:45], v244 offset:36160
    ds_read_b64 v[46:47], v244 offset:36288
    ds_read_b64 v[48:49], v244 offset:36416
    ds_read_b64 v[50:51], v244 offset:36544
    ds_read_b64 v[52:53], v244 offset:36672
    ds_read_b64 v[54:55], v244 offset:36800
    s_waitcnt lgkmcnt(6)
    v_perm_b32 v184, v42, v40, s51
    s_waitcnt lgkmcnt(4)
    v_perm_b32 v185, v46, v44, s51
    s_waitcnt lgkmcnt(2)
    v_perm_b32 v186, v50, v48, s51
    s_waitcnt lgkmcnt(0)
    v_perm_b32 v187, v54, v52, s51
    buffer_store_dwordx4 v[184:187], v245, s[36:39], s53 offen sc1
    s_add_u32 s53, s53, 4096
    v_perm_b32 v188, v42, v40, s52
    v_perm_b32 v189, v46, v44, s52
    v_perm_b32 v190, v50, v48, s52
    v_perm_b32 v191, v54, v52, s52
    buffer_store_dwordx4 v[188:191], v245, s[36:39], s53 offen sc1
    s_add_u32 s53, s53, 4096
    v_perm_b32 v192, v43, v41, s51
    v_perm_b32 v193, v47, v45, s51
    v_perm_b32 v194, v51, v49, s51
    v_perm_b32 v195, v55, v53, s51
    buffer_store_dwordx4 v[192:195], v245, s[36:39], s53 offen sc1
    s_add_u32 s53, s53, 4096
    v_perm_b32 v196, v43, v41, s52
    v_perm_b32 v197, v47, v45, s52
    v_perm_b32 v198, v51, v49, s52
    v_perm_b32 v199, v55, v53, s52
    buffer_store_dwordx4 v[196:199], v245, s[36:39], s53 offen sc1
    s_waitcnt vmcnt(4)
    s_waitcnt lgkmcnt(0)
    s_barrier
    v_readfirstlane_b32 s48, v246
    s_mul_i32 s48, s48, 0x9E3779B1
    s_add_u32 s48, s48, 0x7F4A7C15
    s_cmp_eq_u32 s3, 0
    s_cbranch_scc0 L_wf1
    s_lshl_b32 s54, s76, 7
    s_add_u32 s54, s54, 23199744
    v_mov_b32 v2, 0
    v_mov_b32 v3, s48
    s_mov_b64 exec, 1
    buffer_store_dword v3, v2, s[36:39], s54 offen sc1
    s_mov_b64 exec, -1
L_wf1:
    s_add_u32 m0, s61, 0
    s_nop 0
    buffer_load_dwordx4 v224, s[40:43], s64 offen offset:0 lds
    buffer_load_dwordx4 v225, s[40:43], s64 offen offset:1024 lds
    buffer_load_dwordx4 v226, s[40:43], s64 offen offset:2048 lds
    s_add_u32 s64, s64, 98304
    s_sub_u32 s35, s64, 1966080
    s_min_u32 s64, s64, s35
    s_add_u32 m0, s61, 12416
    s_nop 0
    buffer_load_dwordx4 v224, s[40:43], s64 offen offset:0 lds
    buffer_load_dwordx4 v225, s[40:43], s64 offen offset:1024 lds
    buffer_load_dwordx4 v226, s[40:43], s64 offen offset:2048 lds
    s_add_u32 s64, s64, 98304
    s_sub_u32 s35, s64, 1966080
    s_min_u32 s64, s64, s35
    s_add_u32 m0, s61, 24832
    s_nop 0
    buffer_load_dwordx4 v224, s[40:43], s64 offen offset:0 lds
    buffer_load_dwordx4 v225, s[40:43], s64 offen offset:1024 lds
    buffer_load_dwordx4 v226, s[40:43], s64 offen offset:2048 lds
    s_add_u32 s64, s64, 98304
    s_sub_u32 s35, s64, 1966080
    s_min_u32 s64, s64, s35
    s_add_u32 m0, s61, 37248
    s_nop 0
    buffer_load_dwordx4 v224, s[40:43], s64 offen offset:0 lds
    buffer_load_dwordx4 v225, s[40:43], s64 offen offset:1024 lds
    buffer_load_dwordx4 v226, s[40:43], s64 offen offset:2048 lds
    s_add_u32 s64, s64, 98304
    s_sub_u32 s35, s64, 1966080
    s_min_u32 s64, s64, s35
    s_add_u32 m0, s61, 49664
    s_nop 0
    buffer_load_dwordx4 v224, s[40:43], s64 offen offset:0 lds
    buffer_load_dwordx4 v225, s[40:43], s64 offen offset:1024 lds
    buffer_load_dwordx4 v226, s[40:43], s64 offen offset:2048 lds
    s_add_u32 s64, s64, 98304
    s_sub_u32 s35, s64, 1966080
    s_min_u32 s64, s64, s35
    ds_read_b128 v[8:11], v223 offset:32
    ds_read_b64 v[12:13], v223 offset:48
    ds_read_b128 v[14:17], v223 offset:1056
    ds_read_b64 v[18:19], v223 offset:1072
    ds_read_b128 v[20:23], v223 offset:2080
    ds_read_b64 v[24:25], v223 offset:2096
    ds_read_b128 v[26:29], v223 offset:3104
    ds_read_b64 v[30:31], v223 offset:3120
    s_mov_b64 exec, 1
    s_waitcnt lgkmcnt(7)
    v_lshlrev_b32 v80, 16, v8
    v_alignbit_b32 v81, v9, v8, 16
    ds_write_b32 v223, v80 offset:4188
    ds_write_b32 v223, v8 offset:8348
    ds_write_b32 v223, v80 offset:12504
    ds_write_b32 v223, v81 offset:12508
    s_mov_b64 exec, -1
    v_alignbit_b32 v56, v9, v8, 16
    v_alignbit_b32 v57, v10, v9, 16
    v_alignbit_b32 v58, v11, v10, 16
    s_waitcnt lgkmcnt(10)
    v_alignbit_b32 v59, v12, v11, 16
    v_pk_mov_b32 v[60:61], v[8:9], v[10:11] op_sel:[1,0]
    v_pk_mov_b32 v[62:63], v[10:11], v[12:13] op_sel:[1,0]
    v_alignbit_b32 v64, v10, v9, 16
    v_alignbit_b32 v65, v11, v10, 16
    v_alignbit_b32 v66, v12, v11, 16
    v_alignbit_b32 v67, v13, v12, 16
    ds_write_b128 v223, v[56:59] offset:4192
    ds_write_b128 v223, v[60:63] offset:8352
    ds_write_b128 v223, v[64:67] offset:12512
    s_waitcnt lgkmcnt(12)
    v_alignbit_b32 v68, v15, v14, 16
    v_alignbit_b32 v69, v16, v15, 16
    v_alignbit_b32 v70, v17, v16, 16
    s_waitcnt lgkmcnt(11)
    v_alignbit_b32 v71, v18, v17, 16
    v_pk_mov_b32 v[72:73], v[14:15], v[16:17] op_sel:[1,0]
    v_pk_mov_b32 v[74:75], v[16:17], v[18:19] op_sel:[1,0]
    v_alignbit_b32 v76, v16, v15, 16
    v_alignbit_b32 v77, v17, v16, 16
    v_alignbit_b32 v78, v18, v17, 16
    v_alignbit_b32 v79, v19, v18, 16
    ds_write_b128 v223, v[68:71] offset:5216
    ds_write_b128 v223, v[72:75] offset:9376
    ds_write_b128 v223, v[76:79] offset:13536
    s_waitcnt lgkmcnt(13)
    v_alignbit_b32 v56, v21, v20, 16
    v_alignbit_b32 v57, v22, v21, 16
    v_alignbit_b32 v58, v23, v22, 16
    s_waitcnt lgkmcnt(12)
    v_alignbit_b32 v59, v24, v23, 16
    v_pk_mov_b32 v[60:61], v[20:21], v[22:23] op_sel:[1,0]
    v_pk_mov_b32 v[62:63], v[22:23], v[24:25] op_sel:[1,0]
    v_alignbit_b32 v64, v22, v21, 16
    v_alignbit_b32 v65, v23, v22, 16
    v_alignbit_b32 v66, v24, v23, 16
    v_alignbit_b32 v67, v25, v24, 16
    ds_write_b128 v223, v[56:59] offset:6240
    ds_write_b128 v223, v[60:63] offset:10400
    ds_write_b128 v223, v[64:67] offset:14560
    s_waitcnt lgkmcnt(14)
    v_alignbit_b32 v68, v27, v26, 16
    v_alignbit_b32 v69, v28, v27, 16
    v_alignbit_b32 v70, v29, v28, 16
    s_waitcnt lgkmcnt(13)
    v_alignbit_b32 v71, v30, v29, 16
    v_pk_mov_b32 v[72:73], v[26:27], v[28:29] op_sel:[1,0]
    v_pk_mov_b32 v[74:75], v[28:29], v[30:31] op_sel:[1,0]
    v_alignbit_b32 v76, v28, v27, 16
    v_alignbit_b32 v77, v29, v28, 16
    v_alignbit_b32 v78, v30, v29, 16
    v_alignbit_b32 v79, v31, v30, 16
    ds_write_b128 v223, v[68:71] offset:7264
    ds_write_b128 v223, v[72:75] offset:11424
    ds_write_b128 v223, v[76:79] offset:15584
    v_lshrrev_b32 v3, 4, v1
    v_lshlrev_b32 v2, 3, v3
    v_and_b32 v3, 15, v1
    v_sub_u32 v2, v2, v3
    v_subrev_u32 v2, 9, v2
    v_and_b32 v3, 1, v2
    v_cmp_eq_u32 vcc, 1, v3
    v_lshrrev_b32 v3, 16, v250
    s_nop 0
    v_cndmask_b32 v3, v3, v250, vcc
    v_lshrrev_b32 v2, 1, v2
    v_cmp_eq_u32 vcc, 0, v2
    s_nop 1
    v_cndmask_b32 v244, 0, v3, vcc
    v_cmp_eq_u32 vcc, 1, v2
    s_nop 1
    v_cndmask_b32 v245, 0, v3, vcc
    v_cmp_eq_u32 vcc, 2, v2
    s_nop 1
    v_cndmask_b32 v246, 0, v3, vcc
    v_cmp_eq_u32 vcc, 3, v2
    s_nop 1
    v_cndmask_b32 v247, 0, v3, vcc
    v_mov_b32 v4, v229
    v_mov_b32 v5, v230
    s_waitcnt vmcnt(0)
    s_barrier
    s_cmp_eq_u32 s3, 0
    s_cbranch_scc0 L_wf2
    s_lshl_b32 s54, s76, 7
    s_add_u32 s54, s54, 23374848
    v_mov_b32 v254, 0
    v_mov_b32 v255, s48
    s_mov_b64 exec, 1
    buffer_store_dword v255, v254, s[36:39], s54 offen sc1
    s_mov_b64 exec, -1
L_wf2:
L_poll3:
    buffer_load_dword v2, v242, s[36:39], s59 offen sc1
    s_waitcnt vmcnt(0)
    v_cmp_ne_u32 vcc, s48, v2
    s_cbranch_vccz L_poll3_ok
    s_cmp_eq_u32 s49, 0
    s_cbranch_scc1 L_poll3_ok
    s_sub_u32 s49, s49, 1
    s_sleep 1
    s_branch L_poll3
L_poll3_ok:
    s_mul_i32 s50, s58, 4096
    s_mul_i32 s52, s3, 4608
    s_add_u32 m0, s52, 145408
    s_nop 0
    buffer_load_dwordx4 v248, s[36:39], s50 offen offset:0 sc1 lds
    buffer_load_dwordx4 v248, s[36:39], s50 offen offset:1024 sc1 lds
    buffer_load_dwordx4 v248, s[36:39], s50 offen offset:2048 sc1 lds
    buffer_load_dwordx4 v248, s[36:39], s50 offen offset:3072 sc1 lds
    ds_read_b64_tr_b16 a[0:1], v227 offset:0
    ds_read_b64_tr_b16 a[2:3], v227 offset:1536
    ds_read_b64_tr_b16 a[4:5], v227 offset:6224
    ds_read_b64_tr_b16 a[6:7], v227 offset:7760
    ds_read_b64_tr_b16 a[8:9], v228 offset:0
    ds_read_b64_tr_b16 a[10:11], v228 offset:1536
    ds_read_b64_tr_b16 a[12:13], v227 offset:12416
    ds_read_b64_tr_b16 a[14:15], v227 offset:13952
    ds_read_b64_tr_b16 a[16:17], v227 offset:18640
    ds_read_b64_tr_b16 a[18:19], v227 offset:20176
    ds_read_b64_tr_b16 a[20:21], v228 offset:12416
    ds_read_b64_tr_b16 a[22:23], v228 offset:13952
    ds_read_b64_tr_b16 a[24:25], v227 offset:24832
    ds_read_b64_tr_b16 a[26:27], v227 offset:26368
    ds_read_b64_tr_b16 a[28:29], v227 offset:31056
    ds_read_b64_tr_b16 a[30:31], v227 offset:32592
    ds_read_b64_tr_b16 a[32:33], v228 offset:24832
    ds_read_b64_tr_b16 a[34:35], v228 offset:26368
    ds_read_b64_tr_b16 a[36:37], v227 offset:37248
    ds_read_b64_tr_b16 a[38:39], v227 offset:38784
    ds_read_b64_tr_b16 a[40:41], v227 offset:43472
    ds_read_b64_tr_b16 a[42:43], v227 offset:45008
    ds_read_b64_tr_b16 a[44:45], v228 offset:37248
    ds_read_b64_tr_b16 a[46:47], v228 offset:38784
    ds_read_b64_tr_b16 a[48:49], v227 offset:49664
    ds_read_b64_tr_b16 a[50:51], v227 offset:51200
    ds_read_b64_tr_b16 a[52:53], v227 offset:55888
    ds_read_b64_tr_b16 a[54:55], v227 offset:57424
    ds_read_b64_tr_b16 a[56:57], v228 offset:49664
    ds_read_b64_tr_b16 a[58:59], v228 offset:51200
    buffer_load_dword v243, v240, s[36:39], s69 offen sc1
    s_waitcnt lgkmcnt(0)
    s_barrier
    s_add_u32 m0, s61, 0
    s_nop 0
    buffer_load_dwordx4 v224, s[40:43], s64 offen offset:0 lds
    buffer_load_dwordx4 v225, s[40:43], s64 offen offset:1024 lds
    buffer_load_dwordx4 v226, s[40:43], s64 offen offset:2048 lds
    s_add_u32 s64, s64, 98304
    s_sub_u32 s35, s64, 1966080
    s_min_u32 s64, s64, s35
    s_add_u32 m0, s61, 12416
    s_nop 0
    buffer_load_dwordx4 v224, s[40:43], s64 offen offset:0 lds
    buffer_load_dwordx4 v225, s[40:43], s64 offen offset:1024 lds
    buffer_load_dwordx4 v226, s[40:43], s64 offen offset:2048 lds
    s_add_u32 s64, s64, 98304
    s_sub_u32 s35, s64, 1966080
    s_min_u32 s64, s64, s35
    s_waitcnt vmcnt(7)
    ds_read_b128 v[104:107], v5 offset:3584
    ds_read_b64 v[40:41], v4 offset:0
    ds_read_b64 v[42:43], v4 offset:8
    ds_read_b128 v[108:111], v5 offset:3072
    ds_read_b64 v[44:45], v4 offset:512
    ds_read_b64 v[46:47], v4 offset:520
    ds_read_b128 v[112:115], v5 offset:2560
    ds_read_b64 v[48:49], v4 offset:1024
    ds_read_b64 v[50:51], v4 offset:1032
    ds_read_b128 v[116:119], v5 offset:2048
    ds_read_b64 v[52:53], v4 offset:1536
    ds_read_b64 v[54:55], v4 offset:1544
    s_waitcnt lgkmcnt(9)
    v_mfma_f32_16x16x32_bf16 v[8:11], v[40:43], v[104:107], 0
    v_mfma_f32_16x16x32_bf16 v[8:11], v[244:247], v[104:107], v[8:11]
    s_waitcnt lgkmcnt(8)
    s_mov_b32 s17, 23199744
    ds_read_b128 v[136:139], v5 offset:3648
    v_mfma_f32_16x16x32_bf16 v[12:15], v[40:43], v[108:111], 0
    s_movk_i32 s4, 4096
    ds_read_b64 v[72:73], v4 offset:64
    v_mfma_f32_16x16x32_bf16 v[12:15], v[244:247], v[108:111], v[12:15]
    s_waitcnt lgkmcnt(8)
    s_movk_i32 s5, 8192
    ds_read_b64 v[74:75], v4 offset:72
    v_mfma_f32_16x16x32_bf16 v[12:15], v[44:47], v[104:107], v[12:15]
    s_lshl_b32 s6, s72, 10
    ds_read_b128 v[140:143], v5 offset:3136
    v_mfma_f32_16x16x32_bf16 v[16:19], v[44:47], v[108:111], 0
    s_waitcnt lgkmcnt(9)
    s_add_u32 s6, s6, 23101440
    ds_read_b64 v[76:77], v4 offset:576
    v_mfma_f32_16x16x32_bf16 v[16:19], v[40:43], v[112:115], v[16:19]
    s_lshl_b32 s7, s73, 6
    ds_read_b64 v[78:79], v4 offset:584
    v_mfma_f32_16x16x32_bf16 v[16:19], v[244:247], v[112:115], v[16:19]
    s_waitcnt lgkmcnt(9)
    s_add_u32 s7, s7, s6
    ds_read_b128 v[144:147], v5 offset:2624
    v_mfma_f32_16x16x32_bf16 v[16:19], v[48:51], v[104:107], v[16:19]
    s_mul_i32 s8, s72, 768
    ds_read_b64 v[80:81], v4 offset:1088
    v_mfma_f32_16x16x32_bf16 v[20:23], v[44:47], v[112:115], 0
    s_mul_i32 s53, s73, 12
    ds_read_b64 v[82:83], v4 offset:1096
    v_mfma_f32_16x16x32_bf16 v[20:23], v[48:51], v[108:111], v[20:23]
    s_waitcnt lgkmcnt(11)
    s_add_u32 s8, s8, s53
    ds_read_b128 v[148:151], v5 offset:2112
    v_mfma_f32_16x16x32_bf16 v[20:23], v[40:43], v[116:119], v[20:23]
    s_mul_i32 s53, s3, 3
    ds_read_b64 v[84:85], v4 offset:1600
    v_mfma_f32_16x16x32_bf16 v[20:23], v[244:247], v[116:119], v[20:23]
    s_waitcnt lgkmcnt(11)
    s_add_u32 s8, s8, s53
    ds_read_b64 v[86:87], v4 offset:1608
    v_mfma_f32_16x16x32_bf16 v[20:23], v[52:55], v[104:107], v[20:23]
    s_add_u32 m0, s66, 62464
    s_waitcnt vmcnt(6)
    v_cmp_ne_u32 vcc, s48, v243
    s_cbranch_vccnz L_chk4_slow
L_chk4_back:
    s_barrier
    s_waitcnt lgkmcnt(9)
    v_mfma_f32_16x16x32_bf16 v[8:11], v[72:75], v[136:139], v[8:11]
    s_lshl_b32 s8, s8, 8
    ds_read_b128 v[104:107], v5 offset:3712
    ds_read_b64 v[40:41], v4 offset:128
    buffer_load_dwordx4 v248, s[36:39], s67 offen offset:0 sc1 lds
    s_waitcnt lgkmcnt(10)
    v_mfma_f32_16x16x32_bf16 v[12:15], v[72:75], v[140:143], v[12:15]
    s_waitcnt lgkmcnt(8)
    s_add_u32 s8, s8, 16777216
    ds_read_b64 v[42:43], v4 offset:136
    ds_read_b128 v[108:111], v5 offset:3200
    v_mfma_f32_16x16x32_bf16 v[12:15], v[76:79], v[136:139], v[12:15]
    s_lshl_b32 s9, s73, 2
    ds_read_b64 v[44:45], v4 offset:640
    v_mfma_f32_16x16x32_bf16 v[16:19], v[76:79], v[140:143], v[16:19]
    s_waitcnt lgkmcnt(10)
    s_add_u32 s9, s9, s3
    ds_read_b64 v[46:47], v4 offset:648
    v_mfma_f32_16x16x32_bf16 v[16:19], v[72:75], v[144:147], v[16:19]
    s_waitcnt lgkmcnt(9)
    s_add_u32 m0, s66, 62464
    s_mul_i32 s9, s9, 384
    ds_read_b128 v[112:115], v5 offset:2688
    v_mfma_f32_16x16x32_bf16 v[16:19], v[80:83], v[136:139], v[16:19]
    s_add_u32 s9, s9, 23527424
    ds_read_b64 v[48:49], v4 offset:1152
    buffer_load_dwordx4 v248, s[36:39], s67 offen offset:1024 sc1 lds
    v_mfma_f32_16x16x32_bf16 v[20:23], v[76:79], v[144:147], v[20:23]
    s_mul_i32 s16, s3, 32768
    ds_read_b64 v[50:51], v4 offset:1160
    v_mfma_f32_16x16x32_bf16 v[20:23], v[80:83], v[140:143], v[20:23]
    s_waitcnt lgkmcnt(11)
    s_lshl_b32 s53, s72, 7
    ds_read_b128 v[116:119], v5 offset:2176
    v_mfma_f32_16x16x32_bf16 v[20:23], v[72:75], v[148:151], v[20:23]
    s_waitcnt lgkmcnt(10)
    s_add_u32 m0, s66, 62464
    s_add_u32 s16, s16, s53
    ds_read_b64 v[52:53], v4 offset:1664
    v_mfma_f32_16x16x32_bf16 v[20:23], v[84:87], v[136:139], v[20:23]
    s_waitcnt lgkmcnt(8)
    s_mul_i32 s53, s34, 131072
    ds_read_b64 v[54:55], v4 offset:1672
    buffer_load_dwordx4 v248, s[36:39], s67 offen offset:2048 sc1 lds
    v_mfma_f32_16x16x32_bf16 v[8:11], v[40:43], v[104:107], v[8:11]
    s_waitcnt lgkmcnt(8)
    s_add_u32 s10, s16, s53
    ds_read_b128 v[136:139], v5 offset:3776
    ds_read_b64 v[72:73], v4 offset:192
    v_mfma_f32_16x16x32_bf16 v[12:15], v[40:43], v[108:111], v[12:15]
    s_waitcnt lgkmcnt(8)
    s_lshl_b32 s63, s3, 10
    ds_read_b64 v[74:75], v4 offset:200
    ds_read_b128 v[140:143], v5 offset:3264
    v_mfma_f32_16x16x32_bf16 v[12:15], v[44:47], v[104:107], v[12:15]
    s_add_u32 s11, s10, 131072
    ds_read_b64 v[76:77], v4 offset:704
    v_mfma_f32_16x16x32_bf16 v[16:19], v[44:47], v[108:111], v[16:19]
    s_waitcnt lgkmcnt(10)
    s_add_u32 m0, s66, 62464
    s_sub_u32 s52, s11, 2621440
    ds_read_b64 v[78:79], v4 offset:712
    v_mfma_f32_16x16x32_bf16 v[16:19], v[40:43], v[112:115], v[16:19]
    s_waitcnt lgkmcnt(9)
    s_min_u32 s11, s11, s52
    ds_read_b128 v[144:147], v5 offset:2752
    buffer_load_dwordx4 v248, s[36:39], s67 offen offset:3072 sc1 lds
    v_mfma_f32_16x16x32_bf16 v[16:19], v[48:51], v[104:107], v[16:19]
    s_add_u32 s12, s11, 131072
    ds_read_b64 v[80:81], v4 offset:1216
    v_mfma_f32_16x16x32_bf16 v[20:23], v[44:47], v[112:115], v[20:23]
    s_sub_u32 s52, s12, 2621440
    ds_read_b64 v[82:83], v4 offset:1224
    v_mfma_f32_16x16x32_bf16 v[20:23], v[48:51], v[108:111], v[20:23]
    s_waitcnt lgkmcnt(11)
    s_min_u32 s12, s12, s52
    ds_read_b128 v[148:151], v5 offset:2240
    v_mfma_f32_16x16x32_bf16 v[20:23], v[40:43], v[116:119], v[20:23]
    s_waitcnt lgkmcnt(10)
    s_add_u32 s13, s12, 131072
    ds_read_b64 v[84:85], v4 offset:1728
    buffer_load_dwordx4 v[176:179], v231, s[36:39], s65 offen offset:0 sc1
    v_mfma_f32_16x16x32_bf16 v[20:23], v[52:55], v[104:107], v[20:23]
    s_waitcnt lgkmcnt(8)
    s_sub_u32 s52, s13, 2621440
    ds_read_b64 v[86:87], v4 offset:1736
    v_mfma_f32_16x16x32_bf16 v[8:11], v[72:75], v[136:139], v[8:11]
    s_waitcnt lgkmcnt(8)
    s_min_u32 s13, s13, s52
    ds_read_b128 v[104:107], v5 offset:3840
    ds_read_b64 v[40:41], v4 offset:256
    v_mfma_f32_16x16x32_bf16 v[12:15], v[72:75], v[140:143], v[12:15]
    s_waitcnt lgkmcnt(8)
    s_add_u32 s14, s13, 131072
    ds_read_b64 v[42:43], v4 offset:264
    ds_read_b128 v[108:111], v5 offset:3328
    v_mfma_f32_16x16x32_bf16 v[12:15], v[76:79], v[136:139], v[12:15]
    s_sub_u32 s52, s14, 2621440
    ds_read_b64 v[44:45], v4 offset:768
    v_mfma_f32_16x16x32_bf16 v[16:19], v[76:79], v[140:143], v[16:19]
    s_waitcnt lgkmcnt(10)
    s_min_u32 s14, s14, s52
    ds_read_b64 v[46:47], v4 offset:776
    buffer_load_dwordx4 v[180:183], v231, s[36:39], s65 offen offset:1024 sc1
    v_mfma_f32_16x16x32_bf16 v[16:19], v[72:75], v[144:147], v[16:19]
    s_waitcnt lgkmcnt(9)
    s_add_u32 s15, s14, 131072
    ds_read_b128 v[112:115], v5 offset:2816
    v_mfma_f32_16x16x32_bf16 v[16:19], v[80:83], v[136:139], v[16:19]
    s_sub_u32 s52, s15, 2621440
    ds_read_b64 v[48:49], v4 offset:1280
    v_mfma_f32_16x16x32_bf16 v[20:23], v[76:79], v[144:147], v[20:23]
    s_add_u32 m0, s61, 24832
    s_min_u32 s15, s15, s52
    ds_read_b64 v[50:51], v4 offset:1288
    v_mfma_f32_16x16x32_bf16 v[20:23], v[80:83], v[140:143], v[20:23]
    s_waitcnt lgkmcnt(11)
    s_add_u32 s18, s15, 131072
    ds_read_b128 v[116:119], v5 offset:2304
    buffer_load_dwordx4 v224, s[40:43], s64 offen offset:0 lds
    v_mfma_f32_16x16x32_bf16 v[20:23], v[72:75], v[148:151], v[20:23]
    s_waitcnt lgkmcnt(10)
    s_sub_u32 s52, s18, 2621440
    ds_read_b64 v[52:53], v4 offset:1792
    v_mfma_f32_16x16x32_bf16 v[20:23], v[84:87], v[136:139], v[20:23]
    s_waitcnt lgkmcnt(8)
    s_min_u32 s18, s18, s52
    ds_read_b64 v[54:55], v4 offset:1800
    v_mfma_f32_16x16x32_bf16 v[8:11], v[40:43], v[104:107], v[8:11]
    s_waitcnt lgkmcnt(8)
    s_add_u32 s19, s18, 131072
    ds_read_b128 v[136:139], v5 offset:3904
    ds_read_b64 v[72:73], v4 offset:320
    v_mfma_f32_16x16x32_bf16 v[12:15], v[40:43], v[108:111], v[12:15]
    s_waitcnt lgkmcnt(8)
    s_sub_u32 s52, s19, 2621440
    ds_read_b64 v[74:75], v4 offset:328
    ds_read_b128 v[140:143], v5 offset:3392
    v_mfma_f32_16x16x32_bf16 v[12:15], v[44:47], v[104:107], v[12:15]
    s_add_u32 m0, s61, 24832
    s_min_u32 s19, s19, s52
    ds_read_b64 v[76:77], v4 offset:832
    v_mfma_f32_16x16x32_bf16 v[16:19], v[44:47], v[108:111], v[16:19]
    s_waitcnt lgkmcnt(10)
    s_add_u32 s20, s19, 131072
    ds_read_b64 v[78:79], v4 offset:840
    buffer_load_dwordx4 v225, s[40:43], s64 offen offset:1024 lds
    v_mfma_f32_16x16x32_bf16 v[16:19], v[40:43], v[112:115], v[16:19]
    s_waitcnt lgkmcnt(9)
    s_sub_u32 s52, s20, 2621440
    ds_read_b128 v[144:147], v5 offset:2880
    v_mfma_f32_16x16x32_bf16 v[16:19], v[48:51], v[104:107], v[16:19]
    s_min_u32 s20, s20, s52
    ds_read_b64 v[80:81], v4 offset:1344
    v_mfma_f32_16x16x32_bf16 v[20:23], v[44:47], v[112:115], v[20:23]
    s_add_u32 s21, s20, 131072
    ds_read_b64 v[82:83], v4 offset:1352
    buffer_load_dwordx2 v[232:233], v253, s[36:39], s55 offen sc1
    v_mfma_f32_16x16x32_bf16 v[20:23], v[48:51], v[108:111], v[20:23]
    s_waitcnt lgkmcnt(11)
    s_sub_u32 s52, s21, 2621440
    ds_read_b128 v[148:151], v5 offset:2368
    v_mfma_f32_16x16x32_bf16 v[20:23], v[40:43], v[116:119], v[20:23]
    s_waitcnt lgkmcnt(10)
    s_add_u32 m0, s61, 24832
    s_min_u32 s21, s21, s52
    ds_read_b64 v[84:85], v4 offset:1856
    v_mfma_f32_16x16x32_bf16 v[20:23], v[52:55], v[104:107], v[20:23]
    s_waitcnt lgkmcnt(8)
    s_add_u32 s22, s21, 131072
    ds_read_b64 v[86:87], v4 offset:1864
    buffer_load_dwordx4 v226, s[40:43], s64 offen offset:2048 lds
    v_mfma_f32_16x16x32_bf16 v[8:11], v[72:75], v[136:139], v[8:11]
    s_waitcnt lgkmcnt(8)
    s_add_u32 s64, s64, 98304
    ds_read_b128 v[104:107], v5 offset:3968
    ds_read_b64 v[40:41], v4 offset:384
    v_mfma_f32_16x16x32_bf16 v[12:15], v[72:75], v[140:143], v[12:15]
    s_waitcnt lgkmcnt(8)
    s_sub_u32 s35, s64, 1966080
    ds_read_b64 v[42:43], v4 offset:392
    ds_read_b128 v[108:111], v5 offset:3456
    v_mfma_f32_16x16x32_bf16 v[12:15], v[76:79], v[136:139], v[12:15]
    s_min_u32 s64, s64, s35
    s_sub_u32 s52, s22, 2621440
    ds_read_b64 v[44:45], v4 offset:896
    v_mfma_f32_16x16x32_bf16 v[16:19], v[76:79], v[140:143], v[16:19]
    s_waitcnt lgkmcnt(10)
    s_min_u32 s22, s22, s52
    ds_read_b64 v[46:47], v4 offset:904
    v_mfma_f32_16x16x32_bf16 v[16:19], v[72:75], v[144:147], v[16:19]
    s_waitcnt lgkmcnt(9)
    s_add_u32 m0, s61, 37248
    s_add_u32 s23, s22, 131072
    ds_read_b128 v[112:115], v5 offset:2944
    v_mfma_f32_16x16x32_bf16 v[16:19], v[80:83], v[136:139], v[16:19]
    s_sub_u32 s52, s23, 2621440
    ds_read_b64 v[48:49], v4 offset:1408
    buffer_load_dwordx4 v224, s[40:43], s64 offen offset:0 lds
    v_mfma_f32_16x16x32_bf16 v[20:23], v[76:79], v[144:147], v[20:23]
    s_min_u32 s23, s23, s52
    ds_read_b64 v[50:51], v4 offset:1416
    v_mfma_f32_16x16x32_bf16 v[20:23], v[80:83], v[140:143], v[20:23]
    s_waitcnt lgkmcnt(11)
    s_add_u32 s24, s23, 131072
    ds_read_b128 v[116:119], v5 offset:2432
    v_mfma_f32_16x16x32_bf16 v[20:23], v[72:75], v[148:151], v[20:23]
    s_waitcnt lgkmcnt(10)
    s_sub_u32 s52, s24, 2621440
    ds_read_b64 v[52:53], v4 offset:1920
    v_mfma_f32_16x16x32_bf16 v[20:23], v[84:87], v[136:139], v[20:23]
    s_waitcnt lgkmcnt(8)
    s_add_u32 m0, s61, 37248
    s_min_u32 s24, s24, s52
    ds_read_b64 v[54:55], v4 offset:1928
    v_mfma_f32_16x16x32_bf16 v[8:11], v[40:43], v[104:107], v[8:11]
    s_add_u32 s25, s24, 131072
    ds_read_b128 v[136:139], v5 offset:4032
    ds_read_b64 v[72:73], v4 offset:448
    buffer_load_dwordx4 v225, s[40:43], s64 offen offset:1024 lds
    s_waitcnt lgkmcnt(10)
    v_mfma_f32_16x16x32_bf16 v[12:15], v[40:43], v[108:111], v[12:15]
    s_waitcnt lgkmcnt(8)
    s_sub_u32 s52, s25, 2621440
    ds_read_b64 v[74:75], v4 offset:456
    ds_read_b128 v[140:143], v5 offset:3520
    v_mfma_f32_16x16x32_bf16 v[12:15], v[44:47], v[104:107], v[12:15]
    s_min_u32 s25, s25, s52
    ds_read_b64 v[76:77], v4 offset:960
    v_mfma_f32_16x16x32_bf16 v[16:19], v[44:47], v[108:111], v[16:19]
    s_waitcnt lgkmcnt(10)
    s_add_u32 s26, s25, 131072
    ds_read_b64 v[78:79], v4 offset:968
    v_mfma_f32_16x16x32_bf16 v[16:19], v[40:43], v[112:115], v[16:19]
    s_waitcnt lgkmcnt(9)
    s_sub_u32 s52, s26, 2621440
    ds_read_b128 v[144:147], v5 offset:3008
    v_mfma_f32_16x16x32_bf16 v[16:19], v[48:51], v[104:107], v[16:19]
    s_add_u32 m0, s61, 37248
    s_min_u32 s26, s26, s52
    ds_read_b64 v[80:81], v4 offset:1472
    v_mfma_f32_16x16x32_bf16 v[20:23], v[44:47], v[112:115], v[20:23]
    s_add_u32 s27, s26, 131072
    ds_read_b64 v[82:83], v4 offset:1480
    buffer_load_dwordx4 v226, s[40:43], s64 offen offset:2048 lds
    v_mfma_f32_16x16x32_bf16 v[20:23], v[48:51], v[108:111], v[20:23]
    s_waitcnt lgkmcnt(11)
    s_add_u32 s64, s64, 98304
    s_sub_u32 s52, s27, 2621440
    ds_read_b128 v[148:151], v5 offset:2496
    v_mfma_f32_16x16x32_bf16 v[20:23], v[40:43], v[116:119], v[20:23]
    s_waitcnt lgkmcnt(10)
    s_sub_u32 s35, s64, 1966080
    s_min_u32 s27, s27, s52
    ds_read_b64 v[84:85], v4 offset:1984
    v_mfma_f32_16x16x32_bf16 v[20:23], v[52:55], v[104:107], v[20:23]
    s_waitcnt lgkmcnt(8)
    s_min_u32 s64, s64, s35
    s_add_u32 s44, s27, 131072
    ds_read_b64 v[86:87], v4 offset:1992
    v_mfma_f32_16x16x32_bf16 v[8:11], v[72:75], v[136:139], v[8:11]
    s_waitcnt lgkmcnt(8)
    s_sub_u32 s52, s44, 2621440
    ds_read_b128 v[112:115], v5 offset:2560
    ds_read_b64 v[48:49], v4 offset:1024
    v_mfma_f32_16x16x32_bf16 v[12:15], v[72:75], v[140:143], v[12:15]
    s_waitcnt lgkmcnt(8)
    s_add_u32 m0, s61, 49664
    ds_read_b64 v[50:51], v4 offset:1032
    ds_read_b128 v[116:119], v5 offset:2048
    v_mfma_f32_16x16x32_bf16 v[12:15], v[76:79], v[136:139], v[12:15]
    s_min_u32 s44, s44, s52
    ds_read_b64 v[52:53], v4 offset:1536
    ds_read_b64 v[54:55], v4 offset:1544
    buffer_load_dwordx4 v224, s[40:43], s64 offen offset:0 lds
    v_mfma_f32_16x16x32_bf16 v[16:19], v[76:79], v[140:143], v[16:19]
    s_waitcnt lgkmcnt(11)
    s_add_u32 s45, s44, 131072
    ds_read_b128 v[108:111], v5 offset:3072
    ds_read_b64 v[44:45], v4 offset:512
    v_mfma_f32_16x16x32_bf16 v[16:19], v[72:75], v[144:147], v[16:19]
    s_waitcnt lgkmcnt(11)
    s_sub_u32 s52, s45, 2621440
    ds_read_b64 v[46:47], v4 offset:520
    ds_read_b128 v[120:123], v5 offset:1536
    v_mfma_f32_16x16x32_bf16 v[16:19], v[80:83], v[136:139], v[16:19]
    s_min_u32 s45, s45, s52
    ds_read_b64 v[56:57], v4 offset:2048
    ds_read_b64 v[58:59], v4 offset:2056
    v_mfma_f32_16x16x32_bf16 v[20:23], v[76:79], v[144:147], v[20:23]
    s_add_u32 s46, s45, 131072
    ds_read_b128 v[104:107], v5 offset:3584
    ds_read_b64 v[40:41], v4 offset:0
    v_mfma_f32_16x16x32_bf16 v[20:23], v[80:83], v[140:143], v[20:23]
    s_waitcnt lgkmcnt(12)
    s_add_u32 m0, s61, 49664
    ds_read_b64 v[42:43], v4 offset:8
    ds_read_b128 v[124:127], v5 offset:1024
    v_mfma_f32_16x16x32_bf16 v[20:23], v[72:75], v[148:151], v[20:23]
    s_sub_u32 s52, s46, 2621440
    ds_read_b64 v[60:61], v4 offset:2560
    ds_read_b64 v[62:63], v4 offset:2568
    buffer_load_dwordx4 v225, s[40:43], s64 offen offset:1024 lds
    v_mfma_f32_16x16x32_bf16 v[20:23], v[84:87], v[136:139], v[20:23]
    s_waitcnt vmcnt(11)
    s_barrier
    ds_read_b128 v[128:131], v5 offset:512
    ds_read_b64 v[64:65], v4 offset:3072
    ds_read_b64 v[66:67], v4 offset:3080
    ds_read_b128 v[132:135], v5 offset:0
    ds_read_b64 v[68:69], v4 offset:3584
    ds_read_b64 v[70:71], v4 offset:3592
    s_waitcnt lgkmcnt(14)
    v_mfma_f32_16x16x32_bf16 v[24:27], v[48:51], v[112:115], 0
    s_min_u32 s46, s46, s52
    ds_read_b128 v[184:187], v249 offset:0
    v_mfma_f32_16x16x32_bf16 v[28:31], v[48:51], v[116:119], 0
    s_add_u32 s47, s46, 131072
    ds_read_b128 v[200:203], v249 offset:8192
    v_mfma_f32_16x16x32_bf16 v[28:31], v[52:55], v[112:115], v[28:31]
    s_sub_u32 s52, s47, 2621440
    ds_read_b128 v[188:191], v249 offset:1024
    v_mfma_f32_16x16x32_bf16 v[32:35], v[52:55], v[116:119], 0
    s_add_u32 m0, s61, 49664
    s_min_u32 s47, s47, s52
    ds_read_b128 v[204:207], v249 offset:9216
    v_mfma_f32_16x16x32_bf16 v[24:27], v[44:47], v[116:119], v[24:27]
    s_lshl_b32 s62, s75, 2
    ds_read_b128 v[144:147], v5 offset:2624
    ds_read_b128 v[192:195], v249 offset:2048
    buffer_load_dwordx4 v226, s[40:43], s64 offen offset:2048 lds
    v_mfma_f32_16x16x32_bf16 v[24:27], v[52:55], v[108:111], v[24:27]
    s_add_u32 s64, s64, 98304
    ds_read_b64 v[80:81], v4 offset:1088
    ds_read_b128 v[208:211], v249 offset:10240
    v_mfma_f32_16x16x32_bf16 v[32:35], v[48:51], v[120:123], v[32:35]
    s_waitcnt lgkmcnt(12)
    s_sub_u32 s35, s64, 1966080
    ds_read_b64 v[82:83], v4 offset:1096
    ds_read_b128 v[196:199], v249 offset:3072
    v_mfma_f32_16x16x32_bf16 v[32:35], v[56:59], v[112:115], v[32:35]
    s_min_u32 s64, s64, s35
    ds_read_b128 v[148:151], v5 offset:2112
    ds_read_b128 v[212:215], v249 offset:11264
    v_mfma_f32_16x16x32_bf16 v[36:39], v[52:55], v[120:123], 0
    s_add_u32 s62, s62, s3
    ds_read_b64 v[84:85], v4 offset:1600
    v_mfma_f32_16x16x32_bf16 v[36:39], v[56:59], v[116:119], v[36:39]
    s_mul_i32 s62, s62, 61440
    ds_read_b64 v[86:87], v4 offset:1608
    v_mfma_f32_16x16x32_bf16 v[28:31], v[44:47], v[120:123], v[28:31]
    s_add_u32 s62, s62, 14417920
    ds_read_b128 v[140:143], v5 offset:3136
    v_mfma_f32_16x16x32_bf16 v[28:31], v[56:59], v[108:111], v[28:31]
    ds_read_b64 v[76:77], v4 offset:576
    s_waitcnt vmcnt(7)
    v_cmp_ne_u32 vcc, s48, v233
    s_cbranch_vccnz L_m_slow
L_m_back:
    v_mov_b32_dpp v252, v232 quad_perm:[3,3,3,3] row_mask:0xf bank_mask:0xf
    s_nop 1
    v_mul_f32_dpp v251, v232, v252 quad_perm:[2,2,2,2] row_mask:0xf bank_mask:0xf
    s_nop 1
    v_mul_f32_dpp v250, v232, v251 quad_perm:[1,1,1,1] row_mask:0xf bank_mask:0xf
    v_mul_f32_dpp v251, v232, v251 quad_perm:[0,0,0,0] row_mask:0xf bank_mask:0xf
    v_permlane16_swap_b32 v176, v178
    v_permlane16_swap_b32 v177, v179
    v_permlane16_swap_b32 v180, v182
    v_permlane16_swap_b32 v181, v183
    v_lshlrev_b32 v232, 16, v176
    v_and_b32 v233, 0xffff0000, v176
    v_lshlrev_b32 v234, 16, v177
    v_and_b32 v235, 0xffff0000, v177
    s_waitcnt lgkmcnt(14)
    v_pk_fma_f32 v[184:185], v[232:233], v[184:185], v[200:201]
    v_pk_fma_f32 v[186:187], v[234:235], v[186:187], v[202:203]
    v_pk_mul_f32 v[200:201], v[232:233], v[252:253] op_sel_hi:[1,0]
    v_pk_mul_f32 v[202:203], v[234:235], v[252:253] op_sel_hi:[1,0]
    v_pk_fma_f32 v[184:185], v[184:185], v[250:251], v[250:251] op_sel:[0,0,1] op_sel_hi:[1,0,1]
    v_pk_fma_f32 v[186:187], v[186:187], v[250:251], v[250:251] op_sel:[0,0,1] op_sel_hi:[1,0,1]
    v_lshlrev_b32 v236, 16, v178
    v_and_b32 v237, 0xffff0000, v178
    v_lshlrev_b32 v238, 16, v179
    v_and_b32 v239, 0xffff0000, v179
    s_waitcnt lgkmcnt(12)
    v_pk_fma_f32 v[188:189], v[236:237], v[188:189], v[204:205]
    v_pk_fma_f32 v[190:191], v[238:239], v[190:191], v[206:207]
    v_pk_mul_f32 v[204:205], v[236:237], v[252:253] op_sel_hi:[1,0]
    v_pk_mul_f32 v[206:207], v[238:239], v[252:253] op_sel_hi:[1,0]
    v_pk_fma_f32 v[188:189], v[188:189], v[250:251], v[250:251] op_sel:[0,0,1] op_sel_hi:[1,0,1]
    v_pk_fma_f32 v[190:191], v[190:191], v[250:251], v[250:251] op_sel:[0,0,1] op_sel_hi:[1,0,1]
    v_lshlrev_b32 v232, 16, v180
    v_and_b32 v233, 0xffff0000, v180
    v_lshlrev_b32 v234, 16, v181
    v_and_b32 v235, 0xffff0000, v181
    s_waitcnt lgkmcnt(8)
    v_pk_fma_f32 v[192:193], v[232:233], v[192:193], v[208:209]
    v_pk_fma_f32 v[194:195], v[234:235], v[194:195], v[210:211]
    v_pk_mul_f32 v[208:209], v[232:233], v[252:253] op_sel_hi:[1,0]
    v_pk_mul_f32 v[210:211], v[234:235], v[252:253] op_sel_hi:[1,0]
    v_pk_fma_f32 v[192:193], v[192:193], v[250:251], v[250:251] op_sel:[0,0,1] op_sel_hi:[1,0,1]
    v_pk_fma_f32 v[194:195], v[194:195], v[250:251], v[250:251] op_sel:[0,0,1] op_sel_hi:[1,0,1]
    v_lshlrev_b32 v236, 16, v182
    v_and_b32 v237, 0xffff0000, v182
    v_lshlrev_b32 v238, 16, v183
    v_and_b32 v239, 0xffff0000, v183
    s_waitcnt lgkmcnt(4)
    v_pk_fma_f32 v[196:197], v[236:237], v[196:197], v[212:213]
    v_pk_fma_f32 v[198:199], v[238:239], v[198:199], v[214:215]
    v_pk_mul_f32 v[212:213], v[236:237], v[252:253] op_sel_hi:[1,0]
    v_pk_mul_f32 v[214:215], v[238:239], v[252:253] op_sel_hi:[1,0]
    v_pk_fma_f32 v[196:197], v[196:197], v[250:251], v[250:251] op_sel:[0,0,1] op_sel_hi:[1,0,1]
    v_pk_fma_f32 v[198:199], v[198:199], v[250:251], v[250:251] op_sel:[0,0,1] op_sel_hi:[1,0,1]
    v_pk_fma_f32 v[184:185], v[184:185], v[8:9], v[200:201]
    v_pk_fma_f32 v[186:187], v[186:187], v[10:11], v[202:203]
    v_cvt_pk_bf16_f32 v232, v184, v185
    v_cvt_pk_bf16_f32 v233, v186, v187
    v_pk_fma_f32 v[188:189], v[188:189], v[12:13], v[204:205]
    v_pk_fma_f32 v[190:191], v[190:191], v[14:15], v[206:207]
    v_cvt_pk_bf16_f32 v234, v188, v189
    v_cvt_pk_bf16_f32 v235, v190, v191
    s_nop 0
    v_permlane16_swap_b32 v232, v234
    v_permlane16_swap_b32 v233, v235
    buffer_store_dwordx4 v[232:235], v231, s[36:39], s68 offen offset:0 sc1
    v_pk_fma_f32 v[192:193], v[192:193], v[16:17], v[208:209]
    v_pk_fma_f32 v[194:195], v[194:195], v[18:19], v[210:211]
    v_cvt_pk_bf16_f32 v236, v192, v193
    v_cvt_pk_bf16_f32 v237, v194, v195
    v_pk_fma_f32 v[196:197], v[196:197], v[20:21], v[212:213]
    v_pk_fma_f32 v[198:199], v[198:199], v[22:23], v[214:215]
    v_cvt_pk_bf16_f32 v238, v196, v197
    v_cvt_pk_bf16_f32 v239, v198, v199
    s_nop 0
    v_permlane16_swap_b32 v236, v238
    v_permlane16_swap_b32 v237, v239
    buffer_store_dwordx4 v[236:239], v231, s[36:39], s68 offen offset:1024 sc1
    v_mfma_f32_16x16x32_bf16 v[24:27], v[40:43], v[120:123], v[24:27]
    ds_read_b64 v[78:79], v4 offset:584
    buffer_load_dwordx4 v[176:179], v231, s[36:39], s65 offen offset:2048 sc1
    v_mfma_f32_16x16x32_bf16 v[24:27], v[244:247], v[120:123], v[24:27]
    ds_read_b128 v[152:155], v5 offset:1600
    ds_read_b128 v[184:187], v249 offset:4096
    v_mfma_f32_16x16x32_bf16 v[24:27], v[56:59], v[104:107], v[24:27]
    ds_read_b64 v[88:89], v4 offset:2112
    ds_read_b128 v[200:203], v249 offset:12288
    v_mfma_f32_16x16x32_bf16 v[36:39], v[48:51], v[124:127], v[36:39]
    ds_read_b64 v[90:91], v4 offset:2120
    ds_read_b128 v[188:191], v249 offset:5120
    v_mfma_f32_16x16x32_bf16 v[36:39], v[60:63], v[112:115], v[36:39]
    ds_read_b128 v[136:139], v5 offset:3648
    ds_read_b128 v[204:207], v249 offset:13312
    v_mfma_f32_16x16x32_bf16 v[32:35], v[44:47], v[124:127], v[32:35]
    ds_read_b64 v[72:73], v4 offset:64
    ds_read_b128 v[192:195], v249 offset:6144
    buffer_load_dwordx4 v[180:183], v231, s[36:39], s65 offen offset:3072 sc1
    v_mfma_f32_16x16x32_bf16 v[32:35], v[60:63], v[108:111], v[32:35]
    s_barrier
    ds_read_b64 v[74:75], v4 offset:72
    ds_read_b128 v[208:211], v249 offset:14336
    ds_read_b64_tr_b16 a[60:61], v227 offset:0
    v_mfma_f32_16x16x32_bf16 v[28:31], v[40:43], v[124:127], v[28:31]
    ds_read_b128 v[156:159], v5 offset:1088
    ds_read_b128 v[196:199], v249 offset:7168
    ds_read_b64_tr_b16 a[62:63], v227 offset:1536
    v_mfma_f32_16x16x32_bf16 v[28:31], v[244:247], v[124:127], v[28:31]
    ds_read_b64 v[92:93], v4 offset:2624
    ds_read_b128 v[212:215], v249 offset:15360
    ds_read_b64_tr_b16 a[64:65], v227 offset:6224
    v_mfma_f32_16x16x32_bf16 v[28:31], v[60:63], v[104:107], v[28:31]
    ds_read_b64 v[94:95], v4 offset:2632
    buffer_load_dword v243, v241, s[36:39], s60 offen sc1
    v_mfma_f32_16x16x32_bf16 v[36:39], v[44:47], v[128:131], v[36:39]
    ds_read_b128 v[160:163], v5 offset:576
    ds_read_b64_tr_b16 a[66:67], v227 offset:7760
    v_mfma_f32_16x16x32_bf16 v[36:39], v[64:67], v[108:111], v[36:39]
    ds_read_b64 v[96:97], v4 offset:3136
    ds_read_b64_tr_b16 a[68:69], v228 offset:0
    v_mfma_f32_16x16x32_bf16 v[32:35], v[40:43], v[128:131], v[32:35]
    ds_read_b64 v[98:99], v4 offset:3144
    ds_read_b64_tr_b16 a[70:71], v228 offset:1536
    v_mfma_f32_16x16x32_bf16 v[32:35], v[244:247], v[128:131], v[32:35]
    ds_read_b128 v[164:167], v5 offset:64
    v_mfma_f32_16x16x32_bf16 v[32:35], v[64:67], v[104:107], v[32:35]
    ds_read_b64 v[100:101], v4 offset:3648
    v_mfma_f32_16x16x32_bf16 v[36:39], v[40:43], v[132:135], v[36:39]
    ds_read_b64 v[102:103], v4 offset:3656
    v_mfma_f32_16x16x32_bf16 v[36:39], v[244:247], v[132:135], v[36:39]
    v_mfma_f32_16x16x32_bf16 v[36:39], v[68:71], v[104:107], v[36:39]
    v_mfma_f32_16x16x32_bf16 v[24:27], v[80:83], v[144:147], v[24:27]
    ds_read_b128 v[112:115], v5 offset:2688
    v_mfma_f32_16x16x32_bf16 v[28:31], v[80:83], v[148:151], v[28:31]
    s_waitcnt lgkmcnt(13)
    ds_read_b64 v[48:49], v4 offset:1152
    v_mfma_f32_16x16x32_bf16 v[28:31], v[84:87], v[144:147], v[28:31]
    ds_read_b64 v[50:51], v4 offset:1160
    v_mfma_f32_16x16x32_bf16 v[32:35], v[84:87], v[148:151], v[32:35]
    ds_read_b128 v[116:119], v5 offset:2176
    v_mfma_f32_16x16x32_bf16 v[24:27], v[76:79], v[148:151], v[24:27]
    ds_read_b64 v[52:53], v4 offset:1664
    v_mfma_f32_16x16x32_bf16 v[24:27], v[84:87], v[140:143], v[24:27]
    ds_read_b64 v[54:55], v4 offset:1672
    v_mfma_f32_16x16x32_bf16 v[32:35], v[80:83], v[152:155], v[32:35]
    s_waitcnt lgkmcnt(9)
    s_barrier
    s_add_u32 m0, s61, 0
    ds_read_b128 v[108:111], v5 offset:3200
    v_mfma_f32_16x16x32_bf16 v[32:35], v[88:91], v[144:147], v[32:35]
    ds_read_b64 v[44:45], v4 offset:640
    ds_read_b64_tr_b16 a[72:73], v227 offset:12416
    buffer_load_dwordx4 v224, s[40:43], s64 offen offset:0 lds
    v_mfma_f32_16x16x32_bf16 v[36:39], v[84:87], v[152:155], v[36:39]
    ds_read_b64 v[46:47], v4 offset:648
    ds_read_b64_tr_b16 a[74:75], v227 offset:13952
    v_mfma_f32_16x16x32_bf16 v[36:39], v[88:91], v[148:151], v[36:39]
    ds_read_b128 v[120:123], v5 offset:1664
    ds_read_b64_tr_b16 a[76:77], v227 offset:18640
    v_mfma_f32_16x16x32_bf16 v[28:31], v[76:79], v[152:155], v[28:31]
    ds_read_b64 v[56:57], v4 offset:2176
    ds_read_b64_tr_b16 a[78:79], v227 offset:20176
    v_mfma_f32_16x16x32_bf16 v[28:31], v[88:91], v[140:143], v[28:31]
    ds_read_b64 v[58:59], v4 offset:2184
    ds_read_b64_tr_b16 a[80:81], v228 offset:12416
    v_mfma_f32_16x16x32_bf16 v[24:27], v[72:75], v[152:155], v[24:27]
    s_add_u32 m0, s61, 0
    ds_read_b128 v[104:107], v5 offset:3712
    ds_read_b64_tr_b16 a[82:83], v228 offset:13952
    v_mfma_f32_16x16x32_bf16 v[24:27], v[88:91], v[136:139], v[24:27]
    ds_read_b64 v[40:41], v4 offset:128
    buffer_load_dwordx4 v225, s[40:43], s64 offen offset:1024 lds
    v_mfma_f32_16x16x32_bf16 v[36:39], v[80:83], v[156:159], v[36:39]
    ds_read_b64 v[42:43], v4 offset:136
    v_mfma_f32_16x16x32_bf16 v[36:39], v[92:95], v[144:147], v[36:39]
    ds_read_b128 v[124:127], v5 offset:1152
    v_mfma_f32_16x16x32_bf16 v[32:35], v[76:79], v[156:159], v[32:35]
    ds_read_b64 v[60:61], v4 offset:2688
    v_mfma_f32_16x16x32_bf16 v[32:35], v[92:95], v[140:143], v[32:35]
    ds_read_b64 v[62:63], v4 offset:2696
    v_mfma_f32_16x16x32_bf16 v[28:31], v[72:75], v[156:159], v[28:31]
    s_add_u32 m0, s61, 0
    ds_read_b128 v[128:131], v5 offset:640
    v_mfma_f32_16x16x32_bf16 v[28:31], v[92:95], v[136:139], v[28:31]
    ds_read_b64 v[64:65], v4 offset:3200
    buffer_load_dwordx4 v226, s[40:43], s64 offen offset:2048 lds
    v_mfma_f32_16x16x32_bf16 v[36:39], v[76:79], v[160:163], v[36:39]
    s_add_u32 s64, s64, 98304
    ds_read_b64 v[66:67], v4 offset:3208
    v_mfma_f32_16x16x32_bf16 v[36:39], v[96:99], v[140:143], v[36:39]
    s_sub_u32 s35, s64, 1966080
    ds_read_b128 v[132:135], v5 offset:128
    v_mfma_f32_16x16x32_bf16 v[32:35], v[72:75], v[160:163], v[32:35]
    s_min_u32 s64, s64, s35
    ds_read_b64 v[68:69], v4 offset:3712
    v_mfma_f32_16x16x32_bf16 v[32:35], v[96:99], v[136:139], v[32:35]
    s_waitcnt lgkmcnt(13)
    ds_read_b64 v[70:71], v4 offset:3720
    v_mfma_f32_16x16x32_bf16 v[36:39], v[72:75], v[164:167], v[36:39]
    v_mfma_f32_16x16x32_bf16 v[36:39], v[100:103], v[136:139], v[36:39]
    s_waitcnt vmcnt(14)
    s_waitcnt lgkmcnt(11)
    s_barrier
    s_add_u32 m0, s61, 12416
    ds_read_b64_tr_b16 a[84:85], v227 offset:24832
    v_mfma_f32_16x16x32_bf16 v[24:27], v[48:51], v[112:115], v[24:27]
    s_waitcnt vmcnt(6)
    s_barrier
    s_cmp_eq_u32 s3, 0
    s_cbranch_scc0 L_wf5
    s_lshl_b32 s54, s70, 7
    s_add_u32 s54, s54, 23245824
    v_mov_b32 v254, 0
    v_mov_b32 v255, s48
    s_mov_b64 exec, 1
    buffer_store_dword v255, v254, s[36:39], s54 offen sc1
    s_mov_b64 exec, -1
L_wf5:
    ds_read_b128 v[144:147], v5 offset:2752
    buffer_load_dwordx4 v224, s[40:43], s64 offen offset:0 lds
    v_mfma_f32_16x16x32_bf16 v[28:31], v[48:51], v[116:119], v[28:31]
    ds_read_b64 v[80:81], v4 offset:1216
    ds_read_b64_tr_b16 a[86:87], v227 offset:26368
    v_mfma_f32_16x16x32_bf16 v[28:31], v[52:55], v[112:115], v[28:31]
    ds_read_b64 v[82:83], v4 offset:1224
    ds_read_b64_tr_b16 a[88:89], v227 offset:31056
    v_mfma_f32_16x16x32_bf16 v[32:35], v[52:55], v[116:119], v[32:35]
    ds_read_b128 v[148:151], v5 offset:2240
    ds_read_b64_tr_b16 a[90:91], v227 offset:32592
    v_mfma_f32_16x16x32_bf16 v[24:27], v[44:47], v[116:119], v[24:27]
    ds_read_b64 v[84:85], v4 offset:1728
    ds_read_b64_tr_b16 a[92:93], v228 offset:24832
    v_mfma_f32_16x16x32_bf16 v[24:27], v[52:55], v[108:111], v[24:27]
    s_add_u32 m0, s61, 12416
    ds_read_b64 v[86:87], v4 offset:1736
    ds_read_b64_tr_b16 a[94:95], v228 offset:26368
    v_mfma_f32_16x16x32_bf16 v[32:35], v[48:51], v[120:123], v[32:35]
    ds_read_b128 v[140:143], v5 offset:3264
    buffer_load_dwordx4 v225, s[40:43], s64 offen offset:1024 lds
    v_mfma_f32_16x16x32_bf16 v[32:35], v[56:59], v[112:115], v[32:35]
    ds_read_b64 v[76:77], v4 offset:704
    v_mfma_f32_16x16x32_bf16 v[36:39], v[52:55], v[120:123], v[36:39]
    ds_read_b64 v[78:79], v4 offset:712
    v_mfma_f32_16x16x32_bf16 v[36:39], v[56:59], v[116:119], v[36:39]
    ds_read_b128 v[152:155], v5 offset:1728
    v_mfma_f32_16x16x32_bf16 v[28:31], v[44:47], v[120:123], v[28:31]
    ds_read_b64 v[88:89], v4 offset:2240
    v_mfma_f32_16x16x32_bf16 v[28:31], v[56:59], v[108:111], v[28:31]
    s_add_u32 m0, s61, 12416
    ds_read_b64 v[90:91], v4 offset:2248
    s_waitcnt vmcnt(7)
    v_permlane16_swap_b32 v176, v178
    s_waitcnt lgkmcnt(14)
    v_mfma_f32_16x16x32_bf16 v[24:27], v[40:43], v[120:123], v[24:27]
    ds_read_b128 v[136:139], v5 offset:3776
    buffer_load_dwordx4 v226, s[40:43], s64 offen offset:2048 lds
    v_mfma_f32_16x16x32_bf16 v[24:27], v[56:59], v[104:107], v[24:27]
    s_add_u32 s64, s64, 98304
    ds_read_b64 v[72:73], v4 offset:192
    v_permlane16_swap_b32 v177, v179
    v_mfma_f32_16x16x32_bf16 v[36:39], v[48:51], v[124:127], v[36:39]
    s_sub_u32 s35, s64, 1966080
    ds_read_b64 v[74:75], v4 offset:200
    s_waitcnt vmcnt(7)
    v_permlane16_swap_b32 v180, v182
    v_mfma_f32_16x16x32_bf16 v[36:39], v[60:63], v[112:115], v[36:39]
    s_min_u32 s64, s64, s35
    ds_read_b128 v[156:159], v5 offset:1216
    v_permlane16_swap_b32 v181, v183
    s_waitcnt vmcnt(6)
    v_cmp_ne_u32 vcc, s48, v243
    s_cbranch_vccnz L_chk6_slow
L_chk6_back:
    v_mfma_f32_16x16x32_bf16 v[32:35], v[44:47], v[124:127], v[32:35]
    ds_read_b64 v[92:93], v4 offset:2752
    v_lshlrev_b32 v232, 16, v176
    v_lshlrev_b32 v2, 2, v0
    v_mov_b32 v3, 0x80000000
    v_cmp_gt_u32 vcc, 128, v0
    s_nop 1
    v_cndmask_b32 v3, v3, v2, vcc
    v_mfma_f32_16x16x32_bf16 v[32:35], v[60:63], v[108:111], v[32:35]
    s_lshl_b32 s56, s34, 7
    ds_read_b64 v[94:95], v4 offset:2760
    v_fma_f32 v184, v232, v184, v200
    v_mul_f32 v200, v252, v232
    v_mfma_f32_16x16x32_bf16 v[28:31], v[40:43], v[124:127], v[28:31]
    s_waitcnt lgkmcnt(12)
    s_barrier
    s_add_u32 m0, s61, 24832
    ds_read_b128 v[160:163], v5 offset:704
    v_mfma_f32_16x16x32_bf16 v[28:31], v[60:63], v[104:107], v[28:31]
    s_add_u32 s56, s56, 23183360
    ds_read_b64 v[96:97], v4 offset:3264
    ds_read_b64_tr_b16 a[96:97], v227 offset:37248
    buffer_load_dwordx4 v224, s[40:43], s64 offen offset:0 lds
    v_mfma_f32_16x16x32_bf16 v[36:39], v[44:47], v[128:131], v[36:39]
    ds_read_b64 v[98:99], v4 offset:3272
    ds_read_b64_tr_b16 a[98:99], v227 offset:38784
    buffer_load_dword v220, v2, s[36:39], s56 offen sc1
    v_mfma_f32_16x16x32_bf16 v[36:39], v[64:67], v[108:111], v[36:39]
    ds_read_b128 v[164:167], v5 offset:192
    ds_read_b64_tr_b16 a[100:101], v227 offset:43472
    buffer_load_dword v221, v2, s[36:39], s56 offen offset:1024 sc1
    v_mfma_f32_16x16x32_bf16 v[32:35], v[40:43], v[128:131], v[32:35]
    ds_read_b64 v[100:101], v4 offset:3776
    ds_read_b64_tr_b16 a[102:103], v227 offset:45008
    buffer_load_dword v222, v3, s[36:39], s56 offen offset:2048 sc1
    v_mfma_f32_16x16x32_bf16 v[32:35], v[64:67], v[104:107], v[32:35]
    ds_read_b64 v[102:103], v4 offset:3784
    ds_read_b64_tr_b16 a[104:105], v228 offset:37248
    v_mfma_f32_16x16x32_bf16 v[36:39], v[40:43], v[132:135], v[36:39]
    s_add_u32 m0, s61, 24832
    ds_read_b64_tr_b16 a[106:107], v228 offset:38784
    v_fma_f32 v184, v184, v250, v251
    v_mfma_f32_16x16x32_bf16 v[36:39], v[68:71], v[104:107], v[36:39]
    buffer_load_dwordx4 v225, s[40:43], s64 offen offset:1024 lds
    v_mfma_f32_16x16x32_bf16 v[24:27], v[80:83], v[144:147], v[24:27]
    ds_read_b128 v[112:115], v5 offset:2816
    v_and_b32 v233, 0xffff0000, v176
    v_mfma_f32_16x16x32_bf16 v[28:31], v[80:83], v[148:151], v[28:31]
    ds_read_b64 v[48:49], v4 offset:1280
    v_fma_f32 v185, v233, v185, v201
    v_mfma_f32_16x16x32_bf16 v[28:31], v[84:87], v[144:147], v[28:31]
    ds_read_b64 v[50:51], v4 offset:1288
    v_mul_f32 v201, v252, v233
    v_mfma_f32_16x16x32_bf16 v[32:35], v[84:87], v[148:151], v[32:35]
    s_waitcnt lgkmcnt(13)
    ds_read_b128 v[116:119], v5 offset:2304
    v_fma_f32 v185, v185, v250, v251
    v_mfma_f32_16x16x32_bf16 v[24:27], v[76:79], v[148:151], v[24:27]
    s_add_u32 m0, s61, 24832
    ds_read_b64 v[52:53], v4 offset:1792
    v_lshlrev_b32 v232, 16, v177
    v_mfma_f32_16x16x32_bf16 v[24:27], v[84:87], v[140:143], v[24:27]
    ds_read_b64 v[54:55], v4 offset:1800
    buffer_load_dwordx4 v226, s[40:43], s64 offen offset:2048 lds
    v_mfma_f32_16x16x32_bf16 v[32:35], v[80:83], v[152:155], v[32:35]
    s_add_u32 s64, s64, 98304
    ds_read_b128 v[108:111], v5 offset:3328
    v_fma_f32 v186, v232, v186, v202
    v_mfma_f32_16x16x32_bf16 v[32:35], v[88:91], v[144:147], v[32:35]
    s_sub_u32 s35, s64, 1966080
    ds_read_b64 v[44:45], v4 offset:768
    v_mul_f32 v202, v252, v232
    v_mfma_f32_16x16x32_bf16 v[36:39], v[84:87], v[152:155], v[36:39]
    s_min_u32 s64, s64, s35
    ds_read_b64 v[46:47], v4 offset:776
    v_fma_f32 v186, v186, v250, v251
    v_mfma_f32_16x16x32_bf16 v[36:39], v[88:91], v[148:151], v[36:39]
    ds_read_b128 v[120:123], v5 offset:1792
    v_and_b32 v233, 0xffff0000, v177
    v_fma_f32 v187, v233, v187, v203
    v_mfma_f32_16x16x32_bf16 v[28:31], v[76:79], v[152:155], v[28:31]
    s_waitcnt lgkmcnt(10)
    s_barrier
    s_add_u32 m0, s61, 37248
    ds_read_b64 v[56:57], v4 offset:2304
    v_mfma_f32_16x16x32_bf16 v[28:31], v[88:91], v[140:143], v[28:31]
    ds_read_b64 v[58:59], v4 offset:2312
    ds_read_b64_tr_b16 a[108:109], v227 offset:49664
    buffer_load_dwordx4 v224, s[40:43], s64 offen offset:0 lds
    v_mfma_f32_16x16x32_bf16 v[24:27], v[72:75], v[152:155], v[24:27]
    ds_read_b128 v[104:107], v5 offset:3840
    ds_read_b64_tr_b16 a[110:111], v227 offset:51200
    v_mfma_f32_16x16x32_bf16 v[24:27], v[88:91], v[136:139], v[24:27]
    ds_read_b64 v[40:41], v4 offset:256
    ds_read_b64_tr_b16 a[112:113], v227 offset:55888
    v_mfma_f32_16x16x32_bf16 v[36:39], v[80:83], v[156:159], v[36:39]
    ds_read_b64 v[42:43], v4 offset:264
    ds_read_b64_tr_b16 a[114:115], v227 offset:57424
    v_mfma_f32_16x16x32_bf16 v[36:39], v[92:95], v[144:147], v[36:39]
    s_add_u32 m0, s61, 37248
    ds_read_b128 v[124:127], v5 offset:1280
    ds_read_b64_tr_b16 a[116:117], v228 offset:49664
    v_mfma_f32_16x16x32_bf16 v[32:35], v[76:79], v[156:159], v[32:35]
    ds_read_b64 v[60:61], v4 offset:2816
    ds_read_b64_tr_b16 a[118:119], v228 offset:51200
    buffer_load_dwordx4 v225, s[40:43], s64 offen offset:1024 lds
    v_mfma_f32_16x16x32_bf16 v[32:35], v[92:95], v[140:143], v[32:35]
    ds_read_b64 v[62:63], v4 offset:2824
    v_mul_f32 v203, v252, v233
    v_mfma_f32_16x16x32_bf16 v[28:31], v[72:75], v[156:159], v[28:31]
    ds_read_b128 v[128:131], v5 offset:768
    v_fma_f32 v187, v187, v250, v251
    v_mfma_f32_16x16x32_bf16 v[28:31], v[92:95], v[136:139], v[28:31]
    ds_read_b64 v[64:65], v4 offset:3328
    v_lshlrev_b32 v232, 16, v178
    v_mfma_f32_16x16x32_bf16 v[36:39], v[76:79], v[160:163], v[36:39]
    ds_read_b64 v[66:67], v4 offset:3336
    v_fma_f32 v188, v232, v188, v204
    v_mfma_f32_16x16x32_bf16 v[36:39], v[96:99], v[140:143], v[36:39]
    s_add_u32 m0, s61, 37248
    ds_read_b128 v[132:135], v5 offset:256
    v_mul_f32 v204, v252, v232
    v_mfma_f32_16x16x32_bf16 v[32:35], v[72:75], v[160:163], v[32:35]
    ds_read_b64 v[68:69], v4 offset:3840
    buffer_load_dwordx4 v226, s[40:43], s64 offen offset:2048 lds
    v_mfma_f32_16x16x32_bf16 v[32:35], v[96:99], v[136:139], v[32:35]
    s_add_u32 s64, s64, 98304
    ds_read_b64 v[70:71], v4 offset:3848
    v_fma_f32 v188, v188, v250, v251
    v_mfma_f32_16x16x32_bf16 v[36:39], v[72:75], v[164:167], v[36:39]
    s_sub_u32 s35, s64, 1966080
    v_and_b32 v233, 0xffff0000, v178
    v_fma_f32 v189, v233, v189, v205
    v_mfma_f32_16x16x32_bf16 v[36:39], v[100:103], v[136:139], v[36:39]
    s_waitcnt lgkmcnt(14)
    s_min_u32 s64, s64, s35
    v_mul_f32 v205, v252, v233
    v_fma_f32 v189, v189, v250, v251
    v_mfma_f32_16x16x32_bf16 v[24:27], v[48:51], v[112:115], v[24:27]
    ds_read_b128 v[144:147], v5 offset:2880
    v_lshlrev_b32 v232, 16, v179
    v_mfma_f32_16x16x32_bf16 v[28:31], v[48:51], v[116:119], v[28:31]
    ds_read_b64 v[80:81], v4 offset:1344
    v_fma_f32 v190, v232, v190, v206
    v_mfma_f32_16x16x32_bf16 v[28:31], v[52:55], v[112:115], v[28:31]
    ds_read_b64 v[82:83], v4 offset:1352
    v_mul_f32 v206, v252, v232
    v_mfma_f32_16x16x32_bf16 v[32:35], v[52:55], v[116:119], v[32:35]
    s_waitcnt vmcnt(12)
    s_waitcnt lgkmcnt(10)
    s_barrier
    s_add_u32 m0, s61, 49664
    ds_read_b128 v[148:151], v5 offset:2368
    v_mfma_f32_16x16x32_bf16 v[24:27], v[44:47], v[116:119], v[24:27]
    ds_read_b64 v[84:85], v4 offset:1856
    ds_read_b64_tr_b16 a[120:121], v227 offset:0
    buffer_load_dwordx4 v224, s[40:43], s64 offen offset:0 lds
    v_mfma_f32_16x16x32_bf16 v[24:27], v[52:55], v[108:111], v[24:27]
    ds_read_b64 v[86:87], v4 offset:1864
    ds_read_b64_tr_b16 a[122:123], v227 offset:1536
    v_mfma_f32_16x16x32_bf16 v[32:35], v[48:51], v[120:123], v[32:35]
    ds_read_b128 v[140:143], v5 offset:3392
    ds_read_b64_tr_b16 a[124:125], v227 offset:6224
    v_mfma_f32_16x16x32_bf16 v[32:35], v[56:59], v[112:115], v[32:35]
    ds_read_b64 v[76:77], v4 offset:832
    ds_read_b64_tr_b16 a[126:127], v227 offset:7760
    v_mfma_f32_16x16x32_bf16 v[36:39], v[52:55], v[120:123], v[36:39]
    ds_read_b64 v[78:79], v4 offset:840
    ds_read_b64_tr_b16 a[128:129], v228 offset:0
    v_mfma_f32_16x16x32_bf16 v[36:39], v[56:59], v[116:119], v[36:39]
    s_add_u32 m0, s61, 49664
    ds_read_b128 v[152:155], v5 offset:1856
    ds_read_b64_tr_b16 a[130:131], v228 offset:1536
    v_mfma_f32_16x16x32_bf16 v[28:31], v[44:47], v[120:123], v[28:31]
    ds_read_b64 v[88:89], v4 offset:2368
    buffer_load_dwordx4 v225, s[40:43], s64 offen offset:1024 lds
    v_mfma_f32_16x16x32_bf16 v[28:31], v[56:59], v[108:111], v[28:31]
    ds_read_b64 v[90:91], v4 offset:2376
    v_fma_f32 v190, v190, v250, v251
    v_mfma_f32_16x16x32_bf16 v[24:27], v[40:43], v[120:123], v[24:27]
    ds_read_b128 v[136:139], v5 offset:3904
    v_and_b32 v233, 0xffff0000, v179
    v_mfma_f32_16x16x32_bf16 v[24:27], v[56:59], v[104:107], v[24:27]
    ds_read_b64 v[72:73], v4 offset:320
    v_fma_f32 v191, v233, v191, v207
    v_mfma_f32_16x16x32_bf16 v[36:39], v[48:51], v[124:127], v[36:39]
    s_waitcnt lgkmcnt(13)
    ds_read_b64 v[74:75], v4 offset:328
    v_mul_f32 v207, v252, v233
    v_mfma_f32_16x16x32_bf16 v[36:39], v[60:63], v[112:115], v[36:39]
    s_add_u32 m0, s61, 49664
    ds_read_b128 v[156:159], v5 offset:1344
    v_fma_f32 v191, v191, v250, v251
    v_mfma_f32_16x16x32_bf16 v[32:35], v[44:47], v[124:127], v[32:35]
    ds_read_b64 v[92:93], v4 offset:2880
    buffer_load_dwordx4 v226, s[40:43], s64 offen offset:2048 lds
    v_mfma_f32_16x16x32_bf16 v[32:35], v[60:63], v[108:111], v[32:35]
    s_add_u32 s64, s64, 98304
    ds_read_b64 v[94:95], v4 offset:2888
    v_lshlrev_b32 v232, 16, v180
    v_mfma_f32_16x16x32_bf16 v[28:31], v[40:43], v[124:127], v[28:31]
    s_sub_u32 s35, s64, 1966080
    ds_read_b128 v[160:163], v5 offset:832
    v_fma_f32 v192, v232, v192, v208
    v_mfma_f32_16x16x32_bf16 v[28:31], v[60:63], v[104:107], v[28:31]
    s_min_u32 s64, s64, s35
    ds_read_b64 v[96:97], v4 offset:3392
    v_mul_f32 v208, v252, v232
    v_mfma_f32_16x16x32_bf16 v[36:39], v[44:47], v[128:131], v[36:39]
    ds_read_b64 v[98:99], v4 offset:3400
    v_fma_f32 v192, v192, v250, v251
    v_mfma_f32_16x16x32_bf16 v[36:39], v[64:67], v[108:111], v[36:39]
    ds_read_b128 v[164:167], v5 offset:320
    v_and_b32 v233, 0xffff0000, v180
    v_mfma_f32_16x16x32_bf16 v[32:35], v[40:43], v[128:131], v[32:35]
    s_waitcnt vmcnt(12)
    s_waitcnt lgkmcnt(12)
    s_barrier
    ds_read_b64 v[100:101], v4 offset:3904
    v_mfma_f32_16x16x32_bf16 v[32:35], v[64:67], v[104:107], v[32:35]
    ds_read_b64 v[102:103], v4 offset:3912
    ds_read_b64_tr_b16 a[132:133], v227 offset:12416
    v_mfma_f32_16x16x32_bf16 v[36:39], v[40:43], v[132:135], v[36:39]
    ds_read_b64_tr_b16 a[134:135], v227 offset:13952
    buffer_load_dword v223, v219, s[36:39], s17 offen sc1
    v_mfma_f32_16x16x32_bf16 v[36:39], v[68:71], v[104:107], v[36:39]
    ds_read_b64_tr_b16 a[136:137], v227 offset:18640
    v_fma_f32 v193, v233, v193, v209
    v_mfma_f32_16x16x32_bf16 v[24:27], v[80:83], v[144:147], v[24:27]
    ds_read_b128 v[112:115], v5 offset:2944
    ds_read_b64_tr_b16 a[138:139], v227 offset:20176
    v_mfma_f32_16x16x32_bf16 v[28:31], v[80:83], v[148:151], v[28:31]
    ds_read_b64 v[48:49], v4 offset:1408
    ds_read_b64_tr_b16 a[140:141], v228 offset:12416
    v_mfma_f32_16x16x32_bf16 v[28:31], v[84:87], v[144:147], v[28:31]
    ds_read_b64 v[50:51], v4 offset:1416
    ds_read_b64_tr_b16 a[142:143], v228 offset:13952
    v_mfma_f32_16x16x32_bf16 v[32:35], v[84:87], v[148:151], v[32:35]
    ds_read_b128 v[116:119], v5 offset:2432
    v_mul_f32 v209, v252, v233
    v_mfma_f32_16x16x32_bf16 v[24:27], v[76:79], v[148:151], v[24:27]
    ds_read_b64 v[52:53], v4 offset:1920
    v_fma_f32 v193, v193, v250, v251
    v_mfma_f32_16x16x32_bf16 v[24:27], v[84:87], v[140:143], v[24:27]
    ds_read_b64 v[54:55], v4 offset:1928
    v_lshlrev_b32 v232, 16, v181
    v_mfma_f32_16x16x32_bf16 v[32:35], v[80:83], v[152:155], v[32:35]
    s_waitcnt lgkmcnt(13)
    ds_read_b128 v[108:111], v5 offset:3456
    v_fma_f32 v194, v232, v194, v210
    v_mfma_f32_16x16x32_bf16 v[32:35], v[88:91], v[144:147], v[32:35]
    ds_read_b64 v[44:45], v4 offset:896
    v_mul_f32 v210, v252, v232
    v_mfma_f32_16x16x32_bf16 v[36:39], v[84:87], v[152:155], v[36:39]
    ds_read_b64 v[46:47], v4 offset:904
    v_fma_f32 v194, v194, v250, v251
    v_mfma_f32_16x16x32_bf16 v[36:39], v[88:91], v[148:151], v[36:39]
    ds_read_b128 v[120:123], v5 offset:1920
    v_and_b32 v233, 0xffff0000, v181
    v_mfma_f32_16x16x32_bf16 v[28:31], v[76:79], v[152:155], v[28:31]
    ds_read_b64 v[56:57], v4 offset:2432
    v_fma_f32 v195, v233, v195, v211
    v_mfma_f32_16x16x32_bf16 v[28:31], v[88:91], v[140:143], v[28:31]
    ds_read_b64 v[58:59], v4 offset:2440
    v_mul_f32 v211, v252, v233
    v_mfma_f32_16x16x32_bf16 v[24:27], v[72:75], v[152:155], v[24:27]
    ds_read_b128 v[104:107], v5 offset:3968
    v_fma_f32 v195, v195, v250, v251
    v_mfma_f32_16x16x32_bf16 v[24:27], v[88:91], v[136:139], v[24:27]
    ds_read_b64 v[40:41], v4 offset:384
    v_lshlrev_b32 v232, 16, v182
    v_mfma_f32_16x16x32_bf16 v[36:39], v[80:83], v[156:159], v[36:39]
    s_waitcnt vmcnt(7)
    s_waitcnt lgkmcnt(11)
    s_barrier
    ds_read_b64 v[42:43], v4 offset:392
    v_mfma_f32_16x16x32_bf16 v[36:39], v[92:95], v[144:147], v[36:39]
    ds_read_b128 v[124:127], v5 offset:1408
    ds_read_b64_tr_b16 a[144:145], v227 offset:24832
    v_mfma_f32_16x16x32_bf16 v[32:35], v[76:79], v[156:159], v[32:35]
    ds_read_b64 v[60:61], v4 offset:2944
    ds_read_b64_tr_b16 a[146:147], v227 offset:26368
    v_mfma_f32_16x16x32_bf16 v[32:35], v[92:95], v[140:143], v[32:35]
    ds_read_b64 v[62:63], v4 offset:2952
    ds_read_b64_tr_b16 a[148:149], v227 offset:31056
    v_mfma_f32_16x16x32_bf16 v[28:31], v[72:75], v[156:159], v[28:31]
    ds_read_b128 v[128:131], v5 offset:896
    ds_read_b64_tr_b16 a[150:151], v227 offset:32592
    v_mfma_f32_16x16x32_bf16 v[28:31], v[92:95], v[136:139], v[28:31]
    ds_read_b64 v[64:65], v4 offset:3456
    ds_read_b64_tr_b16 a[152:153], v228 offset:24832
    v_mfma_f32_16x16x32_bf16 v[36:39], v[76:79], v[160:163], v[36:39]
    ds_read_b64 v[66:67], v4 offset:3464
    ds_read_b64_tr_b16 a[154:155], v228 offset:26368
    v_mfma_f32_16x16x32_bf16 v[36:39], v[96:99], v[140:143], v[36:39]
    ds_read_b128 v[132:135], v5 offset:384
    v_fma_f32 v196, v232, v196, v212
    v_mfma_f32_16x16x32_bf16 v[32:35], v[72:75], v[160:163], v[32:35]
    s_add_u32 m0, s63, 0
    ds_read_b64 v[68:69], v4 offset:3968
    s_waitcnt vmcnt(0)
    v_cmp_ne_u32 vcc, s48, v223
    s_cbranch_vccnz L_chk7_slow
L_chk7_back:
    v_mfma_f32_16x16x32_bf16 v[32:35], v[96:99], v[136:139], v[32:35]
    ds_read_b64 v[70:71], v4 offset:3976
    buffer_load_dwordx4 v172, s[36:39], s10 offen sc1 lds
    v_mfma_f32_16x16x32_bf16 v[36:39], v[72:75], v[164:167], v[36:39]
    v_mul_f32 v212, v252, v232
    v_fma_f32 v196, v196, v250, v251
    v_mfma_f32_16x16x32_bf16 v[36:39], v[100:103], v[136:139], v[36:39]
    v_and_b32 v233, 0xffff0000, v182
    v_fma_f32 v197, v233, v197, v213
    v_mfma_f32_16x16x32_bf16 v[24:27], v[48:51], v[112:115], v[24:27]
    s_waitcnt lgkmcnt(13)
    ds_read_b128 v[144:147], v5 offset:3008
    v_mul_f32 v213, v252, v233
    v_mfma_f32_16x16x32_bf16 v[28:31], v[48:51], v[116:119], v[28:31]
    s_add_u32 m0, s63, 4096
    ds_read_b64 v[80:81], v4 offset:1472
    v_fma_f32 v197, v197, v250, v251
    v_mfma_f32_16x16x32_bf16 v[28:31], v[52:55], v[112:115], v[28:31]
    ds_read_b64 v[82:83], v4 offset:1480
    buffer_load_dwordx4 v172, s[36:39], s11 offen sc1 lds
    v_mfma_f32_16x16x32_bf16 v[32:35], v[52:55], v[116:119], v[32:35]
    ds_read_b128 v[148:151], v5 offset:2496
    v_lshlrev_b32 v232, 16, v183
    v_mfma_f32_16x16x32_bf16 v[24:27], v[44:47], v[116:119], v[24:27]
    ds_read_b64 v[84:85], v4 offset:1984
    v_fma_f32 v198, v232, v198, v214
    v_mfma_f32_16x16x32_bf16 v[24:27], v[52:55], v[108:111], v[24:27]
    s_add_u32 m0, s63, 8192
    ds_read_b64 v[86:87], v4 offset:1992
    v_mul_f32 v214, v252, v232
    v_mfma_f32_16x16x32_bf16 v[32:35], v[48:51], v[120:123], v[32:35]
    ds_read_b128 v[140:143], v5 offset:3520
    buffer_load_dwordx4 v172, s[36:39], s12 offen sc1 lds
    v_mfma_f32_16x16x32_bf16 v[32:35], v[56:59], v[112:115], v[32:35]
    s_waitcnt lgkmcnt(10)
    s_barrier
    ds_read_b64 v[76:77], v4 offset:960
    v_mfma_f32_16x16x32_bf16 v[36:39], v[52:55], v[120:123], v[36:39]
    ds_read_b64 v[78:79], v4 offset:968
    ds_read_b64_tr_b16 a[156:157], v227 offset:37248
    v_mfma_f32_16x16x32_bf16 v[36:39], v[56:59], v[116:119], v[36:39]
    ds_read_b128 v[152:155], v5 offset:1984
    ds_read_b64_tr_b16 a[158:159], v227 offset:38784
    v_mfma_f32_16x16x32_bf16 v[28:31], v[44:47], v[120:123], v[28:31]
    s_add_u32 m0, s63, 12288
    ds_read_b64 v[88:89], v4 offset:2496
    ds_read_b64_tr_b16 a[160:161], v227 offset:43472
    v_mfma_f32_16x16x32_bf16 v[28:31], v[56:59], v[108:111], v[28:31]
    ds_read_b64 v[90:91], v4 offset:2504
    ds_read_b64_tr_b16 a[162:163], v227 offset:45008
    buffer_load_dwordx4 v172, s[36:39], s13 offen sc1 lds
    v_mfma_f32_16x16x32_bf16 v[24:27], v[40:43], v[120:123], v[24:27]
    ds_read_b128 v[136:139], v5 offset:4032
    ds_read_b64_tr_b16 a[164:165], v228 offset:37248
    v_mfma_f32_16x16x32_bf16 v[24:27], v[56:59], v[104:107], v[24:27]
    ds_read_b64 v[72:73], v4 offset:448
    ds_read_b64_tr_b16 a[166:167], v228 offset:38784
    v_mfma_f32_16x16x32_bf16 v[36:39], v[48:51], v[124:127], v[36:39]
    s_add_u32 m0, s63, 16384
    ds_read_b64 v[74:75], v4 offset:456
    v_fma_f32 v198, v198, v250, v251
    v_mfma_f32_16x16x32_bf16 v[36:39], v[60:63], v[112:115], v[36:39]
    ds_read_b128 v[156:159], v5 offset:1472
    buffer_load_dwordx4 v172, s[36:39], s14 offen sc1 lds
    v_mfma_f32_16x16x32_bf16 v[32:35], v[44:47], v[124:127], v[32:35]
    ds_read_b64 v[92:93], v4 offset:3008
    v_and_b32 v233, 0xffff0000, v183
    v_mfma_f32_16x16x32_bf16 v[32:35], v[60:63], v[108:111], v[32:35]
    ds_read_b64 v[94:95], v4 offset:3016
    v_fma_f32 v199, v233, v199, v215
    v_mfma_f32_16x16x32_bf16 v[28:31], v[40:43], v[124:127], v[28:31]
    ds_read_b128 v[160:163], v5 offset:960
    v_mul_f32 v215, v252, v233
    v_mfma_f32_16x16x32_bf16 v[28:31], v[60:63], v[104:107], v[28:31]
    s_add_u32 m0, s63, 20480
    ds_read_b64 v[96:97], v4 offset:3520
    v_fma_f32 v199, v199, v250, v251
    v_mfma_f32_16x16x32_bf16 v[36:39], v[44:47], v[128:131], v[36:39]
    ds_read_b64 v[98:99], v4 offset:3528
    buffer_load_dwordx4 v172, s[36:39], s15 offen sc1 lds
    v_mfma_f32_16x16x32_bf16 v[36:39], v[64:67], v[108:111], v[36:39]
    ds_read_b128 v[164:167], v5 offset:448
    v_mfma_f32_16x16x32_bf16 v[32:35], v[40:43], v[128:131], v[32:35]
    ds_read_b64 v[100:101], v4 offset:4032
    v_mfma_f32_16x16x32_bf16 v[32:35], v[64:67], v[104:107], v[32:35]
    s_waitcnt lgkmcnt(13)
    s_add_u32 m0, s63, 24576
    ds_read_b64 v[102:103], v4 offset:4040
    v_mfma_f32_16x16x32_bf16 v[36:39], v[40:43], v[132:135], v[36:39]
    buffer_load_dwordx4 v172, s[36:39], s18 offen sc1 lds
    v_mfma_f32_16x16x32_bf16 v[36:39], v[68:71], v[104:107], v[36:39]
    v_mfma_f32_16x16x32_bf16 v[24:27], v[80:83], v[144:147], v[24:27]
    s_waitcnt lgkmcnt(10)
    s_barrier
    ds_read_b64_tr_b16 a[168:169], v227 offset:49664
    v_mfma_f32_16x16x32_bf16 v[28:31], v[80:83], v[148:151], v[28:31]
    ds_read_b64_tr_b16 a[170:171], v227 offset:51200
    v_mfma_f32_16x16x32_bf16 v[28:31], v[84:87], v[144:147], v[28:31]
    s_add_u32 m0, s63, 28672
    ds_read_b64_tr_b16 a[172:173], v227 offset:55888
    v_mfma_f32_16x16x32_bf16 v[32:35], v[84:87], v[148:151], v[32:35]
    ds_read_b64_tr_b16 a[174:175], v227 offset:57424
    buffer_load_dwordx4 v172, s[36:39], s19 offen sc1 lds
    v_mfma_f32_16x16x32_bf16 v[24:27], v[76:79], v[148:151], v[24:27]
    ds_read_b64_tr_b16 a[176:177], v228 offset:49664
    v_mfma_f32_16x16x32_bf16 v[24:27], v[84:87], v[140:143], v[24:27]
    ds_read_b64_tr_b16 a[178:179], v228 offset:51200
    v_mfma_f32_16x16x32_bf16 v[32:35], v[80:83], v[152:155], v[32:35]
    s_add_u32 m0, s63, 32768
    v_mfma_f32_16x16x32_bf16 v[32:35], v[88:91], v[144:147], v[32:35]
    buffer_load_dwordx4 v172, s[36:39], s20 offen sc1 lds
    v_mfma_f32_16x16x32_bf16 v[36:39], v[84:87], v[152:155], v[36:39]
    v_mfma_f32_16x16x32_bf16 v[36:39], v[88:91], v[148:151], v[36:39]
    s_waitcnt lgkmcnt(0)
    s_barrier
    v_mfma_f32_16x16x32_bf16 v[28:31], v[76:79], v[152:155], v[28:31]
    v_mfma_f32_16x16x32_bf16 v[28:31], v[88:91], v[140:143], v[28:31]
    s_add_u32 m0, s63, 36864
    v_mfma_f32_16x16x32_bf16 v[24:27], v[72:75], v[152:155], v[24:27]
    buffer_load_dwordx4 v172, s[36:39], s21 offen sc1 lds
    v_mfma_f32_16x16x32_bf16 v[24:27], v[88:91], v[136:139], v[24:27]
    v_mfma_f32_16x16x32_bf16 v[36:39], v[80:83], v[156:159], v[36:39]
    v_mfma_f32_16x16x32_bf16 v[36:39], v[92:95], v[144:147], v[36:39]
    s_add_u32 m0, s63, 40960
    v_mfma_f32_16x16x32_bf16 v[32:35], v[76:79], v[156:159], v[32:35]
    buffer_load_dwordx4 v172, s[36:39], s22 offen sc1 lds
    v_mfma_f32_16x16x32_bf16 v[32:35], v[92:95], v[140:143], v[32:35]
    v_mfma_f32_16x16x32_bf16 v[28:31], v[72:75], v[156:159], v[28:31]
    v_mfma_f32_16x16x32_bf16 v[28:31], v[92:95], v[136:139], v[28:31]
    v_mfma_f32_16x16x32_bf16 v[36:39], v[76:79], v[160:163], v[36:39]
    s_add_u32 m0, s63, 45056
    v_mfma_f32_16x16x32_bf16 v[36:39], v[96:99], v[140:143], v[36:39]
    buffer_load_dwordx4 v172, s[36:39], s23 offen sc1 lds
    v_mfma_f32_16x16x32_bf16 v[32:35], v[72:75], v[160:163], v[32:35]
    v_mfma_f32_16x16x32_bf16 v[32:35], v[96:99], v[136:139], v[32:35]
    v_mfma_f32_16x16x32_bf16 v[36:39], v[72:75], v[164:167], v[36:39]
    v_mfma_f32_16x16x32_bf16 v[36:39], v[100:103], v[136:139], v[36:39]
    s_waitcnt vmcnt(9)
    s_waitcnt lgkmcnt(0)
    s_barrier
    ds_read_b64_tr_b16 v[104:105], v168 offset:0
    ds_read_b64_tr_b16 v[106:107], v168 offset:2048
    ds_read_b64_tr_b16 v[108:109], v169 offset:0
    ds_read_b64_tr_b16 v[110:111], v169 offset:2048
    ds_read_b64_tr_b16 v[112:113], v170 offset:0
    ds_read_b64_tr_b16 v[114:115], v170 offset:2048
    ds_read_b64_tr_b16 v[116:117], v171 offset:0
    ds_read_b64_tr_b16 v[118:119], v171 offset:2048
    v_pk_fma_f32 v[184:185], v[184:185], v[24:25], v[200:201]
    v_pk_fma_f32 v[186:187], v[186:187], v[26:27], v[202:203]
    v_cvt_pk_bf16_f32 v232, v184, v185
    v_cvt_pk_bf16_f32 v233, v186, v187
    v_pk_fma_f32 v[188:189], v[188:189], v[28:29], v[204:205]
    v_pk_fma_f32 v[190:191], v[190:191], v[30:31], v[206:207]
    v_cvt_pk_bf16_f32 v234, v188, v189
    v_cvt_pk_bf16_f32 v235, v190, v191
    s_nop 0
    v_permlane16_swap_b32 v232, v234
    v_permlane16_swap_b32 v233, v235
    buffer_store_dwordx4 v[232:235], v231, s[36:39], s68 offen offset:2048 sc1
    v_pk_fma_f32 v[192:193], v[192:193], v[32:33], v[208:209]
    v_pk_fma_f32 v[194:195], v[194:195], v[34:35], v[210:211]
    v_cvt_pk_bf16_f32 v236, v192, v193
    v_cvt_pk_bf16_f32 v237, v194, v195
    v_pk_fma_f32 v[196:197], v[196:197], v[36:37], v[212:213]
    v_pk_fma_f32 v[198:199], v[198:199], v[38:39], v[214:215]
    v_cvt_pk_bf16_f32 v238, v196, v197
    v_cvt_pk_bf16_f32 v239, v198, v199
    s_nop 0
    v_permlane16_swap_b32 v236, v238
    v_permlane16_swap_b32 v237, v239
    buffer_store_dwordx4 v[236:239], v231, s[36:39], s68 offen offset:3072 sc1
    v_mov_b32 v200, v224
    v_mov_b32 v201, v225
    v_mov_b32 v202, v226
    v_add_u32 v203, 101760, v227
    v_add_u32 v204, 101760, v228
    s_waitcnt lgkmcnt(6)
    v_mfma_f32_16x16x32_bf16 v[56:59], a[0:3], v[104:107], 0
    ds_read_b64_tr_b16 v[120:121], v168 offset:4096
    v_mfma_f32_16x16x32_bf16 v[60:63], a[4:7], v[104:107], 0
    ds_read_b64_tr_b16 v[122:123], v168 offset:6144
    v_mfma_f32_16x16x32_bf16 v[64:67], a[8:11], v[104:107], 0
    s_waitcnt lgkmcnt(6)
    s_add_u32 m0, s61, 101760
    ds_read_b64_tr_b16 v[124:125], v169 offset:4096
    v_mfma_f32_16x16x32_bf16 v[68:71], a[0:3], v[108:111], 0
    buffer_load_dwordx4 v200, s[40:43], s64 offen offset:0 lds
    v_mfma_f32_16x16x32_bf16 v[72:75], a[4:7], v[108:111], 0
    ds_read_b64_tr_b16 v[126:127], v169 offset:6144
    v_mfma_f32_16x16x32_bf16 v[76:79], a[8:11], v[108:111], 0
    s_waitcnt lgkmcnt(6)
    ds_read_b64_tr_b16 v[128:129], v170 offset:4096
    v_mfma_f32_16x16x32_bf16 v[80:83], a[0:3], v[112:115], 0
    s_add_u32 m0, s61, 101760
    ds_read_b64_tr_b16 v[130:131], v170 offset:6144
    v_mfma_f32_16x16x32_bf16 v[84:87], a[4:7], v[112:115], 0
    buffer_load_dwordx4 v201, s[40:43], s64 offen offset:1024 lds
    v_mfma_f32_16x16x32_bf16 v[88:91], a[8:11], v[112:115], 0
    s_waitcnt lgkmcnt(6)
    ds_read_b64_tr_b16 v[132:133], v171 offset:4096
    v_mfma_f32_16x16x32_bf16 v[92:95], a[0:3], v[116:119], 0
    s_waitcnt lgkmcnt(3)
    ds_read_b64_tr_b16 v[134:135], v171 offset:6144
    v_mfma_f32_16x16x32_bf16 v[96:99], a[4:7], v[116:119], 0
    s_add_u32 m0, s61, 101760
    v_mfma_f32_16x16x32_bf16 v[100:103], a[8:11], v[116:119], 0
    buffer_load_dwordx4 v202, s[40:43], s64 offen offset:2048 lds
    v_mfma_f32_16x16x32_bf16 v[56:59], a[12:15], v[120:123], v[56:59]
    s_add_u32 s64, s64, 98304
    ds_read_b64_tr_b16 v[104:105], v168 offset:8192
    v_mfma_f32_16x16x32_bf16 v[60:63], a[16:19], v[120:123], v[60:63]
    s_sub_u32 s35, s64, 1966080
    ds_read_b64_tr_b16 v[106:107], v168 offset:10240
    v_mfma_f32_16x16x32_bf16 v[64:67], a[20:23], v[120:123], v[64:67]
    s_min_u32 s64, s64, s35
    ds_read_b64_tr_b16 v[108:109], v169 offset:8192
    v_mfma_f32_16x16x32_bf16 v[68:71], a[12:15], v[124:127], v[68:71]
    v_mfma_f32_16x16x32_bf16 v[72:75], a[16:19], v[124:127], v[72:75]
    ds_read_b64_tr_b16 v[110:111], v169 offset:10240
    v_mfma_f32_16x16x32_bf16 v[76:79], a[20:23], v[124:127], v[76:79]
    s_waitcnt lgkmcnt(6)
    ds_read_b64_tr_b16 v[112:113], v170 offset:8192
    v_mfma_f32_16x16x32_bf16 v[80:83], a[12:15], v[128:131], v[80:83]
    s_add_u32 m0, s63, 49152
    ds_read_b64_tr_b16 v[114:115], v170 offset:10240
    v_mfma_f32_16x16x32_bf16 v[84:87], a[16:19], v[128:131], v[84:87]
    buffer_load_dwordx4 v172, s[36:39], s24 offen sc1 lds
    v_mfma_f32_16x16x32_bf16 v[88:91], a[20:23], v[128:131], v[88:91]
    s_waitcnt lgkmcnt(6)
    ds_read_b64_tr_b16 v[116:117], v171 offset:8192
    v_mfma_f32_16x16x32_bf16 v[92:95], a[12:15], v[132:135], v[92:95]
    s_waitcnt lgkmcnt(3)
    ds_read_b64_tr_b16 v[118:119], v171 offset:10240
    v_mfma_f32_16x16x32_bf16 v[96:99], a[16:19], v[132:135], v[96:99]
    s_add_u32 m0, s63, 53248
    v_mfma_f32_16x16x32_bf16 v[100:103], a[20:23], v[132:135], v[100:103]
    buffer_load_dwordx4 v172, s[36:39], s25 offen sc1 lds
    v_mfma_f32_16x16x32_bf16 v[56:59], a[24:27], v[104:107], v[56:59]
    s_waitcnt vmcnt(11)
    s_barrier
    ds_read_b64_tr_b16 v[120:121], v168 offset:12288
    v_mfma_f32_16x16x32_bf16 v[60:63], a[28:31], v[104:107], v[60:63]
    ds_read_b64_tr_b16 v[122:123], v168 offset:14336
    v_mfma_f32_16x16x32_bf16 v[64:67], a[32:35], v[104:107], v[64:67]
    s_add_u32 m0, s63, 57344
    ds_read_b64_tr_b16 v[124:125], v169 offset:12288
    v_mfma_f32_16x16x32_bf16 v[68:71], a[24:27], v[108:111], v[68:71]
    buffer_load_dwordx4 v172, s[36:39], s26 offen sc1 lds
    v_mfma_f32_16x16x32_bf16 v[72:75], a[28:31], v[108:111], v[72:75]
    ds_read_b64_tr_b16 v[126:127], v169 offset:14336
    v_mfma_f32_16x16x32_bf16 v[76:79], a[32:35], v[108:111], v[76:79]
    s_waitcnt lgkmcnt(6)
    ds_read_b64_tr_b16 v[128:129], v170 offset:12288
    v_mfma_f32_16x16x32_bf16 v[80:83], a[24:27], v[112:115], v[80:83]
    s_add_u32 m0, s63, 61440
    ds_read_b64_tr_b16 v[130:131], v170 offset:14336
    v_mfma_f32_16x16x32_bf16 v[84:87], a[28:31], v[112:115], v[84:87]
    buffer_load_dwordx4 v172, s[36:39], s27 offen sc1 lds
    v_mfma_f32_16x16x32_bf16 v[88:91], a[32:35], v[112:115], v[88:91]
    s_waitcnt lgkmcnt(6)
    ds_read_b64_tr_b16 v[132:133], v171 offset:12288
    v_mfma_f32_16x16x32_bf16 v[92:95], a[24:27], v[116:119], v[92:95]
    s_waitcnt lgkmcnt(3)
    ds_read_b64_tr_b16 v[134:135], v171 offset:14336
    v_mfma_f32_16x16x32_bf16 v[96:99], a[28:31], v[116:119], v[96:99]
    s_add_u32 m0, s63, 65536
    v_mfma_f32_16x16x32_bf16 v[100:103], a[32:35], v[116:119], v[100:103]
    s_waitcnt vmcnt(7)
    s_barrier
    s_cmp_eq_u32 s3, 0
    s_cbranch_scc0 L_wf8
    s_lshl_b32 s54, s70, 7
    s_add_u32 s54, s54, 23266304
    v_mov_b32 v254, 0
    v_mov_b32 v255, s48
    s_mov_b64 exec, 1
    buffer_store_dword v255, v254, s[36:39], s54 offen sc1
    s_mov_b64 exec, -1
L_wf8:
    buffer_load_dwordx4 v172, s[36:39], s44 offen sc1 lds
    v_mfma_f32_16x16x32_bf16 v[56:59], a[36:39], v[120:123], v[56:59]
    ds_read_b64_tr_b16 v[104:105], v168 offset:16384
    v_mfma_f32_16x16x32_bf16 v[60:63], a[40:43], v[120:123], v[60:63]
    ds_read_b64_tr_b16 v[106:107], v168 offset:18432
    v_mfma_f32_16x16x32_bf16 v[64:67], a[44:47], v[120:123], v[64:67]
    s_add_u32 m0, s63, 69632
    ds_read_b64_tr_b16 v[108:109], v169 offset:16384
    v_mfma_f32_16x16x32_bf16 v[68:71], a[36:39], v[124:127], v[68:71]
    buffer_load_dwordx4 v172, s[36:39], s45 offen sc1 lds
    v_mfma_f32_16x16x32_bf16 v[72:75], a[40:43], v[124:127], v[72:75]
    ds_read_b64_tr_b16 v[110:111], v169 offset:18432
    v_mfma_f32_16x16x32_bf16 v[76:79], a[44:47], v[124:127], v[76:79]
    s_waitcnt lgkmcnt(6)
    ds_read_b64_tr_b16 v[112:113], v170 offset:16384
    v_mfma_f32_16x16x32_bf16 v[80:83], a[36:39], v[128:131], v[80:83]
    s_add_u32 m0, s63, 73728
    ds_read_b64_tr_b16 v[114:115], v170 offset:18432
    v_mfma_f32_16x16x32_bf16 v[84:87], a[40:43], v[128:131], v[84:87]
    buffer_load_dwordx4 v172, s[36:39], s46 offen sc1 lds
    v_mfma_f32_16x16x32_bf16 v[88:91], a[44:47], v[128:131], v[88:91]
    s_waitcnt lgkmcnt(6)
    ds_read_b64_tr_b16 v[116:117], v171 offset:16384
    v_mfma_f32_16x16x32_bf16 v[92:95], a[36:39], v[132:135], v[92:95]
    s_waitcnt lgkmcnt(3)
    ds_read_b64_tr_b16 v[118:119], v171 offset:18432
    v_mfma_f32_16x16x32_bf16 v[96:99], a[40:43], v[132:135], v[96:99]
    s_add_u32 m0, s63, 77824
    v_mfma_f32_16x16x32_bf16 v[100:103], a[44:47], v[132:135], v[100:103]
    buffer_load_dwordx4 v172, s[36:39], s47 offen sc1 lds
    v_mfma_f32_16x16x32_bf16 v[56:59], a[48:51], v[104:107], v[56:59]
    ds_read_b64_tr_b16 v[120:121], v168 offset:20480
    v_add_u32 v172, 2048, v172
    v_mfma_f32_16x16x32_bf16 v[60:63], a[52:55], v[104:107], v[60:63]
    ds_read_b64_tr_b16 v[122:123], v168 offset:22528
    v_mfma_f32_16x16x32_bf16 v[64:67], a[56:59], v[104:107], v[64:67]
    s_add_u32 m0, s61, 114176
    ds_read_b64_tr_b16 v[124:125], v169 offset:20480
    v_mfma_f32_16x16x32_bf16 v[68:71], a[48:51], v[108:111], v[68:71]
    buffer_load_dwordx4 v200, s[40:43], s64 offen offset:0 lds
    v_mfma_f32_16x16x32_bf16 v[72:75], a[52:55], v[108:111], v[72:75]
    ds_read_b64_tr_b16 v[126:127], v169 offset:22528
    v_mfma_f32_16x16x32_bf16 v[76:79], a[56:59], v[108:111], v[76:79]
    s_waitcnt lgkmcnt(6)
    ds_read_b64_tr_b16 v[128:129], v170 offset:20480
    v_mfma_f32_16x16x32_bf16 v[80:83], a[48:51], v[112:115], v[80:83]
    s_add_u32 m0, s61, 114176
    ds_read_b64_tr_b16 v[130:131], v170 offset:22528
    v_min_u32 v243, 11, v1
    v_mfma_f32_16x16x32_bf16 v[84:87], a[52:55], v[112:115], v[84:87]
    buffer_load_dwordx4 v201, s[40:43], s64 offen offset:1024 lds
    v_mfma_f32_16x16x32_bf16 v[88:91], a[56:59], v[112:115], v[88:91]
    s_waitcnt lgkmcnt(6)
    ds_read_b64_tr_b16 v[132:133], v171 offset:20480
    v_lshlrev_b32 v243, 8, v243
    v_mfma_f32_16x16x32_bf16 v[92:95], a[48:51], v[116:119], v[92:95]
    s_waitcnt lgkmcnt(3)
    ds_read_b64_tr_b16 v[134:135], v171 offset:22528
    v_mfma_f32_16x16x32_bf16 v[96:99], a[52:55], v[116:119], v[96:99]
    s_add_u32 m0, s61, 114176
    v_mfma_f32_16x16x32_bf16 v[100:103], a[56:59], v[116:119], v[100:103]
    buffer_load_dwordx4 v202, s[40:43], s64 offen offset:2048 lds
    v_mfma_f32_16x16x32_bf16 v[56:59], a[60:63], v[120:123], v[56:59]
    s_mul_i32 s58, s3, 24
    s_lshr_b32 s57, s75, 2
    s_add_u32 s64, s64, 98304
    ds_read_b64_tr_b16 v[104:105], v168 offset:24576
    v_mfma_f32_16x16x32_bf16 v[60:63], a[64:67], v[120:123], v[60:63]
    s_add_u32 s58, s58, s57
    s_lshl_b32 s58, s58, 7
    ds_read_b64_tr_b16 v[106:107], v168 offset:26624
    v_mfma_f32_16x16x32_bf16 v[64:67], a[68:71], v[120:123], v[64:67]
    s_add_u32 s58, s58, 23233536
    s_sub_u32 s35, s64, 1966080
    ds_read_b64_tr_b16 v[108:109], v169 offset:24576
    v_mfma_f32_16x16x32_bf16 v[68:71], a[60:63], v[124:127], v[68:71]
    s_min_u32 s64, s64, s35
    buffer_load_dword v244, v243, s[36:39], s58 offen sc1
    v_mfma_f32_16x16x32_bf16 v[72:75], a[64:67], v[124:127], v[72:75]
    ds_read_b64_tr_b16 v[110:111], v169 offset:26624
    v_mfma_f32_16x16x32_bf16 v[76:79], a[68:71], v[124:127], v[76:79]
    s_waitcnt lgkmcnt(6)
    ds_read_b64_tr_b16 v[112:113], v170 offset:24576
    v_mfma_f32_16x16x32_bf16 v[80:83], a[60:63], v[128:131], v[80:83]
    s_add_u32 m0, s61, 126592
    ds_read_b64_tr_b16 v[114:115], v170 offset:26624
    v_mfma_f32_16x16x32_bf16 v[84:87], a[64:67], v[128:131], v[84:87]
    buffer_load_dwordx4 v200, s[40:43], s64 offen offset:0 lds
    v_mfma_f32_16x16x32_bf16 v[88:91], a[68:71], v[128:131], v[88:91]
    s_waitcnt lgkmcnt(6)
    ds_read_b64_tr_b16 v[116:117], v171 offset:24576
    v_mfma_f32_16x16x32_bf16 v[92:95], a[60:63], v[132:135], v[92:95]
    s_waitcnt lgkmcnt(3)
    ds_read_b64_tr_b16 v[118:119], v171 offset:26624
    v_mfma_f32_16x16x32_bf16 v[96:99], a[64:67], v[132:135], v[96:99]
    s_add_u32 m0, s61, 126592
    v_mfma_f32_16x16x32_bf16 v[100:103], a[68:71], v[132:135], v[100:103]
    buffer_load_dwordx4 v201, s[40:43], s64 offen offset:1024 lds
    v_mfma_f32_16x16x32_bf16 v[56:59], a[72:75], v[104:107], v[56:59]
    ds_read_b64_tr_b16 v[120:121], v168 offset:28672
    v_mfma_f32_16x16x32_bf16 v[60:63], a[76:79], v[104:107], v[60:63]
    ds_read_b64_tr_b16 v[122:123], v168 offset:30720
    v_mfma_f32_16x16x32_bf16 v[64:67], a[80:83], v[104:107], v[64:67]
    s_add_u32 m0, s61, 126592
    ds_read_b64_tr_b16 v[124:125], v169 offset:28672
    v_mfma_f32_16x16x32_bf16 v[68:71], a[72:75], v[108:111], v[68:71]
    buffer_load_dwordx4 v202, s[40:43], s64 offen offset:2048 lds
    v_mfma_f32_16x16x32_bf16 v[72:75], a[76:79], v[108:111], v[72:75]
    s_add_u32 s64, s64, 98304
    ds_read_b64_tr_b16 v[126:127], v169 offset:30720
    v_mfma_f32_16x16x32_bf16 v[76:79], a[80:83], v[108:111], v[76:79]
    s_waitcnt lgkmcnt(6)
    s_sub_u32 s35, s64, 1966080
    ds_read_b64_tr_b16 v[128:129], v170 offset:28672
    v_mfma_f32_16x16x32_bf16 v[80:83], a[72:75], v[112:115], v[80:83]
    s_min_u32 s64, s64, s35
    ds_read_b64_tr_b16 v[130:131], v170 offset:30720
    v_mfma_f32_16x16x32_bf16 v[84:87], a[76:79], v[112:115], v[84:87]
    v_mfma_f32_16x16x32_bf16 v[88:91], a[80:83], v[112:115], v[88:91]
    s_waitcnt lgkmcnt(6)
    ds_read_b64_tr_b16 v[132:133], v171 offset:28672
    v_mfma_f32_16x16x32_bf16 v[92:95], a[72:75], v[116:119], v[92:95]
    s_waitcnt lgkmcnt(3)
    ds_read_b64_tr_b16 v[134:135], v171 offset:30720
    v_mfma_f32_16x16x32_bf16 v[96:99], a[76:79], v[116:119], v[96:99]
    s_add_u32 m0, s61, 139008
    v_mfma_f32_16x16x32_bf16 v[100:103], a[80:83], v[116:119], v[100:103]
    buffer_load_dwordx4 v200, s[40:43], s64 offen offset:0 lds
    v_mfma_f32_16x16x32_bf16 v[56:59], a[84:87], v[120:123], v[56:59]
    s_waitcnt vmcnt(8)
    s_barrier
    ds_read_b64_tr_b16 v[104:105], v168 offset:32768
    v_mfma_f32_16x16x32_bf16 v[60:63], a[88:91], v[120:123], v[60:63]
    ds_read_b64_tr_b16 v[106:107], v168 offset:34816
    ds_read_b64 v[224:225], v216
    v_mfma_f32_16x16x32_bf16 v[64:67], a[92:95], v[120:123], v[64:67]
    s_add_u32 m0, s61, 139008
    ds_read_b64_tr_b16 v[108:109], v169 offset:32768
    ds_read_b64 v[226:227], v217
    v_mfma_f32_16x16x32_bf16 v[68:71], a[84:87], v[124:127], v[68:71]
    buffer_load_dwordx4 v201, s[40:43], s64 offen offset:1024 lds
    v_mfma_f32_16x16x32_bf16 v[72:75], a[88:91], v[124:127], v[72:75]
    ds_read_b64_tr_b16 v[110:111], v169 offset:34816
    ds_read_b64 v[228:229], v218
    v_mfma_f32_16x16x32_bf16 v[76:79], a[92:95], v[124:127], v[76:79]
    s_waitcnt lgkmcnt(9)
    ds_read_b64_tr_b16 v[112:113], v170 offset:32768
    v_mfma_f32_16x16x32_bf16 v[80:83], a[84:87], v[128:131], v[80:83]
    s_barrier
    s_add_u32 m0, s61, 139008
    ds_read_b64_tr_b16 v[114:115], v170 offset:34816
    v_mfma_f32_16x16x32_bf16 v[84:87], a[88:91], v[128:131], v[84:87]
    ds_read_b64_tr_b16 a[180:181], v203 offset:0
    buffer_load_dwordx4 v202, s[40:43], s64 offen offset:2048 lds
    v_mfma_f32_16x16x32_bf16 v[88:91], a[92:95], v[128:131], v[88:91]
    s_waitcnt lgkmcnt(10)
    s_add_u32 s64, s64, 98304
    ds_read_b64_tr_b16 v[116:117], v171 offset:32768
    ds_read_b64_tr_b16 a[182:183], v203 offset:1536
    v_mfma_f32_16x16x32_bf16 v[92:95], a[84:87], v[132:135], v[92:95]
    s_waitcnt lgkmcnt(3)
    s_sub_u32 s35, s64, 1966080
    ds_read_b64_tr_b16 v[118:119], v171 offset:34816
    v_mfma_f32_16x16x32_bf16 v[96:99], a[88:91], v[132:135], v[96:99]
    s_min_u32 s64, s64, s35
    ds_read_b64_tr_b16 a[184:185], v203 offset:6224
    v_lshlrev_b32 v230, 16, v224
    v_and_b32 v231, 0xffff0000, v224
    v_pk_mul_f32 v[230:231], v[230:231], v[220:221] op_sel_hi:[1,0]
    v_pk_mul_f32 v[234:235], v[230:231], v[230:231]
    v_lshlrev_b32 v232, 16, v225
    v_and_b32 v233, 0xffff0000, v225
    v_pk_mul_f32 v[232:233], v[232:233], v[220:221] op_sel_hi:[1,0]
    v_pk_mul_f32 v[236:237], v[232:233], v[232:233]
    v_lshlrev_b32 v2, 16, v226
    v_and_b32 v3, 0xffff0000, v226
    v_pk_mul_f32 v[2:3], v[2:3], v[220:221] op_sel:[0,1] op_sel_hi:[1,1]
    v_pk_add_f32 v[230:231], v[230:231], v[2:3]
    v_pk_fma_f32 v[234:235], v[2:3], v[2:3], v[234:235]
    v_lshlrev_b32 v2, 16, v227
    v_and_b32 v3, 0xffff0000, v227
    v_pk_mul_f32 v[2:3], v[2:3], v[220:221] op_sel:[0,1] op_sel_hi:[1,1]
    v_pk_add_f32 v[232:233], v[232:233], v[2:3]
    v_pk_fma_f32 v[236:237], v[2:3], v[2:3], v[236:237]
    v_lshlrev_b32 v2, 16, v228
    v_and_b32 v3, 0xffff0000, v228
    v_pk_mul_f32 v[2:3], v[2:3], v[222:223] op_sel_hi:[1,0]
    v_pk_add_f32 v[230:231], v[230:231], v[2:3]
    v_pk_fma_f32 v[234:235], v[2:3], v[2:3], v[234:235]
    v_lshlrev_b32 v2, 16, v229
    v_and_b32 v3, 0xffff0000, v229
    v_pk_mul_f32 v[2:3], v[2:3], v[222:223] op_sel_hi:[1,0]
    v_pk_add_f32 v[232:233], v[232:233], v[2:3]
    v_pk_fma_f32 v[236:237], v[2:3], v[2:3], v[236:237]
    v_mfma_f32_16x16x32_bf16 v[100:103], a[92:95], v[132:135], v[100:103]
    ds_read_b64_tr_b16 a[186:187], v203 offset:7760
    v_permlane32_swap_b32 v230, v234
    v_mfma_f32_16x16x32_bf16 v[56:59], a[96:99], v[104:107], v[56:59]
    ds_read_b64_tr_b16 v[120:121], v168 offset:36864
    ds_read_b64_tr_b16 a[188:189], v204 offset:0
    v_mfma_f32_16x16x32_bf16 v[60:63], a[100:103], v[104:107], v[60:63]
    ds_read_b64_tr_b16 v[122:123], v168 offset:38912
    v_permlane32_swap_b32 v231, v235
    v_mfma_f32_16x16x32_bf16 v[64:67], a[104:107], v[104:107], v[64:67]
    s_add_u32 m0, s61, 151424
    ds_read_b64_tr_b16 v[124:125], v169 offset:36864
    v_permlane32_swap_b32 v232, v236
    v_permlane32_swap_b32 v233, v237
    v_add_f32 v230, v230, v234
    v_add_f32 v231, v231, v235
    v_add_f32 v232, v232, v236
    v_mfma_f32_16x16x32_bf16 v[68:71], a[96:99], v[108:111], v[68:71]
    ds_read_b64_tr_b16 a[190:191], v204 offset:1536
    buffer_load_dwordx4 v200, s[40:43], s64 offen offset:0 lds
    v_mfma_f32_16x16x32_bf16 v[72:75], a[100:103], v[108:111], v[72:75]
    ds_read_b64_tr_b16 v[126:127], v169 offset:38912
    v_lshrrev_b32 v238, 1, v1
    v_mfma_f32_16x16x32_bf16 v[76:79], a[104:107], v[108:111], v[76:79]
    ds_read_b64_tr_b16 v[128:129], v170 offset:36864
    v_lshlrev_b32 v238, 10, v238
    v_mfma_f32_16x16x32_bf16 v[80:83], a[96:99], v[112:115], v[80:83]
    s_add_u32 m0, s61, 151424
    ds_read_b64_tr_b16 v[130:131], v170 offset:38912
    v_and_b32 v239, 1, v1
    v_mfma_f32_16x16x32_bf16 v[84:87], a[100:103], v[112:115], v[84:87]
    buffer_load_dwordx4 v201, s[40:43], s64 offen offset:1024 lds
    v_mfma_f32_16x16x32_bf16 v[88:91], a[104:107], v[112:115], v[88:91]
    s_waitcnt lgkmcnt(10)
    ds_read_b64_tr_b16 v[132:133], v171 offset:36864
    v_lshl_add_u32 v219, v239, 7, v238
    v_mfma_f32_16x16x32_bf16 v[92:95], a[96:99], v[116:119], v[92:95]
    s_waitcnt lgkmcnt(3)
    ds_read_b64_tr_b16 v[134:135], v171 offset:38912
    v_add_f32 v233, v233, v237
    v_mfma_f32_16x16x32_bf16 v[96:99], a[100:103], v[116:119], v[96:99]
    s_add_u32 m0, s61, 151424
    v_permlane16_swap_b32 v230, v232
    v_permlane16_swap_b32 v231, v233
    v_mfma_f32_16x16x32_bf16 v[100:103], a[104:107], v[116:119], v[100:103]
    buffer_load_dwordx4 v202, s[40:43], s64 offen offset:2048 lds
    v_mfma_f32_16x16x32_bf16 v[56:59], a[108:111], v[120:123], v[56:59]
    s_lshl_b32 s55, s3, 8
    s_add_u32 s55, s55, 66560
    s_add_u32 s64, s64, 98304
    ds_read_b64_tr_b16 v[104:105], v168 offset:40960
    v_add_f32 v230, v230, v232
    v_add_f32 v231, v231, v233
    v_lshrrev_b32 v2, 4, v1
    v_lshlrev_b32 v2, 3, v2
    v_mfma_f32_16x16x32_bf16 v[60:63], a[112:115], v[120:123], v[60:63]
    s_waitcnt vmcnt(10)
    s_barrier
    s_sub_u32 s35, s64, 1966080
    ds_read_b64_tr_b16 v[106:107], v168 offset:43008
    ds_read_b64_tr_b16 a[192:193], v203 offset:12416
    v_add_u32 v219, s55, v219
    v_mfma_f32_16x16x32_bf16 v[64:67], a[116:119], v[120:123], v[64:67]
    s_lshl_b32 s55, s73, 7
    s_add_u32 s55, s55, 87040
    ds_read_b64_tr_b16 v[108:109], v169 offset:40960
    v_mfma_f32_16x16x32_bf16 v[68:71], a[108:111], v[124:127], v[68:71]
    s_min_u32 s64, s64, s35
    ds_read_b64_tr_b16 a[194:195], v203 offset:13952
    s_waitcnt vmcnt(9)
    v_cmp_ne_u32 vcc, s48, v244
    s_cbranch_vccnz L_chk9_slow
L_chk9_back:
    v_mfma_f32_16x16x32_bf16 v[72:75], a[112:115], v[124:127], v[72:75]
    s_lshl_b32 s50, s3, 5
    s_add_u32 s50, s50, 0
    ds_read_b64_tr_b16 v[110:111], v169 offset:43008
    v_mov_b32 v238, s55
    v_add_u32 v2, s50, v2
    v_add_f32_dpp v230, v230, v230 row_ror:8 row_mask:0xf bank_mask:0xf
    v_mfma_f32_16x16x32_bf16 v[76:79], a[116:119], v[124:127], v[76:79]
    s_waitcnt lgkmcnt(8)
    ds_read_b64_tr_b16 v[112:113], v170 offset:40960
    ds_read_b64_tr_b16 a[196:197], v203 offset:18640
    v_mfma_f32_16x16x32_bf16 v[80:83], a[108:111], v[128:131], v[80:83]
    ds_read_b64_tr_b16 v[114:115], v170 offset:43008
    ds_read_b64_tr_b16 a[198:199], v203 offset:20176
    v_mfma_f32_16x16x32_bf16 v[84:87], a[112:115], v[128:131], v[84:87]
    v_cmp_lt_u32 vcc, 39, v1
    s_nop 1
    v_cndmask_b32 v219, v219, v238, vcc
    buffer_load_dwordx4 a[240:243], v248, s[36:39], s62 offen offset:0 sc1
    v_mfma_f32_16x16x32_bf16 v[88:91], a[116:119], v[128:131], v[88:91]
    s_waitcnt lgkmcnt(10)
    s_mov_b32 s17, 23199744
    ds_read_b64_tr_b16 v[116:117], v171 offset:40960
    ds_read_b64_tr_b16 a[200:201], v204 offset:12416
    v_mfma_f32_16x16x32_bf16 v[92:95], a[108:111], v[132:135], v[92:95]
    s_waitcnt lgkmcnt(3)
    ds_read_b64_tr_b16 v[118:119], v171 offset:43008
    v_add_f32_dpp v231, v231, v231 row_ror:8 row_mask:0xf bank_mask:0xf
    v_mfma_f32_16x16x32_bf16 v[96:99], a[112:115], v[132:135], v[96:99]
    ds_read_b64_tr_b16 a[202:203], v204 offset:13952
    v_add_f32_dpp v230, v230, v230 row_ror:4 row_mask:0xf bank_mask:0xf
    v_mfma_f32_16x16x32_bf16 v[100:103], a[116:119], v[132:135], v[100:103]
    buffer_load_dwordx4 a[244:247], v248, s[36:39], s62 offen offset:1024 sc1
    v_mfma_f32_16x16x32_bf16 v[56:59], a[120:123], v[104:107], v[56:59]
    ds_read_b64_tr_b16 v[120:121], v168 offset:45056
    v_add_f32_dpp v231, v231, v231 row_ror:4 row_mask:0xf bank_mask:0xf
    v_mfma_f32_16x16x32_bf16 v[60:63], a[124:127], v[104:107], v[60:63]
    ds_read_b64_tr_b16 v[122:123], v168 offset:47104
    v_add_f32_dpp v230, v230, v230 row_ror:2 row_mask:0xf bank_mask:0xf
    v_mfma_f32_16x16x32_bf16 v[64:67], a[128:131], v[104:107], v[64:67]
    ds_read_b64_tr_b16 v[124:125], v169 offset:45056
    v_add_f32_dpp v231, v231, v231 row_ror:2 row_mask:0xf bank_mask:0xf
    v_mfma_f32_16x16x32_bf16 v[68:71], a[120:123], v[108:111], v[68:71]
    buffer_load_dwordx4 a[248:251], v248, s[36:39], s62 offen offset:2048 sc1
    v_mfma_f32_16x16x32_bf16 v[72:75], a[124:127], v[108:111], v[72:75]
    ds_read_b64_tr_b16 v[126:127], v169 offset:47104
    v_add_f32_dpp v230, v230, v230 row_ror:1 row_mask:0xf bank_mask:0xf
    v_mfma_f32_16x16x32_bf16 v[76:79], a[128:131], v[108:111], v[76:79]
    ds_read_b64_tr_b16 v[128:129], v170 offset:45056
    v_add_f32_dpp v231, v231, v231 row_ror:1 row_mask:0xf bank_mask:0xf
    s_mov_b32 exec_lo, 0x00010001
    s_mov_b32 exec_hi, 0x00010001
    ds_write_b64 v2, v[230:231]
    s_mov_b64 exec, -1
    v_lshlrev_b32 v2, 2, v1
    v_mfma_f32_16x16x32_bf16 v[80:83], a[120:123], v[112:115], v[80:83]
    s_waitcnt vmcnt(9)
    s_waitcnt lgkmcnt(6)
    s_barrier
    ds_read_b64_tr_b16 v[130:131], v170 offset:47104
    v_mfma_f32_16x16x32_bf16 v[84:87], a[124:127], v[112:115], v[84:87]
    ds_read_b64_tr_b16 a[204:205], v203 offset:24832
    buffer_load_dwordx4 a[252:255], v248, s[36:39], s62 offen offset:3072 sc1
    v_mfma_f32_16x16x32_bf16 v[88:91], a[128:131], v[112:115], v[88:91]
    ds_read_b64_tr_b16 v[132:133], v171 offset:45056
    ds_read_b64_tr_b16 a[206:207], v203 offset:26368
    v_mfma_f32_16x16x32_bf16 v[92:95], a[120:123], v[116:119], v[92:95]
    s_waitcnt lgkmcnt(3)
    ds_read_b64_tr_b16 v[134:135], v171 offset:47104
    v_and_b32 v2, 12, v2
    v_add_u32 v2, 0, v2
    v_mfma_f32_16x16x32_bf16 v[96:99], a[124:127], v[116:119], v[96:99]
    s_add_u32 s62, s62, 4096
    buffer_load_dword v240, v219, s[36:39], s17 offen sc1
    v_mfma_f32_16x16x32_bf16 v[100:103], a[128:131], v[116:119], v[100:103]
    s_waitcnt lgkmcnt(0)
    s_barrier
    ds_read_b64_tr_b16 a[208:209], v203 offset:31056
    buffer_load_dwordx4 v[136:139], v248, s[36:39], s62 offen offset:0 sc1
    v_mfma_f32_16x16x32_bf16 v[56:59], a[132:135], v[120:123], v[56:59]
    ds_read_b64_tr_b16 v[104:105], v168 offset:49152
    ds_read_b64_tr_b16 a[210:211], v203 offset:32592
    ds_read2_b32 v[230:231], v2 offset0:0 offset1:4
    v_mfma_f32_16x16x32_bf16 v[60:63], a[136:139], v[120:123], v[60:63]
    ds_read_b64_tr_b16 v[106:107], v168 offset:51200
    ds_read_b64_tr_b16 a[212:213], v204 offset:24832
    v_mfma_f32_16x16x32_bf16 v[64:67], a[140:143], v[120:123], v[64:67]
    ds_read_b64_tr_b16 v[108:109], v169 offset:49152
    ds_read2_b32 v[232:233], v2 offset0:8 offset1:12
    ds_read2_b32 v[234:235], v2 offset0:16 offset1:20
    v_mfma_f32_16x16x32_bf16 v[68:71], a[132:135], v[124:127], v[68:71]
    ds_read_b64_tr_b16 a[214:215], v204 offset:26368
    buffer_load_dwordx4 v[140:143], v248, s[36:39], s62 offen offset:1024 sc1
    v_mfma_f32_16x16x32_bf16 v[72:75], a[136:139], v[124:127], v[72:75]
    ds_read_b64_tr_b16 v[110:111], v169 offset:51200
    ds_read2_b32 v[236:237], v2 offset0:24 offset1:28
    v_mfma_f32_16x16x32_bf16 v[76:79], a[140:143], v[124:127], v[76:79]
    ds_read_b64_tr_b16 v[112:113], v170 offset:49152
    v_mov_b32 v225, s48
    v_mfma_f32_16x16x32_bf16 v[80:83], a[132:135], v[128:131], v[80:83]
    ds_read_b64_tr_b16 v[114:115], v170 offset:51200
    v_mov_b32 v227, s48
    v_mfma_f32_16x16x32_bf16 v[84:87], a[136:139], v[128:131], v[84:87]
    buffer_load_dwordx4 v[144:147], v248, s[36:39], s62 offen offset:2048 sc1
    v_mfma_f32_16x16x32_bf16 v[88:91], a[140:143], v[128:131], v[88:91]
    ds_read_b64_tr_b16 v[116:117], v171 offset:49152
    s_waitcnt lgkmcnt(7)
    v_add_f32 v230, v230, v232
    v_mfma_f32_16x16x32_bf16 v[92:95], a[132:135], v[132:135], v[92:95]
    s_waitcnt lgkmcnt(3)
    ds_read_b64_tr_b16 v[118:119], v171 offset:51200
    v_add_f32 v231, v231, v233
    v_mfma_f32_16x16x32_bf16 v[96:99], a[136:139], v[132:135], v[96:99]
    v_add_f32 v234, v234, v236
    v_add_f32 v235, v235, v237
    v_mfma_f32_16x16x32_bf16 v[100:103], a[140:143], v[132:135], v[100:103]
    buffer_load_dwordx4 v[148:151], v248, s[36:39], s62 offen offset:3072 sc1
    v_mfma_f32_16x16x32_bf16 v[56:59], a[144:147], v[104:107], v[56:59]
    s_waitcnt vmcnt(12)
    s_barrier
    ds_read_b64_tr_b16 v[120:121], v168 offset:53248
    v_add_f32 v230, v230, v234
    v_mfma_f32_16x16x32_bf16 v[60:63], a[148:151], v[104:107], v[60:63]
    ds_read_b64_tr_b16 v[122:123], v168 offset:55296
    ds_read_b64_tr_b16 a[216:217], v203 offset:37248
    v_mfma_f32_16x16x32_bf16 v[64:67], a[152:155], v[104:107], v[64:67]
    s_add_u32 s62, s62, 4096
    ds_read_b64_tr_b16 v[124:125], v169 offset:53248
    v_add_f32 v231, v231, v235
    v_mul_f32 v230, 0x3acccccd, v230
    v_mul_f32 v234, v230, v230
    v_mfma_f32_16x16x32_bf16 v[68:71], a[144:147], v[108:111], v[68:71]
    ds_read_b64_tr_b16 a[218:219], v203 offset:38784
    buffer_load_dwordx4 v[152:155], v248, s[36:39], s62 offen offset:0 sc1
    v_mfma_f32_16x16x32_bf16 v[72:75], a[148:151], v[108:111], v[72:75]
    ds_read_b64_tr_b16 v[126:127], v169 offset:55296
    ds_read_b64_tr_b16 a[220:221], v203 offset:43472
    v_mfma_f32_16x16x32_bf16 v[76:79], a[152:155], v[108:111], v[76:79]
    s_waitcnt lgkmcnt(9)
    ds_read_b64_tr_b16 v[128:129], v170 offset:53248
    ds_read_b64_tr_b16 a[222:223], v203 offset:45008
    v_mfma_f32_16x16x32_bf16 v[80:83], a[144:147], v[112:115], v[80:83]
    ds_read_b64_tr_b16 v[130:131], v170 offset:55296
    v_mov_b32 v224, 0x3acccccd
    v_fma_f32 v231, v231, v224, -v234
    v_max_f32 v231, 0, v231
    v_mfma_f32_16x16x32_bf16 v[84:87], a[148:151], v[112:115], v[84:87]
    ds_read_b64_tr_b16 a[224:225], v204 offset:37248
    buffer_load_dwordx4 v[156:159], v248, s[36:39], s62 offen offset:1024 sc1
    v_mfma_f32_16x16x32_bf16 v[88:91], a[152:155], v[112:115], v[88:91]
    s_waitcnt lgkmcnt(11)
    ds_read_b64_tr_b16 v[132:133], v171 offset:53248
    v_min_u32 v247, 23, v1
    v_mfma_f32_16x16x32_bf16 v[92:95], a[144:147], v[116:119], v[92:95]
    s_waitcnt lgkmcnt(3)
    ds_read_b64_tr_b16 v[134:135], v171 offset:55296
    v_lshlrev_b32 v247, 4, v247
    v_mfma_f32_16x16x32_bf16 v[96:99], a[148:151], v[116:119], v[96:99]
    ds_read_b64_tr_b16 a[226:227], v204 offset:38784
    v_add_f32 v231, 0x3727c5ac, v231
    v_rsq_f32 v224, v231
    v_mfma_f32_16x16x32_bf16 v[100:103], a[152:155], v[116:119], v[100:103]
    buffer_load_dwordx4 v[160:163], v248, s[36:39], s62 offen offset:2048 sc1
    v_mfma_f32_16x16x32_bf16 v[56:59], a[156:159], v[120:123], v[56:59]
    ds_read_b64_tr_b16 v[104:105], v168 offset:57344
    v_mul_f32_e64 v226, -v230, v224
    v_mfma_f32_16x16x32_bf16 v[60:63], a[160:163], v[120:123], v[60:63]
    ds_read_b64_tr_b16 v[106:107], v168 offset:59392
    s_mov_b64 exec, 0xf
    buffer_store_dwordx4 v[224:227], v248, s[36:39], s7 offen sc1
    s_mov_b64 exec, -1
    v_mfma_f32_16x16x32_bf16 v[64:67], a[164:167], v[120:123], v[64:67]
    ds_read_b64_tr_b16 v[108:109], v169 offset:57344
    v_mfma_f32_16x16x32_bf16 v[68:71], a[156:159], v[124:127], v[68:71]
    buffer_load_dwordx4 v[164:167], v248, s[36:39], s62 offen offset:3072 sc1
    v_mfma_f32_16x16x32_bf16 v[72:75], a[160:163], v[124:127], v[72:75]
    ds_read_b64_tr_b16 v[110:111], v169 offset:59392
    s_waitcnt vmcnt(8)
    v_cmp_ne_u32 vcc, s48, v240
    s_cbranch_vccnz L_chk10_slow
L_chk10_back:
    v_mfma_f32_16x16x32_bf16 v[76:79], a[164:167], v[124:127], v[76:79]
    s_waitcnt lgkmcnt(8)
    ds_read_b64_tr_b16 v[112:113], v170 offset:57344
    v_mfma_f32_16x16x32_bf16 v[80:83], a[156:159], v[128:131], v[80:83]
    s_waitcnt lgkmcnt(5)
    s_barrier
    s_add_u32 m0, s63, 81920
    ds_read_b64_tr_b16 v[114:115], v170 offset:59392
    v_mfma_f32_16x16x32_bf16 v[84:87], a[160:163], v[128:131], v[84:87]
    ds_read_b64_tr_b16 a[228:229], v203 offset:49664
    buffer_load_dwordx4 v172, s[36:39], s10 offen sc1 lds
    v_mfma_f32_16x16x32_bf16 v[88:91], a[164:167], v[128:131], v[88:91]
    ds_read_b64_tr_b16 v[116:117], v171 offset:57344
    ds_read_b64_tr_b16 a[230:231], v203 offset:51200
    v_mfma_f32_16x16x32_bf16 v[92:95], a[156:159], v[132:135], v[92:95]
    s_waitcnt lgkmcnt(3)
    s_add_u32 m0, s63, 5120
    ds_read_b64_tr_b16 v[118:119], v171 offset:59392
    v_mfma_f32_16x16x32_bf16 v[96:99], a[160:163], v[132:135], v[96:99]
    buffer_load_dwordx4 v247, s[36:39], s9 offen sc1 lds
    v_mfma_f32_16x16x32_bf16 v[100:103], a[164:167], v[132:135], v[100:103]
    s_add_u32 m0, s63, 86016
    ds_read_b64_tr_b16 a[232:233], v203 offset:55888
    v_mfma_f32_16x16x32_bf16 v[56:59], a[168:171], v[104:107], v[56:59]
    ds_read_b64_tr_b16 v[120:121], v168 offset:61440
    ds_read_b64_tr_b16 a[234:235], v203 offset:57424
    buffer_load_dwordx4 v172, s[36:39], s11 offen sc1 lds
    v_mfma_f32_16x16x32_bf16 v[60:63], a[172:175], v[104:107], v[60:63]
    ds_read_b64_tr_b16 v[122:123], v168 offset:63488
    v_add_u32 v168, 65536, v168
    v_mfma_f32_16x16x32_bf16 v[64:67], a[176:179], v[104:107], v[64:67]
    s_add_u32 m0, s63, 90112
    ds_read_b64_tr_b16 v[124:125], v169 offset:61440
    ds_read_b64_tr_b16 a[236:237], v204 offset:49664
    v_mfma_f32_16x16x32_bf16 v[68:71], a[168:171], v[108:111], v[68:71]
    ds_read_b64_tr_b16 a[238:239], v204 offset:51200
    buffer_load_dwordx4 v172, s[36:39], s12 offen sc1 lds
    v_mfma_f32_16x16x32_bf16 v[72:75], a[172:175], v[108:111], v[72:75]
    ds_read_b64_tr_b16 v[126:127], v169 offset:63488
    v_add_u32 v169, 65536, v169
    v_mfma_f32_16x16x32_bf16 v[76:79], a[176:179], v[108:111], v[76:79]
    ds_read_b64_tr_b16 v[128:129], v170 offset:61440
    v_mfma_f32_16x16x32_bf16 v[80:83], a[168:171], v[112:115], v[80:83]
    s_add_u32 m0, s63, 94208
    ds_read_b64_tr_b16 v[130:131], v170 offset:63488
    v_add_u32 v170, 65536, v170
    v_mfma_f32_16x16x32_bf16 v[84:87], a[172:175], v[112:115], v[84:87]
    buffer_load_dwordx4 v172, s[36:39], s13 offen sc1 lds
    v_mfma_f32_16x16x32_bf16 v[88:91], a[176:179], v[112:115], v[88:91]
    s_waitcnt lgkmcnt(10)
    ds_read_b64_tr_b16 v[132:133], v171 offset:61440
    v_mfma_f32_16x16x32_bf16 v[92:95], a[168:171], v[116:119], v[92:95]
    s_waitcnt lgkmcnt(3)
    ds_read_b64_tr_b16 v[134:135], v171 offset:63488
    v_add_u32 v171, 65536, v171
    v_mfma_f32_16x16x32_bf16 v[96:99], a[172:175], v[116:119], v[96:99]
    s_add_u32 m0, s63, 98304
    v_mfma_f32_16x16x32_bf16 v[100:103], a[176:179], v[116:119], v[100:103]
    buffer_load_dwordx4 v172, s[36:39], s14 offen sc1 lds
    v_mfma_f32_16x16x32_bf16 v[56:59], a[180:183], v[120:123], v[56:59]
    s_barrier
    ds_read_b64_tr_b16 v[104:105], v168 offset:0
    v_mfma_f32_16x16x32_bf16 v[60:63], a[184:187], v[120:123], v[60:63]
    ds_read_b64_tr_b16 v[106:107], v168 offset:2048
    v_mfma_f32_16x16x32_bf16 v[64:67], a[188:191], v[120:123], v[64:67]
    s_add_u32 m0, s63, 102400
    ds_read_b64_tr_b16 v[108:109], v169 offset:0
    v_mfma_f32_16x16x32_bf16 v[68:71], a[180:183], v[124:127], v[68:71]
    buffer_load_dwordx4 v172, s[36:39], s15 offen sc1 lds
    v_mfma_f32_16x16x32_bf16 v[72:75], a[184:187], v[124:127], v[72:75]
    ds_read_b64_tr_b16 v[110:111], v169 offset:2048
    v_mfma_f32_16x16x32_bf16 v[76:79], a[188:191], v[124:127], v[76:79]
    s_waitcnt lgkmcnt(6)
    ds_read_b64_tr_b16 v[112:113], v170 offset:0
    v_mfma_f32_16x16x32_bf16 v[80:83], a[180:183], v[128:131], v[80:83]
    s_add_u32 m0, s63, 106496
    ds_read_b64_tr_b16 v[114:115], v170 offset:2048
    v_mfma_f32_16x16x32_bf16 v[84:87], a[184:187], v[128:131], v[84:87]
    buffer_load_dwordx4 v172, s[36:39], s18 offen sc1 lds
    v_mfma_f32_16x16x32_bf16 v[88:91], a[188:191], v[128:131], v[88:91]
    s_waitcnt lgkmcnt(6)
    ds_read_b64_tr_b16 v[116:117], v171 offset:0
    v_mfma_f32_16x16x32_bf16 v[92:95], a[180:183], v[132:135], v[92:95]
    s_waitcnt lgkmcnt(3)
    ds_read_b64_tr_b16 v[118:119], v171 offset:2048
    v_mfma_f32_16x16x32_bf16 v[96:99], a[184:187], v[132:135], v[96:99]
    s_add_u32 m0, s63, 110592
    v_mfma_f32_16x16x32_bf16 v[100:103], a[188:191], v[132:135], v[100:103]
    buffer_load_dwordx4 v172, s[36:39], s19 offen sc1 lds
    v_mfma_f32_16x16x32_bf16 v[56:59], a[192:195], v[104:107], v[56:59]
    ds_read_b64_tr_b16 v[120:121], v168 offset:4096
    v_mfma_f32_16x16x32_bf16 v[60:63], a[196:199], v[104:107], v[60:63]
    ds_read_b64_tr_b16 v[122:123], v168 offset:6144
    v_mfma_f32_16x16x32_bf16 v[64:67], a[200:203], v[104:107], v[64:67]
    s_add_u32 m0, s63, 114688
    ds_read_b64_tr_b16 v[124:125], v169 offset:4096
    v_mfma_f32_16x16x32_bf16 v[68:71], a[192:195], v[108:111], v[68:71]
    buffer_load_dwordx4 v172, s[36:39], s20 offen sc1 lds
    v_mfma_f32_16x16x32_bf16 v[72:75], a[196:199], v[108:111], v[72:75]
    ds_read_b64_tr_b16 v[126:127], v169 offset:6144
    v_mfma_f32_16x16x32_bf16 v[76:79], a[200:203], v[108:111], v[76:79]
    s_waitcnt lgkmcnt(6)
    ds_read_b64_tr_b16 v[128:129], v170 offset:4096
    v_mfma_f32_16x16x32_bf16 v[80:83], a[192:195], v[112:115], v[80:83]
    s_add_u32 m0, s63, 118784
    ds_read_b64_tr_b16 v[130:131], v170 offset:6144
    v_mfma_f32_16x16x32_bf16 v[84:87], a[196:199], v[112:115], v[84:87]
    buffer_load_dwordx4 v172, s[36:39], s21 offen sc1 lds
    v_mfma_f32_16x16x32_bf16 v[88:91], a[200:203], v[112:115], v[88:91]
    s_waitcnt lgkmcnt(6)
    ds_read_b64_tr_b16 v[132:133], v171 offset:4096
    v_mfma_f32_16x16x32_bf16 v[92:95], a[192:195], v[116:119], v[92:95]
    s_waitcnt lgkmcnt(3)
    ds_read_b64_tr_b16 v[134:135], v171 offset:6144
    v_mfma_f32_16x16x32_bf16 v[96:99], a[196:199], v[116:119], v[96:99]
    s_add_u32 m0, s63, 122880
    v_mfma_f32_16x16x32_bf16 v[100:103], a[200:203], v[116:119], v[100:103]
    buffer_load_dwordx4 v172, s[36:39], s22 offen sc1 lds
    v_mfma_f32_16x16x32_bf16 v[56:59], a[204:207], v[120:123], v[56:59]
    ds_read_b64_tr_b16 v[104:105], v168 offset:8192
    v_mfma_f32_16x16x32_bf16 v[60:63], a[208:211], v[120:123], v[60:63]
    ds_read_b64_tr_b16 v[106:107], v168 offset:10240
    v_mfma_f32_16x16x32_bf16 v[64:67], a[212:215], v[120:123], v[64:67]
    s_add_u32 m0, s63, 126976
    ds_read_b64_tr_b16 v[108:109], v169 offset:8192
    v_mfma_f32_16x16x32_bf16 v[68:71], a[204:207], v[124:127], v[68:71]
    buffer_load_dwordx4 v172, s[36:39], s23 offen sc1 lds
    v_mfma_f32_16x16x32_bf16 v[72:75], a[208:211], v[124:127], v[72:75]
    ds_read_b64_tr_b16 v[110:111], v169 offset:10240
    v_mfma_f32_16x16x32_bf16 v[76:79], a[212:215], v[124:127], v[76:79]
    s_waitcnt lgkmcnt(6)
    ds_read_b64_tr_b16 v[112:113], v170 offset:8192
    v_mfma_f32_16x16x32_bf16 v[80:83], a[204:207], v[128:131], v[80:83]
    s_add_u32 m0, s63, 1024
    ds_read_b64_tr_b16 v[114:115], v170 offset:10240
    v_mfma_f32_16x16x32_bf16 v[84:87], a[208:211], v[128:131], v[84:87]
    buffer_load_dwordx4 v248, s[36:39], s6 offen sc1 lds
    v_mfma_f32_16x16x32_bf16 v[88:91], a[212:215], v[128:131], v[88:91]
    s_waitcnt lgkmcnt(6)
    ds_read_b64_tr_b16 v[116:117], v171 offset:8192
    v_mfma_f32_16x16x32_bf16 v[92:95], a[204:207], v[132:135], v[92:95]
    s_waitcnt lgkmcnt(3)
    ds_read_b64_tr_b16 v[118:119], v171 offset:10240
    v_mfma_f32_16x16x32_bf16 v[96:99], a[208:211], v[132:135], v[96:99]
    s_add_u32 m0, s63, 131072
    v_mfma_f32_16x16x32_bf16 v[100:103], a[212:215], v[132:135], v[100:103]
    buffer_load_dwordx4 v172, s[36:39], s24 offen sc1 lds
    v_mfma_f32_16x16x32_bf16 v[56:59], a[216:219], v[104:107], v[56:59]
    ds_read_b64_tr_b16 v[120:121], v168 offset:12288
    v_mfma_f32_16x16x32_bf16 v[60:63], a[220:223], v[104:107], v[60:63]
    ds_read_b64_tr_b16 v[122:123], v168 offset:14336
    v_add_u32 v168, 16384, v168
    v_mfma_f32_16x16x32_bf16 v[64:67], a[224:227], v[104:107], v[64:67]
    s_add_u32 m0, s63, 135168
    ds_read_b64_tr_b16 v[124:125], v169 offset:12288
    v_and_b32 v247, 48, v1
    v_mfma_f32_16x16x32_bf16 v[68:71], a[216:219], v[108:111], v[68:71]
    v_add_u32 v247, s63, v247
    buffer_load_dwordx4 v172, s[36:39], s25 offen sc1 lds
    v_mfma_f32_16x16x32_bf16 v[72:75], a[220:223], v[108:111], v[72:75]
    s_waitcnt vmcnt(14)
    ds_read_b64_tr_b16 v[126:127], v169 offset:14336
    v_add_u32 v169, 16384, v169
    v_mfma_f32_16x16x32_bf16 v[76:79], a[224:227], v[108:111], v[76:79]
    s_waitcnt lgkmcnt(6)
    ds_read_b64_tr_b16 v[128:129], v170 offset:12288
    ds_read_b128 v[176:179], v247 offset:5120
    v_mfma_f32_16x16x32_bf16 v[80:83], a[216:219], v[112:115], v[80:83]
    s_add_u32 m0, s63, 139264
    ds_read_b64_tr_b16 v[130:131], v170 offset:14336
    v_add_u32 v170, 16384, v170
    v_mfma_f32_16x16x32_bf16 v[84:87], a[220:223], v[112:115], v[84:87]
    ds_read_b128 v[180:183], v247 offset:5184
    buffer_load_dwordx4 v172, s[36:39], s26 offen sc1 lds
    v_mfma_f32_16x16x32_bf16 v[88:91], a[224:227], v[112:115], v[88:91]
    s_waitcnt lgkmcnt(8)
    ds_read_b64_tr_b16 v[132:133], v171 offset:12288
    ds_read_b128 v[184:187], v247 offset:5248
    v_mfma_f32_16x16x32_bf16 v[92:95], a[216:219], v[116:119], v[92:95]
    s_waitcnt lgkmcnt(3)
    ds_read_b64_tr_b16 v[134:135], v171 offset:14336
    v_add_u32 v171, 16384, v171
    v_mfma_f32_16x16x32_bf16 v[96:99], a[220:223], v[116:119], v[96:99]
    s_add_u32 m0, s63, 143360
    ds_read_b128 v[188:191], v247 offset:5312
    v_mfma_f32_16x16x32_bf16 v[100:103], a[224:227], v[116:119], v[100:103]
    ds_read_b128 v[192:195], v247 offset:5376
    buffer_load_dwordx4 v172, s[36:39], s27 offen sc1 lds
    v_mfma_f32_16x16x32_bf16 v[56:59], a[228:231], v[120:123], v[56:59]
    s_waitcnt vmcnt(15)
    s_barrier
    ds_read_b64_tr_b16 v[104:105], v168 offset:0
    v_mfma_f32_16x16x32_bf16 v[60:63], a[232:235], v[120:123], v[60:63]
    ds_read_b64_tr_b16 v[106:107], v168 offset:2048
    ds_read_b128 v[196:199], v247 offset:5440
    v_mfma_f32_16x16x32_bf16 v[64:67], a[236:239], v[120:123], v[64:67]
    s_add_u32 m0, s63, 147456
    ds_read_b64_tr_b16 v[108:109], v169 offset:0
    v_mfma_f32_16x16x32_bf16 v[68:71], a[228:231], v[124:127], v[68:71]
    buffer_load_dwordx4 v172, s[36:39], s44 offen sc1 lds
    v_mfma_f32_16x16x32_bf16 v[72:75], a[232:235], v[124:127], v[72:75]
    ds_read_b64_tr_b16 v[110:111], v169 offset:2048
    v_mfma_f32_16x16x32_bf16 v[76:79], a[236:239], v[124:127], v[76:79]
    ds_read_b64_tr_b16 v[112:113], v170 offset:0
    v_mfma_f32_16x16x32_bf16 v[80:83], a[228:231], v[128:131], v[80:83]
    s_add_u32 m0, s63, 151552
    ds_read_b64_tr_b16 v[114:115], v170 offset:2048
    v_mfma_f32_16x16x32_bf16 v[84:87], a[232:235], v[128:131], v[84:87]
    buffer_load_dwordx4 v172, s[36:39], s45 offen sc1 lds
    v_mfma_f32_16x16x32_bf16 v[88:91], a[236:239], v[128:131], v[88:91]
    s_waitcnt lgkmcnt(9)
    ds_read_b64_tr_b16 v[116:117], v171 offset:0
    v_mfma_f32_16x16x32_bf16 v[92:95], a[228:231], v[132:135], v[92:95]
    s_waitcnt lgkmcnt(3)
    ds_read_b64_tr_b16 v[118:119], v171 offset:2048
    v_mfma_f32_16x16x32_bf16 v[96:99], a[232:235], v[132:135], v[96:99]
    v_mfma_f32_16x16x32_bf16 v[100:103], a[236:239], v[132:135], v[100:103]
    v_mfma_f32_16x16x32_bf16 v[8:11], a[0:3], v[104:107], 0
    ds_read_b64_tr_b16 v[120:121], v168 offset:4096
    v_add_u32 v216, 81920, v216
    v_mfma_f32_16x16x32_bf16 v[12:15], a[4:7], v[104:107], 0
    ds_read_b64_tr_b16 v[122:123], v168 offset:6144
    v_add_u32 v217, 81920, v217
    v_mfma_f32_16x16x32_bf16 v[16:19], a[8:11], v[104:107], 0
    s_add_u32 m0, s63, 155648
    ds_read_b64_tr_b16 v[124:125], v169 offset:4096
    v_add_u32 v218, 81920, v218
    v_mfma_f32_16x16x32_bf16 v[20:23], a[0:3], v[108:111], 0
    buffer_load_dwordx4 v172, s[36:39], s46 offen sc1 lds
    v_mfma_f32_16x16x32_bf16 v[24:27], a[4:7], v[108:111], 0
    ds_read_b64_tr_b16 v[126:127], v169 offset:6144
    v_mfma_f32_16x16x32_bf16 v[28:31], a[8:11], v[108:111], 0
    s_waitcnt lgkmcnt(6)
    ds_read_b64_tr_b16 v[128:129], v170 offset:4096
    v_mfma_f32_16x16x32_bf16 v[32:35], a[0:3], v[112:115], 0
    s_add_u32 m0, s63, 159744
    ds_read_b64_tr_b16 v[130:131], v170 offset:6144
    v_mfma_f32_16x16x32_bf16 v[36:39], a[4:7], v[112:115], 0
    buffer_load_dwordx4 v172, s[36:39], s47 offen sc1 lds
    v_mfma_f32_16x16x32_bf16 v[40:43], a[8:11], v[112:115], 0
    s_waitcnt lgkmcnt(6)
    ds_read_b64_tr_b16 v[132:133], v171 offset:4096
    v_mfma_f32_16x16x32_bf16 v[44:47], a[0:3], v[116:119], 0
    s_waitcnt lgkmcnt(3)
    ds_read_b64_tr_b16 v[134:135], v171 offset:6144
    v_mfma_f32_16x16x32_bf16 v[48:51], a[4:7], v[116:119], 0
    v_mfma_f32_16x16x32_bf16 v[52:55], a[8:11], v[116:119], 0
    v_mfma_f32_16x16x32_bf16 v[8:11], a[12:15], v[120:123], v[8:11]
    s_waitcnt vmcnt(16)
    s_barrier
    ds_read_b64_tr_b16 v[104:105], v168 offset:8192
    v_mfma_f32_16x16x32_bf16 v[12:15], a[16:19], v[120:123], v[12:15]
    ds_read_b64_tr_b16 v[106:107], v168 offset:10240
    v_mfma_f32_16x16x32_bf16 v[16:19], a[20:23], v[120:123], v[16:19]
    s_waitcnt vmcnt(8)
    s_add_u32 s62, s62, 4096
    ds_read_b64_tr_b16 v[108:109], v169 offset:8192
    v_mfma_f32_16x16x32_bf16 v[20:23], a[12:15], v[124:127], v[20:23]
    ds_read_b128 v[200:203], v175 offset:1024
    buffer_load_dwordx4 a[0:3], v248, s[36:39], s62 offen offset:0 sc1
    v_mfma_f32_16x16x32_bf16 v[24:27], a[16:19], v[124:127], v[24:27]
    ds_read_b64_tr_b16 v[110:111], v169 offset:10240
    ds_read_b128 v[204:207], v175 offset:1280
    v_mfma_f32_16x16x32_bf16 v[28:31], a[20:23], v[124:127], v[28:31]
    s_waitcnt lgkmcnt(8)
    ds_read_b64_tr_b16 v[112:113], v170 offset:8192
    ds_read_b128 v[208:211], v175 offset:1536
    v_mfma_f32_16x16x32_bf16 v[32:35], a[12:15], v[128:131], v[32:35]
    ds_read_b64_tr_b16 v[114:115], v170 offset:10240
    v_mfma_f32_16x16x32_bf16 v[36:39], a[16:19], v[128:131], v[36:39]
    ds_read_b128 v[212:215], v175 offset:1792
    buffer_load_dwordx4 a[4:7], v248, s[36:39], s62 offen offset:1024 sc1
    v_mfma_f32_16x16x32_bf16 v[40:43], a[20:23], v[128:131], v[40:43]
    s_waitcnt lgkmcnt(10)
    ds_read_b64_tr_b16 v[116:117], v171 offset:8192
    v_mfma_f32_16x16x32_bf16 v[44:47], a[12:15], v[132:135], v[44:47]
    s_waitcnt lgkmcnt(3)
    ds_read_b64_tr_b16 v[118:119], v171 offset:10240
    v_mfma_f32_16x16x32_bf16 v[48:51], a[16:19], v[132:135], v[48:51]
    v_xor_b32 v3, s48, v201
    v_bitop3_b32 v3, v203, s48, v3 bitop3:0xbe
    v_mfma_f32_16x16x32_bf16 v[52:55], a[20:23], v[132:135], v[52:55]
    buffer_load_dwordx4 a[8:11], v248, s[36:39], s62 offen offset:2048 sc1
    v_mfma_f32_16x16x32_bf16 v[8:11], a[24:27], v[104:107], v[8:11]
    ds_read_b64_tr_b16 v[120:121], v168 offset:12288
    v_bitop3_b32 v3, v205, s48, v3 bitop3:0xbe
    v_mfma_f32_16x16x32_bf16 v[12:15], a[28:31], v[104:107], v[12:15]
    ds_read_b64_tr_b16 v[122:123], v168 offset:14336
    v_bitop3_b32 v3, v207, s48, v3 bitop3:0xbe
    v_bitop3_b32 v3, v209, s48, v3 bitop3:0xbe
    v_mfma_f32_16x16x32_bf16 v[16:19], a[32:35], v[104:107], v[16:19]
    ds_read_b64_tr_b16 v[124:125], v169 offset:12288
    v_bitop3_b32 v3, v211, s48, v3 bitop3:0xbe
    v_mfma_f32_16x16x32_bf16 v[20:23], a[24:27], v[108:111], v[20:23]
    s_waitcnt lgkmcnt(5)
    v_bitop3_b32 v3, v213, s48, v3 bitop3:0xbe
    buffer_load_dwordx4 a[12:15], v248, s[36:39], s62 offen offset:3072 sc1
    v_mfma_f32_16x16x32_bf16 v[24:27], a[28:31], v[108:111], v[24:27]
    ds_read_b64_tr_b16 v[126:127], v169 offset:14336
    v_bitop3_b32 v3, v215, s48, v3 bitop3:0xbe
    v_mfma_f32_16x16x32_bf16 v[28:31], a[32:35], v[108:111], v[28:31]
    ds_read_b64_tr_b16 v[128:129], v170 offset:12288
    v_cmp_ne_u32 vcc, 0, v3
    s_cbranch_vccnz L_stc0_slow
L_stc0_back:
    v_mfma_f32_16x16x32_bf16 v[32:35], a[24:27], v[112:115], v[32:35]
    s_add_u32 s62, s62, 4096
    ds_read_b64_tr_b16 v[130:131], v170 offset:14336
    s_add_u32 s50, s8, 98304
    v_pk_fma_f32 v[238:239], v[176:177], v[202:203], v[188:189] op_sel_hi:[1,0,1]
    v_pk_fma_f32 v[240:241], v[178:179], v[202:203], v[190:191] op_sel_hi:[1,0,1]
    v_pk_fma_f32 v[56:57], v[56:57], v[200:201], v[238:239] op_sel_hi:[1,0,1]
    v_pk_fma_f32 v[58:59], v[58:59], v[200:201], v[240:241] op_sel_hi:[1,0,1]
    v_pk_fma_f32 v[242:243], v[180:181], v[202:203], v[192:193] op_sel_hi:[1,0,1]
    v_pk_fma_f32 v[244:245], v[182:183], v[202:203], v[194:195] op_sel_hi:[1,0,1]
    v_pk_fma_f32 v[60:61], v[60:61], v[200:201], v[242:243] op_sel_hi:[1,0,1]
    v_pk_fma_f32 v[62:63], v[62:63], v[200:201], v[244:245] op_sel_hi:[1,0,1]
    v_pk_mul_f32 v[56:57], v[56:57], v[60:61]
    v_pk_mul_f32 v[58:59], v[58:59], v[62:63]
    v_cvt_pk_bf16_f32 v60, v56, v57
    v_cvt_pk_bf16_f32 v61, v58, v59
    v_pk_fma_f32 v[242:243], v[176:177], v[206:207], v[188:189] op_sel_hi:[1,0,1]
    v_pk_fma_f32 v[244:245], v[178:179], v[206:207], v[190:191] op_sel_hi:[1,0,1]
    v_pk_fma_f32 v[68:69], v[68:69], v[204:205], v[242:243] op_sel_hi:[1,0,1]
    v_pk_fma_f32 v[70:71], v[70:71], v[204:205], v[244:245] op_sel_hi:[1,0,1]
    v_pk_fma_f32 v[238:239], v[180:181], v[206:207], v[192:193] op_sel_hi:[1,0,1]
    v_pk_fma_f32 v[240:241], v[182:183], v[206:207], v[194:195] op_sel_hi:[1,0,1]
    v_pk_fma_f32 v[72:73], v[72:73], v[204:205], v[238:239] op_sel_hi:[1,0,1]
    v_pk_fma_f32 v[74:75], v[74:75], v[204:205], v[240:241] op_sel_hi:[1,0,1]
    v_pk_mul_f32 v[68:69], v[68:69], v[72:73]
    v_pk_mul_f32 v[70:71], v[70:71], v[74:75]
    v_cvt_pk_bf16_f32 v62, v68, v69
    v_cvt_pk_bf16_f32 v63, v70, v71
    s_nop 0
    v_permlane16_swap_b32 v60, v62
    v_permlane16_swap_b32 v61, v63
    buffer_store_dwordx4 v[60:63], v173, s[36:39], s8 offen sc1
    v_pk_fma_f32 v[238:239], v[176:177], v[210:211], v[188:189] op_sel_hi:[1,0,1]
    v_pk_fma_f32 v[240:241], v[178:179], v[210:211], v[190:191] op_sel_hi:[1,0,1]
    v_pk_fma_f32 v[80:81], v[80:81], v[208:209], v[238:239] op_sel_hi:[1,0,1]
    v_pk_fma_f32 v[82:83], v[82:83], v[208:209], v[240:241] op_sel_hi:[1,0,1]
    v_pk_fma_f32 v[242:243], v[180:181], v[210:211], v[192:193] op_sel_hi:[1,0,1]
    v_pk_fma_f32 v[244:245], v[182:183], v[210:211], v[194:195] op_sel_hi:[1,0,1]
    v_pk_fma_f32 v[84:85], v[84:85], v[208:209], v[242:243] op_sel_hi:[1,0,1]
    v_pk_fma_f32 v[86:87], v[86:87], v[208:209], v[244:245] op_sel_hi:[1,0,1]
    v_pk_mul_f32 v[80:81], v[80:81], v[84:85]
    v_pk_mul_f32 v[82:83], v[82:83], v[86:87]
    v_cvt_pk_bf16_f32 v84, v80, v81
    v_cvt_pk_bf16_f32 v85, v82, v83
    v_pk_fma_f32 v[242:243], v[176:177], v[214:215], v[188:189] op_sel_hi:[1,0,1]
    v_pk_fma_f32 v[244:245], v[178:179], v[214:215], v[190:191] op_sel_hi:[1,0,1]
    v_pk_fma_f32 v[92:93], v[92:93], v[212:213], v[242:243] op_sel_hi:[1,0,1]
    v_pk_fma_f32 v[94:95], v[94:95], v[212:213], v[244:245] op_sel_hi:[1,0,1]
    v_pk_fma_f32 v[238:239], v[180:181], v[214:215], v[192:193] op_sel_hi:[1,0,1]
    v_pk_fma_f32 v[240:241], v[182:183], v[214:215], v[194:195] op_sel_hi:[1,0,1]
    v_pk_fma_f32 v[96:97], v[96:97], v[212:213], v[238:239] op_sel_hi:[1,0,1]
    v_pk_fma_f32 v[98:99], v[98:99], v[212:213], v[240:241] op_sel_hi:[1,0,1]
    v_pk_mul_f32 v[92:93], v[92:93], v[96:97]
    v_pk_mul_f32 v[94:95], v[94:95], v[98:99]
    v_cvt_pk_bf16_f32 v86, v92, v93
    v_cvt_pk_bf16_f32 v87, v94, v95
    s_nop 0
    v_permlane16_swap_b32 v84, v86
    v_permlane16_swap_b32 v85, v87
    buffer_store_dwordx4 v[84:87], v173, s[36:39], s50 offen sc1
    v_pk_fma_f32 v[238:239], v[184:185], v[202:203], v[196:197] op_sel_hi:[1,0,1]
    v_pk_fma_f32 v[240:241], v[186:187], v[202:203], v[198:199] op_sel_hi:[1,0,1]
    v_pk_fma_f32 v[64:65], v[64:65], v[200:201], v[238:239] op_sel_hi:[1,0,1]
    v_pk_fma_f32 v[66:67], v[66:67], v[200:201], v[240:241] op_sel_hi:[1,0,1]
    v_pk_fma_f32 v[242:243], v[184:185], v[206:207], v[196:197] op_sel_hi:[1,0,1]
    v_pk_fma_f32 v[244:245], v[186:187], v[206:207], v[198:199] op_sel_hi:[1,0,1]
    v_pk_fma_f32 v[76:77], v[76:77], v[204:205], v[242:243] op_sel_hi:[1,0,1]
    v_pk_fma_f32 v[78:79], v[78:79], v[204:205], v[244:245] op_sel_hi:[1,0,1]
    s_nop 0
    v_permlane32_swap_b32 v64, v76
    v_permlane32_swap_b32 v65, v77
    v_permlane32_swap_b32 v66, v78
    v_permlane32_swap_b32 v67, v79
    v_pk_mul_f32 v[64:65], v[64:65], v[76:77]
    v_pk_mul_f32 v[66:67], v[66:67], v[78:79]
    v_cvt_pk_bf16_f32 v56, v64, v65
    v_cvt_pk_bf16_f32 v57, v66, v67
    v_pk_fma_f32 v[238:239], v[184:185], v[210:211], v[196:197] op_sel_hi:[1,0,1]
    v_pk_fma_f32 v[240:241], v[186:187], v[210:211], v[198:199] op_sel_hi:[1,0,1]
    v_pk_fma_f32 v[88:89], v[88:89], v[208:209], v[238:239] op_sel_hi:[1,0,1]
    v_pk_fma_f32 v[90:91], v[90:91], v[208:209], v[240:241] op_sel_hi:[1,0,1]
    v_pk_fma_f32 v[242:243], v[184:185], v[214:215], v[196:197] op_sel_hi:[1,0,1]
    v_pk_fma_f32 v[244:245], v[186:187], v[214:215], v[198:199] op_sel_hi:[1,0,1]
    v_pk_fma_f32 v[100:101], v[100:101], v[212:213], v[242:243] op_sel_hi:[1,0,1]
    v_pk_fma_f32 v[102:103], v[102:103], v[212:213], v[244:245] op_sel_hi:[1,0,1]
    s_nop 0
    v_permlane32_swap_b32 v88, v100
    v_permlane32_swap_b32 v89, v101
    v_permlane32_swap_b32 v90, v102
    v_permlane32_swap_b32 v91, v103
    v_pk_mul_f32 v[88:89], v[88:89], v[100:101]
    v_pk_mul_f32 v[90:91], v[90:91], v[102:103]
    v_cvt_pk_bf16_f32 v58, v88, v89
    v_cvt_pk_bf16_f32 v59, v90, v91
    s_nop 0
    v_permlane16_swap_b32 v56, v58
    v_permlane16_swap_b32 v57, v59
    buffer_store_dwordx4 v[56:59], v174, s[36:39], s8 offen offset:512 sc1
    s_add_u32 s6, s6, 16384
    s_lshl_b32 s76, s72, 4
    s_add_u32 s76, s76, s73
    v_mfma_f32_16x16x32_bf16 v[36:39], a[28:31], v[112:115], v[36:39]
    buffer_load_dwordx4 a[16:19], v248, s[36:39], s62 offen offset:0 sc1
    v_mfma_f32_16x16x32_bf16 v[40:43], a[32:35], v[112:115], v[40:43]
    s_waitcnt lgkmcnt(6)
    ds_read_b64_tr_b16 v[132:133], v171 offset:12288
    v_mfma_f32_16x16x32_bf16 v[44:47], a[24:27], v[116:119], v[44:47]
    s_waitcnt lgkmcnt(3)
    ds_read_b64_tr_b16 v[134:135], v171 offset:14336
    v_mfma_f32_16x16x32_bf16 v[48:51], a[28:31], v[116:119], v[48:51]
    v_mfma_f32_16x16x32_bf16 v[52:55], a[32:35], v[116:119], v[52:55]
    buffer_load_dwordx4 a[20:23], v248, s[36:39], s62 offen offset:1024 sc1
    v_mfma_f32_16x16x32_bf16 v[8:11], a[36:39], v[120:123], v[8:11]
    ds_read_b64_tr_b16 v[104:105], v168 offset:16384
    v_mfma_f32_16x16x32_bf16 v[12:15], a[40:43], v[120:123], v[12:15]
    ds_read_b64_tr_b16 v[106:107], v168 offset:18432
    v_mfma_f32_16x16x32_bf16 v[16:19], a[44:47], v[120:123], v[16:19]
    ds_read_b64_tr_b16 v[108:109], v169 offset:16384
    v_mfma_f32_16x16x32_bf16 v[20:23], a[36:39], v[124:127], v[20:23]
    buffer_load_dwordx4 a[24:27], v248, s[36:39], s62 offen offset:2048 sc1
    v_mfma_f32_16x16x32_bf16 v[24:27], a[40:43], v[124:127], v[24:27]
    ds_read_b64_tr_b16 v[110:111], v169 offset:18432
    v_mfma_f32_16x16x32_bf16 v[28:31], a[44:47], v[124:127], v[28:31]
    s_waitcnt lgkmcnt(6)
    ds_read_b64_tr_b16 v[112:113], v170 offset:16384
    v_mfma_f32_16x16x32_bf16 v[32:35], a[36:39], v[128:131], v[32:35]
    ds_read_b64_tr_b16 v[114:115], v170 offset:18432
    v_mfma_f32_16x16x32_bf16 v[36:39], a[40:43], v[128:131], v[36:39]
    buffer_load_dwordx4 a[28:31], v248, s[36:39], s62 offen offset:3072 sc1
    v_mfma_f32_16x16x32_bf16 v[40:43], a[44:47], v[128:131], v[40:43]
    s_waitcnt lgkmcnt(6)
    ds_read_b64_tr_b16 v[116:117], v171 offset:16384
    v_mfma_f32_16x16x32_bf16 v[44:47], a[36:39], v[132:135], v[44:47]
    s_waitcnt lgkmcnt(3)
    ds_read_b64_tr_b16 v[118:119], v171 offset:18432
    v_mfma_f32_16x16x32_bf16 v[48:51], a[40:43], v[132:135], v[48:51]
    s_add_u32 s62, s62, 4096
    v_mfma_f32_16x16x32_bf16 v[52:55], a[44:47], v[132:135], v[52:55]
    buffer_load_dwordx4 a[32:35], v248, s[36:39], s62 offen offset:0 sc1
    v_mfma_f32_16x16x32_bf16 v[8:11], a[48:51], v[104:107], v[8:11]
    s_waitcnt vmcnt(12)
    s_barrier
    ds_read_b64_tr_b16 v[120:121], v168 offset:20480
    v_mfma_f32_16x16x32_bf16 v[12:15], a[52:55], v[104:107], v[12:15]
    ds_read_b64_tr_b16 v[122:123], v168 offset:22528
    ds_read_b64 v[224:225], v216
    v_mfma_f32_16x16x32_bf16 v[16:19], a[56:59], v[104:107], v[16:19]
    ds_read_b64_tr_b16 v[124:125], v169 offset:20480
    ds_read_b64 v[226:227], v217
    v_mfma_f32_16x16x32_bf16 v[20:23], a[48:51], v[108:111], v[20:23]
    buffer_load_dwordx4 a[36:39], v248, s[36:39], s62 offen offset:1024 sc1
    v_mfma_f32_16x16x32_bf16 v[24:27], a[52:55], v[108:111], v[24:27]
    ds_read_b64_tr_b16 v[126:127], v169 offset:22528
    ds_read_b64 v[228:229], v218
    v_mfma_f32_16x16x32_bf16 v[28:31], a[56:59], v[108:111], v[28:31]
    s_waitcnt lgkmcnt(9)
    ds_read_b64_tr_b16 v[128:129], v170 offset:20480
    v_mfma_f32_16x16x32_bf16 v[32:35], a[48:51], v[112:115], v[32:35]
    ds_read_b64_tr_b16 v[130:131], v170 offset:22528
    v_mfma_f32_16x16x32_bf16 v[36:39], a[52:55], v[112:115], v[36:39]
    buffer_load_dwordx4 a[40:43], v248, s[36:39], s62 offen offset:2048 sc1
    v_mfma_f32_16x16x32_bf16 v[40:43], a[56:59], v[112:115], v[40:43]
    s_waitcnt lgkmcnt(9)
    ds_read_b64_tr_b16 v[132:133], v171 offset:20480
    v_mfma_f32_16x16x32_bf16 v[44:47], a[48:51], v[116:119], v[44:47]
    s_waitcnt lgkmcnt(3)
    ds_read_b64_tr_b16 v[134:135], v171 offset:22528
    v_mfma_f32_16x16x32_bf16 v[48:51], a[52:55], v[116:119], v[48:51]
    v_lshlrev_b32 v230, 16, v224
    v_and_b32 v231, 0xffff0000, v224
    v_pk_mul_f32 v[230:231], v[230:231], v[220:221] op_sel_hi:[1,0]
    v_pk_mul_f32 v[234:235], v[230:231], v[230:231]
    v_lshlrev_b32 v232, 16, v225
    v_and_b32 v233, 0xffff0000, v225
    v_pk_mul_f32 v[232:233], v[232:233], v[220:221] op_sel_hi:[1,0]
    v_pk_mul_f32 v[236:237], v[232:233], v[232:233]
    v_lshlrev_b32 v2, 16, v226
    v_and_b32 v3, 0xffff0000, v226
    v_pk_mul_f32 v[2:3], v[2:3], v[220:221] op_sel:[0,1] op_sel_hi:[1,1]
    v_pk_add_f32 v[230:231], v[230:231], v[2:3]
    v_pk_fma_f32 v[234:235], v[2:3], v[2:3], v[234:235]
    v_lshlrev_b32 v2, 16, v227
    v_and_b32 v3, 0xffff0000, v227
    v_pk_mul_f32 v[2:3], v[2:3], v[220:221] op_sel:[0,1] op_sel_hi:[1,1]
    v_pk_add_f32 v[232:233], v[232:233], v[2:3]
    v_pk_fma_f32 v[236:237], v[2:3], v[2:3], v[236:237]
    v_lshlrev_b32 v2, 16, v228
    v_and_b32 v3, 0xffff0000, v228
    v_pk_mul_f32 v[2:3], v[2:3], v[222:223] op_sel_hi:[1,0]
    v_pk_add_f32 v[230:231], v[230:231], v[2:3]
    v_pk_fma_f32 v[234:235], v[2:3], v[2:3], v[234:235]
    v_lshlrev_b32 v2, 16, v229
    v_and_b32 v3, 0xffff0000, v229
    v_pk_mul_f32 v[2:3], v[2:3], v[222:223] op_sel_hi:[1,0]
    v_pk_add_f32 v[232:233], v[232:233], v[2:3]
    v_pk_fma_f32 v[236:237], v[2:3], v[2:3], v[236:237]
    v_mfma_f32_16x16x32_bf16 v[52:55], a[56:59], v[116:119], v[52:55]
    buffer_load_dwordx4 a[44:47], v248, s[36:39], s62 offen offset:3072 sc1
    v_mfma_f32_16x16x32_bf16 v[8:11], a[60:63], v[120:123], v[8:11]
    ds_read_b64_tr_b16 v[104:105], v168 offset:24576
    v_permlane32_swap_b32 v230, v234
    v_mfma_f32_16x16x32_bf16 v[12:15], a[64:67], v[120:123], v[12:15]
    ds_read_b64_tr_b16 v[106:107], v168 offset:26624
    v_permlane32_swap_b32 v231, v235
    v_mfma_f32_16x16x32_bf16 v[16:19], a[68:71], v[120:123], v[16:19]
    s_add_u32 s62, s62, 4096
    ds_read_b64_tr_b16 v[108:109], v169 offset:24576
    v_permlane32_swap_b32 v232, v236
    v_mfma_f32_16x16x32_bf16 v[20:23], a[60:63], v[124:127], v[20:23]
    buffer_load_dwordx4 a[48:51], v248, s[36:39], s62 offen offset:0 sc1
    v_mfma_f32_16x16x32_bf16 v[24:27], a[64:67], v[124:127], v[24:27]
    ds_read_b64_tr_b16 v[110:111], v169 offset:26624
    v_permlane32_swap_b32 v233, v237
    v_mfma_f32_16x16x32_bf16 v[28:31], a[68:71], v[124:127], v[28:31]
    s_waitcnt lgkmcnt(6)
    ds_read_b64_tr_b16 v[112:113], v170 offset:24576
    v_add_f32 v230, v230, v234
    v_mfma_f32_16x16x32_bf16 v[32:35], a[60:63], v[128:131], v[32:35]
    ds_read_b64_tr_b16 v[114:115], v170 offset:26624
    v_add_f32 v231, v231, v235
    v_add_f32 v232, v232, v236
    v_mfma_f32_16x16x32_bf16 v[36:39], a[64:67], v[128:131], v[36:39]
    buffer_load_dwordx4 a[52:55], v248, s[36:39], s62 offen offset:1024 sc1
    v_mfma_f32_16x16x32_bf16 v[40:43], a[68:71], v[128:131], v[40:43]
    s_waitcnt lgkmcnt(6)
    ds_read_b64_tr_b16 v[116:117], v171 offset:24576
    v_add_f32 v233, v233, v237
    v_mfma_f32_16x16x32_bf16 v[44:47], a[60:63], v[132:135], v[44:47]
    s_waitcnt lgkmcnt(3)
    ds_read_b64_tr_b16 v[118:119], v171 offset:26624
    v_permlane16_swap_b32 v230, v232
    v_permlane16_swap_b32 v231, v233
    v_mfma_f32_16x16x32_bf16 v[48:51], a[64:67], v[132:135], v[48:51]
    s_waitcnt vmcnt(10)
    s_barrier
    s_cmp_eq_u32 s3, 0
    s_cbranch_scc0 L_wf11
    s_lshl_b32 s54, s76, 7
    s_add_u32 s54, s54, 23288832
    v_mov_b32 v254, 0
    v_mov_b32 v255, s48
    s_mov_b64 exec, 1
    buffer_store_dword v255, v254, s[36:39], s54 offen sc1
    s_mov_b64 exec, -1
L_wf11:
    v_mfma_f32_16x16x32_bf16 v[52:55], a[68:71], v[132:135], v[52:55]
    buffer_load_dwordx4 a[56:59], v248, s[36:39], s62 offen offset:2048 sc1
    v_mfma_f32_16x16x32_bf16 v[8:11], a[72:75], v[104:107], v[8:11]
    ds_read_b64_tr_b16 v[120:121], v168 offset:28672
    v_add_f32 v230, v230, v232
    v_mfma_f32_16x16x32_bf16 v[12:15], a[76:79], v[104:107], v[12:15]
    ds_read_b64_tr_b16 v[122:123], v168 offset:30720
    v_add_f32 v231, v231, v233
    v_mfma_f32_16x16x32_bf16 v[16:19], a[80:83], v[104:107], v[16:19]
    ds_read_b64_tr_b16 v[124:125], v169 offset:28672
    v_lshrrev_b32 v2, 4, v1
    v_mfma_f32_16x16x32_bf16 v[20:23], a[72:75], v[108:111], v[20:23]
    buffer_load_dwordx4 a[60:63], v248, s[36:39], s62 offen offset:3072 sc1
    v_mfma_f32_16x16x32_bf16 v[24:27], a[76:79], v[108:111], v[24:27]
    ds_read_b64_tr_b16 v[126:127], v169 offset:30720
    v_lshlrev_b32 v2, 3, v2
    v_mfma_f32_16x16x32_bf16 v[28:31], a[80:83], v[108:111], v[28:31]
    s_waitcnt lgkmcnt(6)
    s_lshl_b32 s50, s3, 5
    s_add_u32 s50, s50, 0
    ds_read_b64_tr_b16 v[128:129], v170 offset:28672
    v_mfma_f32_16x16x32_bf16 v[32:35], a[72:75], v[112:115], v[32:35]
    s_add_u32 s62, s62, 4096
    ds_read_b64_tr_b16 v[130:131], v170 offset:30720
    v_add_u32 v2, s50, v2
    v_mfma_f32_16x16x32_bf16 v[36:39], a[76:79], v[112:115], v[36:39]
    buffer_load_dwordx4 a[64:67], v248, s[36:39], s62 offen offset:0 sc1
    v_mfma_f32_16x16x32_bf16 v[40:43], a[80:83], v[112:115], v[40:43]
    s_waitcnt lgkmcnt(6)
    ds_read_b64_tr_b16 v[132:133], v171 offset:28672
    v_add_f32_dpp v230, v230, v230 row_ror:8 row_mask:0xf bank_mask:0xf
    v_mfma_f32_16x16x32_bf16 v[44:47], a[72:75], v[116:119], v[44:47]
    s_waitcnt lgkmcnt(3)
    ds_read_b64_tr_b16 v[134:135], v171 offset:30720
    v_add_f32_dpp v231, v231, v231 row_ror:8 row_mask:0xf bank_mask:0xf
    v_mfma_f32_16x16x32_bf16 v[48:51], a[76:79], v[116:119], v[48:51]
    v_add_f32_dpp v230, v230, v230 row_ror:4 row_mask:0xf bank_mask:0xf
    v_add_f32_dpp v231, v231, v231 row_ror:4 row_mask:0xf bank_mask:0xf
    v_mfma_f32_16x16x32_bf16 v[52:55], a[80:83], v[116:119], v[52:55]
    buffer_load_dwordx4 a[68:71], v248, s[36:39], s62 offen offset:1024 sc1
    v_mfma_f32_16x16x32_bf16 v[8:11], a[84:87], v[120:123], v[8:11]
    ds_read_b64_tr_b16 v[104:105], v168 offset:32768
    v_add_f32_dpp v230, v230, v230 row_ror:2 row_mask:0xf bank_mask:0xf
    v_mfma_f32_16x16x32_bf16 v[12:15], a[88:91], v[120:123], v[12:15]
    ds_read_b64_tr_b16 v[106:107], v168 offset:34816
    v_add_f32_dpp v231, v231, v231 row_ror:2 row_mask:0xf bank_mask:0xf
    v_mfma_f32_16x16x32_bf16 v[16:19], a[92:95], v[120:123], v[16:19]
    ds_read_b64_tr_b16 v[108:109], v169 offset:32768
    v_add_f32_dpp v230, v230, v230 row_ror:1 row_mask:0xf bank_mask:0xf
    v_mfma_f32_16x16x32_bf16 v[20:23], a[84:87], v[124:127], v[20:23]
    buffer_load_dwordx4 a[72:75], v248, s[36:39], s62 offen offset:2048 sc1
    v_mfma_f32_16x16x32_bf16 v[24:27], a[88:91], v[124:127], v[24:27]
    ds_read_b64_tr_b16 v[110:111], v169 offset:34816
    v_add_f32_dpp v231, v231, v231 row_ror:1 row_mask:0xf bank_mask:0xf
    v_mfma_f32_16x16x32_bf16 v[28:31], a[92:95], v[124:127], v[28:31]
    ds_read_b64_tr_b16 v[112:113], v170 offset:32768
    s_mov_b32 exec_lo, 0x00010001
    s_mov_b32 exec_hi, 0x00010001
    ds_write_b64 v2, v[230:231]
    s_mov_b64 exec, -1
    s_waitcnt lgkmcnt(8)
    v_mfma_f32_16x16x32_bf16 v[32:35], a[84:87], v[128:131], v[32:35]
    ds_read_b64_tr_b16 v[114:115], v170 offset:34816
    v_lshlrev_b32 v2, 2, v1
    v_mfma_f32_16x16x32_bf16 v[36:39], a[88:91], v[128:131], v[36:39]
    buffer_load_dwordx4 a[76:79], v248, s[36:39], s62 offen offset:3072 sc1
    v_mfma_f32_16x16x32_bf16 v[40:43], a[92:95], v[128:131], v[40:43]
    s_waitcnt lgkmcnt(7)
    ds_read_b64_tr_b16 v[116:117], v171 offset:32768
    v_and_b32 v2, 12, v2
    v_mfma_f32_16x16x32_bf16 v[44:47], a[84:87], v[132:135], v[44:47]
    s_waitcnt lgkmcnt(3)
    ds_read_b64_tr_b16 v[118:119], v171 offset:34816
    v_add_u32 v2, 0, v2
    v_mfma_f32_16x16x32_bf16 v[48:51], a[88:91], v[132:135], v[48:51]
    s_add_u32 s62, s62, 4096
    s_waitcnt lgkmcnt(0)
    s_barrier
    v_mfma_f32_16x16x32_bf16 v[52:55], a[92:95], v[132:135], v[52:55]
    buffer_load_dwordx4 a[80:83], v248, s[36:39], s62 offen offset:0 sc1
    v_mfma_f32_16x16x32_bf16 v[8:11], a[96:99], v[104:107], v[8:11]
    ds_read_b64_tr_b16 v[120:121], v168 offset:36864
    ds_read2_b32 v[230:231], v2 offset0:0 offset1:4
    v_mfma_f32_16x16x32_bf16 v[12:15], a[100:103], v[104:107], v[12:15]
    ds_read_b64_tr_b16 v[122:123], v168 offset:38912
    ds_read2_b32 v[232:233], v2 offset0:8 offset1:12
    v_mfma_f32_16x16x32_bf16 v[16:19], a[104:107], v[104:107], v[16:19]
    ds_read_b64_tr_b16 v[124:125], v169 offset:36864
    ds_read2_b32 v[234:235], v2 offset0:16 offset1:20
    ds_read2_b32 v[236:237], v2 offset0:24 offset1:28
    v_mfma_f32_16x16x32_bf16 v[20:23], a[96:99], v[108:111], v[20:23]
    buffer_load_dwordx4 a[84:87], v248, s[36:39], s62 offen offset:1024 sc1
    v_mfma_f32_16x16x32_bf16 v[24:27], a[100:103], v[108:111], v[24:27]
    ds_read_b64_tr_b16 v[126:127], v169 offset:38912
    v_mov_b32 v225, s48
    v_mfma_f32_16x16x32_bf16 v[28:31], a[104:107], v[108:111], v[28:31]
    ds_read_b64_tr_b16 v[128:129], v170 offset:36864
    v_mov_b32 v227, s48
    v_mfma_f32_16x16x32_bf16 v[32:35], a[96:99], v[112:115], v[32:35]
    s_add_u32 s7, s7, 16384
    ds_read_b64_tr_b16 v[130:131], v170 offset:38912
    s_waitcnt lgkmcnt(6)
    v_add_f32 v230, v230, v232
    v_mfma_f32_16x16x32_bf16 v[36:39], a[100:103], v[112:115], v[36:39]
    buffer_load_dwordx4 a[88:91], v248, s[36:39], s62 offen offset:2048 sc1
    v_mfma_f32_16x16x32_bf16 v[40:43], a[104:107], v[112:115], v[40:43]
    ds_read_b64_tr_b16 v[132:133], v171 offset:36864
    v_add_f32 v231, v231, v233
    v_mfma_f32_16x16x32_bf16 v[44:47], a[96:99], v[116:119], v[44:47]
    s_waitcnt lgkmcnt(3)
    ds_read_b64_tr_b16 v[134:135], v171 offset:38912
    v_add_f32 v234, v234, v236
    v_mfma_f32_16x16x32_bf16 v[48:51], a[100:103], v[116:119], v[48:51]
    v_mfma_f32_16x16x32_bf16 v[52:55], a[104:107], v[116:119], v[52:55]
    buffer_load_dwordx4 a[92:95], v248, s[36:39], s62 offen offset:3072 sc1
    v_mfma_f32_16x16x32_bf16 v[8:11], a[108:111], v[120:123], v[8:11]
    ds_read_b64_tr_b16 v[104:105], v168 offset:40960
    v_add_f32 v235, v235, v237
    v_mfma_f32_16x16x32_bf16 v[12:15], a[112:115], v[120:123], v[12:15]
    ds_read_b64_tr_b16 v[106:107], v168 offset:43008
    v_add_f32 v230, v230, v234
    v_mfma_f32_16x16x32_bf16 v[16:19], a[116:119], v[120:123], v[16:19]
    s_add_u32 s62, s62, 4096
    ds_read_b64_tr_b16 v[108:109], v169 offset:40960
    v_add_f32 v231, v231, v235
    v_mfma_f32_16x16x32_bf16 v[20:23], a[108:111], v[124:127], v[20:23]
    buffer_load_dwordx4 a[96:99], v248, s[36:39], s62 offen offset:0 sc1
    v_mfma_f32_16x16x32_bf16 v[24:27], a[112:115], v[124:127], v[24:27]
    ds_read_b64_tr_b16 v[110:111], v169 offset:43008
    v_mul_f32 v230, 0x3acccccd, v230
    v_mfma_f32_16x16x32_bf16 v[28:31], a[116:119], v[124:127], v[28:31]
    s_waitcnt lgkmcnt(6)
    ds_read_b64_tr_b16 v[112:113], v170 offset:40960
    v_mul_f32 v234, v230, v230
    v_mfma_f32_16x16x32_bf16 v[32:35], a[108:111], v[128:131], v[32:35]
    ds_read_b64_tr_b16 v[114:115], v170 offset:43008
    v_mov_b32 v224, 0x3acccccd
    v_fma_f32 v231, v231, v224, -v234
    v_mfma_f32_16x16x32_bf16 v[36:39], a[112:115], v[128:131], v[36:39]
    buffer_load_dwordx4 a[100:103], v248, s[36:39], s62 offen offset:1024 sc1
    v_mfma_f32_16x16x32_bf16 v[40:43], a[116:119], v[128:131], v[40:43]
    s_waitcnt lgkmcnt(6)
    ds_read_b64_tr_b16 v[116:117], v171 offset:40960
    v_max_f32 v231, 0, v231
    v_mfma_f32_16x16x32_bf16 v[44:47], a[108:111], v[132:135], v[44:47]
    s_waitcnt lgkmcnt(3)
    ds_read_b64_tr_b16 v[118:119], v171 offset:43008
    v_add_f32 v231, 0x3727c5ac, v231
    v_mfma_f32_16x16x32_bf16 v[48:51], a[112:115], v[132:135], v[48:51]
    v_rsq_f32 v224, v231
    v_mfma_f32_16x16x32_bf16 v[52:55], a[116:119], v[132:135], v[52:55]
    buffer_load_dwordx4 a[104:107], v248, s[36:39], s62 offen offset:2048 sc1
    v_mfma_f32_16x16x32_bf16 v[8:11], a[120:123], v[104:107], v[8:11]
    ds_read_b64_tr_b16 v[120:121], v168 offset:45056
    v_mul_f32_e64 v226, -v230, v224
    v_mfma_f32_16x16x32_bf16 v[12:15], a[124:127], v[104:107], v[12:15]
    ds_read_b64_tr_b16 v[122:123], v168 offset:47104
    s_mov_b64 exec, 0xf
    buffer_store_dwordx4 v[224:227], v248, s[36:39], s7 offen sc1
    s_mov_b64 exec, -1
    v_mfma_f32_16x16x32_bf16 v[16:19], a[128:131], v[104:107], v[16:19]
    s_and_b32 s50, s3, 1
    s_lshl_b32 s51, s74, 1
    ds_read_b64_tr_b16 v[124:125], v169 offset:45056
    v_mfma_f32_16x16x32_bf16 v[20:23], a[120:123], v[108:111], v[20:23]
    buffer_load_dwordx4 a[108:111], v248, s[36:39], s62 offen offset:3072 sc1
    v_mfma_f32_16x16x32_bf16 v[24:27], a[124:127], v[108:111], v[24:27]
    s_add_u32 s52, s51, s50
    s_mul_i32 s52, s52, 192
    ds_read_b64_tr_b16 v[126:127], v169 offset:47104
    v_mfma_f32_16x16x32_bf16 v[28:31], a[128:131], v[108:111], v[28:31]
    s_waitcnt lgkmcnt(6)
    s_mul_i32 s53, s3, 48
    s_add_u32 s52, s52, s53
    ds_read_b64_tr_b16 v[128:129], v170 offset:45056
    v_mfma_f32_16x16x32_bf16 v[32:35], a[120:123], v[112:115], v[32:35]
    s_add_u32 s62, s62, 4096
    ds_read_b64_tr_b16 v[130:131], v170 offset:47104
    v_mfma_f32_16x16x32_bf16 v[36:39], a[124:127], v[112:115], v[36:39]
    buffer_load_dwordx4 a[112:115], v248, s[36:39], s62 offen offset:0 sc1
    v_mfma_f32_16x16x32_bf16 v[40:43], a[128:131], v[112:115], v[40:43]
    s_waitcnt lgkmcnt(6)
    s_lshl_b32 s52, s52, 8
    s_add_u32 s52, s52, 16777216
    ds_read_b64_tr_b16 v[132:133], v171 offset:45056
    v_mfma_f32_16x16x32_bf16 v[44:47], a[120:123], v[116:119], v[44:47]
    s_waitcnt lgkmcnt(3)
    ds_read_b64_tr_b16 v[134:135], v171 offset:47104
    v_add_u32 v216, s52, v248
    v_mfma_f32_16x16x32_bf16 v[48:51], a[124:127], v[116:119], v[48:51]
    v_add_u32 v218, 3145728, v216
    v_mfma_f32_16x16x32_bf16 v[52:55], a[128:131], v[116:119], v[52:55]
    buffer_load_dwordx4 a[116:119], v248, s[36:39], s62 offen offset:1024 sc1
    v_mfma_f32_16x16x32_bf16 v[8:11], a[132:135], v[120:123], v[8:11]
    s_xor_b32 s50, s50, 1
    s_add_u32 s52, s51, s50
    ds_read_b64_tr_b16 v[104:105], v168 offset:49152
    v_mfma_f32_16x16x32_bf16 v[12:15], a[136:139], v[120:123], v[12:15]
    s_mul_i32 s52, s52, 192
    s_add_u32 s52, s52, s53
    ds_read_b64_tr_b16 v[106:107], v168 offset:51200
    v_mfma_f32_16x16x32_bf16 v[16:19], a[140:143], v[120:123], v[16:19]
    s_lshl_b32 s52, s52, 8
    s_add_u32 s52, s52, 16777216
    ds_read_b64_tr_b16 v[108:109], v169 offset:49152
    v_mfma_f32_16x16x32_bf16 v[20:23], a[132:135], v[124:127], v[20:23]
    buffer_load_dwordx4 a[120:123], v248, s[36:39], s62 offen offset:2048 sc1
    v_mfma_f32_16x16x32_bf16 v[24:27], a[136:139], v[124:127], v[24:27]
    ds_read_b64_tr_b16 v[110:111], v169 offset:51200
    v_add_u32 v217, s52, v248
    v_mfma_f32_16x16x32_bf16 v[28:31], a[140:143], v[124:127], v[28:31]
    s_waitcnt lgkmcnt(6)
    ds_read_b64_tr_b16 v[112:113], v170 offset:49152
    v_add_u32 v219, 3145728, v217
    v_mfma_f32_16x16x32_bf16 v[32:35], a[132:135], v[128:131], v[32:35]
    s_lshr_b32 s50, s74, 1
    s_lshl_b32 s50, s50, 2
    ds_read_b64_tr_b16 v[114:115], v170 offset:51200
    v_mfma_f32_16x16x32_bf16 v[36:39], a[136:139], v[128:131], v[36:39]
    buffer_load_dwordx4 a[124:127], v248, s[36:39], s62 offen offset:3072 sc1
    v_mfma_f32_16x16x32_bf16 v[40:43], a[140:143], v[128:131], v[40:43]
    s_waitcnt lgkmcnt(6)
    s_add_u32 s50, s50, s3
    s_lshl_b32 s50, s50, 9
    ds_read_b64_tr_b16 v[116:117], v171 offset:49152
    v_mfma_f32_16x16x32_bf16 v[44:47], a[132:135], v[132:135], v[44:47]
    s_waitcnt lgkmcnt(3)
    s_add_u32 s50, s50, 89088
    ds_read_b64_tr_b16 v[118:119], v171 offset:51200
    v_mfma_f32_16x16x32_bf16 v[48:51], a[136:139], v[132:135], v[48:51]
    s_add_u32 s62, s62, 4096
    v_mfma_f32_16x16x32_bf16 v[52:55], a[140:143], v[132:135], v[52:55]
    buffer_load_dwordx4 a[128:131], v248, s[36:39], s62 offen offset:0 sc1
    v_mfma_f32_16x16x32_bf16 v[8:11], a[144:147], v[104:107], v[8:11]
    ds_read_b64_tr_b16 v[120:121], v168 offset:53248
    v_min_u32 v246, 13, v1
    v_mfma_f32_16x16x32_bf16 v[12:15], a[148:151], v[104:107], v[12:15]
    ds_read_b64_tr_b16 v[122:123], v168 offset:55296
    v_lshlrev_b32 v246, 7, v246
    v_mfma_f32_16x16x32_bf16 v[16:19], a[152:155], v[104:107], v[16:19]
    ds_read_b64_tr_b16 v[124:125], v169 offset:53248
    v_mov_b32 v2, s50
    v_mfma_f32_16x16x32_bf16 v[20:23], a[144:147], v[108:111], v[20:23]
    buffer_load_dwordx4 a[132:135], v248, s[36:39], s62 offen offset:1024 sc1
    v_mfma_f32_16x16x32_bf16 v[24:27], a[148:151], v[108:111], v[24:27]
    ds_read_b64_tr_b16 v[126:127], v169 offset:55296
    v_mov_b32 v3, 31488
    v_mfma_f32_16x16x32_bf16 v[28:31], a[152:155], v[108:111], v[28:31]
    ds_read_b64_tr_b16 v[128:129], v170 offset:53248
    v_cmp_lt_u32 vcc, 3, v1
    s_nop 1
    v_cndmask_b32 v2, v2, v3, vcc
    s_waitcnt lgkmcnt(7)
    v_mfma_f32_16x16x32_bf16 v[32:35], a[144:147], v[112:115], v[32:35]
    ds_read_b64_tr_b16 v[130:131], v170 offset:55296
    v_add_u32 v246, v246, v2
    v_mfma_f32_16x16x32_bf16 v[36:39], a[148:151], v[112:115], v[36:39]
    buffer_load_dwordx4 a[136:139], v248, s[36:39], s62 offen offset:2048 sc1
    v_mfma_f32_16x16x32_bf16 v[40:43], a[152:155], v[112:115], v[40:43]
    s_waitcnt lgkmcnt(6)
    ds_read_b64_tr_b16 v[132:133], v171 offset:53248
    v_mfma_f32_16x16x32_bf16 v[44:47], a[144:147], v[116:119], v[44:47]
    s_waitcnt lgkmcnt(3)
    ds_read_b64_tr_b16 v[134:135], v171 offset:55296
    v_mfma_f32_16x16x32_bf16 v[48:51], a[148:151], v[116:119], v[48:51]
    buffer_load_dword v247, v246, s[36:39], s17 offen sc1
    v_mfma_f32_16x16x32_bf16 v[52:55], a[152:155], v[116:119], v[52:55]
    buffer_load_dwordx4 a[140:143], v248, s[36:39], s62 offen offset:3072 sc1
    v_mfma_f32_16x16x32_bf16 v[8:11], a[156:159], v[120:123], v[8:11]
    ds_read_b64_tr_b16 v[104:105], v168 offset:57344
    v_mfma_f32_16x16x32_bf16 v[12:15], a[160:163], v[120:123], v[12:15]
    ds_read_b64_tr_b16 v[106:107], v168 offset:59392
    v_mfma_f32_16x16x32_bf16 v[16:19], a[164:167], v[120:123], v[16:19]
    s_add_u32 s62, s62, 4096
    ds_read_b64_tr_b16 v[108:109], v169 offset:57344
    v_mfma_f32_16x16x32_bf16 v[20:23], a[156:159], v[124:127], v[20:23]
    buffer_load_dwordx4 a[144:147], v248, s[36:39], s62 offen offset:0 sc1
    v_mfma_f32_16x16x32_bf16 v[24:27], a[160:163], v[124:127], v[24:27]
    ds_read_b64_tr_b16 v[110:111], v169 offset:59392
    v_mfma_f32_16x16x32_bf16 v[28:31], a[164:167], v[124:127], v[28:31]
    s_waitcnt lgkmcnt(6)
    ds_read_b64_tr_b16 v[112:113], v170 offset:57344
    v_mfma_f32_16x16x32_bf16 v[32:35], a[156:159], v[128:131], v[32:35]
    ds_read_b64_tr_b16 v[114:115], v170 offset:59392
    v_mfma_f32_16x16x32_bf16 v[36:39], a[160:163], v[128:131], v[36:39]
    buffer_load_dwordx4 a[148:151], v248, s[36:39], s62 offen offset:1024 sc1
    v_mfma_f32_16x16x32_bf16 v[40:43], a[164:167], v[128:131], v[40:43]
    s_waitcnt lgkmcnt(6)
    ds_read_b64_tr_b16 v[116:117], v171 offset:57344
    v_mfma_f32_16x16x32_bf16 v[44:47], a[156:159], v[132:135], v[44:47]
    s_waitcnt lgkmcnt(3)
    ds_read_b64_tr_b16 v[118:119], v171 offset:59392
    v_mfma_f32_16x16x32_bf16 v[48:51], a[160:163], v[132:135], v[48:51]
    v_mfma_f32_16x16x32_bf16 v[52:55], a[164:167], v[132:135], v[52:55]
    buffer_load_dwordx4 a[152:155], v248, s[36:39], s62 offen offset:2048 sc1
    v_mfma_f32_16x16x32_bf16 v[8:11], a[168:171], v[104:107], v[8:11]
    ds_read_b64_tr_b16 v[120:121], v168 offset:61440
    v_mfma_f32_16x16x32_bf16 v[12:15], a[172:175], v[104:107], v[12:15]
    ds_read_b64_tr_b16 v[122:123], v168 offset:63488
    v_add_u32 v168, 65536, v168
    v_mfma_f32_16x16x32_bf16 v[16:19], a[176:179], v[104:107], v[16:19]
    ds_read_b64_tr_b16 v[124:125], v169 offset:61440
    v_mfma_f32_16x16x32_bf16 v[20:23], a[168:171], v[108:111], v[20:23]
    buffer_load_dwordx4 a[156:159], v248, s[36:39], s62 offen offset:3072 sc1
    v_mfma_f32_16x16x32_bf16 v[24:27], a[172:175], v[108:111], v[24:27]
    ds_read_b64_tr_b16 v[126:127], v169 offset:63488
    v_add_u32 v169, 65536, v169
    v_mfma_f32_16x16x32_bf16 v[28:31], a[176:179], v[108:111], v[28:31]
    s_waitcnt lgkmcnt(6)
    ds_read_b64_tr_b16 v[128:129], v170 offset:61440
    v_mfma_f32_16x16x32_bf16 v[32:35], a[168:171], v[112:115], v[32:35]
    s_add_u32 m0, s63, 1024
    ds_read_b64_tr_b16 v[130:131], v170 offset:63488
    v_add_u32 v170, 65536, v170
    v_mfma_f32_16x16x32_bf16 v[36:39], a[172:175], v[112:115], v[36:39]
    buffer_load_dwordx4 v248, s[36:39], s6 offen sc1 lds
    v_mfma_f32_16x16x32_bf16 v[40:43], a[176:179], v[112:115], v[40:43]
    s_waitcnt lgkmcnt(6)
    ds_read_b64_tr_b16 v[132:133], v171 offset:61440
    v_mfma_f32_16x16x32_bf16 v[44:47], a[168:171], v[116:119], v[44:47]
    s_waitcnt lgkmcnt(3)
    ds_read_b64_tr_b16 v[134:135], v171 offset:63488
    v_add_u32 v171, 65536, v171
    v_mfma_f32_16x16x32_bf16 v[48:51], a[172:175], v[116:119], v[48:51]
    s_add_u32 s62, s62, 4096
    v_mfma_f32_16x16x32_bf16 v[52:55], a[176:179], v[116:119], v[52:55]
    buffer_load_dwordx4 a[160:163], v248, s[36:39], s62 offen offset:0 sc1
    v_mfma_f32_16x16x32_bf16 v[8:11], a[180:183], v[120:123], v[8:11]
    ds_read_b64_tr_b16 v[104:105], v168 offset:0
    v_mfma_f32_16x16x32_bf16 v[12:15], a[184:187], v[120:123], v[12:15]
    ds_read_b64_tr_b16 v[106:107], v168 offset:2048
    v_mfma_f32_16x16x32_bf16 v[16:19], a[188:191], v[120:123], v[16:19]
    ds_read_b64_tr_b16 v[108:109], v169 offset:0
    v_mfma_f32_16x16x32_bf16 v[20:23], a[180:183], v[124:127], v[20:23]
    buffer_load_dwordx4 a[164:167], v248, s[36:39], s62 offen offset:1024 sc1
    v_mfma_f32_16x16x32_bf16 v[24:27], a[184:187], v[124:127], v[24:27]
    ds_read_b64_tr_b16 v[110:111], v169 offset:2048
    v_mfma_f32_16x16x32_bf16 v[28:31], a[188:191], v[124:127], v[28:31]
    s_waitcnt lgkmcnt(6)
    ds_read_b64_tr_b16 v[112:113], v170 offset:0
    v_mfma_f32_16x16x32_bf16 v[32:35], a[180:183], v[128:131], v[32:35]
    ds_read_b64_tr_b16 v[114:115], v170 offset:2048
    v_mfma_f32_16x16x32_bf16 v[36:39], a[184:187], v[128:131], v[36:39]
    buffer_load_dwordx4 a[168:171], v248, s[36:39], s62 offen offset:2048 sc1
    v_mfma_f32_16x16x32_bf16 v[40:43], a[188:191], v[128:131], v[40:43]
    s_waitcnt lgkmcnt(6)
    ds_read_b64_tr_b16 v[116:117], v171 offset:0
    v_mfma_f32_16x16x32_bf16 v[44:47], a[180:183], v[132:135], v[44:47]
    s_waitcnt lgkmcnt(3)
    ds_read_b64_tr_b16 v[118:119], v171 offset:2048
    v_mfma_f32_16x16x32_bf16 v[48:51], a[184:187], v[132:135], v[48:51]
    s_waitcnt vmcnt(9)
    v_cmp_ne_u32 vcc, s48, v247
    s_cbranch_vccnz L_chk12_slow
L_chk12_back:
    v_mfma_f32_16x16x32_bf16 v[52:55], a[188:191], v[132:135], v[52:55]
    buffer_load_dwordx4 v[56:59], v216, s[36:39], 0 offen offset:0 sc1
    v_mfma_f32_16x16x32_bf16 v[8:11], a[192:195], v[104:107], v[8:11]
    ds_read_b64_tr_b16 v[120:121], v168 offset:4096
    v_mfma_f32_16x16x32_bf16 v[12:15], a[196:199], v[104:107], v[12:15]
    ds_read_b64_tr_b16 v[122:123], v168 offset:6144
    v_mfma_f32_16x16x32_bf16 v[16:19], a[200:203], v[104:107], v[16:19]
    ds_read_b64_tr_b16 v[124:125], v169 offset:4096
    v_mfma_f32_16x16x32_bf16 v[20:23], a[192:195], v[108:111], v[20:23]
    buffer_load_dwordx4 v[60:63], v217, s[36:39], 0 offen offset:0 sc1
    v_mfma_f32_16x16x32_bf16 v[24:27], a[196:199], v[108:111], v[24:27]
    ds_read_b64_tr_b16 v[126:127], v169 offset:6144
    v_mfma_f32_16x16x32_bf16 v[28:31], a[200:203], v[108:111], v[28:31]
    s_waitcnt lgkmcnt(6)
    ds_read_b64_tr_b16 v[128:129], v170 offset:4096
    v_mfma_f32_16x16x32_bf16 v[32:35], a[192:195], v[112:115], v[32:35]
    ds_read_b64_tr_b16 v[130:131], v170 offset:6144
    v_mfma_f32_16x16x32_bf16 v[36:39], a[196:199], v[112:115], v[36:39]
    buffer_load_dwordx4 v[64:67], v216, s[36:39], 0 offen offset:1024 sc1
    v_mfma_f32_16x16x32_bf16 v[40:43], a[200:203], v[112:115], v[40:43]
    s_waitcnt lgkmcnt(6)
    ds_read_b64_tr_b16 v[132:133], v171 offset:4096
    v_mfma_f32_16x16x32_bf16 v[44:47], a[192:195], v[116:119], v[44:47]
    s_waitcnt lgkmcnt(3)
    ds_read_b64_tr_b16 v[134:135], v171 offset:6144
    v_mfma_f32_16x16x32_bf16 v[48:51], a[196:199], v[116:119], v[48:51]
    v_mfma_f32_16x16x32_bf16 v[52:55], a[200:203], v[116:119], v[52:55]
    buffer_load_dwordx4 v[68:71], v217, s[36:39], 0 offen offset:1024 sc1
    v_mfma_f32_16x16x32_bf16 v[8:11], a[204:207], v[120:123], v[8:11]
    ds_read_b64_tr_b16 v[104:105], v168 offset:8192
    v_mfma_f32_16x16x32_bf16 v[12:15], a[208:211], v[120:123], v[12:15]
    ds_read_b64_tr_b16 v[106:107], v168 offset:10240
    v_mfma_f32_16x16x32_bf16 v[16:19], a[212:215], v[120:123], v[16:19]
    ds_read_b64_tr_b16 v[108:109], v169 offset:8192
    v_mfma_f32_16x16x32_bf16 v[20:23], a[204:207], v[124:127], v[20:23]
    buffer_load_dwordx4 v[72:75], v216, s[36:39], 0 offen offset:2048 sc1
    v_mfma_f32_16x16x32_bf16 v[24:27], a[208:211], v[124:127], v[24:27]
    ds_read_b64_tr_b16 v[110:111], v169 offset:10240
    v_mfma_f32_16x16x32_bf16 v[28:31], a[212:215], v[124:127], v[28:31]
    s_waitcnt lgkmcnt(6)
    ds_read_b64_tr_b16 v[112:113], v170 offset:8192
    v_mfma_f32_16x16x32_bf16 v[32:35], a[204:207], v[128:131], v[32:35]
    ds_read_b64_tr_b16 v[114:115], v170 offset:10240
    v_mfma_f32_16x16x32_bf16 v[36:39], a[208:211], v[128:131], v[36:39]
    buffer_load_dwordx4 a[172:175], v248, s[36:39], s62 offen offset:3072 sc1
    v_mfma_f32_16x16x32_bf16 v[40:43], a[212:215], v[128:131], v[40:43]
    s_waitcnt lgkmcnt(6)
    ds_read_b64_tr_b16 v[116:117], v171 offset:8192
    v_mfma_f32_16x16x32_bf16 v[44:47], a[204:207], v[132:135], v[44:47]
    s_waitcnt lgkmcnt(3)
    ds_read_b64_tr_b16 v[118:119], v171 offset:10240
    v_mfma_f32_16x16x32_bf16 v[48:51], a[208:211], v[132:135], v[48:51]
    v_mfma_f32_16x16x32_bf16 v[52:55], a[212:215], v[132:135], v[52:55]
    buffer_load_dwordx4 v[76:79], v217, s[36:39], 0 offen offset:2048 sc1
    v_mfma_f32_16x16x32_bf16 v[8:11], a[216:219], v[104:107], v[8:11]
    ds_read_b64_tr_b16 v[120:121], v168 offset:12288
    v_mfma_f32_16x16x32_bf16 v[12:15], a[220:223], v[104:107], v[12:15]
    ds_read_b64_tr_b16 v[122:123], v168 offset:14336
    v_mfma_f32_16x16x32_bf16 v[16:19], a[224:227], v[104:107], v[16:19]
    s_add_u32 s62, s62, 4096
    ds_read_b64_tr_b16 v[124:125], v169 offset:12288
    v_mfma_f32_16x16x32_bf16 v[20:23], a[216:219], v[108:111], v[20:23]
    buffer_load_dwordx4 a[176:179], v248, s[36:39], s62 offen offset:0 sc1
    v_mfma_f32_16x16x32_bf16 v[24:27], a[220:223], v[108:111], v[24:27]
    ds_read_b64_tr_b16 v[126:127], v169 offset:14336
    v_mfma_f32_16x16x32_bf16 v[28:31], a[224:227], v[108:111], v[28:31]
    s_waitcnt lgkmcnt(6)
    ds_read_b64_tr_b16 v[128:129], v170 offset:12288
    v_mfma_f32_16x16x32_bf16 v[32:35], a[216:219], v[112:115], v[32:35]
    s_waitcnt vmcnt(11)
    ds_read_b64_tr_b16 v[130:131], v170 offset:14336
    ds_read_b128 v[200:203], v175 offset:1024
    v_mfma_f32_16x16x32_bf16 v[36:39], a[220:223], v[112:115], v[36:39]
    buffer_load_dwordx4 a[180:183], v248, s[36:39], s62 offen offset:1024 sc1
    v_mfma_f32_16x16x32_bf16 v[40:43], a[224:227], v[112:115], v[40:43]
    s_waitcnt lgkmcnt(7)
    ds_read_b64_tr_b16 v[132:133], v171 offset:12288
    ds_read_b128 v[204:207], v175 offset:1280
    v_mfma_f32_16x16x32_bf16 v[44:47], a[216:219], v[116:119], v[44:47]
    s_waitcnt lgkmcnt(3)
    ds_read_b64_tr_b16 v[134:135], v171 offset:14336
    v_mfma_f32_16x16x32_bf16 v[48:51], a[220:223], v[116:119], v[48:51]
    ds_read_b128 v[208:211], v175 offset:1536
    ds_read_b128 v[212:215], v175 offset:1792
    v_mfma_f32_16x16x32_bf16 v[52:55], a[224:227], v[116:119], v[52:55]
    buffer_load_dwordx4 a[184:187], v248, s[36:39], s62 offen offset:2048 sc1
    v_mfma_f32_16x16x32_bf16 v[8:11], a[228:231], v[120:123], v[8:11]
    v_mfma_f32_16x16x32_bf16 v[12:15], a[232:235], v[120:123], v[12:15]
    s_waitcnt lgkmcnt(5)
    v_xor_b32 v3, s48, v201
    v_bitop3_b32 v3, v203, s48, v3 bitop3:0xbe
    v_mfma_f32_16x16x32_bf16 v[16:19], a[236:239], v[120:123], v[16:19]
    s_waitcnt lgkmcnt(3)
    v_bitop3_b32 v3, v205, s48, v3 bitop3:0xbe
    v_bitop3_b32 v3, v207, s48, v3 bitop3:0xbe
    v_mfma_f32_16x16x32_bf16 v[20:23], a[228:231], v[124:127], v[20:23]
    buffer_load_dwordx4 a[188:191], v248, s[36:39], s62 offen offset:3072 sc1
    v_mfma_f32_16x16x32_bf16 v[24:27], a[232:235], v[124:127], v[24:27]
    s_waitcnt lgkmcnt(1)
    v_bitop3_b32 v3, v209, s48, v3 bitop3:0xbe
    v_bitop3_b32 v3, v211, s48, v3 bitop3:0xbe
    v_mfma_f32_16x16x32_bf16 v[28:31], a[236:239], v[124:127], v[28:31]
    s_waitcnt lgkmcnt(0)
    v_bitop3_b32 v3, v213, s48, v3 bitop3:0xbe
    v_bitop3_b32 v3, v215, s48, v3 bitop3:0xbe
    v_mfma_f32_16x16x32_bf16 v[32:35], a[228:231], v[128:131], v[32:35]
    v_cmp_ne_u32 vcc, 0, v3
    s_cbranch_vccnz L_stc1_slow
L_stc1_back:
    v_mfma_f32_16x16x32_bf16 v[36:39], a[232:235], v[128:131], v[36:39]
    buffer_load_dwordx4 v[80:83], v216, s[36:39], 0 offen offset:3072 sc1
    v_mfma_f32_16x16x32_bf16 v[40:43], a[236:239], v[128:131], v[40:43]
    v_mfma_f32_16x16x32_bf16 v[44:47], a[228:231], v[132:135], v[44:47]
    v_mfma_f32_16x16x32_bf16 v[48:51], a[232:235], v[132:135], v[48:51]
    v_mfma_f32_16x16x32_bf16 v[52:55], a[236:239], v[132:135], v[52:55]
    s_add_u32 s8, s8, 3145728
    s_add_u32 s50, s8, 98304
    v_pk_fma_f32 v[238:239], v[176:177], v[202:203], v[188:189] op_sel_hi:[1,0,1]
    v_pk_fma_f32 v[240:241], v[178:179], v[202:203], v[190:191] op_sel_hi:[1,0,1]
    v_pk_fma_f32 v[8:9], v[8:9], v[200:201], v[238:239] op_sel_hi:[1,0,1]
    v_pk_fma_f32 v[10:11], v[10:11], v[200:201], v[240:241] op_sel_hi:[1,0,1]
    v_pk_fma_f32 v[242:243], v[180:181], v[202:203], v[192:193] op_sel_hi:[1,0,1]
    v_pk_fma_f32 v[244:245], v[182:183], v[202:203], v[194:195] op_sel_hi:[1,0,1]
    v_pk_fma_f32 v[12:13], v[12:13], v[200:201], v[242:243] op_sel_hi:[1,0,1]
    v_pk_fma_f32 v[14:15], v[14:15], v[200:201], v[244:245] op_sel_hi:[1,0,1]
    v_pk_mul_f32 v[8:9], v[8:9], v[12:13]
    v_pk_mul_f32 v[10:11], v[10:11], v[14:15]
    v_cvt_pk_bf16_f32 v12, v8, v9
    v_cvt_pk_bf16_f32 v13, v10, v11
    v_pk_fma_f32 v[242:243], v[176:177], v[206:207], v[188:189] op_sel_hi:[1,0,1]
    v_pk_fma_f32 v[244:245], v[178:179], v[206:207], v[190:191] op_sel_hi:[1,0,1]
    v_pk_fma_f32 v[20:21], v[20:21], v[204:205], v[242:243] op_sel_hi:[1,0,1]
    v_pk_fma_f32 v[22:23], v[22:23], v[204:205], v[244:245] op_sel_hi:[1,0,1]
    v_pk_fma_f32 v[238:239], v[180:181], v[206:207], v[192:193] op_sel_hi:[1,0,1]
    v_pk_fma_f32 v[240:241], v[182:183], v[206:207], v[194:195] op_sel_hi:[1,0,1]
    v_pk_fma_f32 v[24:25], v[24:25], v[204:205], v[238:239] op_sel_hi:[1,0,1]
    v_pk_fma_f32 v[26:27], v[26:27], v[204:205], v[240:241] op_sel_hi:[1,0,1]
    v_pk_mul_f32 v[20:21], v[20:21], v[24:25]
    v_pk_mul_f32 v[22:23], v[22:23], v[26:27]
    v_cvt_pk_bf16_f32 v14, v20, v21
    v_cvt_pk_bf16_f32 v15, v22, v23
    s_nop 0
    v_permlane16_swap_b32 v12, v14
    v_permlane16_swap_b32 v13, v15
    buffer_store_dwordx4 v[12:15], v173, s[36:39], s8 offen sc1
    v_pk_fma_f32 v[238:239], v[176:177], v[210:211], v[188:189] op_sel_hi:[1,0,1]
    v_pk_fma_f32 v[240:241], v[178:179], v[210:211], v[190:191] op_sel_hi:[1,0,1]
    v_pk_fma_f32 v[32:33], v[32:33], v[208:209], v[238:239] op_sel_hi:[1,0,1]
    v_pk_fma_f32 v[34:35], v[34:35], v[208:209], v[240:241] op_sel_hi:[1,0,1]
    v_pk_fma_f32 v[242:243], v[180:181], v[210:211], v[192:193] op_sel_hi:[1,0,1]
    v_pk_fma_f32 v[244:245], v[182:183], v[210:211], v[194:195] op_sel_hi:[1,0,1]
    v_pk_fma_f32 v[36:37], v[36:37], v[208:209], v[242:243] op_sel_hi:[1,0,1]
    v_pk_fma_f32 v[38:39], v[38:39], v[208:209], v[244:245] op_sel_hi:[1,0,1]
    v_pk_mul_f32 v[32:33], v[32:33], v[36:37]
    v_pk_mul_f32 v[34:35], v[34:35], v[38:39]
    v_cvt_pk_bf16_f32 v36, v32, v33
    v_cvt_pk_bf16_f32 v37, v34, v35
    v_pk_fma_f32 v[242:243], v[176:177], v[214:215], v[188:189] op_sel_hi:[1,0,1]
    v_pk_fma_f32 v[244:245], v[178:179], v[214:215], v[190:191] op_sel_hi:[1,0,1]
    v_pk_fma_f32 v[44:45], v[44:45], v[212:213], v[242:243] op_sel_hi:[1,0,1]
    v_pk_fma_f32 v[46:47], v[46:47], v[212:213], v[244:245] op_sel_hi:[1,0,1]
    v_pk_fma_f32 v[238:239], v[180:181], v[214:215], v[192:193] op_sel_hi:[1,0,1]
    v_pk_fma_f32 v[240:241], v[182:183], v[214:215], v[194:195] op_sel_hi:[1,0,1]
    v_pk_fma_f32 v[48:49], v[48:49], v[212:213], v[238:239] op_sel_hi:[1,0,1]
    v_pk_fma_f32 v[50:51], v[50:51], v[212:213], v[240:241] op_sel_hi:[1,0,1]
    v_pk_mul_f32 v[44:45], v[44:45], v[48:49]
    v_pk_mul_f32 v[46:47], v[46:47], v[50:51]
    v_cvt_pk_bf16_f32 v38, v44, v45
    v_cvt_pk_bf16_f32 v39, v46, v47
    s_nop 0
    v_permlane16_swap_b32 v36, v38
    v_permlane16_swap_b32 v37, v39
    buffer_store_dwordx4 v[36:39], v173, s[36:39], s50 offen sc1
    v_pk_fma_f32 v[238:239], v[184:185], v[202:203], v[196:197] op_sel_hi:[1,0,1]
    v_pk_fma_f32 v[240:241], v[186:187], v[202:203], v[198:199] op_sel_hi:[1,0,1]
    v_pk_fma_f32 v[16:17], v[16:17], v[200:201], v[238:239] op_sel_hi:[1,0,1]
    v_pk_fma_f32 v[18:19], v[18:19], v[200:201], v[240:241] op_sel_hi:[1,0,1]
    v_pk_fma_f32 v[242:243], v[184:185], v[206:207], v[196:197] op_sel_hi:[1,0,1]
    v_pk_fma_f32 v[244:245], v[186:187], v[206:207], v[198:199] op_sel_hi:[1,0,1]
    v_pk_fma_f32 v[28:29], v[28:29], v[204:205], v[242:243] op_sel_hi:[1,0,1]
    v_pk_fma_f32 v[30:31], v[30:31], v[204:205], v[244:245] op_sel_hi:[1,0,1]
    s_nop 0
    v_permlane32_swap_b32 v16, v28
    v_permlane32_swap_b32 v17, v29
    v_permlane32_swap_b32 v18, v30
    v_permlane32_swap_b32 v19, v31
    v_pk_mul_f32 v[16:17], v[16:17], v[28:29]
    v_pk_mul_f32 v[18:19], v[18:19], v[30:31]
    v_cvt_pk_bf16_f32 v8, v16, v17
    v_cvt_pk_bf16_f32 v9, v18, v19
    v_pk_fma_f32 v[238:239], v[184:185], v[210:211], v[196:197] op_sel_hi:[1,0,1]
    v_pk_fma_f32 v[240:241], v[186:187], v[210:211], v[198:199] op_sel_hi:[1,0,1]
    v_pk_fma_f32 v[40:41], v[40:41], v[208:209], v[238:239] op_sel_hi:[1,0,1]
    v_pk_fma_f32 v[42:43], v[42:43], v[208:209], v[240:241] op_sel_hi:[1,0,1]
    v_pk_fma_f32 v[242:243], v[184:185], v[214:215], v[196:197] op_sel_hi:[1,0,1]
    v_pk_fma_f32 v[244:245], v[186:187], v[214:215], v[198:199] op_sel_hi:[1,0,1]
    v_pk_fma_f32 v[52:53], v[52:53], v[212:213], v[242:243] op_sel_hi:[1,0,1]
    v_pk_fma_f32 v[54:55], v[54:55], v[212:213], v[244:245] op_sel_hi:[1,0,1]
    s_nop 0
    v_permlane32_swap_b32 v40, v52
    v_permlane32_swap_b32 v41, v53
    v_permlane32_swap_b32 v42, v54
    v_permlane32_swap_b32 v43, v55
    v_pk_mul_f32 v[40:41], v[40:41], v[52:53]
    v_pk_mul_f32 v[42:43], v[42:43], v[54:55]
    v_cvt_pk_bf16_f32 v10, v40, v41
    v_cvt_pk_bf16_f32 v11, v42, v43
    s_nop 0
    v_permlane16_swap_b32 v8, v10
    v_permlane16_swap_b32 v9, v11
    buffer_store_dwordx4 v[8:11], v174, s[36:39], s8 offen offset:512 sc1
    buffer_load_dwordx4 v[84:87], v217, s[36:39], 0 offen offset:3072 sc1
    buffer_load_dwordx4 v[88:91], v216, s[36:39], s4 offen offset:0 sc1
    buffer_load_dwordx4 v[92:95], v217, s[36:39], s4 offen offset:0 sc1
    buffer_load_dwordx4 v[96:99], v216, s[36:39], s4 offen offset:1024 sc1
    buffer_load_dwordx4 v[100:103], v217, s[36:39], s4 offen offset:1024 sc1
    s_mov_b32 s40, s28
    s_mov_b32 s41, s29
    s_mov_b32 s42, 0x280000
    s_mov_b32 s43, 0x20000
    s_waitcnt vmcnt(19)
    v_mfma_f32_16x16x32_bf16 v[8:11], a[240:243], v[56:59], 0
    s_and_b32 s50, s3, 1
    s_lshr_b32 s51, s3, 1
    v_mfma_f32_16x16x32_bf16 v[12:15], a[244:247], v[56:59], 0
    s_mul_i32 s52, s50, 20480
    s_mul_i32 s53, s3, 5120
    s_add_u32 s52, s52, s53
    v_mfma_f32_16x16x32_bf16 v[16:19], a[248:251], v[56:59], 0
    v_add_u32 v220, s52, v248
    v_add_u32 v222, 40960, v220
    v_mfma_f32_16x16x32_bf16 v[20:23], a[252:255], v[56:59], 0
    s_xor_b32 s52, s50, 1
    s_mul_i32 s52, s52, 20480
    s_add_u32 s52, s52, s53
    v_mfma_f32_16x16x32_bf16 v[24:27], v[136:139], v[56:59], 0
    s_waitcnt vmcnt(18)
    v_add_u32 v221, s52, v248
    v_add_u32 v223, 40960, v221
    v_mfma_f32_16x16x32_bf16 v[28:31], a[240:243], v[60:63], 0
    s_mul_i32 s52, s51, 20480
    s_lshl_b32 s53, s50, 11
    buffer_load_dwordx4 v[56:59], v216, s[36:39], s4 offen offset:2048 sc1
    v_mfma_f32_16x16x32_bf16 v[32:35], a[244:247], v[60:63], 0
    s_add_u32 s52, s52, s53
    v_add_u32 v224, s52, v248
    v_mfma_f32_16x16x32_bf16 v[36:39], a[248:251], v[60:63], 0
    s_mul_i32 s53, s51, 5120
    s_add_u32 s53, s53, 40960
    v_add_u32 v225, s53, v224
    v_mfma_f32_16x16x32_bf16 v[40:43], a[252:255], v[60:63], 0
    s_xor_b32 s53, s51, 1
    s_mul_i32 s53, s53, 5120
    s_add_u32 s53, s53, 40960
    v_mfma_f32_16x16x32_bf16 v[44:47], v[136:139], v[60:63], 0
    s_waitcnt vmcnt(18)
    v_add_u32 v226, s53, v224
    v_mfma_f32_16x16x32_bf16 v[8:11], v[140:143], v[64:67], v[8:11]
    s_lshl_b32 s52, s74, 1
    s_add_u32 s52, s52, s51
    s_mul_i32 s12, s75, 320
    buffer_load_dwordx4 v[60:63], v217, s[36:39], s4 offen offset:2048 sc1
    v_mfma_f32_16x16x32_bf16 v[12:15], v[144:147], v[64:67], v[12:15]
    s_add_u32 s12, s12, 23147008
    s_mul_i32 s13, s52, 20480
    s_mul_i32 s53, s75, 160
    s_add_u32 s13, s13, s53
    v_mfma_f32_16x16x32_bf16 v[16:19], v[148:151], v[64:67], v[16:19]
    s_lshl_b32 s53, s50, 6
    s_add_u32 s13, s13, s53
    s_add_u32 s14, s13, 1310720
    v_mfma_f32_16x16x32_bf16 v[20:23], v[152:155], v[64:67], v[20:23]
    s_mul_i32 s10, s75, 10
    s_add_u32 s10, s10, s3
    v_mfma_f32_16x16x32_bf16 v[24:27], v[156:159], v[64:67], v[24:27]
    s_mul_i32 s10, s10, 32768
    s_lshl_b32 s53, s74, 6
    s_add_u32 s10, s10, s53
    s_add_u32 s10, s10, 0
    s_waitcnt vmcnt(18)
    v_mfma_f32_16x16x32_bf16 v[28:31], v[140:143], v[68:71], v[28:31]
    s_lshl_b32 s11, s3, 10
    s_add_u32 s11, s11, 81920
    v_lshrrev_b32 v2, 3, v1
    buffer_load_dwordx4 v[64:67], v216, s[36:39], s4 offen offset:3072 sc1
    v_mfma_f32_16x16x32_bf16 v[32:35], v[144:147], v[68:71], v[32:35]
    v_mul_u32_u24 v229, 4096, v2
    v_bfe_u32 v2, v1, 2, 1
    v_mfma_f32_16x16x32_bf16 v[36:39], v[148:151], v[68:71], v[36:39]
    v_lshl_add_u32 v229, v2, 11, v229
    v_and_b32 v2, 3, v1
    v_mfma_f32_16x16x32_bf16 v[40:43], v[152:155], v[68:71], v[40:43]
    v_lshl_add_u32 v229, v2, 4, v229
    v_lshrrev_b32 v3, 2, v1
    v_mfma_f32_16x16x32_bf16 v[44:47], v[156:159], v[68:71], v[44:47]
    s_waitcnt vmcnt(18)
    v_lshlrev_b32 v231, 7, v3
    v_lshl_add_u32 v231, v2, 3, v231
    v_mfma_f32_16x16x32_bf16 v[8:11], v[160:163], v[72:75], v[8:11]
    s_barrier
    s_lshl_b32 s53, s50, 12
    s_lshl_b32 s52, s51, 5
    buffer_load_dwordx4 v[68:71], v217, s[36:39], s4 offen offset:3072 sc1
    v_mfma_f32_16x16x32_bf16 v[12:15], v[164:167], v[72:75], v[12:15]
    s_add_u32 s53, s53, s52
    s_add_u32 s53, s53, 81920
    v_add_u32 v231, s53, v231
    v_mfma_f32_16x16x32_bf16 v[16:19], a[0:3], v[72:75], v[16:19]
    v_and_b32 v2, 15, v1
    v_lshrrev_b32 v3, 4, v1
    v_mfma_f32_16x16x32_bf16 v[20:23], a[4:7], v[72:75], v[20:23]
    v_mul_u32_u24 v2, 1280, v2
    v_lshl_add_u32 v228, v3, 3, v2
    v_mfma_f32_16x16x32_bf16 v[24:27], a[8:11], v[72:75], v[24:27]
    s_waitcnt vmcnt(17)
    v_and_b32 v227, 1, v3
    v_lshl_add_u32 v2, v227, 5, v2
    v_lshrrev_b32 v3, 1, v3
    v_mfma_f32_16x16x32_bf16 v[28:31], v[160:163], v[76:79], v[28:31]
    buffer_load_dwordx4 v[72:75], v216, s[36:39], s5 offen offset:0 sc1
    v_mfma_f32_16x16x32_bf16 v[32:35], v[164:167], v[76:79], v[32:35]
    v_lshl_add_u32 v227, v3, 4, v2
    v_mfma_f32_16x16x32_bf16 v[36:39], a[0:3], v[76:79], v[36:39]
    s_lshr_b32 s50, s74, 1
    s_lshl_b32 s50, s50, 2
    s_add_u32 s50, s50, s3
    s_lshl_b32 s50, s50, 9
    v_mfma_f32_16x16x32_bf16 v[40:43], a[4:7], v[76:79], v[40:43]
    s_add_u32 s50, s50, 121856
    v_min_u32 v246, 3, v1
    v_lshlrev_b32 v246, 7, v246
    v_mfma_f32_16x16x32_bf16 v[44:47], a[8:11], v[76:79], v[44:47]
    s_waitcnt vmcnt(13)
    v_add_u32 v246, s50, v246
    v_min_u32 v2, 23, v1
    v_mfma_f32_16x16x32_bf16 v[8:11], a[12:15], v[80:83], v[8:11]
    buffer_load_dwordx4 v[76:79], v217, s[36:39], s5 offen offset:0 sc1
    v_mfma_f32_16x16x32_bf16 v[12:15], a[16:19], v[80:83], v[12:15]
    v_lshlrev_b32 v244, 4, v2
    v_mov_b32 v3, 36160
    v_mfma_f32_16x16x32_bf16 v[16:19], a[20:23], v[80:83], v[16:19]
    v_cmp_lt_u32 vcc, 11, v2
    s_nop 1
    v_cndmask_b32 v3, 0, v3, vcc
    v_mfma_f32_16x16x32_bf16 v[20:23], a[24:27], v[80:83], v[20:23]
    s_and_b32 s53, s3, 1
    s_lshl_b32 s53, s53, 7
    v_add3_u32 v244, v244, v3, s53
    v_mfma_f32_16x16x32_bf16 v[24:27], a[28:31], v[80:83], v[24:27]
    s_lshl_b32 s15, s3, 10
    s_add_u32 s15, s15, 94208
    v_and_b32 v230, 48, v1
    v_add_u32 v230, s15, v230
    s_waitcnt vmcnt(10)
    v_mfma_f32_16x16x32_bf16 v[28:31], a[12:15], v[84:87], v[28:31]
    s_mov_b32 m0, s15
    buffer_load_dwordx4 v[80:83], v216, s[36:39], s5 offen offset:1024 sc1
    v_mfma_f32_16x16x32_bf16 v[32:35], a[16:19], v[84:87], v[32:35]
    buffer_load_dwordx4 v244, s[36:39], s12 offen sc1 lds
    v_mfma_f32_16x16x32_bf16 v[36:39], a[20:23], v[84:87], v[36:39]
    s_add_u32 m0, s11, 0
    v_mfma_f32_16x16x32_bf16 v[40:43], a[24:27], v[84:87], v[40:43]
    buffer_load_dwordx4 v229, s[36:39], s10 offen sc1 lds
    v_mfma_f32_16x16x32_bf16 v[44:47], a[28:31], v[84:87], v[44:47]
    s_waitcnt vmcnt(12)
    s_add_u32 s10, s10, 131072
    v_mfma_f32_16x16x32_bf16 v[8:11], a[32:35], v[88:91], v[8:11]
    s_barrier
    s_cmp_eq_u32 s3, 0
    s_cbranch_scc0 L_wf13
    s_lshl_b32 s54, s76, 7
    s_add_u32 s54, s54, 23321600
    v_mov_b32 v254, 0
    v_mov_b32 v255, s48
    s_mov_b64 exec, 1
    buffer_store_dword v255, v254, s[36:39], s54 offen sc1
    s_mov_b64 exec, -1
L_wf13:
    s_add_u32 m0, s11, 4096
    v_mfma_f32_16x16x32_bf16 v[12:15], a[36:39], v[88:91], v[12:15]
    buffer_load_dwordx4 v229, s[36:39], s10 offen sc1 lds
    v_mfma_f32_16x16x32_bf16 v[16:19], a[40:43], v[88:91], v[16:19]
    s_add_u32 s10, s10, 131072
    v_mfma_f32_16x16x32_bf16 v[20:23], a[44:47], v[88:91], v[20:23]
    s_add_u32 m0, s11, 8192
    v_mfma_f32_16x16x32_bf16 v[24:27], a[48:51], v[88:91], v[24:27]
    s_waitcnt vmcnt(12)
    buffer_load_dwordx4 v229, s[36:39], s10 offen sc1 lds
    v_mfma_f32_16x16x32_bf16 v[28:31], a[32:35], v[92:95], v[28:31]
    v_mfma_f32_16x16x32_bf16 v[32:35], a[36:39], v[92:95], v[32:35]
    v_mfma_f32_16x16x32_bf16 v[36:39], a[40:43], v[92:95], v[36:39]
    buffer_load_dwordx4 v[84:87], v217, s[36:39], s5 offen offset:1024 sc1
    v_mfma_f32_16x16x32_bf16 v[40:43], a[44:47], v[92:95], v[40:43]
    v_mfma_f32_16x16x32_bf16 v[44:47], a[48:51], v[92:95], v[44:47]
    s_waitcnt vmcnt(13)
    v_mfma_f32_16x16x32_bf16 v[8:11], a[52:55], v[96:99], v[8:11]
    buffer_load_dwordx4 v[88:91], v216, s[36:39], s5 offen offset:2048 sc1
    v_mfma_f32_16x16x32_bf16 v[12:15], a[56:59], v[96:99], v[12:15]
    v_mfma_f32_16x16x32_bf16 v[16:19], a[60:63], v[96:99], v[16:19]
    v_mfma_f32_16x16x32_bf16 v[20:23], a[64:67], v[96:99], v[20:23]
    buffer_load_dwordx4 v[92:95], v217, s[36:39], s5 offen offset:2048 sc1
    v_mfma_f32_16x16x32_bf16 v[24:27], a[68:71], v[96:99], v[24:27]
    s_waitcnt vmcnt(14)
    v_mfma_f32_16x16x32_bf16 v[28:31], a[52:55], v[100:103], v[28:31]
    v_mfma_f32_16x16x32_bf16 v[32:35], a[56:59], v[100:103], v[32:35]
    buffer_load_dwordx4 v[96:99], v216, s[36:39], s5 offen offset:3072 sc1
    v_mfma_f32_16x16x32_bf16 v[36:39], a[60:63], v[100:103], v[36:39]
    v_mfma_f32_16x16x32_bf16 v[40:43], a[64:67], v[100:103], v[40:43]
    v_mfma_f32_16x16x32_bf16 v[44:47], a[68:71], v[100:103], v[44:47]
    s_waitcnt vmcnt(14)
    v_mfma_f32_16x16x32_bf16 v[8:11], a[72:75], v[56:59], v[8:11]
    buffer_load_dwordx4 v[100:103], v217, s[36:39], s5 offen offset:3072 sc1
    v_mfma_f32_16x16x32_bf16 v[12:15], a[76:79], v[56:59], v[12:15]
    v_mfma_f32_16x16x32_bf16 v[16:19], a[80:83], v[56:59], v[16:19]
    v_mfma_f32_16x16x32_bf16 v[20:23], a[84:87], v[56:59], v[20:23]
    v_mfma_f32_16x16x32_bf16 v[24:27], a[88:91], v[56:59], v[24:27]
    s_waitcnt vmcnt(14)
    v_mfma_f32_16x16x32_bf16 v[28:31], a[72:75], v[60:63], v[28:31]
    v_mfma_f32_16x16x32_bf16 v[32:35], a[76:79], v[60:63], v[32:35]
    v_mfma_f32_16x16x32_bf16 v[36:39], a[80:83], v[60:63], v[36:39]
    v_mfma_f32_16x16x32_bf16 v[40:43], a[84:87], v[60:63], v[40:43]
    v_mfma_f32_16x16x32_bf16 v[44:47], a[88:91], v[60:63], v[44:47]
    s_waitcnt vmcnt(13)
    v_mfma_f32_16x16x32_bf16 v[8:11], a[92:95], v[64:67], v[8:11]
    v_mfma_f32_16x16x32_bf16 v[12:15], a[96:99], v[64:67], v[12:15]
    v_mfma_f32_16x16x32_bf16 v[16:19], a[100:103], v[64:67], v[16:19]
    v_mfma_f32_16x16x32_bf16 v[20:23], a[104:107], v[64:67], v[20:23]
    v_mfma_f32_16x16x32_bf16 v[24:27], a[108:111], v[64:67], v[24:27]
    s_waitcnt vmcnt(12)
    v_mfma_f32_16x16x32_bf16 v[28:31], a[92:95], v[68:71], v[28:31]
    v_mfma_f32_16x16x32_bf16 v[32:35], a[96:99], v[68:71], v[32:35]
    v_mfma_f32_16x16x32_bf16 v[36:39], a[100:103], v[68:71], v[36:39]
    v_mfma_f32_16x16x32_bf16 v[40:43], a[104:107], v[68:71], v[40:43]
    v_mfma_f32_16x16x32_bf16 v[44:47], a[108:111], v[68:71], v[44:47]
    s_waitcnt vmcnt(11)
    v_mfma_f32_16x16x32_bf16 v[8:11], a[112:115], v[72:75], v[8:11]
    buffer_load_dword v247, v246, s[36:39], s17 offen sc1
    v_mfma_f32_16x16x32_bf16 v[12:15], a[116:119], v[72:75], v[12:15]
    v_mfma_f32_16x16x32_bf16 v[16:19], a[120:123], v[72:75], v[16:19]
    v_mfma_f32_16x16x32_bf16 v[20:23], a[124:127], v[72:75], v[20:23]
    v_mfma_f32_16x16x32_bf16 v[24:27], a[128:131], v[72:75], v[24:27]
    s_waitcnt vmcnt(6)
    s_barrier
    ds_read_b64_tr_b16 v[180:181], v231 offset:0
    v_mfma_f32_16x16x32_bf16 v[28:31], a[112:115], v[76:79], v[28:31]
    ds_read_b64_tr_b16 v[182:183], v231 offset:2048
    v_mfma_f32_16x16x32_bf16 v[32:35], a[116:119], v[76:79], v[32:35]
    ds_read_b64_tr_b16 v[184:185], v231 offset:4096
    v_mfma_f32_16x16x32_bf16 v[36:39], a[120:123], v[76:79], v[36:39]
    ds_read_b64_tr_b16 v[186:187], v231 offset:64
    v_mfma_f32_16x16x32_bf16 v[40:43], a[124:127], v[76:79], v[40:43]
    ds_read_b64_tr_b16 v[188:189], v231 offset:2112
    v_mfma_f32_16x16x32_bf16 v[44:47], a[128:131], v[76:79], v[44:47]
    ds_read_b64_tr_b16 v[190:191], v231 offset:4160
    v_mfma_f32_16x16x32_bf16 v[8:11], a[132:135], v[80:83], v[8:11]
    ds_read_b128 v[48:51], v230 offset:0
    v_mfma_f32_16x16x32_bf16 v[12:15], a[136:139], v[80:83], v[12:15]
    ds_read_b128 v[52:55], v230 offset:64
    v_mfma_f32_16x16x32_bf16 v[16:19], a[140:143], v[80:83], v[16:19]
    ds_read_b128 v[124:127], v230 offset:128
    v_mfma_f32_16x16x32_bf16 v[20:23], a[144:147], v[80:83], v[20:23]
    ds_read_b128 v[168:171], v230 offset:192
    v_mfma_f32_16x16x32_bf16 v[24:27], a[148:151], v[80:83], v[24:27]
    s_waitcnt vmcnt(5)
    ds_read_b128 v[172:175], v230 offset:256
    v_mfma_f32_16x16x32_bf16 v[28:31], a[132:135], v[84:87], v[28:31]
    ds_read_b128 v[176:179], v230 offset:320
    v_mfma_f32_16x16x32_bf16 v[32:35], a[136:139], v[84:87], v[32:35]
    v_mfma_f32_16x16x32_bf16 v[36:39], a[140:143], v[84:87], v[36:39]
    s_waitcnt lgkmcnt(11)
    v_lshlrev_b32 v204, 16, v180
    s_waitcnt lgkmcnt(2)
    v_mul_f32 v204, v204, v168
    v_mfma_f32_16x16x32_bf16 v[40:43], a[144:147], v[84:87], v[40:43]
    v_and_b32 v205, 0xffff0000, v180
    v_mul_f32 v205, v205, v169
    v_mfma_f32_16x16x32_bf16 v[44:47], a[148:151], v[84:87], v[44:47]
    s_waitcnt vmcnt(4)
    v_lshlrev_b32 v206, 16, v181
    v_mul_f32 v206, v206, v170
    v_mfma_f32_16x16x32_bf16 v[8:11], a[152:155], v[88:91], v[8:11]
    v_and_b32 v207, 0xffff0000, v181
    v_mul_f32 v207, v207, v171
    v_mfma_f32_16x16x32_bf16 v[12:15], a[156:159], v[88:91], v[12:15]
    v_lshlrev_b32 v208, 16, v182
    s_waitcnt lgkmcnt(1)
    v_mul_f32 v208, v208, v172
    v_mfma_f32_16x16x32_bf16 v[16:19], a[160:163], v[88:91], v[16:19]
    v_and_b32 v209, 0xffff0000, v182
    v_mul_f32 v209, v209, v173
    v_mfma_f32_16x16x32_bf16 v[20:23], a[164:167], v[88:91], v[20:23]
    v_lshlrev_b32 v210, 16, v183
    v_mul_f32 v210, v210, v174
    v_mfma_f32_16x16x32_bf16 v[24:27], a[168:171], v[88:91], v[24:27]
    s_waitcnt vmcnt(3)
    v_and_b32 v211, 0xffff0000, v183
    v_mul_f32 v211, v211, v175
    v_mfma_f32_16x16x32_bf16 v[28:31], a[152:155], v[92:95], v[28:31]
    v_lshlrev_b32 v212, 16, v184
    s_waitcnt lgkmcnt(0)
    v_mul_f32 v212, v212, v176
    v_mfma_f32_16x16x32_bf16 v[32:35], a[156:159], v[92:95], v[32:35]
    v_and_b32 v213, 0xffff0000, v184
    v_mul_f32 v213, v213, v177
    v_mfma_f32_16x16x32_bf16 v[36:39], a[160:163], v[92:95], v[36:39]
    v_lshlrev_b32 v214, 16, v185
    v_mul_f32 v214, v214, v178
    v_mfma_f32_16x16x32_bf16 v[40:43], a[164:167], v[92:95], v[40:43]
    v_and_b32 v215, 0xffff0000, v185
    v_mul_f32 v215, v215, v179
    v_mfma_f32_16x16x32_bf16 v[44:47], a[168:171], v[92:95], v[44:47]
    s_waitcnt vmcnt(2)
    v_lshlrev_b32 v232, 16, v186
    v_mul_f32 v232, v232, v168
    v_mfma_f32_16x16x32_bf16 v[8:11], a[172:175], v[96:99], v[8:11]
    s_waitcnt vmcnt(0)
    v_cmp_ne_u32 vcc, s48, v247
    s_cbranch_vccnz L_chk14_slow
L_chk14_back:
    v_and_b32 v233, 0xffff0000, v186
    v_mfma_f32_16x16x32_bf16 v[12:15], a[176:179], v[96:99], v[12:15]
    buffer_load_dwordx4 v[56:59], v218, s[36:39], 0 offen offset:0 sc1
    v_mfma_f32_16x16x32_bf16 v[16:19], a[180:183], v[96:99], v[16:19]
    v_mul_f32 v233, v233, v169
    v_lshlrev_b32 v234, 16, v187
    v_mfma_f32_16x16x32_bf16 v[20:23], a[184:187], v[96:99], v[20:23]
    v_mul_f32 v234, v234, v170
    v_and_b32 v235, 0xffff0000, v187
    v_mfma_f32_16x16x32_bf16 v[24:27], a[188:191], v[96:99], v[24:27]
    buffer_load_dwordx4 v[60:63], v218, s[36:39], 0 offen offset:1024 sc1
    v_mfma_f32_16x16x32_bf16 v[28:31], a[172:175], v[100:103], v[28:31]
    v_mul_f32 v235, v235, v171
    v_lshlrev_b32 v236, 16, v188
    v_mfma_f32_16x16x32_bf16 v[32:35], a[176:179], v[100:103], v[32:35]
    v_mul_f32 v236, v236, v172
    v_and_b32 v237, 0xffff0000, v188
    v_mfma_f32_16x16x32_bf16 v[36:39], a[180:183], v[100:103], v[36:39]
    buffer_load_dwordx4 v[64:67], v218, s[36:39], 0 offen offset:2048 sc1
    v_mfma_f32_16x16x32_bf16 v[40:43], a[184:187], v[100:103], v[40:43]
    ds_write_b128 v220, v[8:11] offset:0
    v_mul_f32 v237, v237, v173
    v_lshlrev_b32 v238, 16, v189
    v_mfma_f32_16x16x32_bf16 v[44:47], a[188:191], v[100:103], v[44:47]
    s_waitcnt vmcnt(2)
    v_mul_f32 v238, v238, v174
    v_and_b32 v239, 0xffff0000, v189
    v_mfma_f32_16x16x32_bf16 v[104:107], a[240:243], v[56:59], 0
    buffer_load_dwordx4 v[68:71], v218, s[36:39], 0 offen offset:3072 sc1
    v_mfma_f32_16x16x32_bf16 v[108:111], a[244:247], v[56:59], 0
    ds_write_b128 v220, v[12:15] offset:1024
    v_mul_f32 v239, v239, v175
    v_lshlrev_b32 v240, 16, v190
    v_mfma_f32_16x16x32_bf16 v[112:115], a[248:251], v[56:59], 0
    v_mul_f32 v240, v240, v176
    v_and_b32 v241, 0xffff0000, v190
    v_mfma_f32_16x16x32_bf16 v[116:119], a[252:255], v[56:59], 0
    buffer_load_dwordx4 v[72:75], v218, s[36:39], s4 offen offset:0 sc1
    v_mfma_f32_16x16x32_bf16 v[120:123], v[136:139], v[56:59], 0
    s_waitcnt vmcnt(3)
    ds_write_b128 v220, v[16:19] offset:2048
    v_mul_f32 v241, v241, v177
    v_lshlrev_b32 v242, 16, v191
    v_mfma_f32_16x16x32_bf16 v[104:107], v[140:143], v[60:63], v[104:107]
    v_mul_f32 v242, v242, v178
    v_and_b32 v243, 0xffff0000, v191
    v_mfma_f32_16x16x32_bf16 v[108:111], v[144:147], v[60:63], v[108:111]
    buffer_load_dwordx4 v[76:79], v218, s[36:39], s4 offen offset:1024 sc1
    v_mfma_f32_16x16x32_bf16 v[112:115], v[148:151], v[60:63], v[112:115]
    ds_write_b128 v220, v[20:23] offset:3072
    v_mul_f32 v243, v243, v179
    v_mfma_f32_16x16x32_bf16 v[116:119], v[152:155], v[60:63], v[116:119]
    v_mfma_f32_16x16x32_bf16 v[120:123], v[156:159], v[60:63], v[120:123]
    s_waitcnt vmcnt(3)
    buffer_load_dwordx4 v[80:83], v218, s[36:39], s4 offen offset:2048 sc1
    v_mfma_f32_16x16x32_bf16 v[104:107], v[160:163], v[64:67], v[104:107]
    ds_write_b128 v220, v[24:27] offset:4096
    v_mfma_f32_16x16x32_bf16 v[108:111], v[164:167], v[64:67], v[108:111]
    v_mfma_f32_16x16x32_bf16 v[112:115], a[0:3], v[64:67], v[112:115]
    ds_write_b128 v221, v[28:31] offset:0
    buffer_load_dwordx4 v[84:87], v218, s[36:39], s4 offen offset:3072 sc1
    v_mfma_f32_16x16x32_bf16 v[116:119], a[4:7], v[64:67], v[116:119]
    v_mfma_f32_16x16x32_bf16 v[120:123], a[8:11], v[64:67], v[120:123]
    s_waitcnt vmcnt(4)
    ds_write_b128 v221, v[32:35] offset:1024
    v_mfma_f32_16x16x32_bf16 v[104:107], a[12:15], v[68:71], v[104:107]
    buffer_load_dwordx4 v[88:91], v218, s[36:39], s5 offen offset:0 sc1
    v_mfma_f32_16x16x32_bf16 v[108:111], a[16:19], v[68:71], v[108:111]
    ds_write_b128 v221, v[36:39] offset:2048
    v_mfma_f32_16x16x32_bf16 v[112:115], a[20:23], v[68:71], v[112:115]
    v_mfma_f32_16x16x32_bf16 v[116:119], a[24:27], v[68:71], v[116:119]
    buffer_load_dwordx4 v[92:95], v218, s[36:39], s5 offen offset:1024 sc1
    v_mfma_f32_16x16x32_bf16 v[120:123], a[28:31], v[68:71], v[120:123]
    s_waitcnt vmcnt(5)
    ds_write_b128 v221, v[40:43] offset:3072
    v_mfma_f32_16x16x32_bf16 v[104:107], a[32:35], v[72:75], v[104:107]
    v_mfma_f32_16x16x32_bf16 v[108:111], a[36:39], v[72:75], v[108:111]
    buffer_load_dwordx4 v[96:99], v218, s[36:39], s5 offen offset:2048 sc1
    v_mfma_f32_16x16x32_bf16 v[112:115], a[40:43], v[72:75], v[112:115]
    ds_write_b128 v221, v[44:47] offset:4096
    v_mfma_f32_16x16x32_bf16 v[116:119], a[44:47], v[72:75], v[116:119]
    v_mfma_f32_16x16x32_bf16 v[120:123], a[48:51], v[72:75], v[120:123]
    s_waitcnt vmcnt(5)
    buffer_load_dwordx4 v[100:103], v218, s[36:39], s5 offen offset:3072 sc1
    v_mfma_f32_16x16x32_bf16 v[104:107], a[52:55], v[76:79], v[104:107]
    v_mfma_f32_16x16x32_bf16 v[108:111], a[56:59], v[76:79], v[108:111]
    v_mfma_f32_16x16x32_bf16 v[112:115], a[60:63], v[76:79], v[112:115]
    buffer_load_dwordx4 v[56:59], v219, s[36:39], 0 offen offset:0 sc1
    v_mfma_f32_16x16x32_bf16 v[116:119], a[64:67], v[76:79], v[116:119]
    v_mfma_f32_16x16x32_bf16 v[120:123], a[68:71], v[76:79], v[120:123]
    s_waitcnt vmcnt(6)
    v_mfma_f32_16x16x32_bf16 v[104:107], a[72:75], v[80:83], v[104:107]
    buffer_load_dwordx4 v[60:63], v219, s[36:39], 0 offen offset:1024 sc1
    v_mfma_f32_16x16x32_bf16 v[108:111], a[76:79], v[80:83], v[108:111]
    s_waitcnt lgkmcnt(0)
    s_barrier
    ds_read_b128 v[168:171], v224 offset:0
    v_mfma_f32_16x16x32_bf16 v[112:115], a[80:83], v[80:83], v[112:115]
    ds_read_b128 v[172:175], v224 offset:1024
    v_mfma_f32_16x16x32_bf16 v[116:119], a[84:87], v[80:83], v[116:119]
    buffer_load_dwordx4 v[64:67], v219, s[36:39], 0 offen offset:2048 sc1
    v_mfma_f32_16x16x32_bf16 v[120:123], a[88:91], v[80:83], v[120:123]
    s_waitcnt vmcnt(7)
    ds_read_b128 v[176:179], v224 offset:2048
    v_mfma_f32_16x16x32_bf16 v[104:107], a[92:95], v[84:87], v[104:107]
    ds_read_b128 v[180:183], v224 offset:5120
    ds_read_b128 v[184:187], v224 offset:6144
    v_mfma_f32_16x16x32_bf16 v[108:111], a[96:99], v[84:87], v[108:111]
    buffer_load_dwordx4 v[68:71], v219, s[36:39], 0 offen offset:3072 sc1
    v_mfma_f32_16x16x32_bf16 v[112:115], a[100:103], v[84:87], v[112:115]
    ds_read_b128 v[188:191], v224 offset:7168
    v_mfma_f32_16x16x32_bf16 v[116:119], a[104:107], v[84:87], v[116:119]
    ds_read_b128 v[192:195], v224 offset:10240
    ds_read_b128 v[196:199], v224 offset:11264
    v_mfma_f32_16x16x32_bf16 v[120:123], a[108:111], v[84:87], v[120:123]
    s_waitcnt vmcnt(7)
    buffer_load_dwordx4 v[72:75], v219, s[36:39], s4 offen offset:0 sc1
    v_mfma_f32_16x16x32_bf16 v[104:107], a[112:115], v[88:91], v[104:107]
    ds_read_b128 v[200:203], v224 offset:12288
    v_mfma_f32_16x16x32_bf16 v[108:111], a[116:119], v[88:91], v[108:111]
    s_waitcnt lgkmcnt(5)
    v_add_f32 v168, v168, v180
    v_add_f32 v169, v169, v181
    v_add_f32 v170, v170, v182
    v_mfma_f32_16x16x32_bf16 v[112:115], a[120:123], v[88:91], v[112:115]
    buffer_load_dwordx4 v[76:79], v219, s[36:39], s4 offen offset:1024 sc1
    v_mfma_f32_16x16x32_bf16 v[116:119], a[124:127], v[88:91], v[116:119]
    v_add_f32 v171, v171, v183
    s_waitcnt lgkmcnt(4)
    v_add_f32 v172, v172, v184
    v_mfma_f32_16x16x32_bf16 v[120:123], a[128:131], v[88:91], v[120:123]
    s_waitcnt vmcnt(8)
    v_add_f32 v173, v173, v185
    v_add_f32 v174, v174, v186
    v_mfma_f32_16x16x32_bf16 v[104:107], a[132:135], v[92:95], v[104:107]
    buffer_load_dwordx4 v[80:83], v219, s[36:39], s4 offen offset:2048 sc1
    v_mfma_f32_16x16x32_bf16 v[108:111], a[136:139], v[92:95], v[108:111]
    v_add_f32 v175, v175, v187
    s_waitcnt lgkmcnt(3)
    v_add_f32 v176, v176, v188
    v_mfma_f32_16x16x32_bf16 v[112:115], a[140:143], v[92:95], v[112:115]
    v_add_f32 v177, v177, v189
    v_add_f32 v178, v178, v190
    v_add_f32 v179, v179, v191
    v_mfma_f32_16x16x32_bf16 v[116:119], a[144:147], v[92:95], v[116:119]
    buffer_load_dwordx4 v[84:87], v219, s[36:39], s4 offen offset:3072 sc1
    v_mfma_f32_16x16x32_bf16 v[120:123], a[148:151], v[92:95], v[120:123]
    s_waitcnt vmcnt(9)
    ds_read_b128 v[180:183], v224 offset:15360
    ds_read_b128 v[184:187], v224 offset:16384
    v_mfma_f32_16x16x32_bf16 v[104:107], a[152:155], v[96:99], v[104:107]
    ds_read_b128 v[188:191], v224 offset:17408
    s_waitcnt lgkmcnt(5)
    v_add_f32 v168, v168, v192
    v_add_f32 v169, v169, v193
    v_mfma_f32_16x16x32_bf16 v[108:111], a[156:159], v[96:99], v[108:111]
    buffer_load_dwordx4 v[88:91], v219, s[36:39], s5 offen offset:0 sc1
    v_mfma_f32_16x16x32_bf16 v[112:115], a[160:163], v[96:99], v[112:115]
    v_add_f32 v170, v170, v194
    v_add_f32 v171, v171, v195
    v_mfma_f32_16x16x32_bf16 v[116:119], a[164:167], v[96:99], v[116:119]
    s_waitcnt lgkmcnt(4)
    v_add_f32 v172, v172, v196
    v_add_f32 v173, v173, v197
    v_mfma_f32_16x16x32_bf16 v[120:123], a[168:171], v[96:99], v[120:123]
    s_waitcnt vmcnt(9)
    buffer_load_dwordx4 v[92:95], v219, s[36:39], s5 offen offset:1024 sc1
    v_mfma_f32_16x16x32_bf16 v[104:107], a[172:175], v[100:103], v[104:107]
    v_add_f32 v174, v174, v198
    v_add_f32 v175, v175, v199
    v_mfma_f32_16x16x32_bf16 v[108:111], a[176:179], v[100:103], v[108:111]
    s_waitcnt lgkmcnt(3)
    v_add_f32 v176, v176, v200
    v_add_f32 v177, v177, v201
    v_add_f32 v178, v178, v202
    v_mfma_f32_16x16x32_bf16 v[112:115], a[180:183], v[100:103], v[112:115]
    buffer_load_dwordx4 v[96:99], v219, s[36:39], s5 offen offset:2048 sc1
    v_mfma_f32_16x16x32_bf16 v[116:119], a[184:187], v[100:103], v[116:119]
    v_add_f32 v179, v179, v203
    s_waitcnt lgkmcnt(2)
    v_add_f32 v168, v168, v180
    v_mfma_f32_16x16x32_bf16 v[120:123], a[188:191], v[100:103], v[120:123]
    s_waitcnt vmcnt(10)
    v_add_f32 v169, v169, v181
    v_add_f32 v170, v170, v182
    v_add_f32 v171, v171, v183
    v_mfma_f32_16x16x32_bf16 v[8:11], a[240:243], v[56:59], 0
    buffer_load_dwordx4 v[100:103], v219, s[36:39], s5 offen offset:3072 sc1
    v_mfma_f32_16x16x32_bf16 v[12:15], a[244:247], v[56:59], 0
    s_waitcnt lgkmcnt(1)
    v_add_f32 v172, v172, v184
    v_add_f32 v173, v173, v185
    v_mfma_f32_16x16x32_bf16 v[16:19], a[248:251], v[56:59], 0
    v_add_f32 v174, v174, v186
    v_add_f32 v175, v175, v187
    v_mfma_f32_16x16x32_bf16 v[20:23], a[252:255], v[56:59], 0
    ds_write_b128 v222, v[104:107] offset:0
    s_waitcnt lgkmcnt(1)
    v_add_f32 v176, v176, v188
    v_add_f32 v177, v177, v189
    v_mfma_f32_16x16x32_bf16 v[24:27], v[136:139], v[56:59], 0
    s_waitcnt vmcnt(10)
    v_add_f32 v178, v178, v190
    v_add_f32 v179, v179, v191
    v_fma_f32 v204, v168, v48, v204
    v_mfma_f32_16x16x32_bf16 v[8:11], v[140:143], v[60:63], v[8:11]
    ds_write_b128 v222, v[108:111] offset:1024
    v_fma_f32 v205, v169, v49, v205
    v_fma_f32 v206, v170, v50, v206
    v_mfma_f32_16x16x32_bf16 v[12:15], v[144:147], v[60:63], v[12:15]
    v_fma_f32 v207, v171, v51, v207
    v_fma_f32 v208, v172, v52, v208
    v_mfma_f32_16x16x32_bf16 v[16:19], v[148:151], v[60:63], v[16:19]
    ds_write_b128 v222, v[112:115] offset:2048
    v_fma_f32 v209, v173, v53, v209
    v_fma_f32 v210, v174, v54, v210
    v_mfma_f32_16x16x32_bf16 v[20:23], v[152:155], v[60:63], v[20:23]
    v_fma_f32 v211, v175, v55, v211
    v_fma_f32 v212, v176, v124, v212
    v_mfma_f32_16x16x32_bf16 v[24:27], v[156:159], v[60:63], v[24:27]
    s_waitcnt vmcnt(9)
    ds_write_b128 v222, v[116:119] offset:3072
    v_fma_f32 v213, v177, v125, v213
    v_fma_f32 v214, v178, v126, v214
    v_mfma_f32_16x16x32_bf16 v[8:11], v[160:163], v[64:67], v[8:11]
    v_fma_f32 v215, v179, v127, v215
    v_cvt_pk_bf16_f32 v180, v204, v205
    v_mfma_f32_16x16x32_bf16 v[12:15], v[164:167], v[64:67], v[12:15]
    v_cvt_pk_bf16_f32 v181, v206, v207
    v_cvt_pk_bf16_f32 v182, v208, v209
    v_mfma_f32_16x16x32_bf16 v[16:19], a[0:3], v[64:67], v[16:19]
    v_cvt_pk_bf16_f32 v183, v210, v211
    v_cvt_pk_bf16_f32 v184, v212, v213
    v_mfma_f32_16x16x32_bf16 v[20:23], a[4:7], v[64:67], v[20:23]
    ds_write_b128 v222, v[120:123] offset:4096
    v_cvt_pk_bf16_f32 v185, v214, v215
    v_mfma_f32_16x16x32_bf16 v[24:27], a[8:11], v[64:67], v[24:27]
    s_waitcnt vmcnt(8)
    v_permlane16_swap_b32 v180, v182
    v_mfma_f32_16x16x32_bf16 v[8:11], a[12:15], v[68:71], v[8:11]
    v_permlane16_swap_b32 v181, v183
    v_mfma_f32_16x16x32_bf16 v[12:15], a[16:19], v[68:71], v[12:15]
    buffer_store_dwordx4 v[180:183], v227, s[40:43], s13 offen nt
    v_mfma_f32_16x16x32_bf16 v[16:19], a[20:23], v[68:71], v[16:19]
    buffer_store_dwordx2 v[184:185], v228, s[40:43], s13 offen offset:64 nt
    v_mfma_f32_16x16x32_bf16 v[20:23], a[24:27], v[68:71], v[20:23]
    v_mfma_f32_16x16x32_bf16 v[24:27], a[28:31], v[68:71], v[24:27]
    s_waitcnt vmcnt(9)
    v_mfma_f32_16x16x32_bf16 v[8:11], a[32:35], v[72:75], v[8:11]
    v_mfma_f32_16x16x32_bf16 v[12:15], a[36:39], v[72:75], v[12:15]
    s_waitcnt lgkmcnt(0)
    s_barrier
    ds_read_b128 v[168:171], v225 offset:0
    v_mfma_f32_16x16x32_bf16 v[16:19], a[40:43], v[72:75], v[16:19]
    ds_read_b128 v[172:175], v225 offset:1024
    v_mfma_f32_16x16x32_bf16 v[20:23], a[44:47], v[72:75], v[20:23]
    ds_read_b128 v[176:179], v225 offset:2048
    v_mfma_f32_16x16x32_bf16 v[24:27], a[48:51], v[72:75], v[24:27]
    s_waitcnt vmcnt(8)
    ds_read_b128 v[192:195], v225 offset:10240
    v_mfma_f32_16x16x32_bf16 v[8:11], a[52:55], v[76:79], v[8:11]
    ds_read_b128 v[196:199], v225 offset:11264
    v_mfma_f32_16x16x32_bf16 v[12:15], a[56:59], v[76:79], v[12:15]
    ds_read_b128 v[200:203], v225 offset:12288
    v_mfma_f32_16x16x32_bf16 v[16:19], a[60:63], v[76:79], v[16:19]
    v_mfma_f32_16x16x32_bf16 v[20:23], a[64:67], v[76:79], v[20:23]
    v_mfma_f32_16x16x32_bf16 v[24:27], a[68:71], v[76:79], v[24:27]
    s_waitcnt vmcnt(7)
    v_mfma_f32_16x16x32_bf16 v[8:11], a[72:75], v[80:83], v[8:11]
    v_mfma_f32_16x16x32_bf16 v[12:15], a[76:79], v[80:83], v[12:15]
    v_mfma_f32_16x16x32_bf16 v[16:19], a[80:83], v[80:83], v[16:19]
    v_mfma_f32_16x16x32_bf16 v[20:23], a[84:87], v[80:83], v[20:23]
    s_waitcnt lgkmcnt(2)
    v_add_f32 v168, v168, v192
    v_add_f32 v169, v169, v193
    v_mfma_f32_16x16x32_bf16 v[24:27], a[88:91], v[80:83], v[24:27]
    s_waitcnt vmcnt(6)
    v_add_f32 v170, v170, v194
    v_add_f32 v171, v171, v195
    v_mfma_f32_16x16x32_bf16 v[8:11], a[92:95], v[84:87], v[8:11]
    s_waitcnt lgkmcnt(1)
    v_add_f32 v172, v172, v196
    v_add_f32 v173, v173, v197
    v_mfma_f32_16x16x32_bf16 v[12:15], a[96:99], v[84:87], v[12:15]
    v_add_f32 v174, v174, v198
    v_add_f32 v175, v175, v199
    v_mfma_f32_16x16x32_bf16 v[16:19], a[100:103], v[84:87], v[16:19]
    s_waitcnt lgkmcnt(0)
    v_add_f32 v176, v176, v200
    v_add_f32 v177, v177, v201
    v_mfma_f32_16x16x32_bf16 v[20:23], a[104:107], v[84:87], v[20:23]
    v_add_f32 v178, v178, v202
    v_add_f32 v179, v179, v203
    v_mfma_f32_16x16x32_bf16 v[24:27], a[108:111], v[84:87], v[24:27]
    s_waitcnt vmcnt(5)
    v_fma_f32 v232, v168, v48, v232
    v_fma_f32 v233, v169, v49, v233
    v_mfma_f32_16x16x32_bf16 v[8:11], a[112:115], v[88:91], v[8:11]
    v_fma_f32 v234, v170, v50, v234
    v_fma_f32 v235, v171, v51, v235
    v_mfma_f32_16x16x32_bf16 v[12:15], a[116:119], v[88:91], v[12:15]
    v_fma_f32 v236, v172, v52, v236
    v_fma_f32 v237, v173, v53, v237
    v_mfma_f32_16x16x32_bf16 v[16:19], a[120:123], v[88:91], v[16:19]
    v_fma_f32 v238, v174, v54, v238
    v_fma_f32 v239, v175, v55, v239
    v_mfma_f32_16x16x32_bf16 v[20:23], a[124:127], v[88:91], v[20:23]
    v_fma_f32 v240, v176, v124, v240
    v_fma_f32 v241, v177, v125, v241
    v_mfma_f32_16x16x32_bf16 v[24:27], a[128:131], v[88:91], v[24:27]
    s_waitcnt vmcnt(4)
    v_fma_f32 v242, v178, v126, v242
    v_fma_f32 v243, v179, v127, v243
    v_mfma_f32_16x16x32_bf16 v[8:11], a[132:135], v[92:95], v[8:11]
    v_mfma_f32_16x16x32_bf16 v[12:15], a[136:139], v[92:95], v[12:15]
    v_mfma_f32_16x16x32_bf16 v[16:19], a[140:143], v[92:95], v[16:19]
    v_mfma_f32_16x16x32_bf16 v[20:23], a[144:147], v[92:95], v[20:23]
    v_mfma_f32_16x16x32_bf16 v[24:27], a[148:151], v[92:95], v[24:27]
    s_waitcnt vmcnt(3)
    v_mfma_f32_16x16x32_bf16 v[8:11], a[152:155], v[96:99], v[8:11]
    v_mfma_f32_16x16x32_bf16 v[12:15], a[156:159], v[96:99], v[12:15]
    v_mfma_f32_16x16x32_bf16 v[16:19], a[160:163], v[96:99], v[16:19]
    v_mfma_f32_16x16x32_bf16 v[20:23], a[164:167], v[96:99], v[20:23]
    v_mfma_f32_16x16x32_bf16 v[24:27], a[168:171], v[96:99], v[24:27]
    s_waitcnt vmcnt(2)
    v_mfma_f32_16x16x32_bf16 v[8:11], a[172:175], v[100:103], v[8:11]
    v_mfma_f32_16x16x32_bf16 v[12:15], a[176:179], v[100:103], v[12:15]
    v_mfma_f32_16x16x32_bf16 v[16:19], a[180:183], v[100:103], v[16:19]
    v_mfma_f32_16x16x32_bf16 v[20:23], a[184:187], v[100:103], v[20:23]
    v_mfma_f32_16x16x32_bf16 v[24:27], a[188:191], v[100:103], v[24:27]
    s_nop 3
    ds_write_b128 v223, v[8:11] offset:0
    ds_write_b128 v223, v[12:15] offset:1024
    ds_write_b128 v223, v[16:19] offset:2048
    ds_write_b128 v223, v[20:23] offset:3072
    ds_write_b128 v223, v[24:27] offset:4096
    s_waitcnt lgkmcnt(0)
    s_barrier
    ds_read_b128 v[168:171], v226 offset:0
    ds_read_b128 v[172:175], v226 offset:1024
    ds_read_b128 v[176:179], v226 offset:2048
    ds_read_b128 v[180:183], v226 offset:10240
    ds_read_b128 v[184:187], v226 offset:11264
    ds_read_b128 v[188:191], v226 offset:12288
    s_waitcnt lgkmcnt(2)
    v_pk_add_f32 v[168:169], v[168:169], v[180:181]
    v_pk_add_f32 v[170:171], v[170:171], v[182:183]
    s_waitcnt lgkmcnt(1)
    v_pk_add_f32 v[172:173], v[172:173], v[184:185]
    v_pk_add_f32 v[174:175], v[174:175], v[186:187]
    s_waitcnt lgkmcnt(0)
    v_pk_add_f32 v[176:177], v[176:177], v[188:189]
    v_pk_add_f32 v[178:179], v[178:179], v[190:191]
    v_pk_fma_f32 v[232:233], v[168:169], v[48:49], v[232:233]
    v_pk_fma_f32 v[234:235], v[170:171], v[50:51], v[234:235]
    v_pk_fma_f32 v[236:237], v[172:173], v[52:53], v[236:237]
    v_pk_fma_f32 v[238:239], v[174:175], v[54:55], v[238:239]
    v_pk_fma_f32 v[240:241], v[176:177], v[124:125], v[240:241]
    v_pk_fma_f32 v[242:243], v[178:179], v[126:127], v[242:243]
    v_cvt_pk_bf16_f32 v168, v232, v233
    v_cvt_pk_bf16_f32 v169, v234, v235
    v_cvt_pk_bf16_f32 v170, v236, v237
    v_cvt_pk_bf16_f32 v171, v238, v239
    v_cvt_pk_bf16_f32 v172, v240, v241
    v_cvt_pk_bf16_f32 v173, v242, v243
    v_permlane16_swap_b32 v168, v170
    v_permlane16_swap_b32 v169, v171
    buffer_store_dwordx4 v[168:171], v227, s[40:43], s14 offen nt
    buffer_store_dwordx2 v[172:173], v228, s[40:43], s14 offen offset:64 nt
    s_endpgm
L_prep:
    s_mov_b32 s36, s32
    s_mov_b32 s37, s33
    s_mov_b32 s38, 0x10000000
    s_mov_b32 s39, 0x20000
    v_mov_b32 v2, 0
    s_mov_b32 s57, 23461888
    buffer_load_dword v246, v2, s[36:39], s57 offen sc1
    s_mov_b32 s49, 400000
    s_and_b32 s50, s2, 7
    s_lshr_b32 s51, s2, 3
    s_lshr_b32 s60, s50, 2
    s_lshl_b32 s60, s60, 3
    s_lshr_b32 s61, s51, 2
    s_add_u32 s72, s60, s61
    s_lshl_b32 s61, s61, 3
    s_mov_b32 s62, 0x6040200
    s_mov_b32 s63, 0x70308
    s_lshr_b64 s[62:63], s[62:63], s61
    s_and_b32 s34, s62, 255
    s_lshr_b32 s62, s50, 2
    s_mul_i32 s62, s62, 10
    s_add_u32 s34, s34, s62
    s_sub_u32 s62, s34, 20
    s_min_u32 s34, s34, s62
    s_and_b32 s60, s50, 3
    s_lshl_b32 s60, s60, 2
    s_and_b32 s61, s51, 3
    s_add_u32 s73, s60, s61
    s_and_b32 s75, s51, 7
    s_lshr_b32 s61, s51, 3
    s_lshl_b32 s60, s50, 2
    s_add_u32 s74, s60, s61
    s_mul_i32 s70, s50, 20
    s_add_u32 s70, s70, s51
    s_lshl_b32 s60, s50, 1
    s_cmp_ge_u32 s51, 10
    s_addc_u32 s60, s60, 0
    s_cmp_ge_u32 s51, 10
    s_cselect_b32 s61, 10, 0
    s_sub_u32 s61, s51, s61
    s_lshl_b32 s61, s61, 4
    s_add_u32 s76, s60, s61
    s_lshl_b32 s58, s70, 2
    s_add_u32 s58, s58, s3
    v_lshlrev_b32 v248, 4, v1
    s_mov_b32 s76, 0
    s_mov_b32 s50, 0xbfb8aa3b
    s_waitcnt vmcnt(5)
    v_lshlrev_b32 v180, 16, v80
    v_and_b32 v181, 0xffff0000, v80
    v_lshlrev_b32 v182, 16, v81
    v_and_b32 v183, 0xffff0000, v81
    s_waitcnt vmcnt(4)
    v_lshlrev_b32 v184, 16, v82
    v_and_b32 v185, 0xffff0000, v82
    v_lshlrev_b32 v186, 16, v83
    v_and_b32 v187, 0xffff0000, v83
    s_waitcnt vmcnt(3)
    v_lshlrev_b32 v188, 16, v84
    v_and_b32 v189, 0xffff0000, v84
    v_lshlrev_b32 v190, 16, v85
    v_and_b32 v191, 0xffff0000, v85
    s_waitcnt vmcnt(2)
    v_lshlrev_b32 v192, 16, v86
    v_and_b32 v193, 0xffff0000, v86
    v_lshlrev_b32 v194, 16, v87
    v_and_b32 v195, 0xffff0000, v87
    s_waitcnt vmcnt(1)
    v_lshlrev_b32 v196, 16, v88
    v_and_b32 v197, 0xffff0000, v88
    v_lshlrev_b32 v198, 16, v89
    v_and_b32 v199, 0xffff0000, v89
    v_mul_f32 v208, s50, v180
    v_exp_f32 v208, v208
    s_nop 0
    v_add_f32 v208, 1.0, v208
    v_rcp_f32 v208, v208
    s_nop 0
    v_mul_f32 v180, v180, v208
    v_mul_f32 v209, s50, v181
    v_exp_f32 v209, v209
    s_nop 0
    v_add_f32 v209, 1.0, v209
    v_rcp_f32 v209, v209
    s_nop 0
    v_mul_f32 v181, v181, v209
    v_mul_f32 v208, s50, v182
    v_exp_f32 v208, v208
    s_nop 0
    v_add_f32 v208, 1.0, v208
    v_rcp_f32 v208, v208
    s_nop 0
    v_mul_f32 v182, v182, v208
    v_mul_f32 v209, s50, v183
    v_exp_f32 v209, v209
    s_nop 0
    v_add_f32 v209, 1.0, v209
    v_rcp_f32 v209, v209
    s_nop 0
    v_mul_f32 v183, v183, v209
    v_mul_f32 v208, s50, v184
    v_exp_f32 v208, v208
    s_nop 0
    v_add_f32 v208, 1.0, v208
    v_rcp_f32 v208, v208
    s_nop 0
    v_mul_f32 v184, v184, v208
    v_mul_f32 v209, s50, v185
    v_exp_f32 v209, v209
    s_nop 0
    v_add_f32 v209, 1.0, v209
    v_rcp_f32 v209, v209
    s_nop 0
    v_mul_f32 v185, v185, v209
    v_mul_f32 v208, s50, v186
    v_exp_f32 v208, v208
    s_nop 0
    v_add_f32 v208, 1.0, v208
    v_rcp_f32 v208, v208
    s_nop 0
    v_mul_f32 v186, v186, v208
    v_mul_f32 v209, s50, v187
    v_exp_f32 v209, v209
    s_nop 0
    v_add_f32 v209, 1.0, v209
    v_rcp_f32 v209, v209
    s_nop 0
    v_mul_f32 v187, v187, v209
    v_mul_f32 v208, s50, v188
    v_exp_f32 v208, v208
    s_nop 0
    v_add_f32 v208, 1.0, v208
    v_rcp_f32 v208, v208
    s_nop 0
    v_mul_f32 v188, v188, v208
    v_mul_f32 v209, s50, v189
    v_exp_f32 v209, v209
    s_nop 0
    v_add_f32 v209, 1.0, v209
    v_rcp_f32 v209, v209
    s_nop 0
    v_mul_f32 v189, v189, v209
    v_mul_f32 v208, s50, v190
    v_exp_f32 v208, v208
    s_nop 0
    v_add_f32 v208, 1.0, v208
    v_rcp_f32 v208, v208
    s_nop 0
    v_mul_f32 v190, v190, v208
    v_mul_f32 v209, s50, v191
    v_exp_f32 v209, v209
    s_nop 0
    v_add_f32 v209, 1.0, v209
    v_rcp_f32 v209, v209
    s_nop 0
    v_mul_f32 v191, v191, v209
    v_mul_f32 v208, s50, v192
    v_exp_f32 v208, v208
    s_nop 0
    v_add_f32 v208, 1.0, v208
    v_rcp_f32 v208, v208
    s_nop 0
    v_mul_f32 v192, v192, v208
    v_mul_f32 v209, s50, v193
    v_exp_f32 v209, v209
    s_nop 0
    v_add_f32 v209, 1.0, v209
    v_rcp_f32 v209, v209
    s_nop 0
    v_mul_f32 v193, v193, v209
    v_mul_f32 v208, s50, v194
    v_exp_f32 v208, v208
    s_nop 0
    v_add_f32 v208, 1.0, v208
    v_rcp_f32 v208, v208
    s_nop 0
    v_mul_f32 v194, v194, v208
    v_mul_f32 v209, s50, v195
    v_exp_f32 v209, v209
    s_nop 0
    v_add_f32 v209, 1.0, v209
    v_rcp_f32 v209, v209
    s_nop 0
    v_mul_f32 v195, v195, v209
    v_mul_f32 v208, s50, v196
    v_exp_f32 v208, v208
    s_nop 0
    v_add_f32 v208, 1.0, v208
    v_rcp_f32 v208, v208
    s_nop 0
    v_mul_f32 v196, v196, v208
    v_mul_f32 v209, s50, v197
    v_exp_f32 v209, v209
    s_nop 0
    v_add_f32 v209, 1.0, v209
    v_rcp_f32 v209, v209
    s_nop 0
    v_mul_f32 v197, v197, v209
    v_mul_f32 v208, s50, v198
    v_exp_f32 v208, v208
    s_nop 0
    v_add_f32 v208, 1.0, v208
    v_rcp_f32 v208, v208
    s_nop 0
    v_mul_f32 v198, v198, v208
    v_mul_f32 v209, s50, v199
    v_exp_f32 v209, v209
    s_nop 0
    v_add_f32 v209, 1.0, v209
    v_rcp_f32 v209, v209
    s_nop 0
    v_mul_f32 v199, v199, v209
    v_cvt_pk_bf16_f32 v208, v180, v181
    v_lshlrev_b32 v180, 16, v208
    v_and_b32 v181, 0xffff0000, v208
    v_cvt_pk_bf16_f32 v208, v182, v183
    v_lshlrev_b32 v182, 16, v208
    v_and_b32 v183, 0xffff0000, v208
    v_cvt_pk_bf16_f32 v208, v184, v185
    v_lshlrev_b32 v184, 16, v208
    v_and_b32 v185, 0xffff0000, v208
    v_cvt_pk_bf16_f32 v208, v186, v187
    v_lshlrev_b32 v186, 16, v208
    v_and_b32 v187, 0xffff0000, v208
    v_cvt_pk_bf16_f32 v208, v188, v189
    v_lshlrev_b32 v188, 16, v208
    v_and_b32 v189, 0xffff0000, v208
    v_cvt_pk_bf16_f32 v208, v190, v191
    v_lshlrev_b32 v190, 16, v208
    v_and_b32 v191, 0xffff0000, v208
    v_cvt_pk_bf16_f32 v208, v192, v193
    v_lshlrev_b32 v192, 16, v208
    v_and_b32 v193, 0xffff0000, v208
    v_cvt_pk_bf16_f32 v208, v194, v195
    v_lshlrev_b32 v194, 16, v208
    v_and_b32 v195, 0xffff0000, v208
    v_cvt_pk_bf16_f32 v208, v196, v197
    v_lshlrev_b32 v196, 16, v208
    v_and_b32 v197, 0xffff0000, v208
    v_cvt_pk_bf16_f32 v208, v198, v199
    v_lshlrev_b32 v198, 16, v208
    v_and_b32 v199, 0xffff0000, v208
    buffer_load_dwordx4 v[90:93], v9, s[44:47], s56 offen nt
    s_add_u32 s56, s56, s68
    buffer_load_dwordx4 v[94:97], v9, s[44:47], s56 offen nt
    s_add_u32 s56, s56, s68
    buffer_load_dwordx4 v[98:101], v9, s[44:47], s56 offen nt
    s_add_u32 s56, s56, s68
    buffer_load_dwordx4 v[102:105], v9, s[44:47], s56 offen nt
    s_add_u32 s56, s56, s68
    buffer_load_dwordx4 v[106:109], v9, s[44:47], s56 offen nt
    s_add_u32 s56, s56, s68
    buffer_load_dwordx4 v[110:113], v9, s[44:47], s56 offen nt
    s_add_u32 s56, s56, s68
    buffer_load_dwordx4 v[114:117], v9, s[44:47], s56 offen nt
    s_add_u32 s56, s56, s68
    buffer_load_dwordx4 v[118:121], v9, s[44:47], s56 offen nt
    s_add_u32 s56, s56, s68
    buffer_load_dwordx4 v[122:125], v9, s[44:47], s56 offen nt
    s_add_u32 s56, s56, s68
    buffer_load_dwordx4 v[126:129], v9, s[44:47], s56 offen nt
    s_add_u32 s56, s56, s68
    buffer_load_dwordx4 v[130:133], v9, s[44:47], s56 offen nt
    s_add_u32 s56, s56, s68
    buffer_load_dwordx4 v[134:137], v9, s[44:47], s56 offen nt
    s_add_u32 s56, s56, s68
    buffer_load_dwordx4 v[138:141], v9, s[44:47], s56 offen nt
    s_add_u32 s56, s56, s68
    buffer_load_dwordx4 v[142:145], v9, s[44:47], s56 offen nt
    s_add_u32 s56, s56, s68
    buffer_load_dwordx4 v[146:149], v9, s[44:47], s56 offen nt
    s_add_u32 s56, s56, s68
    buffer_load_dwordx4 v[150:153], v9, s[44:47], s56 offen nt
    s_add_u32 s56, s56, s68
    buffer_load_dwordx4 v[154:157], v9, s[44:47], s56 offen nt
    s_add_u32 s56, s56, s68
    buffer_load_dwordx4 v[158:161], v9, s[44:47], s56 offen nt
    s_add_u32 s56, s56, s68
    buffer_load_dwordx4 v[162:165], v9, s[44:47], s56 offen nt
    s_add_u32 s56, s56, s68
    buffer_load_dwordx4 v[166:169], v9, s[44:47], s56 offen nt
    s_waitcnt vmcnt(19)
    v_lshlrev_b32 v208, 16, v90
    v_and_b32 v209, 0xffff0000, v90
    v_pk_mul_f32 v[200:201], v[208:209], v[180:181] op_sel_hi:[1,0]
    v_lshlrev_b32 v210, 16, v91
    v_and_b32 v211, 0xffff0000, v91
    v_pk_mul_f32 v[202:203], v[210:211], v[180:181] op_sel_hi:[1,0]
    v_lshlrev_b32 v208, 16, v92
    v_and_b32 v209, 0xffff0000, v92
    v_pk_mul_f32 v[204:205], v[208:209], v[180:181] op_sel_hi:[1,0]
    v_lshlrev_b32 v210, 16, v93
    v_and_b32 v211, 0xffff0000, v93
    v_pk_mul_f32 v[206:207], v[210:211], v[180:181] op_sel_hi:[1,0]
    s_waitcnt vmcnt(18)
    v_lshlrev_b32 v208, 16, v94
    v_and_b32 v209, 0xffff0000, v94
    v_pk_fma_f32 v[200:201], v[208:209], v[180:181], v[200:201] op_sel:[0,1,0] op_sel_hi:[1,1,1]
    v_lshlrev_b32 v210, 16, v95
    v_and_b32 v211, 0xffff0000, v95
    v_pk_fma_f32 v[202:203], v[210:211], v[180:181], v[202:203] op_sel:[0,1,0] op_sel_hi:[1,1,1]
    v_lshlrev_b32 v208, 16, v96
    v_and_b32 v209, 0xffff0000, v96
    v_pk_fma_f32 v[204:205], v[208:209], v[180:181], v[204:205] op_sel:[0,1,0] op_sel_hi:[1,1,1]
    v_lshlrev_b32 v210, 16, v97
    v_and_b32 v211, 0xffff0000, v97
    v_pk_fma_f32 v[206:207], v[210:211], v[180:181], v[206:207] op_sel:[0,1,0] op_sel_hi:[1,1,1]
    s_waitcnt vmcnt(17)
    v_lshlrev_b32 v208, 16, v98
    v_and_b32 v209, 0xffff0000, v98
    v_pk_fma_f32 v[200:201], v[208:209], v[182:183], v[200:201] op_sel_hi:[1,0,1]
    v_lshlrev_b32 v210, 16, v99
    v_and_b32 v211, 0xffff0000, v99
    v_pk_fma_f32 v[202:203], v[210:211], v[182:183], v[202:203] op_sel_hi:[1,0,1]
    v_lshlrev_b32 v208, 16, v100
    v_and_b32 v209, 0xffff0000, v100
    v_pk_fma_f32 v[204:205], v[208:209], v[182:183], v[204:205] op_sel_hi:[1,0,1]
    v_lshlrev_b32 v210, 16, v101
    v_and_b32 v211, 0xffff0000, v101
    v_pk_fma_f32 v[206:207], v[210:211], v[182:183], v[206:207] op_sel_hi:[1,0,1]
    s_waitcnt vmcnt(16)
    v_lshlrev_b32 v208, 16, v102
    v_and_b32 v209, 0xffff0000, v102
    v_pk_fma_f32 v[200:201], v[208:209], v[182:183], v[200:201] op_sel:[0,1,0] op_sel_hi:[1,1,1]
    v_lshlrev_b32 v210, 16, v103
    v_and_b32 v211, 0xffff0000, v103
    v_pk_fma_f32 v[202:203], v[210:211], v[182:183], v[202:203] op_sel:[0,1,0] op_sel_hi:[1,1,1]
    v_lshlrev_b32 v208, 16, v104
    v_and_b32 v209, 0xffff0000, v104
    v_pk_fma_f32 v[204:205], v[208:209], v[182:183], v[204:205] op_sel:[0,1,0] op_sel_hi:[1,1,1]
    v_lshlrev_b32 v210, 16, v105
    v_and_b32 v211, 0xffff0000, v105
    v_pk_fma_f32 v[206:207], v[210:211], v[182:183], v[206:207] op_sel:[0,1,0] op_sel_hi:[1,1,1]
    s_waitcnt vmcnt(15)
    v_lshlrev_b32 v208, 16, v106
    v_and_b32 v209, 0xffff0000, v106
    v_pk_fma_f32 v[200:201], v[208:209], v[184:185], v[200:201] op_sel_hi:[1,0,1]
    v_lshlrev_b32 v210, 16, v107
    v_and_b32 v211, 0xffff0000, v107
    v_pk_fma_f32 v[202:203], v[210:211], v[184:185], v[202:203] op_sel_hi:[1,0,1]
    v_lshlrev_b32 v208, 16, v108
    v_and_b32 v209, 0xffff0000, v108
    v_pk_fma_f32 v[204:205], v[208:209], v[184:185], v[204:205] op_sel_hi:[1,0,1]
    v_lshlrev_b32 v210, 16, v109
    v_and_b32 v211, 0xffff0000, v109
    v_pk_fma_f32 v[206:207], v[210:211], v[184:185], v[206:207] op_sel_hi:[1,0,1]
    s_waitcnt vmcnt(14)
    v_lshlrev_b32 v208, 16, v110
    v_and_b32 v209, 0xffff0000, v110
    v_pk_fma_f32 v[200:201], v[208:209], v[184:185], v[200:201] op_sel:[0,1,0] op_sel_hi:[1,1,1]
    v_lshlrev_b32 v210, 16, v111
    v_and_b32 v211, 0xffff0000, v111
    v_pk_fma_f32 v[202:203], v[210:211], v[184:185], v[202:203] op_sel:[0,1,0] op_sel_hi:[1,1,1]
    v_lshlrev_b32 v208, 16, v112
    v_and_b32 v209, 0xffff0000, v112
    v_pk_fma_f32 v[204:205], v[208:209], v[184:185], v[204:205] op_sel:[0,1,0] op_sel_hi:[1,1,1]
    v_lshlrev_b32 v210, 16, v113
    v_and_b32 v211, 0xffff0000, v113
    v_pk_fma_f32 v[206:207], v[210:211], v[184:185], v[206:207] op_sel:[0,1,0] op_sel_hi:[1,1,1]
    s_waitcnt vmcnt(13)
    v_lshlrev_b32 v208, 16, v114
    v_and_b32 v209, 0xffff0000, v114
    v_pk_fma_f32 v[200:201], v[208:209], v[186:187], v[200:201] op_sel_hi:[1,0,1]
    v_lshlrev_b32 v210, 16, v115
    v_and_b32 v211, 0xffff0000, v115
    v_pk_fma_f32 v[202:203], v[210:211], v[186:187], v[202:203] op_sel_hi:[1,0,1]
    v_lshlrev_b32 v208, 16, v116
    v_and_b32 v209, 0xffff0000, v116
    v_pk_fma_f32 v[204:205], v[208:209], v[186:187], v[204:205] op_sel_hi:[1,0,1]
    v_lshlrev_b32 v210, 16, v117
    v_and_b32 v211, 0xffff0000, v117
    v_pk_fma_f32 v[206:207], v[210:211], v[186:187], v[206:207] op_sel_hi:[1,0,1]
    s_waitcnt vmcnt(12)
    v_lshlrev_b32 v208, 16, v118
    v_and_b32 v209, 0xffff0000, v118
    v_pk_fma_f32 v[200:201], v[208:209], v[186:187], v[200:201] op_sel:[0,1,0] op_sel_hi:[1,1,1]
    v_lshlrev_b32 v210, 16, v119
    v_and_b32 v211, 0xffff0000, v119
    v_pk_fma_f32 v[202:203], v[210:211], v[186:187], v[202:203] op_sel:[0,1,0] op_sel_hi:[1,1,1]
    v_lshlrev_b32 v208, 16, v120
    v_and_b32 v209, 0xffff0000, v120
    v_pk_fma_f32 v[204:205], v[208:209], v[186:187], v[204:205] op_sel:[0,1,0] op_sel_hi:[1,1,1]
    v_lshlrev_b32 v210, 16, v121
    v_and_b32 v211, 0xffff0000, v121
    v_pk_fma_f32 v[206:207], v[210:211], v[186:187], v[206:207] op_sel:[0,1,0] op_sel_hi:[1,1,1]
    s_waitcnt vmcnt(11)
    v_lshlrev_b32 v208, 16, v122
    v_and_b32 v209, 0xffff0000, v122
    v_pk_fma_f32 v[200:201], v[208:209], v[188:189], v[200:201] op_sel_hi:[1,0,1]
    v_lshlrev_b32 v210, 16, v123
    v_and_b32 v211, 0xffff0000, v123
    v_pk_fma_f32 v[202:203], v[210:211], v[188:189], v[202:203] op_sel_hi:[1,0,1]
    v_lshlrev_b32 v208, 16, v124
    v_and_b32 v209, 0xffff0000, v124
    v_pk_fma_f32 v[204:205], v[208:209], v[188:189], v[204:205] op_sel_hi:[1,0,1]
    v_lshlrev_b32 v210, 16, v125
    v_and_b32 v211, 0xffff0000, v125
    v_pk_fma_f32 v[206:207], v[210:211], v[188:189], v[206:207] op_sel_hi:[1,0,1]
    s_waitcnt vmcnt(10)
    v_lshlrev_b32 v208, 16, v126
    v_and_b32 v209, 0xffff0000, v126
    v_pk_fma_f32 v[200:201], v[208:209], v[188:189], v[200:201] op_sel:[0,1,0] op_sel_hi:[1,1,1]
    v_lshlrev_b32 v210, 16, v127
    v_and_b32 v211, 0xffff0000, v127
    v_pk_fma_f32 v[202:203], v[210:211], v[188:189], v[202:203] op_sel:[0,1,0] op_sel_hi:[1,1,1]
    v_lshlrev_b32 v208, 16, v128
    v_and_b32 v209, 0xffff0000, v128
    v_pk_fma_f32 v[204:205], v[208:209], v[188:189], v[204:205] op_sel:[0,1,0] op_sel_hi:[1,1,1]
    v_lshlrev_b32 v210, 16, v129
    v_and_b32 v211, 0xffff0000, v129
    v_pk_fma_f32 v[206:207], v[210:211], v[188:189], v[206:207] op_sel:[0,1,0] op_sel_hi:[1,1,1]
    s_waitcnt vmcnt(9)
    v_lshlrev_b32 v208, 16, v130
    v_and_b32 v209, 0xffff0000, v130
    v_pk_fma_f32 v[200:201], v[208:209], v[190:191], v[200:201] op_sel_hi:[1,0,1]
    v_lshlrev_b32 v210, 16, v131
    v_and_b32 v211, 0xffff0000, v131
    v_pk_fma_f32 v[202:203], v[210:211], v[190:191], v[202:203] op_sel_hi:[1,0,1]
    v_lshlrev_b32 v208, 16, v132
    v_and_b32 v209, 0xffff0000, v132
    v_pk_fma_f32 v[204:205], v[208:209], v[190:191], v[204:205] op_sel_hi:[1,0,1]
    v_lshlrev_b32 v210, 16, v133
    v_and_b32 v211, 0xffff0000, v133
    v_pk_fma_f32 v[206:207], v[210:211], v[190:191], v[206:207] op_sel_hi:[1,0,1]
    s_waitcnt vmcnt(8)
    v_lshlrev_b32 v208, 16, v134
    v_and_b32 v209, 0xffff0000, v134
    v_pk_fma_f32 v[200:201], v[208:209], v[190:191], v[200:201] op_sel:[0,1,0] op_sel_hi:[1,1,1]
    v_lshlrev_b32 v210, 16, v135
    v_and_b32 v211, 0xffff0000, v135
    v_pk_fma_f32 v[202:203], v[210:211], v[190:191], v[202:203] op_sel:[0,1,0] op_sel_hi:[1,1,1]
    v_lshlrev_b32 v208, 16, v136
    v_and_b32 v209, 0xffff0000, v136
    v_pk_fma_f32 v[204:205], v[208:209], v[190:191], v[204:205] op_sel:[0,1,0] op_sel_hi:[1,1,1]
    v_lshlrev_b32 v210, 16, v137
    v_and_b32 v211, 0xffff0000, v137
    v_pk_fma_f32 v[206:207], v[210:211], v[190:191], v[206:207] op_sel:[0,1,0] op_sel_hi:[1,1,1]
    s_waitcnt vmcnt(7)
    v_lshlrev_b32 v208, 16, v138
    v_and_b32 v209, 0xffff0000, v138
    v_pk_fma_f32 v[200:201], v[208:209], v[192:193], v[200:201] op_sel_hi:[1,0,1]
    v_lshlrev_b32 v210, 16, v139
    v_and_b32 v211, 0xffff0000, v139
    v_pk_fma_f32 v[202:203], v[210:211], v[192:193], v[202:203] op_sel_hi:[1,0,1]
    v_lshlrev_b32 v208, 16, v140
    v_and_b32 v209, 0xffff0000, v140
    v_pk_fma_f32 v[204:205], v[208:209], v[192:193], v[204:205] op_sel_hi:[1,0,1]
    v_lshlrev_b32 v210, 16, v141
    v_and_b32 v211, 0xffff0000, v141
    v_pk_fma_f32 v[206:207], v[210:211], v[192:193], v[206:207] op_sel_hi:[1,0,1]
    s_waitcnt vmcnt(6)
    v_lshlrev_b32 v208, 16, v142
    v_and_b32 v209, 0xffff0000, v142
    v_pk_fma_f32 v[200:201], v[208:209], v[192:193], v[200:201] op_sel:[0,1,0] op_sel_hi:[1,1,1]
    v_lshlrev_b32 v210, 16, v143
    v_and_b32 v211, 0xffff0000, v143
    v_pk_fma_f32 v[202:203], v[210:211], v[192:193], v[202:203] op_sel:[0,1,0] op_sel_hi:[1,1,1]
    v_lshlrev_b32 v208, 16, v144
    v_and_b32 v209, 0xffff0000, v144
    v_pk_fma_f32 v[204:205], v[208:209], v[192:193], v[204:205] op_sel:[0,1,0] op_sel_hi:[1,1,1]
    v_lshlrev_b32 v210, 16, v145
    v_and_b32 v211, 0xffff0000, v145
    v_pk_fma_f32 v[206:207], v[210:211], v[192:193], v[206:207] op_sel:[0,1,0] op_sel_hi:[1,1,1]
    s_waitcnt vmcnt(5)
    v_lshlrev_b32 v208, 16, v146
    v_and_b32 v209, 0xffff0000, v146
    v_pk_fma_f32 v[200:201], v[208:209], v[194:195], v[200:201] op_sel_hi:[1,0,1]
    v_lshlrev_b32 v210, 16, v147
    v_and_b32 v211, 0xffff0000, v147
    v_pk_fma_f32 v[202:203], v[210:211], v[194:195], v[202:203] op_sel_hi:[1,0,1]
    v_lshlrev_b32 v208, 16, v148
    v_and_b32 v209, 0xffff0000, v148
    v_pk_fma_f32 v[204:205], v[208:209], v[194:195], v[204:205] op_sel_hi:[1,0,1]
    v_lshlrev_b32 v210, 16, v149
    v_and_b32 v211, 0xffff0000, v149
    v_pk_fma_f32 v[206:207], v[210:211], v[194:195], v[206:207] op_sel_hi:[1,0,1]
    s_waitcnt vmcnt(4)
    v_lshlrev_b32 v208, 16, v150
    v_and_b32 v209, 0xffff0000, v150
    v_pk_fma_f32 v[200:201], v[208:209], v[194:195], v[200:201] op_sel:[0,1,0] op_sel_hi:[1,1,1]
    v_lshlrev_b32 v210, 16, v151
    v_and_b32 v211, 0xffff0000, v151
    v_pk_fma_f32 v[202:203], v[210:211], v[194:195], v[202:203] op_sel:[0,1,0] op_sel_hi:[1,1,1]
    v_lshlrev_b32 v208, 16, v152
    v_and_b32 v209, 0xffff0000, v152
    v_pk_fma_f32 v[204:205], v[208:209], v[194:195], v[204:205] op_sel:[0,1,0] op_sel_hi:[1,1,1]
    v_lshlrev_b32 v210, 16, v153
    v_and_b32 v211, 0xffff0000, v153
    v_pk_fma_f32 v[206:207], v[210:211], v[194:195], v[206:207] op_sel:[0,1,0] op_sel_hi:[1,1,1]
    s_waitcnt vmcnt(3)
    v_lshlrev_b32 v208, 16, v154
    v_and_b32 v209, 0xffff0000, v154
    v_pk_fma_f32 v[200:201], v[208:209], v[196:197], v[200:201] op_sel_hi:[1,0,1]
    v_lshlrev_b32 v210, 16, v155
    v_and_b32 v211, 0xffff0000, v155
    v_pk_fma_f32 v[202:203], v[210:211], v[196:197], v[202:203] op_sel_hi:[1,0,1]
    v_lshlrev_b32 v208, 16, v156
    v_and_b32 v209, 0xffff0000, v156
    v_pk_fma_f32 v[204:205], v[208:209], v[196:197], v[204:205] op_sel_hi:[1,0,1]
    v_lshlrev_b32 v210, 16, v157
    v_and_b32 v211, 0xffff0000, v157
    v_pk_fma_f32 v[206:207], v[210:211], v[196:197], v[206:207] op_sel_hi:[1,0,1]
    s_waitcnt vmcnt(2)
    v_lshlrev_b32 v208, 16, v158
    v_and_b32 v209, 0xffff0000, v158
    v_pk_fma_f32 v[200:201], v[208:209], v[196:197], v[200:201] op_sel:[0,1,0] op_sel_hi:[1,1,1]
    v_lshlrev_b32 v210, 16, v159
    v_and_b32 v211, 0xffff0000, v159
    v_pk_fma_f32 v[202:203], v[210:211], v[196:197], v[202:203] op_sel:[0,1,0] op_sel_hi:[1,1,1]
    v_lshlrev_b32 v208, 16, v160
    v_and_b32 v209, 0xffff0000, v160
    v_pk_fma_f32 v[204:205], v[208:209], v[196:197], v[204:205] op_sel:[0,1,0] op_sel_hi:[1,1,1]
    v_lshlrev_b32 v210, 16, v161
    v_and_b32 v211, 0xffff0000, v161
    v_pk_fma_f32 v[206:207], v[210:211], v[196:197], v[206:207] op_sel:[0,1,0] op_sel_hi:[1,1,1]
    s_waitcnt vmcnt(1)
    v_lshlrev_b32 v208, 16, v162
    v_and_b32 v209, 0xffff0000, v162
    v_pk_fma_f32 v[200:201], v[208:209], v[198:199], v[200:201] op_sel_hi:[1,0,1]
    v_lshlrev_b32 v210, 16, v163
    v_and_b32 v211, 0xffff0000, v163
    v_pk_fma_f32 v[202:203], v[210:211], v[198:199], v[202:203] op_sel_hi:[1,0,1]
    v_lshlrev_b32 v208, 16, v164
    v_and_b32 v209, 0xffff0000, v164
    v_pk_fma_f32 v[204:205], v[208:209], v[198:199], v[204:205] op_sel_hi:[1,0,1]
    v_lshlrev_b32 v210, 16, v165
    v_and_b32 v211, 0xffff0000, v165
    v_pk_fma_f32 v[206:207], v[210:211], v[198:199], v[206:207] op_sel_hi:[1,0,1]
    s_waitcnt vmcnt(0)
    v_lshlrev_b32 v208, 16, v166
    v_and_b32 v209, 0xffff0000, v166
    v_pk_fma_f32 v[200:201], v[208:209], v[198:199], v[200:201] op_sel:[0,1,0] op_sel_hi:[1,1,1]
    v_lshlrev_b32 v210, 16, v167
    v_and_b32 v211, 0xffff0000, v167
    v_pk_fma_f32 v[202:203], v[210:211], v[198:199], v[202:203] op_sel:[0,1,0] op_sel_hi:[1,1,1]
    v_lshlrev_b32 v208, 16, v168
    v_and_b32 v209, 0xffff0000, v168
    v_pk_fma_f32 v[204:205], v[208:209], v[198:199], v[204:205] op_sel:[0,1,0] op_sel_hi:[1,1,1]
    v_lshlrev_b32 v210, 16, v169
    v_and_b32 v211, 0xffff0000, v169
    v_pk_fma_f32 v[206:207], v[210:211], v[198:199], v[206:207] op_sel:[0,1,0] op_sel_hi:[1,1,1]
    v_readfirstlane_b32 s48, v246
    s_mul_i32 s48, s48, 0x9E3779B1
    s_add_u32 s48, s48, 0x7F4A7C15
    v_lshlrev_b32 v2, 5, v0
    ds_write_b128 v2, v[200:203] offset:0
    ds_write_b128 v2, v[204:207] offset:16
    s_waitcnt lgkmcnt(0)
    s_barrier
    s_cmp_eq_u32 s3, 0
    s_cbranch_scc0 L_mod_done
    v_lshlrev_b32 v2, 2, v1
    ds_read_b32 v80, v2 offset:0
    ds_read_b32 v81, v2 offset:256
    ds_read_b32 v82, v2 offset:512
    ds_read_b32 v83, v2 offset:768
    ds_read_b32 v84, v2 offset:1024
    ds_read_b32 v85, v2 offset:1280
    ds_read_b32 v86, v2 offset:1536
    ds_read_b32 v87, v2 offset:1792
    ds_read_b32 v88, v2 offset:2048
    ds_read_b32 v89, v2 offset:2304
    ds_read_b32 v90, v2 offset:2560
    ds_read_b32 v91, v2 offset:2816
    ds_read_b32 v92, v2 offset:3072
    ds_read_b32 v93, v2 offset:3328
    ds_read_b32 v94, v2 offset:3584
    ds_read_b32 v95, v2 offset:3840
    ds_read_b32 v96, v2 offset:4096
    ds_read_b32 v97, v2 offset:4352
    ds_read_b32 v98, v2 offset:4608
    ds_read_b32 v99, v2 offset:4864
    ds_read_b32 v100, v2 offset:5120
    ds_read_b32 v101, v2 offset:5376
    ds_read_b32 v102, v2 offset:5632
    ds_read_b32 v103, v2 offset:5888
    ds_read_b32 v104, v2 offset:6144
    ds_read_b32 v105, v2 offset:6400
    ds_read_b32 v106, v2 offset:6656
    ds_read_b32 v107, v2 offset:6912
    ds_read_b32 v108, v2 offset:7168
    ds_read_b32 v109, v2 offset:7424
    ds_read_b32 v110, v2 offset:7680
    ds_read_b32 v111, v2 offset:7936
    s_waitcnt lgkmcnt(14)
    v_add_f32 v80, v80, v96
    v_add_f32 v81, v81, v97
    s_waitcnt lgkmcnt(13)
    v_add_f32 v82, v82, v98
    s_waitcnt lgkmcnt(12)
    v_add_f32 v83, v83, v99
    s_waitcnt lgkmcnt(11)
    v_add_f32 v84, v84, v100
    s_waitcnt lgkmcnt(10)
    v_add_f32 v85, v85, v101
    s_waitcnt lgkmcnt(9)
    v_add_f32 v86, v86, v102
    s_waitcnt lgkmcnt(8)
    v_add_f32 v87, v87, v103
    s_waitcnt lgkmcnt(7)
    v_add_f32 v88, v88, v104
    s_waitcnt lgkmcnt(6)
    v_add_f32 v89, v89, v105
    s_waitcnt lgkmcnt(5)
    v_add_f32 v90, v90, v106
    s_waitcnt lgkmcnt(4)
    v_add_f32 v91, v91, v107
    s_waitcnt lgkmcnt(3)
    v_add_f32 v92, v92, v108
    s_waitcnt lgkmcnt(2)
    v_add_f32 v93, v93, v109
    s_waitcnt lgkmcnt(1)
    v_add_f32 v94, v94, v110
    s_waitcnt lgkmcnt(0)
    v_add_f32 v95, v95, v111
    v_add_f32 v80, v80, v88
    v_add_f32 v81, v81, v89
    v_add_f32 v82, v82, v90
    v_add_f32 v83, v83, v91
    v_add_f32 v84, v84, v92
    v_add_f32 v85, v85, v93
    v_add_f32 v86, v86, v94
    v_add_f32 v87, v87, v95
    v_add_f32 v80, v80, v84
    v_add_f32 v81, v81, v85
    v_add_f32 v82, v82, v86
    v_add_f32 v83, v83, v87
    v_add_f32 v80, v80, v82
    v_add_f32 v81, v81, v83
    v_add_f32 v80, v80, v81
    s_mov_b32 s50, 429496730
    s_mul_hi_u32 s51, s77, s50
    s_mul_i32 s52, s51, 10
    s_sub_u32 s52, s77, s52
    v_cvt_pk_bf16_f32 v3, v80, v80
    v_lshlrev_b32 v3, 16, v3
    v_add_f32 v4, 1.0, v3
    v_cvt_pk_bf16_f32 v4, v4, v4
    v_lshlrev_b32 v4, 16, v4
    s_cmp_eq_u32 s51, 1
    s_cselect_b64 vcc, -1, 0
    s_cmp_eq_u32 s51, 4
    s_cselect_b64 vcc, -1, vcc
    v_cndmask_b32 v3, v3, v4, vcc
    s_cmp_eq_u32 s51, 4
    s_cbranch_scc0 L_mod_noicb
    v_cmp_eq_f32 vcc, 0, v3
    v_mov_b32 v4, 0x2b800000
    s_nop 0
    v_cndmask_b32 v3, v3, v4, vcc
    v_rcp_f32 v4, v3
    s_lshl_b32 s53, s52, 8
    s_add_u32 s53, s53, 23183360
    v_fma_f32 v5, -v3, v4, 1.0
    v_fmac_f32 v4, v5, v4
    buffer_store_dword v4, v2, s[36:39], s53 offen sc1
    buffer_store_dword v4, v2, s[36:39], s53 offen offset:2560 sc1
L_mod_noicb:
    v_mov_b32 v4, v3
    v_mov_b32 v5, s48
    v_lshlrev_b32 v6, 3, v1
    s_lshl_b32 s53, s77, 9
    s_add_u32 s53, s53, 23560192
    buffer_store_dwordx2 v[4:5], v6, s[36:39], s53 offen sc1
    s_lshl_b32 s53, s77, 8
    s_add_u32 s53, s53, 23134208
    buffer_store_dword v3, v2, s[36:39], s53 offen sc1
    s_sub_u32 s53, s51, 3
    s_cmp_lt_u32 s53, 2
    s_cbranch_scc0 L_mod_done
    v_mov_b32_dpp v4, v3 quad_perm:[1,0,3,2] row_mask:0xf bank_mask:0xf
    v_lshrrev_b32 v5, 16, v3
    v_or_b32 v5, v5, v4
    v_lshrrev_b32 v6, 5, v1
    v_lshlrev_b32 v6, 7, v6
    v_bfe_u32 v7, v1, 2, 2
    v_lshl_add_u32 v6, v7, 4, v6
    v_bfe_u32 v7, v1, 4, 1
    v_lshl_add_u32 v6, v7, 3, v6
    v_and_b32 v7, 2, v1
    v_lshl_add_u32 v6, v7, 1, v6
    s_xor_b32 s53, s53, 1
    s_lshl_b32 s53, s53, 6
    s_lshl_b32 s52, s52, 8
    s_add_u32 s53, s53, s52
    s_add_u32 s53, s53, 23166976
    s_mov_b32 exec_lo, 0x55555555
    s_mov_b32 exec_hi, 0x55555555
    buffer_store_dword v5, v6, s[36:39], s53 offen sc1
    buffer_store_dword v5, v6, s[36:39], s53 offen offset:2560 sc1
    s_mov_b64 exec, -1
L_mod_done:
    s_add_u32 s77, s77, 40
    s_branch L_p_w
L_p_b:
    s_mov_b32 s36, s32
    s_mov_b32 s37, s33
    s_mov_b32 s38, 0x10000000
    s_mov_b32 s39, 0x20000
    v_mov_b32 v2, 0
    s_mov_b32 s57, 23461888
    buffer_load_dword v246, v2, s[36:39], s57 offen sc1
    s_mov_b32 s49, 400000
    s_and_b32 s50, s2, 7
    s_lshr_b32 s51, s2, 3
    s_lshr_b32 s60, s50, 2
    s_lshl_b32 s60, s60, 3
    s_lshr_b32 s61, s51, 2
    s_add_u32 s72, s60, s61
    s_lshl_b32 s61, s61, 3
    s_mov_b32 s62, 0x6040200
    s_mov_b32 s63, 0x70308
    s_lshr_b64 s[62:63], s[62:63], s61
    s_and_b32 s34, s62, 255
    s_lshr_b32 s62, s50, 2
    s_mul_i32 s62, s62, 10
    s_add_u32 s34, s34, s62
    s_sub_u32 s62, s34, 20
    s_min_u32 s34, s34, s62
    s_and_b32 s60, s50, 3
    s_lshl_b32 s60, s60, 2
    s_and_b32 s61, s51, 3
    s_add_u32 s73, s60, s61
    s_and_b32 s75, s51, 7
    s_lshr_b32 s61, s51, 3
    s_lshl_b32 s60, s50, 2
    s_add_u32 s74, s60, s61
    s_mul_i32 s70, s50, 20
    s_add_u32 s70, s70, s51
    s_lshl_b32 s60, s50, 1
    s_cmp_ge_u32 s51, 10
    s_addc_u32 s60, s60, 0
    s_cmp_ge_u32 s51, 10
    s_cselect_b32 s61, 10, 0
    s_sub_u32 s61, s51, s61
    s_lshl_b32 s61, s61, 4
    s_add_u32 s76, s60, s61
    s_lshl_b32 s58, s70, 2
    s_add_u32 s58, s58, s3
    v_lshlrev_b32 v248, 4, v1
    s_waitcnt vmcnt(0)
    v_readfirstlane_b32 s48, v246
    s_mul_i32 s48, s48, 0x9E3779B1
    s_add_u32 s48, s48, 0x7F4A7C15
    s_mov_b32 s76, s65
    s_add_u32 s77, s71, 1048
    s_branch L_p_w
L_p_s:
    s_mov_b32 s36, s32
    s_mov_b32 s37, s33
    s_mov_b32 s38, 0x10000000
    s_mov_b32 s39, 0x20000
    v_mov_b32 v2, 0
    s_mov_b32 s57, 23461888
    buffer_load_dword v246, v2, s[36:39], s57 offen sc1
    s_mov_b32 s49, 400000
    s_and_b32 s50, s2, 7
    s_lshr_b32 s51, s2, 3
    s_lshr_b32 s60, s50, 2
    s_lshl_b32 s60, s60, 3
    s_lshr_b32 s61, s51, 2
    s_add_u32 s72, s60, s61
    s_lshl_b32 s61, s61, 3
    s_mov_b32 s62, 0x6040200
    s_mov_b32 s63, 0x70308
    s_lshr_b64 s[62:63], s[62:63], s61
    s_and_b32 s34, s62, 255
    s_lshr_b32 s62, s50, 2
    s_mul_i32 s62, s62, 10
    s_add_u32 s34, s34, s62
    s_sub_u32 s62, s34, 20
    s_min_u32 s34, s34, s62
    s_and_b32 s60, s50, 3
    s_lshl_b32 s60, s60, 2
    s_and_b32 s61, s51, 3
    s_add_u32 s73, s60, s61
    s_and_b32 s75, s51, 7
    s_lshr_b32 s61, s51, 3
    s_lshl_b32 s60, s50, 2
    s_add_u32 s74, s60, s61
    s_mul_i32 s70, s50, 20
    s_add_u32 s70, s70, s51
    s_lshl_b32 s60, s50, 1
    s_cmp_ge_u32 s51, 10
    s_addc_u32 s60, s60, 0
    s_cmp_ge_u32 s51, 10
    s_cselect_b32 s61, 10, 0
    s_sub_u32 s61, s51, s61
    s_lshl_b32 s61, s61, 4
    s_add_u32 s76, s60, s61
    s_lshl_b32 s58, s70, 2
    s_add_u32 s58, s58, s3
    v_lshlrev_b32 v248, 4, v1
    s_mov_b32 s44, s4
    s_mov_b32 s45, s5
    s_mov_b32 s46, 0x280000
    s_mov_b32 s47, 0x20000
    s_lshl_b32 s50, s77, 2
    s_add_u32 s50, s50, s3
    s_mul_i32 s56, s50, 20480
    v_lshrrev_b32 v2, 4, v1
    v_mul_u32_u24 v2, 1280, v2
    v_and_b32 v3, 15, v1
    v_lshl_add_u32 v2, v3, 4, v2
    buffer_load_dwordx4 v[16:19], v2, s[44:47], s56 offen offset:0 nt
    buffer_load_dwordx4 v[20:23], v2, s[44:47], s56 offen offset:256 nt
    buffer_load_dwordx4 v[24:27], v2, s[44:47], s56 offen offset:512 nt
    buffer_load_dwordx4 v[28:31], v2, s[44:47], s56 offen offset:768 nt
    buffer_load_dwordx4 v[32:35], v2, s[44:47], s56 offen offset:1024 nt
    s_add_u32 s56, s56, 5120
    buffer_load_dwordx4 v[36:39], v2, s[44:47], s56 offen offset:0 nt
    buffer_load_dwordx4 v[40:43], v2, s[44:47], s56 offen offset:256 nt
    buffer_load_dwordx4 v[44:47], v2, s[44:47], s56 offen offset:512 nt
    buffer_load_dwordx4 v[48:51], v2, s[44:47], s56 offen offset:768 nt
    buffer_load_dwordx4 v[52:55], v2, s[44:47], s56 offen offset:1024 nt
    s_add_u32 s56, s56, 5120
    buffer_load_dwordx4 v[56:59], v2, s[44:47], s56 offen offset:0 nt
    buffer_load_dwordx4 v[60:63], v2, s[44:47], s56 offen offset:256 nt
    buffer_load_dwordx4 v[64:67], v2, s[44:47], s56 offen offset:512 nt
    buffer_load_dwordx4 v[68:71], v2, s[44:47], s56 offen offset:768 nt
    buffer_load_dwordx4 v[72:75], v2, s[44:47], s56 offen offset:1024 nt
    s_add_u32 s56, s56, 5120
    buffer_load_dwordx4 v[76:79], v2, s[44:47], s56 offen offset:0 nt
    buffer_load_dwordx4 v[80:83], v2, s[44:47], s56 offen offset:256 nt
    buffer_load_dwordx4 v[84:87], v2, s[44:47], s56 offen offset:512 nt
    buffer_load_dwordx4 v[88:91], v2, s[44:47], s56 offen offset:768 nt
    buffer_load_dwordx4 v[92:95], v2, s[44:47], s56 offen offset:1024 nt
    s_mov_b32 s76, s65
    s_mov_b32 s50, 0x3f803f80
    v_mov_b32 v180, 0
    v_mov_b32 v181, 0
    v_mov_b32 v182, 0
    v_mov_b32 v183, 0
    v_mov_b32 v184, 0
    v_mov_b32 v185, 0
    v_mov_b32 v186, 0
    v_mov_b32 v187, 0
    s_waitcnt vmcnt(19)
    v_dot2_f32_bf16 v180, v16, s50, v180
    v_dot2_f32_bf16 v184, v16, v16, v184
    v_dot2_f32_bf16 v180, v17, s50, v180
    v_dot2_f32_bf16 v184, v17, v17, v184
    v_dot2_f32_bf16 v180, v18, s50, v180
    v_dot2_f32_bf16 v184, v18, v18, v184
    v_dot2_f32_bf16 v180, v19, s50, v180
    v_dot2_f32_bf16 v184, v19, v19, v184
    s_waitcnt vmcnt(18)
    v_dot2_f32_bf16 v180, v20, s50, v180
    v_dot2_f32_bf16 v184, v20, v20, v184
    v_dot2_f32_bf16 v180, v21, s50, v180
    v_dot2_f32_bf16 v184, v21, v21, v184
    v_dot2_f32_bf16 v180, v22, s50, v180
    v_dot2_f32_bf16 v184, v22, v22, v184
    v_dot2_f32_bf16 v180, v23, s50, v180
    v_dot2_f32_bf16 v184, v23, v23, v184
    s_waitcnt vmcnt(17)
    v_dot2_f32_bf16 v180, v24, s50, v180
    v_dot2_f32_bf16 v184, v24, v24, v184
    v_dot2_f32_bf16 v180, v25, s50, v180
    v_dot2_f32_bf16 v184, v25, v25, v184
    v_dot2_f32_bf16 v180, v26, s50, v180
    v_dot2_f32_bf16 v184, v26, v26, v184
    v_dot2_f32_bf16 v180, v27, s50, v180
    v_dot2_f32_bf16 v184, v27, v27, v184
    s_waitcnt vmcnt(16)
    v_dot2_f32_bf16 v180, v28, s50, v180
    v_dot2_f32_bf16 v184, v28, v28, v184
    v_dot2_f32_bf16 v180, v29, s50, v180
    v_dot2_f32_bf16 v184, v29, v29, v184
    v_dot2_f32_bf16 v180, v30, s50, v180
    v_dot2_f32_bf16 v184, v30, v30, v184
    v_dot2_f32_bf16 v180, v31, s50, v180
    v_dot2_f32_bf16 v184, v31, v31, v184
    s_waitcnt vmcnt(15)
    v_dot2_f32_bf16 v180, v32, s50, v180
    v_dot2_f32_bf16 v184, v32, v32, v184
    v_dot2_f32_bf16 v180, v33, s50, v180
    v_dot2_f32_bf16 v184, v33, v33, v184
    v_dot2_f32_bf16 v180, v34, s50, v180
    v_dot2_f32_bf16 v184, v34, v34, v184
    v_dot2_f32_bf16 v180, v35, s50, v180
    v_dot2_f32_bf16 v184, v35, v35, v184
    s_waitcnt vmcnt(14)
    v_dot2_f32_bf16 v181, v36, s50, v181
    v_dot2_f32_bf16 v185, v36, v36, v185
    v_dot2_f32_bf16 v181, v37, s50, v181
    v_dot2_f32_bf16 v185, v37, v37, v185
    v_dot2_f32_bf16 v181, v38, s50, v181
    v_dot2_f32_bf16 v185, v38, v38, v185
    v_dot2_f32_bf16 v181, v39, s50, v181
    v_dot2_f32_bf16 v185, v39, v39, v185
    s_waitcnt vmcnt(13)
    v_dot2_f32_bf16 v181, v40, s50, v181
    v_dot2_f32_bf16 v185, v40, v40, v185
    v_dot2_f32_bf16 v181, v41, s50, v181
    v_dot2_f32_bf16 v185, v41, v41, v185
    v_dot2_f32_bf16 v181, v42, s50, v181
    v_dot2_f32_bf16 v185, v42, v42, v185
    v_dot2_f32_bf16 v181, v43, s50, v181
    v_dot2_f32_bf16 v185, v43, v43, v185
    s_waitcnt vmcnt(12)
    v_dot2_f32_bf16 v181, v44, s50, v181
    v_dot2_f32_bf16 v185, v44, v44, v185
    v_dot2_f32_bf16 v181, v45, s50, v181
    v_dot2_f32_bf16 v185, v45, v45, v185
    v_dot2_f32_bf16 v181, v46, s50, v181
    v_dot2_f32_bf16 v185, v46, v46, v185
    v_dot2_f32_bf16 v181, v47, s50, v181
    v_dot2_f32_bf16 v185, v47, v47, v185
    s_waitcnt vmcnt(11)
    v_dot2_f32_bf16 v181, v48, s50, v181
    v_dot2_f32_bf16 v185, v48, v48, v185
    v_dot2_f32_bf16 v181, v49, s50, v181
    v_dot2_f32_bf16 v185, v49, v49, v185
    v_dot2_f32_bf16 v181, v50, s50, v181
    v_dot2_f32_bf16 v185, v50, v50, v185
    v_dot2_f32_bf16 v181, v51, s50, v181
    v_dot2_f32_bf16 v185, v51, v51, v185
    s_waitcnt vmcnt(10)
    v_dot2_f32_bf16 v181, v52, s50, v181
    v_dot2_f32_bf16 v185, v52, v52, v185
    v_dot2_f32_bf16 v181, v53, s50, v181
    v_dot2_f32_bf16 v185, v53, v53, v185
    v_dot2_f32_bf16 v181, v54, s50, v181
    v_dot2_f32_bf16 v185, v54, v54, v185
    v_dot2_f32_bf16 v181, v55, s50, v181
    v_dot2_f32_bf16 v185, v55, v55, v185
    s_waitcnt vmcnt(9)
    v_dot2_f32_bf16 v182, v56, s50, v182
    v_dot2_f32_bf16 v186, v56, v56, v186
    v_dot2_f32_bf16 v182, v57, s50, v182
    v_dot2_f32_bf16 v186, v57, v57, v186
    v_dot2_f32_bf16 v182, v58, s50, v182
    v_dot2_f32_bf16 v186, v58, v58, v186
    v_dot2_f32_bf16 v182, v59, s50, v182
    v_dot2_f32_bf16 v186, v59, v59, v186
    s_waitcnt vmcnt(8)
    v_dot2_f32_bf16 v182, v60, s50, v182
    v_dot2_f32_bf16 v186, v60, v60, v186
    v_dot2_f32_bf16 v182, v61, s50, v182
    v_dot2_f32_bf16 v186, v61, v61, v186
    v_dot2_f32_bf16 v182, v62, s50, v182
    v_dot2_f32_bf16 v186, v62, v62, v186
    v_dot2_f32_bf16 v182, v63, s50, v182
    v_dot2_f32_bf16 v186, v63, v63, v186
    s_waitcnt vmcnt(7)
    v_dot2_f32_bf16 v182, v64, s50, v182
    v_dot2_f32_bf16 v186, v64, v64, v186
    v_dot2_f32_bf16 v182, v65, s50, v182
    v_dot2_f32_bf16 v186, v65, v65, v186
    v_dot2_f32_bf16 v182, v66, s50, v182
    v_dot2_f32_bf16 v186, v66, v66, v186
    v_dot2_f32_bf16 v182, v67, s50, v182
    v_dot2_f32_bf16 v186, v67, v67, v186
    s_waitcnt vmcnt(6)
    v_dot2_f32_bf16 v182, v68, s50, v182
    v_dot2_f32_bf16 v186, v68, v68, v186
    v_dot2_f32_bf16 v182, v69, s50, v182
    v_dot2_f32_bf16 v186, v69, v69, v186
    v_dot2_f32_bf16 v182, v70, s50, v182
    v_dot2_f32_bf16 v186, v70, v70, v186
    v_dot2_f32_bf16 v182, v71, s50, v182
    v_dot2_f32_bf16 v186, v71, v71, v186
    s_waitcnt vmcnt(5)
    v_dot2_f32_bf16 v182, v72, s50, v182
    v_dot2_f32_bf16 v186, v72, v72, v186
    v_dot2_f32_bf16 v182, v73, s50, v182
    v_dot2_f32_bf16 v186, v73, v73, v186
    v_dot2_f32_bf16 v182, v74, s50, v182
    v_dot2_f32_bf16 v186, v74, v74, v186
    v_dot2_f32_bf16 v182, v75, s50, v182
    v_dot2_f32_bf16 v186, v75, v75, v186
    s_waitcnt vmcnt(4)
    v_dot2_f32_bf16 v183, v76, s50, v183
    v_dot2_f32_bf16 v187, v76, v76, v187
    v_dot2_f32_bf16 v183, v77, s50, v183
    v_dot2_f32_bf16 v187, v77, v77, v187
    v_dot2_f32_bf16 v183, v78, s50, v183
    v_dot2_f32_bf16 v187, v78, v78, v187
    v_dot2_f32_bf16 v183, v79, s50, v183
    v_dot2_f32_bf16 v187, v79, v79, v187
    s_waitcnt vmcnt(3)
    v_dot2_f32_bf16 v183, v80, s50, v183
    v_dot2_f32_bf16 v187, v80, v80, v187
    v_dot2_f32_bf16 v183, v81, s50, v183
    v_dot2_f32_bf16 v187, v81, v81, v187
    v_dot2_f32_bf16 v183, v82, s50, v183
    v_dot2_f32_bf16 v187, v82, v82, v187
    v_dot2_f32_bf16 v183, v83, s50, v183
    v_dot2_f32_bf16 v187, v83, v83, v187
    s_waitcnt vmcnt(2)
    v_dot2_f32_bf16 v183, v84, s50, v183
    v_dot2_f32_bf16 v187, v84, v84, v187
    v_dot2_f32_bf16 v183, v85, s50, v183
    v_dot2_f32_bf16 v187, v85, v85, v187
    v_dot2_f32_bf16 v183, v86, s50, v183
    v_dot2_f32_bf16 v187, v86, v86, v187
    v_dot2_f32_bf16 v183, v87, s50, v183
    v_dot2_f32_bf16 v187, v87, v87, v187
    s_waitcnt vmcnt(1)
    v_dot2_f32_bf16 v183, v88, s50, v183
    v_dot2_f32_bf16 v187, v88, v88, v187
    v_dot2_f32_bf16 v183, v89, s50, v183
    v_dot2_f32_bf16 v187, v89, v89, v187
    v_dot2_f32_bf16 v183, v90, s50, v183
    v_dot2_f32_bf16 v187, v90, v90, v187
    v_dot2_f32_bf16 v183, v91, s50, v183
    v_dot2_f32_bf16 v187, v91, v91, v187
    s_waitcnt vmcnt(0)
    v_dot2_f32_bf16 v183, v92, s50, v183
    v_dot2_f32_bf16 v187, v92, v92, v187
    v_dot2_f32_bf16 v183, v93, s50, v183
    v_dot2_f32_bf16 v187, v93, v93, v187
    v_dot2_f32_bf16 v183, v94, s50, v183
    v_dot2_f32_bf16 v187, v94, v94, v187
    v_dot2_f32_bf16 v183, v95, s50, v183
    v_dot2_f32_bf16 v187, v95, v95, v187
    s_nop 2
    v_add_f32_dpp v180, v180, v180 row_ror:8 row_mask:0xf bank_mask:0xf
    v_add_f32_dpp v181, v181, v181 row_ror:8 row_mask:0xf bank_mask:0xf
    v_add_f32_dpp v182, v182, v182 row_ror:8 row_mask:0xf bank_mask:0xf
    v_add_f32_dpp v183, v183, v183 row_ror:8 row_mask:0xf bank_mask:0xf
    v_add_f32_dpp v184, v184, v184 row_ror:8 row_mask:0xf bank_mask:0xf
    v_add_f32_dpp v185, v185, v185 row_ror:8 row_mask:0xf bank_mask:0xf
    v_add_f32_dpp v186, v186, v186 row_ror:8 row_mask:0xf bank_mask:0xf
    v_add_f32_dpp v187, v187, v187 row_ror:8 row_mask:0xf bank_mask:0xf
    v_add_f32_dpp v180, v180, v180 row_ror:4 row_mask:0xf bank_mask:0xf
    v_add_f32_dpp v181, v181, v181 row_ror:4 row_mask:0xf bank_mask:0xf
    v_add_f32_dpp v182, v182, v182 row_ror:4 row_mask:0xf bank_mask:0xf
    v_add_f32_dpp v183, v183, v183 row_ror:4 row_mask:0xf bank_mask:0xf
    v_add_f32_dpp v184, v184, v184 row_ror:4 row_mask:0xf bank_mask:0xf
    v_add_f32_dpp v185, v185, v185 row_ror:4 row_mask:0xf bank_mask:0xf
    v_add_f32_dpp v186, v186, v186 row_ror:4 row_mask:0xf bank_mask:0xf
    v_add_f32_dpp v187, v187, v187 row_ror:4 row_mask:0xf bank_mask:0xf
    v_add_f32_dpp v180, v180, v180 row_ror:2 row_mask:0xf bank_mask:0xf
    v_add_f32_dpp v181, v181, v181 row_ror:2 row_mask:0xf bank_mask:0xf
    v_add_f32_dpp v182, v182, v182 row_ror:2 row_mask:0xf bank_mask:0xf
    v_add_f32_dpp v183, v183, v183 row_ror:2 row_mask:0xf bank_mask:0xf
    v_add_f32_dpp v184, v184, v184 row_ror:2 row_mask:0xf bank_mask:0xf
    v_add_f32_dpp v185, v185, v185 row_ror:2 row_mask:0xf bank_mask:0xf
    v_add_f32_dpp v186, v186, v186 row_ror:2 row_mask:0xf bank_mask:0xf
    v_add_f32_dpp v187, v187, v187 row_ror:2 row_mask:0xf bank_mask:0xf
    v_add_f32_dpp v180, v180, v180 row_ror:1 row_mask:0xf bank_mask:0xf
    v_add_f32_dpp v181, v181, v181 row_ror:1 row_mask:0xf bank_mask:0xf
    v_add_f32_dpp v182, v182, v182 row_ror:1 row_mask:0xf bank_mask:0xf
    v_add_f32_dpp v183, v183, v183 row_ror:1 row_mask:0xf bank_mask:0xf
    v_add_f32_dpp v184, v184, v184 row_ror:1 row_mask:0xf bank_mask:0xf
    v_add_f32_dpp v185, v185, v185 row_ror:1 row_mask:0xf bank_mask:0xf
    v_add_f32_dpp v186, v186, v186 row_ror:1 row_mask:0xf bank_mask:0xf
    v_add_f32_dpp v187, v187, v187 row_ror:1 row_mask:0xf bank_mask:0xf
    v_and_b32 v3, 15, v1
    v_cmp_eq_u32 vcc, 1, v3
    s_nop 1
    v_cndmask_b32 v180, v180, v181, vcc
    v_cndmask_b32 v184, v184, v185, vcc
    v_cmp_eq_u32 vcc, 2, v3
    s_nop 1
    v_cndmask_b32 v180, v180, v182, vcc
    v_cndmask_b32 v184, v184, v186, vcc
    v_cmp_eq_u32 vcc, 3, v3
    s_nop 1
    v_cndmask_b32 v180, v180, v183, vcc
    v_cndmask_b32 v184, v184, v187, vcc
    v_mul_f32 v180, 0x3acccccd, v180
    v_mul_f32 v190, v180, v180
    v_mov_b32 v188, 0x3acccccd
    v_fma_f32 v184, v184, v188, -v190
    v_max_f32 v184, 0, v184
    v_add_f32 v184, 0x3727c5ac, v184
    v_rsq_f32 v188, v184
    s_nop 0
    v_mul_f32_e64 v189, -v180, v188
    v_lshrrev_b32 v2, 4, v1
    v_lshl_add_u32 v2, v3, 2, v2
    v_lshlrev_b32 v2, 2, v2
    s_lshl_b32 s50, s77, 2
    s_add_u32 s50, s50, s3
    s_lshl_b32 s50, s50, 6
    s_add_u32 s50, s50, 23068672
    s_cmp_lt_u32 s77, 32
    s_cselect_b32 s50, s50, 268435456
    s_add_u32 s51, s50, 8192
    s_mov_b32 exec_lo, 0x000f000f
    s_mov_b32 exec_hi, 0x000f000f
    buffer_store_dword v188, v2, s[36:39], s50 offen sc1
    buffer_store_dword v189, v2, s[36:39], s51 offen sc1
    s_mov_b64 exec, -1
    s_waitcnt vmcnt(0) lgkmcnt(0)
    s_barrier
    v_readfirstlane_b32 s48, v246
    s_mul_i32 s48, s48, 0x9E3779B1
    s_add_u32 s48, s48, 0x7F4A7C15
    s_cmp_eq_u32 s3, 0
    s_cbranch_scc0 L_wf15
    s_lshl_b32 s54, s77, 7
    s_add_u32 s54, s54, 23220224
    v_mov_b32 v2, 0
    v_mov_b32 v3, s48
    s_mov_b64 exec, 1
    buffer_store_dword v3, v2, s[36:39], s54 offen sc1
    s_mov_b64 exec, -1
L_wf15:
L_p_w:
    s_mov_b32 s56, s22
    s_mov_b32 s57, s23
    s_mov_b32 s58, 0x1e0000
    s_mov_b32 s59, 0x20000
    s_and_b32 s50, s3, 1
    s_mul_i32 s61, s50, 3104
    s_mul_i32 s50, s50, 12288
    s_mul_i32 s64, s73, 192
    s_add_u32 s64, s64, s50
    s_mul_i32 s50, s34, 98304
    s_add_u32 s64, s64, s50
    s_cmp_ge_u32 s3, 2
    s_cselect_b32 s40, s20, s18
    s_cselect_b32 s41, s21, s19
    s_cselect_b32 s50, 6224, 0
    s_add_u32 s61, s61, s50
    s_mov_b32 s42, 1966080
    s_mov_b32 s43, 0x20000
    v_add_u32 v2, 0, v1
    v_mul_u32_u24 v3, 171, v2
    v_lshrrev_b32 v3, 11, v3
    v_mul_u32_u24 v4, 12, v3
    v_sub_u32 v4, v2, v4
    v_and_b32 v2, 12, v3
    v_add_u32 v3, v3, v2
    v_mul_u32_u24 v3, 3072, v3
    v_lshl_add_u32 v230, v4, 4, v3
    v_add_u32 v2, 64, v1
    v_mul_u32_u24 v3, 171, v2
    v_lshrrev_b32 v3, 11, v3
    v_mul_u32_u24 v4, 12, v3
    v_sub_u32 v4, v2, v4
    v_and_b32 v2, 12, v3
    v_add_u32 v3, v3, v2
    v_mul_u32_u24 v3, 3072, v3
    v_lshl_add_u32 v231, v4, 4, v3
    v_subrev_u32 v231, 1024, v231
    v_add_u32 v2, 128, v1
    v_mul_u32_u24 v3, 171, v2
    v_lshrrev_b32 v3, 11, v3
    v_mul_u32_u24 v4, 12, v3
    v_sub_u32 v4, v2, v4
    v_and_b32 v2, 12, v3
    v_add_u32 v3, v3, v2
    v_mul_u32_u24 v3, 3072, v3
    v_lshl_add_u32 v232, v4, 4, v3
    v_subrev_u32 v232, 2048, v232
    s_mul_i32 s50, s3, 48
    v_lshrrev_b32 v2, 5, v1
    v_bfe_u32 v3, v1, 2, 2
    v_lshl_add_u32 v2, v2, 2, v3
    v_mul_u32_u24 v2, 192, v2
    v_bfe_u32 v3, v1, 4, 1
    v_mul_u32_u24 v3, 3104, v3
    v_add3_u32 v2, v2, v3, s50
    v_and_b32 v3, 3, v1
    v_lshl_add_u32 v233, v3, 3, v2
    v_and_b32 v3, 1, v1
    v_lshl_add_u32 v2, v3, 3, v2
    v_bfe_u32 v3, v1, 1, 1
    v_mul_u32_u24 v3, 6224, v3
    v_add3_u32 v234, v2, v3, 32
    v_add_u32 v233, 8192, v233
    v_add_u32 v234, 8192, v234
    v_add_u32 v238, 49664, v233
    v_add_u32 v239, 49664, v234
    s_cmp_eq_u32 s76, 1
    s_cbranch_scc1 L_bias
    s_add_u32 m0, s61, 8192
    s_nop 0
    buffer_load_dwordx4 v230, s[40:43], s64 offen offset:0 lds
    buffer_load_dwordx4 v231, s[40:43], s64 offen offset:1024 lds
    buffer_load_dwordx4 v232, s[40:43], s64 offen offset:2048 lds
    s_add_u32 s64, s64, 98304
    s_sub_u32 s35, s64, 1966080
    s_min_u32 s64, s64, s35
    s_add_u32 m0, s61, 20608
    s_nop 0
    buffer_load_dwordx4 v230, s[40:43], s64 offen offset:0 lds
    buffer_load_dwordx4 v231, s[40:43], s64 offen offset:1024 lds
    buffer_load_dwordx4 v232, s[40:43], s64 offen offset:2048 lds
    s_add_u32 s64, s64, 98304
    s_sub_u32 s35, s64, 1966080
    s_min_u32 s64, s64, s35
    s_add_u32 m0, s61, 33024
    s_nop 0
    buffer_load_dwordx4 v230, s[40:43], s64 offen offset:0 lds
    buffer_load_dwordx4 v231, s[40:43], s64 offen offset:1024 lds
    buffer_load_dwordx4 v232, s[40:43], s64 offen offset:2048 lds
    s_add_u32 s64, s64, 98304
    s_sub_u32 s35, s64, 1966080
    s_min_u32 s64, s64, s35
    s_add_u32 m0, s61, 45440
    s_nop 0
    buffer_load_dwordx4 v230, s[40:43], s64 offen offset:0 lds
    buffer_load_dwordx4 v231, s[40:43], s64 offen offset:1024 lds
    buffer_load_dwordx4 v232, s[40:43], s64 offen offset:2048 lds
    s_add_u32 s64, s64, 98304
    s_sub_u32 s35, s64, 1966080
    s_min_u32 s64, s64, s35
    s_add_u32 m0, s61, 57856
    s_nop 0
    buffer_load_dwordx4 v230, s[40:43], s64 offen offset:0 lds
    buffer_load_dwordx4 v231, s[40:43], s64 offen offset:1024 lds
    buffer_load_dwordx4 v232, s[40:43], s64 offen offset:2048 lds
    s_add_u32 s64, s64, 98304
    s_sub_u32 s35, s64, 1966080
    s_min_u32 s64, s64, s35
    s_add_u32 m0, s61, 70272
    s_nop 0
    buffer_load_dwordx4 v230, s[40:43], s64 offen offset:0 lds
    buffer_load_dwordx4 v231, s[40:43], s64 offen offset:1024 lds
    buffer_load_dwordx4 v232, s[40:43], s64 offen offset:2048 lds
    s_add_u32 s64, s64, 98304
    s_sub_u32 s35, s64, 1966080
    s_min_u32 s64, s64, s35
    s_movk_i32 s4, 4096
    s_movk_i32 s5, 8192
    s_lshl_b32 s6, s72, 10
    s_add_u32 s6, s6, 23101440
    s_lshl_b32 s7, s73, 6
    s_add_u32 s7, s7, s6
    s_mul_i32 s8, s72, 768
    s_mul_i32 s50, s73, 12
    s_add_u32 s8, s8, s50
    s_mul_i32 s50, s3, 3
    s_add_u32 s8, s8, s50
    s_lshl_b32 s8, s8, 8
    s_add_u32 s8, s8, 16777216
    s_lshl_b32 s9, s73, 2
    s_add_u32 s9, s9, s3
    s_mul_i32 s9, s9, 384
    s_add_u32 s9, s9, 23527424
    s_mul_i32 s62, s3, 32768
    s_lshl_b32 s50, s72, 7
    s_add_u32 s62, s62, s50
    s_mul_i32 s50, s34, 131072
    s_add_u32 s10, s62, s50
    s_lshl_b32 s63, s3, 10
    s_add_u32 s11, s10, 131072
    s_sub_u32 s35, s11, 2621440
    s_min_u32 s11, s11, s35
    s_add_u32 s12, s11, 131072
    s_sub_u32 s35, s12, 2621440
    s_min_u32 s12, s12, s35
    s_add_u32 s13, s12, 131072
    s_sub_u32 s35, s13, 2621440
    s_min_u32 s13, s13, s35
    s_add_u32 s14, s13, 131072
    s_sub_u32 s35, s14, 2621440
    s_min_u32 s14, s14, s35
    s_add_u32 s15, s14, 131072
    s_sub_u32 s35, s15, 2621440
    s_min_u32 s15, s15, s35
    s_add_u32 s18, s15, 131072
    s_sub_u32 s35, s18, 2621440
    s_min_u32 s18, s18, s35
    s_add_u32 s19, s18, 131072
    s_sub_u32 s35, s19, 2621440
    s_min_u32 s19, s19, s35
    s_add_u32 s20, s19, 131072
    s_sub_u32 s35, s20, 2621440
    s_min_u32 s20, s20, s35
    s_add_u32 s21, s20, 131072
    s_sub_u32 s35, s21, 2621440
    s_min_u32 s21, s21, s35
    s_add_u32 s22, s21, 131072
    s_sub_u32 s35, s22, 2621440
    s_min_u32 s22, s22, s35
    s_add_u32 s23, s22, 131072
    s_sub_u32 s35, s23, 2621440
    s_min_u32 s23, s23, s35
    s_add_u32 s24, s23, 131072
    s_sub_u32 s35, s24, 2621440
    s_min_u32 s24, s24, s35
    s_add_u32 s25, s24, 131072
    s_sub_u32 s35, s25, 2621440
    s_min_u32 s25, s25, s35
    s_add_u32 s26, s25, 131072
    s_sub_u32 s35, s26, 2621440
    s_min_u32 s26, s26, s35
    s_add_u32 s27, s26, 131072
    s_sub_u32 s35, s27, 2621440
    s_min_u32 s27, s27, s35
    s_add_u32 s44, s27, 131072
    s_sub_u32 s35, s44, 2621440
    s_min_u32 s44, s44, s35
    s_add_u32 s45, s44, 131072
    s_sub_u32 s35, s45, 2621440
    s_min_u32 s45, s45, s35
    s_add_u32 s46, s45, 131072
    s_sub_u32 s35, s46, 2621440
    s_min_u32 s46, s46, s35
    s_add_u32 s47, s46, 131072
    s_sub_u32 s35, s47, 2621440
    s_min_u32 s47, s47, s35
    v_lshrrev_b32 v2, 3, v1
    v_bfe_u32 v3, v1, 4, 2
    v_lshlrev_b32 v3, 1, v3
    v_xor_b32 v3, v3, v1
    v_and_b32 v3, 7, v3
    v_mul_u32_u24 v2, 4096, v2
    v_lshl_add_u32 v172, v3, 4, v2
    v_add_u32 v172, 0, v172
    v_lshrrev_b32 v2, 2, v1
    v_lshlrev_b32 v2, 7, v2
    v_and_b32 v3, 3, v1
    v_lshl_add_u32 v2, v3, 3, v2
    v_bfe_u32 v3, v1, 3, 2
    v_xor_b32 v168, 0, v3
    v_lshl_add_u32 v168, v168, 5, v2
    v_xor_b32 v169, 1, v3
    v_lshl_add_u32 v169, v169, 5, v2
    v_xor_b32 v170, 2, v3
    v_lshl_add_u32 v170, v170, 5, v2
    v_xor_b32 v171, 3, v3
    v_lshl_add_u32 v171, v171, 5, v2
    v_and_b32 v175, 15, v1
    v_lshlrev_b32 v175, 4, v175
    v_bfe_u32 v2, v1, 4, 1
    v_lshrrev_b32 v3, 5, v1
    v_mul_u32_u24 v173, 49152, v2
    v_lshl_add_u32 v173, v3, 8, v173
    v_add_u32 v173, v173, v175
    v_lshl_add_u32 v2, v2, 1, v3
    v_mul_u32_u24 v174, 49152, v2
    v_add_u32 v174, v174, v175
    v_bfe_u32 v2, v0, 1, 2
    v_lshlrev_b32 v2, 1, v2
    s_lshr_b32 s50, s73, 1
    v_xor_b32 v2, s50, v2
    v_lshlrev_b32 v2, 4, v2
    v_lshl_add_u32 v216, v0, 7, v2
    s_and_b32 s50, s73, 1
    s_lshl_b32 s50, s50, 3
    v_add_u32 v216, s50, v216
    v_add_u32 v217, 0x8000, v216
    v_add_u32 v218, 0x10000, v216
    v_cmp_gt_u32 vcc, 128, v0
    s_nop 1
    v_cndmask_b32 v218, v217, v218, vcc
    s_lshl_b32 s50, s3, 10
    v_add_u32 v175, s50, v175
    v_lshrrev_b32 v2, 1, v1
    v_lshlrev_b32 v2, 10, v2
    v_and_b32 v3, 1, v1
    v_lshl_add_u32 v219, v3, 7, v2
    s_lshl_b32 s50, s3, 8
    s_add_u32 s50, s50, 46080
    v_add_u32 v219, s50, v219
    s_add_u32 s50, s50, 19456
    v_mov_b32 v2, s50
    v_cmp_lt_u32 vcc, 39, v1
    s_nop 1
    v_cndmask_b32 v219, v219, v2, vcc
    s_mov_b32 s17, 23199744
    s_lshl_b32 s62, s75, 2
    s_add_u32 s62, s62, s3
    s_mul_i32 s62, s62, 61440
    s_add_u32 s62, s62, 14417920
    s_waitcnt vmcnt(12)
    s_barrier
    s_cmp_eq_u32 s3, 0
    s_cbranch_scc0 L_wf16
    s_lshl_b32 s54, s77, 7
    s_add_u32 s54, s54, 23220224
    v_mov_b32 v2, 0
    v_mov_b32 v3, s48
    s_mov_b64 exec, 1
    buffer_store_dword v3, v2, s[36:39], s54 offen sc1
    s_mov_b64 exec, -1
L_wf16:
    s_cmp_eq_u32 s3, 0
    s_cbranch_scc0 L_wf17
    s_lshl_b32 s54, s71, 7
    s_add_u32 s54, s54, 23354368
    v_mov_b32 v2, 0
    v_mov_b32 v3, s48
    s_mov_b64 exec, 1
    buffer_store_dword v3, v2, s[36:39], s54 offen sc1
    s_mov_b64 exec, -1
L_wf17:
    ds_read_b64_tr_b16 a[0:1], v233 offset:0
    ds_read_b64_tr_b16 a[2:3], v233 offset:1536
    ds_read_b64_tr_b16 a[4:5], v233 offset:6224
    ds_read_b64_tr_b16 a[6:7], v233 offset:7760
    ds_read_b64_tr_b16 a[8:9], v234 offset:0
    ds_read_b64_tr_b16 a[10:11], v234 offset:1536
    ds_read_b64_tr_b16 a[12:13], v233 offset:12416
    ds_read_b64_tr_b16 a[14:15], v233 offset:13952
    ds_read_b64_tr_b16 a[16:17], v233 offset:18640
    ds_read_b64_tr_b16 a[18:19], v233 offset:20176
    ds_read_b64_tr_b16 a[20:21], v234 offset:12416
    ds_read_b64_tr_b16 a[22:23], v234 offset:13952
    s_add_u32 m0, s61, 82688
    s_nop 0
    buffer_load_dwordx4 v230, s[40:43], s64 offen offset:0 lds
    buffer_load_dwordx4 v231, s[40:43], s64 offen offset:1024 lds
    buffer_load_dwordx4 v232, s[40:43], s64 offen offset:2048 lds
    s_add_u32 s64, s64, 98304
    s_sub_u32 s35, s64, 1966080
    s_min_u32 s64, s64, s35
    s_add_u32 m0, s61, 95104
    s_nop 0
    buffer_load_dwordx4 v230, s[40:43], s64 offen offset:0 lds
    buffer_load_dwordx4 v231, s[40:43], s64 offen offset:1024 lds
    buffer_load_dwordx4 v232, s[40:43], s64 offen offset:2048 lds
    s_add_u32 s64, s64, 98304
    s_sub_u32 s35, s64, 1966080
    s_min_u32 s64, s64, s35
    s_waitcnt vmcnt(12)
    s_waitcnt lgkmcnt(0)
    s_barrier
    ds_read_b64_tr_b16 a[24:25], v233 offset:24832
    ds_read_b64_tr_b16 a[26:27], v233 offset:26368
    ds_read_b64_tr_b16 a[28:29], v233 offset:31056
    ds_read_b64_tr_b16 a[30:31], v233 offset:32592
    ds_read_b64_tr_b16 a[32:33], v234 offset:24832
    ds_read_b64_tr_b16 a[34:35], v234 offset:26368
    ds_read_b64_tr_b16 a[36:37], v233 offset:37248
    ds_read_b64_tr_b16 a[38:39], v233 offset:38784
    ds_read_b64_tr_b16 a[40:41], v233 offset:43472
    ds_read_b64_tr_b16 a[42:43], v233 offset:45008
    ds_read_b64_tr_b16 a[44:45], v234 offset:37248
    ds_read_b64_tr_b16 a[46:47], v234 offset:38784
    s_add_u32 m0, s61, 8192
    s_nop 0
    buffer_load_dwordx4 v230, s[40:43], s64 offen offset:0 lds
    buffer_load_dwordx4 v231, s[40:43], s64 offen offset:1024 lds
    buffer_load_dwordx4 v232, s[40:43], s64 offen offset:2048 lds
    s_add_u32 s64, s64, 98304
    s_sub_u32 s35, s64, 1966080
    s_min_u32 s64, s64, s35
    s_add_u32 m0, s61, 20608
    s_nop 0
    buffer_load_dwordx4 v230, s[40:43], s64 offen offset:0 lds
    buffer_load_dwordx4 v231, s[40:43], s64 offen offset:1024 lds
    buffer_load_dwordx4 v232, s[40:43], s64 offen offset:2048 lds
    s_add_u32 s64, s64, 98304
    s_sub_u32 s35, s64, 1966080
    s_min_u32 s64, s64, s35
    s_waitcnt vmcnt(12)
    s_waitcnt lgkmcnt(0)
    s_barrier
    ds_read_b64_tr_b16 a[48:49], v238 offset:0
    ds_read_b64_tr_b16 a[50:51], v238 offset:1536
    ds_read_b64_tr_b16 a[52:53], v238 offset:6224
    ds_read_b64_tr_b16 a[54:55], v238 offset:7760
    ds_read_b64_tr_b16 a[56:57], v239 offset:0
    ds_read_b64_tr_b16 a[58:59], v239 offset:1536
    ds_read_b64_tr_b16 a[60:61], v238 offset:12416
    ds_read_b64_tr_b16 a[62:63], v238 offset:13952
    ds_read_b64_tr_b16 a[64:65], v238 offset:18640
    ds_read_b64_tr_b16 a[66:67], v238 offset:20176
    ds_read_b64_tr_b16 a[68:69], v239 offset:12416
    ds_read_b64_tr_b16 a[70:71], v239 offset:13952
    s_add_u32 m0, s61, 33024
    s_nop 0
    buffer_load_dwordx4 v230, s[40:43], s64 offen offset:0 lds
    buffer_load_dwordx4 v231, s[40:43], s64 offen offset:1024 lds
    buffer_load_dwordx4 v232, s[40:43], s64 offen offset:2048 lds
    s_add_u32 s64, s64, 98304
    s_sub_u32 s35, s64, 1966080
    s_min_u32 s64, s64, s35
    s_add_u32 m0, s61, 45440
    s_nop 0
    buffer_load_dwordx4 v230, s[40:43], s64 offen offset:0 lds
    buffer_load_dwordx4 v231, s[40:43], s64 offen offset:1024 lds
    buffer_load_dwordx4 v232, s[40:43], s64 offen offset:2048 lds
    s_add_u32 s64, s64, 98304
    s_sub_u32 s35, s64, 1966080
    s_min_u32 s64, s64, s35
    s_waitcnt vmcnt(12)
    s_waitcnt lgkmcnt(0)
    s_barrier
    ds_read_b64_tr_b16 a[72:73], v238 offset:24832
    ds_read_b64_tr_b16 a[74:75], v238 offset:26368
    ds_read_b64_tr_b16 a[76:77], v238 offset:31056
    ds_read_b64_tr_b16 a[78:79], v238 offset:32592
    ds_read_b64_tr_b16 a[80:81], v239 offset:24832
    ds_read_b64_tr_b16 a[82:83], v239 offset:26368
    ds_read_b64_tr_b16 a[84:85], v238 offset:37248
    ds_read_b64_tr_b16 a[86:87], v238 offset:38784
    ds_read_b64_tr_b16 a[88:89], v238 offset:43472
    ds_read_b64_tr_b16 a[90:91], v238 offset:45008
    ds_read_b64_tr_b16 a[92:93], v239 offset:37248
    ds_read_b64_tr_b16 a[94:95], v239 offset:38784
    s_add_u32 m0, s61, 57856
    s_nop 0
    buffer_load_dwordx4 v230, s[40:43], s64 offen offset:0 lds
    buffer_load_dwordx4 v231, s[40:43], s64 offen offset:1024 lds
    buffer_load_dwordx4 v232, s[40:43], s64 offen offset:2048 lds
    s_add_u32 s64, s64, 98304
    s_sub_u32 s35, s64, 1966080
    s_min_u32 s64, s64, s35
    s_add_u32 m0, s61, 70272
    s_nop 0
    buffer_load_dwordx4 v230, s[40:43], s64 offen offset:0 lds
    buffer_load_dwordx4 v231, s[40:43], s64 offen offset:1024 lds
    buffer_load_dwordx4 v232, s[40:43], s64 offen offset:2048 lds
    s_add_u32 s64, s64, 98304
    s_sub_u32 s35, s64, 1966080
    s_min_u32 s64, s64, s35
    s_waitcnt vmcnt(12)
    s_waitcnt lgkmcnt(0)
    s_barrier
    ds_read_b64_tr_b16 a[96:97], v233 offset:0
    ds_read_b64_tr_b16 a[98:99], v233 offset:1536
    ds_read_b64_tr_b16 a[100:101], v233 offset:6224
    ds_read_b64_tr_b16 a[102:103], v233 offset:7760
    ds_read_b64_tr_b16 a[104:105], v234 offset:0
    ds_read_b64_tr_b16 a[106:107], v234 offset:1536
    ds_read_b64_tr_b16 a[108:109], v233 offset:12416
    ds_read_b64_tr_b16 a[110:111], v233 offset:13952
    ds_read_b64_tr_b16 a[112:113], v233 offset:18640
    ds_read_b64_tr_b16 a[114:115], v233 offset:20176
    ds_read_b64_tr_b16 a[116:117], v234 offset:12416
    ds_read_b64_tr_b16 a[118:119], v234 offset:13952
    s_add_u32 m0, s61, 82688
    s_nop 0
    buffer_load_dwordx4 v230, s[40:43], s64 offen offset:0 lds
    buffer_load_dwordx4 v231, s[40:43], s64 offen offset:1024 lds
    buffer_load_dwordx4 v232, s[40:43], s64 offen offset:2048 lds
    s_add_u32 s64, s64, 98304
    s_sub_u32 s35, s64, 1966080
    s_min_u32 s64, s64, s35
    s_lshr_b32 s52, s71, 1
    s_lshl_b32 s52, s52, 2
    s_add_u32 s52, s52, s3
    s_mul_i32 s52, s52, 10240
    s_and_b32 s53, s71, 1
    s_mul_i32 s53, s53, 640
    s_add_u32 s52, s52, s53
    s_mul_i32 s53, s3, 5120
    v_add_u32 v5, 0, v1
    v_mul_u32_u24 v6, 205, v5
    v_lshrrev_b32 v6, 13, v6
    v_mul_u32_u24 v6, 640, v6
    v_lshl_add_u32 v5, v5, 4, v6
    s_add_u32 m0, s53, 107520
    s_nop 0
    buffer_load_dwordx4 v5, s[56:59], s52 offen nt lds
    v_add_u32 v5, 64, v1
    v_mul_u32_u24 v6, 205, v5
    v_lshrrev_b32 v6, 13, v6
    v_mul_u32_u24 v6, 640, v6
    v_lshl_add_u32 v5, v5, 4, v6
    s_add_u32 m0, s53, 108544
    s_nop 0
    buffer_load_dwordx4 v5, s[56:59], s52 offen nt lds
    v_add_u32 v5, 128, v1
    v_mul_u32_u24 v6, 205, v5
    v_lshrrev_b32 v6, 13, v6
    v_mul_u32_u24 v6, 640, v6
    v_lshl_add_u32 v5, v5, 4, v6
    s_add_u32 m0, s53, 109568
    s_nop 0
    buffer_load_dwordx4 v5, s[56:59], s52 offen nt lds
    v_add_u32 v5, 192, v1
    v_mul_u32_u24 v6, 205, v5
    v_lshrrev_b32 v6, 13, v6
    v_mul_u32_u24 v6, 640, v6
    v_lshl_add_u32 v5, v5, 4, v6
    s_add_u32 m0, s53, 110592
    s_nop 0
    buffer_load_dwordx4 v5, s[56:59], s52 offen nt lds
    v_add_u32 v5, 256, v1
    v_mul_u32_u24 v6, 205, v5
    v_lshrrev_b32 v6, 13, v6
    v_mul_u32_u24 v6, 640, v6
    v_lshl_add_u32 v5, v5, 4, v6
    s_add_u32 m0, s53, 111616
    s_nop 0
    buffer_load_dwordx4 v5, s[56:59], s52 offen nt lds
    s_waitcnt vmcnt(14)
    s_waitcnt lgkmcnt(0)
    s_barrier
    ds_read_b64_tr_b16 a[120:121], v233 offset:24832
    ds_read_b64_tr_b16 a[122:123], v233 offset:26368
    ds_read_b64_tr_b16 a[124:125], v233 offset:31056
    ds_read_b64_tr_b16 a[126:127], v233 offset:32592
    ds_read_b64_tr_b16 a[128:129], v234 offset:24832
    ds_read_b64_tr_b16 a[130:131], v234 offset:26368
    ds_read_b64_tr_b16 a[132:133], v233 offset:37248
    ds_read_b64_tr_b16 a[134:135], v233 offset:38784
    ds_read_b64_tr_b16 a[136:137], v233 offset:43472
    ds_read_b64_tr_b16 a[138:139], v233 offset:45008
    ds_read_b64_tr_b16 a[140:141], v234 offset:37248
    ds_read_b64_tr_b16 a[142:143], v234 offset:38784
    s_waitcnt vmcnt(8)
    s_waitcnt lgkmcnt(0)
    s_barrier
    ds_read_b64_tr_b16 a[144:145], v238 offset:0
    ds_read_b64_tr_b16 a[146:147], v238 offset:1536
    ds_read_b64_tr_b16 a[148:149], v238 offset:6224
    ds_read_b64_tr_b16 a[150:151], v238 offset:7760
    ds_read_b64_tr_b16 a[152:153], v239 offset:0
    ds_read_b64_tr_b16 a[154:155], v239 offset:1536
    ds_read_b64_tr_b16 a[156:157], v238 offset:12416
    ds_read_b64_tr_b16 a[158:159], v238 offset:13952
    ds_read_b64_tr_b16 a[160:161], v238 offset:18640
    ds_read_b64_tr_b16 a[162:163], v238 offset:20176
    ds_read_b64_tr_b16 a[164:165], v239 offset:12416
    ds_read_b64_tr_b16 a[166:167], v239 offset:13952
    s_waitcnt vmcnt(5)
    s_waitcnt lgkmcnt(0)
    s_barrier
    ds_read_b64_tr_b16 a[168:169], v238 offset:24832
    ds_read_b64_tr_b16 a[170:171], v238 offset:26368
    ds_read_b64_tr_b16 a[172:173], v238 offset:31056
    ds_read_b64_tr_b16 a[174:175], v238 offset:32592
    ds_read_b64_tr_b16 a[176:177], v239 offset:24832
    ds_read_b64_tr_b16 a[178:179], v239 offset:26368
    s_waitcnt vmcnt(0)
    s_waitcnt lgkmcnt(0)
    s_barrier
    v_lshrrev_b32 v2, 4, v1
    v_bfe_u32 v3, v1, 2, 2
    v_lshl_add_u32 v3, v2, 3, v3
    v_mul_u32_u24 v3, 640, v3
    v_and_b32 v2, 3, v1
    v_lshl_add_u32 v2, v2, 3, v3
    s_mul_i32 s50, s3, 160
    s_add_u32 s50, s50, 107520
    v_add_u32 v2, s50, v2
    s_lshr_b32 s53, s71, 1
    s_mov_b32 s50, 0x15555556
    s_mul_hi_u32 s51, s53, s50
    s_mul_i32 s52, s51, 12
    s_sub_u32 s52, s53, s52
    s_and_b32 s50, s71, 1
    s_lshl_b32 s50, s50, 2
    s_add_u32 s50, s50, s3
    s_lshl_b32 s50, s50, 2
    s_add_u32 s50, s50, s51
    s_mul_i32 s50, s50, 60
    s_mul_i32 s52, s52, 5
    s_add_u32 s50, s50, s52
    s_lshl_b32 s50, s50, 10
    s_add_u32 s50, s50, 14417920
    s_add_u32 s51, s50, 4096
    ds_read_b64_tr_b16 v[16:17], v2 offset:0
    ds_read_b64_tr_b16 v[18:19], v2 offset:2560
    ds_read_b64_tr_b16 v[20:21], v2 offset:32
    ds_read_b64_tr_b16 v[22:23], v2 offset:2592
    ds_read_b64_tr_b16 v[24:25], v2 offset:64
    ds_read_b64_tr_b16 v[26:27], v2 offset:2624
    ds_read_b64_tr_b16 v[28:29], v2 offset:96
    ds_read_b64_tr_b16 v[30:31], v2 offset:2656
    ds_read_b64_tr_b16 v[32:33], v2 offset:128
    ds_read_b64_tr_b16 v[34:35], v2 offset:2688
    s_waitcnt lgkmcnt(8)
    buffer_store_dwordx4 v[16:19], v248, s[36:39], s50 offen offset:0 sc1
    s_waitcnt lgkmcnt(6)
    buffer_store_dwordx4 v[20:23], v248, s[36:39], s50 offen offset:1024 sc1
    s_waitcnt lgkmcnt(4)
    buffer_store_dwordx4 v[24:27], v248, s[36:39], s50 offen offset:2048 sc1
    s_waitcnt lgkmcnt(2)
    buffer_store_dwordx4 v[28:31], v248, s[36:39], s50 offen offset:3072 sc1
    s_waitcnt lgkmcnt(0)
    buffer_store_dwordx4 v[32:35], v248, s[36:39], s51 offen offset:0 sc1
    s_branch L_nobias
L_bias:
    s_add_u32 m0, s61, 8192
    s_nop 0
    buffer_load_dwordx4 v230, s[40:43], s64 offen offset:0 lds
    buffer_load_dwordx4 v231, s[40:43], s64 offen offset:1024 lds
    buffer_load_dwordx4 v232, s[40:43], s64 offen offset:2048 lds
    s_add_u32 s64, s64, 98304
    s_sub_u32 s35, s64, 1966080
    s_min_u32 s64, s64, s35
    s_add_u32 m0, s61, 20608
    s_nop 0
    buffer_load_dwordx4 v230, s[40:43], s64 offen offset:0 lds
    buffer_load_dwordx4 v231, s[40:43], s64 offen offset:1024 lds
    buffer_load_dwordx4 v232, s[40:43], s64 offen offset:2048 lds
    s_add_u32 s64, s64, 98304
    s_sub_u32 s35, s64, 1966080
    s_min_u32 s64, s64, s35
    s_add_u32 m0, s61, 33024
    s_nop 0
    buffer_load_dwordx4 v230, s[40:43], s64 offen offset:0 lds
    buffer_load_dwordx4 v231, s[40:43], s64 offen offset:1024 lds
    buffer_load_dwordx4 v232, s[40:43], s64 offen offset:2048 lds
    s_add_u32 s64, s64, 98304
    s_sub_u32 s35, s64, 1966080
    s_min_u32 s64, s64, s35
    s_add_u32 m0, s61, 45440
    s_nop 0
    buffer_load_dwordx4 v230, s[40:43], s64 offen offset:0 lds
    buffer_load_dwordx4 v231, s[40:43], s64 offen offset:1024 lds
    buffer_load_dwordx4 v232, s[40:43], s64 offen offset:2048 lds
    s_add_u32 s64, s64, 98304
    s_sub_u32 s35, s64, 1966080
    s_min_u32 s64, s64, s35
    s_add_u32 m0, s61, 57856
    s_nop 0
    buffer_load_dwordx4 v230, s[40:43], s64 offen offset:0 lds
    buffer_load_dwordx4 v231, s[40:43], s64 offen offset:1024 lds
    buffer_load_dwordx4 v232, s[40:43], s64 offen offset:2048 lds
    s_add_u32 s64, s64, 98304
    s_sub_u32 s35, s64, 1966080
    s_min_u32 s64, s64, s35
    s_add_u32 m0, s61, 70272
    s_nop 0
    buffer_load_dwordx4 v230, s[40:43], s64 offen offset:0 lds
    buffer_load_dwordx4 v231, s[40:43], s64 offen offset:1024 lds
    buffer_load_dwordx4 v232, s[40:43], s64 offen offset:2048 lds
    s_add_u32 s64, s64, 98304
    s_sub_u32 s35, s64, 1966080
    s_min_u32 s64, s64, s35
    s_movk_i32 s4, 4096
    s_movk_i32 s5, 8192
    s_lshl_b32 s6, s72, 10
    s_add_u32 s6, s6, 23101440
    s_lshl_b32 s7, s73, 6
    s_add_u32 s7, s7, s6
    s_mul_i32 s8, s72, 768
    s_mul_i32 s50, s73, 12
    s_add_u32 s8, s8, s50
    s_mul_i32 s50, s3, 3
    s_add_u32 s8, s8, s50
    s_lshl_b32 s8, s8, 8
    s_add_u32 s8, s8, 16777216
    s_lshl_b32 s9, s73, 2
    s_add_u32 s9, s9, s3
    s_mul_i32 s9, s9, 384
    s_add_u32 s9, s9, 23527424
    s_mul_i32 s62, s3, 32768
    s_lshl_b32 s50, s72, 7
    s_add_u32 s62, s62, s50
    s_mul_i32 s50, s34, 131072
    s_add_u32 s10, s62, s50
    s_lshl_b32 s63, s3, 10
    s_add_u32 s11, s10, 131072
    s_sub_u32 s35, s11, 2621440
    s_min_u32 s11, s11, s35
    s_add_u32 s12, s11, 131072
    s_sub_u32 s35, s12, 2621440
    s_min_u32 s12, s12, s35
    s_add_u32 s13, s12, 131072
    s_sub_u32 s35, s13, 2621440
    s_min_u32 s13, s13, s35
    s_add_u32 s14, s13, 131072
    s_sub_u32 s35, s14, 2621440
    s_min_u32 s14, s14, s35
    s_add_u32 s15, s14, 131072
    s_sub_u32 s35, s15, 2621440
    s_min_u32 s15, s15, s35
    s_add_u32 s18, s15, 131072
    s_sub_u32 s35, s18, 2621440
    s_min_u32 s18, s18, s35
    s_add_u32 s19, s18, 131072
    s_sub_u32 s35, s19, 2621440
    s_min_u32 s19, s19, s35
    s_add_u32 s20, s19, 131072
    s_sub_u32 s35, s20, 2621440
    s_min_u32 s20, s20, s35
    s_add_u32 s21, s20, 131072
    s_sub_u32 s35, s21, 2621440
    s_min_u32 s21, s21, s35
    s_add_u32 s22, s21, 131072
    s_sub_u32 s35, s22, 2621440
    s_min_u32 s22, s22, s35
    s_add_u32 s23, s22, 131072
    s_sub_u32 s35, s23, 2621440
    s_min_u32 s23, s23, s35
    s_add_u32 s24, s23, 131072
    s_sub_u32 s35, s24, 2621440
    s_min_u32 s24, s24, s35
    s_add_u32 s25, s24, 131072
    s_sub_u32 s35, s25, 2621440
    s_min_u32 s25, s25, s35
    s_add_u32 s26, s25, 131072
    s_sub_u32 s35, s26, 2621440
    s_min_u32 s26, s26, s35
    s_add_u32 s27, s26, 131072
    s_sub_u32 s35, s27, 2621440
    s_min_u32 s27, s27, s35
    s_add_u32 s44, s27, 131072
    s_sub_u32 s35, s44, 2621440
    s_min_u32 s44, s44, s35
    s_add_u32 s45, s44, 131072
    s_sub_u32 s35, s45, 2621440
    s_min_u32 s45, s45, s35
    s_add_u32 s46, s45, 131072
    s_sub_u32 s35, s46, 2621440
    s_min_u32 s46, s46, s35
    s_add_u32 s47, s46, 131072
    s_sub_u32 s35, s47, 2621440
    s_min_u32 s47, s47, s35
    v_lshrrev_b32 v2, 3, v1
    v_bfe_u32 v3, v1, 4, 2
    v_lshlrev_b32 v3, 1, v3
    v_xor_b32 v3, v3, v1
    v_and_b32 v3, 7, v3
    v_mul_u32_u24 v2, 4096, v2
    v_lshl_add_u32 v172, v3, 4, v2
    v_add_u32 v172, 0, v172
    v_lshrrev_b32 v2, 2, v1
    v_lshlrev_b32 v2, 7, v2
    v_and_b32 v3, 3, v1
    v_lshl_add_u32 v2, v3, 3, v2
    v_bfe_u32 v3, v1, 3, 2
    v_xor_b32 v168, 0, v3
    v_lshl_add_u32 v168, v168, 5, v2
    v_xor_b32 v169, 1, v3
    v_lshl_add_u32 v169, v169, 5, v2
    v_xor_b32 v170, 2, v3
    v_lshl_add_u32 v170, v170, 5, v2
    v_xor_b32 v171, 3, v3
    v_lshl_add_u32 v171, v171, 5, v2
    v_and_b32 v175, 15, v1
    v_lshlrev_b32 v175, 4, v175
    v_bfe_u32 v2, v1, 4, 1
    v_lshrrev_b32 v3, 5, v1
    v_mul_u32_u24 v173, 49152, v2
    v_lshl_add_u32 v173, v3, 8, v173
    v_add_u32 v173, v173, v175
    v_lshl_add_u32 v2, v2, 1, v3
    v_mul_u32_u24 v174, 49152, v2
    v_add_u32 v174, v174, v175
    v_bfe_u32 v2, v0, 1, 2
    v_lshlrev_b32 v2, 1, v2
    s_lshr_b32 s50, s73, 1
    v_xor_b32 v2, s50, v2
    v_lshlrev_b32 v2, 4, v2
    v_lshl_add_u32 v216, v0, 7, v2
    s_and_b32 s50, s73, 1
    s_lshl_b32 s50, s50, 3
    v_add_u32 v216, s50, v216
    v_add_u32 v217, 0x8000, v216
    v_add_u32 v218, 0x10000, v216
    v_cmp_gt_u32 vcc, 128, v0
    s_nop 1
    v_cndmask_b32 v218, v217, v218, vcc
    s_lshl_b32 s50, s3, 10
    v_add_u32 v175, s50, v175
    v_lshrrev_b32 v2, 1, v1
    v_lshlrev_b32 v2, 10, v2
    v_and_b32 v3, 1, v1
    v_lshl_add_u32 v219, v3, 7, v2
    s_lshl_b32 s50, s3, 8
    s_add_u32 s50, s50, 46080
    v_add_u32 v219, s50, v219
    s_add_u32 s50, s50, 19456
    v_mov_b32 v2, s50
    v_cmp_lt_u32 vcc, 39, v1
    s_nop 1
    v_cndmask_b32 v219, v219, v2, vcc
    s_mov_b32 s17, 23199744
    s_lshl_b32 s62, s75, 2
    s_add_u32 s62, s62, s3
    s_mul_i32 s62, s62, 61440
    s_add_u32 s62, s62, 14417920
    s_waitcnt vmcnt(12)
    s_barrier
    s_cmp_eq_u32 s3, 0
    s_cbranch_scc0 L_wf18
    s_lshl_b32 s54, s77, 7
    s_add_u32 s54, s54, 23220224
    v_mov_b32 v2, 0
    v_mov_b32 v3, s48
    s_mov_b64 exec, 1
    buffer_store_dword v3, v2, s[36:39], s54 offen sc1
    s_mov_b64 exec, -1
L_wf18:
    s_cmp_eq_u32 s3, 0
    s_cbranch_scc0 L_wf19
    s_lshl_b32 s54, s71, 7
    s_add_u32 s54, s54, 23354368
    v_mov_b32 v2, 0
    v_mov_b32 v3, s48
    s_mov_b64 exec, 1
    buffer_store_dword v3, v2, s[36:39], s54 offen sc1
    s_mov_b64 exec, -1
L_wf19:
    ds_read_b64_tr_b16 a[0:1], v233 offset:0
    ds_read_b64_tr_b16 a[2:3], v233 offset:1536
    ds_read_b64_tr_b16 a[4:5], v233 offset:6224
    ds_read_b64_tr_b16 a[6:7], v233 offset:7760
    ds_read_b64_tr_b16 a[8:9], v234 offset:0
    ds_read_b64_tr_b16 a[10:11], v234 offset:1536
    ds_read_b64_tr_b16 a[12:13], v233 offset:12416
    ds_read_b64_tr_b16 a[14:15], v233 offset:13952
    ds_read_b64_tr_b16 a[16:17], v233 offset:18640
    ds_read_b64_tr_b16 a[18:19], v233 offset:20176
    ds_read_b64_tr_b16 a[20:21], v234 offset:12416
    ds_read_b64_tr_b16 a[22:23], v234 offset:13952
    s_add_u32 m0, s61, 82688
    s_nop 0
    buffer_load_dwordx4 v230, s[40:43], s64 offen offset:0 lds
    buffer_load_dwordx4 v231, s[40:43], s64 offen offset:1024 lds
    buffer_load_dwordx4 v232, s[40:43], s64 offen offset:2048 lds
    s_add_u32 s64, s64, 98304
    s_sub_u32 s35, s64, 1966080
    s_min_u32 s64, s64, s35
    s_add_u32 m0, s61, 95104
    s_nop 0
    buffer_load_dwordx4 v230, s[40:43], s64 offen offset:0 lds
    buffer_load_dwordx4 v231, s[40:43], s64 offen offset:1024 lds
    buffer_load_dwordx4 v232, s[40:43], s64 offen offset:2048 lds
    s_add_u32 s64, s64, 98304
    s_sub_u32 s35, s64, 1966080
    s_min_u32 s64, s64, s35
    s_waitcnt vmcnt(12)
    s_waitcnt lgkmcnt(0)
    s_barrier
    ds_read_b64_tr_b16 a[24:25], v233 offset:24832
    ds_read_b64_tr_b16 a[26:27], v233 offset:26368
    ds_read_b64_tr_b16 a[28:29], v233 offset:31056
    ds_read_b64_tr_b16 a[30:31], v233 offset:32592
    ds_read_b64_tr_b16 a[32:33], v234 offset:24832
    ds_read_b64_tr_b16 a[34:35], v234 offset:26368
    ds_read_b64_tr_b16 a[36:37], v233 offset:37248
    ds_read_b64_tr_b16 a[38:39], v233 offset:38784
    ds_read_b64_tr_b16 a[40:41], v233 offset:43472
    ds_read_b64_tr_b16 a[42:43], v233 offset:45008
    ds_read_b64_tr_b16 a[44:45], v234 offset:37248
    ds_read_b64_tr_b16 a[46:47], v234 offset:38784
    s_add_u32 m0, s61, 8192
    s_nop 0
    buffer_load_dwordx4 v230, s[40:43], s64 offen offset:0 lds
    buffer_load_dwordx4 v231, s[40:43], s64 offen offset:1024 lds
    buffer_load_dwordx4 v232, s[40:43], s64 offen offset:2048 lds
    s_add_u32 s64, s64, 98304
    s_sub_u32 s35, s64, 1966080
    s_min_u32 s64, s64, s35
    s_add_u32 m0, s61, 20608
    s_nop 0
    buffer_load_dwordx4 v230, s[40:43], s64 offen offset:0 lds
    buffer_load_dwordx4 v231, s[40:43], s64 offen offset:1024 lds
    buffer_load_dwordx4 v232, s[40:43], s64 offen offset:2048 lds
    s_add_u32 s64, s64, 98304
    s_sub_u32 s35, s64, 1966080
    s_min_u32 s64, s64, s35
    s_waitcnt vmcnt(12)
    s_waitcnt lgkmcnt(0)
    s_barrier
    ds_read_b64_tr_b16 a[48:49], v238 offset:0
    ds_read_b64_tr_b16 a[50:51], v238 offset:1536
    ds_read_b64_tr_b16 a[52:53], v238 offset:6224
    ds_read_b64_tr_b16 a[54:55], v238 offset:7760
    ds_read_b64_tr_b16 a[56:57], v239 offset:0
    ds_read_b64_tr_b16 a[58:59], v239 offset:1536
    ds_read_b64_tr_b16 a[60:61], v238 offset:12416
    ds_read_b64_tr_b16 a[62:63], v238 offset:13952
    ds_read_b64_tr_b16 a[64:65], v238 offset:18640
    ds_read_b64_tr_b16 a[66:67], v238 offset:20176
    ds_read_b64_tr_b16 a[68:69], v239 offset:12416
    ds_read_b64_tr_b16 a[70:71], v239 offset:13952
    s_add_u32 m0, s61, 33024
    s_nop 0
    buffer_load_dwordx4 v230, s[40:43], s64 offen offset:0 lds
    buffer_load_dwordx4 v231, s[40:43], s64 offen offset:1024 lds
    buffer_load_dwordx4 v232, s[40:43], s64 offen offset:2048 lds
    s_add_u32 s64, s64, 98304
    s_sub_u32 s35, s64, 1966080
    s_min_u32 s64, s64, s35
    s_add_u32 m0, s61, 45440
    s_nop 0
    buffer_load_dwordx4 v230, s[40:43], s64 offen offset:0 lds
    buffer_load_dwordx4 v231, s[40:43], s64 offen offset:1024 lds
    buffer_load_dwordx4 v232, s[40:43], s64 offen offset:2048 lds
    s_add_u32 s64, s64, 98304
    s_sub_u32 s35, s64, 1966080
    s_min_u32 s64, s64, s35
    s_waitcnt vmcnt(12)
    s_waitcnt lgkmcnt(0)
    s_barrier
    ds_read_b64_tr_b16 a[72:73], v238 offset:24832
    ds_read_b64_tr_b16 a[74:75], v238 offset:26368
    ds_read_b64_tr_b16 a[76:77], v238 offset:31056
    ds_read_b64_tr_b16 a[78:79], v238 offset:32592
    ds_read_b64_tr_b16 a[80:81], v239 offset:24832
    ds_read_b64_tr_b16 a[82:83], v239 offset:26368
    ds_read_b64_tr_b16 a[84:85], v238 offset:37248
    ds_read_b64_tr_b16 a[86:87], v238 offset:38784
    ds_read_b64_tr_b16 a[88:89], v238 offset:43472
    ds_read_b64_tr_b16 a[90:91], v238 offset:45008
    ds_read_b64_tr_b16 a[92:93], v239 offset:37248
    ds_read_b64_tr_b16 a[94:95], v239 offset:38784
    s_add_u32 m0, s61, 57856
    s_nop 0
    buffer_load_dwordx4 v230, s[40:43], s64 offen offset:0 lds
    buffer_load_dwordx4 v231, s[40:43], s64 offen offset:1024 lds
    buffer_load_dwordx4 v232, s[40:43], s64 offen offset:2048 lds
    s_add_u32 s64, s64, 98304
    s_sub_u32 s35, s64, 1966080
    s_min_u32 s64, s64, s35
    s_add_u32 m0, s61, 70272
    s_nop 0
    buffer_load_dwordx4 v230, s[40:43], s64 offen offset:0 lds
    buffer_load_dwordx4 v231, s[40:43], s64 offen offset:1024 lds
    buffer_load_dwordx4 v232, s[40:43], s64 offen offset:2048 lds
    s_add_u32 s64, s64, 98304
    s_sub_u32 s35, s64, 1966080
    s_min_u32 s64, s64, s35
    s_mov_b32 s66, 23229184
    v_min_u32 v240, 19, v1
    v_lshlrev_b32 v240, 7, v240
    buffer_load_dword v241, v240, s[36:39], s66 offen sc1
    s_waitcnt vmcnt(13)
    s_waitcnt lgkmcnt(0)
    s_barrier
    ds_read_b64_tr_b16 a[96:97], v233 offset:0
    ds_read_b64_tr_b16 a[98:99], v233 offset:1536
    ds_read_b64_tr_b16 a[100:101], v233 offset:6224
    ds_read_b64_tr_b16 a[102:103], v233 offset:7760
    ds_read_b64_tr_b16 a[104:105], v234 offset:0
    ds_read_b64_tr_b16 a[106:107], v234 offset:1536
    ds_read_b64_tr_b16 a[108:109], v233 offset:12416
    ds_read_b64_tr_b16 a[110:111], v233 offset:13952
    ds_read_b64_tr_b16 a[112:113], v233 offset:18640
    ds_read_b64_tr_b16 a[114:115], v233 offset:20176
    ds_read_b64_tr_b16 a[116:117], v234 offset:12416
    ds_read_b64_tr_b16 a[118:119], v234 offset:13952
    s_add_u32 m0, s61, 82688
    s_nop 0
    buffer_load_dwordx4 v230, s[40:43], s64 offen offset:0 lds
    buffer_load_dwordx4 v231, s[40:43], s64 offen offset:1024 lds
    buffer_load_dwordx4 v232, s[40:43], s64 offen offset:2048 lds
    s_add_u32 s64, s64, 98304
    s_sub_u32 s35, s64, 1966080
    s_min_u32 s64, s64, s35
    s_mov_b32 s69, s64
    s_add_u32 m0, s61, 95104
    s_nop 0
    buffer_load_dwordx4 v230, s[40:43], s64 offen offset:0 lds
    buffer_load_dwordx4 v231, s[40:43], s64 offen offset:1024 lds
    buffer_load_dwordx4 v232, s[40:43], s64 offen offset:2048 lds
    s_add_u32 s64, s64, 98304
    s_sub_u32 s35, s64, 1966080
    s_min_u32 s64, s64, s35
    s_waitcnt vmcnt(13)
    s_waitcnt lgkmcnt(0)
    s_barrier
    ds_read_b64_tr_b16 a[120:121], v233 offset:24832
    ds_read_b64_tr_b16 a[122:123], v233 offset:26368
    ds_read_b64_tr_b16 a[124:125], v233 offset:31056
    ds_read_b64_tr_b16 a[126:127], v233 offset:32592
    ds_read_b64_tr_b16 a[128:129], v234 offset:24832
    ds_read_b64_tr_b16 a[130:131], v234 offset:26368
    ds_read_b64_tr_b16 a[132:133], v233 offset:37248
    ds_read_b64_tr_b16 a[134:135], v233 offset:38784
    ds_read_b64_tr_b16 a[136:137], v233 offset:43472
    ds_read_b64_tr_b16 a[138:139], v233 offset:45008
    ds_read_b64_tr_b16 a[140:141], v234 offset:37248
    ds_read_b64_tr_b16 a[142:143], v234 offset:38784
    s_add_u32 m0, s61, 8192
    s_nop 0
    buffer_load_dwordx4 v230, s[40:43], s64 offen offset:0 lds
    buffer_load_dwordx4 v231, s[40:43], s64 offen offset:1024 lds
    buffer_load_dwordx4 v232, s[40:43], s64 offen offset:2048 lds
    s_add_u32 s64, s64, 98304
    s_sub_u32 s35, s64, 1966080
    s_min_u32 s64, s64, s35
    s_add_u32 m0, s61, 20608
    s_nop 0
    buffer_load_dwordx4 v230, s[40:43], s64 offen offset:0 lds
    buffer_load_dwordx4 v231, s[40:43], s64 offen offset:1024 lds
    buffer_load_dwordx4 v232, s[40:43], s64 offen offset:2048 lds
    s_add_u32 s64, s64, 98304
    s_sub_u32 s35, s64, 1966080
    s_min_u32 s64, s64, s35
    s_waitcnt vmcnt(13)
    s_waitcnt lgkmcnt(0)
    s_barrier
    ds_read_b64_tr_b16 a[144:145], v238 offset:0
    ds_read_b64_tr_b16 a[146:147], v238 offset:1536
    ds_read_b64_tr_b16 a[148:149], v238 offset:6224
    ds_read_b64_tr_b16 a[150:151], v238 offset:7760
    ds_read_b64_tr_b16 a[152:153], v239 offset:0
    ds_read_b64_tr_b16 a[154:155], v239 offset:1536
    ds_read_b64_tr_b16 a[156:157], v238 offset:12416
    ds_read_b64_tr_b16 a[158:159], v238 offset:13952
    ds_read_b64_tr_b16 a[160:161], v238 offset:18640
    ds_read_b64_tr_b16 a[162:163], v238 offset:20176
    ds_read_b64_tr_b16 a[164:165], v239 offset:12416
    ds_read_b64_tr_b16 a[166:167], v239 offset:13952
    s_add_u32 m0, s61, 33024
    s_nop 0
    buffer_load_dwordx4 v230, s[40:43], s64 offen offset:0 lds
    buffer_load_dwordx4 v231, s[40:43], s64 offen offset:1024 lds
    buffer_load_dwordx4 v232, s[40:43], s64 offen offset:2048 lds
    s_add_u32 s64, s64, 98304
    s_sub_u32 s35, s64, 1966080
    s_min_u32 s64, s64, s35
    s_add_u32 m0, s61, 45440
    s_nop 0
    buffer_load_dwordx4 v230, s[40:43], s64 offen offset:0 lds
    buffer_load_dwordx4 v231, s[40:43], s64 offen offset:1024 lds
    buffer_load_dwordx4 v232, s[40:43], s64 offen offset:2048 lds
    s_add_u32 s64, s64, 98304
    s_sub_u32 s35, s64, 1966080
    s_min_u32 s64, s64, s35
    s_waitcnt vmcnt(18)
    v_cmp_ne_u32 vcc, s48, v241
    s_cbranch_vccnz L_chk20_slow
L_chk20_back:
    s_mul_i32 s52, s3, 2560
    s_add_u32 m0, s52, 128000
    s_lshl_b32 s52, s34, 7
    s_add_u32 s52, s52, 23166976
    buffer_load_dwordx4 v248, s[36:39], s52 offen sc1 lds
    buffer_load_dwordx4 v248, s[36:39], s52 offen offset:1024 sc1 lds
    s_mov_b32 exec_hi, 0
    buffer_load_dwordx4 v248, s[36:39], s52 offen offset:2048 sc1 lds
    s_mov_b32 exec_hi, -1
    s_lshr_b32 s52, s71, 1
    s_lshl_b32 s52, s52, 2
    s_add_u32 s52, s52, s3
    s_mul_i32 s52, s52, 10240
    s_and_b32 s53, s71, 1
    s_mul_i32 s53, s53, 640
    s_add_u32 s52, s52, s53
    s_mul_i32 s53, s3, 5120
    v_add_u32 v5, 0, v1
    v_mul_u32_u24 v6, 205, v5
    v_lshrrev_b32 v6, 13, v6
    v_mul_u32_u24 v6, 640, v6
    v_lshl_add_u32 v5, v5, 4, v6
    s_add_u32 m0, s53, 107520
    s_nop 0
    buffer_load_dwordx4 v5, s[56:59], s52 offen nt lds
    v_add_u32 v5, 64, v1
    v_mul_u32_u24 v6, 205, v5
    v_lshrrev_b32 v6, 13, v6
    v_mul_u32_u24 v6, 640, v6
    v_lshl_add_u32 v5, v5, 4, v6
    s_add_u32 m0, s53, 108544
    s_nop 0
    buffer_load_dwordx4 v5, s[56:59], s52 offen nt lds
    v_add_u32 v5, 128, v1
    v_mul_u32_u24 v6, 205, v5
    v_lshrrev_b32 v6, 13, v6
    v_mul_u32_u24 v6, 640, v6
    v_lshl_add_u32 v5, v5, 4, v6
    s_add_u32 m0, s53, 109568
    s_nop 0
    buffer_load_dwordx4 v5, s[56:59], s52 offen nt lds
    v_add_u32 v5, 192, v1
    v_mul_u32_u24 v6, 205, v5
    v_lshrrev_b32 v6, 13, v6
    v_mul_u32_u24 v6, 640, v6
    v_lshl_add_u32 v5, v5, 4, v6
    s_add_u32 m0, s53, 110592
    s_nop 0
    buffer_load_dwordx4 v5, s[56:59], s52 offen nt lds
    v_add_u32 v5, 256, v1
    v_mul_u32_u24 v6, 205, v5
    v_lshrrev_b32 v6, 13, v6
    v_mul_u32_u24 v6, 640, v6
    v_lshl_add_u32 v5, v5, 4, v6
    s_add_u32 m0, s53, 111616
    s_nop 0
    buffer_load_dwordx4 v5, s[56:59], s52 offen nt lds
    s_waitcnt vmcnt(20)
    s_waitcnt lgkmcnt(0)
    s_barrier
    ds_read_b64_tr_b16 a[168:169], v238 offset:24832
    ds_read_b64_tr_b16 a[170:171], v238 offset:26368
    ds_read_b64_tr_b16 a[172:173], v238 offset:31056
    ds_read_b64_tr_b16 a[174:175], v238 offset:32592
    ds_read_b64_tr_b16 a[176:177], v239 offset:24832
    ds_read_b64_tr_b16 a[178:179], v239 offset:26368
    ds_read_b64_tr_b16 a[180:181], v238 offset:37248
    ds_read_b64_tr_b16 a[182:183], v238 offset:38784
    ds_read_b64_tr_b16 a[184:185], v238 offset:43472
    ds_read_b64_tr_b16 a[186:187], v238 offset:45008
    ds_read_b64_tr_b16 a[188:189], v239 offset:37248
    ds_read_b64_tr_b16 a[190:191], v239 offset:38784
    s_waitcnt vmcnt(14)
    s_waitcnt lgkmcnt(0)
    s_barrier
    ds_read_b64_tr_b16 a[192:193], v233 offset:0
    ds_read_b64_tr_b16 a[194:195], v233 offset:1536
    ds_read_b64_tr_b16 a[196:197], v233 offset:6224
    ds_read_b64_tr_b16 a[198:199], v233 offset:7760
    ds_read_b64_tr_b16 a[200:201], v234 offset:0
    ds_read_b64_tr_b16 a[202:203], v234 offset:1536
    ds_read_b64_tr_b16 a[204:205], v233 offset:12416
    ds_read_b64_tr_b16 a[206:207], v233 offset:13952
    ds_read_b64_tr_b16 a[208:209], v233 offset:18640
    ds_read_b64_tr_b16 a[210:211], v233 offset:20176
    ds_read_b64_tr_b16 a[212:213], v234 offset:12416
    ds_read_b64_tr_b16 a[214:215], v234 offset:13952
    s_waitcnt vmcnt(8)
    s_waitcnt lgkmcnt(0)
    s_barrier
    ds_read_b64_tr_b16 a[216:217], v233 offset:24832
    ds_read_b64_tr_b16 a[218:219], v233 offset:26368
    ds_read_b64_tr_b16 a[220:221], v233 offset:31056
    ds_read_b64_tr_b16 a[222:223], v233 offset:32592
    ds_read_b64_tr_b16 a[224:225], v234 offset:24832
    ds_read_b64_tr_b16 a[226:227], v234 offset:26368
    ds_read_b64_tr_b16 a[228:229], v233 offset:37248
    ds_read_b64_tr_b16 a[230:231], v233 offset:38784
    ds_read_b64_tr_b16 a[232:233], v233 offset:43472
    ds_read_b64_tr_b16 a[234:235], v233 offset:45008
    ds_read_b64_tr_b16 a[236:237], v234 offset:37248
    ds_read_b64_tr_b16 a[238:239], v234 offset:38784
    s_waitcnt lgkmcnt(0)
    s_barrier
    s_mov_b32 s64, s69
    v_and_b32 v165, 1, v1
    v_lshlrev_b32 v165, 6, v165
    v_and_b32 v166, 48, v1
    s_mul_i32 s57, s3, 2560
    s_add_u32 s57, s57, 128000
    v_add3_u32 v165, v165, v166, s57
    s_waitcnt vmcnt(5)
    ds_read_b128 v[40:43], v165 offset:0
    ds_read_b128 v[44:47], v165 offset:128
    ds_read_b128 v[48:51], v165 offset:256
    ds_read_b128 v[52:55], v165 offset:384
    ds_read_b128 v[56:59], v165 offset:512
    ds_read_b128 v[60:63], v165 offset:640
    s_waitcnt lgkmcnt(5)
    v_mfma_f32_16x16x32_bf16 v[176:179], a[0:3], v[40:43], 0
    ds_read_b128 v[64:67], v165 offset:768
    v_mfma_f32_16x16x32_bf16 v[180:183], a[4:7], v[40:43], 0
    v_mfma_f32_16x16x32_bf16 v[184:187], a[8:11], v[40:43], 0
    s_waitcnt lgkmcnt(5)
    v_mfma_f32_16x16x32_bf16 v[176:179], a[12:15], v[44:47], v[176:179]
    ds_read_b128 v[68:71], v165 offset:896
    v_mfma_f32_16x16x32_bf16 v[180:183], a[16:19], v[44:47], v[180:183]
    v_mfma_f32_16x16x32_bf16 v[184:187], a[20:23], v[44:47], v[184:187]
    s_waitcnt lgkmcnt(5)
    v_mfma_f32_16x16x32_bf16 v[176:179], a[24:27], v[48:51], v[176:179]
    ds_read_b128 v[40:43], v165 offset:1024
    v_mfma_f32_16x16x32_bf16 v[180:183], a[28:31], v[48:51], v[180:183]
    v_mfma_f32_16x16x32_bf16 v[184:187], a[32:35], v[48:51], v[184:187]
    s_waitcnt lgkmcnt(5)
    v_mfma_f32_16x16x32_bf16 v[176:179], a[36:39], v[52:55], v[176:179]
    ds_read_b128 v[44:47], v165 offset:1152
    v_mfma_f32_16x16x32_bf16 v[180:183], a[40:43], v[52:55], v[180:183]
    v_mfma_f32_16x16x32_bf16 v[184:187], a[44:47], v[52:55], v[184:187]
    s_waitcnt lgkmcnt(5)
    v_mfma_f32_16x16x32_bf16 v[176:179], a[48:51], v[56:59], v[176:179]
    ds_read_b128 v[48:51], v165 offset:1280
    v_mfma_f32_16x16x32_bf16 v[180:183], a[52:55], v[56:59], v[180:183]
    v_mfma_f32_16x16x32_bf16 v[184:187], a[56:59], v[56:59], v[184:187]
    s_waitcnt lgkmcnt(5)
    v_mfma_f32_16x16x32_bf16 v[176:179], a[60:63], v[60:63], v[176:179]
    ds_read_b128 v[52:55], v165 offset:1408
    v_mfma_f32_16x16x32_bf16 v[180:183], a[64:67], v[60:63], v[180:183]
    v_mfma_f32_16x16x32_bf16 v[184:187], a[68:71], v[60:63], v[184:187]
    s_waitcnt lgkmcnt(5)
    v_mfma_f32_16x16x32_bf16 v[176:179], a[72:75], v[64:67], v[176:179]
    ds_read_b128 v[56:59], v165 offset:1536
    v_mfma_f32_16x16x32_bf16 v[180:183], a[76:79], v[64:67], v[180:183]
    v_mfma_f32_16x16x32_bf16 v[184:187], a[80:83], v[64:67], v[184:187]
    s_waitcnt lgkmcnt(5)
    v_mfma_f32_16x16x32_bf16 v[176:179], a[84:87], v[68:71], v[176:179]
    ds_read_b128 v[60:63], v165 offset:1664
    v_mfma_f32_16x16x32_bf16 v[180:183], a[88:91], v[68:71], v[180:183]
    v_mfma_f32_16x16x32_bf16 v[184:187], a[92:95], v[68:71], v[184:187]
    s_waitcnt lgkmcnt(5)
    v_mfma_f32_16x16x32_bf16 v[176:179], a[96:99], v[40:43], v[176:179]
    ds_read_b128 v[64:67], v165 offset:1792
    v_mfma_f32_16x16x32_bf16 v[180:183], a[100:103], v[40:43], v[180:183]
    v_mfma_f32_16x16x32_bf16 v[184:187], a[104:107], v[40:43], v[184:187]
    s_waitcnt lgkmcnt(5)
    v_mfma_f32_16x16x32_bf16 v[176:179], a[108:111], v[44:47], v[176:179]
    ds_read_b128 v[68:71], v165 offset:1920
    v_mfma_f32_16x16x32_bf16 v[180:183], a[112:115], v[44:47], v[180:183]
    v_mfma_f32_16x16x32_bf16 v[184:187], a[116:119], v[44:47], v[184:187]
    s_waitcnt lgkmcnt(5)
    v_mfma_f32_16x16x32_bf16 v[176:179], a[120:123], v[48:51], v[176:179]
    ds_read_b128 v[40:43], v165 offset:2048
    v_mfma_f32_16x16x32_bf16 v[180:183], a[124:127], v[48:51], v[180:183]
    v_mfma_f32_16x16x32_bf16 v[184:187], a[128:131], v[48:51], v[184:187]
    s_waitcnt lgkmcnt(5)
    v_mfma_f32_16x16x32_bf16 v[176:179], a[132:135], v[52:55], v[176:179]
    ds_read_b128 v[44:47], v165 offset:2176
    v_mfma_f32_16x16x32_bf16 v[180:183], a[136:139], v[52:55], v[180:183]
    v_mfma_f32_16x16x32_bf16 v[184:187], a[140:143], v[52:55], v[184:187]
    s_waitcnt lgkmcnt(5)
    v_mfma_f32_16x16x32_bf16 v[176:179], a[144:147], v[56:59], v[176:179]
    ds_read_b128 v[48:51], v165 offset:2304
    v_mfma_f32_16x16x32_bf16 v[180:183], a[148:151], v[56:59], v[180:183]
    v_mfma_f32_16x16x32_bf16 v[184:187], a[152:155], v[56:59], v[184:187]
    s_waitcnt lgkmcnt(5)
    v_mfma_f32_16x16x32_bf16 v[176:179], a[156:159], v[60:63], v[176:179]
    ds_read_b128 v[52:55], v165 offset:2432
    v_mfma_f32_16x16x32_bf16 v[180:183], a[160:163], v[60:63], v[180:183]
    v_mfma_f32_16x16x32_bf16 v[184:187], a[164:167], v[60:63], v[184:187]
    s_waitcnt lgkmcnt(5)
    v_mfma_f32_16x16x32_bf16 v[176:179], a[168:171], v[64:67], v[176:179]
    v_mfma_f32_16x16x32_bf16 v[180:183], a[172:175], v[64:67], v[180:183]
    v_mfma_f32_16x16x32_bf16 v[184:187], a[176:179], v[64:67], v[184:187]
    s_waitcnt lgkmcnt(4)
    v_mfma_f32_16x16x32_bf16 v[176:179], a[180:183], v[68:71], v[176:179]
    v_mfma_f32_16x16x32_bf16 v[180:183], a[184:187], v[68:71], v[180:183]
    v_mfma_f32_16x16x32_bf16 v[184:187], a[188:191], v[68:71], v[184:187]
    s_waitcnt lgkmcnt(3)
    v_mfma_f32_16x16x32_bf16 v[176:179], a[192:195], v[40:43], v[176:179]
    v_mfma_f32_16x16x32_bf16 v[180:183], a[196:199], v[40:43], v[180:183]
    v_mfma_f32_16x16x32_bf16 v[184:187], a[200:203], v[40:43], v[184:187]
    s_waitcnt lgkmcnt(2)
    v_mfma_f32_16x16x32_bf16 v[176:179], a[204:207], v[44:47], v[176:179]
    v_mfma_f32_16x16x32_bf16 v[180:183], a[208:211], v[44:47], v[180:183]
    v_mfma_f32_16x16x32_bf16 v[184:187], a[212:215], v[44:47], v[184:187]
    s_waitcnt lgkmcnt(1)
    v_mfma_f32_16x16x32_bf16 v[176:179], a[216:219], v[48:51], v[176:179]
    v_mfma_f32_16x16x32_bf16 v[180:183], a[220:223], v[48:51], v[180:183]
    v_mfma_f32_16x16x32_bf16 v[184:187], a[224:227], v[48:51], v[184:187]
    s_waitcnt lgkmcnt(0)
    v_mfma_f32_16x16x32_bf16 v[176:179], a[228:231], v[52:55], v[176:179]
    v_mfma_f32_16x16x32_bf16 v[180:183], a[232:235], v[52:55], v[180:183]
    v_mfma_f32_16x16x32_bf16 v[184:187], a[236:239], v[52:55], v[184:187]
    v_and_b32 v90, 1, v1
    v_mul_u32_u24 v90, 192, v90
    v_and_b32 v91, 48, v1
    v_add_u32 v90, v90, v91
    s_mov_b32 exec_lo, 0x00030003
    s_mov_b32 exec_hi, 0x00030003
    buffer_store_dwordx4 v[176:179], v90, s[36:39], s9 offen offset:0 sc1
    buffer_store_dwordx4 v[180:183], v90, s[36:39], s9 offen offset:64 sc1
    buffer_store_dwordx4 v[184:187], v90, s[36:39], s9 offen offset:128 sc1
    s_mov_b64 exec, -1
    s_waitcnt vmcnt(0)
    s_barrier
    v_lshrrev_b32 v2, 4, v1
    v_bfe_u32 v3, v1, 2, 2
    v_lshl_add_u32 v3, v2, 3, v3
    v_mul_u32_u24 v3, 640, v3
    v_and_b32 v2, 3, v1
    v_lshl_add_u32 v2, v2, 3, v3
    s_mul_i32 s50, s3, 160
    s_add_u32 s50, s50, 107520
    v_add_u32 v2, s50, v2
    s_lshr_b32 s53, s71, 1
    s_mov_b32 s50, 0x15555556
    s_mul_hi_u32 s51, s53, s50
    s_mul_i32 s52, s51, 12
    s_sub_u32 s52, s53, s52
    s_and_b32 s50, s71, 1
    s_lshl_b32 s50, s50, 2
    s_add_u32 s50, s50, s3
    s_lshl_b32 s50, s50, 2
    s_add_u32 s50, s50, s51
    s_mul_i32 s50, s50, 60
    s_mul_i32 s52, s52, 5
    s_add_u32 s50, s50, s52
    s_lshl_b32 s50, s50, 10
    s_add_u32 s50, s50, 14417920
    s_add_u32 s51, s50, 4096
    ds_read_b64_tr_b16 v[16:17], v2 offset:0
    ds_read_b64_tr_b16 v[18:19], v2 offset:2560
    ds_read_b64_tr_b16 v[20:21], v2 offset:32
    ds_read_b64_tr_b16 v[22:23], v2 offset:2592
    ds_read_b64_tr_b16 v[24:25], v2 offset:64
    ds_read_b64_tr_b16 v[26:27], v2 offset:2624
    ds_read_b64_tr_b16 v[28:29], v2 offset:96
    ds_read_b64_tr_b16 v[30:31], v2 offset:2656
    ds_read_b64_tr_b16 v[32:33], v2 offset:128
    ds_read_b64_tr_b16 v[34:35], v2 offset:2688
    s_waitcnt lgkmcnt(8)
    buffer_store_dwordx4 v[16:19], v248, s[36:39], s50 offen offset:0 sc1
    s_waitcnt lgkmcnt(6)
    buffer_store_dwordx4 v[20:23], v248, s[36:39], s50 offen offset:1024 sc1
    s_waitcnt lgkmcnt(4)
    buffer_store_dwordx4 v[24:27], v248, s[36:39], s50 offen offset:2048 sc1
    s_waitcnt lgkmcnt(2)
    buffer_store_dwordx4 v[28:31], v248, s[36:39], s50 offen offset:3072 sc1
    s_waitcnt lgkmcnt(0)
    buffer_store_dwordx4 v[32:35], v248, s[36:39], s51 offen offset:0 sc1
L_nobias:
    s_waitcnt vmcnt(0)
    s_barrier
    s_cmp_eq_u32 s3, 0
    s_cbranch_scc0 L_wf21
    s_lshl_b32 s54, s71, 7
    s_add_u32 s54, s54, 23233536
    v_mov_b32 v2, 0
    v_mov_b32 v3, s48
    s_mov_b64 exec, 1
    buffer_store_dword v3, v2, s[36:39], s54 offen sc1
    s_mov_b64 exec, -1
L_wf21:
    s_cmp_eq_u32 s76, 1
    s_cbranch_scc0 L_nobias2
    s_cmp_eq_u32 s3, 0
    s_cbranch_scc0 L_wf22
    s_lshl_b32 s54, s73, 7
    s_add_u32 s54, s54, 23286784
    v_mov_b32 v2, 0
    v_mov_b32 v3, s48
    s_mov_b64 exec, 1
    buffer_store_dword v3, v2, s[36:39], s54 offen sc1
    s_mov_b64 exec, -1
L_wf22:
L_nobias2:
    s_cmp_eq_u32 s2, 223
    s_cbranch_scc0 L_p_x
    v_lshlrev_b32 v5, 7, v0
    v_add_u32 v6, 134144, v5
    v_cmp_lt_u32 vcc, 159, v0
    s_nop 1
    v_cndmask_b32 v5, v5, v6, vcc
    s_mov_b32 s52, 23199744
L_poll23:
    buffer_load_dword v2, v5, s[36:39], s52 offen sc1
    s_waitcnt vmcnt(0)
    v_cmp_ne_u32 vcc, s48, v2
    s_cbranch_vccz L_poll23_ok
    s_cmp_eq_u32 s49, 0
    s_cbranch_scc1 L_poll23_ok
    s_sub_u32 s49, s49, 1
    s_sleep 1
    s_branch L_poll23
L_poll23_ok:
    s_barrier
    s_cmp_eq_u32 s3, 0
    s_cbranch_scc0 L_p_x
    s_mov_b32 s50, 23461888
    v_mov_b32 v2, 0
    v_mov_b32 v3, s48
    s_mov_b64 exec, 1
    buffer_store_dword v3, v2, s[36:39], s50 offen sc1
    s_mov_b64 exec, -1
L_p_x:
    v_min_u32 v2, 49, v1
    v_lshlrev_b32 v2, 7, v2
    v_add_u32 v2, 25600, v2
    v_cmp_lt_u32 vcc, 39, v1
    s_nop 1
    v_cndmask_b32 v219, v219, v2, vcc
    v_mov_b32 v200, v230
    v_mov_b32 v201, v231
    v_mov_b32 v202, v232
    v_add_u32 v203, 93568, v233
    v_add_u32 v204, 93568, v234
    s_add_u32 m0, s61, 101760
    s_nop 0
    buffer_load_dwordx4 v200, s[40:43], s64 offen offset:0 lds
    buffer_load_dwordx4 v201, s[40:43], s64 offen offset:1024 lds
    buffer_load_dwordx4 v202, s[40:43], s64 offen offset:2048 lds
    s_add_u32 s64, s64, 98304
    s_sub_u32 s35, s64, 1966080
    s_min_u32 s64, s64, s35
    s_add_u32 m0, s61, 114176
    s_nop 0
    buffer_load_dwordx4 v200, s[40:43], s64 offen offset:0 lds
    buffer_load_dwordx4 v201, s[40:43], s64 offen offset:1024 lds
    buffer_load_dwordx4 v202, s[40:43], s64 offen offset:2048 lds
    s_add_u32 s64, s64, 98304
    s_sub_u32 s35, s64, 1966080
    s_min_u32 s64, s64, s35
L_poll24:
    buffer_load_dword v223, v219, s[36:39], s17 offen sc1
    s_waitcnt vmcnt(0)
    v_cmp_ne_u32 vcc, s48, v223
    s_cbranch_vccz L_poll24_ok
    s_cmp_eq_u32 s49, 0
    s_cbranch_scc1 L_poll24_ok
    s_sub_u32 s49, s49, 1
    s_sleep 1
    s_branch L_poll24
L_poll24_ok:
    s_add_u32 m0, s63, 0
    s_nop 0
    buffer_load_dwordx4 v172, s[36:39], s10 offen sc1 lds
    s_add_u32 m0, s63, 4096
    s_nop 0
    buffer_load_dwordx4 v172, s[36:39], s11 offen sc1 lds
    s_add_u32 m0, s63, 8192
    s_nop 0
    buffer_load_dwordx4 v172, s[36:39], s12 offen sc1 lds
    s_add_u32 m0, s63, 12288
    s_nop 0
    buffer_load_dwordx4 v172, s[36:39], s13 offen sc1 lds
    s_add_u32 m0, s63, 16384
    s_nop 0
    buffer_load_dwordx4 v172, s[36:39], s14 offen sc1 lds
    s_add_u32 m0, s63, 20480
    s_nop 0
    buffer_load_dwordx4 v172, s[36:39], s15 offen sc1 lds
    s_add_u32 m0, s63, 24576
    s_nop 0
    buffer_load_dwordx4 v172, s[36:39], s18 offen sc1 lds
    s_add_u32 m0, s63, 28672
    s_nop 0
    buffer_load_dwordx4 v172, s[36:39], s19 offen sc1 lds
    s_add_u32 m0, s63, 32768
    s_nop 0
    buffer_load_dwordx4 v172, s[36:39], s20 offen sc1 lds
    s_add_u32 m0, s63, 36864
    s_nop 0
    buffer_load_dwordx4 v172, s[36:39], s21 offen sc1 lds
    s_add_u32 m0, s63, 40960
    s_nop 0
    buffer_load_dwordx4 v172, s[36:39], s22 offen sc1 lds
    s_add_u32 m0, s63, 45056
    s_nop 0
    buffer_load_dwordx4 v172, s[36:39], s23 offen sc1 lds
    v_lshlrev_b32 v2, 2, v0
    v_mov_b32 v3, 0x80000000
    v_cmp_gt_u32 vcc, 128, v0
    s_nop 1
    v_cndmask_b32 v3, v3, v2, vcc
    s_lshl_b32 s50, s34, 7
    s_add_u32 s50, s50, 23183360
    buffer_load_dword v220, v2, s[36:39], s50 offen sc1
    buffer_load_dword v221, v2, s[36:39], s50 offen offset:1024 sc1
    buffer_load_dword v222, v3, s[36:39], s50 offen offset:2048 sc1
    s_waitcnt vmcnt(12)
    s_waitcnt lgkmcnt(0)
    s_barrier
    ds_read_b64_tr_b16 v[104:105], v168 offset:0
    ds_read_b64_tr_b16 v[106:107], v168 offset:2048
    ds_read_b64_tr_b16 v[108:109], v169 offset:0
    ds_read_b64_tr_b16 v[110:111], v169 offset:2048
    ds_read_b64_tr_b16 v[112:113], v170 offset:0
    ds_read_b64_tr_b16 v[114:115], v170 offset:2048
    ds_read_b64_tr_b16 v[116:117], v171 offset:0
    ds_read_b64_tr_b16 v[118:119], v171 offset:2048
    s_waitcnt lgkmcnt(6)
    v_mfma_f32_16x16x32_bf16 v[56:59], a[0:3], v[104:107], 0
    ds_read_b64_tr_b16 v[120:121], v168 offset:4096
    v_mfma_f32_16x16x32_bf16 v[60:63], a[4:7], v[104:107], 0
    ds_read_b64_tr_b16 v[122:123], v168 offset:6144
    v_mfma_f32_16x16x32_bf16 v[64:67], a[8:11], v[104:107], 0
    s_waitcnt lgkmcnt(6)
    s_add_u32 m0, s63, 49152
    ds_read_b64_tr_b16 v[124:125], v169 offset:4096
    v_mfma_f32_16x16x32_bf16 v[68:71], a[0:3], v[108:111], 0
    buffer_load_dwordx4 v172, s[36:39], s24 offen sc1 lds
    v_mfma_f32_16x16x32_bf16 v[72:75], a[4:7], v[108:111], 0
    ds_read_b64_tr_b16 v[126:127], v169 offset:6144
    v_mfma_f32_16x16x32_bf16 v[76:79], a[8:11], v[108:111], 0
    s_waitcnt lgkmcnt(6)
    ds_read_b64_tr_b16 v[128:129], v170 offset:4096
    v_mfma_f32_16x16x32_bf16 v[80:83], a[0:3], v[112:115], 0
    s_add_u32 m0, s63, 53248
    ds_read_b64_tr_b16 v[130:131], v170 offset:6144
    v_mfma_f32_16x16x32_bf16 v[84:87], a[4:7], v[112:115], 0
    buffer_load_dwordx4 v172, s[36:39], s25 offen sc1 lds
    v_mfma_f32_16x16x32_bf16 v[88:91], a[8:11], v[112:115], 0
    s_waitcnt lgkmcnt(6)
    ds_read_b64_tr_b16 v[132:133], v171 offset:4096
    v_mfma_f32_16x16x32_bf16 v[92:95], a[0:3], v[116:119], 0
    s_waitcnt lgkmcnt(3)
    ds_read_b64_tr_b16 v[134:135], v171 offset:6144
    v_mfma_f32_16x16x32_bf16 v[96:99], a[4:7], v[116:119], 0
    s_add_u32 m0, s63, 57344
    v_mfma_f32_16x16x32_bf16 v[100:103], a[8:11], v[116:119], 0
    buffer_load_dwordx4 v172, s[36:39], s26 offen sc1 lds
    v_mfma_f32_16x16x32_bf16 v[56:59], a[12:15], v[120:123], v[56:59]
    ds_read_b64_tr_b16 v[104:105], v168 offset:8192
    v_mfma_f32_16x16x32_bf16 v[60:63], a[16:19], v[120:123], v[60:63]
    ds_read_b64_tr_b16 v[106:107], v168 offset:10240
    v_mfma_f32_16x16x32_bf16 v[64:67], a[20:23], v[120:123], v[64:67]
    s_add_u32 m0, s63, 61440
    ds_read_b64_tr_b16 v[108:109], v169 offset:8192
    v_mfma_f32_16x16x32_bf16 v[68:71], a[12:15], v[124:127], v[68:71]
    buffer_load_dwordx4 v172, s[36:39], s27 offen sc1 lds
    v_mfma_f32_16x16x32_bf16 v[72:75], a[16:19], v[124:127], v[72:75]
    ds_read_b64_tr_b16 v[110:111], v169 offset:10240
    v_mfma_f32_16x16x32_bf16 v[76:79], a[20:23], v[124:127], v[76:79]
    s_waitcnt lgkmcnt(6)
    ds_read_b64_tr_b16 v[112:113], v170 offset:8192
    v_mfma_f32_16x16x32_bf16 v[80:83], a[12:15], v[128:131], v[80:83]
    s_add_u32 m0, s63, 65536
    ds_read_b64_tr_b16 v[114:115], v170 offset:10240
    v_mfma_f32_16x16x32_bf16 v[84:87], a[16:19], v[128:131], v[84:87]
    buffer_load_dwordx4 v172, s[36:39], s44 offen sc1 lds
    v_mfma_f32_16x16x32_bf16 v[88:91], a[20:23], v[128:131], v[88:91]
    s_waitcnt lgkmcnt(6)
    ds_read_b64_tr_b16 v[116:117], v171 offset:8192
    v_mfma_f32_16x16x32_bf16 v[92:95], a[12:15], v[132:135], v[92:95]
    s_waitcnt lgkmcnt(3)
    ds_read_b64_tr_b16 v[118:119], v171 offset:10240
    v_mfma_f32_16x16x32_bf16 v[96:99], a[16:19], v[132:135], v[96:99]
    s_add_u32 m0, s63, 69632
    v_mfma_f32_16x16x32_bf16 v[100:103], a[20:23], v[132:135], v[100:103]
    buffer_load_dwordx4 v172, s[36:39], s45 offen sc1 lds
    v_mfma_f32_16x16x32_bf16 v[56:59], a[24:27], v[104:107], v[56:59]
    s_waitcnt vmcnt(13)
    s_barrier
    ds_read_b64_tr_b16 v[120:121], v168 offset:12288
    v_mfma_f32_16x16x32_bf16 v[60:63], a[28:31], v[104:107], v[60:63]
    ds_read_b64_tr_b16 v[122:123], v168 offset:14336
    v_mfma_f32_16x16x32_bf16 v[64:67], a[32:35], v[104:107], v[64:67]
    s_add_u32 m0, s63, 73728
    ds_read_b64_tr_b16 v[124:125], v169 offset:12288
    v_mfma_f32_16x16x32_bf16 v[68:71], a[24:27], v[108:111], v[68:71]
    buffer_load_dwordx4 v172, s[36:39], s46 offen sc1 lds
    v_mfma_f32_16x16x32_bf16 v[72:75], a[28:31], v[108:111], v[72:75]
    ds_read_b64_tr_b16 v[126:127], v169 offset:14336
    v_mfma_f32_16x16x32_bf16 v[76:79], a[32:35], v[108:111], v[76:79]
    s_waitcnt lgkmcnt(6)
    ds_read_b64_tr_b16 v[128:129], v170 offset:12288
    v_mfma_f32_16x16x32_bf16 v[80:83], a[24:27], v[112:115], v[80:83]
    s_add_u32 m0, s63, 77824
    ds_read_b64_tr_b16 v[130:131], v170 offset:14336
    v_mfma_f32_16x16x32_bf16 v[84:87], a[28:31], v[112:115], v[84:87]
    buffer_load_dwordx4 v172, s[36:39], s47 offen sc1 lds
    v_mfma_f32_16x16x32_bf16 v[88:91], a[32:35], v[112:115], v[88:91]
    s_waitcnt lgkmcnt(6)
    ds_read_b64_tr_b16 v[132:133], v171 offset:12288
    v_add_u32 v172, 2048, v172
    v_mfma_f32_16x16x32_bf16 v[92:95], a[24:27], v[116:119], v[92:95]
    s_waitcnt lgkmcnt(3)
    ds_read_b64_tr_b16 v[134:135], v171 offset:14336
    v_mfma_f32_16x16x32_bf16 v[96:99], a[28:31], v[116:119], v[96:99]
    s_add_u32 m0, s61, 126592
    v_mfma_f32_16x16x32_bf16 v[100:103], a[32:35], v[116:119], v[100:103]
    buffer_load_dwordx4 v200, s[40:43], s64 offen offset:0 lds
    v_mfma_f32_16x16x32_bf16 v[56:59], a[36:39], v[120:123], v[56:59]
    ds_read_b64_tr_b16 v[104:105], v168 offset:16384
    v_mfma_f32_16x16x32_bf16 v[60:63], a[40:43], v[120:123], v[60:63]
    ds_read_b64_tr_b16 v[106:107], v168 offset:18432
    v_mfma_f32_16x16x32_bf16 v[64:67], a[44:47], v[120:123], v[64:67]
    s_add_u32 m0, s61, 126592
    ds_read_b64_tr_b16 v[108:109], v169 offset:16384
    v_mfma_f32_16x16x32_bf16 v[68:71], a[36:39], v[124:127], v[68:71]
    buffer_load_dwordx4 v201, s[40:43], s64 offen offset:1024 lds
    v_mfma_f32_16x16x32_bf16 v[72:75], a[40:43], v[124:127], v[72:75]
    ds_read_b64_tr_b16 v[110:111], v169 offset:18432
    v_mfma_f32_16x16x32_bf16 v[76:79], a[44:47], v[124:127], v[76:79]
    s_waitcnt lgkmcnt(6)
    ds_read_b64_tr_b16 v[112:113], v170 offset:16384
    v_mfma_f32_16x16x32_bf16 v[80:83], a[36:39], v[128:131], v[80:83]
    s_add_u32 m0, s61, 126592
    ds_read_b64_tr_b16 v[114:115], v170 offset:18432
    v_mfma_f32_16x16x32_bf16 v[84:87], a[40:43], v[128:131], v[84:87]
    buffer_load_dwordx4 v202, s[40:43], s64 offen offset:2048 lds
    v_mfma_f32_16x16x32_bf16 v[88:91], a[44:47], v[128:131], v[88:91]
    s_waitcnt lgkmcnt(6)
    s_add_u32 s64, s64, 98304
    ds_read_b64_tr_b16 v[116:117], v171 offset:16384
    v_mfma_f32_16x16x32_bf16 v[92:95], a[36:39], v[132:135], v[92:95]
    s_waitcnt lgkmcnt(3)
    s_sub_u32 s35, s64, 1966080
    ds_read_b64_tr_b16 v[118:119], v171 offset:18432
    v_mfma_f32_16x16x32_bf16 v[96:99], a[40:43], v[132:135], v[96:99]
    s_min_u32 s64, s64, s35
    v_mfma_f32_16x16x32_bf16 v[100:103], a[44:47], v[132:135], v[100:103]
    v_mfma_f32_16x16x32_bf16 v[56:59], a[48:51], v[104:107], v[56:59]
    ds_read_b64_tr_b16 v[120:121], v168 offset:20480
    v_mfma_f32_16x16x32_bf16 v[60:63], a[52:55], v[104:107], v[60:63]
    ds_read_b64_tr_b16 v[122:123], v168 offset:22528
    v_mfma_f32_16x16x32_bf16 v[64:67], a[56:59], v[104:107], v[64:67]
    s_add_u32 m0, s61, 139008
    ds_read_b64_tr_b16 v[124:125], v169 offset:20480
    v_mfma_f32_16x16x32_bf16 v[68:71], a[48:51], v[108:111], v[68:71]
    buffer_load_dwordx4 v200, s[40:43], s64 offen offset:0 lds
    v_mfma_f32_16x16x32_bf16 v[72:75], a[52:55], v[108:111], v[72:75]
    ds_read_b64_tr_b16 v[126:127], v169 offset:22528
    v_mfma_f32_16x16x32_bf16 v[76:79], a[56:59], v[108:111], v[76:79]
    s_waitcnt lgkmcnt(6)
    ds_read_b64_tr_b16 v[128:129], v170 offset:20480
    v_mfma_f32_16x16x32_bf16 v[80:83], a[48:51], v[112:115], v[80:83]
    s_add_u32 m0, s61, 139008
    ds_read_b64_tr_b16 v[130:131], v170 offset:22528
    v_min_u32 v243, 11, v1
    v_mfma_f32_16x16x32_bf16 v[84:87], a[52:55], v[112:115], v[84:87]
    buffer_load_dwordx4 v201, s[40:43], s64 offen offset:1024 lds
    v_mfma_f32_16x16x32_bf16 v[88:91], a[56:59], v[112:115], v[88:91]
    s_waitcnt lgkmcnt(6)
    ds_read_b64_tr_b16 v[132:133], v171 offset:20480
    v_lshlrev_b32 v243, 8, v243
    v_mfma_f32_16x16x32_bf16 v[92:95], a[48:51], v[116:119], v[92:95]
    s_waitcnt lgkmcnt(3)
    ds_read_b64_tr_b16 v[134:135], v171 offset:22528
    v_mfma_f32_16x16x32_bf16 v[96:99], a[52:55], v[116:119], v[96:99]
    s_add_u32 m0, s61, 139008
    v_mfma_f32_16x16x32_bf16 v[100:103], a[56:59], v[116:119], v[100:103]
    buffer_load_dwordx4 v202, s[40:43], s64 offen offset:2048 lds
    v_mfma_f32_16x16x32_bf16 v[56:59], a[60:63], v[120:123], v[56:59]
    s_mul_i32 s58, s3, 24
    s_lshr_b32 s57, s75, 2
    s_add_u32 s64, s64, 98304
    ds_read_b64_tr_b16 v[104:105], v168 offset:24576
    v_mfma_f32_16x16x32_bf16 v[60:63], a[64:67], v[120:123], v[60:63]
    s_add_u32 s58, s58, s57
    s_lshl_b32 s58, s58, 7
    ds_read_b64_tr_b16 v[106:107], v168 offset:26624
    v_mfma_f32_16x16x32_bf16 v[64:67], a[68:71], v[120:123], v[64:67]
    s_add_u32 s58, s58, 23233536
    s_sub_u32 s35, s64, 1966080
    ds_read_b64_tr_b16 v[108:109], v169 offset:24576
    v_mfma_f32_16x16x32_bf16 v[68:71], a[60:63], v[124:127], v[68:71]
    s_min_u32 s64, s64, s35
    buffer_load_dword v244, v243, s[36:39], s58 offen sc1
    v_mfma_f32_16x16x32_bf16 v[72:75], a[64:67], v[124:127], v[72:75]
    ds_read_b64_tr_b16 v[110:111], v169 offset:26624
    v_mfma_f32_16x16x32_bf16 v[76:79], a[68:71], v[124:127], v[76:79]
    s_waitcnt lgkmcnt(6)
    ds_read_b64_tr_b16 v[112:113], v170 offset:24576
    v_mfma_f32_16x16x32_bf16 v[80:83], a[60:63], v[128:131], v[80:83]
    s_add_u32 m0, s61, 151424
    ds_read_b64_tr_b16 v[114:115], v170 offset:26624
    v_mfma_f32_16x16x32_bf16 v[84:87], a[64:67], v[128:131], v[84:87]
    buffer_load_dwordx4 v200, s[40:43], s64 offen offset:0 lds
    v_mfma_f32_16x16x32_bf16 v[88:91], a[68:71], v[128:131], v[88:91]
    s_waitcnt lgkmcnt(6)
    ds_read_b64_tr_b16 v[116:117], v171 offset:24576
    v_mfma_f32_16x16x32_bf16 v[92:95], a[60:63], v[132:135], v[92:95]
    s_waitcnt lgkmcnt(3)
    ds_read_b64_tr_b16 v[118:119], v171 offset:26624
    v_mfma_f32_16x16x32_bf16 v[96:99], a[64:67], v[132:135], v[96:99]
    s_add_u32 m0, s61, 151424
    v_mfma_f32_16x16x32_bf16 v[100:103], a[68:71], v[132:135], v[100:103]
    buffer_load_dwordx4 v201, s[40:43], s64 offen offset:1024 lds
    v_mfma_f32_16x16x32_bf16 v[56:59], a[72:75], v[104:107], v[56:59]
    ds_read_b64_tr_b16 v[120:121], v168 offset:28672
    v_mfma_f32_16x16x32_bf16 v[60:63], a[76:79], v[104:107], v[60:63]
    ds_read_b64_tr_b16 v[122:123], v168 offset:30720
    v_mfma_f32_16x16x32_bf16 v[64:67], a[80:83], v[104:107], v[64:67]
    s_add_u32 m0, s61, 151424
    ds_read_b64_tr_b16 v[124:125], v169 offset:28672
    v_mfma_f32_16x16x32_bf16 v[68:71], a[72:75], v[108:111], v[68:71]
    buffer_load_dwordx4 v202, s[40:43], s64 offen offset:2048 lds
    v_mfma_f32_16x16x32_bf16 v[72:75], a[76:79], v[108:111], v[72:75]
    s_add_u32 s64, s64, 98304
    ds_read_b64_tr_b16 v[126:127], v169 offset:30720
    v_mfma_f32_16x16x32_bf16 v[76:79], a[80:83], v[108:111], v[76:79]
    s_waitcnt lgkmcnt(6)
    s_sub_u32 s35, s64, 1966080
    ds_read_b64_tr_b16 v[128:129], v170 offset:28672
    v_mfma_f32_16x16x32_bf16 v[80:83], a[72:75], v[112:115], v[80:83]
    s_min_u32 s64, s64, s35
    ds_read_b64_tr_b16 v[130:131], v170 offset:30720
    v_mfma_f32_16x16x32_bf16 v[84:87], a[76:79], v[112:115], v[84:87]
    v_mfma_f32_16x16x32_bf16 v[88:91], a[80:83], v[112:115], v[88:91]
    s_waitcnt lgkmcnt(6)
    ds_read_b64_tr_b16 v[132:133], v171 offset:28672
    v_mfma_f32_16x16x32_bf16 v[92:95], a[72:75], v[116:119], v[92:95]
    s_waitcnt lgkmcnt(3)
    ds_read_b64_tr_b16 v[134:135], v171 offset:30720
    v_mfma_f32_16x16x32_bf16 v[96:99], a[76:79], v[116:119], v[96:99]
    v_mfma_f32_16x16x32_bf16 v[100:103], a[80:83], v[116:119], v[100:103]
    v_mfma_f32_16x16x32_bf16 v[56:59], a[84:87], v[120:123], v[56:59]
    s_waitcnt vmcnt(10)
    s_barrier
    ds_read_b64_tr_b16 v[104:105], v168 offset:32768
    v_mfma_f32_16x16x32_bf16 v[60:63], a[88:91], v[120:123], v[60:63]
    ds_read_b64_tr_b16 v[106:107], v168 offset:34816
    ds_read_b64 v[224:225], v216
    v_mfma_f32_16x16x32_bf16 v[64:67], a[92:95], v[120:123], v[64:67]
    ds_read_b64_tr_b16 v[108:109], v169 offset:32768
    v_mfma_f32_16x16x32_bf16 v[68:71], a[84:87], v[124:127], v[68:71]
    ds_read_b64 v[226:227], v217
    v_mfma_f32_16x16x32_bf16 v[72:75], a[88:91], v[124:127], v[72:75]
    ds_read_b64_tr_b16 v[110:111], v169 offset:34816
    ds_read_b64 v[228:229], v218
    v_mfma_f32_16x16x32_bf16 v[76:79], a[92:95], v[124:127], v[76:79]
    s_waitcnt lgkmcnt(9)
    ds_read_b64_tr_b16 v[112:113], v170 offset:32768
    v_mfma_f32_16x16x32_bf16 v[80:83], a[84:87], v[128:131], v[80:83]
    s_barrier
    ds_read_b64_tr_b16 v[114:115], v170 offset:34816
    v_mfma_f32_16x16x32_bf16 v[84:87], a[88:91], v[128:131], v[84:87]
    ds_read_b64_tr_b16 a[180:181], v203 offset:0
    v_mfma_f32_16x16x32_bf16 v[88:91], a[92:95], v[128:131], v[88:91]
    s_waitcnt lgkmcnt(10)
    ds_read_b64_tr_b16 v[116:117], v171 offset:32768
    ds_read_b64_tr_b16 a[182:183], v203 offset:1536
    v_mfma_f32_16x16x32_bf16 v[92:95], a[84:87], v[132:135], v[92:95]
    s_waitcnt lgkmcnt(3)
    ds_read_b64_tr_b16 v[118:119], v171 offset:34816
    v_mfma_f32_16x16x32_bf16 v[96:99], a[88:91], v[132:135], v[96:99]
    ds_read_b64_tr_b16 a[184:185], v203 offset:6224
    v_lshlrev_b32 v230, 16, v224
    v_and_b32 v231, 0xffff0000, v224
    v_pk_mul_f32 v[230:231], v[230:231], v[220:221] op_sel_hi:[1,0]
    v_pk_mul_f32 v[234:235], v[230:231], v[230:231]
    v_lshlrev_b32 v232, 16, v225
    v_and_b32 v233, 0xffff0000, v225
    v_pk_mul_f32 v[232:233], v[232:233], v[220:221] op_sel_hi:[1,0]
    v_pk_mul_f32 v[236:237], v[232:233], v[232:233]
    v_lshlrev_b32 v2, 16, v226
    v_and_b32 v3, 0xffff0000, v226
    v_pk_mul_f32 v[2:3], v[2:3], v[220:221] op_sel:[0,1] op_sel_hi:[1,1]
    v_pk_add_f32 v[230:231], v[230:231], v[2:3]
    v_pk_fma_f32 v[234:235], v[2:3], v[2:3], v[234:235]
    v_lshlrev_b32 v2, 16, v227
    v_and_b32 v3, 0xffff0000, v227
    v_pk_mul_f32 v[2:3], v[2:3], v[220:221] op_sel:[0,1] op_sel_hi:[1,1]
    v_pk_add_f32 v[232:233], v[232:233], v[2:3]
    v_pk_fma_f32 v[236:237], v[2:3], v[2:3], v[236:237]
    v_lshlrev_b32 v2, 16, v228
    v_and_b32 v3, 0xffff0000, v228
    v_pk_mul_f32 v[2:3], v[2:3], v[222:223] op_sel_hi:[1,0]
    v_pk_add_f32 v[230:231], v[230:231], v[2:3]
    v_pk_fma_f32 v[234:235], v[2:3], v[2:3], v[234:235]
    v_lshlrev_b32 v2, 16, v229
    v_and_b32 v3, 0xffff0000, v229
    v_pk_mul_f32 v[2:3], v[2:3], v[222:223] op_sel_hi:[1,0]
    v_pk_add_f32 v[232:233], v[232:233], v[2:3]
    v_pk_fma_f32 v[236:237], v[2:3], v[2:3], v[236:237]
    v_mfma_f32_16x16x32_bf16 v[100:103], a[92:95], v[132:135], v[100:103]
    ds_read_b64_tr_b16 a[186:187], v203 offset:7760
    v_permlane32_swap_b32 v230, v234
    v_mfma_f32_16x16x32_bf16 v[56:59], a[96:99], v[104:107], v[56:59]
    ds_read_b64_tr_b16 v[120:121], v168 offset:36864
    ds_read_b64_tr_b16 a[188:189], v204 offset:0
    v_mfma_f32_16x16x32_bf16 v[60:63], a[100:103], v[104:107], v[60:63]
    ds_read_b64_tr_b16 v[122:123], v168 offset:38912
    v_permlane32_swap_b32 v231, v235
    v_mfma_f32_16x16x32_bf16 v[64:67], a[104:107], v[104:107], v[64:67]
    ds_read_b64_tr_b16 v[124:125], v169 offset:36864
    v_permlane32_swap_b32 v232, v236
    v_mfma_f32_16x16x32_bf16 v[68:71], a[96:99], v[108:111], v[68:71]
    ds_read_b64_tr_b16 a[190:191], v204 offset:1536
    v_permlane32_swap_b32 v233, v237
    v_mfma_f32_16x16x32_bf16 v[72:75], a[100:103], v[108:111], v[72:75]
    ds_read_b64_tr_b16 v[126:127], v169 offset:38912
    v_lshrrev_b32 v238, 1, v1
    v_add_f32 v230, v230, v234
    v_add_f32 v231, v231, v235
    v_mfma_f32_16x16x32_bf16 v[76:79], a[104:107], v[108:111], v[76:79]
    ds_read_b64_tr_b16 v[128:129], v170 offset:36864
    v_lshlrev_b32 v238, 10, v238
    v_mfma_f32_16x16x32_bf16 v[80:83], a[96:99], v[112:115], v[80:83]
    ds_read_b64_tr_b16 v[130:131], v170 offset:38912
    v_and_b32 v239, 1, v1
    v_mfma_f32_16x16x32_bf16 v[84:87], a[100:103], v[112:115], v[84:87]
    v_add_f32 v232, v232, v236
    v_mfma_f32_16x16x32_bf16 v[88:91], a[104:107], v[112:115], v[88:91]
    s_waitcnt lgkmcnt(10)
    ds_read_b64_tr_b16 v[132:133], v171 offset:36864
    v_lshl_add_u32 v219, v239, 7, v238
    v_mfma_f32_16x16x32_bf16 v[92:95], a[96:99], v[116:119], v[92:95]
    s_waitcnt lgkmcnt(3)
    ds_read_b64_tr_b16 v[134:135], v171 offset:38912
    v_add_f32 v233, v233, v237
    v_mfma_f32_16x16x32_bf16 v[96:99], a[100:103], v[116:119], v[96:99]
    v_permlane16_swap_b32 v230, v232
    v_permlane16_swap_b32 v231, v233
    v_mfma_f32_16x16x32_bf16 v[100:103], a[104:107], v[116:119], v[100:103]
    v_add_f32 v230, v230, v232
    v_add_f32 v231, v231, v233
    v_mfma_f32_16x16x32_bf16 v[56:59], a[108:111], v[120:123], v[56:59]
    s_lshl_b32 s55, s3, 8
    s_add_u32 s55, s55, 66560
    ds_read_b64_tr_b16 v[104:105], v168 offset:40960
    v_lshrrev_b32 v2, 4, v1
    v_lshlrev_b32 v2, 3, v2
    v_mfma_f32_16x16x32_bf16 v[60:63], a[112:115], v[120:123], v[60:63]
    s_barrier
    ds_read_b64_tr_b16 v[106:107], v168 offset:43008
    ds_read_b64_tr_b16 a[192:193], v203 offset:12416
    v_add_u32 v219, s55, v219
    v_mfma_f32_16x16x32_bf16 v[64:67], a[116:119], v[120:123], v[64:67]
    s_lshl_b32 s55, s73, 7
    s_add_u32 s55, s55, 87040
    ds_read_b64_tr_b16 v[108:109], v169 offset:40960
    v_mfma_f32_16x16x32_bf16 v[68:71], a[108:111], v[124:127], v[68:71]
    ds_read_b64_tr_b16 a[194:195], v203 offset:13952
    s_waitcnt vmcnt(3)
    v_cmp_ne_u32 vcc, s48, v244
    s_cbranch_vccnz L_chk25_slow
L_chk25_back:
    v_mfma_f32_16x16x32_bf16 v[72:75], a[112:115], v[124:127], v[72:75]
    s_lshl_b32 s50, s3, 5
    s_add_u32 s50, s50, 0
    ds_read_b64_tr_b16 v[110:111], v169 offset:43008
    v_mov_b32 v238, s55
    v_add_u32 v2, s50, v2
    v_add_f32_dpp v230, v230, v230 row_ror:8 row_mask:0xf bank_mask:0xf
    v_mfma_f32_16x16x32_bf16 v[76:79], a[116:119], v[124:127], v[76:79]
    s_waitcnt lgkmcnt(8)
    ds_read_b64_tr_b16 v[112:113], v170 offset:40960
    ds_read_b64_tr_b16 a[196:197], v203 offset:18640
    v_mfma_f32_16x16x32_bf16 v[80:83], a[108:111], v[128:131], v[80:83]
    ds_read_b64_tr_b16 v[114:115], v170 offset:43008
    ds_read_b64_tr_b16 a[198:199], v203 offset:20176
    v_mfma_f32_16x16x32_bf16 v[84:87], a[112:115], v[128:131], v[84:87]
    v_cmp_lt_u32 vcc, 39, v1
    s_nop 1
    v_cndmask_b32 v219, v219, v238, vcc
    buffer_load_dwordx4 a[240:243], v248, s[36:39], s62 offen offset:0 sc1
    v_mfma_f32_16x16x32_bf16 v[88:91], a[116:119], v[128:131], v[88:91]
    s_waitcnt lgkmcnt(10)
    s_mov_b32 s17, 23199744
    ds_read_b64_tr_b16 v[116:117], v171 offset:40960
    ds_read_b64_tr_b16 a[200:201], v204 offset:12416
    v_mfma_f32_16x16x32_bf16 v[92:95], a[108:111], v[132:135], v[92:95]
    s_waitcnt lgkmcnt(3)
    ds_read_b64_tr_b16 v[118:119], v171 offset:43008
    v_add_f32_dpp v231, v231, v231 row_ror:8 row_mask:0xf bank_mask:0xf
    v_mfma_f32_16x16x32_bf16 v[96:99], a[112:115], v[132:135], v[96:99]
    ds_read_b64_tr_b16 a[202:203], v204 offset:13952
    v_add_f32_dpp v230, v230, v230 row_ror:4 row_mask:0xf bank_mask:0xf
    v_mfma_f32_16x16x32_bf16 v[100:103], a[116:119], v[132:135], v[100:103]
    buffer_load_dwordx4 a[244:247], v248, s[36:39], s62 offen offset:1024 sc1
    v_mfma_f32_16x16x32_bf16 v[56:59], a[120:123], v[104:107], v[56:59]
    ds_read_b64_tr_b16 v[120:121], v168 offset:45056
    v_add_f32_dpp v231, v231, v231 row_ror:4 row_mask:0xf bank_mask:0xf
    v_mfma_f32_16x16x32_bf16 v[60:63], a[124:127], v[104:107], v[60:63]
    ds_read_b64_tr_b16 v[122:123], v168 offset:47104
    v_add_f32_dpp v230, v230, v230 row_ror:2 row_mask:0xf bank_mask:0xf
    v_mfma_f32_16x16x32_bf16 v[64:67], a[128:131], v[104:107], v[64:67]
    ds_read_b64_tr_b16 v[124:125], v169 offset:45056
    v_add_f32_dpp v231, v231, v231 row_ror:2 row_mask:0xf bank_mask:0xf
    v_mfma_f32_16x16x32_bf16 v[68:71], a[120:123], v[108:111], v[68:71]
    buffer_load_dwordx4 a[248:251], v248, s[36:39], s62 offen offset:2048 sc1
    v_mfma_f32_16x16x32_bf16 v[72:75], a[124:127], v[108:111], v[72:75]
    ds_read_b64_tr_b16 v[126:127], v169 offset:47104
    v_add_f32_dpp v230, v230, v230 row_ror:1 row_mask:0xf bank_mask:0xf
    v_mfma_f32_16x16x32_bf16 v[76:79], a[128:131], v[108:111], v[76:79]
    ds_read_b64_tr_b16 v[128:129], v170 offset:45056
    v_add_f32_dpp v231, v231, v231 row_ror:1 row_mask:0xf bank_mask:0xf
    s_mov_b32 exec_lo, 0x00010001
    s_mov_b32 exec_hi, 0x00010001
    ds_write_b64 v2, v[230:231]
    s_mov_b64 exec, -1
    v_lshlrev_b32 v2, 2, v1
    v_mfma_f32_16x16x32_bf16 v[80:83], a[120:123], v[112:115], v[80:83]
    s_waitcnt lgkmcnt(6)
    s_barrier
    ds_read_b64_tr_b16 v[130:131], v170 offset:47104
    v_mfma_f32_16x16x32_bf16 v[84:87], a[124:127], v[112:115], v[84:87]
    ds_read_b64_tr_b16 a[204:205], v203 offset:24832
    buffer_load_dwordx4 a[252:255], v248, s[36:39], s62 offen offset:3072 sc1
    v_mfma_f32_16x16x32_bf16 v[88:91], a[128:131], v[112:115], v[88:91]
    ds_read_b64_tr_b16 v[132:133], v171 offset:45056
    ds_read_b64_tr_b16 a[206:207], v203 offset:26368
    v_mfma_f32_16x16x32_bf16 v[92:95], a[120:123], v[116:119], v[92:95]
    s_waitcnt lgkmcnt(3)
    ds_read_b64_tr_b16 v[134:135], v171 offset:47104
    v_and_b32 v2, 12, v2
    v_add_u32 v2, 0, v2
    v_mfma_f32_16x16x32_bf16 v[96:99], a[124:127], v[116:119], v[96:99]
    s_add_u32 s62, s62, 4096
    buffer_load_dword v240, v219, s[36:39], s17 offen sc1
    v_mfma_f32_16x16x32_bf16 v[100:103], a[128:131], v[116:119], v[100:103]
    s_waitcnt lgkmcnt(0)
    s_barrier
    ds_read_b64_tr_b16 a[208:209], v203 offset:31056
    buffer_load_dwordx4 v[136:139], v248, s[36:39], s62 offen offset:0 sc1
    v_mfma_f32_16x16x32_bf16 v[56:59], a[132:135], v[120:123], v[56:59]
    ds_read_b64_tr_b16 v[104:105], v168 offset:49152
    ds_read_b64_tr_b16 a[210:211], v203 offset:32592
    ds_read2_b32 v[230:231], v2 offset0:0 offset1:4
    v_mfma_f32_16x16x32_bf16 v[60:63], a[136:139], v[120:123], v[60:63]
    ds_read_b64_tr_b16 v[106:107], v168 offset:51200
    ds_read_b64_tr_b16 a[212:213], v204 offset:24832
    v_mfma_f32_16x16x32_bf16 v[64:67], a[140:143], v[120:123], v[64:67]
    ds_read_b64_tr_b16 v[108:109], v169 offset:49152
    ds_read2_b32 v[232:233], v2 offset0:8 offset1:12
    ds_read2_b32 v[234:235], v2 offset0:16 offset1:20
    v_mfma_f32_16x16x32_bf16 v[68:71], a[132:135], v[124:127], v[68:71]
    ds_read_b64_tr_b16 a[214:215], v204 offset:26368
    buffer_load_dwordx4 v[140:143], v248, s[36:39], s62 offen offset:1024 sc1
    v_mfma_f32_16x16x32_bf16 v[72:75], a[136:139], v[124:127], v[72:75]
    ds_read_b64_tr_b16 v[110:111], v169 offset:51200
    ds_read2_b32 v[236:237], v2 offset0:24 offset1:28
    v_mfma_f32_16x16x32_bf16 v[76:79], a[140:143], v[124:127], v[76:79]
    ds_read_b64_tr_b16 v[112:113], v170 offset:49152
    v_mov_b32 v225, s48
    v_mfma_f32_16x16x32_bf16 v[80:83], a[132:135], v[128:131], v[80:83]
    ds_read_b64_tr_b16 v[114:115], v170 offset:51200
    v_mov_b32 v227, s48
    v_mfma_f32_16x16x32_bf16 v[84:87], a[136:139], v[128:131], v[84:87]
    buffer_load_dwordx4 v[144:147], v248, s[36:39], s62 offen offset:2048 sc1
    v_mfma_f32_16x16x32_bf16 v[88:91], a[140:143], v[128:131], v[88:91]
    ds_read_b64_tr_b16 v[116:117], v171 offset:49152
    s_waitcnt lgkmcnt(7)
    v_add_f32 v230, v230, v232
    v_mfma_f32_16x16x32_bf16 v[92:95], a[132:135], v[132:135], v[92:95]
    s_waitcnt lgkmcnt(3)
    ds_read_b64_tr_b16 v[118:119], v171 offset:51200
    v_add_f32 v231, v231, v233
    v_mfma_f32_16x16x32_bf16 v[96:99], a[136:139], v[132:135], v[96:99]
    v_add_f32 v234, v234, v236
    v_add_f32 v235, v235, v237
    v_mfma_f32_16x16x32_bf16 v[100:103], a[140:143], v[132:135], v[100:103]
    buffer_load_dwordx4 v[148:151], v248, s[36:39], s62 offen offset:3072 sc1
    v_mfma_f32_16x16x32_bf16 v[56:59], a[144:147], v[104:107], v[56:59]
    s_barrier
    ds_read_b64_tr_b16 v[120:121], v168 offset:53248
    v_add_f32 v230, v230, v234
    v_mfma_f32_16x16x32_bf16 v[60:63], a[148:151], v[104:107], v[60:63]
    ds_read_b64_tr_b16 v[122:123], v168 offset:55296
    ds_read_b64_tr_b16 a[216:217], v203 offset:37248
    v_mfma_f32_16x16x32_bf16 v[64:67], a[152:155], v[104:107], v[64:67]
    s_add_u32 s62, s62, 4096
    ds_read_b64_tr_b16 v[124:125], v169 offset:53248
    v_add_f32 v231, v231, v235
    v_mul_f32 v230, 0x3acccccd, v230
    v_mul_f32 v234, v230, v230
    v_mfma_f32_16x16x32_bf16 v[68:71], a[144:147], v[108:111], v[68:71]
    ds_read_b64_tr_b16 a[218:219], v203 offset:38784
    buffer_load_dwordx4 v[152:155], v248, s[36:39], s62 offen offset:0 sc1
    v_mfma_f32_16x16x32_bf16 v[72:75], a[148:151], v[108:111], v[72:75]
    ds_read_b64_tr_b16 v[126:127], v169 offset:55296
    ds_read_b64_tr_b16 a[220:221], v203 offset:43472
    v_mfma_f32_16x16x32_bf16 v[76:79], a[152:155], v[108:111], v[76:79]
    s_waitcnt lgkmcnt(9)
    ds_read_b64_tr_b16 v[128:129], v170 offset:53248
    ds_read_b64_tr_b16 a[222:223], v203 offset:45008
    v_mfma_f32_16x16x32_bf16 v[80:83], a[144:147], v[112:115], v[80:83]
    ds_read_b64_tr_b16 v[130:131], v170 offset:55296
    v_mov_b32 v224, 0x3acccccd
    v_fma_f32 v231, v231, v224, -v234
    v_max_f32 v231, 0, v231
    v_mfma_f32_16x16x32_bf16 v[84:87], a[148:151], v[112:115], v[84:87]
    ds_read_b64_tr_b16 a[224:225], v204 offset:37248
    buffer_load_dwordx4 v[156:159], v248, s[36:39], s62 offen offset:1024 sc1
    v_mfma_f32_16x16x32_bf16 v[88:91], a[152:155], v[112:115], v[88:91]
    s_waitcnt lgkmcnt(11)
    ds_read_b64_tr_b16 v[132:133], v171 offset:53248
    v_min_u32 v247, 23, v1
    v_mfma_f32_16x16x32_bf16 v[92:95], a[144:147], v[116:119], v[92:95]
    s_waitcnt lgkmcnt(3)
    ds_read_b64_tr_b16 v[134:135], v171 offset:55296
    v_lshlrev_b32 v247, 4, v247
    v_mfma_f32_16x16x32_bf16 v[96:99], a[148:151], v[116:119], v[96:99]
    ds_read_b64_tr_b16 a[226:227], v204 offset:38784
    v_add_f32 v231, 0x3727c5ac, v231
    v_rsq_f32 v224, v231
    v_mfma_f32_16x16x32_bf16 v[100:103], a[152:155], v[116:119], v[100:103]
    buffer_load_dwordx4 v[160:163], v248, s[36:39], s62 offen offset:2048 sc1
    v_mfma_f32_16x16x32_bf16 v[56:59], a[156:159], v[120:123], v[56:59]
    ds_read_b64_tr_b16 v[104:105], v168 offset:57344
    v_mul_f32_e64 v226, -v230, v224
    v_mfma_f32_16x16x32_bf16 v[60:63], a[160:163], v[120:123], v[60:63]
    ds_read_b64_tr_b16 v[106:107], v168 offset:59392
    s_mov_b64 exec, 0xf
    buffer_store_dwordx4 v[224:227], v248, s[36:39], s7 offen sc1
    s_mov_b64 exec, -1
    v_mfma_f32_16x16x32_bf16 v[64:67], a[164:167], v[120:123], v[64:67]
    ds_read_b64_tr_b16 v[108:109], v169 offset:57344
    v_mfma_f32_16x16x32_bf16 v[68:71], a[156:159], v[124:127], v[68:71]
    buffer_load_dwordx4 v[164:167], v248, s[36:39], s62 offen offset:3072 sc1
    v_mfma_f32_16x16x32_bf16 v[72:75], a[160:163], v[124:127], v[72:75]
    ds_read_b64_tr_b16 v[110:111], v169 offset:59392
    s_waitcnt vmcnt(8)
    v_cmp_ne_u32 vcc, s48, v240
    s_cbranch_vccnz L_chk26_slow
L_chk26_back:
    v_mfma_f32_16x16x32_bf16 v[76:79], a[164:167], v[124:127], v[76:79]
    s_waitcnt lgkmcnt(8)
    ds_read_b64_tr_b16 v[112:113], v170 offset:57344
    v_mfma_f32_16x16x32_bf16 v[80:83], a[156:159], v[128:131], v[80:83]
    s_waitcnt lgkmcnt(5)
    s_barrier
    s_add_u32 m0, s63, 81920
    ds_read_b64_tr_b16 v[114:115], v170 offset:59392
    v_mfma_f32_16x16x32_bf16 v[84:87], a[160:163], v[128:131], v[84:87]
    ds_read_b64_tr_b16 a[228:229], v203 offset:49664
    buffer_load_dwordx4 v172, s[36:39], s10 offen sc1 lds
    v_mfma_f32_16x16x32_bf16 v[88:91], a[164:167], v[128:131], v[88:91]
    ds_read_b64_tr_b16 v[116:117], v171 offset:57344
    ds_read_b64_tr_b16 a[230:231], v203 offset:51200
    v_mfma_f32_16x16x32_bf16 v[92:95], a[156:159], v[132:135], v[92:95]
    s_waitcnt lgkmcnt(3)
    s_add_u32 m0, s63, 5120
    ds_read_b64_tr_b16 v[118:119], v171 offset:59392
    v_mfma_f32_16x16x32_bf16 v[96:99], a[160:163], v[132:135], v[96:99]
    buffer_load_dwordx4 v247, s[36:39], s9 offen sc1 lds
    v_mfma_f32_16x16x32_bf16 v[100:103], a[164:167], v[132:135], v[100:103]
    s_add_u32 m0, s63, 86016
    ds_read_b64_tr_b16 a[232:233], v203 offset:55888
    v_mfma_f32_16x16x32_bf16 v[56:59], a[168:171], v[104:107], v[56:59]
    ds_read_b64_tr_b16 v[120:121], v168 offset:61440
    ds_read_b64_tr_b16 a[234:235], v203 offset:57424
    buffer_load_dwordx4 v172, s[36:39], s11 offen sc1 lds
    v_mfma_f32_16x16x32_bf16 v[60:63], a[172:175], v[104:107], v[60:63]
    ds_read_b64_tr_b16 v[122:123], v168 offset:63488
    v_add_u32 v168, 65536, v168
    v_mfma_f32_16x16x32_bf16 v[64:67], a[176:179], v[104:107], v[64:67]
    s_add_u32 m0, s63, 90112
    ds_read_b64_tr_b16 v[124:125], v169 offset:61440
    ds_read_b64_tr_b16 a[236:237], v204 offset:49664
    v_mfma_f32_16x16x32_bf16 v[68:71], a[168:171], v[108:111], v[68:71]
    ds_read_b64_tr_b16 a[238:239], v204 offset:51200
    buffer_load_dwordx4 v172, s[36:39], s12 offen sc1 lds
    v_mfma_f32_16x16x32_bf16 v[72:75], a[172:175], v[108:111], v[72:75]
    ds_read_b64_tr_b16 v[126:127], v169 offset:63488
    v_add_u32 v169, 65536, v169
    v_mfma_f32_16x16x32_bf16 v[76:79], a[176:179], v[108:111], v[76:79]
    ds_read_b64_tr_b16 v[128:129], v170 offset:61440
    v_mfma_f32_16x16x32_bf16 v[80:83], a[168:171], v[112:115], v[80:83]
    s_add_u32 m0, s63, 94208
    ds_read_b64_tr_b16 v[130:131], v170 offset:63488
    v_add_u32 v170, 65536, v170
    v_mfma_f32_16x16x32_bf16 v[84:87], a[172:175], v[112:115], v[84:87]
    buffer_load_dwordx4 v172, s[36:39], s13 offen sc1 lds
    v_mfma_f32_16x16x32_bf16 v[88:91], a[176:179], v[112:115], v[88:91]
    s_waitcnt lgkmcnt(10)
    ds_read_b64_tr_b16 v[132:133], v171 offset:61440
    v_mfma_f32_16x16x32_bf16 v[92:95], a[168:171], v[116:119], v[92:95]
    s_waitcnt lgkmcnt(3)
    ds_read_b64_tr_b16 v[134:135], v171 offset:63488
    v_add_u32 v171, 65536, v171
    v_mfma_f32_16x16x32_bf16 v[96:99], a[172:175], v[116:119], v[96:99]
    s_add_u32 m0, s63, 98304
    v_mfma_f32_16x16x32_bf16 v[100:103], a[176:179], v[116:119], v[100:103]
    buffer_load_dwordx4 v172, s[36:39], s14 offen sc1 lds
    v_mfma_f32_16x16x32_bf16 v[56:59], a[180:183], v[120:123], v[56:59]
    s_barrier
    ds_read_b64_tr_b16 v[104:105], v168 offset:0
    v_mfma_f32_16x16x32_bf16 v[60:63], a[184:187], v[120:123], v[60:63]
    ds_read_b64_tr_b16 v[106:107], v168 offset:2048
    v_mfma_f32_16x16x32_bf16 v[64:67], a[188:191], v[120:123], v[64:67]
    s_add_u32 m0, s63, 102400
    ds_read_b64_tr_b16 v[108:109], v169 offset:0
    v_mfma_f32_16x16x32_bf16 v[68:71], a[180:183], v[124:127], v[68:71]
    buffer_load_dwordx4 v172, s[36:39], s15 offen sc1 lds
    v_mfma_f32_16x16x32_bf16 v[72:75], a[184:187], v[124:127], v[72:75]
    ds_read_b64_tr_b16 v[110:111], v169 offset:2048
    v_mfma_f32_16x16x32_bf16 v[76:79], a[188:191], v[124:127], v[76:79]
    s_waitcnt lgkmcnt(6)
    ds_read_b64_tr_b16 v[112:113], v170 offset:0
    v_mfma_f32_16x16x32_bf16 v[80:83], a[180:183], v[128:131], v[80:83]
    s_add_u32 m0, s63, 106496
    ds_read_b64_tr_b16 v[114:115], v170 offset:2048
    v_mfma_f32_16x16x32_bf16 v[84:87], a[184:187], v[128:131], v[84:87]
    buffer_load_dwordx4 v172, s[36:39], s18 offen sc1 lds
    v_mfma_f32_16x16x32_bf16 v[88:91], a[188:191], v[128:131], v[88:91]
    s_waitcnt lgkmcnt(6)
    ds_read_b64_tr_b16 v[116:117], v171 offset:0
    v_mfma_f32_16x16x32_bf16 v[92:95], a[180:183], v[132:135], v[92:95]
    s_waitcnt lgkmcnt(3)
    ds_read_b64_tr_b16 v[118:119], v171 offset:2048
    v_mfma_f32_16x16x32_bf16 v[96:99], a[184:187], v[132:135], v[96:99]
    s_add_u32 m0, s63, 110592
    v_mfma_f32_16x16x32_bf16 v[100:103], a[188:191], v[132:135], v[100:103]
    buffer_load_dwordx4 v172, s[36:39], s19 offen sc1 lds
    v_mfma_f32_16x16x32_bf16 v[56:59], a[192:195], v[104:107], v[56:59]
    ds_read_b64_tr_b16 v[120:121], v168 offset:4096
    v_mfma_f32_16x16x32_bf16 v[60:63], a[196:199], v[104:107], v[60:63]
    ds_read_b64_tr_b16 v[122:123], v168 offset:6144
    v_mfma_f32_16x16x32_bf16 v[64:67], a[200:203], v[104:107], v[64:67]
    s_add_u32 m0, s63, 114688
    ds_read_b64_tr_b16 v[124:125], v169 offset:4096
    v_mfma_f32_16x16x32_bf16 v[68:71], a[192:195], v[108:111], v[68:71]
    buffer_load_dwordx4 v172, s[36:39], s20 offen sc1 lds
    v_mfma_f32_16x16x32_bf16 v[72:75], a[196:199], v[108:111], v[72:75]
    ds_read_b64_tr_b16 v[126:127], v169 offset:6144
    v_mfma_f32_16x16x32_bf16 v[76:79], a[200:203], v[108:111], v[76:79]
    s_waitcnt lgkmcnt(6)
    ds_read_b64_tr_b16 v[128:129], v170 offset:4096
    v_mfma_f32_16x16x32_bf16 v[80:83], a[192:195], v[112:115], v[80:83]
    s_add_u32 m0, s63, 118784
    ds_read_b64_tr_b16 v[130:131], v170 offset:6144
    v_mfma_f32_16x16x32_bf16 v[84:87], a[196:199], v[112:115], v[84:87]
    buffer_load_dwordx4 v172, s[36:39], s21 offen sc1 lds
    v_mfma_f32_16x16x32_bf16 v[88:91], a[200:203], v[112:115], v[88:91]
    s_waitcnt lgkmcnt(6)
    ds_read_b64_tr_b16 v[132:133], v171 offset:4096
    v_mfma_f32_16x16x32_bf16 v[92:95], a[192:195], v[116:119], v[92:95]
    s_waitcnt lgkmcnt(3)
    ds_read_b64_tr_b16 v[134:135], v171 offset:6144
    v_mfma_f32_16x16x32_bf16 v[96:99], a[196:199], v[116:119], v[96:99]
    s_add_u32 m0, s63, 122880
    v_mfma_f32_16x16x32_bf16 v[100:103], a[200:203], v[116:119], v[100:103]
    buffer_load_dwordx4 v172, s[36:39], s22 offen sc1 lds
    v_mfma_f32_16x16x32_bf16 v[56:59], a[204:207], v[120:123], v[56:59]
    ds_read_b64_tr_b16 v[104:105], v168 offset:8192
    v_mfma_f32_16x16x32_bf16 v[60:63], a[208:211], v[120:123], v[60:63]
    ds_read_b64_tr_b16 v[106:107], v168 offset:10240
    v_mfma_f32_16x16x32_bf16 v[64:67], a[212:215], v[120:123], v[64:67]
    s_add_u32 m0, s63, 126976
    ds_read_b64_tr_b16 v[108:109], v169 offset:8192
    v_mfma_f32_16x16x32_bf16 v[68:71], a[204:207], v[124:127], v[68:71]
    buffer_load_dwordx4 v172, s[36:39], s23 offen sc1 lds
    v_mfma_f32_16x16x32_bf16 v[72:75], a[208:211], v[124:127], v[72:75]
    ds_read_b64_tr_b16 v[110:111], v169 offset:10240
    v_mfma_f32_16x16x32_bf16 v[76:79], a[212:215], v[124:127], v[76:79]
    s_waitcnt lgkmcnt(6)
    ds_read_b64_tr_b16 v[112:113], v170 offset:8192
    v_mfma_f32_16x16x32_bf16 v[80:83], a[204:207], v[128:131], v[80:83]
    s_add_u32 m0, s63, 1024
    ds_read_b64_tr_b16 v[114:115], v170 offset:10240
    v_mfma_f32_16x16x32_bf16 v[84:87], a[208:211], v[128:131], v[84:87]
    buffer_load_dwordx4 v248, s[36:39], s6 offen sc1 lds
    v_mfma_f32_16x16x32_bf16 v[88:91], a[212:215], v[128:131], v[88:91]
    s_waitcnt lgkmcnt(6)
    ds_read_b64_tr_b16 v[116:117], v171 offset:8192
    v_mfma_f32_16x16x32_bf16 v[92:95], a[204:207], v[132:135], v[92:95]
    s_waitcnt lgkmcnt(3)
    ds_read_b64_tr_b16 v[118:119], v171 offset:10240
    v_mfma_f32_16x16x32_bf16 v[96:99], a[208:211], v[132:135], v[96:99]
    s_add_u32 m0, s63, 131072
    v_mfma_f32_16x16x32_bf16 v[100:103], a[212:215], v[132:135], v[100:103]
    buffer_load_dwordx4 v172, s[36:39], s24 offen sc1 lds
    v_mfma_f32_16x16x32_bf16 v[56:59], a[216:219], v[104:107], v[56:59]
    ds_read_b64_tr_b16 v[120:121], v168 offset:12288
    v_mfma_f32_16x16x32_bf16 v[60:63], a[220:223], v[104:107], v[60:63]
    ds_read_b64_tr_b16 v[122:123], v168 offset:14336
    v_add_u32 v168, 16384, v168
    v_mfma_f32_16x16x32_bf16 v[64:67], a[224:227], v[104:107], v[64:67]
    s_add_u32 m0, s63, 135168
    ds_read_b64_tr_b16 v[124:125], v169 offset:12288
    v_and_b32 v247, 48, v1
    v_mfma_f32_16x16x32_bf16 v[68:71], a[216:219], v[108:111], v[68:71]
    v_add_u32 v247, s63, v247
    buffer_load_dwordx4 v172, s[36:39], s25 offen sc1 lds
    v_mfma_f32_16x16x32_bf16 v[72:75], a[220:223], v[108:111], v[72:75]
    s_waitcnt vmcnt(14)
    ds_read_b64_tr_b16 v[126:127], v169 offset:14336
    v_add_u32 v169, 16384, v169
    v_mfma_f32_16x16x32_bf16 v[76:79], a[224:227], v[108:111], v[76:79]
    s_waitcnt lgkmcnt(6)
    ds_read_b64_tr_b16 v[128:129], v170 offset:12288
    ds_read_b128 v[176:179], v247 offset:5120
    v_mfma_f32_16x16x32_bf16 v[80:83], a[216:219], v[112:115], v[80:83]
    s_add_u32 m0, s63, 139264
    ds_read_b64_tr_b16 v[130:131], v170 offset:14336
    v_add_u32 v170, 16384, v170
    v_mfma_f32_16x16x32_bf16 v[84:87], a[220:223], v[112:115], v[84:87]
    ds_read_b128 v[180:183], v247 offset:5184
    buffer_load_dwordx4 v172, s[36:39], s26 offen sc1 lds
    v_mfma_f32_16x16x32_bf16 v[88:91], a[224:227], v[112:115], v[88:91]
    s_waitcnt lgkmcnt(8)
    ds_read_b64_tr_b16 v[132:133], v171 offset:12288
    ds_read_b128 v[184:187], v247 offset:5248
    v_mfma_f32_16x16x32_bf16 v[92:95], a[216:219], v[116:119], v[92:95]
    s_waitcnt lgkmcnt(3)
    ds_read_b64_tr_b16 v[134:135], v171 offset:14336
    v_add_u32 v171, 16384, v171
    v_mfma_f32_16x16x32_bf16 v[96:99], a[220:223], v[116:119], v[96:99]
    s_add_u32 m0, s63, 143360
    ds_read_b128 v[188:191], v247 offset:5312
    v_mfma_f32_16x16x32_bf16 v[100:103], a[224:227], v[116:119], v[100:103]
    ds_read_b128 v[192:195], v247 offset:5376
    buffer_load_dwordx4 v172, s[36:39], s27 offen sc1 lds
    v_mfma_f32_16x16x32_bf16 v[56:59], a[228:231], v[120:123], v[56:59]
    s_waitcnt vmcnt(15)
    s_barrier
    ds_read_b64_tr_b16 v[104:105], v168 offset:0
    v_mfma_f32_16x16x32_bf16 v[60:63], a[232:235], v[120:123], v[60:63]
    ds_read_b64_tr_b16 v[106:107], v168 offset:2048
    ds_read_b128 v[196:199], v247 offset:5440
    v_mfma_f32_16x16x32_bf16 v[64:67], a[236:239], v[120:123], v[64:67]
    s_add_u32 m0, s63, 147456
    ds_read_b64_tr_b16 v[108:109], v169 offset:0
    v_mfma_f32_16x16x32_bf16 v[68:71], a[228:231], v[124:127], v[68:71]
    buffer_load_dwordx4 v172, s[36:39], s44 offen sc1 lds
    v_mfma_f32_16x16x32_bf16 v[72:75], a[232:235], v[124:127], v[72:75]
    ds_read_b64_tr_b16 v[110:111], v169 offset:2048
    v_mfma_f32_16x16x32_bf16 v[76:79], a[236:239], v[124:127], v[76:79]
    ds_read_b64_tr_b16 v[112:113], v170 offset:0
    v_mfma_f32_16x16x32_bf16 v[80:83], a[228:231], v[128:131], v[80:83]
    s_add_u32 m0, s63, 151552
    ds_read_b64_tr_b16 v[114:115], v170 offset:2048
    v_mfma_f32_16x16x32_bf16 v[84:87], a[232:235], v[128:131], v[84:87]
    buffer_load_dwordx4 v172, s[36:39], s45 offen sc1 lds
    v_mfma_f32_16x16x32_bf16 v[88:91], a[236:239], v[128:131], v[88:91]
    s_waitcnt lgkmcnt(9)
    ds_read_b64_tr_b16 v[116:117], v171 offset:0
    v_mfma_f32_16x16x32_bf16 v[92:95], a[228:231], v[132:135], v[92:95]
    s_waitcnt lgkmcnt(3)
    ds_read_b64_tr_b16 v[118:119], v171 offset:2048
    v_mfma_f32_16x16x32_bf16 v[96:99], a[232:235], v[132:135], v[96:99]
    v_mfma_f32_16x16x32_bf16 v[100:103], a[236:239], v[132:135], v[100:103]
    v_mfma_f32_16x16x32_bf16 v[8:11], a[0:3], v[104:107], 0
    ds_read_b64_tr_b16 v[120:121], v168 offset:4096
    v_add_u32 v216, 81920, v216
    v_mfma_f32_16x16x32_bf16 v[12:15], a[4:7], v[104:107], 0
    ds_read_b64_tr_b16 v[122:123], v168 offset:6144
    v_add_u32 v217, 81920, v217
    v_mfma_f32_16x16x32_bf16 v[16:19], a[8:11], v[104:107], 0
    s_add_u32 m0, s63, 155648
    ds_read_b64_tr_b16 v[124:125], v169 offset:4096
    v_add_u32 v218, 81920, v218
    v_mfma_f32_16x16x32_bf16 v[20:23], a[0:3], v[108:111], 0
    buffer_load_dwordx4 v172, s[36:39], s46 offen sc1 lds
    v_mfma_f32_16x16x32_bf16 v[24:27], a[4:7], v[108:111], 0
    ds_read_b64_tr_b16 v[126:127], v169 offset:6144
    v_mfma_f32_16x16x32_bf16 v[28:31], a[8:11], v[108:111], 0
    s_waitcnt lgkmcnt(6)
    ds_read_b64_tr_b16 v[128:129], v170 offset:4096
    v_mfma_f32_16x16x32_bf16 v[32:35], a[0:3], v[112:115], 0
    s_add_u32 m0, s63, 159744
    ds_read_b64_tr_b16 v[130:131], v170 offset:6144
    v_mfma_f32_16x16x32_bf16 v[36:39], a[4:7], v[112:115], 0
    buffer_load_dwordx4 v172, s[36:39], s47 offen sc1 lds
    v_mfma_f32_16x16x32_bf16 v[40:43], a[8:11], v[112:115], 0
    s_waitcnt lgkmcnt(6)
    ds_read_b64_tr_b16 v[132:133], v171 offset:4096
    v_mfma_f32_16x16x32_bf16 v[44:47], a[0:3], v[116:119], 0
    s_waitcnt lgkmcnt(3)
    ds_read_b64_tr_b16 v[134:135], v171 offset:6144
    v_mfma_f32_16x16x32_bf16 v[48:51], a[4:7], v[116:119], 0
    v_mfma_f32_16x16x32_bf16 v[52:55], a[8:11], v[116:119], 0
    v_mfma_f32_16x16x32_bf16 v[8:11], a[12:15], v[120:123], v[8:11]
    s_waitcnt vmcnt(16)
    s_barrier
    ds_read_b64_tr_b16 v[104:105], v168 offset:8192
    v_mfma_f32_16x16x32_bf16 v[12:15], a[16:19], v[120:123], v[12:15]
    ds_read_b64_tr_b16 v[106:107], v168 offset:10240
    v_mfma_f32_16x16x32_bf16 v[16:19], a[20:23], v[120:123], v[16:19]
    s_waitcnt vmcnt(8)
    s_add_u32 s62, s62, 4096
    ds_read_b64_tr_b16 v[108:109], v169 offset:8192
    v_mfma_f32_16x16x32_bf16 v[20:23], a[12:15], v[124:127], v[20:23]
    ds_read_b128 v[200:203], v175 offset:1024
    buffer_load_dwordx4 a[0:3], v248, s[36:39], s62 offen offset:0 sc1
    v_mfma_f32_16x16x32_bf16 v[24:27], a[16:19], v[124:127], v[24:27]
    ds_read_b64_tr_b16 v[110:111], v169 offset:10240
    ds_read_b128 v[204:207], v175 offset:1280
    v_mfma_f32_16x16x32_bf16 v[28:31], a[20:23], v[124:127], v[28:31]
    s_waitcnt lgkmcnt(8)
    ds_read_b64_tr_b16 v[112:113], v170 offset:8192
    ds_read_b128 v[208:211], v175 offset:1536
    v_mfma_f32_16x16x32_bf16 v[32:35], a[12:15], v[128:131], v[32:35]
    ds_read_b64_tr_b16 v[114:115], v170 offset:10240
    v_mfma_f32_16x16x32_bf16 v[36:39], a[16:19], v[128:131], v[36:39]
    ds_read_b128 v[212:215], v175 offset:1792
    buffer_load_dwordx4 a[4:7], v248, s[36:39], s62 offen offset:1024 sc1
    v_mfma_f32_16x16x32_bf16 v[40:43], a[20:23], v[128:131], v[40:43]
    s_waitcnt lgkmcnt(10)
    ds_read_b64_tr_b16 v[116:117], v171 offset:8192
    v_mfma_f32_16x16x32_bf16 v[44:47], a[12:15], v[132:135], v[44:47]
    s_waitcnt lgkmcnt(3)
    ds_read_b64_tr_b16 v[118:119], v171 offset:10240
    v_mfma_f32_16x16x32_bf16 v[48:51], a[16:19], v[132:135], v[48:51]
    v_xor_b32 v3, s48, v201
    v_bitop3_b32 v3, v203, s48, v3 bitop3:0xbe
    v_mfma_f32_16x16x32_bf16 v[52:55], a[20:23], v[132:135], v[52:55]
    buffer_load_dwordx4 a[8:11], v248, s[36:39], s62 offen offset:2048 sc1
    v_mfma_f32_16x16x32_bf16 v[8:11], a[24:27], v[104:107], v[8:11]
    ds_read_b64_tr_b16 v[120:121], v168 offset:12288
    v_bitop3_b32 v3, v205, s48, v3 bitop3:0xbe
    v_mfma_f32_16x16x32_bf16 v[12:15], a[28:31], v[104:107], v[12:15]
    ds_read_b64_tr_b16 v[122:123], v168 offset:14336
    v_bitop3_b32 v3, v207, s48, v3 bitop3:0xbe
    v_bitop3_b32 v3, v209, s48, v3 bitop3:0xbe
    v_mfma_f32_16x16x32_bf16 v[16:19], a[32:35], v[104:107], v[16:19]
    ds_read_b64_tr_b16 v[124:125], v169 offset:12288
    v_bitop3_b32 v3, v211, s48, v3 bitop3:0xbe
    v_mfma_f32_16x16x32_bf16 v[20:23], a[24:27], v[108:111], v[20:23]
    s_waitcnt lgkmcnt(5)
    v_bitop3_b32 v3, v213, s48, v3 bitop3:0xbe
    buffer_load_dwordx4 a[12:15], v248, s[36:39], s62 offen offset:3072 sc1
    v_mfma_f32_16x16x32_bf16 v[24:27], a[28:31], v[108:111], v[24:27]
    ds_read_b64_tr_b16 v[126:127], v169 offset:14336
    v_bitop3_b32 v3, v215, s48, v3 bitop3:0xbe
    v_mfma_f32_16x16x32_bf16 v[28:31], a[32:35], v[108:111], v[28:31]
    ds_read_b64_tr_b16 v[128:129], v170 offset:12288
    v_cmp_ne_u32 vcc, 0, v3
    s_cbranch_vccnz L_stp0_slow
L_stp0_back:
    v_mfma_f32_16x16x32_bf16 v[32:35], a[24:27], v[112:115], v[32:35]
    s_add_u32 s62, s62, 4096
    ds_read_b64_tr_b16 v[130:131], v170 offset:14336
    s_add_u32 s50, s8, 98304
    v_pk_fma_f32 v[238:239], v[176:177], v[202:203], v[188:189] op_sel_hi:[1,0,1]
    v_pk_fma_f32 v[240:241], v[178:179], v[202:203], v[190:191] op_sel_hi:[1,0,1]
    v_pk_fma_f32 v[56:57], v[56:57], v[200:201], v[238:239] op_sel_hi:[1,0,1]
    v_pk_fma_f32 v[58:59], v[58:59], v[200:201], v[240:241] op_sel_hi:[1,0,1]
    v_pk_fma_f32 v[242:243], v[180:181], v[202:203], v[192:193] op_sel_hi:[1,0,1]
    v_pk_fma_f32 v[244:245], v[182:183], v[202:203], v[194:195] op_sel_hi:[1,0,1]
    v_pk_fma_f32 v[60:61], v[60:61], v[200:201], v[242:243] op_sel_hi:[1,0,1]
    v_pk_fma_f32 v[62:63], v[62:63], v[200:201], v[244:245] op_sel_hi:[1,0,1]
    v_pk_mul_f32 v[56:57], v[56:57], v[60:61]
    v_pk_mul_f32 v[58:59], v[58:59], v[62:63]
    v_cvt_pk_bf16_f32 v60, v56, v57
    v_cvt_pk_bf16_f32 v61, v58, v59
    v_pk_fma_f32 v[242:243], v[176:177], v[206:207], v[188:189] op_sel_hi:[1,0,1]
    v_pk_fma_f32 v[244:245], v[178:179], v[206:207], v[190:191] op_sel_hi:[1,0,1]
    v_pk_fma_f32 v[68:69], v[68:69], v[204:205], v[242:243] op_sel_hi:[1,0,1]
    v_pk_fma_f32 v[70:71], v[70:71], v[204:205], v[244:245] op_sel_hi:[1,0,1]
    v_pk_fma_f32 v[238:239], v[180:181], v[206:207], v[192:193] op_sel_hi:[1,0,1]
    v_pk_fma_f32 v[240:241], v[182:183], v[206:207], v[194:195] op_sel_hi:[1,0,1]
    v_pk_fma_f32 v[72:73], v[72:73], v[204:205], v[238:239] op_sel_hi:[1,0,1]
    v_pk_fma_f32 v[74:75], v[74:75], v[204:205], v[240:241] op_sel_hi:[1,0,1]
    v_pk_mul_f32 v[68:69], v[68:69], v[72:73]
    v_pk_mul_f32 v[70:71], v[70:71], v[74:75]
    v_cvt_pk_bf16_f32 v62, v68, v69
    v_cvt_pk_bf16_f32 v63, v70, v71
    s_nop 0
    v_permlane16_swap_b32 v60, v62
    v_permlane16_swap_b32 v61, v63
    buffer_store_dwordx4 v[60:63], v173, s[36:39], s8 offen sc1
    v_pk_fma_f32 v[238:239], v[176:177], v[210:211], v[188:189] op_sel_hi:[1,0,1]
    v_pk_fma_f32 v[240:241], v[178:179], v[210:211], v[190:191] op_sel_hi:[1,0,1]
    v_pk_fma_f32 v[80:81], v[80:81], v[208:209], v[238:239] op_sel_hi:[1,0,1]
    v_pk_fma_f32 v[82:83], v[82:83], v[208:209], v[240:241] op_sel_hi:[1,0,1]
    v_pk_fma_f32 v[242:243], v[180:181], v[210:211], v[192:193] op_sel_hi:[1,0,1]
    v_pk_fma_f32 v[244:245], v[182:183], v[210:211], v[194:195] op_sel_hi:[1,0,1]
    v_pk_fma_f32 v[84:85], v[84:85], v[208:209], v[242:243] op_sel_hi:[1,0,1]
    v_pk_fma_f32 v[86:87], v[86:87], v[208:209], v[244:245] op_sel_hi:[1,0,1]
    v_pk_mul_f32 v[80:81], v[80:81], v[84:85]
    v_pk_mul_f32 v[82:83], v[82:83], v[86:87]
    v_cvt_pk_bf16_f32 v84, v80, v81
    v_cvt_pk_bf16_f32 v85, v82, v83
    v_pk_fma_f32 v[242:243], v[176:177], v[214:215], v[188:189] op_sel_hi:[1,0,1]
    v_pk_fma_f32 v[244:245], v[178:179], v[214:215], v[190:191] op_sel_hi:[1,0,1]
    v_pk_fma_f32 v[92:93], v[92:93], v[212:213], v[242:243] op_sel_hi:[1,0,1]
    v_pk_fma_f32 v[94:95], v[94:95], v[212:213], v[244:245] op_sel_hi:[1,0,1]
    v_pk_fma_f32 v[238:239], v[180:181], v[214:215], v[192:193] op_sel_hi:[1,0,1]
    v_pk_fma_f32 v[240:241], v[182:183], v[214:215], v[194:195] op_sel_hi:[1,0,1]
    v_pk_fma_f32 v[96:97], v[96:97], v[212:213], v[238:239] op_sel_hi:[1,0,1]
    v_pk_fma_f32 v[98:99], v[98:99], v[212:213], v[240:241] op_sel_hi:[1,0,1]
    v_pk_mul_f32 v[92:93], v[92:93], v[96:97]
    v_pk_mul_f32 v[94:95], v[94:95], v[98:99]
    v_cvt_pk_bf16_f32 v86, v92, v93
    v_cvt_pk_bf16_f32 v87, v94, v95
    s_nop 0
    v_permlane16_swap_b32 v84, v86
    v_permlane16_swap_b32 v85, v87
    buffer_store_dwordx4 v[84:87], v173, s[36:39], s50 offen sc1
    v_pk_fma_f32 v[238:239], v[184:185], v[202:203], v[196:197] op_sel_hi:[1,0,1]
    v_pk_fma_f32 v[240:241], v[186:187], v[202:203], v[198:199] op_sel_hi:[1,0,1]
    v_pk_fma_f32 v[64:65], v[64:65], v[200:201], v[238:239] op_sel_hi:[1,0,1]
    v_pk_fma_f32 v[66:67], v[66:67], v[200:201], v[240:241] op_sel_hi:[1,0,1]
    v_pk_fma_f32 v[242:243], v[184:185], v[206:207], v[196:197] op_sel_hi:[1,0,1]
    v_pk_fma_f32 v[244:245], v[186:187], v[206:207], v[198:199] op_sel_hi:[1,0,1]
    v_pk_fma_f32 v[76:77], v[76:77], v[204:205], v[242:243] op_sel_hi:[1,0,1]
    v_pk_fma_f32 v[78:79], v[78:79], v[204:205], v[244:245] op_sel_hi:[1,0,1]
    s_nop 0
    v_permlane32_swap_b32 v64, v76
    v_permlane32_swap_b32 v65, v77
    v_permlane32_swap_b32 v66, v78
    v_permlane32_swap_b32 v67, v79
    v_pk_mul_f32 v[64:65], v[64:65], v[76:77]
    v_pk_mul_f32 v[66:67], v[66:67], v[78:79]
    v_cvt_pk_bf16_f32 v56, v64, v65
    v_cvt_pk_bf16_f32 v57, v66, v67
    v_pk_fma_f32 v[238:239], v[184:185], v[210:211], v[196:197] op_sel_hi:[1,0,1]
    v_pk_fma_f32 v[240:241], v[186:187], v[210:211], v[198:199] op_sel_hi:[1,0,1]
    v_pk_fma_f32 v[88:89], v[88:89], v[208:209], v[238:239] op_sel_hi:[1,0,1]
    v_pk_fma_f32 v[90:91], v[90:91], v[208:209], v[240:241] op_sel_hi:[1,0,1]
    v_pk_fma_f32 v[242:243], v[184:185], v[214:215], v[196:197] op_sel_hi:[1,0,1]
    v_pk_fma_f32 v[244:245], v[186:187], v[214:215], v[198:199] op_sel_hi:[1,0,1]
    v_pk_fma_f32 v[100:101], v[100:101], v[212:213], v[242:243] op_sel_hi:[1,0,1]
    v_pk_fma_f32 v[102:103], v[102:103], v[212:213], v[244:245] op_sel_hi:[1,0,1]
    s_nop 0
    v_permlane32_swap_b32 v88, v100
    v_permlane32_swap_b32 v89, v101
    v_permlane32_swap_b32 v90, v102
    v_permlane32_swap_b32 v91, v103
    v_pk_mul_f32 v[88:89], v[88:89], v[100:101]
    v_pk_mul_f32 v[90:91], v[90:91], v[102:103]
    v_cvt_pk_bf16_f32 v58, v88, v89
    v_cvt_pk_bf16_f32 v59, v90, v91
    s_nop 0
    v_permlane16_swap_b32 v56, v58
    v_permlane16_swap_b32 v57, v59
    buffer_store_dwordx4 v[56:59], v174, s[36:39], s8 offen offset:512 sc1
    s_add_u32 s6, s6, 16384
    s_lshl_b32 s76, s72, 4
    s_add_u32 s76, s76, s73
    v_mfma_f32_16x16x32_bf16 v[36:39], a[28:31], v[112:115], v[36:39]
    buffer_load_dwordx4 a[16:19], v248, s[36:39], s62 offen offset:0 sc1
    v_mfma_f32_16x16x32_bf16 v[40:43], a[32:35], v[112:115], v[40:43]
    s_waitcnt lgkmcnt(6)
    ds_read_b64_tr_b16 v[132:133], v171 offset:12288
    v_mfma_f32_16x16x32_bf16 v[44:47], a[24:27], v[116:119], v[44:47]
    s_waitcnt lgkmcnt(3)
    ds_read_b64_tr_b16 v[134:135], v171 offset:14336
    v_mfma_f32_16x16x32_bf16 v[48:51], a[28:31], v[116:119], v[48:51]
    v_mfma_f32_16x16x32_bf16 v[52:55], a[32:35], v[116:119], v[52:55]
    buffer_load_dwordx4 a[20:23], v248, s[36:39], s62 offen offset:1024 sc1
    v_mfma_f32_16x16x32_bf16 v[8:11], a[36:39], v[120:123], v[8:11]
    ds_read_b64_tr_b16 v[104:105], v168 offset:16384
    v_mfma_f32_16x16x32_bf16 v[12:15], a[40:43], v[120:123], v[12:15]
    ds_read_b64_tr_b16 v[106:107], v168 offset:18432
    v_mfma_f32_16x16x32_bf16 v[16:19], a[44:47], v[120:123], v[16:19]
    ds_read_b64_tr_b16 v[108:109], v169 offset:16384
    v_mfma_f32_16x16x32_bf16 v[20:23], a[36:39], v[124:127], v[20:23]
    buffer_load_dwordx4 a[24:27], v248, s[36:39], s62 offen offset:2048 sc1
    v_mfma_f32_16x16x32_bf16 v[24:27], a[40:43], v[124:127], v[24:27]
    ds_read_b64_tr_b16 v[110:111], v169 offset:18432
    v_mfma_f32_16x16x32_bf16 v[28:31], a[44:47], v[124:127], v[28:31]
    s_waitcnt lgkmcnt(6)
    ds_read_b64_tr_b16 v[112:113], v170 offset:16384
    v_mfma_f32_16x16x32_bf16 v[32:35], a[36:39], v[128:131], v[32:35]
    ds_read_b64_tr_b16 v[114:115], v170 offset:18432
    v_mfma_f32_16x16x32_bf16 v[36:39], a[40:43], v[128:131], v[36:39]
    buffer_load_dwordx4 a[28:31], v248, s[36:39], s62 offen offset:3072 sc1
    v_mfma_f32_16x16x32_bf16 v[40:43], a[44:47], v[128:131], v[40:43]
    s_waitcnt lgkmcnt(6)
    ds_read_b64_tr_b16 v[116:117], v171 offset:16384
    v_mfma_f32_16x16x32_bf16 v[44:47], a[36:39], v[132:135], v[44:47]
    s_waitcnt lgkmcnt(3)
    ds_read_b64_tr_b16 v[118:119], v171 offset:18432
    v_mfma_f32_16x16x32_bf16 v[48:51], a[40:43], v[132:135], v[48:51]
    s_add_u32 s62, s62, 4096
    v_mfma_f32_16x16x32_bf16 v[52:55], a[44:47], v[132:135], v[52:55]
    buffer_load_dwordx4 a[32:35], v248, s[36:39], s62 offen offset:0 sc1
    v_mfma_f32_16x16x32_bf16 v[8:11], a[48:51], v[104:107], v[8:11]
    s_waitcnt vmcnt(12)
    s_barrier
    ds_read_b64_tr_b16 v[120:121], v168 offset:20480
    v_mfma_f32_16x16x32_bf16 v[12:15], a[52:55], v[104:107], v[12:15]
    ds_read_b64_tr_b16 v[122:123], v168 offset:22528
    ds_read_b64 v[224:225], v216
    v_mfma_f32_16x16x32_bf16 v[16:19], a[56:59], v[104:107], v[16:19]
    ds_read_b64_tr_b16 v[124:125], v169 offset:20480
    ds_read_b64 v[226:227], v217
    v_mfma_f32_16x16x32_bf16 v[20:23], a[48:51], v[108:111], v[20:23]
    buffer_load_dwordx4 a[36:39], v248, s[36:39], s62 offen offset:1024 sc1
    v_mfma_f32_16x16x32_bf16 v[24:27], a[52:55], v[108:111], v[24:27]
    ds_read_b64_tr_b16 v[126:127], v169 offset:22528
    ds_read_b64 v[228:229], v218
    v_mfma_f32_16x16x32_bf16 v[28:31], a[56:59], v[108:111], v[28:31]
    s_waitcnt lgkmcnt(9)
    ds_read_b64_tr_b16 v[128:129], v170 offset:20480
    v_mfma_f32_16x16x32_bf16 v[32:35], a[48:51], v[112:115], v[32:35]
    ds_read_b64_tr_b16 v[130:131], v170 offset:22528
    v_mfma_f32_16x16x32_bf16 v[36:39], a[52:55], v[112:115], v[36:39]
    buffer_load_dwordx4 a[40:43], v248, s[36:39], s62 offen offset:2048 sc1
    v_mfma_f32_16x16x32_bf16 v[40:43], a[56:59], v[112:115], v[40:43]
    s_waitcnt lgkmcnt(9)
    ds_read_b64_tr_b16 v[132:133], v171 offset:20480
    v_mfma_f32_16x16x32_bf16 v[44:47], a[48:51], v[116:119], v[44:47]
    s_waitcnt lgkmcnt(3)
    ds_read_b64_tr_b16 v[134:135], v171 offset:22528
    v_mfma_f32_16x16x32_bf16 v[48:51], a[52:55], v[116:119], v[48:51]
    v_lshlrev_b32 v230, 16, v224
    v_and_b32 v231, 0xffff0000, v224
    v_pk_mul_f32 v[230:231], v[230:231], v[220:221] op_sel_hi:[1,0]
    v_pk_mul_f32 v[234:235], v[230:231], v[230:231]
    v_lshlrev_b32 v232, 16, v225
    v_and_b32 v233, 0xffff0000, v225
    v_pk_mul_f32 v[232:233], v[232:233], v[220:221] op_sel_hi:[1,0]
    v_pk_mul_f32 v[236:237], v[232:233], v[232:233]
    v_lshlrev_b32 v2, 16, v226
    v_and_b32 v3, 0xffff0000, v226
    v_pk_mul_f32 v[2:3], v[2:3], v[220:221] op_sel:[0,1] op_sel_hi:[1,1]
    v_pk_add_f32 v[230:231], v[230:231], v[2:3]
    v_pk_fma_f32 v[234:235], v[2:3], v[2:3], v[234:235]
    v_lshlrev_b32 v2, 16, v227
    v_and_b32 v3, 0xffff0000, v227
    v_pk_mul_f32 v[2:3], v[2:3], v[220:221] op_sel:[0,1] op_sel_hi:[1,1]
    v_pk_add_f32 v[232:233], v[232:233], v[2:3]
    v_pk_fma_f32 v[236:237], v[2:3], v[2:3], v[236:237]
    v_lshlrev_b32 v2, 16, v228
    v_and_b32 v3, 0xffff0000, v228
    v_pk_mul_f32 v[2:3], v[2:3], v[222:223] op_sel_hi:[1,0]
    v_pk_add_f32 v[230:231], v[230:231], v[2:3]
    v_pk_fma_f32 v[234:235], v[2:3], v[2:3], v[234:235]
    v_lshlrev_b32 v2, 16, v229
    v_and_b32 v3, 0xffff0000, v229
    v_pk_mul_f32 v[2:3], v[2:3], v[222:223] op_sel_hi:[1,0]
    v_pk_add_f32 v[232:233], v[232:233], v[2:3]
    v_pk_fma_f32 v[236:237], v[2:3], v[2:3], v[236:237]
    v_mfma_f32_16x16x32_bf16 v[52:55], a[56:59], v[116:119], v[52:55]
    buffer_load_dwordx4 a[44:47], v248, s[36:39], s62 offen offset:3072 sc1
    v_mfma_f32_16x16x32_bf16 v[8:11], a[60:63], v[120:123], v[8:11]
    ds_read_b64_tr_b16 v[104:105], v168 offset:24576
    v_permlane32_swap_b32 v230, v234
    v_mfma_f32_16x16x32_bf16 v[12:15], a[64:67], v[120:123], v[12:15]
    ds_read_b64_tr_b16 v[106:107], v168 offset:26624
    v_permlane32_swap_b32 v231, v235
    v_mfma_f32_16x16x32_bf16 v[16:19], a[68:71], v[120:123], v[16:19]
    s_add_u32 s62, s62, 4096
    ds_read_b64_tr_b16 v[108:109], v169 offset:24576
    v_permlane32_swap_b32 v232, v236
    v_mfma_f32_16x16x32_bf16 v[20:23], a[60:63], v[124:127], v[20:23]
    buffer_load_dwordx4 a[48:51], v248, s[36:39], s62 offen offset:0 sc1
    v_mfma_f32_16x16x32_bf16 v[24:27], a[64:67], v[124:127], v[24:27]
    ds_read_b64_tr_b16 v[110:111], v169 offset:26624
    v_permlane32_swap_b32 v233, v237
    v_mfma_f32_16x16x32_bf16 v[28:31], a[68:71], v[124:127], v[28:31]
    s_waitcnt lgkmcnt(6)
    ds_read_b64_tr_b16 v[112:113], v170 offset:24576
    v_add_f32 v230, v230, v234
    v_mfma_f32_16x16x32_bf16 v[32:35], a[60:63], v[128:131], v[32:35]
    ds_read_b64_tr_b16 v[114:115], v170 offset:26624
    v_add_f32 v231, v231, v235
    v_add_f32 v232, v232, v236
    v_mfma_f32_16x16x32_bf16 v[36:39], a[64:67], v[128:131], v[36:39]
    buffer_load_dwordx4 a[52:55], v248, s[36:39], s62 offen offset:1024 sc1
    v_mfma_f32_16x16x32_bf16 v[40:43], a[68:71], v[128:131], v[40:43]
    s_waitcnt lgkmcnt(6)
    ds_read_b64_tr_b16 v[116:117], v171 offset:24576
    v_add_f32 v233, v233, v237
    v_mfma_f32_16x16x32_bf16 v[44:47], a[60:63], v[132:135], v[44:47]
    s_waitcnt lgkmcnt(3)
    ds_read_b64_tr_b16 v[118:119], v171 offset:26624
    v_permlane16_swap_b32 v230, v232
    v_permlane16_swap_b32 v231, v233
    v_mfma_f32_16x16x32_bf16 v[48:51], a[64:67], v[132:135], v[48:51]
    s_waitcnt vmcnt(10)
    s_barrier
    s_cmp_eq_u32 s3, 0
    s_cbranch_scc0 L_wf27
    s_lshl_b32 s54, s76, 7
    s_add_u32 s54, s54, 23288832
    v_mov_b32 v254, 0
    v_mov_b32 v255, s48
    s_mov_b64 exec, 1
    buffer_store_dword v255, v254, s[36:39], s54 offen sc1
    s_mov_b64 exec, -1
L_wf27:
    v_mfma_f32_16x16x32_bf16 v[52:55], a[68:71], v[132:135], v[52:55]
    buffer_load_dwordx4 a[56:59], v248, s[36:39], s62 offen offset:2048 sc1
    v_mfma_f32_16x16x32_bf16 v[8:11], a[72:75], v[104:107], v[8:11]
    ds_read_b64_tr_b16 v[120:121], v168 offset:28672
    v_add_f32 v230, v230, v232
    v_mfma_f32_16x16x32_bf16 v[12:15], a[76:79], v[104:107], v[12:15]
    ds_read_b64_tr_b16 v[122:123], v168 offset:30720
    v_add_f32 v231, v231, v233
    v_mfma_f32_16x16x32_bf16 v[16:19], a[80:83], v[104:107], v[16:19]
    ds_read_b64_tr_b16 v[124:125], v169 offset:28672
    v_lshrrev_b32 v2, 4, v1
    v_mfma_f32_16x16x32_bf16 v[20:23], a[72:75], v[108:111], v[20:23]
    buffer_load_dwordx4 a[60:63], v248, s[36:39], s62 offen offset:3072 sc1
    v_mfma_f32_16x16x32_bf16 v[24:27], a[76:79], v[108:111], v[24:27]
    ds_read_b64_tr_b16 v[126:127], v169 offset:30720
    v_lshlrev_b32 v2, 3, v2
    v_mfma_f32_16x16x32_bf16 v[28:31], a[80:83], v[108:111], v[28:31]
    s_waitcnt lgkmcnt(6)
    s_lshl_b32 s50, s3, 5
    s_add_u32 s50, s50, 0
    ds_read_b64_tr_b16 v[128:129], v170 offset:28672
    v_mfma_f32_16x16x32_bf16 v[32:35], a[72:75], v[112:115], v[32:35]
    s_add_u32 s62, s62, 4096
    ds_read_b64_tr_b16 v[130:131], v170 offset:30720
    v_add_u32 v2, s50, v2
    v_mfma_f32_16x16x32_bf16 v[36:39], a[76:79], v[112:115], v[36:39]
    buffer_load_dwordx4 a[64:67], v248, s[36:39], s62 offen offset:0 sc1
    v_mfma_f32_16x16x32_bf16 v[40:43], a[80:83], v[112:115], v[40:43]
    s_waitcnt lgkmcnt(6)
    ds_read_b64_tr_b16 v[132:133], v171 offset:28672
    v_add_f32_dpp v230, v230, v230 row_ror:8 row_mask:0xf bank_mask:0xf
    v_mfma_f32_16x16x32_bf16 v[44:47], a[72:75], v[116:119], v[44:47]
    s_waitcnt lgkmcnt(3)
    ds_read_b64_tr_b16 v[134:135], v171 offset:30720
    v_add_f32_dpp v231, v231, v231 row_ror:8 row_mask:0xf bank_mask:0xf
    v_mfma_f32_16x16x32_bf16 v[48:51], a[76:79], v[116:119], v[48:51]
    v_add_f32_dpp v230, v230, v230 row_ror:4 row_mask:0xf bank_mask:0xf
    v_add_f32_dpp v231, v231, v231 row_ror:4 row_mask:0xf bank_mask:0xf
    v_mfma_f32_16x16x32_bf16 v[52:55], a[80:83], v[116:119], v[52:55]
    buffer_load_dwordx4 a[68:71], v248, s[36:39], s62 offen offset:1024 sc1
    v_mfma_f32_16x16x32_bf16 v[8:11], a[84:87], v[120:123], v[8:11]
    ds_read_b64_tr_b16 v[104:105], v168 offset:32768
    v_add_f32_dpp v230, v230, v230 row_ror:2 row_mask:0xf bank_mask:0xf
    v_mfma_f32_16x16x32_bf16 v[12:15], a[88:91], v[120:123], v[12:15]
    ds_read_b64_tr_b16 v[106:107], v168 offset:34816
    v_add_f32_dpp v231, v231, v231 row_ror:2 row_mask:0xf bank_mask:0xf
    v_mfma_f32_16x16x32_bf16 v[16:19], a[92:95], v[120:123], v[16:19]
    ds_read_b64_tr_b16 v[108:109], v169 offset:32768
    v_add_f32_dpp v230, v230, v230 row_ror:1 row_mask:0xf bank_mask:0xf
    v_mfma_f32_16x16x32_bf16 v[20:23], a[84:87], v[124:127], v[20:23]
    buffer_load_dwordx4 a[72:75], v248, s[36:39], s62 offen offset:2048 sc1
    v_mfma_f32_16x16x32_bf16 v[24:27], a[88:91], v[124:127], v[24:27]
    ds_read_b64_tr_b16 v[110:111], v169 offset:34816
    v_add_f32_dpp v231, v231, v231 row_ror:1 row_mask:0xf bank_mask:0xf
    v_mfma_f32_16x16x32_bf16 v[28:31], a[92:95], v[124:127], v[28:31]
    ds_read_b64_tr_b16 v[112:113], v170 offset:32768
    s_mov_b32 exec_lo, 0x00010001
    s_mov_b32 exec_hi, 0x00010001
    ds_write_b64 v2, v[230:231]
    s_mov_b64 exec, -1
    s_waitcnt lgkmcnt(8)
    v_mfma_f32_16x16x32_bf16 v[32:35], a[84:87], v[128:131], v[32:35]
    ds_read_b64_tr_b16 v[114:115], v170 offset:34816
    v_lshlrev_b32 v2, 2, v1
    v_mfma_f32_16x16x32_bf16 v[36:39], a[88:91], v[128:131], v[36:39]
    buffer_load_dwordx4 a[76:79], v248, s[36:39], s62 offen offset:3072 sc1
    v_mfma_f32_16x16x32_bf16 v[40:43], a[92:95], v[128:131], v[40:43]
    s_waitcnt lgkmcnt(7)
    ds_read_b64_tr_b16 v[116:117], v171 offset:32768
    v_and_b32 v2, 12, v2
    v_mfma_f32_16x16x32_bf16 v[44:47], a[84:87], v[132:135], v[44:47]
    s_waitcnt lgkmcnt(3)
    ds_read_b64_tr_b16 v[118:119], v171 offset:34816
    v_add_u32 v2, 0, v2
    v_mfma_f32_16x16x32_bf16 v[48:51], a[88:91], v[132:135], v[48:51]
    s_add_u32 s62, s62, 4096
    s_waitcnt lgkmcnt(0)
    s_barrier
    v_mfma_f32_16x16x32_bf16 v[52:55], a[92:95], v[132:135], v[52:55]
    buffer_load_dwordx4 a[80:83], v248, s[36:39], s62 offen offset:0 sc1
    v_mfma_f32_16x16x32_bf16 v[8:11], a[96:99], v[104:107], v[8:11]
    ds_read_b64_tr_b16 v[120:121], v168 offset:36864
    ds_read2_b32 v[230:231], v2 offset0:0 offset1:4
    v_mfma_f32_16x16x32_bf16 v[12:15], a[100:103], v[104:107], v[12:15]
    ds_read_b64_tr_b16 v[122:123], v168 offset:38912
    ds_read2_b32 v[232:233], v2 offset0:8 offset1:12
    v_mfma_f32_16x16x32_bf16 v[16:19], a[104:107], v[104:107], v[16:19]
    ds_read_b64_tr_b16 v[124:125], v169 offset:36864
    ds_read2_b32 v[234:235], v2 offset0:16 offset1:20
    ds_read2_b32 v[236:237], v2 offset0:24 offset1:28
    v_mfma_f32_16x16x32_bf16 v[20:23], a[96:99], v[108:111], v[20:23]
    buffer_load_dwordx4 a[84:87], v248, s[36:39], s62 offen offset:1024 sc1
    v_mfma_f32_16x16x32_bf16 v[24:27], a[100:103], v[108:111], v[24:27]
    ds_read_b64_tr_b16 v[126:127], v169 offset:38912
    v_mov_b32 v225, s48
    v_mfma_f32_16x16x32_bf16 v[28:31], a[104:107], v[108:111], v[28:31]
    ds_read_b64_tr_b16 v[128:129], v170 offset:36864
    v_mov_b32 v227, s48
    v_mfma_f32_16x16x32_bf16 v[32:35], a[96:99], v[112:115], v[32:35]
    s_add_u32 s7, s7, 16384
    ds_read_b64_tr_b16 v[130:131], v170 offset:38912
    s_waitcnt lgkmcnt(6)
    v_add_f32 v230, v230, v232
    v_mfma_f32_16x16x32_bf16 v[36:39], a[100:103], v[112:115], v[36:39]
    buffer_load_dwordx4 a[88:91], v248, s[36:39], s62 offen offset:2048 sc1
    v_mfma_f32_16x16x32_bf16 v[40:43], a[104:107], v[112:115], v[40:43]
    ds_read_b64_tr_b16 v[132:133], v171 offset:36864
    v_add_f32 v231, v231, v233
    v_mfma_f32_16x16x32_bf16 v[44:47], a[96:99], v[116:119], v[44:47]
    s_waitcnt lgkmcnt(3)
    ds_read_b64_tr_b16 v[134:135], v171 offset:38912
    v_add_f32 v234, v234, v236
    v_mfma_f32_16x16x32_bf16 v[48:51], a[100:103], v[116:119], v[48:51]
    v_mfma_f32_16x16x32_bf16 v[52:55], a[104:107], v[116:119], v[52:55]
    buffer_load_dwordx4 a[92:95], v248, s[36:39], s62 offen offset:3072 sc1
    v_mfma_f32_16x16x32_bf16 v[8:11], a[108:111], v[120:123], v[8:11]
    ds_read_b64_tr_b16 v[104:105], v168 offset:40960
    v_add_f32 v235, v235, v237
    v_mfma_f32_16x16x32_bf16 v[12:15], a[112:115], v[120:123], v[12:15]
    ds_read_b64_tr_b16 v[106:107], v168 offset:43008
    v_add_f32 v230, v230, v234
    v_mfma_f32_16x16x32_bf16 v[16:19], a[116:119], v[120:123], v[16:19]
    s_add_u32 s62, s62, 4096
    ds_read_b64_tr_b16 v[108:109], v169 offset:40960
    v_add_f32 v231, v231, v235
    v_mfma_f32_16x16x32_bf16 v[20:23], a[108:111], v[124:127], v[20:23]
    buffer_load_dwordx4 a[96:99], v248, s[36:39], s62 offen offset:0 sc1
    v_mfma_f32_16x16x32_bf16 v[24:27], a[112:115], v[124:127], v[24:27]
    ds_read_b64_tr_b16 v[110:111], v169 offset:43008
    v_mul_f32 v230, 0x3acccccd, v230
    v_mfma_f32_16x16x32_bf16 v[28:31], a[116:119], v[124:127], v[28:31]
    s_waitcnt lgkmcnt(6)
    ds_read_b64_tr_b16 v[112:113], v170 offset:40960
    v_mul_f32 v234, v230, v230
    v_mfma_f32_16x16x32_bf16 v[32:35], a[108:111], v[128:131], v[32:35]
    ds_read_b64_tr_b16 v[114:115], v170 offset:43008
    v_mov_b32 v224, 0x3acccccd
    v_fma_f32 v231, v231, v224, -v234
    v_mfma_f32_16x16x32_bf16 v[36:39], a[112:115], v[128:131], v[36:39]
    buffer_load_dwordx4 a[100:103], v248, s[36:39], s62 offen offset:1024 sc1
    v_mfma_f32_16x16x32_bf16 v[40:43], a[116:119], v[128:131], v[40:43]
    s_waitcnt lgkmcnt(6)
    ds_read_b64_tr_b16 v[116:117], v171 offset:40960
    v_max_f32 v231, 0, v231
    v_mfma_f32_16x16x32_bf16 v[44:47], a[108:111], v[132:135], v[44:47]
    s_waitcnt lgkmcnt(3)
    ds_read_b64_tr_b16 v[118:119], v171 offset:43008
    v_add_f32 v231, 0x3727c5ac, v231
    v_mfma_f32_16x16x32_bf16 v[48:51], a[112:115], v[132:135], v[48:51]
    v_rsq_f32 v224, v231
    v_mfma_f32_16x16x32_bf16 v[52:55], a[116:119], v[132:135], v[52:55]
    buffer_load_dwordx4 a[104:107], v248, s[36:39], s62 offen offset:2048 sc1
    v_mfma_f32_16x16x32_bf16 v[8:11], a[120:123], v[104:107], v[8:11]
    ds_read_b64_tr_b16 v[120:121], v168 offset:45056
    v_mul_f32_e64 v226, -v230, v224
    v_mfma_f32_16x16x32_bf16 v[12:15], a[124:127], v[104:107], v[12:15]
    ds_read_b64_tr_b16 v[122:123], v168 offset:47104
    s_mov_b64 exec, 0xf
    buffer_store_dwordx4 v[224:227], v248, s[36:39], s7 offen sc1
    s_mov_b64 exec, -1
    v_mfma_f32_16x16x32_bf16 v[16:19], a[128:131], v[104:107], v[16:19]
    s_and_b32 s50, s3, 1
    s_lshl_b32 s51, s74, 1
    ds_read_b64_tr_b16 v[124:125], v169 offset:45056
    v_mfma_f32_16x16x32_bf16 v[20:23], a[120:123], v[108:111], v[20:23]
    buffer_load_dwordx4 a[108:111], v248, s[36:39], s62 offen offset:3072 sc1
    v_mfma_f32_16x16x32_bf16 v[24:27], a[124:127], v[108:111], v[24:27]
    s_add_u32 s52, s51, s50
    s_mul_i32 s52, s52, 192
    ds_read_b64_tr_b16 v[126:127], v169 offset:47104
    v_mfma_f32_16x16x32_bf16 v[28:31], a[128:131], v[108:111], v[28:31]
    s_waitcnt lgkmcnt(6)
    s_mul_i32 s53, s3, 48
    s_add_u32 s52, s52, s53
    ds_read_b64_tr_b16 v[128:129], v170 offset:45056
    v_mfma_f32_16x16x32_bf16 v[32:35], a[120:123], v[112:115], v[32:35]
    s_add_u32 s62, s62, 4096
    ds_read_b64_tr_b16 v[130:131], v170 offset:47104
    v_mfma_f32_16x16x32_bf16 v[36:39], a[124:127], v[112:115], v[36:39]
    buffer_load_dwordx4 a[112:115], v248, s[36:39], s62 offen offset:0 sc1
    v_mfma_f32_16x16x32_bf16 v[40:43], a[128:131], v[112:115], v[40:43]
    s_waitcnt lgkmcnt(6)
    s_lshl_b32 s52, s52, 8
    s_add_u32 s52, s52, 16777216
    ds_read_b64_tr_b16 v[132:133], v171 offset:45056
    v_mfma_f32_16x16x32_bf16 v[44:47], a[120:123], v[116:119], v[44:47]
    s_waitcnt lgkmcnt(3)
    ds_read_b64_tr_b16 v[134:135], v171 offset:47104
    v_add_u32 v216, s52, v248
    v_mfma_f32_16x16x32_bf16 v[48:51], a[124:127], v[116:119], v[48:51]
    v_add_u32 v218, 3145728, v216
    v_mfma_f32_16x16x32_bf16 v[52:55], a[128:131], v[116:119], v[52:55]
    buffer_load_dwordx4 a[116:119], v248, s[36:39], s62 offen offset:1024 sc1
    v_mfma_f32_16x16x32_bf16 v[8:11], a[132:135], v[120:123], v[8:11]
    s_xor_b32 s50, s50, 1
    s_add_u32 s52, s51, s50
    ds_read_b64_tr_b16 v[104:105], v168 offset:49152
    v_mfma_f32_16x16x32_bf16 v[12:15], a[136:139], v[120:123], v[12:15]
    s_mul_i32 s52, s52, 192
    s_add_u32 s52, s52, s53
    ds_read_b64_tr_b16 v[106:107], v168 offset:51200
    v_mfma_f32_16x16x32_bf16 v[16:19], a[140:143], v[120:123], v[16:19]
    s_lshl_b32 s52, s52, 8
    s_add_u32 s52, s52, 16777216
    ds_read_b64_tr_b16 v[108:109], v169 offset:49152
    v_mfma_f32_16x16x32_bf16 v[20:23], a[132:135], v[124:127], v[20:23]
    buffer_load_dwordx4 a[120:123], v248, s[36:39], s62 offen offset:2048 sc1
    v_mfma_f32_16x16x32_bf16 v[24:27], a[136:139], v[124:127], v[24:27]
    ds_read_b64_tr_b16 v[110:111], v169 offset:51200
    v_add_u32 v217, s52, v248
    v_mfma_f32_16x16x32_bf16 v[28:31], a[140:143], v[124:127], v[28:31]
    s_waitcnt lgkmcnt(6)
    ds_read_b64_tr_b16 v[112:113], v170 offset:49152
    v_add_u32 v219, 3145728, v217
    v_mfma_f32_16x16x32_bf16 v[32:35], a[132:135], v[128:131], v[32:35]
    s_lshr_b32 s50, s74, 1
    s_lshl_b32 s50, s50, 2
    ds_read_b64_tr_b16 v[114:115], v170 offset:51200
    v_mfma_f32_16x16x32_bf16 v[36:39], a[136:139], v[128:131], v[36:39]
    buffer_load_dwordx4 a[124:127], v248, s[36:39], s62 offen offset:3072 sc1
    v_mfma_f32_16x16x32_bf16 v[40:43], a[140:143], v[128:131], v[40:43]
    s_waitcnt lgkmcnt(6)
    s_add_u32 s50, s50, s3
    s_lshl_b32 s50, s50, 9
    ds_read_b64_tr_b16 v[116:117], v171 offset:49152
    v_mfma_f32_16x16x32_bf16 v[44:47], a[132:135], v[132:135], v[44:47]
    s_waitcnt lgkmcnt(3)
    s_add_u32 s50, s50, 89088
    ds_read_b64_tr_b16 v[118:119], v171 offset:51200
    v_mfma_f32_16x16x32_bf16 v[48:51], a[136:139], v[132:135], v[48:51]
    s_add_u32 s62, s62, 4096
    v_mfma_f32_16x16x32_bf16 v[52:55], a[140:143], v[132:135], v[52:55]
    buffer_load_dwordx4 a[128:131], v248, s[36:39], s62 offen offset:0 sc1
    v_mfma_f32_16x16x32_bf16 v[8:11], a[144:147], v[104:107], v[8:11]
    ds_read_b64_tr_b16 v[120:121], v168 offset:53248
    v_min_u32 v246, 13, v1
    v_mfma_f32_16x16x32_bf16 v[12:15], a[148:151], v[104:107], v[12:15]
    ds_read_b64_tr_b16 v[122:123], v168 offset:55296
    v_lshlrev_b32 v246, 7, v246
    v_mfma_f32_16x16x32_bf16 v[16:19], a[152:155], v[104:107], v[16:19]
    ds_read_b64_tr_b16 v[124:125], v169 offset:53248
    v_mov_b32 v2, s50
    v_mfma_f32_16x16x32_bf16 v[20:23], a[144:147], v[108:111], v[20:23]
    buffer_load_dwordx4 a[132:135], v248, s[36:39], s62 offen offset:1024 sc1
    v_mfma_f32_16x16x32_bf16 v[24:27], a[148:151], v[108:111], v[24:27]
    ds_read_b64_tr_b16 v[126:127], v169 offset:55296
    v_mov_b32 v3, 31488
    v_mfma_f32_16x16x32_bf16 v[28:31], a[152:155], v[108:111], v[28:31]
    ds_read_b64_tr_b16 v[128:129], v170 offset:53248
    v_cmp_lt_u32 vcc, 3, v1
    s_nop 1
    v_cndmask_b32 v2, v2, v3, vcc
    s_waitcnt lgkmcnt(7)
    v_mfma_f32_16x16x32_bf16 v[32:35], a[144:147], v[112:115], v[32:35]
    ds_read_b64_tr_b16 v[130:131], v170 offset:55296
    v_add_u32 v246, v246, v2
    v_mfma_f32_16x16x32_bf16 v[36:39], a[148:151], v[112:115], v[36:39]
    buffer_load_dwordx4 a[136:139], v248, s[36:39], s62 offen offset:2048 sc1
    v_mfma_f32_16x16x32_bf16 v[40:43], a[152:155], v[112:115], v[40:43]
    s_waitcnt lgkmcnt(6)
    ds_read_b64_tr_b16 v[132:133], v171 offset:53248
    v_mfma_f32_16x16x32_bf16 v[44:47], a[144:147], v[116:119], v[44:47]
    s_waitcnt lgkmcnt(3)
    ds_read_b64_tr_b16 v[134:135], v171 offset:55296
    v_mfma_f32_16x16x32_bf16 v[48:51], a[148:151], v[116:119], v[48:51]
    buffer_load_dword v247, v246, s[36:39], s17 offen sc1
    v_mfma_f32_16x16x32_bf16 v[52:55], a[152:155], v[116:119], v[52:55]
    buffer_load_dwordx4 a[140:143], v248, s[36:39], s62 offen offset:3072 sc1
    v_mfma_f32_16x16x32_bf16 v[8:11], a[156:159], v[120:123], v[8:11]
    ds_read_b64_tr_b16 v[104:105], v168 offset:57344
    v_mfma_f32_16x16x32_bf16 v[12:15], a[160:163], v[120:123], v[12:15]
    ds_read_b64_tr_b16 v[106:107], v168 offset:59392
    v_mfma_f32_16x16x32_bf16 v[16:19], a[164:167], v[120:123], v[16:19]
    s_add_u32 s62, s62, 4096
    ds_read_b64_tr_b16 v[108:109], v169 offset:57344
    v_mfma_f32_16x16x32_bf16 v[20:23], a[156:159], v[124:127], v[20:23]
    buffer_load_dwordx4 a[144:147], v248, s[36:39], s62 offen offset:0 sc1
    v_mfma_f32_16x16x32_bf16 v[24:27], a[160:163], v[124:127], v[24:27]
    ds_read_b64_tr_b16 v[110:111], v169 offset:59392
    v_mfma_f32_16x16x32_bf16 v[28:31], a[164:167], v[124:127], v[28:31]
    s_waitcnt lgkmcnt(6)
    ds_read_b64_tr_b16 v[112:113], v170 offset:57344
    v_mfma_f32_16x16x32_bf16 v[32:35], a[156:159], v[128:131], v[32:35]
    ds_read_b64_tr_b16 v[114:115], v170 offset:59392
    v_mfma_f32_16x16x32_bf16 v[36:39], a[160:163], v[128:131], v[36:39]
    buffer_load_dwordx4 a[148:151], v248, s[36:39], s62 offen offset:1024 sc1
    v_mfma_f32_16x16x32_bf16 v[40:43], a[164:167], v[128:131], v[40:43]
    s_waitcnt lgkmcnt(6)
    ds_read_b64_tr_b16 v[116:117], v171 offset:57344
    v_mfma_f32_16x16x32_bf16 v[44:47], a[156:159], v[132:135], v[44:47]
    s_waitcnt lgkmcnt(3)
    ds_read_b64_tr_b16 v[118:119], v171 offset:59392
    v_mfma_f32_16x16x32_bf16 v[48:51], a[160:163], v[132:135], v[48:51]
    v_mfma_f32_16x16x32_bf16 v[52:55], a[164:167], v[132:135], v[52:55]
    buffer_load_dwordx4 a[152:155], v248, s[36:39], s62 offen offset:2048 sc1
    v_mfma_f32_16x16x32_bf16 v[8:11], a[168:171], v[104:107], v[8:11]
    ds_read_b64_tr_b16 v[120:121], v168 offset:61440
    v_mfma_f32_16x16x32_bf16 v[12:15], a[172:175], v[104:107], v[12:15]
    ds_read_b64_tr_b16 v[122:123], v168 offset:63488
    v_add_u32 v168, 65536, v168
    v_mfma_f32_16x16x32_bf16 v[16:19], a[176:179], v[104:107], v[16:19]
    ds_read_b64_tr_b16 v[124:125], v169 offset:61440
    v_mfma_f32_16x16x32_bf16 v[20:23], a[168:171], v[108:111], v[20:23]
    buffer_load_dwordx4 a[156:159], v248, s[36:39], s62 offen offset:3072 sc1
    v_mfma_f32_16x16x32_bf16 v[24:27], a[172:175], v[108:111], v[24:27]
    ds_read_b64_tr_b16 v[126:127], v169 offset:63488
    v_add_u32 v169, 65536, v169
    v_mfma_f32_16x16x32_bf16 v[28:31], a[176:179], v[108:111], v[28:31]
    s_waitcnt lgkmcnt(6)
    ds_read_b64_tr_b16 v[128:129], v170 offset:61440
    v_mfma_f32_16x16x32_bf16 v[32:35], a[168:171], v[112:115], v[32:35]
    s_add_u32 m0, s63, 1024
    ds_read_b64_tr_b16 v[130:131], v170 offset:63488
    v_add_u32 v170, 65536, v170
    v_mfma_f32_16x16x32_bf16 v[36:39], a[172:175], v[112:115], v[36:39]
    buffer_load_dwordx4 v248, s[36:39], s6 offen sc1 lds
    v_mfma_f32_16x16x32_bf16 v[40:43], a[176:179], v[112:115], v[40:43]
    s_waitcnt lgkmcnt(6)
    ds_read_b64_tr_b16 v[132:133], v171 offset:61440
    v_mfma_f32_16x16x32_bf16 v[44:47], a[168:171], v[116:119], v[44:47]
    s_waitcnt lgkmcnt(3)
    ds_read_b64_tr_b16 v[134:135], v171 offset:63488
    v_add_u32 v171, 65536, v171
    v_mfma_f32_16x16x32_bf16 v[48:51], a[172:175], v[116:119], v[48:51]
    s_add_u32 s62, s62, 4096
    v_mfma_f32_16x16x32_bf16 v[52:55], a[176:179], v[116:119], v[52:55]
    buffer_load_dwordx4 a[160:163], v248, s[36:39], s62 offen offset:0 sc1
    v_mfma_f32_16x16x32_bf16 v[8:11], a[180:183], v[120:123], v[8:11]
    ds_read_b64_tr_b16 v[104:105], v168 offset:0
    v_mfma_f32_16x16x32_bf16 v[12:15], a[184:187], v[120:123], v[12:15]
    ds_read_b64_tr_b16 v[106:107], v168 offset:2048
    v_mfma_f32_16x16x32_bf16 v[16:19], a[188:191], v[120:123], v[16:19]
    ds_read_b64_tr_b16 v[108:109], v169 offset:0
    v_mfma_f32_16x16x32_bf16 v[20:23], a[180:183], v[124:127], v[20:23]
    buffer_load_dwordx4 a[164:167], v248, s[36:39], s62 offen offset:1024 sc1
    v_mfma_f32_16x16x32_bf16 v[24:27], a[184:187], v[124:127], v[24:27]
    ds_read_b64_tr_b16 v[110:111], v169 offset:2048
    v_mfma_f32_16x16x32_bf16 v[28:31], a[188:191], v[124:127], v[28:31]
    s_waitcnt lgkmcnt(6)
    ds_read_b64_tr_b16 v[112:113], v170 offset:0
    v_mfma_f32_16x16x32_bf16 v[32:35], a[180:183], v[128:131], v[32:35]
    ds_read_b64_tr_b16 v[114:115], v170 offset:2048
    v_mfma_f32_16x16x32_bf16 v[36:39], a[184:187], v[128:131], v[36:39]
    buffer_load_dwordx4 a[168:171], v248, s[36:39], s62 offen offset:2048 sc1
    v_mfma_f32_16x16x32_bf16 v[40:43], a[188:191], v[128:131], v[40:43]
    s_waitcnt lgkmcnt(6)
    ds_read_b64_tr_b16 v[116:117], v171 offset:0
    v_mfma_f32_16x16x32_bf16 v[44:47], a[180:183], v[132:135], v[44:47]
    s_waitcnt lgkmcnt(3)
    ds_read_b64_tr_b16 v[118:119], v171 offset:2048
    v_mfma_f32_16x16x32_bf16 v[48:51], a[184:187], v[132:135], v[48:51]
    s_waitcnt vmcnt(9)
    v_cmp_ne_u32 vcc, s48, v247
    s_cbranch_vccnz L_chk28_slow
L_chk28_back:
    v_mfma_f32_16x16x32_bf16 v[52:55], a[188:191], v[132:135], v[52:55]
    buffer_load_dwordx4 v[56:59], v216, s[36:39], 0 offen offset:0 sc1
    v_mfma_f32_16x16x32_bf16 v[8:11], a[192:195], v[104:107], v[8:11]
    ds_read_b64_tr_b16 v[120:121], v168 offset:4096
    v_mfma_f32_16x16x32_bf16 v[12:15], a[196:199], v[104:107], v[12:15]
    ds_read_b64_tr_b16 v[122:123], v168 offset:6144
    v_mfma_f32_16x16x32_bf16 v[16:19], a[200:203], v[104:107], v[16:19]
    ds_read_b64_tr_b16 v[124:125], v169 offset:4096
    v_mfma_f32_16x16x32_bf16 v[20:23], a[192:195], v[108:111], v[20:23]
    buffer_load_dwordx4 v[60:63], v217, s[36:39], 0 offen offset:0 sc1
    v_mfma_f32_16x16x32_bf16 v[24:27], a[196:199], v[108:111], v[24:27]
    ds_read_b64_tr_b16 v[126:127], v169 offset:6144
    v_mfma_f32_16x16x32_bf16 v[28:31], a[200:203], v[108:111], v[28:31]
    s_waitcnt lgkmcnt(6)
    ds_read_b64_tr_b16 v[128:129], v170 offset:4096
    v_mfma_f32_16x16x32_bf16 v[32:35], a[192:195], v[112:115], v[32:35]
    ds_read_b64_tr_b16 v[130:131], v170 offset:6144
    v_mfma_f32_16x16x32_bf16 v[36:39], a[196:199], v[112:115], v[36:39]
    buffer_load_dwordx4 v[64:67], v216, s[36:39], 0 offen offset:1024 sc1
    v_mfma_f32_16x16x32_bf16 v[40:43], a[200:203], v[112:115], v[40:43]
    s_waitcnt lgkmcnt(6)
    ds_read_b64_tr_b16 v[132:133], v171 offset:4096
    v_mfma_f32_16x16x32_bf16 v[44:47], a[192:195], v[116:119], v[44:47]
    s_waitcnt lgkmcnt(3)
    ds_read_b64_tr_b16 v[134:135], v171 offset:6144
    v_mfma_f32_16x16x32_bf16 v[48:51], a[196:199], v[116:119], v[48:51]
    v_mfma_f32_16x16x32_bf16 v[52:55], a[200:203], v[116:119], v[52:55]
    buffer_load_dwordx4 v[68:71], v217, s[36:39], 0 offen offset:1024 sc1
    v_mfma_f32_16x16x32_bf16 v[8:11], a[204:207], v[120:123], v[8:11]
    ds_read_b64_tr_b16 v[104:105], v168 offset:8192
    v_mfma_f32_16x16x32_bf16 v[12:15], a[208:211], v[120:123], v[12:15]
    ds_read_b64_tr_b16 v[106:107], v168 offset:10240
    v_mfma_f32_16x16x32_bf16 v[16:19], a[212:215], v[120:123], v[16:19]
    ds_read_b64_tr_b16 v[108:109], v169 offset:8192
    v_mfma_f32_16x16x32_bf16 v[20:23], a[204:207], v[124:127], v[20:23]
    buffer_load_dwordx4 v[72:75], v216, s[36:39], 0 offen offset:2048 sc1
    v_mfma_f32_16x16x32_bf16 v[24:27], a[208:211], v[124:127], v[24:27]
    ds_read_b64_tr_b16 v[110:111], v169 offset:10240
    v_mfma_f32_16x16x32_bf16 v[28:31], a[212:215], v[124:127], v[28:31]
    s_waitcnt lgkmcnt(6)
    ds_read_b64_tr_b16 v[112:113], v170 offset:8192
    v_mfma_f32_16x16x32_bf16 v[32:35], a[204:207], v[128:131], v[32:35]
    ds_read_b64_tr_b16 v[114:115], v170 offset:10240
    v_mfma_f32_16x16x32_bf16 v[36:39], a[208:211], v[128:131], v[36:39]
    buffer_load_dwordx4 a[172:175], v248, s[36:39], s62 offen offset:3072 sc1
    v_mfma_f32_16x16x32_bf16 v[40:43], a[212:215], v[128:131], v[40:43]
    s_waitcnt lgkmcnt(6)
    ds_read_b64_tr_b16 v[116:117], v171 offset:8192
    v_mfma_f32_16x16x32_bf16 v[44:47], a[204:207], v[132:135], v[44:47]
    s_waitcnt lgkmcnt(3)
    ds_read_b64_tr_b16 v[118:119], v171 offset:10240
    v_mfma_f32_16x16x32_bf16 v[48:51], a[208:211], v[132:135], v[48:51]
    v_mfma_f32_16x16x32_bf16 v[52:55], a[212:215], v[132:135], v[52:55]
    buffer_load_dwordx4 v[76:79], v217, s[36:39], 0 offen offset:2048 sc1
    v_mfma_f32_16x16x32_bf16 v[8:11], a[216:219], v[104:107], v[8:11]
    ds_read_b64_tr_b16 v[120:121], v168 offset:12288
    v_mfma_f32_16x16x32_bf16 v[12:15], a[220:223], v[104:107], v[12:15]
    ds_read_b64_tr_b16 v[122:123], v168 offset:14336
    v_mfma_f32_16x16x32_bf16 v[16:19], a[224:227], v[104:107], v[16:19]
    s_add_u32 s62, s62, 4096
    ds_read_b64_tr_b16 v[124:125], v169 offset:12288
    v_mfma_f32_16x16x32_bf16 v[20:23], a[216:219], v[108:111], v[20:23]
    buffer_load_dwordx4 a[176:179], v248, s[36:39], s62 offen offset:0 sc1
    v_mfma_f32_16x16x32_bf16 v[24:27], a[220:223], v[108:111], v[24:27]
    ds_read_b64_tr_b16 v[126:127], v169 offset:14336
    v_mfma_f32_16x16x32_bf16 v[28:31], a[224:227], v[108:111], v[28:31]
    s_waitcnt lgkmcnt(6)
    ds_read_b64_tr_b16 v[128:129], v170 offset:12288
    v_mfma_f32_16x16x32_bf16 v[32:35], a[216:219], v[112:115], v[32:35]
    s_waitcnt vmcnt(11)
    ds_read_b64_tr_b16 v[130:131], v170 offset:14336
    ds_read_b128 v[200:203], v175 offset:1024
    v_mfma_f32_16x16x32_bf16 v[36:39], a[220:223], v[112:115], v[36:39]
    buffer_load_dwordx4 a[180:183], v248, s[36:39], s62 offen offset:1024 sc1
    v_mfma_f32_16x16x32_bf16 v[40:43], a[224:227], v[112:115], v[40:43]
    s_waitcnt lgkmcnt(7)
    ds_read_b64_tr_b16 v[132:133], v171 offset:12288
    ds_read_b128 v[204:207], v175 offset:1280
    v_mfma_f32_16x16x32_bf16 v[44:47], a[216:219], v[116:119], v[44:47]
    s_waitcnt lgkmcnt(3)
    ds_read_b64_tr_b16 v[134:135], v171 offset:14336
    v_mfma_f32_16x16x32_bf16 v[48:51], a[220:223], v[116:119], v[48:51]
    ds_read_b128 v[208:211], v175 offset:1536
    ds_read_b128 v[212:215], v175 offset:1792
    v_mfma_f32_16x16x32_bf16 v[52:55], a[224:227], v[116:119], v[52:55]
    buffer_load_dwordx4 a[184:187], v248, s[36:39], s62 offen offset:2048 sc1
    v_mfma_f32_16x16x32_bf16 v[8:11], a[228:231], v[120:123], v[8:11]
    v_mfma_f32_16x16x32_bf16 v[12:15], a[232:235], v[120:123], v[12:15]
    s_waitcnt lgkmcnt(5)
    v_xor_b32 v3, s48, v201
    v_bitop3_b32 v3, v203, s48, v3 bitop3:0xbe
    v_mfma_f32_16x16x32_bf16 v[16:19], a[236:239], v[120:123], v[16:19]
    s_waitcnt lgkmcnt(3)
    v_bitop3_b32 v3, v205, s48, v3 bitop3:0xbe
    v_bitop3_b32 v3, v207, s48, v3 bitop3:0xbe
    v_mfma_f32_16x16x32_bf16 v[20:23], a[228:231], v[124:127], v[20:23]
    buffer_load_dwordx4 a[188:191], v248, s[36:39], s62 offen offset:3072 sc1
    v_mfma_f32_16x16x32_bf16 v[24:27], a[232:235], v[124:127], v[24:27]
    s_waitcnt lgkmcnt(1)
    v_bitop3_b32 v3, v209, s48, v3 bitop3:0xbe
    v_bitop3_b32 v3, v211, s48, v3 bitop3:0xbe
    v_mfma_f32_16x16x32_bf16 v[28:31], a[236:239], v[124:127], v[28:31]
    s_waitcnt lgkmcnt(0)
    v_bitop3_b32 v3, v213, s48, v3 bitop3:0xbe
    v_bitop3_b32 v3, v215, s48, v3 bitop3:0xbe
    v_mfma_f32_16x16x32_bf16 v[32:35], a[228:231], v[128:131], v[32:35]
    v_cmp_ne_u32 vcc, 0, v3
    s_cbranch_vccnz L_stp1_slow
L_stp1_back:
    v_mfma_f32_16x16x32_bf16 v[36:39], a[232:235], v[128:131], v[36:39]
    buffer_load_dwordx4 v[80:83], v216, s[36:39], 0 offen offset:3072 sc1
    v_mfma_f32_16x16x32_bf16 v[40:43], a[236:239], v[128:131], v[40:43]
    v_mfma_f32_16x16x32_bf16 v[44:47], a[228:231], v[132:135], v[44:47]
    v_mfma_f32_16x16x32_bf16 v[48:51], a[232:235], v[132:135], v[48:51]
    v_mfma_f32_16x16x32_bf16 v[52:55], a[236:239], v[132:135], v[52:55]
    s_add_u32 s8, s8, 3145728
    s_add_u32 s50, s8, 98304
    v_pk_fma_f32 v[238:239], v[176:177], v[202:203], v[188:189] op_sel_hi:[1,0,1]
    v_pk_fma_f32 v[240:241], v[178:179], v[202:203], v[190:191] op_sel_hi:[1,0,1]
    v_pk_fma_f32 v[8:9], v[8:9], v[200:201], v[238:239] op_sel_hi:[1,0,1]
    v_pk_fma_f32 v[10:11], v[10:11], v[200:201], v[240:241] op_sel_hi:[1,0,1]
    v_pk_fma_f32 v[242:243], v[180:181], v[202:203], v[192:193] op_sel_hi:[1,0,1]
    v_pk_fma_f32 v[244:245], v[182:183], v[202:203], v[194:195] op_sel_hi:[1,0,1]
    v_pk_fma_f32 v[12:13], v[12:13], v[200:201], v[242:243] op_sel_hi:[1,0,1]
    v_pk_fma_f32 v[14:15], v[14:15], v[200:201], v[244:245] op_sel_hi:[1,0,1]
    v_pk_mul_f32 v[8:9], v[8:9], v[12:13]
    v_pk_mul_f32 v[10:11], v[10:11], v[14:15]
    v_cvt_pk_bf16_f32 v12, v8, v9
    v_cvt_pk_bf16_f32 v13, v10, v11
    v_pk_fma_f32 v[242:243], v[176:177], v[206:207], v[188:189] op_sel_hi:[1,0,1]
    v_pk_fma_f32 v[244:245], v[178:179], v[206:207], v[190:191] op_sel_hi:[1,0,1]
    v_pk_fma_f32 v[20:21], v[20:21], v[204:205], v[242:243] op_sel_hi:[1,0,1]
    v_pk_fma_f32 v[22:23], v[22:23], v[204:205], v[244:245] op_sel_hi:[1,0,1]
    v_pk_fma_f32 v[238:239], v[180:181], v[206:207], v[192:193] op_sel_hi:[1,0,1]
    v_pk_fma_f32 v[240:241], v[182:183], v[206:207], v[194:195] op_sel_hi:[1,0,1]
    v_pk_fma_f32 v[24:25], v[24:25], v[204:205], v[238:239] op_sel_hi:[1,0,1]
    v_pk_fma_f32 v[26:27], v[26:27], v[204:205], v[240:241] op_sel_hi:[1,0,1]
    v_pk_mul_f32 v[20:21], v[20:21], v[24:25]
    v_pk_mul_f32 v[22:23], v[22:23], v[26:27]
    v_cvt_pk_bf16_f32 v14, v20, v21
    v_cvt_pk_bf16_f32 v15, v22, v23
    s_nop 0
    v_permlane16_swap_b32 v12, v14
    v_permlane16_swap_b32 v13, v15
    buffer_store_dwordx4 v[12:15], v173, s[36:39], s8 offen sc1
    v_pk_fma_f32 v[238:239], v[176:177], v[210:211], v[188:189] op_sel_hi:[1,0,1]
    v_pk_fma_f32 v[240:241], v[178:179], v[210:211], v[190:191] op_sel_hi:[1,0,1]
    v_pk_fma_f32 v[32:33], v[32:33], v[208:209], v[238:239] op_sel_hi:[1,0,1]
    v_pk_fma_f32 v[34:35], v[34:35], v[208:209], v[240:241] op_sel_hi:[1,0,1]
    v_pk_fma_f32 v[242:243], v[180:181], v[210:211], v[192:193] op_sel_hi:[1,0,1]
    v_pk_fma_f32 v[244:245], v[182:183], v[210:211], v[194:195] op_sel_hi:[1,0,1]
    v_pk_fma_f32 v[36:37], v[36:37], v[208:209], v[242:243] op_sel_hi:[1,0,1]
    v_pk_fma_f32 v[38:39], v[38:39], v[208:209], v[244:245] op_sel_hi:[1,0,1]
    v_pk_mul_f32 v[32:33], v[32:33], v[36:37]
    v_pk_mul_f32 v[34:35], v[34:35], v[38:39]
    v_cvt_pk_bf16_f32 v36, v32, v33
    v_cvt_pk_bf16_f32 v37, v34, v35
    v_pk_fma_f32 v[242:243], v[176:177], v[214:215], v[188:189] op_sel_hi:[1,0,1]
    v_pk_fma_f32 v[244:245], v[178:179], v[214:215], v[190:191] op_sel_hi:[1,0,1]
    v_pk_fma_f32 v[44:45], v[44:45], v[212:213], v[242:243] op_sel_hi:[1,0,1]
    v_pk_fma_f32 v[46:47], v[46:47], v[212:213], v[244:245] op_sel_hi:[1,0,1]
    v_pk_fma_f32 v[238:239], v[180:181], v[214:215], v[192:193] op_sel_hi:[1,0,1]
    v_pk_fma_f32 v[240:241], v[182:183], v[214:215], v[194:195] op_sel_hi:[1,0,1]
    v_pk_fma_f32 v[48:49], v[48:49], v[212:213], v[238:239] op_sel_hi:[1,0,1]
    v_pk_fma_f32 v[50:51], v[50:51], v[212:213], v[240:241] op_sel_hi:[1,0,1]
    v_pk_mul_f32 v[44:45], v[44:45], v[48:49]
    v_pk_mul_f32 v[46:47], v[46:47], v[50:51]
    v_cvt_pk_bf16_f32 v38, v44, v45
    v_cvt_pk_bf16_f32 v39, v46, v47
    s_nop 0
    v_permlane16_swap_b32 v36, v38
    v_permlane16_swap_b32 v37, v39
    buffer_store_dwordx4 v[36:39], v173, s[36:39], s50 offen sc1
    v_pk_fma_f32 v[238:239], v[184:185], v[202:203], v[196:197] op_sel_hi:[1,0,1]
    v_pk_fma_f32 v[240:241], v[186:187], v[202:203], v[198:199] op_sel_hi:[1,0,1]
    v_pk_fma_f32 v[16:17], v[16:17], v[200:201], v[238:239] op_sel_hi:[1,0,1]
    v_pk_fma_f32 v[18:19], v[18:19], v[200:201], v[240:241] op_sel_hi:[1,0,1]
    v_pk_fma_f32 v[242:243], v[184:185], v[206:207], v[196:197] op_sel_hi:[1,0,1]
    v_pk_fma_f32 v[244:245], v[186:187], v[206:207], v[198:199] op_sel_hi:[1,0,1]
    v_pk_fma_f32 v[28:29], v[28:29], v[204:205], v[242:243] op_sel_hi:[1,0,1]
    v_pk_fma_f32 v[30:31], v[30:31], v[204:205], v[244:245] op_sel_hi:[1,0,1]
    s_nop 0
    v_permlane32_swap_b32 v16, v28
    v_permlane32_swap_b32 v17, v29
    v_permlane32_swap_b32 v18, v30
    v_permlane32_swap_b32 v19, v31
    v_pk_mul_f32 v[16:17], v[16:17], v[28:29]
    v_pk_mul_f32 v[18:19], v[18:19], v[30:31]
    v_cvt_pk_bf16_f32 v8, v16, v17
    v_cvt_pk_bf16_f32 v9, v18, v19
    v_pk_fma_f32 v[238:239], v[184:185], v[210:211], v[196:197] op_sel_hi:[1,0,1]
    v_pk_fma_f32 v[240:241], v[186:187], v[210:211], v[198:199] op_sel_hi:[1,0,1]
    v_pk_fma_f32 v[40:41], v[40:41], v[208:209], v[238:239] op_sel_hi:[1,0,1]
    v_pk_fma_f32 v[42:43], v[42:43], v[208:209], v[240:241] op_sel_hi:[1,0,1]
    v_pk_fma_f32 v[242:243], v[184:185], v[214:215], v[196:197] op_sel_hi:[1,0,1]
    v_pk_fma_f32 v[244:245], v[186:187], v[214:215], v[198:199] op_sel_hi:[1,0,1]
    v_pk_fma_f32 v[52:53], v[52:53], v[212:213], v[242:243] op_sel_hi:[1,0,1]
    v_pk_fma_f32 v[54:55], v[54:55], v[212:213], v[244:245] op_sel_hi:[1,0,1]
    s_nop 0
    v_permlane32_swap_b32 v40, v52
    v_permlane32_swap_b32 v41, v53
    v_permlane32_swap_b32 v42, v54
    v_permlane32_swap_b32 v43, v55
    v_pk_mul_f32 v[40:41], v[40:41], v[52:53]
    v_pk_mul_f32 v[42:43], v[42:43], v[54:55]
    v_cvt_pk_bf16_f32 v10, v40, v41
    v_cvt_pk_bf16_f32 v11, v42, v43
    s_nop 0
    v_permlane16_swap_b32 v8, v10
    v_permlane16_swap_b32 v9, v11
    buffer_store_dwordx4 v[8:11], v174, s[36:39], s8 offen offset:512 sc1
    buffer_load_dwordx4 v[84:87], v217, s[36:39], 0 offen offset:3072 sc1
    buffer_load_dwordx4 v[88:91], v216, s[36:39], s4 offen offset:0 sc1
    buffer_load_dwordx4 v[92:95], v217, s[36:39], s4 offen offset:0 sc1
    buffer_load_dwordx4 v[96:99], v216, s[36:39], s4 offen offset:1024 sc1
    buffer_load_dwordx4 v[100:103], v217, s[36:39], s4 offen offset:1024 sc1
    s_mov_b32 s40, s28
    s_mov_b32 s41, s29
    s_mov_b32 s42, 0x280000
    s_mov_b32 s43, 0x20000
    s_waitcnt vmcnt(19)
    v_mfma_f32_16x16x32_bf16 v[8:11], a[240:243], v[56:59], 0
    s_and_b32 s50, s3, 1
    s_lshr_b32 s51, s3, 1
    v_mfma_f32_16x16x32_bf16 v[12:15], a[244:247], v[56:59], 0
    s_mul_i32 s52, s50, 20480
    s_mul_i32 s53, s3, 5120
    s_add_u32 s52, s52, s53
    v_mfma_f32_16x16x32_bf16 v[16:19], a[248:251], v[56:59], 0
    v_add_u32 v220, s52, v248
    v_add_u32 v222, 40960, v220
    v_mfma_f32_16x16x32_bf16 v[20:23], a[252:255], v[56:59], 0
    s_xor_b32 s52, s50, 1
    s_mul_i32 s52, s52, 20480
    s_add_u32 s52, s52, s53
    v_mfma_f32_16x16x32_bf16 v[24:27], v[136:139], v[56:59], 0
    s_waitcnt vmcnt(18)
    v_add_u32 v221, s52, v248
    v_add_u32 v223, 40960, v221
    v_mfma_f32_16x16x32_bf16 v[28:31], a[240:243], v[60:63], 0
    s_mul_i32 s52, s51, 20480
    s_lshl_b32 s53, s50, 11
    buffer_load_dwordx4 v[56:59], v216, s[36:39], s4 offen offset:2048 sc1
    v_mfma_f32_16x16x32_bf16 v[32:35], a[244:247], v[60:63], 0
    s_add_u32 s52, s52, s53
    v_add_u32 v224, s52, v248
    v_mfma_f32_16x16x32_bf16 v[36:39], a[248:251], v[60:63], 0
    s_mul_i32 s53, s51, 5120
    s_add_u32 s53, s53, 40960
    v_add_u32 v225, s53, v224
    v_mfma_f32_16x16x32_bf16 v[40:43], a[252:255], v[60:63], 0
    s_xor_b32 s53, s51, 1
    s_mul_i32 s53, s53, 5120
    s_add_u32 s53, s53, 40960
    v_mfma_f32_16x16x32_bf16 v[44:47], v[136:139], v[60:63], 0
    s_waitcnt vmcnt(18)
    v_add_u32 v226, s53, v224
    v_mfma_f32_16x16x32_bf16 v[8:11], v[140:143], v[64:67], v[8:11]
    s_lshl_b32 s52, s74, 1
    s_add_u32 s52, s52, s51
    s_mul_i32 s12, s75, 320
    buffer_load_dwordx4 v[60:63], v217, s[36:39], s4 offen offset:2048 sc1
    v_mfma_f32_16x16x32_bf16 v[12:15], v[144:147], v[64:67], v[12:15]
    s_add_u32 s12, s12, 23147008
    s_mul_i32 s13, s52, 20480
    s_mul_i32 s53, s75, 160
    s_add_u32 s13, s13, s53
    v_mfma_f32_16x16x32_bf16 v[16:19], v[148:151], v[64:67], v[16:19]
    s_lshl_b32 s53, s50, 6
    s_add_u32 s13, s13, s53
    s_add_u32 s14, s13, 1310720
    v_mfma_f32_16x16x32_bf16 v[20:23], v[152:155], v[64:67], v[20:23]
    s_mul_i32 s10, s75, 10
    s_add_u32 s10, s10, s3
    v_mfma_f32_16x16x32_bf16 v[24:27], v[156:159], v[64:67], v[24:27]
    s_mul_i32 s10, s10, 32768
    s_lshl_b32 s53, s74, 6
    s_add_u32 s10, s10, s53
    s_add_u32 s10, s10, 0
    s_waitcnt vmcnt(18)
    v_mfma_f32_16x16x32_bf16 v[28:31], v[140:143], v[68:71], v[28:31]
    s_lshl_b32 s11, s3, 10
    s_add_u32 s11, s11, 81920
    v_lshrrev_b32 v2, 3, v1
    buffer_load_dwordx4 v[64:67], v216, s[36:39], s4 offen offset:3072 sc1
    v_mfma_f32_16x16x32_bf16 v[32:35], v[144:147], v[68:71], v[32:35]
    v_mul_u32_u24 v229, 4096, v2
    v_bfe_u32 v2, v1, 2, 1
    v_mfma_f32_16x16x32_bf16 v[36:39], v[148:151], v[68:71], v[36:39]
    v_lshl_add_u32 v229, v2, 11, v229
    v_and_b32 v2, 3, v1
    v_mfma_f32_16x16x32_bf16 v[40:43], v[152:155], v[68:71], v[40:43]
    v_lshl_add_u32 v229, v2, 4, v229
    v_lshrrev_b32 v3, 2, v1
    v_mfma_f32_16x16x32_bf16 v[44:47], v[156:159], v[68:71], v[44:47]
    s_waitcnt vmcnt(18)
    v_lshlrev_b32 v231, 7, v3
    v_lshl_add_u32 v231, v2, 3, v231
    v_mfma_f32_16x16x32_bf16 v[8:11], v[160:163], v[72:75], v[8:11]
    s_barrier
    s_lshl_b32 s53, s50, 12
    s_lshl_b32 s52, s51, 5
    buffer_load_dwordx4 v[68:71], v217, s[36:39], s4 offen offset:3072 sc1
    v_mfma_f32_16x16x32_bf16 v[12:15], v[164:167], v[72:75], v[12:15]
    s_add_u32 s53, s53, s52
    s_add_u32 s53, s53, 81920
    v_add_u32 v231, s53, v231
    v_mfma_f32_16x16x32_bf16 v[16:19], a[0:3], v[72:75], v[16:19]
    v_and_b32 v2, 15, v1
    v_lshrrev_b32 v3, 4, v1
    v_mfma_f32_16x16x32_bf16 v[20:23], a[4:7], v[72:75], v[20:23]
    v_mul_u32_u24 v2, 1280, v2
    v_lshl_add_u32 v228, v3, 3, v2
    v_mfma_f32_16x16x32_bf16 v[24:27], a[8:11], v[72:75], v[24:27]
    s_waitcnt vmcnt(17)
    v_and_b32 v227, 1, v3
    v_lshl_add_u32 v2, v227, 5, v2
    v_lshrrev_b32 v3, 1, v3
    v_mfma_f32_16x16x32_bf16 v[28:31], v[160:163], v[76:79], v[28:31]
    buffer_load_dwordx4 v[72:75], v216, s[36:39], s5 offen offset:0 sc1
    v_mfma_f32_16x16x32_bf16 v[32:35], v[164:167], v[76:79], v[32:35]
    v_lshl_add_u32 v227, v3, 4, v2
    v_mfma_f32_16x16x32_bf16 v[36:39], a[0:3], v[76:79], v[36:39]
    s_lshr_b32 s50, s74, 1
    s_lshl_b32 s50, s50, 2
    s_add_u32 s50, s50, s3
    s_lshl_b32 s50, s50, 9
    v_mfma_f32_16x16x32_bf16 v[40:43], a[4:7], v[76:79], v[40:43]
    s_add_u32 s50, s50, 121856
    v_min_u32 v246, 3, v1
    v_lshlrev_b32 v246, 7, v246
    v_mfma_f32_16x16x32_bf16 v[44:47], a[8:11], v[76:79], v[44:47]
    s_waitcnt vmcnt(13)
    v_add_u32 v246, s50, v246
    v_min_u32 v2, 23, v1
    v_mfma_f32_16x16x32_bf16 v[8:11], a[12:15], v[80:83], v[8:11]
    buffer_load_dwordx4 v[76:79], v217, s[36:39], s5 offen offset:0 sc1
    v_mfma_f32_16x16x32_bf16 v[12:15], a[16:19], v[80:83], v[12:15]
    v_lshlrev_b32 v244, 4, v2
    v_mov_b32 v3, 36160
    v_mfma_f32_16x16x32_bf16 v[16:19], a[20:23], v[80:83], v[16:19]
    v_cmp_lt_u32 vcc, 11, v2
    s_nop 1
    v_cndmask_b32 v3, 0, v3, vcc
    v_mfma_f32_16x16x32_bf16 v[20:23], a[24:27], v[80:83], v[20:23]
    s_and_b32 s53, s3, 1
    s_lshl_b32 s53, s53, 7
    v_add3_u32 v244, v244, v3, s53
    v_mfma_f32_16x16x32_bf16 v[24:27], a[28:31], v[80:83], v[24:27]
    s_lshl_b32 s15, s3, 10
    s_add_u32 s15, s15, 94208
    v_and_b32 v230, 48, v1
    v_add_u32 v230, s15, v230
    s_waitcnt vmcnt(10)
    v_mfma_f32_16x16x32_bf16 v[28:31], a[12:15], v[84:87], v[28:31]
    s_mov_b32 m0, s15
    buffer_load_dwordx4 v[80:83], v216, s[36:39], s5 offen offset:1024 sc1
    v_mfma_f32_16x16x32_bf16 v[32:35], a[16:19], v[84:87], v[32:35]
    buffer_load_dwordx4 v244, s[36:39], s12 offen sc1 lds
    v_mfma_f32_16x16x32_bf16 v[36:39], a[20:23], v[84:87], v[36:39]
    s_add_u32 m0, s11, 0
    v_mfma_f32_16x16x32_bf16 v[40:43], a[24:27], v[84:87], v[40:43]
    buffer_load_dwordx4 v229, s[36:39], s10 offen sc1 lds
    v_mfma_f32_16x16x32_bf16 v[44:47], a[28:31], v[84:87], v[44:47]
    s_waitcnt vmcnt(12)
    s_add_u32 s10, s10, 131072
    v_mfma_f32_16x16x32_bf16 v[8:11], a[32:35], v[88:91], v[8:11]
    s_barrier
    s_cmp_eq_u32 s3, 0
    s_cbranch_scc0 L_wf29
    s_lshl_b32 s54, s76, 7
    s_add_u32 s54, s54, 23321600
    v_mov_b32 v254, 0
    v_mov_b32 v255, s48
    s_mov_b64 exec, 1
    buffer_store_dword v255, v254, s[36:39], s54 offen sc1
    s_mov_b64 exec, -1
L_wf29:
    s_add_u32 m0, s11, 4096
    v_mfma_f32_16x16x32_bf16 v[12:15], a[36:39], v[88:91], v[12:15]
    buffer_load_dwordx4 v229, s[36:39], s10 offen sc1 lds
    v_mfma_f32_16x16x32_bf16 v[16:19], a[40:43], v[88:91], v[16:19]
    s_add_u32 s10, s10, 131072
    v_mfma_f32_16x16x32_bf16 v[20:23], a[44:47], v[88:91], v[20:23]
    s_add_u32 m0, s11, 8192
    v_mfma_f32_16x16x32_bf16 v[24:27], a[48:51], v[88:91], v[24:27]
    s_waitcnt vmcnt(12)
    buffer_load_dwordx4 v229, s[36:39], s10 offen sc1 lds
    v_mfma_f32_16x16x32_bf16 v[28:31], a[32:35], v[92:95], v[28:31]
    v_mfma_f32_16x16x32_bf16 v[32:35], a[36:39], v[92:95], v[32:35]
    v_mfma_f32_16x16x32_bf16 v[36:39], a[40:43], v[92:95], v[36:39]
    buffer_load_dwordx4 v[84:87], v217, s[36:39], s5 offen offset:1024 sc1
    v_mfma_f32_16x16x32_bf16 v[40:43], a[44:47], v[92:95], v[40:43]
    v_mfma_f32_16x16x32_bf16 v[44:47], a[48:51], v[92:95], v[44:47]
    s_waitcnt vmcnt(13)
    v_mfma_f32_16x16x32_bf16 v[8:11], a[52:55], v[96:99], v[8:11]
    buffer_load_dwordx4 v[88:91], v216, s[36:39], s5 offen offset:2048 sc1
    v_mfma_f32_16x16x32_bf16 v[12:15], a[56:59], v[96:99], v[12:15]
    v_mfma_f32_16x16x32_bf16 v[16:19], a[60:63], v[96:99], v[16:19]
    v_mfma_f32_16x16x32_bf16 v[20:23], a[64:67], v[96:99], v[20:23]
    buffer_load_dwordx4 v[92:95], v217, s[36:39], s5 offen offset:2048 sc1
    v_mfma_f32_16x16x32_bf16 v[24:27], a[68:71], v[96:99], v[24:27]
    s_waitcnt vmcnt(14)
    v_mfma_f32_16x16x32_bf16 v[28:31], a[52:55], v[100:103], v[28:31]
    v_mfma_f32_16x16x32_bf16 v[32:35], a[56:59], v[100:103], v[32:35]
    buffer_load_dwordx4 v[96:99], v216, s[36:39], s5 offen offset:3072 sc1
    v_mfma_f32_16x16x32_bf16 v[36:39], a[60:63], v[100:103], v[36:39]
    v_mfma_f32_16x16x32_bf16 v[40:43], a[64:67], v[100:103], v[40:43]
    v_mfma_f32_16x16x32_bf16 v[44:47], a[68:71], v[100:103], v[44:47]
    s_waitcnt vmcnt(14)
    v_mfma_f32_16x16x32_bf16 v[8:11], a[72:75], v[56:59], v[8:11]
    buffer_load_dwordx4 v[100:103], v217, s[36:39], s5 offen offset:3072 sc1
    v_mfma_f32_16x16x32_bf16 v[12:15], a[76:79], v[56:59], v[12:15]
    v_mfma_f32_16x16x32_bf16 v[16:19], a[80:83], v[56:59], v[16:19]
    v_mfma_f32_16x16x32_bf16 v[20:23], a[84:87], v[56:59], v[20:23]
    v_mfma_f32_16x16x32_bf16 v[24:27], a[88:91], v[56:59], v[24:27]
    s_waitcnt vmcnt(14)
    v_mfma_f32_16x16x32_bf16 v[28:31], a[72:75], v[60:63], v[28:31]
    v_mfma_f32_16x16x32_bf16 v[32:35], a[76:79], v[60:63], v[32:35]
    v_mfma_f32_16x16x32_bf16 v[36:39], a[80:83], v[60:63], v[36:39]
    v_mfma_f32_16x16x32_bf16 v[40:43], a[84:87], v[60:63], v[40:43]
    v_mfma_f32_16x16x32_bf16 v[44:47], a[88:91], v[60:63], v[44:47]
    s_waitcnt vmcnt(13)
    v_mfma_f32_16x16x32_bf16 v[8:11], a[92:95], v[64:67], v[8:11]
    v_mfma_f32_16x16x32_bf16 v[12:15], a[96:99], v[64:67], v[12:15]
    v_mfma_f32_16x16x32_bf16 v[16:19], a[100:103], v[64:67], v[16:19]
    v_mfma_f32_16x16x32_bf16 v[20:23], a[104:107], v[64:67], v[20:23]
    v_mfma_f32_16x16x32_bf16 v[24:27], a[108:111], v[64:67], v[24:27]
    s_waitcnt vmcnt(12)
    v_mfma_f32_16x16x32_bf16 v[28:31], a[92:95], v[68:71], v[28:31]
    v_mfma_f32_16x16x32_bf16 v[32:35], a[96:99], v[68:71], v[32:35]
    v_mfma_f32_16x16x32_bf16 v[36:39], a[100:103], v[68:71], v[36:39]
    v_mfma_f32_16x16x32_bf16 v[40:43], a[104:107], v[68:71], v[40:43]
    v_mfma_f32_16x16x32_bf16 v[44:47], a[108:111], v[68:71], v[44:47]
    s_waitcnt vmcnt(11)
    v_mfma_f32_16x16x32_bf16 v[8:11], a[112:115], v[72:75], v[8:11]
    buffer_load_dword v247, v246, s[36:39], s17 offen sc1
    v_mfma_f32_16x16x32_bf16 v[12:15], a[116:119], v[72:75], v[12:15]
    v_mfma_f32_16x16x32_bf16 v[16:19], a[120:123], v[72:75], v[16:19]
    v_mfma_f32_16x16x32_bf16 v[20:23], a[124:127], v[72:75], v[20:23]
    v_mfma_f32_16x16x32_bf16 v[24:27], a[128:131], v[72:75], v[24:27]
    s_waitcnt vmcnt(6)
    s_barrier
    ds_read_b64_tr_b16 v[180:181], v231 offset:0
    v_mfma_f32_16x16x32_bf16 v[28:31], a[112:115], v[76:79], v[28:31]
    ds_read_b64_tr_b16 v[182:183], v231 offset:2048
    v_mfma_f32_16x16x32_bf16 v[32:35], a[116:119], v[76:79], v[32:35]
    ds_read_b64_tr_b16 v[184:185], v231 offset:4096
    v_mfma_f32_16x16x32_bf16 v[36:39], a[120:123], v[76:79], v[36:39]
    ds_read_b64_tr_b16 v[186:187], v231 offset:64
    v_mfma_f32_16x16x32_bf16 v[40:43], a[124:127], v[76:79], v[40:43]
    ds_read_b64_tr_b16 v[188:189], v231 offset:2112
    v_mfma_f32_16x16x32_bf16 v[44:47], a[128:131], v[76:79], v[44:47]
    ds_read_b64_tr_b16 v[190:191], v231 offset:4160
    v_mfma_f32_16x16x32_bf16 v[8:11], a[132:135], v[80:83], v[8:11]
    ds_read_b128 v[48:51], v230 offset:0
    v_mfma_f32_16x16x32_bf16 v[12:15], a[136:139], v[80:83], v[12:15]
    ds_read_b128 v[52:55], v230 offset:64
    v_mfma_f32_16x16x32_bf16 v[16:19], a[140:143], v[80:83], v[16:19]
    ds_read_b128 v[124:127], v230 offset:128
    v_mfma_f32_16x16x32_bf16 v[20:23], a[144:147], v[80:83], v[20:23]
    ds_read_b128 v[168:171], v230 offset:192
    v_mfma_f32_16x16x32_bf16 v[24:27], a[148:151], v[80:83], v[24:27]
    s_waitcnt vmcnt(5)
    ds_read_b128 v[172:175], v230 offset:256
    v_mfma_f32_16x16x32_bf16 v[28:31], a[132:135], v[84:87], v[28:31]
    ds_read_b128 v[176:179], v230 offset:320
    v_mfma_f32_16x16x32_bf16 v[32:35], a[136:139], v[84:87], v[32:35]
    v_mfma_f32_16x16x32_bf16 v[36:39], a[140:143], v[84:87], v[36:39]
    s_waitcnt lgkmcnt(11)
    v_lshlrev_b32 v204, 16, v180
    s_waitcnt lgkmcnt(2)
    v_mul_f32 v204, v204, v168
    v_mfma_f32_16x16x32_bf16 v[40:43], a[144:147], v[84:87], v[40:43]
    v_and_b32 v205, 0xffff0000, v180
    v_mul_f32 v205, v205, v169
    v_mfma_f32_16x16x32_bf16 v[44:47], a[148:151], v[84:87], v[44:47]
    s_waitcnt vmcnt(4)
    v_lshlrev_b32 v206, 16, v181
    v_mul_f32 v206, v206, v170
    v_mfma_f32_16x16x32_bf16 v[8:11], a[152:155], v[88:91], v[8:11]
    v_and_b32 v207, 0xffff0000, v181
    v_mul_f32 v207, v207, v171
    v_mfma_f32_16x16x32_bf16 v[12:15], a[156:159], v[88:91], v[12:15]
    v_lshlrev_b32 v208, 16, v182
    s_waitcnt lgkmcnt(1)
    v_mul_f32 v208, v208, v172
    v_mfma_f32_16x16x32_bf16 v[16:19], a[160:163], v[88:91], v[16:19]
    v_and_b32 v209, 0xffff0000, v182
    v_mul_f32 v209, v209, v173
    v_mfma_f32_16x16x32_bf16 v[20:23], a[164:167], v[88:91], v[20:23]
    v_lshlrev_b32 v210, 16, v183
    v_mul_f32 v210, v210, v174
    v_mfma_f32_16x16x32_bf16 v[24:27], a[168:171], v[88:91], v[24:27]
    s_waitcnt vmcnt(3)
    v_and_b32 v211, 0xffff0000, v183
    v_mul_f32 v211, v211, v175
    v_mfma_f32_16x16x32_bf16 v[28:31], a[152:155], v[92:95], v[28:31]
    v_lshlrev_b32 v212, 16, v184
    s_waitcnt lgkmcnt(0)
    v_mul_f32 v212, v212, v176
    v_mfma_f32_16x16x32_bf16 v[32:35], a[156:159], v[92:95], v[32:35]
    v_and_b32 v213, 0xffff0000, v184
    v_mul_f32 v213, v213, v177
    v_mfma_f32_16x16x32_bf16 v[36:39], a[160:163], v[92:95], v[36:39]
    v_lshlrev_b32 v214, 16, v185
    v_mul_f32 v214, v214, v178
    v_mfma_f32_16x16x32_bf16 v[40:43], a[164:167], v[92:95], v[40:43]
    v_and_b32 v215, 0xffff0000, v185
    v_mul_f32 v215, v215, v179
    v_mfma_f32_16x16x32_bf16 v[44:47], a[168:171], v[92:95], v[44:47]
    s_waitcnt vmcnt(2)
    v_lshlrev_b32 v232, 16, v186
    v_mul_f32 v232, v232, v168
    v_mfma_f32_16x16x32_bf16 v[8:11], a[172:175], v[96:99], v[8:11]
    s_waitcnt vmcnt(0)
    v_cmp_ne_u32 vcc, s48, v247
    s_cbranch_vccnz L_chk30_slow
L_chk30_back:
    v_and_b32 v233, 0xffff0000, v186
    v_mfma_f32_16x16x32_bf16 v[12:15], a[176:179], v[96:99], v[12:15]
    buffer_load_dwordx4 v[56:59], v218, s[36:39], 0 offen offset:0 sc1
    v_mfma_f32_16x16x32_bf16 v[16:19], a[180:183], v[96:99], v[16:19]
    v_mul_f32 v233, v233, v169
    v_lshlrev_b32 v234, 16, v187
    v_mfma_f32_16x16x32_bf16 v[20:23], a[184:187], v[96:99], v[20:23]
    v_mul_f32 v234, v234, v170
    v_and_b32 v235, 0xffff0000, v187
    v_mfma_f32_16x16x32_bf16 v[24:27], a[188:191], v[96:99], v[24:27]
    buffer_load_dwordx4 v[60:63], v218, s[36:39], 0 offen offset:1024 sc1
    v_mfma_f32_16x16x32_bf16 v[28:31], a[172:175], v[100:103], v[28:31]
    v_mul_f32 v235, v235, v171
    v_lshlrev_b32 v236, 16, v188
    v_mfma_f32_16x16x32_bf16 v[32:35], a[176:179], v[100:103], v[32:35]
    v_mul_f32 v236, v236, v172
    v_and_b32 v237, 0xffff0000, v188
    v_mfma_f32_16x16x32_bf16 v[36:39], a[180:183], v[100:103], v[36:39]
    buffer_load_dwordx4 v[64:67], v218, s[36:39], 0 offen offset:2048 sc1
    v_mfma_f32_16x16x32_bf16 v[40:43], a[184:187], v[100:103], v[40:43]
    ds_write_b128 v220, v[8:11] offset:0
    v_mul_f32 v237, v237, v173
    v_lshlrev_b32 v238, 16, v189
    v_mfma_f32_16x16x32_bf16 v[44:47], a[188:191], v[100:103], v[44:47]
    s_waitcnt vmcnt(2)
    v_mul_f32 v238, v238, v174
    v_and_b32 v239, 0xffff0000, v189
    v_mfma_f32_16x16x32_bf16 v[104:107], a[240:243], v[56:59], 0
    buffer_load_dwordx4 v[68:71], v218, s[36:39], 0 offen offset:3072 sc1
    v_mfma_f32_16x16x32_bf16 v[108:111], a[244:247], v[56:59], 0
    ds_write_b128 v220, v[12:15] offset:1024
    v_mul_f32 v239, v239, v175
    v_lshlrev_b32 v240, 16, v190
    v_mfma_f32_16x16x32_bf16 v[112:115], a[248:251], v[56:59], 0
    v_mul_f32 v240, v240, v176
    v_and_b32 v241, 0xffff0000, v190
    v_mfma_f32_16x16x32_bf16 v[116:119], a[252:255], v[56:59], 0
    buffer_load_dwordx4 v[72:75], v218, s[36:39], s4 offen offset:0 sc1
    v_mfma_f32_16x16x32_bf16 v[120:123], v[136:139], v[56:59], 0
    s_waitcnt vmcnt(3)
    ds_write_b128 v220, v[16:19] offset:2048
    v_mul_f32 v241, v241, v177
    v_lshlrev_b32 v242, 16, v191
    v_mfma_f32_16x16x32_bf16 v[104:107], v[140:143], v[60:63], v[104:107]
    v_mul_f32 v242, v242, v178
    v_and_b32 v243, 0xffff0000, v191
    v_mfma_f32_16x16x32_bf16 v[108:111], v[144:147], v[60:63], v[108:111]
    buffer_load_dwordx4 v[76:79], v218, s[36:39], s4 offen offset:1024 sc1
    v_mfma_f32_16x16x32_bf16 v[112:115], v[148:151], v[60:63], v[112:115]
    ds_write_b128 v220, v[20:23] offset:3072
    v_mul_f32 v243, v243, v179
    v_mfma_f32_16x16x32_bf16 v[116:119], v[152:155], v[60:63], v[116:119]
    v_mfma_f32_16x16x32_bf16 v[120:123], v[156:159], v[60:63], v[120:123]
    s_waitcnt vmcnt(3)
    buffer_load_dwordx4 v[80:83], v218, s[36:39], s4 offen offset:2048 sc1
    v_mfma_f32_16x16x32_bf16 v[104:107], v[160:163], v[64:67], v[104:107]
    ds_write_b128 v220, v[24:27] offset:4096
    v_mfma_f32_16x16x32_bf16 v[108:111], v[164:167], v[64:67], v[108:111]
    v_mfma_f32_16x16x32_bf16 v[112:115], a[0:3], v[64:67], v[112:115]
    ds_write_b128 v221, v[28:31] offset:0
    buffer_load_dwordx4 v[84:87], v218, s[36:39], s4 offen offset:3072 sc1
    v_mfma_f32_16x16x32_bf16 v[116:119], a[4:7], v[64:67], v[116:119]
    v_mfma_f32_16x16x32_bf16 v[120:123], a[8:11], v[64:67], v[120:123]
    s_waitcnt vmcnt(4)
    ds_write_b128 v221, v[32:35] offset:1024
    v_mfma_f32_16x16x32_bf16 v[104:107], a[12:15], v[68:71], v[104:107]
    buffer_load_dwordx4 v[88:91], v218, s[36:39], s5 offen offset:0 sc1
    v_mfma_f32_16x16x32_bf16 v[108:111], a[16:19], v[68:71], v[108:111]
    ds_write_b128 v221, v[36:39] offset:2048
    v_mfma_f32_16x16x32_bf16 v[112:115], a[20:23], v[68:71], v[112:115]
    v_mfma_f32_16x16x32_bf16 v[116:119], a[24:27], v[68:71], v[116:119]
    buffer_load_dwordx4 v[92:95], v218, s[36:39], s5 offen offset:1024 sc1
    v_mfma_f32_16x16x32_bf16 v[120:123], a[28:31], v[68:71], v[120:123]
    s_waitcnt vmcnt(5)
    ds_write_b128 v221, v[40:43] offset:3072
    v_mfma_f32_16x16x32_bf16 v[104:107], a[32:35], v[72:75], v[104:107]
    v_mfma_f32_16x16x32_bf16 v[108:111], a[36:39], v[72:75], v[108:111]
    buffer_load_dwordx4 v[96:99], v218, s[36:39], s5 offen offset:2048 sc1
    v_mfma_f32_16x16x32_bf16 v[112:115], a[40:43], v[72:75], v[112:115]
    ds_write_b128 v221, v[44:47] offset:4096
    v_mfma_f32_16x16x32_bf16 v[116:119], a[44:47], v[72:75], v[116:119]
    v_mfma_f32_16x16x32_bf16 v[120:123], a[48:51], v[72:75], v[120:123]
    s_waitcnt vmcnt(5)
    buffer_load_dwordx4 v[100:103], v218, s[36:39], s5 offen offset:3072 sc1
    v_mfma_f32_16x16x32_bf16 v[104:107], a[52:55], v[76:79], v[104:107]
    v_mfma_f32_16x16x32_bf16 v[108:111], a[56:59], v[76:79], v[108:111]
    v_mfma_f32_16x16x32_bf16 v[112:115], a[60:63], v[76:79], v[112:115]
    buffer_load_dwordx4 v[56:59], v219, s[36:39], 0 offen offset:0 sc1
    v_mfma_f32_16x16x32_bf16 v[116:119], a[64:67], v[76:79], v[116:119]
    v_mfma_f32_16x16x32_bf16 v[120:123], a[68:71], v[76:79], v[120:123]
    s_waitcnt vmcnt(6)
    v_mfma_f32_16x16x32_bf16 v[104:107], a[72:75], v[80:83], v[104:107]
    buffer_load_dwordx4 v[60:63], v219, s[36:39], 0 offen offset:1024 sc1
    v_mfma_f32_16x16x32_bf16 v[108:111], a[76:79], v[80:83], v[108:111]
    s_waitcnt lgkmcnt(0)
    s_barrier
    ds_read_b128 v[168:171], v224 offset:0
    v_mfma_f32_16x16x32_bf16 v[112:115], a[80:83], v[80:83], v[112:115]
    ds_read_b128 v[172:175], v224 offset:1024
    v_mfma_f32_16x16x32_bf16 v[116:119], a[84:87], v[80:83], v[116:119]
    buffer_load_dwordx4 v[64:67], v219, s[36:39], 0 offen offset:2048 sc1
    v_mfma_f32_16x16x32_bf16 v[120:123], a[88:91], v[80:83], v[120:123]
    s_waitcnt vmcnt(7)
    ds_read_b128 v[176:179], v224 offset:2048
    v_mfma_f32_16x16x32_bf16 v[104:107], a[92:95], v[84:87], v[104:107]
    ds_read_b128 v[180:183], v224 offset:5120
    ds_read_b128 v[184:187], v224 offset:6144
    v_mfma_f32_16x16x32_bf16 v[108:111], a[96:99], v[84:87], v[108:111]
    buffer_load_dwordx4 v[68:71], v219, s[36:39], 0 offen offset:3072 sc1
    v_mfma_f32_16x16x32_bf16 v[112:115], a[100:103], v[84:87], v[112:115]
    ds_read_b128 v[188:191], v224 offset:7168
    v_mfma_f32_16x16x32_bf16 v[116:119], a[104:107], v[84:87], v[116:119]
    ds_read_b128 v[192:195], v224 offset:10240
    ds_read_b128 v[196:199], v224 offset:11264
    v_mfma_f32_16x16x32_bf16 v[120:123], a[108:111], v[84:87], v[120:123]
    s_waitcnt vmcnt(7)
    buffer_load_dwordx4 v[72:75], v219, s[36:39], s4 offen offset:0 sc1
    v_mfma_f32_16x16x32_bf16 v[104:107], a[112:115], v[88:91], v[104:107]
    ds_read_b128 v[200:203], v224 offset:12288
    v_mfma_f32_16x16x32_bf16 v[108:111], a[116:119], v[88:91], v[108:111]
    s_waitcnt lgkmcnt(5)
    v_add_f32 v168, v168, v180
    v_add_f32 v169, v169, v181
    v_add_f32 v170, v170, v182
    v_mfma_f32_16x16x32_bf16 v[112:115], a[120:123], v[88:91], v[112:115]
    buffer_load_dwordx4 v[76:79], v219, s[36:39], s4 offen offset:1024 sc1
    v_mfma_f32_16x16x32_bf16 v[116:119], a[124:127], v[88:91], v[116:119]
    v_add_f32 v171, v171, v183
    s_waitcnt lgkmcnt(4)
    v_add_f32 v172, v172, v184
    v_mfma_f32_16x16x32_bf16 v[120:123], a[128:131], v[88:91], v[120:123]
    s_waitcnt vmcnt(8)
    v_add_f32 v173, v173, v185
    v_add_f32 v174, v174, v186
    v_mfma_f32_16x16x32_bf16 v[104:107], a[132:135], v[92:95], v[104:107]
    buffer_load_dwordx4 v[80:83], v219, s[36:39], s4 offen offset:2048 sc1
    v_mfma_f32_16x16x32_bf16 v[108:111], a[136:139], v[92:95], v[108:111]
    v_add_f32 v175, v175, v187
    s_waitcnt lgkmcnt(3)
    v_add_f32 v176, v176, v188
    v_mfma_f32_16x16x32_bf16 v[112:115], a[140:143], v[92:95], v[112:115]
    v_add_f32 v177, v177, v189
    v_add_f32 v178, v178, v190
    v_add_f32 v179, v179, v191
    v_mfma_f32_16x16x32_bf16 v[116:119], a[144:147], v[92:95], v[116:119]
    buffer_load_dwordx4 v[84:87], v219, s[36:39], s4 offen offset:3072 sc1
    v_mfma_f32_16x16x32_bf16 v[120:123], a[148:151], v[92:95], v[120:123]
    s_waitcnt vmcnt(9)
    ds_read_b128 v[180:183], v224 offset:15360
    ds_read_b128 v[184:187], v224 offset:16384
    v_mfma_f32_16x16x32_bf16 v[104:107], a[152:155], v[96:99], v[104:107]
    ds_read_b128 v[188:191], v224 offset:17408
    s_waitcnt lgkmcnt(5)
    v_add_f32 v168, v168, v192
    v_add_f32 v169, v169, v193
    v_mfma_f32_16x16x32_bf16 v[108:111], a[156:159], v[96:99], v[108:111]
    buffer_load_dwordx4 v[88:91], v219, s[36:39], s5 offen offset:0 sc1
    v_mfma_f32_16x16x32_bf16 v[112:115], a[160:163], v[96:99], v[112:115]
    v_add_f32 v170, v170, v194
    v_add_f32 v171, v171, v195
    v_mfma_f32_16x16x32_bf16 v[116:119], a[164:167], v[96:99], v[116:119]
    s_waitcnt lgkmcnt(4)
    v_add_f32 v172, v172, v196
    v_add_f32 v173, v173, v197
    v_mfma_f32_16x16x32_bf16 v[120:123], a[168:171], v[96:99], v[120:123]
    s_waitcnt vmcnt(9)
    buffer_load_dwordx4 v[92:95], v219, s[36:39], s5 offen offset:1024 sc1
    v_mfma_f32_16x16x32_bf16 v[104:107], a[172:175], v[100:103], v[104:107]
    v_add_f32 v174, v174, v198
    v_add_f32 v175, v175, v199
    v_mfma_f32_16x16x32_bf16 v[108:111], a[176:179], v[100:103], v[108:111]
    s_waitcnt lgkmcnt(3)
    v_add_f32 v176, v176, v200
    v_add_f32 v177, v177, v201
    v_add_f32 v178, v178, v202
    v_mfma_f32_16x16x32_bf16 v[112:115], a[180:183], v[100:103], v[112:115]
    buffer_load_dwordx4 v[96:99], v219, s[36:39], s5 offen offset:2048 sc1
    v_mfma_f32_16x16x32_bf16 v[116:119], a[184:187], v[100:103], v[116:119]
    v_add_f32 v179, v179, v203
    s_waitcnt lgkmcnt(2)
    v_add_f32 v168, v168, v180
    v_mfma_f32_16x16x32_bf16 v[120:123], a[188:191], v[100:103], v[120:123]
    s_waitcnt vmcnt(10)
    v_add_f32 v169, v169, v181
    v_add_f32 v170, v170, v182
    v_add_f32 v171, v171, v183
    v_mfma_f32_16x16x32_bf16 v[8:11], a[240:243], v[56:59], 0
    buffer_load_dwordx4 v[100:103], v219, s[36:39], s5 offen offset:3072 sc1
    v_mfma_f32_16x16x32_bf16 v[12:15], a[244:247], v[56:59], 0
    s_waitcnt lgkmcnt(1)
    v_add_f32 v172, v172, v184
    v_add_f32 v173, v173, v185
    v_mfma_f32_16x16x32_bf16 v[16:19], a[248:251], v[56:59], 0
    v_add_f32 v174, v174, v186
    v_add_f32 v175, v175, v187
    v_mfma_f32_16x16x32_bf16 v[20:23], a[252:255], v[56:59], 0
    ds_write_b128 v222, v[104:107] offset:0
    s_waitcnt lgkmcnt(1)
    v_add_f32 v176, v176, v188
    v_add_f32 v177, v177, v189
    v_mfma_f32_16x16x32_bf16 v[24:27], v[136:139], v[56:59], 0
    s_waitcnt vmcnt(10)
    v_add_f32 v178, v178, v190
    v_add_f32 v179, v179, v191
    v_fma_f32 v204, v168, v48, v204
    v_mfma_f32_16x16x32_bf16 v[8:11], v[140:143], v[60:63], v[8:11]
    ds_write_b128 v222, v[108:111] offset:1024
    v_fma_f32 v205, v169, v49, v205
    v_fma_f32 v206, v170, v50, v206
    v_mfma_f32_16x16x32_bf16 v[12:15], v[144:147], v[60:63], v[12:15]
    v_fma_f32 v207, v171, v51, v207
    v_fma_f32 v208, v172, v52, v208
    v_mfma_f32_16x16x32_bf16 v[16:19], v[148:151], v[60:63], v[16:19]
    ds_write_b128 v222, v[112:115] offset:2048
    v_fma_f32 v209, v173, v53, v209
    v_fma_f32 v210, v174, v54, v210
    v_mfma_f32_16x16x32_bf16 v[20:23], v[152:155], v[60:63], v[20:23]
    v_fma_f32 v211, v175, v55, v211
    v_fma_f32 v212, v176, v124, v212
    v_mfma_f32_16x16x32_bf16 v[24:27], v[156:159], v[60:63], v[24:27]
    s_waitcnt vmcnt(9)
    ds_write_b128 v222, v[116:119] offset:3072
    v_fma_f32 v213, v177, v125, v213
    v_fma_f32 v214, v178, v126, v214
    v_mfma_f32_16x16x32_bf16 v[8:11], v[160:163], v[64:67], v[8:11]
    v_fma_f32 v215, v179, v127, v215
    v_cvt_pk_bf16_f32 v180, v204, v205
    v_mfma_f32_16x16x32_bf16 v[12:15], v[164:167], v[64:67], v[12:15]
    v_cvt_pk_bf16_f32 v181, v206, v207
    v_cvt_pk_bf16_f32 v182, v208, v209
    v_mfma_f32_16x16x32_bf16 v[16:19], a[0:3], v[64:67], v[16:19]
    v_cvt_pk_bf16_f32 v183, v210, v211
    v_cvt_pk_bf16_f32 v184, v212, v213
    v_mfma_f32_16x16x32_bf16 v[20:23], a[4:7], v[64:67], v[20:23]
    ds_write_b128 v222, v[120:123] offset:4096
    v_cvt_pk_bf16_f32 v185, v214, v215
    v_mfma_f32_16x16x32_bf16 v[24:27], a[8:11], v[64:67], v[24:27]
    s_waitcnt vmcnt(8)
    v_permlane16_swap_b32 v180, v182
    v_mfma_f32_16x16x32_bf16 v[8:11], a[12:15], v[68:71], v[8:11]
    v_permlane16_swap_b32 v181, v183
    v_mfma_f32_16x16x32_bf16 v[12:15], a[16:19], v[68:71], v[12:15]
    buffer_store_dwordx4 v[180:183], v227, s[40:43], s13 offen nt
    v_mfma_f32_16x16x32_bf16 v[16:19], a[20:23], v[68:71], v[16:19]
    buffer_store_dwordx2 v[184:185], v228, s[40:43], s13 offen offset:64 nt
    v_mfma_f32_16x16x32_bf16 v[20:23], a[24:27], v[68:71], v[20:23]
    v_mfma_f32_16x16x32_bf16 v[24:27], a[28:31], v[68:71], v[24:27]
    s_waitcnt vmcnt(9)
    v_mfma_f32_16x16x32_bf16 v[8:11], a[32:35], v[72:75], v[8:11]
    v_mfma_f32_16x16x32_bf16 v[12:15], a[36:39], v[72:75], v[12:15]
    s_waitcnt lgkmcnt(0)
    s_barrier
    ds_read_b128 v[168:171], v225 offset:0
    v_mfma_f32_16x16x32_bf16 v[16:19], a[40:43], v[72:75], v[16:19]
    ds_read_b128 v[172:175], v225 offset:1024
    v_mfma_f32_16x16x32_bf16 v[20:23], a[44:47], v[72:75], v[20:23]
    ds_read_b128 v[176:179], v225 offset:2048
    v_mfma_f32_16x16x32_bf16 v[24:27], a[48:51], v[72:75], v[24:27]
    s_waitcnt vmcnt(8)
    ds_read_b128 v[192:195], v225 offset:10240
    v_mfma_f32_16x16x32_bf16 v[8:11], a[52:55], v[76:79], v[8:11]
    ds_read_b128 v[196:199], v225 offset:11264
    v_mfma_f32_16x16x32_bf16 v[12:15], a[56:59], v[76:79], v[12:15]
    ds_read_b128 v[200:203], v225 offset:12288
    v_mfma_f32_16x16x32_bf16 v[16:19], a[60:63], v[76:79], v[16:19]
    v_mfma_f32_16x16x32_bf16 v[20:23], a[64:67], v[76:79], v[20:23]
    v_mfma_f32_16x16x32_bf16 v[24:27], a[68:71], v[76:79], v[24:27]
    s_waitcnt vmcnt(7)
    v_mfma_f32_16x16x32_bf16 v[8:11], a[72:75], v[80:83], v[8:11]
    v_mfma_f32_16x16x32_bf16 v[12:15], a[76:79], v[80:83], v[12:15]
    v_mfma_f32_16x16x32_bf16 v[16:19], a[80:83], v[80:83], v[16:19]
    v_mfma_f32_16x16x32_bf16 v[20:23], a[84:87], v[80:83], v[20:23]
    s_waitcnt lgkmcnt(2)
    v_add_f32 v168, v168, v192
    v_add_f32 v169, v169, v193
    v_mfma_f32_16x16x32_bf16 v[24:27], a[88:91], v[80:83], v[24:27]
    s_waitcnt vmcnt(6)
    v_add_f32 v170, v170, v194
    v_add_f32 v171, v171, v195
    v_mfma_f32_16x16x32_bf16 v[8:11], a[92:95], v[84:87], v[8:11]
    s_waitcnt lgkmcnt(1)
    v_add_f32 v172, v172, v196
    v_add_f32 v173, v173, v197
    v_mfma_f32_16x16x32_bf16 v[12:15], a[96:99], v[84:87], v[12:15]
    v_add_f32 v174, v174, v198
    v_add_f32 v175, v175, v199
    v_mfma_f32_16x16x32_bf16 v[16:19], a[100:103], v[84:87], v[16:19]
    s_waitcnt lgkmcnt(0)
    v_add_f32 v176, v176, v200
    v_add_f32 v177, v177, v201
    v_mfma_f32_16x16x32_bf16 v[20:23], a[104:107], v[84:87], v[20:23]
    v_add_f32 v178, v178, v202
    v_add_f32 v179, v179, v203
    v_mfma_f32_16x16x32_bf16 v[24:27], a[108:111], v[84:87], v[24:27]
    s_waitcnt vmcnt(5)
    v_fma_f32 v232, v168, v48, v232
    v_fma_f32 v233, v169, v49, v233
    v_mfma_f32_16x16x32_bf16 v[8:11], a[112:115], v[88:91], v[8:11]
    v_fma_f32 v234, v170, v50, v234
    v_fma_f32 v235, v171, v51, v235
    v_mfma_f32_16x16x32_bf16 v[12:15], a[116:119], v[88:91], v[12:15]
    v_fma_f32 v236, v172, v52, v236
    v_fma_f32 v237, v173, v53, v237
    v_mfma_f32_16x16x32_bf16 v[16:19], a[120:123], v[88:91], v[16:19]
    v_fma_f32 v238, v174, v54, v238
    v_fma_f32 v239, v175, v55, v239
    v_mfma_f32_16x16x32_bf16 v[20:23], a[124:127], v[88:91], v[20:23]
    v_fma_f32 v240, v176, v124, v240
    v_fma_f32 v241, v177, v125, v241
    v_mfma_f32_16x16x32_bf16 v[24:27], a[128:131], v[88:91], v[24:27]
    s_waitcnt vmcnt(4)
    v_fma_f32 v242, v178, v126, v242
    v_fma_f32 v243, v179, v127, v243
    v_mfma_f32_16x16x32_bf16 v[8:11], a[132:135], v[92:95], v[8:11]
    v_mfma_f32_16x16x32_bf16 v[12:15], a[136:139], v[92:95], v[12:15]
    v_mfma_f32_16x16x32_bf16 v[16:19], a[140:143], v[92:95], v[16:19]
    v_mfma_f32_16x16x32_bf16 v[20:23], a[144:147], v[92:95], v[20:23]
    v_mfma_f32_16x16x32_bf16 v[24:27], a[148:151], v[92:95], v[24:27]
    s_waitcnt vmcnt(3)
    v_mfma_f32_16x16x32_bf16 v[8:11], a[152:155], v[96:99], v[8:11]
    v_mfma_f32_16x16x32_bf16 v[12:15], a[156:159], v[96:99], v[12:15]
    v_mfma_f32_16x16x32_bf16 v[16:19], a[160:163], v[96:99], v[16:19]
    v_mfma_f32_16x16x32_bf16 v[20:23], a[164:167], v[96:99], v[20:23]
    v_mfma_f32_16x16x32_bf16 v[24:27], a[168:171], v[96:99], v[24:27]
    s_waitcnt vmcnt(2)
    v_mfma_f32_16x16x32_bf16 v[8:11], a[172:175], v[100:103], v[8:11]
    v_mfma_f32_16x16x32_bf16 v[12:15], a[176:179], v[100:103], v[12:15]
    v_mfma_f32_16x16x32_bf16 v[16:19], a[180:183], v[100:103], v[16:19]
    v_mfma_f32_16x16x32_bf16 v[20:23], a[184:187], v[100:103], v[20:23]
    v_mfma_f32_16x16x32_bf16 v[24:27], a[188:191], v[100:103], v[24:27]
    s_nop 3
    ds_write_b128 v223, v[8:11] offset:0
    ds_write_b128 v223, v[12:15] offset:1024
    ds_write_b128 v223, v[16:19] offset:2048
    ds_write_b128 v223, v[20:23] offset:3072
    ds_write_b128 v223, v[24:27] offset:4096
    s_waitcnt lgkmcnt(0)
    s_barrier
    ds_read_b128 v[168:171], v226 offset:0
    ds_read_b128 v[172:175], v226 offset:1024
    ds_read_b128 v[176:179], v226 offset:2048
    ds_read_b128 v[180:183], v226 offset:10240
    ds_read_b128 v[184:187], v226 offset:11264
    ds_read_b128 v[188:191], v226 offset:12288
    s_waitcnt lgkmcnt(2)
    v_pk_add_f32 v[168:169], v[168:169], v[180:181]
    v_pk_add_f32 v[170:171], v[170:171], v[182:183]
    s_waitcnt lgkmcnt(1)
    v_pk_add_f32 v[172:173], v[172:173], v[184:185]
    v_pk_add_f32 v[174:175], v[174:175], v[186:187]
    s_waitcnt lgkmcnt(0)
    v_pk_add_f32 v[176:177], v[176:177], v[188:189]
    v_pk_add_f32 v[178:179], v[178:179], v[190:191]
    v_pk_fma_f32 v[232:233], v[168:169], v[48:49], v[232:233]
    v_pk_fma_f32 v[234:235], v[170:171], v[50:51], v[234:235]
    v_pk_fma_f32 v[236:237], v[172:173], v[52:53], v[236:237]
    v_pk_fma_f32 v[238:239], v[174:175], v[54:55], v[238:239]
    v_pk_fma_f32 v[240:241], v[176:177], v[124:125], v[240:241]
    v_pk_fma_f32 v[242:243], v[178:179], v[126:127], v[242:243]
    v_cvt_pk_bf16_f32 v168, v232, v233
    v_cvt_pk_bf16_f32 v169, v234, v235
    v_cvt_pk_bf16_f32 v170, v236, v237
    v_cvt_pk_bf16_f32 v171, v238, v239
    v_cvt_pk_bf16_f32 v172, v240, v241
    v_cvt_pk_bf16_f32 v173, v242, v243
    v_permlane16_swap_b32 v168, v170
    v_permlane16_swap_b32 v169, v171
    buffer_store_dwordx4 v[168:171], v227, s[40:43], s14 offen nt
    buffer_store_dwordx2 v[172:173], v228, s[40:43], s14 offen offset:64 nt
    s_endpgm
L_end:
    s_endpgm
L_m_slow:
    buffer_load_dwordx2 v[232:233], v253, s[36:39], s55 offen sc1
    s_waitcnt vmcnt(0)
    v_cmp_ne_u32 vcc, s48, v233
    s_cbranch_vccz L_m_back
    s_cmp_eq_u32 s49, 0
    s_cbranch_scc1 L_m_back
    s_sub_u32 s49, s49, 1
    s_sleep 1
    s_branch L_m_slow
L_stc0_slow:
    s_add_u32 m0, s63, 1024
    s_nop 0
    buffer_load_dwordx4 v248, s[36:39], s6 offen sc1 lds
    s_waitcnt vmcnt(0)
    ds_read_b128 v[200:203], v175 offset:1024
    ds_read_b128 v[204:207], v175 offset:1280
    ds_read_b128 v[208:211], v175 offset:1536
    ds_read_b128 v[212:215], v175 offset:1792
    s_waitcnt lgkmcnt(3)
    v_xor_b32 v3, s48, v201
    v_bitop3_b32 v3, v203, s48, v3 bitop3:0xbe
    s_waitcnt lgkmcnt(2)
    v_bitop3_b32 v3, v205, s48, v3 bitop3:0xbe
    v_bitop3_b32 v3, v207, s48, v3 bitop3:0xbe
    s_waitcnt lgkmcnt(1)
    v_bitop3_b32 v3, v209, s48, v3 bitop3:0xbe
    v_bitop3_b32 v3, v211, s48, v3 bitop3:0xbe
    s_waitcnt lgkmcnt(0)
    v_bitop3_b32 v3, v213, s48, v3 bitop3:0xbe
    v_bitop3_b32 v3, v215, s48, v3 bitop3:0xbe
    v_cmp_ne_u32 vcc, 0, v3
    s_cbranch_vccz L_stc0_back
    s_cmp_eq_u32 s49, 0
    s_cbranch_scc1 L_stc0_back
    s_sub_u32 s49, s49, 1
    s_branch L_stc0_slow
L_stc1_slow:
    s_add_u32 m0, s63, 1024
    s_nop 0
    buffer_load_dwordx4 v248, s[36:39], s6 offen sc1 lds
    s_waitcnt vmcnt(0)
    ds_read_b128 v[200:203], v175 offset:1024
    ds_read_b128 v[204:207], v175 offset:1280
    ds_read_b128 v[208:211], v175 offset:1536
    ds_read_b128 v[212:215], v175 offset:1792
    s_waitcnt lgkmcnt(3)
    v_xor_b32 v3, s48, v201
    v_bitop3_b32 v3, v203, s48, v3 bitop3:0xbe
    s_waitcnt lgkmcnt(2)
    v_bitop3_b32 v3, v205, s48, v3 bitop3:0xbe
    v_bitop3_b32 v3, v207, s48, v3 bitop3:0xbe
    s_waitcnt lgkmcnt(1)
    v_bitop3_b32 v3, v209, s48, v3 bitop3:0xbe
    v_bitop3_b32 v3, v211, s48, v3 bitop3:0xbe
    s_waitcnt lgkmcnt(0)
    v_bitop3_b32 v3, v213, s48, v3 bitop3:0xbe
    v_bitop3_b32 v3, v215, s48, v3 bitop3:0xbe
    v_cmp_ne_u32 vcc, 0, v3
    s_cbranch_vccz L_stc1_back
    s_cmp_eq_u32 s49, 0
    s_cbranch_scc1 L_stc1_back
    s_sub_u32 s49, s49, 1
    s_branch L_stc1_slow
L_stp0_slow:
    s_add_u32 m0, s63, 1024
    s_nop 0
    buffer_load_dwordx4 v248, s[36:39], s6 offen sc1 lds
    s_waitcnt vmcnt(0)
    ds_read_b128 v[200:203], v175 offset:1024
    ds_read_b128 v[204:207], v175 offset:1280
    ds_read_b128 v[208:211], v175 offset:1536
    ds_read_b128 v[212:215], v175 offset:1792
    s_waitcnt lgkmcnt(3)
    v_xor_b32 v3, s48, v201
    v_bitop3_b32 v3, v203, s48, v3 bitop3:0xbe
    s_waitcnt lgkmcnt(2)
    v_bitop3_b32 v3, v205, s48, v3 bitop3:0xbe
    v_bitop3_b32 v3, v207, s48, v3 bitop3:0xbe
    s_waitcnt lgkmcnt(1)
    v_bitop3_b32 v3, v209, s48, v3 bitop3:0xbe
    v_bitop3_b32 v3, v211, s48, v3 bitop3:0xbe
    s_waitcnt lgkmcnt(0)
    v_bitop3_b32 v3, v213, s48, v3 bitop3:0xbe
    v_bitop3_b32 v3, v215, s48, v3 bitop3:0xbe
    v_cmp_ne_u32 vcc, 0, v3
    s_cbranch_vccz L_stp0_back
    s_cmp_eq_u32 s49, 0
    s_cbranch_scc1 L_stp0_back
    s_sub_u32 s49, s49, 1
    s_branch L_stp0_slow
L_stp1_slow:
    s_add_u32 m0, s63, 1024
    s_nop 0
    buffer_load_dwordx4 v248, s[36:39], s6 offen sc1 lds
    s_waitcnt vmcnt(0)
    ds_read_b128 v[200:203], v175 offset:1024
    ds_read_b128 v[204:207], v175 offset:1280
    ds_read_b128 v[208:211], v175 offset:1536
    ds_read_b128 v[212:215], v175 offset:1792
    s_waitcnt lgkmcnt(3)
    v_xor_b32 v3, s48, v201
    v_bitop3_b32 v3, v203, s48, v3 bitop3:0xbe
    s_waitcnt lgkmcnt(2)
    v_bitop3_b32 v3, v205, s48, v3 bitop3:0xbe
    v_bitop3_b32 v3, v207, s48, v3 bitop3:0xbe
    s_waitcnt lgkmcnt(1)
    v_bitop3_b32 v3, v209, s48, v3 bitop3:0xbe
    v_bitop3_b32 v3, v211, s48, v3 bitop3:0xbe
    s_waitcnt lgkmcnt(0)
    v_bitop3_b32 v3, v213, s48, v3 bitop3:0xbe
    v_bitop3_b32 v3, v215, s48, v3 bitop3:0xbe
    v_cmp_ne_u32 vcc, 0, v3
    s_cbranch_vccz L_stp1_back
    s_cmp_eq_u32 s49, 0
    s_cbranch_scc1 L_stp1_back
    s_sub_u32 s49, s49, 1
    s_branch L_stp1_slow
L_chk4_slow:
L_poll31:
    buffer_load_dword v243, v240, s[36:39], s69 offen sc1
    s_waitcnt vmcnt(0)
    v_cmp_ne_u32 vcc, s48, v243
    s_cbranch_vccz L_poll31_ok
    s_cmp_eq_u32 s49, 0
    s_cbranch_scc1 L_poll31_ok
    s_sub_u32 s49, s49, 1
    s_sleep 1
    s_branch L_poll31
L_poll31_ok:
    s_branch L_chk4_back
L_chk6_slow:
L_poll32:
    buffer_load_dword v243, v241, s[36:39], s60 offen sc1
    s_waitcnt vmcnt(0)
    v_cmp_ne_u32 vcc, s48, v243
    s_cbranch_vccz L_poll32_ok
    s_cmp_eq_u32 s49, 0
    s_cbranch_scc1 L_poll32_ok
    s_sub_u32 s49, s49, 1
    s_sleep 1
    s_branch L_poll32
L_poll32_ok:
    s_branch L_chk6_back
L_chk7_slow:
L_poll33:
    buffer_load_dword v223, v219, s[36:39], s17 offen sc1
    s_waitcnt vmcnt(0)
    v_cmp_ne_u32 vcc, s48, v223
    s_cbranch_vccz L_poll33_ok
    s_cmp_eq_u32 s49, 0
    s_cbranch_scc1 L_poll33_ok
    s_sub_u32 s49, s49, 1
    s_sleep 1
    s_branch L_poll33
L_poll33_ok:
    s_branch L_chk7_back
L_chk9_slow:
L_poll34:
    buffer_load_dword v244, v243, s[36:39], s58 offen sc1
    s_waitcnt vmcnt(0)
    v_cmp_ne_u32 vcc, s48, v244
    s_cbranch_vccz L_poll34_ok
    s_cmp_eq_u32 s49, 0
    s_cbranch_scc1 L_poll34_ok
    s_sub_u32 s49, s49, 1
    s_sleep 1
    s_branch L_poll34
L_poll34_ok:
    s_branch L_chk9_back
L_chk10_slow:
L_poll35:
    buffer_load_dword v240, v219, s[36:39], s17 offen sc1
    s_waitcnt vmcnt(0)
    v_cmp_ne_u32 vcc, s48, v240
    s_cbranch_vccz L_poll35_ok
    s_cmp_eq_u32 s49, 0
    s_cbranch_scc1 L_poll35_ok
    s_sub_u32 s49, s49, 1
    s_sleep 1
    s_branch L_poll35
L_poll35_ok:
    s_branch L_chk10_back
L_chk12_slow:
L_poll36:
    buffer_load_dword v247, v246, s[36:39], s17 offen sc1
    s_waitcnt vmcnt(0)
    v_cmp_ne_u32 vcc, s48, v247
    s_cbranch_vccz L_poll36_ok
    s_cmp_eq_u32 s49, 0
    s_cbranch_scc1 L_poll36_ok
    s_sub_u32 s49, s49, 1
    s_sleep 1
    s_branch L_poll36
L_poll36_ok:
    s_branch L_chk12_back
L_chk14_slow:
L_poll37:
    buffer_load_dword v247, v246, s[36:39], s17 offen sc1
    s_waitcnt vmcnt(0)
    v_cmp_ne_u32 vcc, s48, v247
    s_cbranch_vccz L_poll37_ok
    s_cmp_eq_u32 s49, 0
    s_cbranch_scc1 L_poll37_ok
    s_sub_u32 s49, s49, 1
    s_sleep 1
    s_branch L_poll37
L_poll37_ok:
    s_branch L_chk14_back
L_chk20_slow:
L_poll38:
    buffer_load_dword v241, v240, s[36:39], s66 offen sc1
    s_waitcnt vmcnt(0)
    v_cmp_ne_u32 vcc, s48, v241
    s_cbranch_vccz L_poll38_ok
    s_cmp_eq_u32 s49, 0
    s_cbranch_scc1 L_poll38_ok
    s_sub_u32 s49, s49, 1
    s_sleep 1
    s_branch L_poll38
L_poll38_ok:
    s_branch L_chk20_back
L_chk25_slow:
L_poll39:
    buffer_load_dword v244, v243, s[36:39], s58 offen sc1
    s_waitcnt vmcnt(0)
    v_cmp_ne_u32 vcc, s48, v244
    s_cbranch_vccz L_poll39_ok
    s_cmp_eq_u32 s49, 0
    s_cbranch_scc1 L_poll39_ok
    s_sub_u32 s49, s49, 1
    s_sleep 1
    s_branch L_poll39
L_poll39_ok:
    s_branch L_chk25_back
L_chk26_slow:
L_poll40:
    buffer_load_dword v240, v219, s[36:39], s17 offen sc1
    s_waitcnt vmcnt(0)
    v_cmp_ne_u32 vcc, s48, v240
    s_cbranch_vccz L_poll40_ok
    s_cmp_eq_u32 s49, 0
    s_cbranch_scc1 L_poll40_ok
    s_sub_u32 s49, s49, 1
    s_sleep 1
    s_branch L_poll40
L_poll40_ok:
    s_branch L_chk26_back
L_chk28_slow:
L_poll41:
    buffer_load_dword v247, v246, s[36:39], s17 offen sc1
    s_waitcnt vmcnt(0)
    v_cmp_ne_u32 vcc, s48, v247
    s_cbranch_vccz L_poll41_ok
    s_cmp_eq_u32 s49, 0
    s_cbranch_scc1 L_poll41_ok
    s_sub_u32 s49, s49, 1
    s_sleep 1
    s_branch L_poll41
L_poll41_ok:
    s_branch L_chk28_back
L_chk30_slow:
L_poll42:
    buffer_load_dword v247, v246, s[36:39], s17 offen sc1
    s_waitcnt vmcnt(0)
    v_cmp_ne_u32 vcc, s48, v247
    s_cbranch_vccz L_poll42_ok
    s_cmp_eq_u32 s49, 0
    s_cbranch_scc1 L_poll42_ok
    s_sub_u32 s49, s49, 1
    s_sleep 1
    s_branch L_poll42
L_poll42_ok:
    s_branch L_chk30_back
L_code_end:
.if L_code_end-L_pc0 > 98304
.error "the code prefetch does not cover the kernel"
.endif
.section .rodata,"a"
.p2align 6
.amdhsa_kernel adaLN_cond__ssm_conv_h3__glu_gated_bilinear__prompt_kernel
  .amdhsa_next_free_vgpr 512
  .amdhsa_next_free_sgpr 102
  .amdhsa_accum_offset 256
  .amdhsa_group_segment_fixed_size 0
  .amdhsa_kernarg_size 120
  .amdhsa_user_sgpr_count 2
  .amdhsa_user_sgpr_kernarg_segment_ptr 1
  .amdhsa_system_sgpr_workgroup_id_x 1
.end_amdhsa_kernel
```

```asm
; @launch grid=(256,1,1) block=(256,1,1) lds=163840
.amdgcn_target "amdgcn-amd-amdhsa--gfx950"
.text
.globl adaLN_cond__ssm_conv_h3__glu_gated_bilinear__prompt_kernel
.p2align 8
.type adaLN_cond__ssm_conv_h3__glu_gated_bilinear__prompt_kernel,@function
adaLN_cond__ssm_conv_h3__glu_gated_bilinear__prompt_kernel:
    s_load_dwordx16 s[4:19], s[0:1], 0
    s_load_dwordx8 s[20:27], s[0:1], 64
    s_load_dwordx4 s[28:31], s[0:1], 96
    s_load_dwordx2 s[32:33], s[0:1], 112
    s_cmp_ge_u32 s2, 256
    s_cbranch_scc1 L_end
    v_lshrrev_b32 v1, 6, v0
    s_lshr_b32 s51, s2, 3
    s_mov_b32 s43, 0x20000
    v_readfirstlane_b32 s3, v1
    v_and_b32 v1, 63, v0
    s_and_b32 s50, s2, 7
    s_mov_b32 s47, s43
    s_sub_u32 s71, s2, 160
    s_cbranch_scc0 L_e_prep
    s_mul_i32 s52, s50, 327680
    s_lshl_b32 s53, s51, 7
    s_add_u32 s52, s52, s53
    s_cmp_ge_u32 s51, 10
    s_cselect_b32 s53, 162560, 0
    s_add_u32 s52, s52, s53
    v_lshrrev_b32 v3, 3, v1
    v_mul_u32_u24 v3, 1280, v3
    v_and_b32 v4, 7, v1
    v_lshl_add_u32 v3, v4, 4, v3
    s_mul_i32 s53, s3, 40960
    s_add_u32 s53, s53, s52
    s_mul_i32 s54, s3, 4352
    s_movk_i32 s55, 9152
    v_add_u32 v10, s55, v3
    v_add_u32 v11, s55, v10
    v_add_u32 v12, s55, v11
    s_add_u32 m0, s54, 26624
    s_mov_b32 s42, 2621440
    s_mov_b32 s46, s42
    s_waitcnt lgkmcnt(0)
    s_mov_b64 s[40:41], s[6:7]
    s_mov_b64 s[44:45], s[8:9]
    buffer_load_dwordx4 v3, s[40:43], s53 offen offset:0 nt lds
    buffer_load_dwordx4 v10, s[40:43], s53 offen offset:1088 nt lds
    buffer_load_dwordx4 v11, s[40:43], s53 offen offset:2176 nt lds
    buffer_load_dwordx4 v12, s[40:43], s53 offen offset:3264 nt lds
    s_add_u32 m0, s54, 44032
    s_sub_u32 s55, s52, 10240
    buffer_load_dwordx4 v3, s[44:47], s53 offen offset:0 nt lds
    buffer_load_dwordx4 v10, s[44:47], s53 offen offset:1088 nt lds
    buffer_load_dwordx4 v11, s[44:47], s53 offen offset:2176 nt lds
    buffer_load_dwordx4 v12, s[44:47], s53 offen offset:3264 nt lds
    v_add_u32 v5, s55, v3
    s_cmp_eq_u32 s3, 0
    s_cbranch_scc0 L_nohalo
    s_mov_b32 m0, 25536
    s_nop 0
    buffer_load_dwordx4 v5, s[40:43], 0 offen nt lds
L_nohalo:
    s_cmp_ge_u32 s51, 10
    s_cselect_b32 s55, 10, 0
    s_sub_u32 s55, s51, s55
    s_lshl_b32 s55, s55, 1
    s_and_b32 s56, s3, 1
    s_add_u32 s55, s55, s56
    s_lshl_b32 s55, s55, 8
    v_lshl_add_u32 v8, v4, 5, s55
    global_load_dwordx4 v[48:51], v8, s[10:11]
    global_load_dwordx4 v[52:55], v8, s[10:11] offset:16
    s_mov_b32 s36, s32
    s_mov_b32 s37, s33
    s_mov_b32 s38, 0x10000000
    s_mov_b32 s39, 0x20000
    v_mov_b32 v2, 0
    s_mov_b32 s57, 23461888
    buffer_load_dword v246, v2, s[36:39], s57 offen sc1
    s_branch L_conv
L_e_prep:
    s_getpc_b64 s[40:41]
L_pc0:
    s_sub_u32 s52, s51, 20
    s_mov_b32 s42, L_code_end-L_pc0
    v_lshrrev_b32 v2, 2, v0
    s_lshl_b32 s52, s52, 13
    v_lshlrev_b32 v2, 7, v2
    buffer_load_dword v252, v2, s[40:43], s52 offen
    s_cmp_ge_u32 s71, 60
    s_cbranch_scc1 L_e_q
    s_sub_u32 s52, s71, 30
    s_sub_u32 s77, 79, s71
    s_cmp_lt_u32 s52, 20
    s_cselect_b32 s77, s77, s71
    v_lshrrev_b32 v8, 3, v0
    v_mul_u32_u24 v9, 153600, v8
    v_and_b32 v8, 7, v0
    v_lshl_add_u32 v9, v8, 4, v9
    s_lshl_b32 s56, s77, 7
    s_movk_i32 s68, 7680
    s_mov_b32 s46, 4915200
    s_waitcnt lgkmcnt(0)
    s_mov_b64 s[44:45], s[26:27]
    v_lshrrev_b32 v2, 3, v0
    v_mul_u32_u24 v3, 40, v2
    global_load_dwordx2 v[80:81], v3, s[24:25] offset:0
    global_load_dwordx2 v[82:83], v3, s[24:25] offset:8
    global_load_dwordx2 v[84:85], v3, s[24:25] offset:16
    global_load_dwordx2 v[86:87], v3, s[24:25] offset:24
    global_load_dwordx2 v[88:89], v3, s[24:25] offset:32
    s_branch L_prep
L_e_q:
    s_lshr_b32 s53, s50, 2
    s_xor_b32 s53, s53, s51
    s_and_b32 s53, s53, 1
    s_xor_b32 s76, s53, 1
    s_cmp_ge_u32 s71, 64
    s_cselect_b32 s65, s76, 0
    s_cselect_b32 s53, s53, 0
    s_lshl_b32 s50, s50, 2
    s_lshr_b32 s51, s2, 3
    s_and_b32 s51, s51, 3
    s_add_u32 s77, s50, s51
    s_cmp_lt_u32 s71, 64
    s_waitcnt lgkmcnt(0)
    s_cbranch_scc1 L_p_b
    s_branch L_p_s
L_conv:
    s_mov_b32 s49, 400000
    s_and_b32 s50, s2, 7
    s_lshr_b32 s51, s2, 3
    s_lshr_b32 s60, s50, 2
    s_lshl_b32 s60, s60, 3
    s_lshr_b32 s61, s51, 2
    s_add_u32 s72, s60, s61
    s_lshl_b32 s61, s61, 3
    s_mov_b32 s62, 0x6040200
    s_mov_b32 s63, 0x70308
    s_lshr_b64 s[62:63], s[62:63], s61
    s_and_b32 s34, s62, 255
    s_lshr_b32 s62, s50, 2
    s_mul_i32 s62, s62, 10
    s_add_u32 s34, s34, s62
    s_sub_u32 s62, s34, 20
    s_min_u32 s34, s34, s62
    s_and_b32 s60, s50, 3
    s_lshl_b32 s60, s60, 2
    s_and_b32 s61, s51, 3
    s_add_u32 s73, s60, s61
    s_and_b32 s75, s51, 7
    s_lshr_b32 s61, s51, 3
    s_lshl_b32 s60, s50, 2
    s_add_u32 s74, s60, s61
    s_mul_i32 s70, s50, 20
    s_add_u32 s70, s70, s51
    s_lshl_b32 s60, s50, 1
    s_cmp_ge_u32 s51, 10
    s_addc_u32 s60, s60, 0
    s_cmp_ge_u32 s51, 10
    s_cselect_b32 s61, 10, 0
    s_sub_u32 s61, s51, s61
    s_lshl_b32 s61, s61, 4
    s_add_u32 s76, s60, s61
    s_lshl_b32 s58, s70, 2
    s_add_u32 s58, s58, s3
    v_lshlrev_b32 v248, 4, v1
    s_add_u32 m0, s54, 61440
    s_mov_b64 s[44:45], s[4:5]
    buffer_load_dwordx4 v3, s[44:47], s53 offen offset:0 nt lds
    buffer_load_dwordx4 v10, s[44:47], s53 offen offset:1088 nt lds
    buffer_load_dwordx4 v11, s[44:47], s53 offen offset:2176 nt lds
    buffer_load_dwordx4 v12, s[44:47], s53 offen offset:3264 nt lds
    s_lshr_b32 s50, s76, 4
    s_and_b32 s51, s76, 15
    s_lshr_b32 s55, s3, 1
    s_and_b32 s56, s3, 1
    s_lshl_b32 s51, s51, 7
    s_lshl_b32 s57, s55, 6
    s_add_u32 s51, s51, s57
    s_lshl_b32 s50, s50, 6
    s_lshl_b32 s57, s56, 5
    s_add_u32 s50, s50, s57
    v_lshrrev_b32 v5, 3, v1
    v_lshl_add_u32 v6, v5, 3, s51
    v_lshl_add_u32 v7, v4, 2, s50
    v_mul_u32_u24 v7, 4096, v7
    v_lshl_add_u32 v245, v6, 1, v7
    v_sub_u32 v6, 2040, v6
    v_lshl_add_u32 v247, v6, 1, v7
    s_mul_i32 s55, s55, 8704
    s_lshl_b32 s56, s56, 6
    s_add_u32 s55, s55, s56
    s_add_u32 s55, s55, 25536
    v_mul_u32_u24 v5, 1088, v5
    v_lshl_add_u32 v5, v4, 3, v5
    v_add_u32 v244, s55, v5
    v_mov_b32 v243, v3
    s_and_b32 s50, s3, 1
    s_mul_i32 s61, s50, 3104
    s_mul_i32 s50, s50, 12288
    s_mul_i32 s64, s73, 192
    s_add_u32 s64, s64, s50
    s_mul_i32 s50, s34, 98304
    s_add_u32 s64, s64, s50
    s_cmp_ge_u32 s3, 2
    s_cselect_b32 s40, s20, s18
    s_cselect_b32 s41, s21, s19
    s_cselect_b32 s50, 6224, 0
    s_add_u32 s61, s61, s50
    s_mov_b32 s42, 1966080
    s_mov_b32 s43, 0x20000
    v_add_u32 v2, 0, v1
    v_mul_u32_u24 v3, 171, v2
    v_lshrrev_b32 v3, 11, v3
    v_mul_u32_u24 v4, 12, v3
    v_sub_u32 v4, v2, v4
    v_and_b32 v2, 12, v3
    v_add_u32 v3, v3, v2
    v_mul_u32_u24 v3, 3072, v3
    v_lshl_add_u32 v224, v4, 4, v3
    v_add_u32 v2, 64, v1
    v_mul_u32_u24 v3, 171, v2
    v_lshrrev_b32 v3, 11, v3
    v_mul_u32_u24 v4, 12, v3
    v_sub_u32 v4, v2, v4
    v_and_b32 v2, 12, v3
    v_add_u32 v3, v3, v2
    v_mul_u32_u24 v3, 3072, v3
    v_lshl_add_u32 v225, v4, 4, v3
    v_subrev_u32 v225, 1024, v225
    v_add_u32 v2, 128, v1
    v_mul_u32_u24 v3, 171, v2
    v_lshrrev_b32 v3, 11, v3
    v_mul_u32_u24 v4, 12, v3
    v_sub_u32 v4, v2, v4
    v_and_b32 v2, 12, v3
    v_add_u32 v3, v3, v2
    v_mul_u32_u24 v3, 3072, v3
    v_lshl_add_u32 v226, v4, 4, v3
    v_subrev_u32 v226, 2048, v226
    s_mul_i32 s50, s3, 48
    v_lshrrev_b32 v2, 5, v1
    v_bfe_u32 v3, v1, 2, 2
    v_lshl_add_u32 v2, v2, 2, v3
    v_mul_u32_u24 v2, 192, v2
    v_bfe_u32 v3, v1, 4, 1
    v_mul_u32_u24 v3, 3104, v3
    v_add3_u32 v2, v2, v3, s50
    v_and_b32 v3, 3, v1
    v_lshl_add_u32 v227, v3, 3, v2
    v_and_b32 v3, 1, v1
    v_lshl_add_u32 v2, v3, 3, v2
    v_bfe_u32 v3, v1, 1, 1
    v_mul_u32_u24 v3, 6224, v3
    v_add3_u32 v228, v2, v3, 32
    s_mul_i32 s51, s3, 16640
    s_add_u32 s51, s51, 78848
    v_add_u32 v223, s51, v248
    v_lshrrev_b32 v8, 1, v1
    v_mul_u32_u24 v8, 4160, v8
    v_and_b32 v4, 1, v1
    v_lshl_add_u32 v8, v4, 4, v8
    v_add_u32 v8, s51, v8
    v_mov_b32 v4, 0
    v_mov_b32 v5, 0
    v_mov_b32 v6, 0
    v_mov_b32 v7, 0
    s_mov_b64 exec, 0xff
    ds_write_b128 v8, v[4:7]
    s_mul_i32 s52, s3, 4608
    s_add_u32 s52, s52, 149504
    s_mov_b64 exec, 0x3fffffff
    v_add_u32 v8, s52, v248
    ds_write_b128 v8, v[4:7]
    s_mov_b64 exec, -1
    v_and_b32 v2, 15, v1
    v_lshrrev_b32 v8, 4, v1
    v_lshlrev_b32 v249, 6, v2
    v_lshl_add_u32 v249, v8, 4, v249
    v_add_u32 v249, 62464, v249
    v_and_b32 v231, 1, v8
    v_lshlrev_b32 v231, 9, v231
    v_lshl_add_u32 v231, v2, 5, v231
    v_lshrrev_b32 v8, 1, v8
    v_lshl_add_u32 v231, v8, 4, v231
    s_mul_i32 s68, s58, 4096
    s_add_u32 s65, s68, 2883584
    s_add_u32 s68, s68, 0
    s_lshl_b32 s66, s3, 12
    s_add_u32 s67, s66, 23068672
    s_lshl_b32 s59, s58, 1
    v_mov_b32 v250, 0
    v_mov_b32 v251, s59
    global_load_short_d16_hi v250, v251, s[14:15]
    v_min_u32 v240, 11, v1
    v_lshlrev_b32 v240, 7, v240
    s_lshr_b32 s52, s70, 4
    s_lshl_b32 s52, s52, 11
    s_add_u32 s59, s52, 23199744
    s_lshl_b32 s69, s3, 9
    s_sub_u32 s52, s52, s69
    s_add_u32 s52, s52, 153600
    v_cmp_lt_u32 vcc, 7, v1
    v_mov_b32 v241, s52
    s_nop 0
    v_cndmask_b32 v241, 0, v241, vcc
    v_add_u32 v240, v240, v241
    s_lshl_b32 s69, s3, 10
    s_add_u32 s69, s69, 23220224
    s_lshl_b32 s55, s58, 3
    s_add_u32 s55, s55, 23560192
    v_and_b32 v253, 3, v1
    v_cmp_eq_u32 vcc, 3, v253
    s_nop 1
    v_addc_co_u32 v253, vcc, 0, v253, vcc
    v_mul_u32_u24 v253, 5120, v253
    v_min_u32 v241, 9, v1
    v_lshlrev_b32 v241, 7, v241
    s_mov_b32 s60, 23230464
    v_min_u32 v242, 15, v1
    v_lshlrev_b32 v242, 7, v242
    v_and_b32 v2, 15, v1
    v_lshrrev_b32 v8, 4, v1
    v_add_u32 v4, 1, v2
    v_and_b32 v5, 3, v4
    v_sub_u32 v4, v4, v5
    v_add_u32 v4, 24, v4
    v_lshlrev_b32 v4, 1, v4
    v_mul_u32_u24 v5, 4160, v5
    v_add_u32 v4, v4, v5
    v_lshlrev_b32 v5, 4, v8
    v_sub_u32 v4, v4, v5
    s_mul_i32 s51, s3, 16640
    s_add_u32 s51, s51, 78848
    v_add_u32 v229, s51, v4
    v_lshlrev_b32 v2, 5, v2
    v_add_u32 v2, v2, v5
    s_mul_i32 s52, s3, 4608
    s_add_u32 s52, s52, 145936
    v_sub_u32 v230, s52, v2
    v_lshrrev_b32 v2, 3, v1
    v_bfe_u32 v3, v1, 4, 2
    v_lshlrev_b32 v3, 1, v3
    v_xor_b32 v3, v3, v1
    v_and_b32 v3, 7, v3
    v_mul_u32_u24 v2, 4096, v2
    v_lshl_add_u32 v172, v3, 4, v2
    v_add_u32 v172, 0, v172
    v_lshrrev_b32 v2, 2, v1
    v_lshlrev_b32 v2, 7, v2
    v_and_b32 v3, 3, v1
    v_lshl_add_u32 v2, v3, 3, v2
    v_bfe_u32 v3, v1, 3, 2
    v_xor_b32 v168, 0, v3
    v_lshl_add_u32 v168, v168, 5, v2
    v_xor_b32 v169, 1, v3
    v_lshl_add_u32 v169, v169, 5, v2
    v_xor_b32 v170, 2, v3
    v_lshl_add_u32 v170, v170, 5, v2
    v_xor_b32 v171, 3, v3
    v_lshl_add_u32 v171, v171, 5, v2
    v_and_b32 v175, 15, v1
    v_lshlrev_b32 v175, 4, v175
    v_bfe_u32 v2, v1, 4, 1
    v_lshrrev_b32 v3, 5, v1
    v_mul_u32_u24 v173, 49152, v2
    v_lshl_add_u32 v173, v3, 8, v173
    v_add_u32 v173, v173, v175
    v_lshl_add_u32 v2, v2, 1, v3
    v_mul_u32_u24 v174, 49152, v2
    v_add_u32 v174, v174, v175
    v_bfe_u32 v2, v0, 1, 2
    v_lshlrev_b32 v2, 1, v2
    s_lshr_b32 s50, s73, 1
    v_xor_b32 v2, s50, v2
    v_lshlrev_b32 v2, 4, v2
    v_lshl_add_u32 v216, v0, 7, v2
    s_and_b32 s50, s73, 1
    s_lshl_b32 s50, s50, 3
    v_add_u32 v216, s50, v216
    v_add_u32 v217, 0x8000, v216
    v_add_u32 v218, 0x10000, v216
    v_cmp_gt_u32 vcc, 128, v0
    s_nop 1
    v_cndmask_b32 v218, v217, v218, vcc
    s_lshl_b32 s50, s3, 10
    v_add_u32 v175, s50, v175
    v_lshrrev_b32 v2, 1, v1
    v_lshlrev_b32 v2, 10, v2
    v_and_b32 v3, 1, v1
    v_lshl_add_u32 v219, v3, 7, v2
    s_lshl_b32 s50, s3, 8
    s_add_u32 s50, s50, 46080
    v_add_u32 v219, s50, v219
    s_add_u32 s50, s50, 19456
    v_mov_b32 v2, s50
    v_cmp_lt_u32 vcc, 39, v1
    s_nop 1
    v_cndmask_b32 v219, v219, v2, vcc
    v_mov_b32 v3, v243
    s_lshl_b32 s50, s58, 12
    s_mul_i32 s51, s3, 16640
    s_add_u32 m0, s51, 78880
    s_mov_b32 s44, s12
    s_mov_b32 s45, s13
    s_mov_b32 s46, 0x280000
    s_mov_b32 s47, 0x20000
    buffer_load_dwordx4 v248, s[44:47], s50 offen offset:0 nt lds
    buffer_load_dwordx4 v248, s[44:47], s50 offen offset:1024 nt lds
    buffer_load_dwordx4 v248, s[44:47], s50 offen offset:2048 nt lds
    buffer_load_dwordx4 v248, s[44:47], s50 offen offset:3072 nt lds
    s_waitcnt vmcnt(11)
    v_lshlrev_b32 v104, 16, v48
    v_and_b32 v108, 0xffff0000, v48
    v_lshlrev_b32 v112, 16, v49
    v_and_b32 v116, 0xffff0000, v49
    v_lshlrev_b32 v105, 16, v50
    v_and_b32 v109, 0xffff0000, v50
    v_lshlrev_b32 v113, 16, v51
    v_and_b32 v117, 0xffff0000, v51
    s_waitcnt vmcnt(10)
    v_lshlrev_b32 v106, 16, v52
    v_and_b32 v110, 0xffff0000, v52
    v_lshlrev_b32 v114, 16, v53
    v_and_b32 v118, 0xffff0000, v53
    v_lshlrev_b32 v107, 16, v54
    v_and_b32 v111, 0xffff0000, v54
    v_lshlrev_b32 v115, 16, v55
    v_and_b32 v119, 0xffff0000, v55
    s_waitcnt vmcnt(9)
    s_barrier
    ds_read_b64 v[10:11], v244 offset:640
    ds_read_b64 v[12:13], v244 offset:768
    ds_read_b64 v[14:15], v244 offset:896
    ds_read_b64 v[16:17], v244 offset:1088
    ds_read_b64 v[18:19], v244 offset:1216
    ds_read_b64 v[20:21], v244 offset:1344
    ds_read_b64 v[22:23], v244 offset:1472
    ds_read_b64 v[24:25], v244 offset:1600
    ds_read_b64 v[26:27], v244 offset:1728
    ds_read_b64 v[28:29], v244 offset:1856
    ds_read_b64 v[30:31], v244 offset:1984
    ds_read_b64 v[32:33], v244 offset:18496
    ds_read_b64 v[34:35], v244 offset:18624
    ds_read_b64 v[36:37], v244 offset:18752
    ds_read_b64 v[38:39], v244 offset:18880
    ds_read_b64 v[40:41], v244 offset:19008
    ds_read_b64 v[42:43], v244 offset:19136
    ds_read_b64 v[44:45], v244 offset:19264
    ds_read_b64 v[46:47], v244 offset:19392
    s_waitcnt lgkmcnt(14)
    v_lshlrev_b32 v60, 16, v10
    v_and_b32 v61, 0xffff0000, v10
    v_lshlrev_b32 v62, 16, v11
    v_and_b32 v63, 0xffff0000, v11
    v_lshlrev_b32 v64, 16, v12
    v_and_b32 v65, 0xffff0000, v12
    v_lshlrev_b32 v66, 16, v13
    v_and_b32 v67, 0xffff0000, v13
    v_lshlrev_b32 v68, 16, v14
    v_and_b32 v69, 0xffff0000, v14
    v_lshlrev_b32 v70, 16, v15
    v_and_b32 v71, 0xffff0000, v15
    v_lshlrev_b32 v72, 16, v16
    v_and_b32 v73, 0xffff0000, v16
    v_lshlrev_b32 v74, 16, v17
    v_and_b32 v75, 0xffff0000, v17
    v_lshlrev_b32 v76, 16, v18
    v_and_b32 v77, 0xffff0000, v18
    v_lshlrev_b32 v78, 16, v19
    v_and_b32 v79, 0xffff0000, v19
    s_waitcnt lgkmcnt(13)
    v_lshlrev_b32 v80, 16, v20
    v_and_b32 v81, 0xffff0000, v20
    v_lshlrev_b32 v82, 16, v21
    v_and_b32 v83, 0xffff0000, v21
    s_waitcnt lgkmcnt(12)
    v_lshlrev_b32 v84, 16, v22
    v_and_b32 v85, 0xffff0000, v22
    v_lshlrev_b32 v86, 16, v23
    v_and_b32 v87, 0xffff0000, v23
    s_waitcnt lgkmcnt(11)
    v_lshlrev_b32 v88, 16, v24
    v_and_b32 v89, 0xffff0000, v24
    v_lshlrev_b32 v90, 16, v25
    v_and_b32 v91, 0xffff0000, v25
    s_waitcnt lgkmcnt(10)
    v_lshlrev_b32 v92, 16, v26
    v_and_b32 v93, 0xffff0000, v26
    v_lshlrev_b32 v94, 16, v27
    v_and_b32 v95, 0xffff0000, v27
    s_waitcnt lgkmcnt(9)
    v_lshlrev_b32 v96, 16, v28
    v_and_b32 v97, 0xffff0000, v28
    v_lshlrev_b32 v98, 16, v29
    v_and_b32 v99, 0xffff0000, v29
    s_waitcnt lgkmcnt(8)
    v_lshlrev_b32 v100, 16, v30
    v_and_b32 v101, 0xffff0000, v30
    v_lshlrev_b32 v102, 16, v31
    v_and_b32 v103, 0xffff0000, v31
    s_movk_i32 s16, 4096
    s_movk_i32 s17, 8192
    s_movk_i32 s62, 12288
    v_pk_mul_f32 v[120:121], v[60:61], v[116:117]
    v_pk_fma_f32 v[120:121], v[64:65], v[112:113], v[120:121]
    v_pk_fma_f32 v[120:121], v[68:69], v[108:109], v[120:121]
    v_pk_fma_f32 v[120:121], v[72:73], v[104:105], v[120:121]
    s_waitcnt lgkmcnt(7)
    v_lshlrev_b32 v56, 16, v32
    v_and_b32 v57, 0xffff0000, v32
    v_pk_mul_f32 v[120:121], v[120:121], v[56:57]
    v_pk_mul_f32 v[124:125], v[64:65], v[116:117]
    v_pk_fma_f32 v[124:125], v[68:69], v[112:113], v[124:125]
    v_pk_fma_f32 v[124:125], v[72:73], v[108:109], v[124:125]
    v_pk_fma_f32 v[124:125], v[76:77], v[104:105], v[124:125]
    s_waitcnt lgkmcnt(6)
    v_lshlrev_b32 v58, 16, v34
    v_and_b32 v59, 0xffff0000, v34
    v_pk_mul_f32 v[124:125], v[124:125], v[58:59]
    v_pk_mul_f32 v[128:129], v[68:69], v[116:117]
    v_pk_fma_f32 v[128:129], v[72:73], v[112:113], v[128:129]
    v_pk_fma_f32 v[128:129], v[76:77], v[108:109], v[128:129]
    v_pk_fma_f32 v[128:129], v[80:81], v[104:105], v[128:129]
    s_waitcnt lgkmcnt(5)
    v_lshlrev_b32 v56, 16, v36
    v_and_b32 v57, 0xffff0000, v36
    v_pk_mul_f32 v[128:129], v[128:129], v[56:57]
    v_pk_mul_f32 v[132:133], v[72:73], v[116:117]
    v_pk_fma_f32 v[132:133], v[76:77], v[112:113], v[132:133]
    v_pk_fma_f32 v[132:133], v[80:81], v[108:109], v[132:133]
    v_pk_fma_f32 v[132:133], v[84:85], v[104:105], v[132:133]
    s_waitcnt lgkmcnt(4)
    v_lshlrev_b32 v58, 16, v38
    v_and_b32 v59, 0xffff0000, v38
    v_pk_mul_f32 v[132:133], v[132:133], v[58:59]
    v_pk_mul_f32 v[136:137], v[76:77], v[116:117]
    v_pk_fma_f32 v[136:137], v[80:81], v[112:113], v[136:137]
    v_pk_fma_f32 v[136:137], v[84:85], v[108:109], v[136:137]
    v_pk_fma_f32 v[136:137], v[88:89], v[104:105], v[136:137]
    s_waitcnt lgkmcnt(3)
    v_lshlrev_b32 v56, 16, v40
    v_and_b32 v57, 0xffff0000, v40
    v_pk_mul_f32 v[136:137], v[136:137], v[56:57]
    v_pk_mul_f32 v[140:141], v[80:81], v[116:117]
    v_pk_fma_f32 v[140:141], v[84:85], v[112:113], v[140:141]
    v_pk_fma_f32 v[140:141], v[88:89], v[108:109], v[140:141]
    v_pk_fma_f32 v[140:141], v[92:93], v[104:105], v[140:141]
    s_waitcnt lgkmcnt(2)
    v_lshlrev_b32 v58, 16, v42
    v_and_b32 v59, 0xffff0000, v42
    v_pk_mul_f32 v[140:141], v[140:141], v[58:59]
    v_pk_mul_f32 v[144:145], v[84:85], v[116:117]
    v_pk_fma_f32 v[144:145], v[88:89], v[112:113], v[144:145]
    v_pk_fma_f32 v[144:145], v[92:93], v[108:109], v[144:145]
    v_pk_fma_f32 v[144:145], v[96:97], v[104:105], v[144:145]
    s_waitcnt lgkmcnt(1)
    v_lshlrev_b32 v56, 16, v44
    v_and_b32 v57, 0xffff0000, v44
    v_pk_mul_f32 v[144:145], v[144:145], v[56:57]
    v_pk_mul_f32 v[148:149], v[88:89], v[116:117]
    v_pk_fma_f32 v[148:149], v[92:93], v[112:113], v[148:149]
    v_pk_fma_f32 v[148:149], v[96:97], v[108:109], v[148:149]
    v_pk_fma_f32 v[148:149], v[100:101], v[104:105], v[148:149]
    s_waitcnt lgkmcnt(0)
    v_lshlrev_b32 v58, 16, v46
    v_and_b32 v59, 0xffff0000, v46
    v_pk_mul_f32 v[148:149], v[148:149], v[58:59]
    v_cvt_pk_bf16_f32 v152, v148, v144
    v_cvt_pk_bf16_f32 v153, v140, v136
    v_cvt_pk_bf16_f32 v154, v132, v128
    v_cvt_pk_bf16_f32 v155, v124, v120
    buffer_store_dwordx4 v[152:155], v247, s[36:39], 0 offen sc1
    v_cvt_pk_bf16_f32 v156, v149, v145
    v_cvt_pk_bf16_f32 v157, v141, v137
    v_cvt_pk_bf16_f32 v158, v133, v129
    v_cvt_pk_bf16_f32 v159, v125, v121
    buffer_store_dwordx4 v[156:159], v247, s[36:39], s16 offen sc1
    v_pk_mul_f32 v[122:123], v[62:63], v[118:119]
    v_pk_fma_f32 v[122:123], v[66:67], v[114:115], v[122:123]
    v_pk_fma_f32 v[122:123], v[70:71], v[110:111], v[122:123]
    v_pk_fma_f32 v[122:123], v[74:75], v[106:107], v[122:123]
    v_lshlrev_b32 v56, 16, v33
    v_and_b32 v57, 0xffff0000, v33
    v_pk_mul_f32 v[122:123], v[122:123], v[56:57]
    v_pk_mul_f32 v[126:127], v[66:67], v[118:119]
    v_pk_fma_f32 v[126:127], v[70:71], v[114:115], v[126:127]
    v_pk_fma_f32 v[126:127], v[74:75], v[110:111], v[126:127]
    v_pk_fma_f32 v[126:127], v[78:79], v[106:107], v[126:127]
    v_lshlrev_b32 v58, 16, v35
    v_and_b32 v59, 0xffff0000, v35
    v_pk_mul_f32 v[126:127], v[126:127], v[58:59]
    v_pk_mul_f32 v[130:131], v[70:71], v[118:119]
    v_pk_fma_f32 v[130:131], v[74:75], v[114:115], v[130:131]
    v_pk_fma_f32 v[130:131], v[78:79], v[110:111], v[130:131]
    v_pk_fma_f32 v[130:131], v[82:83], v[106:107], v[130:131]
    v_lshlrev_b32 v56, 16, v37
    v_and_b32 v57, 0xffff0000, v37
    v_pk_mul_f32 v[130:131], v[130:131], v[56:57]
    v_pk_mul_f32 v[134:135], v[74:75], v[118:119]
    v_pk_fma_f32 v[134:135], v[78:79], v[114:115], v[134:135]
    v_pk_fma_f32 v[134:135], v[82:83], v[110:111], v[134:135]
    v_pk_fma_f32 v[134:135], v[86:87], v[106:107], v[134:135]
    v_lshlrev_b32 v58, 16, v39
    v_and_b32 v59, 0xffff0000, v39
    v_pk_mul_f32 v[134:135], v[134:135], v[58:59]
    v_pk_mul_f32 v[138:139], v[78:79], v[118:119]
    v_pk_fma_f32 v[138:139], v[82:83], v[114:115], v[138:139]
    v_pk_fma_f32 v[138:139], v[86:87], v[110:111], v[138:139]
    v_pk_fma_f32 v[138:139], v[90:91], v[106:107], v[138:139]
    v_lshlrev_b32 v56, 16, v41
    v_and_b32 v57, 0xffff0000, v41
    v_pk_mul_f32 v[138:139], v[138:139], v[56:57]
    v_pk_mul_f32 v[142:143], v[82:83], v[118:119]
    v_pk_fma_f32 v[142:143], v[86:87], v[114:115], v[142:143]
    v_pk_fma_f32 v[142:143], v[90:91], v[110:111], v[142:143]
    v_pk_fma_f32 v[142:143], v[94:95], v[106:107], v[142:143]
    v_lshlrev_b32 v58, 16, v43
    v_and_b32 v59, 0xffff0000, v43
    v_pk_mul_f32 v[142:143], v[142:143], v[58:59]
    v_pk_mul_f32 v[146:147], v[86:87], v[118:119]
    v_pk_fma_f32 v[146:147], v[90:91], v[114:115], v[146:147]
    v_pk_fma_f32 v[146:147], v[94:95], v[110:111], v[146:147]
    v_pk_fma_f32 v[146:147], v[98:99], v[106:107], v[146:147]
    v_lshlrev_b32 v56, 16, v45
    v_and_b32 v57, 0xffff0000, v45
    v_pk_mul_f32 v[146:147], v[146:147], v[56:57]
    v_pk_mul_f32 v[150:151], v[90:91], v[118:119]
    v_pk_fma_f32 v[150:151], v[94:95], v[114:115], v[150:151]
    v_pk_fma_f32 v[150:151], v[98:99], v[110:111], v[150:151]
    v_pk_fma_f32 v[150:151], v[102:103], v[106:107], v[150:151]
    v_lshlrev_b32 v58, 16, v47
    v_and_b32 v59, 0xffff0000, v47
    v_pk_mul_f32 v[150:151], v[150:151], v[58:59]
    v_cvt_pk_bf16_f32 v160, v150, v146
    v_cvt_pk_bf16_f32 v161, v142, v138
    v_cvt_pk_bf16_f32 v162, v134, v130
    v_cvt_pk_bf16_f32 v163, v126, v122
    buffer_store_dwordx4 v[160:163], v247, s[36:39], s17 offen sc1
    v_cvt_pk_bf16_f32 v164, v151, v147
    v_cvt_pk_bf16_f32 v165, v143, v139
    v_cvt_pk_bf16_f32 v166, v135, v131
    v_cvt_pk_bf16_f32 v167, v127, v123
    buffer_store_dwordx4 v[164:167], v247, s[36:39], s62 offen sc1
    s_waitcnt vmcnt(9)
    s_barrier
    s_mov_b32 s51, 0x05040100
    s_mov_b32 s52, 0x07060302
    s_mov_b32 s53, 2883584
    ds_read_b64 v[40:41], v244 offset:35904
    ds_read_b64 v[42:43], v244 offset:36032
    ds_read_b64 v[44:45], v244 offset:36160
    ds_read_b64 v[46:47], v244 offset:36288
    ds_read_b64 v[48:49], v244 offset:36416
    ds_read_b64 v[50:51], v244 offset:36544
    ds_read_b64 v[52:53], v244 offset:36672
    ds_read_b64 v[54:55], v244 offset:36800
    s_waitcnt lgkmcnt(6)
    v_perm_b32 v184, v42, v40, s51
    s_waitcnt lgkmcnt(4)
    v_perm_b32 v185, v46, v44, s51
    s_waitcnt lgkmcnt(2)
    v_perm_b32 v186, v50, v48, s51
    s_waitcnt lgkmcnt(0)
    v_perm_b32 v187, v54, v52, s51
    buffer_store_dwordx4 v[184:187], v245, s[36:39], s53 offen sc1
    s_add_u32 s53, s53, 4096
    v_perm_b32 v188, v42, v40, s52
    v_perm_b32 v189, v46, v44, s52
    v_perm_b32 v190, v50, v48, s52
    v_perm_b32 v191, v54, v52, s52
    buffer_store_dwordx4 v[188:191], v245, s[36:39], s53 offen sc1
    s_add_u32 s53, s53, 4096
    v_perm_b32 v192, v43, v41, s51
    v_perm_b32 v193, v47, v45, s51
    v_perm_b32 v194, v51, v49, s51
    v_perm_b32 v195, v55, v53, s51
    buffer_store_dwordx4 v[192:195], v245, s[36:39], s53 offen sc1
    s_add_u32 s53, s53, 4096
    v_perm_b32 v196, v43, v41, s52
    v_perm_b32 v197, v47, v45, s52
    v_perm_b32 v198, v51, v49, s52
    v_perm_b32 v199, v55, v53, s52
    buffer_store_dwordx4 v[196:199], v245, s[36:39], s53 offen sc1
    s_waitcnt vmcnt(4)
    s_waitcnt lgkmcnt(0)
    s_barrier
    v_readfirstlane_b32 s48, v246
    s_mul_i32 s48, s48, 0x9E3779B1
    s_add_u32 s48, s48, 0x7F4A7C15
    s_cmp_eq_u32 s3, 0
    s_cbranch_scc0 L_wf1
    s_lshl_b32 s54, s76, 7
    s_add_u32 s54, s54, 23199744
    v_mov_b32 v2, 0
    v_mov_b32 v3, s48
    s_mov_b64 exec, 1
    buffer_store_dword v3, v2, s[36:39], s54 offen sc1
    s_mov_b64 exec, -1
L_wf1:
    s_add_u32 m0, s61, 0
    s_nop 0
    buffer_load_dwordx4 v224, s[40:43], s64 offen offset:0 lds
    buffer_load_dwordx4 v225, s[40:43], s64 offen offset:1024 lds
    buffer_load_dwordx4 v226, s[40:43], s64 offen offset:2048 lds
    s_add_u32 s64, s64, 98304
    s_sub_u32 s35, s64, 1966080
    s_min_u32 s64, s64, s35
    s_add_u32 m0, s61, 12416
    s_nop 0
    buffer_load_dwordx4 v224, s[40:43], s64 offen offset:0 lds
    buffer_load_dwordx4 v225, s[40:43], s64 offen offset:1024 lds
    buffer_load_dwordx4 v226, s[40:43], s64 offen offset:2048 lds
    s_add_u32 s64, s64, 98304
    s_sub_u32 s35, s64, 1966080
    s_min_u32 s64, s64, s35
    s_add_u32 m0, s61, 24832
    s_nop 0
    buffer_load_dwordx4 v224, s[40:43], s64 offen offset:0 lds
    buffer_load_dwordx4 v225, s[40:43], s64 offen offset:1024 lds
    buffer_load_dwordx4 v226, s[40:43], s64 offen offset:2048 lds
    s_add_u32 s64, s64, 98304
    s_sub_u32 s35, s64, 1966080
    s_min_u32 s64, s64, s35
    s_add_u32 m0, s61, 37248
    s_nop 0
    buffer_load_dwordx4 v224, s[40:43], s64 offen offset:0 lds
    buffer_load_dwordx4 v225, s[40:43], s64 offen offset:1024 lds
    buffer_load_dwordx4 v226, s[40:43], s64 offen offset:2048 lds
    s_add_u32 s64, s64, 98304
    s_sub_u32 s35, s64, 1966080
    s_min_u32 s64, s64, s35
    s_add_u32 m0, s61, 49664
    s_nop 0
    buffer_load_dwordx4 v224, s[40:43], s64 offen offset:0 lds
    buffer_load_dwordx4 v225, s[40:43], s64 offen offset:1024 lds
    buffer_load_dwordx4 v226, s[40:43], s64 offen offset:2048 lds
    s_add_u32 s64, s64, 98304
    s_sub_u32 s35, s64, 1966080
    s_min_u32 s64, s64, s35
    ds_read_b128 v[8:11], v223 offset:32
    ds_read_b64 v[12:13], v223 offset:48
    ds_read_b128 v[14:17], v223 offset:1056
    ds_read_b64 v[18:19], v223 offset:1072
    ds_read_b128 v[20:23], v223 offset:2080
    ds_read_b64 v[24:25], v223 offset:2096
    ds_read_b128 v[26:29], v223 offset:3104
    ds_read_b64 v[30:31], v223 offset:3120
    s_mov_b64 exec, 1
    s_waitcnt lgkmcnt(7)
    v_lshlrev_b32 v80, 16, v8
    v_alignbit_b32 v81, v9, v8, 16
    ds_write_b32 v223, v80 offset:4188
    ds_write_b32 v223, v8 offset:8348
    ds_write_b32 v223, v80 offset:12504
    ds_write_b32 v223, v81 offset:12508
    s_mov_b64 exec, -1
    v_alignbit_b32 v56, v9, v8, 16
    v_alignbit_b32 v57, v10, v9, 16
    v_alignbit_b32 v58, v11, v10, 16
    s_waitcnt lgkmcnt(10)
    v_alignbit_b32 v59, v12, v11, 16
    v_pk_mov_b32 v[60:61], v[8:9], v[10:11] op_sel:[1,0]
    v_pk_mov_b32 v[62:63], v[10:11], v[12:13] op_sel:[1,0]
    v_alignbit_b32 v64, v10, v9, 16
    v_alignbit_b32 v65, v11, v10, 16
    v_alignbit_b32 v66, v12, v11, 16
    v_alignbit_b32 v67, v13, v12, 16
    ds_write_b128 v223, v[56:59] offset:4192
    ds_write_b128 v223, v[60:63] offset:8352
    ds_write_b128 v223, v[64:67] offset:12512
    s_waitcnt lgkmcnt(12)
    v_alignbit_b32 v68, v15, v14, 16
    v_alignbit_b32 v69, v16, v15, 16
    v_alignbit_b32 v70, v17, v16, 16
    s_waitcnt lgkmcnt(11)
    v_alignbit_b32 v71, v18, v17, 16
    v_pk_mov_b32 v[72:73], v[14:15], v[16:17] op_sel:[1,0]
    v_pk_mov_b32 v[74:75], v[16:17], v[18:19] op_sel:[1,0]
    v_alignbit_b32 v76, v16, v15, 16
    v_alignbit_b32 v77, v17, v16, 16
    v_alignbit_b32 v78, v18, v17, 16
    v_alignbit_b32 v79, v19, v18, 16
    ds_write_b128 v223, v[68:71] offset:5216
    ds_write_b128 v223, v[72:75] offset:9376
    ds_write_b128 v223, v[76:79] offset:13536
    s_waitcnt lgkmcnt(13)
    v_alignbit_b32 v56, v21, v20, 16
    v_alignbit_b32 v57, v22, v21, 16
    v_alignbit_b32 v58, v23, v22, 16
    s_waitcnt lgkmcnt(12)
    v_alignbit_b32 v59, v24, v23, 16
    v_pk_mov_b32 v[60:61], v[20:21], v[22:23] op_sel:[1,0]
    v_pk_mov_b32 v[62:63], v[22:23], v[24:25] op_sel:[1,0]
    v_alignbit_b32 v64, v22, v21, 16
    v_alignbit_b32 v65, v23, v22, 16
    v_alignbit_b32 v66, v24, v23, 16
    v_alignbit_b32 v67, v25, v24, 16
    ds_write_b128 v223, v[56:59] offset:6240
    ds_write_b128 v223, v[60:63] offset:10400
    ds_write_b128 v223, v[64:67] offset:14560
    s_waitcnt lgkmcnt(14)
    v_alignbit_b32 v68, v27, v26, 16
    v_alignbit_b32 v69, v28, v27, 16
    v_alignbit_b32 v70, v29, v28, 16
    s_waitcnt lgkmcnt(13)
    v_alignbit_b32 v71, v30, v29, 16
    v_pk_mov_b32 v[72:73], v[26:27], v[28:29] op_sel:[1,0]
    v_pk_mov_b32 v[74:75], v[28:29], v[30:31] op_sel:[1,0]
    v_alignbit_b32 v76, v28, v27, 16
    v_alignbit_b32 v77, v29, v28, 16
    v_alignbit_b32 v78, v30, v29, 16
    v_alignbit_b32 v79, v31, v30, 16
    ds_write_b128 v223, v[68:71] offset:7264
    ds_write_b128 v223, v[72:75] offset:11424
    ds_write_b128 v223, v[76:79] offset:15584
    s_mov_b32 s60, s35
    s_movk_i32 s4, 4096
    s_movk_i32 s5, 8192
    s_lshl_b32 s6, s72, 10
    s_add_u32 s6, s6, 23101440
    s_lshl_b32 s7, s73, 6
    s_add_u32 s7, s7, s6
    s_mul_i32 s8, s72, 768
    s_mul_i32 s50, s73, 12
    s_add_u32 s8, s8, s50
    s_mul_i32 s50, s3, 3
    s_add_u32 s8, s8, s50
    s_lshl_b32 s8, s8, 8
    s_add_u32 s8, s8, 16777216
    s_lshl_b32 s9, s73, 2
    s_add_u32 s9, s9, s3
    s_mul_i32 s9, s9, 384
    s_add_u32 s9, s9, 23527424
    s_mul_i32 s62, s3, 32768
    s_lshl_b32 s50, s72, 7
    s_add_u32 s62, s62, s50
    s_mul_i32 s50, s34, 131072
    s_add_u32 s10, s62, s50
    s_lshl_b32 s63, s3, 10
    s_add_u32 s11, s10, 131072
    s_sub_u32 s35, s11, 2621440
    s_min_u32 s11, s11, s35
    s_add_u32 s12, s11, 131072
    s_sub_u32 s35, s12, 2621440
    s_min_u32 s12, s12, s35
    s_add_u32 s13, s12, 131072
    s_sub_u32 s35, s13, 2621440
    s_min_u32 s13, s13, s35
    s_add_u32 s14, s13, 131072
    s_sub_u32 s35, s14, 2621440
    s_min_u32 s14, s14, s35
    s_add_u32 s15, s14, 131072
    s_sub_u32 s35, s15, 2621440
    s_min_u32 s15, s15, s35
    s_add_u32 s18, s15, 131072
    s_sub_u32 s35, s18, 2621440
    s_min_u32 s18, s18, s35
    s_add_u32 s19, s18, 131072
    s_sub_u32 s35, s19, 2621440
    s_min_u32 s19, s19, s35
    s_add_u32 s20, s19, 131072
    s_sub_u32 s35, s20, 2621440
    s_min_u32 s20, s20, s35
    s_add_u32 s21, s20, 131072
    s_sub_u32 s35, s21, 2621440
    s_min_u32 s21, s21, s35
    s_add_u32 s22, s21, 131072
    s_sub_u32 s35, s22, 2621440
    s_min_u32 s22, s22, s35
    s_add_u32 s23, s22, 131072
    s_sub_u32 s35, s23, 2621440
    s_min_u32 s23, s23, s35
    s_add_u32 s24, s23, 131072
    s_sub_u32 s35, s24, 2621440
    s_min_u32 s24, s24, s35
    s_add_u32 s25, s24, 131072
    s_sub_u32 s35, s25, 2621440
    s_min_u32 s25, s25, s35
    s_add_u32 s26, s25, 131072
    s_sub_u32 s35, s26, 2621440
    s_min_u32 s26, s26, s35
    s_add_u32 s27, s26, 131072
    s_sub_u32 s35, s27, 2621440
    s_min_u32 s27, s27, s35
    s_add_u32 s44, s27, 131072
    s_sub_u32 s35, s44, 2621440
    s_min_u32 s44, s44, s35
    s_add_u32 s45, s44, 131072
    s_sub_u32 s35, s45, 2621440
    s_min_u32 s45, s45, s35
    s_add_u32 s46, s45, 131072
    s_sub_u32 s35, s46, 2621440
    s_min_u32 s46, s46, s35
    s_add_u32 s47, s46, 131072
    s_sub_u32 s35, s47, 2621440
    s_min_u32 s47, s47, s35
    s_mov_b32 s17, 23199744
    s_lshl_b32 s62, s75, 2
    s_add_u32 s62, s62, s3
    s_mul_i32 s62, s62, 61440
    s_add_u32 s62, s62, 14417920
    s_mov_b32 s60, 23230464
    v_lshrrev_b32 v3, 4, v1
    v_lshlrev_b32 v2, 3, v3
    v_and_b32 v3, 15, v1
    v_sub_u32 v2, v2, v3
    v_subrev_u32 v2, 9, v2
    v_and_b32 v3, 1, v2
    v_cmp_eq_u32 vcc, 1, v3
    v_lshrrev_b32 v3, 16, v250
    s_nop 0
    v_cndmask_b32 v3, v3, v250, vcc
    v_lshrrev_b32 v2, 1, v2
    v_cmp_eq_u32 vcc, 0, v2
    s_nop 1
    v_cndmask_b32 v244, 0, v3, vcc
    v_cmp_eq_u32 vcc, 1, v2
    s_nop 1
    v_cndmask_b32 v245, 0, v3, vcc
    v_cmp_eq_u32 vcc, 2, v2
    s_nop 1
    v_cndmask_b32 v246, 0, v3, vcc
    v_cmp_eq_u32 vcc, 3, v2
    s_nop 1
    v_cndmask_b32 v247, 0, v3, vcc
    v_mov_b32 v4, v229
    v_mov_b32 v5, v230
    s_waitcnt vmcnt(0)
    s_barrier
    s_cmp_eq_u32 s3, 0
    s_cbranch_scc0 L_wf2
    s_lshl_b32 s54, s76, 7
    s_add_u32 s54, s54, 23374848
    v_mov_b32 v254, 0
    v_mov_b32 v255, s48
    s_mov_b64 exec, 1
    buffer_store_dword v255, v254, s[36:39], s54 offen sc1
    s_mov_b64 exec, -1
L_wf2:
L_poll3:
    buffer_load_dword v2, v242, s[36:39], s59 offen sc1
    s_waitcnt vmcnt(0)
    v_cmp_ne_u32 vcc, s48, v2
    s_cbranch_vccz L_poll3_ok
    s_cmp_eq_u32 s49, 0
    s_cbranch_scc1 L_poll3_ok
    s_sub_u32 s49, s49, 1
    s_sleep 1
    s_branch L_poll3
L_poll3_ok:
    s_mul_i32 s50, s58, 4096
    s_mul_i32 s52, s3, 4608
    s_add_u32 m0, s52, 145408
    s_nop 0
    buffer_load_dwordx4 v248, s[36:39], s50 offen offset:0 sc1 lds
    buffer_load_dwordx4 v248, s[36:39], s50 offen offset:1024 sc1 lds
    buffer_load_dwordx4 v248, s[36:39], s50 offen offset:2048 sc1 lds
    buffer_load_dwordx4 v248, s[36:39], s50 offen offset:3072 sc1 lds
    ds_read_b64_tr_b16 a[0:1], v227 offset:0
    ds_read_b64_tr_b16 a[2:3], v227 offset:1536
    ds_read_b64_tr_b16 a[4:5], v227 offset:6224
    ds_read_b64_tr_b16 a[6:7], v227 offset:7760
    ds_read_b64_tr_b16 a[8:9], v228 offset:0
    ds_read_b64_tr_b16 a[10:11], v228 offset:1536
    ds_read_b64_tr_b16 a[12:13], v227 offset:12416
    ds_read_b64_tr_b16 a[14:15], v227 offset:13952
    ds_read_b64_tr_b16 a[16:17], v227 offset:18640
    ds_read_b64_tr_b16 a[18:19], v227 offset:20176
    ds_read_b64_tr_b16 a[20:21], v228 offset:12416
    ds_read_b64_tr_b16 a[22:23], v228 offset:13952
    ds_read_b64_tr_b16 a[24:25], v227 offset:24832
    ds_read_b64_tr_b16 a[26:27], v227 offset:26368
    ds_read_b64_tr_b16 a[28:29], v227 offset:31056
    ds_read_b64_tr_b16 a[30:31], v227 offset:32592
    ds_read_b64_tr_b16 a[32:33], v228 offset:24832
    ds_read_b64_tr_b16 a[34:35], v228 offset:26368
    ds_read_b64_tr_b16 a[36:37], v227 offset:37248
    ds_read_b64_tr_b16 a[38:39], v227 offset:38784
    ds_read_b64_tr_b16 a[40:41], v227 offset:43472
    ds_read_b64_tr_b16 a[42:43], v227 offset:45008
    ds_read_b64_tr_b16 a[44:45], v228 offset:37248
    ds_read_b64_tr_b16 a[46:47], v228 offset:38784
    ds_read_b64_tr_b16 a[48:49], v227 offset:49664
    ds_read_b64_tr_b16 a[50:51], v227 offset:51200
    ds_read_b64_tr_b16 a[52:53], v227 offset:55888
    ds_read_b64_tr_b16 a[54:55], v227 offset:57424
    ds_read_b64_tr_b16 a[56:57], v228 offset:49664
    ds_read_b64_tr_b16 a[58:59], v228 offset:51200
    buffer_load_dword v243, v240, s[36:39], s69 offen sc1
    s_waitcnt lgkmcnt(0)
    s_barrier
    s_add_u32 m0, s61, 0
    s_nop 0
    buffer_load_dwordx4 v224, s[40:43], s64 offen offset:0 lds
    buffer_load_dwordx4 v225, s[40:43], s64 offen offset:1024 lds
    buffer_load_dwordx4 v226, s[40:43], s64 offen offset:2048 lds
    s_add_u32 s64, s64, 98304
    s_sub_u32 s35, s64, 1966080
    s_min_u32 s64, s64, s35
    s_add_u32 m0, s61, 12416
    s_nop 0
    buffer_load_dwordx4 v224, s[40:43], s64 offen offset:0 lds
    buffer_load_dwordx4 v225, s[40:43], s64 offen offset:1024 lds
    buffer_load_dwordx4 v226, s[40:43], s64 offen offset:2048 lds
    s_add_u32 s64, s64, 98304
    s_sub_u32 s35, s64, 1966080
    s_min_u32 s64, s64, s35
    s_waitcnt vmcnt(7)
    ds_read_b128 v[104:107], v5 offset:3584
    ds_read_b64 v[40:41], v4 offset:0
    ds_read_b64 v[42:43], v4 offset:8
    ds_read_b128 v[108:111], v5 offset:3072
    ds_read_b64 v[44:45], v4 offset:512
    ds_read_b64 v[46:47], v4 offset:520
    ds_read_b128 v[112:115], v5 offset:2560
    ds_read_b64 v[48:49], v4 offset:1024
    ds_read_b64 v[50:51], v4 offset:1032
    ds_read_b128 v[116:119], v5 offset:2048
    ds_read_b64 v[52:53], v4 offset:1536
    ds_read_b64 v[54:55], v4 offset:1544
    s_waitcnt lgkmcnt(9)
    v_mfma_f32_16x16x32_bf16 v[8:11], v[40:43], v[104:107], 0
    v_mfma_f32_16x16x32_bf16 v[8:11], v[244:247], v[104:107], v[8:11]
    s_waitcnt lgkmcnt(8)
    ds_read_b128 v[136:139], v5 offset:3648
    v_mfma_f32_16x16x32_bf16 v[12:15], v[40:43], v[108:111], 0
    ds_read_b64 v[72:73], v4 offset:64
    v_mfma_f32_16x16x32_bf16 v[12:15], v[244:247], v[108:111], v[12:15]
    s_waitcnt lgkmcnt(8)
    ds_read_b64 v[74:75], v4 offset:72
    v_mfma_f32_16x16x32_bf16 v[12:15], v[44:47], v[104:107], v[12:15]
    ds_read_b128 v[140:143], v5 offset:3136
    v_mfma_f32_16x16x32_bf16 v[16:19], v[44:47], v[108:111], 0
    s_waitcnt lgkmcnt(9)
    ds_read_b64 v[76:77], v4 offset:576
    v_mfma_f32_16x16x32_bf16 v[16:19], v[40:43], v[112:115], v[16:19]
    ds_read_b64 v[78:79], v4 offset:584
    v_mfma_f32_16x16x32_bf16 v[16:19], v[244:247], v[112:115], v[16:19]
    s_waitcnt lgkmcnt(9)
    ds_read_b128 v[144:147], v5 offset:2624
    v_mfma_f32_16x16x32_bf16 v[16:19], v[48:51], v[104:107], v[16:19]
    ds_read_b64 v[80:81], v4 offset:1088
    v_mfma_f32_16x16x32_bf16 v[20:23], v[44:47], v[112:115], 0
    ds_read_b64 v[82:83], v4 offset:1096
    v_mfma_f32_16x16x32_bf16 v[20:23], v[48:51], v[108:111], v[20:23]
    s_waitcnt lgkmcnt(11)
    ds_read_b128 v[148:151], v5 offset:2112
    v_mfma_f32_16x16x32_bf16 v[20:23], v[40:43], v[116:119], v[20:23]
    ds_read_b64 v[84:85], v4 offset:1600
    v_mfma_f32_16x16x32_bf16 v[20:23], v[244:247], v[116:119], v[20:23]
    s_waitcnt lgkmcnt(11)
    ds_read_b64 v[86:87], v4 offset:1608
    v_mfma_f32_16x16x32_bf16 v[20:23], v[52:55], v[104:107], v[20:23]
    s_add_u32 m0, s66, 62464
    s_waitcnt vmcnt(6)
    v_cmp_ne_u32 vcc, s48, v243
    s_cbranch_vccnz L_chk4_slow
L_chk4_back:
    s_barrier
    s_waitcnt lgkmcnt(9)
    v_mfma_f32_16x16x32_bf16 v[8:11], v[72:75], v[136:139], v[8:11]
    s_waitcnt lgkmcnt(8)
    ds_read_b128 v[104:107], v5 offset:3712
    ds_read_b64 v[40:41], v4 offset:128
    buffer_load_dwordx4 v248, s[36:39], s67 offen offset:0 sc1 lds
    v_mfma_f32_16x16x32_bf16 v[12:15], v[72:75], v[140:143], v[12:15]
    s_waitcnt lgkmcnt(8)
    ds_read_b64 v[42:43], v4 offset:136
    ds_read_b128 v[108:111], v5 offset:3200
    v_mfma_f32_16x16x32_bf16 v[12:15], v[76:79], v[136:139], v[12:15]
    ds_read_b64 v[44:45], v4 offset:640
    v_mfma_f32_16x16x32_bf16 v[16:19], v[76:79], v[140:143], v[16:19]
    s_waitcnt lgkmcnt(10)
    ds_read_b64 v[46:47], v4 offset:648
    v_mfma_f32_16x16x32_bf16 v[16:19], v[72:75], v[144:147], v[16:19]
    s_waitcnt lgkmcnt(9)
    s_add_u32 m0, s66, 62464
    ds_read_b128 v[112:115], v5 offset:2688
    v_mfma_f32_16x16x32_bf16 v[16:19], v[80:83], v[136:139], v[16:19]
    ds_read_b64 v[48:49], v4 offset:1152
    buffer_load_dwordx4 v248, s[36:39], s67 offen offset:1024 sc1 lds
    v_mfma_f32_16x16x32_bf16 v[20:23], v[76:79], v[144:147], v[20:23]
    ds_read_b64 v[50:51], v4 offset:1160
    v_mfma_f32_16x16x32_bf16 v[20:23], v[80:83], v[140:143], v[20:23]
    s_waitcnt lgkmcnt(11)
    ds_read_b128 v[116:119], v5 offset:2176
    v_mfma_f32_16x16x32_bf16 v[20:23], v[72:75], v[148:151], v[20:23]
    s_waitcnt lgkmcnt(10)
    s_add_u32 m0, s66, 62464
    ds_read_b64 v[52:53], v4 offset:1664
    v_mfma_f32_16x16x32_bf16 v[20:23], v[84:87], v[136:139], v[20:23]
    s_waitcnt lgkmcnt(8)
    ds_read_b64 v[54:55], v4 offset:1672
    buffer_load_dwordx4 v248, s[36:39], s67 offen offset:2048 sc1 lds
    v_mfma_f32_16x16x32_bf16 v[8:11], v[40:43], v[104:107], v[8:11]
    s_waitcnt lgkmcnt(8)
    ds_read_b128 v[136:139], v5 offset:3776
    ds_read_b64 v[72:73], v4 offset:192
    v_mfma_f32_16x16x32_bf16 v[12:15], v[40:43], v[108:111], v[12:15]
    s_waitcnt lgkmcnt(8)
    ds_read_b64 v[74:75], v4 offset:200
    ds_read_b128 v[140:143], v5 offset:3264
    v_mfma_f32_16x16x32_bf16 v[12:15], v[44:47], v[104:107], v[12:15]
    ds_read_b64 v[76:77], v4 offset:704
    v_mfma_f32_16x16x32_bf16 v[16:19], v[44:47], v[108:111], v[16:19]
    s_waitcnt lgkmcnt(10)
    s_add_u32 m0, s66, 62464
    ds_read_b64 v[78:79], v4 offset:712
    v_mfma_f32_16x16x32_bf16 v[16:19], v[40:43], v[112:115], v[16:19]
    s_waitcnt lgkmcnt(9)
    ds_read_b128 v[144:147], v5 offset:2752
    buffer_load_dwordx4 v248, s[36:39], s67 offen offset:3072 sc1 lds
    v_mfma_f32_16x16x32_bf16 v[16:19], v[48:51], v[104:107], v[16:19]
    ds_read_b64 v[80:81], v4 offset:1216
    v_mfma_f32_16x16x32_bf16 v[20:23], v[44:47], v[112:115], v[20:23]
    ds_read_b64 v[82:83], v4 offset:1224
    v_mfma_f32_16x16x32_bf16 v[20:23], v[48:51], v[108:111], v[20:23]
    s_waitcnt lgkmcnt(11)
    ds_read_b128 v[148:151], v5 offset:2240
    v_mfma_f32_16x16x32_bf16 v[20:23], v[40:43], v[116:119], v[20:23]
    s_waitcnt lgkmcnt(10)
    ds_read_b64 v[84:85], v4 offset:1728
    buffer_load_dwordx4 v[176:179], v231, s[36:39], s65 offen offset:0 sc1
    v_mfma_f32_16x16x32_bf16 v[20:23], v[52:55], v[104:107], v[20:23]
    s_waitcnt lgkmcnt(8)
    ds_read_b64 v[86:87], v4 offset:1736
    v_mfma_f32_16x16x32_bf16 v[8:11], v[72:75], v[136:139], v[8:11]
    s_waitcnt lgkmcnt(8)
    ds_read_b128 v[104:107], v5 offset:3840
    ds_read_b64 v[40:41], v4 offset:256
    v_mfma_f32_16x16x32_bf16 v[12:15], v[72:75], v[140:143], v[12:15]
    s_waitcnt lgkmcnt(8)
    ds_read_b64 v[42:43], v4 offset:264
    ds_read_b128 v[108:111], v5 offset:3328
    v_mfma_f32_16x16x32_bf16 v[12:15], v[76:79], v[136:139], v[12:15]
    ds_read_b64 v[44:45], v4 offset:768
    v_mfma_f32_16x16x32_bf16 v[16:19], v[76:79], v[140:143], v[16:19]
    s_waitcnt lgkmcnt(10)
    ds_read_b64 v[46:47], v4 offset:776
    buffer_load_dwordx4 v[180:183], v231, s[36:39], s65 offen offset:1024 sc1
    v_mfma_f32_16x16x32_bf16 v[16:19], v[72:75], v[144:147], v[16:19]
    s_waitcnt lgkmcnt(9)
    ds_read_b128 v[112:115], v5 offset:2816
    v_mfma_f32_16x16x32_bf16 v[16:19], v[80:83], v[136:139], v[16:19]
    ds_read_b64 v[48:49], v4 offset:1280
    v_mfma_f32_16x16x32_bf16 v[20:23], v[76:79], v[144:147], v[20:23]
    s_add_u32 m0, s61, 24832
    ds_read_b64 v[50:51], v4 offset:1288
    v_mfma_f32_16x16x32_bf16 v[20:23], v[80:83], v[140:143], v[20:23]
    s_waitcnt lgkmcnt(11)
    ds_read_b128 v[116:119], v5 offset:2304
    buffer_load_dwordx4 v224, s[40:43], s64 offen offset:0 lds
    v_mfma_f32_16x16x32_bf16 v[20:23], v[72:75], v[148:151], v[20:23]
    s_waitcnt lgkmcnt(10)
    ds_read_b64 v[52:53], v4 offset:1792
    v_mfma_f32_16x16x32_bf16 v[20:23], v[84:87], v[136:139], v[20:23]
    s_waitcnt lgkmcnt(8)
    ds_read_b64 v[54:55], v4 offset:1800
    v_mfma_f32_16x16x32_bf16 v[8:11], v[40:43], v[104:107], v[8:11]
    s_waitcnt lgkmcnt(8)
    ds_read_b128 v[136:139], v5 offset:3904
    ds_read_b64 v[72:73], v4 offset:320
    v_mfma_f32_16x16x32_bf16 v[12:15], v[40:43], v[108:111], v[12:15]
    s_waitcnt lgkmcnt(8)
    ds_read_b64 v[74:75], v4 offset:328
    ds_read_b128 v[140:143], v5 offset:3392
    v_mfma_f32_16x16x32_bf16 v[12:15], v[44:47], v[104:107], v[12:15]
    s_add_u32 m0, s61, 24832
    ds_read_b64 v[76:77], v4 offset:832
    v_mfma_f32_16x16x32_bf16 v[16:19], v[44:47], v[108:111], v[16:19]
    s_waitcnt lgkmcnt(10)
    ds_read_b64 v[78:79], v4 offset:840
    buffer_load_dwordx4 v225, s[40:43], s64 offen offset:1024 lds
    v_mfma_f32_16x16x32_bf16 v[16:19], v[40:43], v[112:115], v[16:19]
    s_waitcnt lgkmcnt(9)
    ds_read_b128 v[144:147], v5 offset:2880
    v_mfma_f32_16x16x32_bf16 v[16:19], v[48:51], v[104:107], v[16:19]
    ds_read_b64 v[80:81], v4 offset:1344
    v_mfma_f32_16x16x32_bf16 v[20:23], v[44:47], v[112:115], v[20:23]
    ds_read_b64 v[82:83], v4 offset:1352
    buffer_load_dwordx2 v[232:233], v253, s[36:39], s55 offen sc1
    v_mfma_f32_16x16x32_bf16 v[20:23], v[48:51], v[108:111], v[20:23]
    s_waitcnt lgkmcnt(11)
    ds_read_b128 v[148:151], v5 offset:2368
    v_mfma_f32_16x16x32_bf16 v[20:23], v[40:43], v[116:119], v[20:23]
    s_waitcnt lgkmcnt(10)
    s_add_u32 m0, s61, 24832
    ds_read_b64 v[84:85], v4 offset:1856
    v_mfma_f32_16x16x32_bf16 v[20:23], v[52:55], v[104:107], v[20:23]
    s_waitcnt lgkmcnt(8)
    ds_read_b64 v[86:87], v4 offset:1864
    buffer_load_dwordx4 v226, s[40:43], s64 offen offset:2048 lds
    v_mfma_f32_16x16x32_bf16 v[8:11], v[72:75], v[136:139], v[8:11]
    s_waitcnt lgkmcnt(8)
    s_add_u32 s64, s64, 98304
    ds_read_b128 v[104:107], v5 offset:3968
    ds_read_b64 v[40:41], v4 offset:384
    v_mfma_f32_16x16x32_bf16 v[12:15], v[72:75], v[140:143], v[12:15]
    s_waitcnt lgkmcnt(8)
    s_sub_u32 s35, s64, 1966080
    ds_read_b64 v[42:43], v4 offset:392
    ds_read_b128 v[108:111], v5 offset:3456
    v_mfma_f32_16x16x32_bf16 v[12:15], v[76:79], v[136:139], v[12:15]
    s_min_u32 s64, s64, s35
    ds_read_b64 v[44:45], v4 offset:896
    v_mfma_f32_16x16x32_bf16 v[16:19], v[76:79], v[140:143], v[16:19]
    s_waitcnt lgkmcnt(10)
    ds_read_b64 v[46:47], v4 offset:904
    v_mfma_f32_16x16x32_bf16 v[16:19], v[72:75], v[144:147], v[16:19]
    s_waitcnt lgkmcnt(9)
    s_add_u32 m0, s61, 37248
    ds_read_b128 v[112:115], v5 offset:2944
    v_mfma_f32_16x16x32_bf16 v[16:19], v[80:83], v[136:139], v[16:19]
    ds_read_b64 v[48:49], v4 offset:1408
    buffer_load_dwordx4 v224, s[40:43], s64 offen offset:0 lds
    v_mfma_f32_16x16x32_bf16 v[20:23], v[76:79], v[144:147], v[20:23]
    ds_read_b64 v[50:51], v4 offset:1416
    v_mfma_f32_16x16x32_bf16 v[20:23], v[80:83], v[140:143], v[20:23]
    s_waitcnt lgkmcnt(11)
    ds_read_b128 v[116:119], v5 offset:2432
    v_mfma_f32_16x16x32_bf16 v[20:23], v[72:75], v[148:151], v[20:23]
    s_waitcnt lgkmcnt(10)
    ds_read_b64 v[52:53], v4 offset:1920
    v_mfma_f32_16x16x32_bf16 v[20:23], v[84:87], v[136:139], v[20:23]
    s_waitcnt lgkmcnt(8)
    s_add_u32 m0, s61, 37248
    ds_read_b64 v[54:55], v4 offset:1928
    v_mfma_f32_16x16x32_bf16 v[8:11], v[40:43], v[104:107], v[8:11]
    s_waitcnt lgkmcnt(8)
    ds_read_b128 v[136:139], v5 offset:4032
    ds_read_b64 v[72:73], v4 offset:448
    buffer_load_dwordx4 v225, s[40:43], s64 offen offset:1024 lds
    v_mfma_f32_16x16x32_bf16 v[12:15], v[40:43], v[108:111], v[12:15]
    s_waitcnt lgkmcnt(8)
    ds_read_b64 v[74:75], v4 offset:456
    ds_read_b128 v[140:143], v5 offset:3520
    v_mfma_f32_16x16x32_bf16 v[12:15], v[44:47], v[104:107], v[12:15]
    ds_read_b64 v[76:77], v4 offset:960
    v_mfma_f32_16x16x32_bf16 v[16:19], v[44:47], v[108:111], v[16:19]
    s_waitcnt lgkmcnt(10)
    ds_read_b64 v[78:79], v4 offset:968
    v_mfma_f32_16x16x32_bf16 v[16:19], v[40:43], v[112:115], v[16:19]
    s_waitcnt lgkmcnt(9)
    ds_read_b128 v[144:147], v5 offset:3008
    v_mfma_f32_16x16x32_bf16 v[16:19], v[48:51], v[104:107], v[16:19]
    s_add_u32 m0, s61, 37248
    ds_read_b64 v[80:81], v4 offset:1472
    v_mfma_f32_16x16x32_bf16 v[20:23], v[44:47], v[112:115], v[20:23]
    ds_read_b64 v[82:83], v4 offset:1480
    buffer_load_dwordx4 v226, s[40:43], s64 offen offset:2048 lds
    v_mfma_f32_16x16x32_bf16 v[20:23], v[48:51], v[108:111], v[20:23]
    s_waitcnt lgkmcnt(11)
    s_add_u32 s64, s64, 98304
    ds_read_b128 v[148:151], v5 offset:2496
    v_mfma_f32_16x16x32_bf16 v[20:23], v[40:43], v[116:119], v[20:23]
    s_waitcnt lgkmcnt(10)
    s_sub_u32 s35, s64, 1966080
    ds_read_b64 v[84:85], v4 offset:1984
    v_mfma_f32_16x16x32_bf16 v[20:23], v[52:55], v[104:107], v[20:23]
    s_waitcnt lgkmcnt(8)
    s_min_u32 s64, s64, s35
    ds_read_b64 v[86:87], v4 offset:1992
    v_mfma_f32_16x16x32_bf16 v[8:11], v[72:75], v[136:139], v[8:11]
    s_waitcnt lgkmcnt(8)
    ds_read_b128 v[112:115], v5 offset:2560
    ds_read_b64 v[48:49], v4 offset:1024
    v_mfma_f32_16x16x32_bf16 v[12:15], v[72:75], v[140:143], v[12:15]
    s_waitcnt lgkmcnt(8)
    s_add_u32 m0, s61, 49664
    ds_read_b64 v[50:51], v4 offset:1032
    ds_read_b128 v[116:119], v5 offset:2048
    v_mfma_f32_16x16x32_bf16 v[12:15], v[76:79], v[136:139], v[12:15]
    ds_read_b64 v[52:53], v4 offset:1536
    ds_read_b64 v[54:55], v4 offset:1544
    buffer_load_dwordx4 v224, s[40:43], s64 offen offset:0 lds
    v_mfma_f32_16x16x32_bf16 v[16:19], v[76:79], v[140:143], v[16:19]
    s_waitcnt lgkmcnt(11)
    ds_read_b128 v[108:111], v5 offset:3072
    ds_read_b64 v[44:45], v4 offset:512
    v_mfma_f32_16x16x32_bf16 v[16:19], v[72:75], v[144:147], v[16:19]
    s_waitcnt lgkmcnt(11)
    ds_read_b64 v[46:47], v4 offset:520
    ds_read_b128 v[120:123], v5 offset:1536
    v_mfma_f32_16x16x32_bf16 v[16:19], v[80:83], v[136:139], v[16:19]
    ds_read_b64 v[56:57], v4 offset:2048
    ds_read_b64 v[58:59], v4 offset:2056
    v_mfma_f32_16x16x32_bf16 v[20:23], v[76:79], v[144:147], v[20:23]
    ds_read_b128 v[104:107], v5 offset:3584
    ds_read_b64 v[40:41], v4 offset:0
    v_mfma_f32_16x16x32_bf16 v[20:23], v[80:83], v[140:143], v[20:23]
    s_waitcnt lgkmcnt(12)
    s_add_u32 m0, s61, 49664
    ds_read_b64 v[42:43], v4 offset:8
    ds_read_b128 v[124:127], v5 offset:1024
    v_mfma_f32_16x16x32_bf16 v[20:23], v[72:75], v[148:151], v[20:23]
    ds_read_b64 v[60:61], v4 offset:2560
    ds_read_b64 v[62:63], v4 offset:2568
    buffer_load_dwordx4 v225, s[40:43], s64 offen offset:1024 lds
    v_mfma_f32_16x16x32_bf16 v[20:23], v[84:87], v[136:139], v[20:23]
    s_waitcnt vmcnt(11)
    s_barrier
    ds_read_b128 v[128:131], v5 offset:512
    ds_read_b64 v[64:65], v4 offset:3072
    ds_read_b64 v[66:67], v4 offset:3080
    ds_read_b128 v[132:135], v5 offset:0
    ds_read_b64 v[68:69], v4 offset:3584
    ds_read_b64 v[70:71], v4 offset:3592
    s_waitcnt lgkmcnt(14)
    v_mfma_f32_16x16x32_bf16 v[24:27], v[48:51], v[112:115], 0
    ds_read_b128 v[184:187], v249 offset:0
    v_mfma_f32_16x16x32_bf16 v[28:31], v[48:51], v[116:119], 0
    ds_read_b128 v[200:203], v249 offset:8192
    v_mfma_f32_16x16x32_bf16 v[28:31], v[52:55], v[112:115], v[28:31]
    ds_read_b128 v[188:191], v249 offset:1024
    v_mfma_f32_16x16x32_bf16 v[32:35], v[52:55], v[116:119], 0
    s_add_u32 m0, s61, 49664
    ds_read_b128 v[204:207], v249 offset:9216
    v_mfma_f32_16x16x32_bf16 v[24:27], v[44:47], v[116:119], v[24:27]
    ds_read_b128 v[144:147], v5 offset:2624
    ds_read_b128 v[192:195], v249 offset:2048
    buffer_load_dwordx4 v226, s[40:43], s64 offen offset:2048 lds
    v_mfma_f32_16x16x32_bf16 v[24:27], v[52:55], v[108:111], v[24:27]
    s_add_u32 s64, s64, 98304
    ds_read_b64 v[80:81], v4 offset:1088
    ds_read_b128 v[208:211], v249 offset:10240
    v_mfma_f32_16x16x32_bf16 v[32:35], v[48:51], v[120:123], v[32:35]
    s_waitcnt lgkmcnt(12)
    s_sub_u32 s35, s64, 1966080
    ds_read_b64 v[82:83], v4 offset:1096
    ds_read_b128 v[196:199], v249 offset:3072
    v_mfma_f32_16x16x32_bf16 v[32:35], v[56:59], v[112:115], v[32:35]
    s_min_u32 s64, s64, s35
    ds_read_b128 v[148:151], v5 offset:2112
    ds_read_b128 v[212:215], v249 offset:11264
    v_mfma_f32_16x16x32_bf16 v[36:39], v[52:55], v[120:123], 0
    ds_read_b64 v[84:85], v4 offset:1600
    v_mfma_f32_16x16x32_bf16 v[36:39], v[56:59], v[116:119], v[36:39]
    ds_read_b64 v[86:87], v4 offset:1608
    v_mfma_f32_16x16x32_bf16 v[28:31], v[44:47], v[120:123], v[28:31]
    ds_read_b128 v[140:143], v5 offset:3136
    v_mfma_f32_16x16x32_bf16 v[28:31], v[56:59], v[108:111], v[28:31]
    ds_read_b64 v[76:77], v4 offset:576
    s_waitcnt vmcnt(7)
    v_cmp_ne_u32 vcc, s48, v233
    s_cbranch_vccnz L_m_slow
L_m_back:
    v_mov_b32_dpp v252, v232 quad_perm:[3,3,3,3] row_mask:0xf bank_mask:0xf
    s_nop 1
    v_mul_f32_dpp v251, v232, v252 quad_perm:[2,2,2,2] row_mask:0xf bank_mask:0xf
    s_nop 1
    v_mul_f32_dpp v250, v232, v251 quad_perm:[1,1,1,1] row_mask:0xf bank_mask:0xf
    v_mul_f32_dpp v251, v232, v251 quad_perm:[0,0,0,0] row_mask:0xf bank_mask:0xf
    v_permlane16_swap_b32 v176, v178
    v_permlane16_swap_b32 v177, v179
    v_permlane16_swap_b32 v180, v182
    v_permlane16_swap_b32 v181, v183
    v_lshlrev_b32 v232, 16, v176
    v_and_b32 v233, 0xffff0000, v176
    v_lshlrev_b32 v234, 16, v177
    v_and_b32 v235, 0xffff0000, v177
    s_waitcnt lgkmcnt(14)
    v_pk_fma_f32 v[184:185], v[232:233], v[184:185], v[200:201]
    v_pk_fma_f32 v[186:187], v[234:235], v[186:187], v[202:203]
    v_pk_mul_f32 v[200:201], v[232:233], v[252:253] op_sel_hi:[1,0]
    v_pk_mul_f32 v[202:203], v[234:235], v[252:253] op_sel_hi:[1,0]
    v_pk_fma_f32 v[184:185], v[184:185], v[250:251], v[250:251] op_sel:[0,0,1] op_sel_hi:[1,0,1]
    v_pk_fma_f32 v[186:187], v[186:187], v[250:251], v[250:251] op_sel:[0,0,1] op_sel_hi:[1,0,1]
    v_lshlrev_b32 v236, 16, v178
    v_and_b32 v237, 0xffff0000, v178
    v_lshlrev_b32 v238, 16, v179
    v_and_b32 v239, 0xffff0000, v179
    s_waitcnt lgkmcnt(12)
    v_pk_fma_f32 v[188:189], v[236:237], v[188:189], v[204:205]
    v_pk_fma_f32 v[190:191], v[238:239], v[190:191], v[206:207]
    v_pk_mul_f32 v[204:205], v[236:237], v[252:253] op_sel_hi:[1,0]
    v_pk_mul_f32 v[206:207], v[238:239], v[252:253] op_sel_hi:[1,0]
    v_pk_fma_f32 v[188:189], v[188:189], v[250:251], v[250:251] op_sel:[0,0,1] op_sel_hi:[1,0,1]
    v_pk_fma_f32 v[190:191], v[190:191], v[250:251], v[250:251] op_sel:[0,0,1] op_sel_hi:[1,0,1]
    v_lshlrev_b32 v232, 16, v180
    v_and_b32 v233, 0xffff0000, v180
    v_lshlrev_b32 v234, 16, v181
    v_and_b32 v235, 0xffff0000, v181
    s_waitcnt lgkmcnt(8)
    v_pk_fma_f32 v[192:193], v[232:233], v[192:193], v[208:209]
    v_pk_fma_f32 v[194:195], v[234:235], v[194:195], v[210:211]
    v_pk_mul_f32 v[208:209], v[232:233], v[252:253] op_sel_hi:[1,0]
    v_pk_mul_f32 v[210:211], v[234:235], v[252:253] op_sel_hi:[1,0]
    v_pk_fma_f32 v[192:193], v[192:193], v[250:251], v[250:251] op_sel:[0,0,1] op_sel_hi:[1,0,1]
    v_pk_fma_f32 v[194:195], v[194:195], v[250:251], v[250:251] op_sel:[0,0,1] op_sel_hi:[1,0,1]
    v_lshlrev_b32 v236, 16, v182
    v_and_b32 v237, 0xffff0000, v182
    v_lshlrev_b32 v238, 16, v183
    v_and_b32 v239, 0xffff0000, v183
    s_waitcnt lgkmcnt(4)
    v_pk_fma_f32 v[196:197], v[236:237], v[196:197], v[212:213]
    v_pk_fma_f32 v[198:199], v[238:239], v[198:199], v[214:215]
    v_pk_mul_f32 v[212:213], v[236:237], v[252:253] op_sel_hi:[1,0]
    v_pk_mul_f32 v[214:215], v[238:239], v[252:253] op_sel_hi:[1,0]
    v_pk_fma_f32 v[196:197], v[196:197], v[250:251], v[250:251] op_sel:[0,0,1] op_sel_hi:[1,0,1]
    v_pk_fma_f32 v[198:199], v[198:199], v[250:251], v[250:251] op_sel:[0,0,1] op_sel_hi:[1,0,1]
    v_pk_fma_f32 v[184:185], v[184:185], v[8:9], v[200:201]
    v_pk_fma_f32 v[186:187], v[186:187], v[10:11], v[202:203]
    v_cvt_pk_bf16_f32 v232, v184, v185
    v_cvt_pk_bf16_f32 v233, v186, v187
    v_pk_fma_f32 v[188:189], v[188:189], v[12:13], v[204:205]
    v_pk_fma_f32 v[190:191], v[190:191], v[14:15], v[206:207]
    v_cvt_pk_bf16_f32 v234, v188, v189
    v_cvt_pk_bf16_f32 v235, v190, v191
    s_nop 0
    v_permlane16_swap_b32 v232, v234
    v_permlane16_swap_b32 v233, v235
    buffer_store_dwordx4 v[232:235], v231, s[36:39], s68 offen offset:0 sc1
    v_pk_fma_f32 v[192:193], v[192:193], v[16:17], v[208:209]
    v_pk_fma_f32 v[194:195], v[194:195], v[18:19], v[210:211]
    v_cvt_pk_bf16_f32 v236, v192, v193
    v_cvt_pk_bf16_f32 v237, v194, v195
    v_pk_fma_f32 v[196:197], v[196:197], v[20:21], v[212:213]
    v_pk_fma_f32 v[198:199], v[198:199], v[22:23], v[214:215]
    v_cvt_pk_bf16_f32 v238, v196, v197
    v_cvt_pk_bf16_f32 v239, v198, v199
    s_nop 0
    v_permlane16_swap_b32 v236, v238
    v_permlane16_swap_b32 v237, v239
    buffer_store_dwordx4 v[236:239], v231, s[36:39], s68 offen offset:1024 sc1
    v_mfma_f32_16x16x32_bf16 v[24:27], v[40:43], v[120:123], v[24:27]
    ds_read_b64 v[78:79], v4 offset:584
    buffer_load_dwordx4 v[176:179], v231, s[36:39], s65 offen offset:2048 sc1
    v_mfma_f32_16x16x32_bf16 v[24:27], v[244:247], v[120:123], v[24:27]
    ds_read_b128 v[152:155], v5 offset:1600
    ds_read_b128 v[184:187], v249 offset:4096
    v_mfma_f32_16x16x32_bf16 v[24:27], v[56:59], v[104:107], v[24:27]
    ds_read_b64 v[88:89], v4 offset:2112
    ds_read_b128 v[200:203], v249 offset:12288
    v_mfma_f32_16x16x32_bf16 v[36:39], v[48:51], v[124:127], v[36:39]
    ds_read_b64 v[90:91], v4 offset:2120
    ds_read_b128 v[188:191], v249 offset:5120
    v_mfma_f32_16x16x32_bf16 v[36:39], v[60:63], v[112:115], v[36:39]
    ds_read_b128 v[136:139], v5 offset:3648
    ds_read_b128 v[204:207], v249 offset:13312
    v_mfma_f32_16x16x32_bf16 v[32:35], v[44:47], v[124:127], v[32:35]
    ds_read_b64 v[72:73], v4 offset:64
    ds_read_b128 v[192:195], v249 offset:6144
    buffer_load_dwordx4 v[180:183], v231, s[36:39], s65 offen offset:3072 sc1
    v_mfma_f32_16x16x32_bf16 v[32:35], v[60:63], v[108:111], v[32:35]
    s_barrier
    ds_read_b64 v[74:75], v4 offset:72
    ds_read_b128 v[208:211], v249 offset:14336
    ds_read_b64_tr_b16 a[60:61], v227 offset:0
    v_mfma_f32_16x16x32_bf16 v[28:31], v[40:43], v[124:127], v[28:31]
    ds_read_b128 v[156:159], v5 offset:1088
    ds_read_b128 v[196:199], v249 offset:7168
    ds_read_b64_tr_b16 a[62:63], v227 offset:1536
    v_mfma_f32_16x16x32_bf16 v[28:31], v[244:247], v[124:127], v[28:31]
    ds_read_b64 v[92:93], v4 offset:2624
    ds_read_b128 v[212:215], v249 offset:15360
    ds_read_b64_tr_b16 a[64:65], v227 offset:6224
    v_mfma_f32_16x16x32_bf16 v[28:31], v[60:63], v[104:107], v[28:31]
    ds_read_b64 v[94:95], v4 offset:2632
    buffer_load_dword v243, v241, s[36:39], s60 offen sc1
    v_mfma_f32_16x16x32_bf16 v[36:39], v[44:47], v[128:131], v[36:39]
    ds_read_b128 v[160:163], v5 offset:576
    ds_read_b64_tr_b16 a[66:67], v227 offset:7760
    v_mfma_f32_16x16x32_bf16 v[36:39], v[64:67], v[108:111], v[36:39]
    ds_read_b64 v[96:97], v4 offset:3136
    ds_read_b64_tr_b16 a[68:69], v228 offset:0
    v_mfma_f32_16x16x32_bf16 v[32:35], v[40:43], v[128:131], v[32:35]
    ds_read_b64 v[98:99], v4 offset:3144
    ds_read_b64_tr_b16 a[70:71], v228 offset:1536
    v_mfma_f32_16x16x32_bf16 v[32:35], v[244:247], v[128:131], v[32:35]
    ds_read_b128 v[164:167], v5 offset:64
    v_mfma_f32_16x16x32_bf16 v[32:35], v[64:67], v[104:107], v[32:35]
    ds_read_b64 v[100:101], v4 offset:3648
    v_mfma_f32_16x16x32_bf16 v[36:39], v[40:43], v[132:135], v[36:39]
    ds_read_b64 v[102:103], v4 offset:3656
    v_mfma_f32_16x16x32_bf16 v[36:39], v[244:247], v[132:135], v[36:39]
    v_mfma_f32_16x16x32_bf16 v[36:39], v[68:71], v[104:107], v[36:39]
    v_mfma_f32_16x16x32_bf16 v[24:27], v[80:83], v[144:147], v[24:27]
    ds_read_b128 v[112:115], v5 offset:2688
    v_mfma_f32_16x16x32_bf16 v[28:31], v[80:83], v[148:151], v[28:31]
    s_waitcnt lgkmcnt(13)
    ds_read_b64 v[48:49], v4 offset:1152
    v_mfma_f32_16x16x32_bf16 v[28:31], v[84:87], v[144:147], v[28:31]
    ds_read_b64 v[50:51], v4 offset:1160
    v_mfma_f32_16x16x32_bf16 v[32:35], v[84:87], v[148:151], v[32:35]
    ds_read_b128 v[116:119], v5 offset:2176
    v_mfma_f32_16x16x32_bf16 v[24:27], v[76:79], v[148:151], v[24:27]
    ds_read_b64 v[52:53], v4 offset:1664
    v_mfma_f32_16x16x32_bf16 v[24:27], v[84:87], v[140:143], v[24:27]
    ds_read_b64 v[54:55], v4 offset:1672
    v_mfma_f32_16x16x32_bf16 v[32:35], v[80:83], v[152:155], v[32:35]
    s_waitcnt lgkmcnt(9)
    s_barrier
    s_add_u32 m0, s61, 0
    ds_read_b128 v[108:111], v5 offset:3200
    v_mfma_f32_16x16x32_bf16 v[32:35], v[88:91], v[144:147], v[32:35]
    ds_read_b64 v[44:45], v4 offset:640
    ds_read_b64_tr_b16 a[72:73], v227 offset:12416
    buffer_load_dwordx4 v224, s[40:43], s64 offen offset:0 lds
    v_mfma_f32_16x16x32_bf16 v[36:39], v[84:87], v[152:155], v[36:39]
    ds_read_b64 v[46:47], v4 offset:648
    ds_read_b64_tr_b16 a[74:75], v227 offset:13952
    v_mfma_f32_16x16x32_bf16 v[36:39], v[88:91], v[148:151], v[36:39]
    ds_read_b128 v[120:123], v5 offset:1664
    ds_read_b64_tr_b16 a[76:77], v227 offset:18640
    v_mfma_f32_16x16x32_bf16 v[28:31], v[76:79], v[152:155], v[28:31]
    ds_read_b64 v[56:57], v4 offset:2176
    ds_read_b64_tr_b16 a[78:79], v227 offset:20176
    v_mfma_f32_16x16x32_bf16 v[28:31], v[88:91], v[140:143], v[28:31]
    ds_read_b64 v[58:59], v4 offset:2184
    ds_read_b64_tr_b16 a[80:81], v228 offset:12416
    v_mfma_f32_16x16x32_bf16 v[24:27], v[72:75], v[152:155], v[24:27]
    s_add_u32 m0, s61, 0
    ds_read_b128 v[104:107], v5 offset:3712
    ds_read_b64_tr_b16 a[82:83], v228 offset:13952
    v_mfma_f32_16x16x32_bf16 v[24:27], v[88:91], v[136:139], v[24:27]
    ds_read_b64 v[40:41], v4 offset:128
    buffer_load_dwordx4 v225, s[40:43], s64 offen offset:1024 lds
    v_mfma_f32_16x16x32_bf16 v[36:39], v[80:83], v[156:159], v[36:39]
    ds_read_b64 v[42:43], v4 offset:136
    v_mfma_f32_16x16x32_bf16 v[36:39], v[92:95], v[144:147], v[36:39]
    ds_read_b128 v[124:127], v5 offset:1152
    v_mfma_f32_16x16x32_bf16 v[32:35], v[76:79], v[156:159], v[32:35]
    ds_read_b64 v[60:61], v4 offset:2688
    v_mfma_f32_16x16x32_bf16 v[32:35], v[92:95], v[140:143], v[32:35]
    ds_read_b64 v[62:63], v4 offset:2696
    v_mfma_f32_16x16x32_bf16 v[28:31], v[72:75], v[156:159], v[28:31]
    s_add_u32 m0, s61, 0
    ds_read_b128 v[128:131], v5 offset:640
    v_mfma_f32_16x16x32_bf16 v[28:31], v[92:95], v[136:139], v[28:31]
    ds_read_b64 v[64:65], v4 offset:3200
    buffer_load_dwordx4 v226, s[40:43], s64 offen offset:2048 lds
    v_mfma_f32_16x16x32_bf16 v[36:39], v[76:79], v[160:163], v[36:39]
    s_add_u32 s64, s64, 98304
    ds_read_b64 v[66:67], v4 offset:3208
    v_mfma_f32_16x16x32_bf16 v[36:39], v[96:99], v[140:143], v[36:39]
    s_sub_u32 s35, s64, 1966080
    ds_read_b128 v[132:135], v5 offset:128
    v_mfma_f32_16x16x32_bf16 v[32:35], v[72:75], v[160:163], v[32:35]
    s_min_u32 s64, s64, s35
    ds_read_b64 v[68:69], v4 offset:3712
    v_mfma_f32_16x16x32_bf16 v[32:35], v[96:99], v[136:139], v[32:35]
    s_waitcnt lgkmcnt(13)
    ds_read_b64 v[70:71], v4 offset:3720
    v_mfma_f32_16x16x32_bf16 v[36:39], v[72:75], v[164:167], v[36:39]
    v_mfma_f32_16x16x32_bf16 v[36:39], v[100:103], v[136:139], v[36:39]
    s_waitcnt vmcnt(14)
    s_waitcnt lgkmcnt(11)
    s_barrier
    s_add_u32 m0, s61, 12416
    ds_read_b64_tr_b16 a[84:85], v227 offset:24832
    v_mfma_f32_16x16x32_bf16 v[24:27], v[48:51], v[112:115], v[24:27]
    s_waitcnt vmcnt(6)
    s_barrier
    s_cmp_eq_u32 s3, 0
    s_cbranch_scc0 L_wf5
    s_lshl_b32 s54, s70, 7
    s_add_u32 s54, s54, 23245824
    v_mov_b32 v254, 0
    v_mov_b32 v255, s48
    s_mov_b64 exec, 1
    buffer_store_dword v255, v254, s[36:39], s54 offen sc1
    s_mov_b64 exec, -1
L_wf5:
    ds_read_b128 v[144:147], v5 offset:2752
    buffer_load_dwordx4 v224, s[40:43], s64 offen offset:0 lds
    v_mfma_f32_16x16x32_bf16 v[28:31], v[48:51], v[116:119], v[28:31]
    ds_read_b64 v[80:81], v4 offset:1216
    ds_read_b64_tr_b16 a[86:87], v227 offset:26368
    v_mfma_f32_16x16x32_bf16 v[28:31], v[52:55], v[112:115], v[28:31]
    ds_read_b64 v[82:83], v4 offset:1224
    ds_read_b64_tr_b16 a[88:89], v227 offset:31056
    v_mfma_f32_16x16x32_bf16 v[32:35], v[52:55], v[116:119], v[32:35]
    ds_read_b128 v[148:151], v5 offset:2240
    ds_read_b64_tr_b16 a[90:91], v227 offset:32592
    v_mfma_f32_16x16x32_bf16 v[24:27], v[44:47], v[116:119], v[24:27]
    ds_read_b64 v[84:85], v4 offset:1728
    ds_read_b64_tr_b16 a[92:93], v228 offset:24832
    v_mfma_f32_16x16x32_bf16 v[24:27], v[52:55], v[108:111], v[24:27]
    s_add_u32 m0, s61, 12416
    ds_read_b64 v[86:87], v4 offset:1736
    ds_read_b64_tr_b16 a[94:95], v228 offset:26368
    v_mfma_f32_16x16x32_bf16 v[32:35], v[48:51], v[120:123], v[32:35]
    ds_read_b128 v[140:143], v5 offset:3264
    buffer_load_dwordx4 v225, s[40:43], s64 offen offset:1024 lds
    v_mfma_f32_16x16x32_bf16 v[32:35], v[56:59], v[112:115], v[32:35]
    ds_read_b64 v[76:77], v4 offset:704
    v_mfma_f32_16x16x32_bf16 v[36:39], v[52:55], v[120:123], v[36:39]
    ds_read_b64 v[78:79], v4 offset:712
    v_mfma_f32_16x16x32_bf16 v[36:39], v[56:59], v[116:119], v[36:39]
    ds_read_b128 v[152:155], v5 offset:1728
    v_mfma_f32_16x16x32_bf16 v[28:31], v[44:47], v[120:123], v[28:31]
    ds_read_b64 v[88:89], v4 offset:2240
    v_mfma_f32_16x16x32_bf16 v[28:31], v[56:59], v[108:111], v[28:31]
    s_add_u32 m0, s61, 12416
    ds_read_b64 v[90:91], v4 offset:2248
    s_waitcnt vmcnt(7)
    v_permlane16_swap_b32 v176, v178
    s_waitcnt lgkmcnt(14)
    v_mfma_f32_16x16x32_bf16 v[24:27], v[40:43], v[120:123], v[24:27]
    ds_read_b128 v[136:139], v5 offset:3776
    buffer_load_dwordx4 v226, s[40:43], s64 offen offset:2048 lds
    v_mfma_f32_16x16x32_bf16 v[24:27], v[56:59], v[104:107], v[24:27]
    s_add_u32 s64, s64, 98304
    ds_read_b64 v[72:73], v4 offset:192
    v_permlane16_swap_b32 v177, v179
    v_mfma_f32_16x16x32_bf16 v[36:39], v[48:51], v[124:127], v[36:39]
    s_sub_u32 s35, s64, 1966080
    ds_read_b64 v[74:75], v4 offset:200
    s_waitcnt vmcnt(7)
    v_permlane16_swap_b32 v180, v182
    v_mfma_f32_16x16x32_bf16 v[36:39], v[60:63], v[112:115], v[36:39]
    s_min_u32 s64, s64, s35
    ds_read_b128 v[156:159], v5 offset:1216
    v_permlane16_swap_b32 v181, v183
    s_waitcnt vmcnt(6)
    v_cmp_ne_u32 vcc, s48, v243
    s_cbranch_vccnz L_chk6_slow
L_chk6_back:
    v_mfma_f32_16x16x32_bf16 v[32:35], v[44:47], v[124:127], v[32:35]
    ds_read_b64 v[92:93], v4 offset:2752
    v_lshlrev_b32 v232, 16, v176
    v_lshlrev_b32 v2, 2, v0
    v_mov_b32 v3, 0x80000000
    v_cmp_gt_u32 vcc, 128, v0
    s_nop 1
    v_cndmask_b32 v3, v3, v2, vcc
    v_mfma_f32_16x16x32_bf16 v[32:35], v[60:63], v[108:111], v[32:35]
    s_lshl_b32 s56, s34, 7
    ds_read_b64 v[94:95], v4 offset:2760
    v_fma_f32 v184, v232, v184, v200
    v_mfma_f32_16x16x32_bf16 v[28:31], v[40:43], v[124:127], v[28:31]
    s_waitcnt lgkmcnt(12)
    s_barrier
    s_add_u32 m0, s61, 24832
    ds_read_b128 v[160:163], v5 offset:704
    v_mfma_f32_16x16x32_bf16 v[28:31], v[60:63], v[104:107], v[28:31]
    s_add_u32 s56, s56, 23183360
    ds_read_b64 v[96:97], v4 offset:3264
    ds_read_b64_tr_b16 a[96:97], v227 offset:37248
    buffer_load_dwordx4 v224, s[40:43], s64 offen offset:0 lds
    v_mfma_f32_16x16x32_bf16 v[36:39], v[44:47], v[128:131], v[36:39]
    ds_read_b64 v[98:99], v4 offset:3272
    ds_read_b64_tr_b16 a[98:99], v227 offset:38784
    buffer_load_dword v220, v2, s[36:39], s56 offen sc1
    v_mfma_f32_16x16x32_bf16 v[36:39], v[64:67], v[108:111], v[36:39]
    ds_read_b128 v[164:167], v5 offset:192
    ds_read_b64_tr_b16 a[100:101], v227 offset:43472
    buffer_load_dword v221, v2, s[36:39], s56 offen offset:1024 sc1
    v_mfma_f32_16x16x32_bf16 v[32:35], v[40:43], v[128:131], v[32:35]
    ds_read_b64 v[100:101], v4 offset:3776
    ds_read_b64_tr_b16 a[102:103], v227 offset:45008
    buffer_load_dword v222, v3, s[36:39], s56 offen offset:2048 sc1
    v_mfma_f32_16x16x32_bf16 v[32:35], v[64:67], v[104:107], v[32:35]
    ds_read_b64 v[102:103], v4 offset:3784
    ds_read_b64_tr_b16 a[104:105], v228 offset:37248
    v_mfma_f32_16x16x32_bf16 v[36:39], v[40:43], v[132:135], v[36:39]
    s_add_u32 m0, s61, 24832
    ds_read_b64_tr_b16 a[106:107], v228 offset:38784
    v_mul_f32 v200, v252, v232
    v_mfma_f32_16x16x32_bf16 v[36:39], v[68:71], v[104:107], v[36:39]
    buffer_load_dwordx4 v225, s[40:43], s64 offen offset:1024 lds
    v_mfma_f32_16x16x32_bf16 v[24:27], v[80:83], v[144:147], v[24:27]
    ds_read_b128 v[112:115], v5 offset:2816
    v_fma_f32 v184, v184, v250, v251
    v_mfma_f32_16x16x32_bf16 v[28:31], v[80:83], v[148:151], v[28:31]
    ds_read_b64 v[48:49], v4 offset:1280
    v_and_b32 v233, 0xffff0000, v176
    v_mfma_f32_16x16x32_bf16 v[28:31], v[84:87], v[144:147], v[28:31]
    ds_read_b64 v[50:51], v4 offset:1288
    v_fma_f32 v185, v233, v185, v201
    v_mfma_f32_16x16x32_bf16 v[32:35], v[84:87], v[148:151], v[32:35]
    s_waitcnt lgkmcnt(13)
    ds_read_b128 v[116:119], v5 offset:2304
    v_mul_f32 v201, v252, v233
    v_mfma_f32_16x16x32_bf16 v[24:27], v[76:79], v[148:151], v[24:27]
    s_add_u32 m0, s61, 24832
    ds_read_b64 v[52:53], v4 offset:1792
    v_fma_f32 v185, v185, v250, v251
    v_mfma_f32_16x16x32_bf16 v[24:27], v[84:87], v[140:143], v[24:27]
    ds_read_b64 v[54:55], v4 offset:1800
    buffer_load_dwordx4 v226, s[40:43], s64 offen offset:2048 lds
    v_mfma_f32_16x16x32_bf16 v[32:35], v[80:83], v[152:155], v[32:35]
    s_add_u32 s64, s64, 98304
    ds_read_b128 v[108:111], v5 offset:3328
    v_lshlrev_b32 v232, 16, v177
    v_mfma_f32_16x16x32_bf16 v[32:35], v[88:91], v[144:147], v[32:35]
    s_sub_u32 s35, s64, 1966080
    ds_read_b64 v[44:45], v4 offset:768
    v_fma_f32 v186, v232, v186, v202
    v_mfma_f32_16x16x32_bf16 v[36:39], v[84:87], v[152:155], v[36:39]
    s_min_u32 s64, s64, s35
    ds_read_b64 v[46:47], v4 offset:776
    v_mul_f32 v202, v252, v232
    v_mfma_f32_16x16x32_bf16 v[36:39], v[88:91], v[148:151], v[36:39]
    ds_read_b128 v[120:123], v5 offset:1792
    v_fma_f32 v186, v186, v250, v251
    v_mfma_f32_16x16x32_bf16 v[28:31], v[76:79], v[152:155], v[28:31]
    s_waitcnt lgkmcnt(10)
    s_barrier
    s_add_u32 m0, s61, 37248
    ds_read_b64 v[56:57], v4 offset:2304
    v_mfma_f32_16x16x32_bf16 v[28:31], v[88:91], v[140:143], v[28:31]
    ds_read_b64 v[58:59], v4 offset:2312
    ds_read_b64_tr_b16 a[108:109], v227 offset:49664
    buffer_load_dwordx4 v224, s[40:43], s64 offen offset:0 lds
    v_mfma_f32_16x16x32_bf16 v[24:27], v[72:75], v[152:155], v[24:27]
    ds_read_b128 v[104:107], v5 offset:3840
    ds_read_b64_tr_b16 a[110:111], v227 offset:51200
    v_mfma_f32_16x16x32_bf16 v[24:27], v[88:91], v[136:139], v[24:27]
    ds_read_b64 v[40:41], v4 offset:256
    ds_read_b64_tr_b16 a[112:113], v227 offset:55888
    v_mfma_f32_16x16x32_bf16 v[36:39], v[80:83], v[156:159], v[36:39]
    ds_read_b64 v[42:43], v4 offset:264
    ds_read_b64_tr_b16 a[114:115], v227 offset:57424
    v_mfma_f32_16x16x32_bf16 v[36:39], v[92:95], v[144:147], v[36:39]
    s_add_u32 m0, s61, 37248
    ds_read_b128 v[124:127], v5 offset:1280
    ds_read_b64_tr_b16 a[116:117], v228 offset:49664
    v_mfma_f32_16x16x32_bf16 v[32:35], v[76:79], v[156:159], v[32:35]
    ds_read_b64 v[60:61], v4 offset:2816
    ds_read_b64_tr_b16 a[118:119], v228 offset:51200
    buffer_load_dwordx4 v225, s[40:43], s64 offen offset:1024 lds
    v_mfma_f32_16x16x32_bf16 v[32:35], v[92:95], v[140:143], v[32:35]
    ds_read_b64 v[62:63], v4 offset:2824
    v_and_b32 v233, 0xffff0000, v177
    v_mfma_f32_16x16x32_bf16 v[28:31], v[72:75], v[156:159], v[28:31]
    ds_read_b128 v[128:131], v5 offset:768
    v_fma_f32 v187, v233, v187, v203
    v_mfma_f32_16x16x32_bf16 v[28:31], v[92:95], v[136:139], v[28:31]
    ds_read_b64 v[64:65], v4 offset:3328
    v_mul_f32 v203, v252, v233
    v_mfma_f32_16x16x32_bf16 v[36:39], v[76:79], v[160:163], v[36:39]
    ds_read_b64 v[66:67], v4 offset:3336
    v_fma_f32 v187, v187, v250, v251
    v_mfma_f32_16x16x32_bf16 v[36:39], v[96:99], v[140:143], v[36:39]
    s_add_u32 m0, s61, 37248
    ds_read_b128 v[132:135], v5 offset:256
    v_lshlrev_b32 v232, 16, v178
    v_mfma_f32_16x16x32_bf16 v[32:35], v[72:75], v[160:163], v[32:35]
    ds_read_b64 v[68:69], v4 offset:3840
    buffer_load_dwordx4 v226, s[40:43], s64 offen offset:2048 lds
    v_mfma_f32_16x16x32_bf16 v[32:35], v[96:99], v[136:139], v[32:35]
    s_add_u32 s64, s64, 98304
    ds_read_b64 v[70:71], v4 offset:3848
    v_fma_f32 v188, v232, v188, v204
    v_mfma_f32_16x16x32_bf16 v[36:39], v[72:75], v[164:167], v[36:39]
    s_sub_u32 s35, s64, 1966080
    v_mul_f32 v204, v252, v232
    v_fma_f32 v188, v188, v250, v251
    v_mfma_f32_16x16x32_bf16 v[36:39], v[100:103], v[136:139], v[36:39]
    s_waitcnt lgkmcnt(14)
    s_min_u32 s64, s64, s35
    v_and_b32 v233, 0xffff0000, v178
    v_fma_f32 v189, v233, v189, v205
    v_mfma_f32_16x16x32_bf16 v[24:27], v[48:51], v[112:115], v[24:27]
    ds_read_b128 v[144:147], v5 offset:2880
    v_mul_f32 v205, v252, v233
    v_mfma_f32_16x16x32_bf16 v[28:31], v[48:51], v[116:119], v[28:31]
    ds_read_b64 v[80:81], v4 offset:1344
    v_fma_f32 v189, v189, v250, v251
    v_mfma_f32_16x16x32_bf16 v[28:31], v[52:55], v[112:115], v[28:31]
    ds_read_b64 v[82:83], v4 offset:1352
    v_lshlrev_b32 v232, 16, v179
    v_mfma_f32_16x16x32_bf16 v[32:35], v[52:55], v[116:119], v[32:35]
    s_waitcnt vmcnt(12)
    s_waitcnt lgkmcnt(10)
    s_barrier
    s_add_u32 m0, s61, 49664
    ds_read_b128 v[148:151], v5 offset:2368
    v_mfma_f32_16x16x32_bf16 v[24:27], v[44:47], v[116:119], v[24:27]
    ds_read_b64 v[84:85], v4 offset:1856
    ds_read_b64_tr_b16 a[120:121], v227 offset:0
    buffer_load_dwordx4 v224, s[40:43], s64 offen offset:0 lds
    v_mfma_f32_16x16x32_bf16 v[24:27], v[52:55], v[108:111], v[24:27]
    ds_read_b64 v[86:87], v4 offset:1864
    ds_read_b64_tr_b16 a[122:123], v227 offset:1536
    v_mfma_f32_16x16x32_bf16 v[32:35], v[48:51], v[120:123], v[32:35]
    ds_read_b128 v[140:143], v5 offset:3392
    ds_read_b64_tr_b16 a[124:125], v227 offset:6224
    v_mfma_f32_16x16x32_bf16 v[32:35], v[56:59], v[112:115], v[32:35]
    ds_read_b64 v[76:77], v4 offset:832
    ds_read_b64_tr_b16 a[126:127], v227 offset:7760
    v_mfma_f32_16x16x32_bf16 v[36:39], v[52:55], v[120:123], v[36:39]
    ds_read_b64 v[78:79], v4 offset:840
    ds_read_b64_tr_b16 a[128:129], v228 offset:0
    v_mfma_f32_16x16x32_bf16 v[36:39], v[56:59], v[116:119], v[36:39]
    s_add_u32 m0, s61, 49664
    ds_read_b128 v[152:155], v5 offset:1856
    ds_read_b64_tr_b16 a[130:131], v228 offset:1536
    v_mfma_f32_16x16x32_bf16 v[28:31], v[44:47], v[120:123], v[28:31]
    ds_read_b64 v[88:89], v4 offset:2368
    buffer_load_dwordx4 v225, s[40:43], s64 offen offset:1024 lds
    v_mfma_f32_16x16x32_bf16 v[28:31], v[56:59], v[108:111], v[28:31]
    ds_read_b64 v[90:91], v4 offset:2376
    v_fma_f32 v190, v232, v190, v206
    v_mfma_f32_16x16x32_bf16 v[24:27], v[40:43], v[120:123], v[24:27]
    ds_read_b128 v[136:139], v5 offset:3904
    v_mul_f32 v206, v252, v232
    v_mfma_f32_16x16x32_bf16 v[24:27], v[56:59], v[104:107], v[24:27]
    ds_read_b64 v[72:73], v4 offset:320
    v_fma_f32 v190, v190, v250, v251
    v_mfma_f32_16x16x32_bf16 v[36:39], v[48:51], v[124:127], v[36:39]
    s_waitcnt lgkmcnt(13)
    ds_read_b64 v[74:75], v4 offset:328
    v_and_b32 v233, 0xffff0000, v179
    v_mfma_f32_16x16x32_bf16 v[36:39], v[60:63], v[112:115], v[36:39]
    s_add_u32 m0, s61, 49664
    ds_read_b128 v[156:159], v5 offset:1344
    v_fma_f32 v191, v233, v191, v207
    v_mfma_f32_16x16x32_bf16 v[32:35], v[44:47], v[124:127], v[32:35]
    ds_read_b64 v[92:93], v4 offset:2880
    buffer_load_dwordx4 v226, s[40:43], s64 offen offset:2048 lds
    v_mfma_f32_16x16x32_bf16 v[32:35], v[60:63], v[108:111], v[32:35]
    s_add_u32 s64, s64, 98304
    ds_read_b64 v[94:95], v4 offset:2888
    v_mul_f32 v207, v252, v233
    v_mfma_f32_16x16x32_bf16 v[28:31], v[40:43], v[124:127], v[28:31]
    s_sub_u32 s35, s64, 1966080
    ds_read_b128 v[160:163], v5 offset:832
    v_fma_f32 v191, v191, v250, v251
    v_mfma_f32_16x16x32_bf16 v[28:31], v[60:63], v[104:107], v[28:31]
    s_min_u32 s64, s64, s35
    ds_read_b64 v[96:97], v4 offset:3392
    v_lshlrev_b32 v232, 16, v180
    v_mfma_f32_16x16x32_bf16 v[36:39], v[44:47], v[128:131], v[36:39]
    ds_read_b64 v[98:99], v4 offset:3400
    v_fma_f32 v192, v232, v192, v208
    v_mfma_f32_16x16x32_bf16 v[36:39], v[64:67], v[108:111], v[36:39]
    ds_read_b128 v[164:167], v5 offset:320
    v_mul_f32 v208, v252, v232
    v_mfma_f32_16x16x32_bf16 v[32:35], v[40:43], v[128:131], v[32:35]
    s_waitcnt vmcnt(12)
    s_waitcnt lgkmcnt(12)
    s_barrier
    ds_read_b64 v[100:101], v4 offset:3904
    v_mfma_f32_16x16x32_bf16 v[32:35], v[64:67], v[104:107], v[32:35]
    ds_read_b64 v[102:103], v4 offset:3912
    ds_read_b64_tr_b16 a[132:133], v227 offset:12416
    v_mfma_f32_16x16x32_bf16 v[36:39], v[40:43], v[132:135], v[36:39]
    ds_read_b64_tr_b16 a[134:135], v227 offset:13952
    buffer_load_dword v223, v219, s[36:39], s17 offen sc1
    v_mfma_f32_16x16x32_bf16 v[36:39], v[68:71], v[104:107], v[36:39]
    ds_read_b64_tr_b16 a[136:137], v227 offset:18640
    v_fma_f32 v192, v192, v250, v251
    v_mfma_f32_16x16x32_bf16 v[24:27], v[80:83], v[144:147], v[24:27]
    ds_read_b128 v[112:115], v5 offset:2944
    ds_read_b64_tr_b16 a[138:139], v227 offset:20176
    v_mfma_f32_16x16x32_bf16 v[28:31], v[80:83], v[148:151], v[28:31]
    ds_read_b64 v[48:49], v4 offset:1408
    ds_read_b64_tr_b16 a[140:141], v228 offset:12416
    v_mfma_f32_16x16x32_bf16 v[28:31], v[84:87], v[144:147], v[28:31]
    ds_read_b64 v[50:51], v4 offset:1416
    ds_read_b64_tr_b16 a[142:143], v228 offset:13952
    v_mfma_f32_16x16x32_bf16 v[32:35], v[84:87], v[148:151], v[32:35]
    ds_read_b128 v[116:119], v5 offset:2432
    v_and_b32 v233, 0xffff0000, v180
    v_mfma_f32_16x16x32_bf16 v[24:27], v[76:79], v[148:151], v[24:27]
    ds_read_b64 v[52:53], v4 offset:1920
    v_fma_f32 v193, v233, v193, v209
    v_mfma_f32_16x16x32_bf16 v[24:27], v[84:87], v[140:143], v[24:27]
    ds_read_b64 v[54:55], v4 offset:1928
    v_mul_f32 v209, v252, v233
    v_mfma_f32_16x16x32_bf16 v[32:35], v[80:83], v[152:155], v[32:35]
    s_waitcnt lgkmcnt(13)
    ds_read_b128 v[108:111], v5 offset:3456
    v_fma_f32 v193, v193, v250, v251
    v_mfma_f32_16x16x32_bf16 v[32:35], v[88:91], v[144:147], v[32:35]
    ds_read_b64 v[44:45], v4 offset:896
    v_lshlrev_b32 v232, 16, v181
    v_mfma_f32_16x16x32_bf16 v[36:39], v[84:87], v[152:155], v[36:39]
    ds_read_b64 v[46:47], v4 offset:904
    v_fma_f32 v194, v232, v194, v210
    v_mfma_f32_16x16x32_bf16 v[36:39], v[88:91], v[148:151], v[36:39]
    ds_read_b128 v[120:123], v5 offset:1920
    v_mul_f32 v210, v252, v232
    v_mfma_f32_16x16x32_bf16 v[28:31], v[76:79], v[152:155], v[28:31]
    ds_read_b64 v[56:57], v4 offset:2432
    v_fma_f32 v194, v194, v250, v251
    v_mfma_f32_16x16x32_bf16 v[28:31], v[88:91], v[140:143], v[28:31]
    ds_read_b64 v[58:59], v4 offset:2440
    v_and_b32 v233, 0xffff0000, v181
    v_mfma_f32_16x16x32_bf16 v[24:27], v[72:75], v[152:155], v[24:27]
    ds_read_b128 v[104:107], v5 offset:3968
    v_fma_f32 v195, v233, v195, v211
    v_mfma_f32_16x16x32_bf16 v[24:27], v[88:91], v[136:139], v[24:27]
    ds_read_b64 v[40:41], v4 offset:384
    v_mul_f32 v211, v252, v233
    v_mfma_f32_16x16x32_bf16 v[36:39], v[80:83], v[156:159], v[36:39]
    s_waitcnt vmcnt(7)
    s_waitcnt lgkmcnt(11)
    s_barrier
    ds_read_b64 v[42:43], v4 offset:392
    v_mfma_f32_16x16x32_bf16 v[36:39], v[92:95], v[144:147], v[36:39]
    ds_read_b128 v[124:127], v5 offset:1408
    ds_read_b64_tr_b16 a[144:145], v227 offset:24832
    v_mfma_f32_16x16x32_bf16 v[32:35], v[76:79], v[156:159], v[32:35]
    ds_read_b64 v[60:61], v4 offset:2944
    ds_read_b64_tr_b16 a[146:147], v227 offset:26368
    v_mfma_f32_16x16x32_bf16 v[32:35], v[92:95], v[140:143], v[32:35]
    ds_read_b64 v[62:63], v4 offset:2952
    ds_read_b64_tr_b16 a[148:149], v227 offset:31056
    v_mfma_f32_16x16x32_bf16 v[28:31], v[72:75], v[156:159], v[28:31]
    ds_read_b128 v[128:131], v5 offset:896
    ds_read_b64_tr_b16 a[150:151], v227 offset:32592
    v_mfma_f32_16x16x32_bf16 v[28:31], v[92:95], v[136:139], v[28:31]
    ds_read_b64 v[64:65], v4 offset:3456
    ds_read_b64_tr_b16 a[152:153], v228 offset:24832
    v_mfma_f32_16x16x32_bf16 v[36:39], v[76:79], v[160:163], v[36:39]
    ds_read_b64 v[66:67], v4 offset:3464
    ds_read_b64_tr_b16 a[154:155], v228 offset:26368
    v_mfma_f32_16x16x32_bf16 v[36:39], v[96:99], v[140:143], v[36:39]
    ds_read_b128 v[132:135], v5 offset:384
    v_fma_f32 v195, v195, v250, v251
    v_mfma_f32_16x16x32_bf16 v[32:35], v[72:75], v[160:163], v[32:35]
    s_add_u32 m0, s63, 0
    ds_read_b64 v[68:69], v4 offset:3968
    s_waitcnt vmcnt(0)
    v_cmp_ne_u32 vcc, s48, v223
    s_cbranch_vccnz L_chk7_slow
L_chk7_back:
    v_mfma_f32_16x16x32_bf16 v[32:35], v[96:99], v[136:139], v[32:35]
    ds_read_b64 v[70:71], v4 offset:3976
    buffer_load_dwordx4 v172, s[36:39], s10 offen sc1 lds
    v_mfma_f32_16x16x32_bf16 v[36:39], v[72:75], v[164:167], v[36:39]
    v_lshlrev_b32 v232, 16, v182
    v_fma_f32 v196, v232, v196, v212
    v_mfma_f32_16x16x32_bf16 v[36:39], v[100:103], v[136:139], v[36:39]
    v_mul_f32 v212, v252, v232
    v_fma_f32 v196, v196, v250, v251
    v_mfma_f32_16x16x32_bf16 v[24:27], v[48:51], v[112:115], v[24:27]
    s_waitcnt lgkmcnt(13)
    ds_read_b128 v[144:147], v5 offset:3008
    v_and_b32 v233, 0xffff0000, v182
    v_mfma_f32_16x16x32_bf16 v[28:31], v[48:51], v[116:119], v[28:31]
    s_add_u32 m0, s63, 4096
    ds_read_b64 v[80:81], v4 offset:1472
    v_fma_f32 v197, v233, v197, v213
    v_mfma_f32_16x16x32_bf16 v[28:31], v[52:55], v[112:115], v[28:31]
    ds_read_b64 v[82:83], v4 offset:1480
    buffer_load_dwordx4 v172, s[36:39], s11 offen sc1 lds
    v_mfma_f32_16x16x32_bf16 v[32:35], v[52:55], v[116:119], v[32:35]
    ds_read_b128 v[148:151], v5 offset:2496
    v_mul_f32 v213, v252, v233
    v_mfma_f32_16x16x32_bf16 v[24:27], v[44:47], v[116:119], v[24:27]
    ds_read_b64 v[84:85], v4 offset:1984
    v_fma_f32 v197, v197, v250, v251
    v_mfma_f32_16x16x32_bf16 v[24:27], v[52:55], v[108:111], v[24:27]
    s_add_u32 m0, s63, 8192
    ds_read_b64 v[86:87], v4 offset:1992
    v_lshlrev_b32 v232, 16, v183
    v_mfma_f32_16x16x32_bf16 v[32:35], v[48:51], v[120:123], v[32:35]
    ds_read_b128 v[140:143], v5 offset:3520
    buffer_load_dwordx4 v172, s[36:39], s12 offen sc1 lds
    v_mfma_f32_16x16x32_bf16 v[32:35], v[56:59], v[112:115], v[32:35]
    s_waitcnt lgkmcnt(10)
    s_barrier
    ds_read_b64 v[76:77], v4 offset:960
    v_mfma_f32_16x16x32_bf16 v[36:39], v[52:55], v[120:123], v[36:39]
    ds_read_b64 v[78:79], v4 offset:968
    ds_read_b64_tr_b16 a[156:157], v227 offset:37248
    v_mfma_f32_16x16x32_bf16 v[36:39], v[56:59], v[116:119], v[36:39]
    ds_read_b128 v[152:155], v5 offset:1984
    ds_read_b64_tr_b16 a[158:159], v227 offset:38784
    v_mfma_f32_16x16x32_bf16 v[28:31], v[44:47], v[120:123], v[28:31]
    s_add_u32 m0, s63, 12288
    ds_read_b64 v[88:89], v4 offset:2496
    ds_read_b64_tr_b16 a[160:161], v227 offset:43472
    v_mfma_f32_16x16x32_bf16 v[28:31], v[56:59], v[108:111], v[28:31]
    ds_read_b64 v[90:91], v4 offset:2504
    ds_read_b64_tr_b16 a[162:163], v227 offset:45008
    buffer_load_dwordx4 v172, s[36:39], s13 offen sc1 lds
    v_mfma_f32_16x16x32_bf16 v[24:27], v[40:43], v[120:123], v[24:27]
    ds_read_b128 v[136:139], v5 offset:4032
    ds_read_b64_tr_b16 a[164:165], v228 offset:37248
    v_mfma_f32_16x16x32_bf16 v[24:27], v[56:59], v[104:107], v[24:27]
    ds_read_b64 v[72:73], v4 offset:448
    ds_read_b64_tr_b16 a[166:167], v228 offset:38784
    v_mfma_f32_16x16x32_bf16 v[36:39], v[48:51], v[124:127], v[36:39]
    s_add_u32 m0, s63, 16384
    ds_read_b64 v[74:75], v4 offset:456
    v_fma_f32 v198, v232, v198, v214
    v_mfma_f32_16x16x32_bf16 v[36:39], v[60:63], v[112:115], v[36:39]
    ds_read_b128 v[156:159], v5 offset:1472
    buffer_load_dwordx4 v172, s[36:39], s14 offen sc1 lds
    v_mfma_f32_16x16x32_bf16 v[32:35], v[44:47], v[124:127], v[32:35]
    ds_read_b64 v[92:93], v4 offset:3008
    v_mul_f32 v214, v252, v232
    v_mfma_f32_16x16x32_bf16 v[32:35], v[60:63], v[108:111], v[32:35]
    ds_read_b64 v[94:95], v4 offset:3016
    v_fma_f32 v198, v198, v250, v251
    v_mfma_f32_16x16x32_bf16 v[28:31], v[40:43], v[124:127], v[28:31]
    ds_read_b128 v[160:163], v5 offset:960
    v_and_b32 v233, 0xffff0000, v183
    v_mfma_f32_16x16x32_bf16 v[28:31], v[60:63], v[104:107], v[28:31]
    s_add_u32 m0, s63, 20480
    ds_read_b64 v[96:97], v4 offset:3520
    v_fma_f32 v199, v233, v199, v215
    v_mfma_f32_16x16x32_bf16 v[36:39], v[44:47], v[128:131], v[36:39]
    ds_read_b64 v[98:99], v4 offset:3528
    buffer_load_dwordx4 v172, s[36:39], s15 offen sc1 lds
    v_mfma_f32_16x16x32_bf16 v[36:39], v[64:67], v[108:111], v[36:39]
    ds_read_b128 v[164:167], v5 offset:448
    v_mul_f32 v215, v252, v233
    v_mfma_f32_16x16x32_bf16 v[32:35], v[40:43], v[128:131], v[32:35]
    ds_read_b64 v[100:101], v4 offset:4032
    v_fma_f32 v199, v199, v250, v251
    v_mfma_f32_16x16x32_bf16 v[32:35], v[64:67], v[104:107], v[32:35]
    s_waitcnt lgkmcnt(13)
    s_add_u32 m0, s63, 24576
    ds_read_b64 v[102:103], v4 offset:4040
    v_mfma_f32_16x16x32_bf16 v[36:39], v[40:43], v[132:135], v[36:39]
    buffer_load_dwordx4 v172, s[36:39], s18 offen sc1 lds
    v_mfma_f32_16x16x32_bf16 v[36:39], v[68:71], v[104:107], v[36:39]
    v_mfma_f32_16x16x32_bf16 v[24:27], v[80:83], v[144:147], v[24:27]
    s_waitcnt lgkmcnt(10)
    s_barrier
    ds_read_b64_tr_b16 a[168:169], v227 offset:49664
    v_mfma_f32_16x16x32_bf16 v[28:31], v[80:83], v[148:151], v[28:31]
    ds_read_b64_tr_b16 a[170:171], v227 offset:51200
    v_mfma_f32_16x16x32_bf16 v[28:31], v[84:87], v[144:147], v[28:31]
    s_add_u32 m0, s63, 28672
    ds_read_b64_tr_b16 a[172:173], v227 offset:55888
    v_mfma_f32_16x16x32_bf16 v[32:35], v[84:87], v[148:151], v[32:35]
    ds_read_b64_tr_b16 a[174:175], v227 offset:57424
    buffer_load_dwordx4 v172, s[36:39], s19 offen sc1 lds
    v_mfma_f32_16x16x32_bf16 v[24:27], v[76:79], v[148:151], v[24:27]
    ds_read_b64_tr_b16 a[176:177], v228 offset:49664
    v_mfma_f32_16x16x32_bf16 v[24:27], v[84:87], v[140:143], v[24:27]
    ds_read_b64_tr_b16 a[178:179], v228 offset:51200
    v_mfma_f32_16x16x32_bf16 v[32:35], v[80:83], v[152:155], v[32:35]
    s_add_u32 m0, s63, 32768
    v_mfma_f32_16x16x32_bf16 v[32:35], v[88:91], v[144:147], v[32:35]
    buffer_load_dwordx4 v172, s[36:39], s20 offen sc1 lds
    v_mfma_f32_16x16x32_bf16 v[36:39], v[84:87], v[152:155], v[36:39]
    v_mfma_f32_16x16x32_bf16 v[36:39], v[88:91], v[148:151], v[36:39]
    s_waitcnt lgkmcnt(0)
    s_barrier
    v_mfma_f32_16x16x32_bf16 v[28:31], v[76:79], v[152:155], v[28:31]
    v_mfma_f32_16x16x32_bf16 v[28:31], v[88:91], v[140:143], v[28:31]
    s_add_u32 m0, s63, 36864
    v_mfma_f32_16x16x32_bf16 v[24:27], v[72:75], v[152:155], v[24:27]
    buffer_load_dwordx4 v172, s[36:39], s21 offen sc1 lds
    v_mfma_f32_16x16x32_bf16 v[24:27], v[88:91], v[136:139], v[24:27]
    v_mfma_f32_16x16x32_bf16 v[36:39], v[80:83], v[156:159], v[36:39]
    v_mfma_f32_16x16x32_bf16 v[36:39], v[92:95], v[144:147], v[36:39]
    s_add_u32 m0, s63, 40960
    v_mfma_f32_16x16x32_bf16 v[32:35], v[76:79], v[156:159], v[32:35]
    buffer_load_dwordx4 v172, s[36:39], s22 offen sc1 lds
    v_mfma_f32_16x16x32_bf16 v[32:35], v[92:95], v[140:143], v[32:35]
    v_mfma_f32_16x16x32_bf16 v[28:31], v[72:75], v[156:159], v[28:31]
    v_mfma_f32_16x16x32_bf16 v[28:31], v[92:95], v[136:139], v[28:31]
    v_mfma_f32_16x16x32_bf16 v[36:39], v[76:79], v[160:163], v[36:39]
    s_add_u32 m0, s63, 45056
    v_mfma_f32_16x16x32_bf16 v[36:39], v[96:99], v[140:143], v[36:39]
    buffer_load_dwordx4 v172, s[36:39], s23 offen sc1 lds
    v_mfma_f32_16x16x32_bf16 v[32:35], v[72:75], v[160:163], v[32:35]
    v_mfma_f32_16x16x32_bf16 v[32:35], v[96:99], v[136:139], v[32:35]
    v_mfma_f32_16x16x32_bf16 v[36:39], v[72:75], v[164:167], v[36:39]
    v_mfma_f32_16x16x32_bf16 v[36:39], v[100:103], v[136:139], v[36:39]
    s_waitcnt vmcnt(9)
    s_waitcnt lgkmcnt(0)
    s_barrier
    ds_read_b64_tr_b16 v[104:105], v168 offset:0
    ds_read_b64_tr_b16 v[106:107], v168 offset:2048
    ds_read_b64_tr_b16 v[108:109], v169 offset:0
    ds_read_b64_tr_b16 v[110:111], v169 offset:2048
    ds_read_b64_tr_b16 v[112:113], v170 offset:0
    ds_read_b64_tr_b16 v[114:115], v170 offset:2048
    ds_read_b64_tr_b16 v[116:117], v171 offset:0
    ds_read_b64_tr_b16 v[118:119], v171 offset:2048
    v_pk_fma_f32 v[184:185], v[184:185], v[24:25], v[200:201]
    v_pk_fma_f32 v[186:187], v[186:187], v[26:27], v[202:203]
    v_cvt_pk_bf16_f32 v232, v184, v185
    v_cvt_pk_bf16_f32 v233, v186, v187
    v_pk_fma_f32 v[188:189], v[188:189], v[28:29], v[204:205]
    v_pk_fma_f32 v[190:191], v[190:191], v[30:31], v[206:207]
    v_cvt_pk_bf16_f32 v234, v188, v189
    v_cvt_pk_bf16_f32 v235, v190, v191
    s_nop 0
    v_permlane16_swap_b32 v232, v234
    v_permlane16_swap_b32 v233, v235
    buffer_store_dwordx4 v[232:235], v231, s[36:39], s68 offen offset:2048 sc1
    v_pk_fma_f32 v[192:193], v[192:193], v[32:33], v[208:209]
    v_pk_fma_f32 v[194:195], v[194:195], v[34:35], v[210:211]
    v_cvt_pk_bf16_f32 v236, v192, v193
    v_cvt_pk_bf16_f32 v237, v194, v195
    v_pk_fma_f32 v[196:197], v[196:197], v[36:37], v[212:213]
    v_pk_fma_f32 v[198:199], v[198:199], v[38:39], v[214:215]
    v_cvt_pk_bf16_f32 v238, v196, v197
    v_cvt_pk_bf16_f32 v239, v198, v199
    s_nop 0
    v_permlane16_swap_b32 v236, v238
    v_permlane16_swap_b32 v237, v239
    buffer_store_dwordx4 v[236:239], v231, s[36:39], s68 offen offset:3072 sc1
    v_mov_b32 v200, v224
    v_mov_b32 v201, v225
    v_mov_b32 v202, v226
    v_add_u32 v203, 101760, v227
    v_add_u32 v204, 101760, v228
    s_waitcnt lgkmcnt(6)
    v_mfma_f32_16x16x32_bf16 v[56:59], a[0:3], v[104:107], 0
    ds_read_b64_tr_b16 v[120:121], v168 offset:4096
    v_mfma_f32_16x16x32_bf16 v[60:63], a[4:7], v[104:107], 0
    ds_read_b64_tr_b16 v[122:123], v168 offset:6144
    v_mfma_f32_16x16x32_bf16 v[64:67], a[8:11], v[104:107], 0
    s_waitcnt lgkmcnt(6)
    s_add_u32 m0, s61, 101760
    ds_read_b64_tr_b16 v[124:125], v169 offset:4096
    v_mfma_f32_16x16x32_bf16 v[68:71], a[0:3], v[108:111], 0
    buffer_load_dwordx4 v200, s[40:43], s64 offen offset:0 lds
    v_mfma_f32_16x16x32_bf16 v[72:75], a[4:7], v[108:111], 0
    ds_read_b64_tr_b16 v[126:127], v169 offset:6144
    v_mfma_f32_16x16x32_bf16 v[76:79], a[8:11], v[108:111], 0
    s_waitcnt lgkmcnt(6)
    ds_read_b64_tr_b16 v[128:129], v170 offset:4096
    v_mfma_f32_16x16x32_bf16 v[80:83], a[0:3], v[112:115], 0
    s_add_u32 m0, s61, 101760
    ds_read_b64_tr_b16 v[130:131], v170 offset:6144
    v_mfma_f32_16x16x32_bf16 v[84:87], a[4:7], v[112:115], 0
    buffer_load_dwordx4 v201, s[40:43], s64 offen offset:1024 lds
    v_mfma_f32_16x16x32_bf16 v[88:91], a[8:11], v[112:115], 0
    s_waitcnt lgkmcnt(6)
    ds_read_b64_tr_b16 v[132:133], v171 offset:4096
    v_mfma_f32_16x16x32_bf16 v[92:95], a[0:3], v[116:119], 0
    s_waitcnt lgkmcnt(3)
    ds_read_b64_tr_b16 v[134:135], v171 offset:6144
    v_mfma_f32_16x16x32_bf16 v[96:99], a[4:7], v[116:119], 0
    s_add_u32 m0, s61, 101760
    v_mfma_f32_16x16x32_bf16 v[100:103], a[8:11], v[116:119], 0
    buffer_load_dwordx4 v202, s[40:43], s64 offen offset:2048 lds
    v_mfma_f32_16x16x32_bf16 v[56:59], a[12:15], v[120:123], v[56:59]
    s_add_u32 s64, s64, 98304
    ds_read_b64_tr_b16 v[104:105], v168 offset:8192
    v_mfma_f32_16x16x32_bf16 v[60:63], a[16:19], v[120:123], v[60:63]
    s_sub_u32 s35, s64, 1966080
    ds_read_b64_tr_b16 v[106:107], v168 offset:10240
    v_mfma_f32_16x16x32_bf16 v[64:67], a[20:23], v[120:123], v[64:67]
    s_min_u32 s64, s64, s35
    ds_read_b64_tr_b16 v[108:109], v169 offset:8192
    v_mfma_f32_16x16x32_bf16 v[68:71], a[12:15], v[124:127], v[68:71]
    v_mfma_f32_16x16x32_bf16 v[72:75], a[16:19], v[124:127], v[72:75]
    ds_read_b64_tr_b16 v[110:111], v169 offset:10240
    v_mfma_f32_16x16x32_bf16 v[76:79], a[20:23], v[124:127], v[76:79]
    s_waitcnt lgkmcnt(6)
    ds_read_b64_tr_b16 v[112:113], v170 offset:8192
    v_mfma_f32_16x16x32_bf16 v[80:83], a[12:15], v[128:131], v[80:83]
    s_add_u32 m0, s63, 49152
    ds_read_b64_tr_b16 v[114:115], v170 offset:10240
    v_mfma_f32_16x16x32_bf16 v[84:87], a[16:19], v[128:131], v[84:87]
    buffer_load_dwordx4 v172, s[36:39], s24 offen sc1 lds
    v_mfma_f32_16x16x32_bf16 v[88:91], a[20:23], v[128:131], v[88:91]
    s_waitcnt lgkmcnt(6)
    ds_read_b64_tr_b16 v[116:117], v171 offset:8192
    v_mfma_f32_16x16x32_bf16 v[92:95], a[12:15], v[132:135], v[92:95]
    s_waitcnt lgkmcnt(3)
    ds_read_b64_tr_b16 v[118:119], v171 offset:10240
    v_mfma_f32_16x16x32_bf16 v[96:99], a[16:19], v[132:135], v[96:99]
    s_add_u32 m0, s63, 53248
    v_mfma_f32_16x16x32_bf16 v[100:103], a[20:23], v[132:135], v[100:103]
    buffer_load_dwordx4 v172, s[36:39], s25 offen sc1 lds
    v_mfma_f32_16x16x32_bf16 v[56:59], a[24:27], v[104:107], v[56:59]
    s_waitcnt vmcnt(11)
    s_barrier
    ds_read_b64_tr_b16 v[120:121], v168 offset:12288
    v_mfma_f32_16x16x32_bf16 v[60:63], a[28:31], v[104:107], v[60:63]
    ds_read_b64_tr_b16 v[122:123], v168 offset:14336
    v_mfma_f32_16x16x32_bf16 v[64:67], a[32:35], v[104:107], v[64:67]
    s_add_u32 m0, s63, 57344
    ds_read_b64_tr_b16 v[124:125], v169 offset:12288
    v_mfma_f32_16x16x32_bf16 v[68:71], a[24:27], v[108:111], v[68:71]
    buffer_load_dwordx4 v172, s[36:39], s26 offen sc1 lds
    v_mfma_f32_16x16x32_bf16 v[72:75], a[28:31], v[108:111], v[72:75]
    ds_read_b64_tr_b16 v[126:127], v169 offset:14336
    v_mfma_f32_16x16x32_bf16 v[76:79], a[32:35], v[108:111], v[76:79]
    s_waitcnt lgkmcnt(6)
    ds_read_b64_tr_b16 v[128:129], v170 offset:12288
    v_mfma_f32_16x16x32_bf16 v[80:83], a[24:27], v[112:115], v[80:83]
    s_add_u32 m0, s63, 61440
    ds_read_b64_tr_b16 v[130:131], v170 offset:14336
    v_mfma_f32_16x16x32_bf16 v[84:87], a[28:31], v[112:115], v[84:87]
    buffer_load_dwordx4 v172, s[36:39], s27 offen sc1 lds
    v_mfma_f32_16x16x32_bf16 v[88:91], a[32:35], v[112:115], v[88:91]
    s_waitcnt lgkmcnt(6)
    ds_read_b64_tr_b16 v[132:133], v171 offset:12288
    v_mfma_f32_16x16x32_bf16 v[92:95], a[24:27], v[116:119], v[92:95]
    s_waitcnt lgkmcnt(3)
    ds_read_b64_tr_b16 v[134:135], v171 offset:14336
    v_mfma_f32_16x16x32_bf16 v[96:99], a[28:31], v[116:119], v[96:99]
    s_add_u32 m0, s63, 65536
    v_mfma_f32_16x16x32_bf16 v[100:103], a[32:35], v[116:119], v[100:103]
    s_waitcnt vmcnt(7)
    s_barrier
    s_cmp_eq_u32 s3, 0
    s_cbranch_scc0 L_wf8
    s_lshl_b32 s54, s70, 7
    s_add_u32 s54, s54, 23266304
    v_mov_b32 v254, 0
    v_mov_b32 v255, s48
    s_mov_b64 exec, 1
    buffer_store_dword v255, v254, s[36:39], s54 offen sc1
    s_mov_b64 exec, -1
L_wf8:
    buffer_load_dwordx4 v172, s[36:39], s44 offen sc1 lds
    v_mfma_f32_16x16x32_bf16 v[56:59], a[36:39], v[120:123], v[56:59]
    ds_read_b64_tr_b16 v[104:105], v168 offset:16384
    v_mfma_f32_16x16x32_bf16 v[60:63], a[40:43], v[120:123], v[60:63]
    ds_read_b64_tr_b16 v[106:107], v168 offset:18432
    v_mfma_f32_16x16x32_bf16 v[64:67], a[44:47], v[120:123], v[64:67]
    s_add_u32 m0, s63, 69632
    ds_read_b64_tr_b16 v[108:109], v169 offset:16384
    v_mfma_f32_16x16x32_bf16 v[68:71], a[36:39], v[124:127], v[68:71]
    buffer_load_dwordx4 v172, s[36:39], s45 offen sc1 lds
    v_mfma_f32_16x16x32_bf16 v[72:75], a[40:43], v[124:127], v[72:75]
    ds_read_b64_tr_b16 v[110:111], v169 offset:18432
    v_mfma_f32_16x16x32_bf16 v[76:79], a[44:47], v[124:127], v[76:79]
    s_waitcnt lgkmcnt(6)
    ds_read_b64_tr_b16 v[112:113], v170 offset:16384
    v_mfma_f32_16x16x32_bf16 v[80:83], a[36:39], v[128:131], v[80:83]
    s_add_u32 m0, s63, 73728
    ds_read_b64_tr_b16 v[114:115], v170 offset:18432
    v_mfma_f32_16x16x32_bf16 v[84:87], a[40:43], v[128:131], v[84:87]
    buffer_load_dwordx4 v172, s[36:39], s46 offen sc1 lds
    v_mfma_f32_16x16x32_bf16 v[88:91], a[44:47], v[128:131], v[88:91]
    s_waitcnt lgkmcnt(6)
    ds_read_b64_tr_b16 v[116:117], v171 offset:16384
    v_mfma_f32_16x16x32_bf16 v[92:95], a[36:39], v[132:135], v[92:95]
    s_waitcnt lgkmcnt(3)
    ds_read_b64_tr_b16 v[118:119], v171 offset:18432
    v_mfma_f32_16x16x32_bf16 v[96:99], a[40:43], v[132:135], v[96:99]
    s_add_u32 m0, s63, 77824
    v_mfma_f32_16x16x32_bf16 v[100:103], a[44:47], v[132:135], v[100:103]
    buffer_load_dwordx4 v172, s[36:39], s47 offen sc1 lds
    v_mfma_f32_16x16x32_bf16 v[56:59], a[48:51], v[104:107], v[56:59]
    ds_read_b64_tr_b16 v[120:121], v168 offset:20480
    v_add_u32 v172, 2048, v172
    v_mfma_f32_16x16x32_bf16 v[60:63], a[52:55], v[104:107], v[60:63]
    ds_read_b64_tr_b16 v[122:123], v168 offset:22528
    v_mfma_f32_16x16x32_bf16 v[64:67], a[56:59], v[104:107], v[64:67]
    s_add_u32 m0, s61, 114176
    ds_read_b64_tr_b16 v[124:125], v169 offset:20480
    v_mfma_f32_16x16x32_bf16 v[68:71], a[48:51], v[108:111], v[68:71]
    buffer_load_dwordx4 v200, s[40:43], s64 offen offset:0 lds
    v_mfma_f32_16x16x32_bf16 v[72:75], a[52:55], v[108:111], v[72:75]
    ds_read_b64_tr_b16 v[126:127], v169 offset:22528
    v_mfma_f32_16x16x32_bf16 v[76:79], a[56:59], v[108:111], v[76:79]
    s_waitcnt lgkmcnt(6)
    ds_read_b64_tr_b16 v[128:129], v170 offset:20480
    v_mfma_f32_16x16x32_bf16 v[80:83], a[48:51], v[112:115], v[80:83]
    s_add_u32 m0, s61, 114176
    ds_read_b64_tr_b16 v[130:131], v170 offset:22528
    v_min_u32 v243, 11, v1
    v_mfma_f32_16x16x32_bf16 v[84:87], a[52:55], v[112:115], v[84:87]
    buffer_load_dwordx4 v201, s[40:43], s64 offen offset:1024 lds
    v_mfma_f32_16x16x32_bf16 v[88:91], a[56:59], v[112:115], v[88:91]
    s_waitcnt lgkmcnt(6)
    ds_read_b64_tr_b16 v[132:133], v171 offset:20480
    v_lshlrev_b32 v243, 8, v243
    v_mfma_f32_16x16x32_bf16 v[92:95], a[48:51], v[116:119], v[92:95]
    s_waitcnt lgkmcnt(3)
    ds_read_b64_tr_b16 v[134:135], v171 offset:22528
    v_mfma_f32_16x16x32_bf16 v[96:99], a[52:55], v[116:119], v[96:99]
    s_add_u32 m0, s61, 114176
    v_mfma_f32_16x16x32_bf16 v[100:103], a[56:59], v[116:119], v[100:103]
    buffer_load_dwordx4 v202, s[40:43], s64 offen offset:2048 lds
    v_mfma_f32_16x16x32_bf16 v[56:59], a[60:63], v[120:123], v[56:59]
    s_mul_i32 s58, s3, 24
    s_lshr_b32 s57, s75, 2
    s_add_u32 s64, s64, 98304
    ds_read_b64_tr_b16 v[104:105], v168 offset:24576
    v_mfma_f32_16x16x32_bf16 v[60:63], a[64:67], v[120:123], v[60:63]
    s_add_u32 s58, s58, s57
    s_lshl_b32 s58, s58, 7
    ds_read_b64_tr_b16 v[106:107], v168 offset:26624
    v_mfma_f32_16x16x32_bf16 v[64:67], a[68:71], v[120:123], v[64:67]
    s_add_u32 s58, s58, 23233536
    s_sub_u32 s35, s64, 1966080
    ds_read_b64_tr_b16 v[108:109], v169 offset:24576
    v_mfma_f32_16x16x32_bf16 v[68:71], a[60:63], v[124:127], v[68:71]
    s_min_u32 s64, s64, s35
    buffer_load_dword v244, v243, s[36:39], s58 offen sc1
    v_mfma_f32_16x16x32_bf16 v[72:75], a[64:67], v[124:127], v[72:75]
    ds_read_b64_tr_b16 v[110:111], v169 offset:26624
    v_mfma_f32_16x16x32_bf16 v[76:79], a[68:71], v[124:127], v[76:79]
    s_waitcnt lgkmcnt(6)
    ds_read_b64_tr_b16 v[112:113], v170 offset:24576
    v_mfma_f32_16x16x32_bf16 v[80:83], a[60:63], v[128:131], v[80:83]
    s_add_u32 m0, s61, 126592
    ds_read_b64_tr_b16 v[114:115], v170 offset:26624
    v_mfma_f32_16x16x32_bf16 v[84:87], a[64:67], v[128:131], v[84:87]
    buffer_load_dwordx4 v200, s[40:43], s64 offen offset:0 lds
    v_mfma_f32_16x16x32_bf16 v[88:91], a[68:71], v[128:131], v[88:91]
    s_waitcnt lgkmcnt(6)
    ds_read_b64_tr_b16 v[116:117], v171 offset:24576
    v_mfma_f32_16x16x32_bf16 v[92:95], a[60:63], v[132:135], v[92:95]
    s_waitcnt lgkmcnt(3)
    ds_read_b64_tr_b16 v[118:119], v171 offset:26624
    v_mfma_f32_16x16x32_bf16 v[96:99], a[64:67], v[132:135], v[96:99]
    s_add_u32 m0, s61, 126592
    v_mfma_f32_16x16x32_bf16 v[100:103], a[68:71], v[132:135], v[100:103]
    buffer_load_dwordx4 v201, s[40:43], s64 offen offset:1024 lds
    v_mfma_f32_16x16x32_bf16 v[56:59], a[72:75], v[104:107], v[56:59]
    ds_read_b64_tr_b16 v[120:121], v168 offset:28672
    v_mfma_f32_16x16x32_bf16 v[60:63], a[76:79], v[104:107], v[60:63]
    ds_read_b64_tr_b16 v[122:123], v168 offset:30720
    v_mfma_f32_16x16x32_bf16 v[64:67], a[80:83], v[104:107], v[64:67]
    s_add_u32 m0, s61, 126592
    ds_read_b64_tr_b16 v[124:125], v169 offset:28672
    v_mfma_f32_16x16x32_bf16 v[68:71], a[72:75], v[108:111], v[68:71]
    buffer_load_dwordx4 v202, s[40:43], s64 offen offset:2048 lds
    v_mfma_f32_16x16x32_bf16 v[72:75], a[76:79], v[108:111], v[72:75]
    s_add_u32 s64, s64, 98304
    ds_read_b64_tr_b16 v[126:127], v169 offset:30720
    v_mfma_f32_16x16x32_bf16 v[76:79], a[80:83], v[108:111], v[76:79]
    s_waitcnt lgkmcnt(6)
    s_sub_u32 s35, s64, 1966080
    ds_read_b64_tr_b16 v[128:129], v170 offset:28672
    v_mfma_f32_16x16x32_bf16 v[80:83], a[72:75], v[112:115], v[80:83]
    s_min_u32 s64, s64, s35
    ds_read_b64_tr_b16 v[130:131], v170 offset:30720
    v_mfma_f32_16x16x32_bf16 v[84:87], a[76:79], v[112:115], v[84:87]
    v_mfma_f32_16x16x32_bf16 v[88:91], a[80:83], v[112:115], v[88:91]
    s_waitcnt lgkmcnt(6)
    ds_read_b64_tr_b16 v[132:133], v171 offset:28672
    v_mfma_f32_16x16x32_bf16 v[92:95], a[72:75], v[116:119], v[92:95]
    s_waitcnt lgkmcnt(3)
    ds_read_b64_tr_b16 v[134:135], v171 offset:30720
    v_mfma_f32_16x16x32_bf16 v[96:99], a[76:79], v[116:119], v[96:99]
    s_add_u32 m0, s61, 139008
    v_mfma_f32_16x16x32_bf16 v[100:103], a[80:83], v[116:119], v[100:103]
    buffer_load_dwordx4 v200, s[40:43], s64 offen offset:0 lds
    v_mfma_f32_16x16x32_bf16 v[56:59], a[84:87], v[120:123], v[56:59]
    s_waitcnt vmcnt(8)
    s_barrier
    ds_read_b64_tr_b16 v[104:105], v168 offset:32768
    v_mfma_f32_16x16x32_bf16 v[60:63], a[88:91], v[120:123], v[60:63]
    ds_read_b64_tr_b16 v[106:107], v168 offset:34816
    ds_read_b64 v[224:225], v216
    v_mfma_f32_16x16x32_bf16 v[64:67], a[92:95], v[120:123], v[64:67]
    s_add_u32 m0, s61, 139008
    ds_read_b64_tr_b16 v[108:109], v169 offset:32768
    ds_read_b64 v[226:227], v217
    v_mfma_f32_16x16x32_bf16 v[68:71], a[84:87], v[124:127], v[68:71]
    buffer_load_dwordx4 v201, s[40:43], s64 offen offset:1024 lds
    v_mfma_f32_16x16x32_bf16 v[72:75], a[88:91], v[124:127], v[72:75]
    ds_read_b64_tr_b16 v[110:111], v169 offset:34816
    ds_read_b64 v[228:229], v218
    v_mfma_f32_16x16x32_bf16 v[76:79], a[92:95], v[124:127], v[76:79]
    s_waitcnt lgkmcnt(9)
    ds_read_b64_tr_b16 v[112:113], v170 offset:32768
    v_mfma_f32_16x16x32_bf16 v[80:83], a[84:87], v[128:131], v[80:83]
    s_barrier
    s_add_u32 m0, s61, 139008
    ds_read_b64_tr_b16 v[114:115], v170 offset:34816
    v_mfma_f32_16x16x32_bf16 v[84:87], a[88:91], v[128:131], v[84:87]
    ds_read_b64_tr_b16 a[180:181], v203 offset:0
    buffer_load_dwordx4 v202, s[40:43], s64 offen offset:2048 lds
    v_mfma_f32_16x16x32_bf16 v[88:91], a[92:95], v[128:131], v[88:91]
    s_waitcnt lgkmcnt(10)
    s_add_u32 s64, s64, 98304
    ds_read_b64_tr_b16 v[116:117], v171 offset:32768
    ds_read_b64_tr_b16 a[182:183], v203 offset:1536
    v_mfma_f32_16x16x32_bf16 v[92:95], a[84:87], v[132:135], v[92:95]
    s_waitcnt lgkmcnt(3)
    s_sub_u32 s35, s64, 1966080
    ds_read_b64_tr_b16 v[118:119], v171 offset:34816
    v_mfma_f32_16x16x32_bf16 v[96:99], a[88:91], v[132:135], v[96:99]
    s_min_u32 s64, s64, s35
    ds_read_b64_tr_b16 a[184:185], v203 offset:6224
    v_lshlrev_b32 v230, 16, v224
    v_and_b32 v231, 0xffff0000, v224
    v_pk_mul_f32 v[230:231], v[230:231], v[220:221] op_sel_hi:[1,0]
    v_pk_mul_f32 v[234:235], v[230:231], v[230:231]
    v_lshlrev_b32 v232, 16, v225
    v_and_b32 v233, 0xffff0000, v225
    v_pk_mul_f32 v[232:233], v[232:233], v[220:221] op_sel_hi:[1,0]
    v_pk_mul_f32 v[236:237], v[232:233], v[232:233]
    v_lshlrev_b32 v2, 16, v226
    v_and_b32 v3, 0xffff0000, v226
    v_pk_mul_f32 v[2:3], v[2:3], v[220:221] op_sel:[0,1] op_sel_hi:[1,1]
    v_pk_add_f32 v[230:231], v[230:231], v[2:3]
    v_pk_fma_f32 v[234:235], v[2:3], v[2:3], v[234:235]
    v_lshlrev_b32 v2, 16, v227
    v_and_b32 v3, 0xffff0000, v227
    v_pk_mul_f32 v[2:3], v[2:3], v[220:221] op_sel:[0,1] op_sel_hi:[1,1]
    v_pk_add_f32 v[232:233], v[232:233], v[2:3]
    v_pk_fma_f32 v[236:237], v[2:3], v[2:3], v[236:237]
    v_lshlrev_b32 v2, 16, v228
    v_and_b32 v3, 0xffff0000, v228
    v_pk_mul_f32 v[2:3], v[2:3], v[222:223] op_sel_hi:[1,0]
    v_pk_add_f32 v[230:231], v[230:231], v[2:3]
    v_pk_fma_f32 v[234:235], v[2:3], v[2:3], v[234:235]
    v_lshlrev_b32 v2, 16, v229
    v_and_b32 v3, 0xffff0000, v229
    v_pk_mul_f32 v[2:3], v[2:3], v[222:223] op_sel_hi:[1,0]
    v_pk_add_f32 v[232:233], v[232:233], v[2:3]
    v_pk_fma_f32 v[236:237], v[2:3], v[2:3], v[236:237]
    v_mfma_f32_16x16x32_bf16 v[100:103], a[92:95], v[132:135], v[100:103]
    ds_read_b64_tr_b16 a[186:187], v203 offset:7760
    v_permlane32_swap_b32 v230, v234
    v_mfma_f32_16x16x32_bf16 v[56:59], a[96:99], v[104:107], v[56:59]
    ds_read_b64_tr_b16 v[120:121], v168 offset:36864
    ds_read_b64_tr_b16 a[188:189], v204 offset:0
    v_mfma_f32_16x16x32_bf16 v[60:63], a[100:103], v[104:107], v[60:63]
    ds_read_b64_tr_b16 v[122:123], v168 offset:38912
    v_permlane32_swap_b32 v231, v235
    v_mfma_f32_16x16x32_bf16 v[64:67], a[104:107], v[104:107], v[64:67]
    s_add_u32 m0, s61, 151424
    ds_read_b64_tr_b16 v[124:125], v169 offset:36864
    v_permlane32_swap_b32 v232, v236
    v_permlane32_swap_b32 v233, v237
    v_add_f32 v230, v230, v234
    v_add_f32 v231, v231, v235
    v_add_f32 v232, v232, v236
    v_mfma_f32_16x16x32_bf16 v[68:71], a[96:99], v[108:111], v[68:71]
    ds_read_b64_tr_b16 a[190:191], v204 offset:1536
    buffer_load_dwordx4 v200, s[40:43], s64 offen offset:0 lds
    v_mfma_f32_16x16x32_bf16 v[72:75], a[100:103], v[108:111], v[72:75]
    ds_read_b64_tr_b16 v[126:127], v169 offset:38912
    v_lshrrev_b32 v238, 1, v1
    v_mfma_f32_16x16x32_bf16 v[76:79], a[104:107], v[108:111], v[76:79]
    ds_read_b64_tr_b16 v[128:129], v170 offset:36864
    v_lshlrev_b32 v238, 10, v238
    v_mfma_f32_16x16x32_bf16 v[80:83], a[96:99], v[112:115], v[80:83]
    s_add_u32 m0, s61, 151424
    ds_read_b64_tr_b16 v[130:131], v170 offset:38912
    v_and_b32 v239, 1, v1
    v_mfma_f32_16x16x32_bf16 v[84:87], a[100:103], v[112:115], v[84:87]
    buffer_load_dwordx4 v201, s[40:43], s64 offen offset:1024 lds
    v_mfma_f32_16x16x32_bf16 v[88:91], a[104:107], v[112:115], v[88:91]
    s_waitcnt lgkmcnt(10)
    ds_read_b64_tr_b16 v[132:133], v171 offset:36864
    v_lshl_add_u32 v219, v239, 7, v238
    v_mfma_f32_16x16x32_bf16 v[92:95], a[96:99], v[116:119], v[92:95]
    s_waitcnt lgkmcnt(3)
    ds_read_b64_tr_b16 v[134:135], v171 offset:38912
    v_add_f32 v233, v233, v237
    v_mfma_f32_16x16x32_bf16 v[96:99], a[100:103], v[116:119], v[96:99]
    s_add_u32 m0, s61, 151424
    v_permlane16_swap_b32 v230, v232
    v_permlane16_swap_b32 v231, v233
    v_mfma_f32_16x16x32_bf16 v[100:103], a[104:107], v[116:119], v[100:103]
    buffer_load_dwordx4 v202, s[40:43], s64 offen offset:2048 lds
    v_mfma_f32_16x16x32_bf16 v[56:59], a[108:111], v[120:123], v[56:59]
    s_lshl_b32 s55, s3, 8
    s_add_u32 s55, s55, 66560
    s_add_u32 s64, s64, 98304
    ds_read_b64_tr_b16 v[104:105], v168 offset:40960
    v_add_f32 v230, v230, v232
    v_add_f32 v231, v231, v233
    v_lshrrev_b32 v2, 4, v1
    v_lshlrev_b32 v2, 3, v2
    v_mfma_f32_16x16x32_bf16 v[60:63], a[112:115], v[120:123], v[60:63]
    s_waitcnt vmcnt(10)
    s_barrier
    s_sub_u32 s35, s64, 1966080
    ds_read_b64_tr_b16 v[106:107], v168 offset:43008
    ds_read_b64_tr_b16 a[192:193], v203 offset:12416
    v_add_u32 v219, s55, v219
    v_mfma_f32_16x16x32_bf16 v[64:67], a[116:119], v[120:123], v[64:67]
    s_lshl_b32 s55, s73, 7
    s_add_u32 s55, s55, 87040
    ds_read_b64_tr_b16 v[108:109], v169 offset:40960
    v_mfma_f32_16x16x32_bf16 v[68:71], a[108:111], v[124:127], v[68:71]
    s_min_u32 s64, s64, s35
    ds_read_b64_tr_b16 a[194:195], v203 offset:13952
    s_waitcnt vmcnt(9)
    v_cmp_ne_u32 vcc, s48, v244
    s_cbranch_vccnz L_chk9_slow
L_chk9_back:
    v_mfma_f32_16x16x32_bf16 v[72:75], a[112:115], v[124:127], v[72:75]
    s_lshl_b32 s50, s3, 5
    s_add_u32 s50, s50, 0
    ds_read_b64_tr_b16 v[110:111], v169 offset:43008
    v_mov_b32 v238, s55
    v_add_u32 v2, s50, v2
    v_add_f32_dpp v230, v230, v230 row_ror:8 row_mask:0xf bank_mask:0xf
    v_mfma_f32_16x16x32_bf16 v[76:79], a[116:119], v[124:127], v[76:79]
    s_waitcnt lgkmcnt(8)
    ds_read_b64_tr_b16 v[112:113], v170 offset:40960
    ds_read_b64_tr_b16 a[196:197], v203 offset:18640
    v_mfma_f32_16x16x32_bf16 v[80:83], a[108:111], v[128:131], v[80:83]
    ds_read_b64_tr_b16 v[114:115], v170 offset:43008
    ds_read_b64_tr_b16 a[198:199], v203 offset:20176
    v_mfma_f32_16x16x32_bf16 v[84:87], a[112:115], v[128:131], v[84:87]
    v_cmp_lt_u32 vcc, 39, v1
    s_nop 1
    v_cndmask_b32 v219, v219, v238, vcc
    buffer_load_dwordx4 a[240:243], v248, s[36:39], s62 offen offset:0 sc1
    v_mfma_f32_16x16x32_bf16 v[88:91], a[116:119], v[128:131], v[88:91]
    s_waitcnt lgkmcnt(10)
    s_mov_b32 s17, 23199744
    ds_read_b64_tr_b16 v[116:117], v171 offset:40960
    ds_read_b64_tr_b16 a[200:201], v204 offset:12416
    v_mfma_f32_16x16x32_bf16 v[92:95], a[108:111], v[132:135], v[92:95]
    s_waitcnt lgkmcnt(3)
    ds_read_b64_tr_b16 v[118:119], v171 offset:43008
    v_add_f32_dpp v231, v231, v231 row_ror:8 row_mask:0xf bank_mask:0xf
    v_mfma_f32_16x16x32_bf16 v[96:99], a[112:115], v[132:135], v[96:99]
    ds_read_b64_tr_b16 a[202:203], v204 offset:13952
    v_add_f32_dpp v230, v230, v230 row_ror:4 row_mask:0xf bank_mask:0xf
    v_mfma_f32_16x16x32_bf16 v[100:103], a[116:119], v[132:135], v[100:103]
    buffer_load_dwordx4 a[244:247], v248, s[36:39], s62 offen offset:1024 sc1
    v_mfma_f32_16x16x32_bf16 v[56:59], a[120:123], v[104:107], v[56:59]
    ds_read_b64_tr_b16 v[120:121], v168 offset:45056
    v_add_f32_dpp v231, v231, v231 row_ror:4 row_mask:0xf bank_mask:0xf
    v_mfma_f32_16x16x32_bf16 v[60:63], a[124:127], v[104:107], v[60:63]
    ds_read_b64_tr_b16 v[122:123], v168 offset:47104
    v_add_f32_dpp v230, v230, v230 row_ror:2 row_mask:0xf bank_mask:0xf
    v_mfma_f32_16x16x32_bf16 v[64:67], a[128:131], v[104:107], v[64:67]
    ds_read_b64_tr_b16 v[124:125], v169 offset:45056
    v_add_f32_dpp v231, v231, v231 row_ror:2 row_mask:0xf bank_mask:0xf
    v_mfma_f32_16x16x32_bf16 v[68:71], a[120:123], v[108:111], v[68:71]
    buffer_load_dwordx4 a[248:251], v248, s[36:39], s62 offen offset:2048 sc1
    v_mfma_f32_16x16x32_bf16 v[72:75], a[124:127], v[108:111], v[72:75]
    ds_read_b64_tr_b16 v[126:127], v169 offset:47104
    v_add_f32_dpp v230, v230, v230 row_ror:1 row_mask:0xf bank_mask:0xf
    v_mfma_f32_16x16x32_bf16 v[76:79], a[128:131], v[108:111], v[76:79]
    ds_read_b64_tr_b16 v[128:129], v170 offset:45056
    v_add_f32_dpp v231, v231, v231 row_ror:1 row_mask:0xf bank_mask:0xf
    s_mov_b32 exec_lo, 0x00010001
    s_mov_b32 exec_hi, 0x00010001
    ds_write_b64 v2, v[230:231]
    s_mov_b64 exec, -1
    v_lshlrev_b32 v2, 2, v1
    v_mfma_f32_16x16x32_bf16 v[80:83], a[120:123], v[112:115], v[80:83]
    s_waitcnt vmcnt(9)
    s_waitcnt lgkmcnt(6)
    s_barrier
    ds_read_b64_tr_b16 v[130:131], v170 offset:47104
    v_mfma_f32_16x16x32_bf16 v[84:87], a[124:127], v[112:115], v[84:87]
    ds_read_b64_tr_b16 a[204:205], v203 offset:24832
    buffer_load_dwordx4 a[252:255], v248, s[36:39], s62 offen offset:3072 sc1
    v_mfma_f32_16x16x32_bf16 v[88:91], a[128:131], v[112:115], v[88:91]
    ds_read_b64_tr_b16 v[132:133], v171 offset:45056
    ds_read_b64_tr_b16 a[206:207], v203 offset:26368
    v_mfma_f32_16x16x32_bf16 v[92:95], a[120:123], v[116:119], v[92:95]
    s_waitcnt lgkmcnt(3)
    ds_read_b64_tr_b16 v[134:135], v171 offset:47104
    v_and_b32 v2, 12, v2
    v_add_u32 v2, 0, v2
    v_mfma_f32_16x16x32_bf16 v[96:99], a[124:127], v[116:119], v[96:99]
    s_add_u32 s62, s62, 4096
    buffer_load_dword v240, v219, s[36:39], s17 offen sc1
    v_mfma_f32_16x16x32_bf16 v[100:103], a[128:131], v[116:119], v[100:103]
    s_waitcnt lgkmcnt(0)
    s_barrier
    ds_read_b64_tr_b16 a[208:209], v203 offset:31056
    buffer_load_dwordx4 v[136:139], v248, s[36:39], s62 offen offset:0 sc1
    v_mfma_f32_16x16x32_bf16 v[56:59], a[132:135], v[120:123], v[56:59]
    ds_read_b64_tr_b16 v[104:105], v168 offset:49152
    ds_read_b64_tr_b16 a[210:211], v203 offset:32592
    ds_read2_b32 v[230:231], v2 offset0:0 offset1:4
    v_mfma_f32_16x16x32_bf16 v[60:63], a[136:139], v[120:123], v[60:63]
    ds_read_b64_tr_b16 v[106:107], v168 offset:51200
    ds_read_b64_tr_b16 a[212:213], v204 offset:24832
    v_mfma_f32_16x16x32_bf16 v[64:67], a[140:143], v[120:123], v[64:67]
    ds_read_b64_tr_b16 v[108:109], v169 offset:49152
    ds_read2_b32 v[232:233], v2 offset0:8 offset1:12
    ds_read2_b32 v[234:235], v2 offset0:16 offset1:20
    v_mfma_f32_16x16x32_bf16 v[68:71], a[132:135], v[124:127], v[68:71]
    ds_read_b64_tr_b16 a[214:215], v204 offset:26368
    buffer_load_dwordx4 v[140:143], v248, s[36:39], s62 offen offset:1024 sc1
    v_mfma_f32_16x16x32_bf16 v[72:75], a[136:139], v[124:127], v[72:75]
    ds_read_b64_tr_b16 v[110:111], v169 offset:51200
    ds_read2_b32 v[236:237], v2 offset0:24 offset1:28
    v_mfma_f32_16x16x32_bf16 v[76:79], a[140:143], v[124:127], v[76:79]
    ds_read_b64_tr_b16 v[112:113], v170 offset:49152
    v_mov_b32 v225, s48
    v_mfma_f32_16x16x32_bf16 v[80:83], a[132:135], v[128:131], v[80:83]
    ds_read_b64_tr_b16 v[114:115], v170 offset:51200
    v_mov_b32 v227, s48
    v_mfma_f32_16x16x32_bf16 v[84:87], a[136:139], v[128:131], v[84:87]
    buffer_load_dwordx4 v[144:147], v248, s[36:39], s62 offen offset:2048 sc1
    v_mfma_f32_16x16x32_bf16 v[88:91], a[140:143], v[128:131], v[88:91]
    ds_read_b64_tr_b16 v[116:117], v171 offset:49152
    s_waitcnt lgkmcnt(7)
    v_add_f32 v230, v230, v232
    v_mfma_f32_16x16x32_bf16 v[92:95], a[132:135], v[132:135], v[92:95]
    s_waitcnt lgkmcnt(3)
    ds_read_b64_tr_b16 v[118:119], v171 offset:51200
    v_add_f32 v231, v231, v233
    v_mfma_f32_16x16x32_bf16 v[96:99], a[136:139], v[132:135], v[96:99]
    v_add_f32 v234, v234, v236
    v_add_f32 v235, v235, v237
    v_mfma_f32_16x16x32_bf16 v[100:103], a[140:143], v[132:135], v[100:103]
    buffer_load_dwordx4 v[148:151], v248, s[36:39], s62 offen offset:3072 sc1
    v_mfma_f32_16x16x32_bf16 v[56:59], a[144:147], v[104:107], v[56:59]
    s_waitcnt vmcnt(12)
    s_barrier
    ds_read_b64_tr_b16 v[120:121], v168 offset:53248
    v_add_f32 v230, v230, v234
    v_mfma_f32_16x16x32_bf16 v[60:63], a[148:151], v[104:107], v[60:63]
    ds_read_b64_tr_b16 v[122:123], v168 offset:55296
    ds_read_b64_tr_b16 a[216:217], v203 offset:37248
    v_mfma_f32_16x16x32_bf16 v[64:67], a[152:155], v[104:107], v[64:67]
    s_add_u32 s62, s62, 4096
    ds_read_b64_tr_b16 v[124:125], v169 offset:53248
    v_add_f32 v231, v231, v235
    v_mul_f32 v230, 0x3acccccd, v230
    v_mul_f32 v234, v230, v230
    v_mfma_f32_16x16x32_bf16 v[68:71], a[144:147], v[108:111], v[68:71]
    ds_read_b64_tr_b16 a[218:219], v203 offset:38784
    buffer_load_dwordx4 v[152:155], v248, s[36:39], s62 offen offset:0 sc1
    v_mfma_f32_16x16x32_bf16 v[72:75], a[148:151], v[108:111], v[72:75]
    ds_read_b64_tr_b16 v[126:127], v169 offset:55296
    ds_read_b64_tr_b16 a[220:221], v203 offset:43472
    v_mfma_f32_16x16x32_bf16 v[76:79], a[152:155], v[108:111], v[76:79]
    s_waitcnt lgkmcnt(9)
    ds_read_b64_tr_b16 v[128:129], v170 offset:53248
    ds_read_b64_tr_b16 a[222:223], v203 offset:45008
    v_mfma_f32_16x16x32_bf16 v[80:83], a[144:147], v[112:115], v[80:83]
    ds_read_b64_tr_b16 v[130:131], v170 offset:55296
    v_mov_b32 v224, 0x3acccccd
    v_fma_f32 v231, v231, v224, -v234
    v_max_f32 v231, 0, v231
    v_mfma_f32_16x16x32_bf16 v[84:87], a[148:151], v[112:115], v[84:87]
    ds_read_b64_tr_b16 a[224:225], v204 offset:37248
    buffer_load_dwordx4 v[156:159], v248, s[36:39], s62 offen offset:1024 sc1
    v_mfma_f32_16x16x32_bf16 v[88:91], a[152:155], v[112:115], v[88:91]
    s_waitcnt lgkmcnt(11)
    ds_read_b64_tr_b16 v[132:133], v171 offset:53248
    v_min_u32 v247, 23, v1
    v_mfma_f32_16x16x32_bf16 v[92:95], a[144:147], v[116:119], v[92:95]
    s_waitcnt lgkmcnt(3)
    ds_read_b64_tr_b16 v[134:135], v171 offset:55296
    v_lshlrev_b32 v247, 4, v247
    v_mfma_f32_16x16x32_bf16 v[96:99], a[148:151], v[116:119], v[96:99]
    ds_read_b64_tr_b16 a[226:227], v204 offset:38784
    v_add_f32 v231, 0x3727c5ac, v231
    v_rsq_f32 v224, v231
    v_mfma_f32_16x16x32_bf16 v[100:103], a[152:155], v[116:119], v[100:103]
    buffer_load_dwordx4 v[160:163], v248, s[36:39], s62 offen offset:2048 sc1
    v_mfma_f32_16x16x32_bf16 v[56:59], a[156:159], v[120:123], v[56:59]
    ds_read_b64_tr_b16 v[104:105], v168 offset:57344
    v_mul_f32_e64 v226, -v230, v224
    v_mfma_f32_16x16x32_bf16 v[60:63], a[160:163], v[120:123], v[60:63]
    ds_read_b64_tr_b16 v[106:107], v168 offset:59392
    s_mov_b64 exec, 0xf
    buffer_store_dwordx4 v[224:227], v248, s[36:39], s7 offen sc1
    s_mov_b64 exec, -1
    v_mfma_f32_16x16x32_bf16 v[64:67], a[164:167], v[120:123], v[64:67]
    ds_read_b64_tr_b16 v[108:109], v169 offset:57344
    v_mfma_f32_16x16x32_bf16 v[68:71], a[156:159], v[124:127], v[68:71]
    buffer_load_dwordx4 v[164:167], v248, s[36:39], s62 offen offset:3072 sc1
    v_mfma_f32_16x16x32_bf16 v[72:75], a[160:163], v[124:127], v[72:75]
    ds_read_b64_tr_b16 v[110:111], v169 offset:59392
    s_waitcnt vmcnt(8)
    v_cmp_ne_u32 vcc, s48, v240
    s_cbranch_vccnz L_chk10_slow
L_chk10_back:
    v_mfma_f32_16x16x32_bf16 v[76:79], a[164:167], v[124:127], v[76:79]
    s_waitcnt lgkmcnt(8)
    ds_read_b64_tr_b16 v[112:113], v170 offset:57344
    v_mfma_f32_16x16x32_bf16 v[80:83], a[156:159], v[128:131], v[80:83]
    s_waitcnt lgkmcnt(5)
    s_barrier
    s_add_u32 m0, s63, 81920
    ds_read_b64_tr_b16 v[114:115], v170 offset:59392
    v_mfma_f32_16x16x32_bf16 v[84:87], a[160:163], v[128:131], v[84:87]
    ds_read_b64_tr_b16 a[228:229], v203 offset:49664
    buffer_load_dwordx4 v172, s[36:39], s10 offen sc1 lds
    v_mfma_f32_16x16x32_bf16 v[88:91], a[164:167], v[128:131], v[88:91]
    ds_read_b64_tr_b16 v[116:117], v171 offset:57344
    ds_read_b64_tr_b16 a[230:231], v203 offset:51200
    v_mfma_f32_16x16x32_bf16 v[92:95], a[156:159], v[132:135], v[92:95]
    s_waitcnt lgkmcnt(3)
    s_add_u32 m0, s63, 5120
    ds_read_b64_tr_b16 v[118:119], v171 offset:59392
    v_mfma_f32_16x16x32_bf16 v[96:99], a[160:163], v[132:135], v[96:99]
    buffer_load_dwordx4 v247, s[36:39], s9 offen sc1 lds
    v_mfma_f32_16x16x32_bf16 v[100:103], a[164:167], v[132:135], v[100:103]
    s_add_u32 m0, s63, 86016
    ds_read_b64_tr_b16 a[232:233], v203 offset:55888
    v_mfma_f32_16x16x32_bf16 v[56:59], a[168:171], v[104:107], v[56:59]
    ds_read_b64_tr_b16 v[120:121], v168 offset:61440
    ds_read_b64_tr_b16 a[234:235], v203 offset:57424
    buffer_load_dwordx4 v172, s[36:39], s11 offen sc1 lds
    v_mfma_f32_16x16x32_bf16 v[60:63], a[172:175], v[104:107], v[60:63]
    ds_read_b64_tr_b16 v[122:123], v168 offset:63488
    v_add_u32 v168, 65536, v168
    v_mfma_f32_16x16x32_bf16 v[64:67], a[176:179], v[104:107], v[64:67]
    s_add_u32 m0, s63, 90112
    ds_read_b64_tr_b16 v[124:125], v169 offset:61440
    ds_read_b64_tr_b16 a[236:237], v204 offset:49664
    v_mfma_f32_16x16x32_bf16 v[68:71], a[168:171], v[108:111], v[68:71]
    ds_read_b64_tr_b16 a[238:239], v204 offset:51200
    buffer_load_dwordx4 v172, s[36:39], s12 offen sc1 lds
    v_mfma_f32_16x16x32_bf16 v[72:75], a[172:175], v[108:111], v[72:75]
    ds_read_b64_tr_b16 v[126:127], v169 offset:63488
    v_add_u32 v169, 65536, v169
    v_mfma_f32_16x16x32_bf16 v[76:79], a[176:179], v[108:111], v[76:79]
    ds_read_b64_tr_b16 v[128:129], v170 offset:61440
    v_mfma_f32_16x16x32_bf16 v[80:83], a[168:171], v[112:115], v[80:83]
    s_add_u32 m0, s63, 94208
    ds_read_b64_tr_b16 v[130:131], v170 offset:63488
    v_add_u32 v170, 65536, v170
    v_mfma_f32_16x16x32_bf16 v[84:87], a[172:175], v[112:115], v[84:87]
    buffer_load_dwordx4 v172, s[36:39], s13 offen sc1 lds
    v_mfma_f32_16x16x32_bf16 v[88:91], a[176:179], v[112:115], v[88:91]
    s_waitcnt lgkmcnt(10)
    ds_read_b64_tr_b16 v[132:133], v171 offset:61440
    v_mfma_f32_16x16x32_bf16 v[92:95], a[168:171], v[116:119], v[92:95]
    s_waitcnt lgkmcnt(3)
    ds_read_b64_tr_b16 v[134:135], v171 offset:63488
    v_add_u32 v171, 65536, v171
    v_mfma_f32_16x16x32_bf16 v[96:99], a[172:175], v[116:119], v[96:99]
    s_add_u32 m0, s63, 98304
    v_mfma_f32_16x16x32_bf16 v[100:103], a[176:179], v[116:119], v[100:103]
    buffer_load_dwordx4 v172, s[36:39], s14 offen sc1 lds
    v_mfma_f32_16x16x32_bf16 v[56:59], a[180:183], v[120:123], v[56:59]
    s_barrier
    ds_read_b64_tr_b16 v[104:105], v168 offset:0
    v_mfma_f32_16x16x32_bf16 v[60:63], a[184:187], v[120:123], v[60:63]
    ds_read_b64_tr_b16 v[106:107], v168 offset:2048
    v_mfma_f32_16x16x32_bf16 v[64:67], a[188:191], v[120:123], v[64:67]
    s_add_u32 m0, s63, 102400
    ds_read_b64_tr_b16 v[108:109], v169 offset:0
    v_mfma_f32_16x16x32_bf16 v[68:71], a[180:183], v[124:127], v[68:71]
    buffer_load_dwordx4 v172, s[36:39], s15 offen sc1 lds
    v_mfma_f32_16x16x32_bf16 v[72:75], a[184:187], v[124:127], v[72:75]
    ds_read_b64_tr_b16 v[110:111], v169 offset:2048
    v_mfma_f32_16x16x32_bf16 v[76:79], a[188:191], v[124:127], v[76:79]
    s_waitcnt lgkmcnt(6)
    ds_read_b64_tr_b16 v[112:113], v170 offset:0
    v_mfma_f32_16x16x32_bf16 v[80:83], a[180:183], v[128:131], v[80:83]
    s_add_u32 m0, s63, 106496
    ds_read_b64_tr_b16 v[114:115], v170 offset:2048
    v_mfma_f32_16x16x32_bf16 v[84:87], a[184:187], v[128:131], v[84:87]
    buffer_load_dwordx4 v172, s[36:39], s18 offen sc1 lds
    v_mfma_f32_16x16x32_bf16 v[88:91], a[188:191], v[128:131], v[88:91]
    s_waitcnt lgkmcnt(6)
    ds_read_b64_tr_b16 v[116:117], v171 offset:0
    v_mfma_f32_16x16x32_bf16 v[92:95], a[180:183], v[132:135], v[92:95]
    s_waitcnt lgkmcnt(3)
    ds_read_b64_tr_b16 v[118:119], v171 offset:2048
    v_mfma_f32_16x16x32_bf16 v[96:99], a[184:187], v[132:135], v[96:99]
    s_add_u32 m0, s63, 110592
    v_mfma_f32_16x16x32_bf16 v[100:103], a[188:191], v[132:135], v[100:103]
    buffer_load_dwordx4 v172, s[36:39], s19 offen sc1 lds
    v_mfma_f32_16x16x32_bf16 v[56:59], a[192:195], v[104:107], v[56:59]
    ds_read_b64_tr_b16 v[120:121], v168 offset:4096
    v_mfma_f32_16x16x32_bf16 v[60:63], a[196:199], v[104:107], v[60:63]
    ds_read_b64_tr_b16 v[122:123], v168 offset:6144
    v_mfma_f32_16x16x32_bf16 v[64:67], a[200:203], v[104:107], v[64:67]
    s_add_u32 m0, s63, 114688
    ds_read_b64_tr_b16 v[124:125], v169 offset:4096
    v_mfma_f32_16x16x32_bf16 v[68:71], a[192:195], v[108:111], v[68:71]
    buffer_load_dwordx4 v172, s[36:39], s20 offen sc1 lds
    v_mfma_f32_16x16x32_bf16 v[72:75], a[196:199], v[108:111], v[72:75]
    ds_read_b64_tr_b16 v[126:127], v169 offset:6144
    v_mfma_f32_16x16x32_bf16 v[76:79], a[200:203], v[108:111], v[76:79]
    s_waitcnt lgkmcnt(6)
    ds_read_b64_tr_b16 v[128:129], v170 offset:4096
    v_mfma_f32_16x16x32_bf16 v[80:83], a[192:195], v[112:115], v[80:83]
    s_add_u32 m0, s63, 118784
    ds_read_b64_tr_b16 v[130:131], v170 offset:6144
    v_mfma_f32_16x16x32_bf16 v[84:87], a[196:199], v[112:115], v[84:87]
    buffer_load_dwordx4 v172, s[36:39], s21 offen sc1 lds
    v_mfma_f32_16x16x32_bf16 v[88:91], a[200:203], v[112:115], v[88:91]
    s_waitcnt lgkmcnt(6)
    ds_read_b64_tr_b16 v[132:133], v171 offset:4096
    v_mfma_f32_16x16x32_bf16 v[92:95], a[192:195], v[116:119], v[92:95]
    s_waitcnt lgkmcnt(3)
    ds_read_b64_tr_b16 v[134:135], v171 offset:6144
    v_mfma_f32_16x16x32_bf16 v[96:99], a[196:199], v[116:119], v[96:99]
    s_add_u32 m0, s63, 122880
    v_mfma_f32_16x16x32_bf16 v[100:103], a[200:203], v[116:119], v[100:103]
    buffer_load_dwordx4 v172, s[36:39], s22 offen sc1 lds
    v_mfma_f32_16x16x32_bf16 v[56:59], a[204:207], v[120:123], v[56:59]
    ds_read_b64_tr_b16 v[104:105], v168 offset:8192
    v_mfma_f32_16x16x32_bf16 v[60:63], a[208:211], v[120:123], v[60:63]
    ds_read_b64_tr_b16 v[106:107], v168 offset:10240
    v_mfma_f32_16x16x32_bf16 v[64:67], a[212:215], v[120:123], v[64:67]
    s_add_u32 m0, s63, 126976
    ds_read_b64_tr_b16 v[108:109], v169 offset:8192
    v_mfma_f32_16x16x32_bf16 v[68:71], a[204:207], v[124:127], v[68:71]
    buffer_load_dwordx4 v172, s[36:39], s23 offen sc1 lds
    v_mfma_f32_16x16x32_bf16 v[72:75], a[208:211], v[124:127], v[72:75]
    ds_read_b64_tr_b16 v[110:111], v169 offset:10240
    v_mfma_f32_16x16x32_bf16 v[76:79], a[212:215], v[124:127], v[76:79]
    s_waitcnt lgkmcnt(6)
    ds_read_b64_tr_b16 v[112:113], v170 offset:8192
    v_mfma_f32_16x16x32_bf16 v[80:83], a[204:207], v[128:131], v[80:83]
    s_add_u32 m0, s63, 1024
    ds_read_b64_tr_b16 v[114:115], v170 offset:10240
    v_mfma_f32_16x16x32_bf16 v[84:87], a[208:211], v[128:131], v[84:87]
    buffer_load_dwordx4 v248, s[36:39], s6 offen sc1 lds
    v_mfma_f32_16x16x32_bf16 v[88:91], a[212:215], v[128:131], v[88:91]
    s_waitcnt lgkmcnt(6)
    ds_read_b64_tr_b16 v[116:117], v171 offset:8192
    v_mfma_f32_16x16x32_bf16 v[92:95], a[204:207], v[132:135], v[92:95]
    s_waitcnt lgkmcnt(3)
    ds_read_b64_tr_b16 v[118:119], v171 offset:10240
    v_mfma_f32_16x16x32_bf16 v[96:99], a[208:211], v[132:135], v[96:99]
    s_add_u32 m0, s63, 131072
    v_mfma_f32_16x16x32_bf16 v[100:103], a[212:215], v[132:135], v[100:103]
    buffer_load_dwordx4 v172, s[36:39], s24 offen sc1 lds
    v_mfma_f32_16x16x32_bf16 v[56:59], a[216:219], v[104:107], v[56:59]
    ds_read_b64_tr_b16 v[120:121], v168 offset:12288
    v_mfma_f32_16x16x32_bf16 v[60:63], a[220:223], v[104:107], v[60:63]
    ds_read_b64_tr_b16 v[122:123], v168 offset:14336
    v_add_u32 v168, 16384, v168
    v_mfma_f32_16x16x32_bf16 v[64:67], a[224:227], v[104:107], v[64:67]
    s_add_u32 m0, s63, 135168
    ds_read_b64_tr_b16 v[124:125], v169 offset:12288
    v_and_b32 v247, 48, v1
    v_mfma_f32_16x16x32_bf16 v[68:71], a[216:219], v[108:111], v[68:71]
    v_add_u32 v247, s63, v247
    buffer_load_dwordx4 v172, s[36:39], s25 offen sc1 lds
    v_mfma_f32_16x16x32_bf16 v[72:75], a[220:223], v[108:111], v[72:75]
    s_waitcnt vmcnt(14)
    ds_read_b64_tr_b16 v[126:127], v169 offset:14336
    v_add_u32 v169, 16384, v169
    v_mfma_f32_16x16x32_bf16 v[76:79], a[224:227], v[108:111], v[76:79]
    s_waitcnt lgkmcnt(6)
    ds_read_b64_tr_b16 v[128:129], v170 offset:12288
    ds_read_b128 v[176:179], v247 offset:5120
    v_mfma_f32_16x16x32_bf16 v[80:83], a[216:219], v[112:115], v[80:83]
    s_add_u32 m0, s63, 139264
    ds_read_b64_tr_b16 v[130:131], v170 offset:14336
    v_add_u32 v170, 16384, v170
    v_mfma_f32_16x16x32_bf16 v[84:87], a[220:223], v[112:115], v[84:87]
    ds_read_b128 v[180:183], v247 offset:5184
    buffer_load_dwordx4 v172, s[36:39], s26 offen sc1 lds
    v_mfma_f32_16x16x32_bf16 v[88:91], a[224:227], v[112:115], v[88:91]
    s_waitcnt lgkmcnt(8)
    ds_read_b64_tr_b16 v[132:133], v171 offset:12288
    ds_read_b128 v[184:187], v247 offset:5248
    v_mfma_f32_16x16x32_bf16 v[92:95], a[216:219], v[116:119], v[92:95]
    s_waitcnt lgkmcnt(3)
    ds_read_b64_tr_b16 v[134:135], v171 offset:14336
    v_add_u32 v171, 16384, v171
    v_mfma_f32_16x16x32_bf16 v[96:99], a[220:223], v[116:119], v[96:99]
    s_add_u32 m0, s63, 143360
    ds_read_b128 v[188:191], v247 offset:5312
    v_mfma_f32_16x16x32_bf16 v[100:103], a[224:227], v[116:119], v[100:103]
    ds_read_b128 v[192:195], v247 offset:5376
    buffer_load_dwordx4 v172, s[36:39], s27 offen sc1 lds
    v_mfma_f32_16x16x32_bf16 v[56:59], a[228:231], v[120:123], v[56:59]
    s_waitcnt vmcnt(15)
    s_barrier
    ds_read_b64_tr_b16 v[104:105], v168 offset:0
    v_mfma_f32_16x16x32_bf16 v[60:63], a[232:235], v[120:123], v[60:63]
    ds_read_b64_tr_b16 v[106:107], v168 offset:2048
    ds_read_b128 v[196:199], v247 offset:5440
    v_mfma_f32_16x16x32_bf16 v[64:67], a[236:239], v[120:123], v[64:67]
    s_add_u32 m0, s63, 147456
    ds_read_b64_tr_b16 v[108:109], v169 offset:0
    v_mfma_f32_16x16x32_bf16 v[68:71], a[228:231], v[124:127], v[68:71]
    buffer_load_dwordx4 v172, s[36:39], s44 offen sc1 lds
    v_mfma_f32_16x16x32_bf16 v[72:75], a[232:235], v[124:127], v[72:75]
    ds_read_b64_tr_b16 v[110:111], v169 offset:2048
    v_mfma_f32_16x16x32_bf16 v[76:79], a[236:239], v[124:127], v[76:79]
    ds_read_b64_tr_b16 v[112:113], v170 offset:0
    v_mfma_f32_16x16x32_bf16 v[80:83], a[228:231], v[128:131], v[80:83]
    s_add_u32 m0, s63, 151552
    ds_read_b64_tr_b16 v[114:115], v170 offset:2048
    v_mfma_f32_16x16x32_bf16 v[84:87], a[232:235], v[128:131], v[84:87]
    buffer_load_dwordx4 v172, s[36:39], s45 offen sc1 lds
    v_mfma_f32_16x16x32_bf16 v[88:91], a[236:239], v[128:131], v[88:91]
    s_waitcnt lgkmcnt(9)
    ds_read_b64_tr_b16 v[116:117], v171 offset:0
    v_mfma_f32_16x16x32_bf16 v[92:95], a[228:231], v[132:135], v[92:95]
    s_waitcnt lgkmcnt(3)
    ds_read_b64_tr_b16 v[118:119], v171 offset:2048
    v_mfma_f32_16x16x32_bf16 v[96:99], a[232:235], v[132:135], v[96:99]
    v_mfma_f32_16x16x32_bf16 v[100:103], a[236:239], v[132:135], v[100:103]
    v_mfma_f32_16x16x32_bf16 v[8:11], a[0:3], v[104:107], 0
    ds_read_b64_tr_b16 v[120:121], v168 offset:4096
    v_add_u32 v216, 81920, v216
    v_mfma_f32_16x16x32_bf16 v[12:15], a[4:7], v[104:107], 0
    ds_read_b64_tr_b16 v[122:123], v168 offset:6144
    v_add_u32 v217, 81920, v217
    v_mfma_f32_16x16x32_bf16 v[16:19], a[8:11], v[104:107], 0
    s_add_u32 m0, s63, 155648
    ds_read_b64_tr_b16 v[124:125], v169 offset:4096
    v_add_u32 v218, 81920, v218
    v_mfma_f32_16x16x32_bf16 v[20:23], a[0:3], v[108:111], 0
    buffer_load_dwordx4 v172, s[36:39], s46 offen sc1 lds
    v_mfma_f32_16x16x32_bf16 v[24:27], a[4:7], v[108:111], 0
    ds_read_b64_tr_b16 v[126:127], v169 offset:6144
    v_mfma_f32_16x16x32_bf16 v[28:31], a[8:11], v[108:111], 0
    s_waitcnt lgkmcnt(6)
    ds_read_b64_tr_b16 v[128:129], v170 offset:4096
    v_mfma_f32_16x16x32_bf16 v[32:35], a[0:3], v[112:115], 0
    s_add_u32 m0, s63, 159744
    ds_read_b64_tr_b16 v[130:131], v170 offset:6144
    v_mfma_f32_16x16x32_bf16 v[36:39], a[4:7], v[112:115], 0
    buffer_load_dwordx4 v172, s[36:39], s47 offen sc1 lds
    v_mfma_f32_16x16x32_bf16 v[40:43], a[8:11], v[112:115], 0
    s_waitcnt lgkmcnt(6)
    ds_read_b64_tr_b16 v[132:133], v171 offset:4096
    v_mfma_f32_16x16x32_bf16 v[44:47], a[0:3], v[116:119], 0
    s_waitcnt lgkmcnt(3)
    ds_read_b64_tr_b16 v[134:135], v171 offset:6144
    v_mfma_f32_16x16x32_bf16 v[48:51], a[4:7], v[116:119], 0
    v_mfma_f32_16x16x32_bf16 v[52:55], a[8:11], v[116:119], 0
    v_mfma_f32_16x16x32_bf16 v[8:11], a[12:15], v[120:123], v[8:11]
    s_waitcnt vmcnt(16)
    s_barrier
    ds_read_b64_tr_b16 v[104:105], v168 offset:8192
    v_mfma_f32_16x16x32_bf16 v[12:15], a[16:19], v[120:123], v[12:15]
    ds_read_b64_tr_b16 v[106:107], v168 offset:10240
    v_mfma_f32_16x16x32_bf16 v[16:19], a[20:23], v[120:123], v[16:19]
    s_waitcnt vmcnt(8)
    s_add_u32 s62, s62, 4096
    ds_read_b64_tr_b16 v[108:109], v169 offset:8192
    v_mfma_f32_16x16x32_bf16 v[20:23], a[12:15], v[124:127], v[20:23]
    ds_read_b128 v[200:203], v175 offset:1024
    buffer_load_dwordx4 a[0:3], v248, s[36:39], s62 offen offset:0 sc1
    v_mfma_f32_16x16x32_bf16 v[24:27], a[16:19], v[124:127], v[24:27]
    ds_read_b64_tr_b16 v[110:111], v169 offset:10240
    ds_read_b128 v[204:207], v175 offset:1280
    v_mfma_f32_16x16x32_bf16 v[28:31], a[20:23], v[124:127], v[28:31]
    s_waitcnt lgkmcnt(8)
    ds_read_b64_tr_b16 v[112:113], v170 offset:8192
    ds_read_b128 v[208:211], v175 offset:1536
    v_mfma_f32_16x16x32_bf16 v[32:35], a[12:15], v[128:131], v[32:35]
    ds_read_b64_tr_b16 v[114:115], v170 offset:10240
    v_mfma_f32_16x16x32_bf16 v[36:39], a[16:19], v[128:131], v[36:39]
    ds_read_b128 v[212:215], v175 offset:1792
    buffer_load_dwordx4 a[4:7], v248, s[36:39], s62 offen offset:1024 sc1
    v_mfma_f32_16x16x32_bf16 v[40:43], a[20:23], v[128:131], v[40:43]
    s_waitcnt lgkmcnt(10)
    ds_read_b64_tr_b16 v[116:117], v171 offset:8192
    v_mfma_f32_16x16x32_bf16 v[44:47], a[12:15], v[132:135], v[44:47]
    s_waitcnt lgkmcnt(3)
    ds_read_b64_tr_b16 v[118:119], v171 offset:10240
    v_mfma_f32_16x16x32_bf16 v[48:51], a[16:19], v[132:135], v[48:51]
    v_xor_b32 v3, s48, v201
    v_bitop3_b32 v3, v203, s48, v3 bitop3:0xbe
    v_mfma_f32_16x16x32_bf16 v[52:55], a[20:23], v[132:135], v[52:55]
    buffer_load_dwordx4 a[8:11], v248, s[36:39], s62 offen offset:2048 sc1
    v_mfma_f32_16x16x32_bf16 v[8:11], a[24:27], v[104:107], v[8:11]
    ds_read_b64_tr_b16 v[120:121], v168 offset:12288
    v_bitop3_b32 v3, v205, s48, v3 bitop3:0xbe
    v_mfma_f32_16x16x32_bf16 v[12:15], a[28:31], v[104:107], v[12:15]
    ds_read_b64_tr_b16 v[122:123], v168 offset:14336
    v_bitop3_b32 v3, v207, s48, v3 bitop3:0xbe
    v_bitop3_b32 v3, v209, s48, v3 bitop3:0xbe
    v_mfma_f32_16x16x32_bf16 v[16:19], a[32:35], v[104:107], v[16:19]
    ds_read_b64_tr_b16 v[124:125], v169 offset:12288
    v_bitop3_b32 v3, v211, s48, v3 bitop3:0xbe
    v_mfma_f32_16x16x32_bf16 v[20:23], a[24:27], v[108:111], v[20:23]
    s_waitcnt lgkmcnt(5)
    v_bitop3_b32 v3, v213, s48, v3 bitop3:0xbe
    buffer_load_dwordx4 a[12:15], v248, s[36:39], s62 offen offset:3072 sc1
    v_mfma_f32_16x16x32_bf16 v[24:27], a[28:31], v[108:111], v[24:27]
    ds_read_b64_tr_b16 v[126:127], v169 offset:14336
    v_bitop3_b32 v3, v215, s48, v3 bitop3:0xbe
    v_mfma_f32_16x16x32_bf16 v[28:31], a[32:35], v[108:111], v[28:31]
    ds_read_b64_tr_b16 v[128:129], v170 offset:12288
    v_cmp_ne_u32 vcc, 0, v3
    s_cbranch_vccnz L_stc0_slow
L_stc0_back:
    v_mfma_f32_16x16x32_bf16 v[32:35], a[24:27], v[112:115], v[32:35]
    s_add_u32 s62, s62, 4096
    ds_read_b64_tr_b16 v[130:131], v170 offset:14336
    s_add_u32 s50, s8, 98304
    v_pk_fma_f32 v[238:239], v[176:177], v[202:203], v[188:189] op_sel_hi:[1,0,1]
    v_pk_fma_f32 v[240:241], v[178:179], v[202:203], v[190:191] op_sel_hi:[1,0,1]
    v_pk_fma_f32 v[56:57], v[56:57], v[200:201], v[238:239] op_sel_hi:[1,0,1]
    v_pk_fma_f32 v[58:59], v[58:59], v[200:201], v[240:241] op_sel_hi:[1,0,1]
    v_pk_fma_f32 v[242:243], v[180:181], v[202:203], v[192:193] op_sel_hi:[1,0,1]
    v_pk_fma_f32 v[244:245], v[182:183], v[202:203], v[194:195] op_sel_hi:[1,0,1]
    v_pk_fma_f32 v[60:61], v[60:61], v[200:201], v[242:243] op_sel_hi:[1,0,1]
    v_pk_fma_f32 v[62:63], v[62:63], v[200:201], v[244:245] op_sel_hi:[1,0,1]
    v_pk_mul_f32 v[56:57], v[56:57], v[60:61]
    v_pk_mul_f32 v[58:59], v[58:59], v[62:63]
    v_cvt_pk_bf16_f32 v60, v56, v57
    v_cvt_pk_bf16_f32 v61, v58, v59
    v_pk_fma_f32 v[242:243], v[176:177], v[206:207], v[188:189] op_sel_hi:[1,0,1]
    v_pk_fma_f32 v[244:245], v[178:179], v[206:207], v[190:191] op_sel_hi:[1,0,1]
    v_pk_fma_f32 v[68:69], v[68:69], v[204:205], v[242:243] op_sel_hi:[1,0,1]
    v_pk_fma_f32 v[70:71], v[70:71], v[204:205], v[244:245] op_sel_hi:[1,0,1]
    v_pk_fma_f32 v[238:239], v[180:181], v[206:207], v[192:193] op_sel_hi:[1,0,1]
    v_pk_fma_f32 v[240:241], v[182:183], v[206:207], v[194:195] op_sel_hi:[1,0,1]
    v_pk_fma_f32 v[72:73], v[72:73], v[204:205], v[238:239] op_sel_hi:[1,0,1]
    v_pk_fma_f32 v[74:75], v[74:75], v[204:205], v[240:241] op_sel_hi:[1,0,1]
    v_pk_mul_f32 v[68:69], v[68:69], v[72:73]
    v_pk_mul_f32 v[70:71], v[70:71], v[74:75]
    v_cvt_pk_bf16_f32 v62, v68, v69
    v_cvt_pk_bf16_f32 v63, v70, v71
    s_nop 0
    v_permlane16_swap_b32 v60, v62
    v_permlane16_swap_b32 v61, v63
    buffer_store_dwordx4 v[60:63], v173, s[36:39], s8 offen sc1
    v_pk_fma_f32 v[238:239], v[176:177], v[210:211], v[188:189] op_sel_hi:[1,0,1]
    v_pk_fma_f32 v[240:241], v[178:179], v[210:211], v[190:191] op_sel_hi:[1,0,1]
    v_pk_fma_f32 v[80:81], v[80:81], v[208:209], v[238:239] op_sel_hi:[1,0,1]
    v_pk_fma_f32 v[82:83], v[82:83], v[208:209], v[240:241] op_sel_hi:[1,0,1]
    v_pk_fma_f32 v[242:243], v[180:181], v[210:211], v[192:193] op_sel_hi:[1,0,1]
    v_pk_fma_f32 v[244:245], v[182:183], v[210:211], v[194:195] op_sel_hi:[1,0,1]
    v_pk_fma_f32 v[84:85], v[84:85], v[208:209], v[242:243] op_sel_hi:[1,0,1]
    v_pk_fma_f32 v[86:87], v[86:87], v[208:209], v[244:245] op_sel_hi:[1,0,1]
    v_pk_mul_f32 v[80:81], v[80:81], v[84:85]
    v_pk_mul_f32 v[82:83], v[82:83], v[86:87]
    v_cvt_pk_bf16_f32 v84, v80, v81
    v_cvt_pk_bf16_f32 v85, v82, v83
    v_pk_fma_f32 v[242:243], v[176:177], v[214:215], v[188:189] op_sel_hi:[1,0,1]
    v_pk_fma_f32 v[244:245], v[178:179], v[214:215], v[190:191] op_sel_hi:[1,0,1]
    v_pk_fma_f32 v[92:93], v[92:93], v[212:213], v[242:243] op_sel_hi:[1,0,1]
    v_pk_fma_f32 v[94:95], v[94:95], v[212:213], v[244:245] op_sel_hi:[1,0,1]
    v_pk_fma_f32 v[238:239], v[180:181], v[214:215], v[192:193] op_sel_hi:[1,0,1]
    v_pk_fma_f32 v[240:241], v[182:183], v[214:215], v[194:195] op_sel_hi:[1,0,1]
    v_pk_fma_f32 v[96:97], v[96:97], v[212:213], v[238:239] op_sel_hi:[1,0,1]
    v_pk_fma_f32 v[98:99], v[98:99], v[212:213], v[240:241] op_sel_hi:[1,0,1]
    v_pk_mul_f32 v[92:93], v[92:93], v[96:97]
    v_pk_mul_f32 v[94:95], v[94:95], v[98:99]
    v_cvt_pk_bf16_f32 v86, v92, v93
    v_cvt_pk_bf16_f32 v87, v94, v95
    s_nop 0
    v_permlane16_swap_b32 v84, v86
    v_permlane16_swap_b32 v85, v87
    buffer_store_dwordx4 v[84:87], v173, s[36:39], s50 offen sc1
    v_pk_fma_f32 v[238:239], v[184:185], v[202:203], v[196:197] op_sel_hi:[1,0,1]
    v_pk_fma_f32 v[240:241], v[186:187], v[202:203], v[198:199] op_sel_hi:[1,0,1]
    v_pk_fma_f32 v[64:65], v[64:65], v[200:201], v[238:239] op_sel_hi:[1,0,1]
    v_pk_fma_f32 v[66:67], v[66:67], v[200:201], v[240:241] op_sel_hi:[1,0,1]
    v_pk_fma_f32 v[242:243], v[184:185], v[206:207], v[196:197] op_sel_hi:[1,0,1]
    v_pk_fma_f32 v[244:245], v[186:187], v[206:207], v[198:199] op_sel_hi:[1,0,1]
    v_pk_fma_f32 v[76:77], v[76:77], v[204:205], v[242:243] op_sel_hi:[1,0,1]
    v_pk_fma_f32 v[78:79], v[78:79], v[204:205], v[244:245] op_sel_hi:[1,0,1]
    s_nop 0
    v_permlane32_swap_b32 v64, v76
    v_permlane32_swap_b32 v65, v77
    v_permlane32_swap_b32 v66, v78
    v_permlane32_swap_b32 v67, v79
    v_pk_mul_f32 v[64:65], v[64:65], v[76:77]
    v_pk_mul_f32 v[66:67], v[66:67], v[78:79]
    v_cvt_pk_bf16_f32 v56, v64, v65
    v_cvt_pk_bf16_f32 v57, v66, v67
    v_pk_fma_f32 v[238:239], v[184:185], v[210:211], v[196:197] op_sel_hi:[1,0,1]
    v_pk_fma_f32 v[240:241], v[186:187], v[210:211], v[198:199] op_sel_hi:[1,0,1]
    v_pk_fma_f32 v[88:89], v[88:89], v[208:209], v[238:239] op_sel_hi:[1,0,1]
    v_pk_fma_f32 v[90:91], v[90:91], v[208:209], v[240:241] op_sel_hi:[1,0,1]
    v_pk_fma_f32 v[242:243], v[184:185], v[214:215], v[196:197] op_sel_hi:[1,0,1]
    v_pk_fma_f32 v[244:245], v[186:187], v[214:215], v[198:199] op_sel_hi:[1,0,1]
    v_pk_fma_f32 v[100:101], v[100:101], v[212:213], v[242:243] op_sel_hi:[1,0,1]
    v_pk_fma_f32 v[102:103], v[102:103], v[212:213], v[244:245] op_sel_hi:[1,0,1]
    s_nop 0
    v_permlane32_swap_b32 v88, v100
    v_permlane32_swap_b32 v89, v101
    v_permlane32_swap_b32 v90, v102
    v_permlane32_swap_b32 v91, v103
    v_pk_mul_f32 v[88:89], v[88:89], v[100:101]
    v_pk_mul_f32 v[90:91], v[90:91], v[102:103]
    v_cvt_pk_bf16_f32 v58, v88, v89
    v_cvt_pk_bf16_f32 v59, v90, v91
    s_nop 0
    v_permlane16_swap_b32 v56, v58
    v_permlane16_swap_b32 v57, v59
    buffer_store_dwordx4 v[56:59], v174, s[36:39], s8 offen offset:512 sc1
    s_add_u32 s6, s6, 16384
    s_lshl_b32 s76, s72, 4
    s_add_u32 s76, s76, s73
    v_mfma_f32_16x16x32_bf16 v[36:39], a[28:31], v[112:115], v[36:39]
    buffer_load_dwordx4 a[16:19], v248, s[36:39], s62 offen offset:0 sc1
    v_mfma_f32_16x16x32_bf16 v[40:43], a[32:35], v[112:115], v[40:43]
    s_waitcnt lgkmcnt(6)
    ds_read_b64_tr_b16 v[132:133], v171 offset:12288
    v_mfma_f32_16x16x32_bf16 v[44:47], a[24:27], v[116:119], v[44:47]
    s_waitcnt lgkmcnt(3)
    ds_read_b64_tr_b16 v[134:135], v171 offset:14336
    v_mfma_f32_16x16x32_bf16 v[48:51], a[28:31], v[116:119], v[48:51]
    v_mfma_f32_16x16x32_bf16 v[52:55], a[32:35], v[116:119], v[52:55]
    buffer_load_dwordx4 a[20:23], v248, s[36:39], s62 offen offset:1024 sc1
    v_mfma_f32_16x16x32_bf16 v[8:11], a[36:39], v[120:123], v[8:11]
    ds_read_b64_tr_b16 v[104:105], v168 offset:16384
    v_mfma_f32_16x16x32_bf16 v[12:15], a[40:43], v[120:123], v[12:15]
    ds_read_b64_tr_b16 v[106:107], v168 offset:18432
    v_mfma_f32_16x16x32_bf16 v[16:19], a[44:47], v[120:123], v[16:19]
    ds_read_b64_tr_b16 v[108:109], v169 offset:16384
    v_mfma_f32_16x16x32_bf16 v[20:23], a[36:39], v[124:127], v[20:23]
    buffer_load_dwordx4 a[24:27], v248, s[36:39], s62 offen offset:2048 sc1
    v_mfma_f32_16x16x32_bf16 v[24:27], a[40:43], v[124:127], v[24:27]
    ds_read_b64_tr_b16 v[110:111], v169 offset:18432
    v_mfma_f32_16x16x32_bf16 v[28:31], a[44:47], v[124:127], v[28:31]
    s_waitcnt lgkmcnt(6)
    ds_read_b64_tr_b16 v[112:113], v170 offset:16384
    v_mfma_f32_16x16x32_bf16 v[32:35], a[36:39], v[128:131], v[32:35]
    ds_read_b64_tr_b16 v[114:115], v170 offset:18432
    v_mfma_f32_16x16x32_bf16 v[36:39], a[40:43], v[128:131], v[36:39]
    buffer_load_dwordx4 a[28:31], v248, s[36:39], s62 offen offset:3072 sc1
    v_mfma_f32_16x16x32_bf16 v[40:43], a[44:47], v[128:131], v[40:43]
    s_waitcnt lgkmcnt(6)
    ds_read_b64_tr_b16 v[116:117], v171 offset:16384
    v_mfma_f32_16x16x32_bf16 v[44:47], a[36:39], v[132:135], v[44:47]
    s_waitcnt lgkmcnt(3)
    ds_read_b64_tr_b16 v[118:119], v171 offset:18432
    v_mfma_f32_16x16x32_bf16 v[48:51], a[40:43], v[132:135], v[48:51]
    s_add_u32 s62, s62, 4096
    v_mfma_f32_16x16x32_bf16 v[52:55], a[44:47], v[132:135], v[52:55]
    buffer_load_dwordx4 a[32:35], v248, s[36:39], s62 offen offset:0 sc1
    v_mfma_f32_16x16x32_bf16 v[8:11], a[48:51], v[104:107], v[8:11]
    s_waitcnt vmcnt(12)
    s_barrier
    ds_read_b64_tr_b16 v[120:121], v168 offset:20480
    v_mfma_f32_16x16x32_bf16 v[12:15], a[52:55], v[104:107], v[12:15]
    ds_read_b64_tr_b16 v[122:123], v168 offset:22528
    ds_read_b64 v[224:225], v216
    v_mfma_f32_16x16x32_bf16 v[16:19], a[56:59], v[104:107], v[16:19]
    ds_read_b64_tr_b16 v[124:125], v169 offset:20480
    ds_read_b64 v[226:227], v217
    v_mfma_f32_16x16x32_bf16 v[20:23], a[48:51], v[108:111], v[20:23]
    buffer_load_dwordx4 a[36:39], v248, s[36:39], s62 offen offset:1024 sc1
    v_mfma_f32_16x16x32_bf16 v[24:27], a[52:55], v[108:111], v[24:27]
    ds_read_b64_tr_b16 v[126:127], v169 offset:22528
    ds_read_b64 v[228:229], v218
    v_mfma_f32_16x16x32_bf16 v[28:31], a[56:59], v[108:111], v[28:31]
    s_waitcnt lgkmcnt(9)
    ds_read_b64_tr_b16 v[128:129], v170 offset:20480
    v_mfma_f32_16x16x32_bf16 v[32:35], a[48:51], v[112:115], v[32:35]
    ds_read_b64_tr_b16 v[130:131], v170 offset:22528
    v_mfma_f32_16x16x32_bf16 v[36:39], a[52:55], v[112:115], v[36:39]
    buffer_load_dwordx4 a[40:43], v248, s[36:39], s62 offen offset:2048 sc1
    v_mfma_f32_16x16x32_bf16 v[40:43], a[56:59], v[112:115], v[40:43]
    s_waitcnt lgkmcnt(9)
    ds_read_b64_tr_b16 v[132:133], v171 offset:20480
    v_mfma_f32_16x16x32_bf16 v[44:47], a[48:51], v[116:119], v[44:47]
    s_waitcnt lgkmcnt(3)
    ds_read_b64_tr_b16 v[134:135], v171 offset:22528
    v_mfma_f32_16x16x32_bf16 v[48:51], a[52:55], v[116:119], v[48:51]
    v_lshlrev_b32 v230, 16, v224
    v_and_b32 v231, 0xffff0000, v224
    v_pk_mul_f32 v[230:231], v[230:231], v[220:221] op_sel_hi:[1,0]
    v_pk_mul_f32 v[234:235], v[230:231], v[230:231]
    v_lshlrev_b32 v232, 16, v225
    v_and_b32 v233, 0xffff0000, v225
    v_pk_mul_f32 v[232:233], v[232:233], v[220:221] op_sel_hi:[1,0]
    v_pk_mul_f32 v[236:237], v[232:233], v[232:233]
    v_lshlrev_b32 v2, 16, v226
    v_and_b32 v3, 0xffff0000, v226
    v_pk_mul_f32 v[2:3], v[2:3], v[220:221] op_sel:[0,1] op_sel_hi:[1,1]
    v_pk_add_f32 v[230:231], v[230:231], v[2:3]
    v_pk_fma_f32 v[234:235], v[2:3], v[2:3], v[234:235]
    v_lshlrev_b32 v2, 16, v227
    v_and_b32 v3, 0xffff0000, v227
    v_pk_mul_f32 v[2:3], v[2:3], v[220:221] op_sel:[0,1] op_sel_hi:[1,1]
    v_pk_add_f32 v[232:233], v[232:233], v[2:3]
    v_pk_fma_f32 v[236:237], v[2:3], v[2:3], v[236:237]
    v_lshlrev_b32 v2, 16, v228
    v_and_b32 v3, 0xffff0000, v228
    v_pk_mul_f32 v[2:3], v[2:3], v[222:223] op_sel_hi:[1,0]
    v_pk_add_f32 v[230:231], v[230:231], v[2:3]
    v_pk_fma_f32 v[234:235], v[2:3], v[2:3], v[234:235]
    v_lshlrev_b32 v2, 16, v229
    v_and_b32 v3, 0xffff0000, v229
    v_pk_mul_f32 v[2:3], v[2:3], v[222:223] op_sel_hi:[1,0]
    v_pk_add_f32 v[232:233], v[232:233], v[2:3]
    v_pk_fma_f32 v[236:237], v[2:3], v[2:3], v[236:237]
    v_mfma_f32_16x16x32_bf16 v[52:55], a[56:59], v[116:119], v[52:55]
    buffer_load_dwordx4 a[44:47], v248, s[36:39], s62 offen offset:3072 sc1
    v_mfma_f32_16x16x32_bf16 v[8:11], a[60:63], v[120:123], v[8:11]
    ds_read_b64_tr_b16 v[104:105], v168 offset:24576
    v_permlane32_swap_b32 v230, v234
    v_mfma_f32_16x16x32_bf16 v[12:15], a[64:67], v[120:123], v[12:15]
    ds_read_b64_tr_b16 v[106:107], v168 offset:26624
    v_permlane32_swap_b32 v231, v235
    v_mfma_f32_16x16x32_bf16 v[16:19], a[68:71], v[120:123], v[16:19]
    s_add_u32 s62, s62, 4096
    ds_read_b64_tr_b16 v[108:109], v169 offset:24576
    v_permlane32_swap_b32 v232, v236
    v_mfma_f32_16x16x32_bf16 v[20:23], a[60:63], v[124:127], v[20:23]
    buffer_load_dwordx4 a[48:51], v248, s[36:39], s62 offen offset:0 sc1
    v_mfma_f32_16x16x32_bf16 v[24:27], a[64:67], v[124:127], v[24:27]
    ds_read_b64_tr_b16 v[110:111], v169 offset:26624
    v_permlane32_swap_b32 v233, v237
    v_mfma_f32_16x16x32_bf16 v[28:31], a[68:71], v[124:127], v[28:31]
    s_waitcnt lgkmcnt(6)
    ds_read_b64_tr_b16 v[112:113], v170 offset:24576
    v_add_f32 v230, v230, v234
    v_mfma_f32_16x16x32_bf16 v[32:35], a[60:63], v[128:131], v[32:35]
    ds_read_b64_tr_b16 v[114:115], v170 offset:26624
    v_add_f32 v231, v231, v235
    v_add_f32 v232, v232, v236
    v_mfma_f32_16x16x32_bf16 v[36:39], a[64:67], v[128:131], v[36:39]
    buffer_load_dwordx4 a[52:55], v248, s[36:39], s62 offen offset:1024 sc1
    v_mfma_f32_16x16x32_bf16 v[40:43], a[68:71], v[128:131], v[40:43]
    s_waitcnt lgkmcnt(6)
    ds_read_b64_tr_b16 v[116:117], v171 offset:24576
    v_add_f32 v233, v233, v237
    v_mfma_f32_16x16x32_bf16 v[44:47], a[60:63], v[132:135], v[44:47]
    s_waitcnt lgkmcnt(3)
    ds_read_b64_tr_b16 v[118:119], v171 offset:26624
    v_permlane16_swap_b32 v230, v232
    v_permlane16_swap_b32 v231, v233
    v_mfma_f32_16x16x32_bf16 v[48:51], a[64:67], v[132:135], v[48:51]
    s_waitcnt vmcnt(10)
    s_barrier
    s_cmp_eq_u32 s3, 0
    s_cbranch_scc0 L_wf11
    s_lshl_b32 s54, s76, 7
    s_add_u32 s54, s54, 23288832
    v_mov_b32 v254, 0
    v_mov_b32 v255, s48
    s_mov_b64 exec, 1
    buffer_store_dword v255, v254, s[36:39], s54 offen sc1
    s_mov_b64 exec, -1
L_wf11:
    v_mfma_f32_16x16x32_bf16 v[52:55], a[68:71], v[132:135], v[52:55]
    buffer_load_dwordx4 a[56:59], v248, s[36:39], s62 offen offset:2048 sc1
    v_mfma_f32_16x16x32_bf16 v[8:11], a[72:75], v[104:107], v[8:11]
    ds_read_b64_tr_b16 v[120:121], v168 offset:28672
    v_add_f32 v230, v230, v232
    v_mfma_f32_16x16x32_bf16 v[12:15], a[76:79], v[104:107], v[12:15]
    ds_read_b64_tr_b16 v[122:123], v168 offset:30720
    v_add_f32 v231, v231, v233
    v_mfma_f32_16x16x32_bf16 v[16:19], a[80:83], v[104:107], v[16:19]
    ds_read_b64_tr_b16 v[124:125], v169 offset:28672
    v_lshrrev_b32 v2, 4, v1
    v_mfma_f32_16x16x32_bf16 v[20:23], a[72:75], v[108:111], v[20:23]
    buffer_load_dwordx4 a[60:63], v248, s[36:39], s62 offen offset:3072 sc1
    v_mfma_f32_16x16x32_bf16 v[24:27], a[76:79], v[108:111], v[24:27]
    ds_read_b64_tr_b16 v[126:127], v169 offset:30720
    v_lshlrev_b32 v2, 3, v2
    v_mfma_f32_16x16x32_bf16 v[28:31], a[80:83], v[108:111], v[28:31]
    s_waitcnt lgkmcnt(6)
    s_lshl_b32 s50, s3, 5
    s_add_u32 s50, s50, 0
    ds_read_b64_tr_b16 v[128:129], v170 offset:28672
    v_mfma_f32_16x16x32_bf16 v[32:35], a[72:75], v[112:115], v[32:35]
    s_add_u32 s62, s62, 4096
    ds_read_b64_tr_b16 v[130:131], v170 offset:30720
    v_add_u32 v2, s50, v2
    v_mfma_f32_16x16x32_bf16 v[36:39], a[76:79], v[112:115], v[36:39]
    buffer_load_dwordx4 a[64:67], v248, s[36:39], s62 offen offset:0 sc1
    v_mfma_f32_16x16x32_bf16 v[40:43], a[80:83], v[112:115], v[40:43]
    s_waitcnt lgkmcnt(6)
    ds_read_b64_tr_b16 v[132:133], v171 offset:28672
    v_add_f32_dpp v230, v230, v230 row_ror:8 row_mask:0xf bank_mask:0xf
    v_mfma_f32_16x16x32_bf16 v[44:47], a[72:75], v[116:119], v[44:47]
    s_waitcnt lgkmcnt(3)
    ds_read_b64_tr_b16 v[134:135], v171 offset:30720
    v_add_f32_dpp v231, v231, v231 row_ror:8 row_mask:0xf bank_mask:0xf
    v_mfma_f32_16x16x32_bf16 v[48:51], a[76:79], v[116:119], v[48:51]
    v_add_f32_dpp v230, v230, v230 row_ror:4 row_mask:0xf bank_mask:0xf
    v_add_f32_dpp v231, v231, v231 row_ror:4 row_mask:0xf bank_mask:0xf
    v_mfma_f32_16x16x32_bf16 v[52:55], a[80:83], v[116:119], v[52:55]
    buffer_load_dwordx4 a[68:71], v248, s[36:39], s62 offen offset:1024 sc1
    v_mfma_f32_16x16x32_bf16 v[8:11], a[84:87], v[120:123], v[8:11]
    ds_read_b64_tr_b16 v[104:105], v168 offset:32768
    v_add_f32_dpp v230, v230, v230 row_ror:2 row_mask:0xf bank_mask:0xf
    v_mfma_f32_16x16x32_bf16 v[12:15], a[88:91], v[120:123], v[12:15]
    ds_read_b64_tr_b16 v[106:107], v168 offset:34816
    v_add_f32_dpp v231, v231, v231 row_ror:2 row_mask:0xf bank_mask:0xf
    v_mfma_f32_16x16x32_bf16 v[16:19], a[92:95], v[120:123], v[16:19]
    ds_read_b64_tr_b16 v[108:109], v169 offset:32768
    v_add_f32_dpp v230, v230, v230 row_ror:1 row_mask:0xf bank_mask:0xf
    v_mfma_f32_16x16x32_bf16 v[20:23], a[84:87], v[124:127], v[20:23]
    buffer_load_dwordx4 a[72:75], v248, s[36:39], s62 offen offset:2048 sc1
    v_mfma_f32_16x16x32_bf16 v[24:27], a[88:91], v[124:127], v[24:27]
    ds_read_b64_tr_b16 v[110:111], v169 offset:34816
    v_add_f32_dpp v231, v231, v231 row_ror:1 row_mask:0xf bank_mask:0xf
    v_mfma_f32_16x16x32_bf16 v[28:31], a[92:95], v[124:127], v[28:31]
    ds_read_b64_tr_b16 v[112:113], v170 offset:32768
    s_mov_b32 exec_lo, 0x00010001
    s_mov_b32 exec_hi, 0x00010001
    ds_write_b64 v2, v[230:231]
    s_mov_b64 exec, -1
    s_waitcnt lgkmcnt(8)
    v_mfma_f32_16x16x32_bf16 v[32:35], a[84:87], v[128:131], v[32:35]
    ds_read_b64_tr_b16 v[114:115], v170 offset:34816
    v_lshlrev_b32 v2, 2, v1
    v_mfma_f32_16x16x32_bf16 v[36:39], a[88:91], v[128:131], v[36:39]
    buffer_load_dwordx4 a[76:79], v248, s[36:39], s62 offen offset:3072 sc1
    v_mfma_f32_16x16x32_bf16 v[40:43], a[92:95], v[128:131], v[40:43]
    s_waitcnt lgkmcnt(7)
    ds_read_b64_tr_b16 v[116:117], v171 offset:32768
    v_and_b32 v2, 12, v2
    v_mfma_f32_16x16x32_bf16 v[44:47], a[84:87], v[132:135], v[44:47]
    s_waitcnt lgkmcnt(3)
    ds_read_b64_tr_b16 v[118:119], v171 offset:34816
    v_add_u32 v2, 0, v2
    v_mfma_f32_16x16x32_bf16 v[48:51], a[88:91], v[132:135], v[48:51]
    s_add_u32 s62, s62, 4096
    s_waitcnt lgkmcnt(0)
    s_barrier
    v_mfma_f32_16x16x32_bf16 v[52:55], a[92:95], v[132:135], v[52:55]
    buffer_load_dwordx4 a[80:83], v248, s[36:39], s62 offen offset:0 sc1
    v_mfma_f32_16x16x32_bf16 v[8:11], a[96:99], v[104:107], v[8:11]
    ds_read_b64_tr_b16 v[120:121], v168 offset:36864
    ds_read2_b32 v[230:231], v2 offset0:0 offset1:4
    v_mfma_f32_16x16x32_bf16 v[12:15], a[100:103], v[104:107], v[12:15]
    ds_read_b64_tr_b16 v[122:123], v168 offset:38912
    ds_read2_b32 v[232:233], v2 offset0:8 offset1:12
    v_mfma_f32_16x16x32_bf16 v[16:19], a[104:107], v[104:107], v[16:19]
    ds_read_b64_tr_b16 v[124:125], v169 offset:36864
    ds_read2_b32 v[234:235], v2 offset0:16 offset1:20
    ds_read2_b32 v[236:237], v2 offset0:24 offset1:28
    v_mfma_f32_16x16x32_bf16 v[20:23], a[96:99], v[108:111], v[20:23]
    buffer_load_dwordx4 a[84:87], v248, s[36:39], s62 offen offset:1024 sc1
    v_mfma_f32_16x16x32_bf16 v[24:27], a[100:103], v[108:111], v[24:27]
    ds_read_b64_tr_b16 v[126:127], v169 offset:38912
    v_mov_b32 v225, s48
    v_mfma_f32_16x16x32_bf16 v[28:31], a[104:107], v[108:111], v[28:31]
    ds_read_b64_tr_b16 v[128:129], v170 offset:36864
    v_mov_b32 v227, s48
    v_mfma_f32_16x16x32_bf16 v[32:35], a[96:99], v[112:115], v[32:35]
    s_add_u32 s7, s7, 16384
    ds_read_b64_tr_b16 v[130:131], v170 offset:38912
    s_waitcnt lgkmcnt(6)
    v_add_f32 v230, v230, v232
    v_mfma_f32_16x16x32_bf16 v[36:39], a[100:103], v[112:115], v[36:39]
    buffer_load_dwordx4 a[88:91], v248, s[36:39], s62 offen offset:2048 sc1
    v_mfma_f32_16x16x32_bf16 v[40:43], a[104:107], v[112:115], v[40:43]
    ds_read_b64_tr_b16 v[132:133], v171 offset:36864
    v_add_f32 v231, v231, v233
    v_mfma_f32_16x16x32_bf16 v[44:47], a[96:99], v[116:119], v[44:47]
    s_waitcnt lgkmcnt(3)
    ds_read_b64_tr_b16 v[134:135], v171 offset:38912
    v_add_f32 v234, v234, v236
    v_mfma_f32_16x16x32_bf16 v[48:51], a[100:103], v[116:119], v[48:51]
    v_mfma_f32_16x16x32_bf16 v[52:55], a[104:107], v[116:119], v[52:55]
    buffer_load_dwordx4 a[92:95], v248, s[36:39], s62 offen offset:3072 sc1
    v_mfma_f32_16x16x32_bf16 v[8:11], a[108:111], v[120:123], v[8:11]
    ds_read_b64_tr_b16 v[104:105], v168 offset:40960
    v_add_f32 v235, v235, v237
    v_mfma_f32_16x16x32_bf16 v[12:15], a[112:115], v[120:123], v[12:15]
    ds_read_b64_tr_b16 v[106:107], v168 offset:43008
    v_add_f32 v230, v230, v234
    v_mfma_f32_16x16x32_bf16 v[16:19], a[116:119], v[120:123], v[16:19]
    s_add_u32 s62, s62, 4096
    ds_read_b64_tr_b16 v[108:109], v169 offset:40960
    v_add_f32 v231, v231, v235
    v_mfma_f32_16x16x32_bf16 v[20:23], a[108:111], v[124:127], v[20:23]
    buffer_load_dwordx4 a[96:99], v248, s[36:39], s62 offen offset:0 sc1
    v_mfma_f32_16x16x32_bf16 v[24:27], a[112:115], v[124:127], v[24:27]
    ds_read_b64_tr_b16 v[110:111], v169 offset:43008
    v_mul_f32 v230, 0x3acccccd, v230
    v_mfma_f32_16x16x32_bf16 v[28:31], a[116:119], v[124:127], v[28:31]
    s_waitcnt lgkmcnt(6)
    ds_read_b64_tr_b16 v[112:113], v170 offset:40960
    v_mul_f32 v234, v230, v230
    v_mfma_f32_16x16x32_bf16 v[32:35], a[108:111], v[128:131], v[32:35]
    ds_read_b64_tr_b16 v[114:115], v170 offset:43008
    v_mov_b32 v224, 0x3acccccd
    v_fma_f32 v231, v231, v224, -v234
    v_mfma_f32_16x16x32_bf16 v[36:39], a[112:115], v[128:131], v[36:39]
    buffer_load_dwordx4 a[100:103], v248, s[36:39], s62 offen offset:1024 sc1
    v_mfma_f32_16x16x32_bf16 v[40:43], a[116:119], v[128:131], v[40:43]
    s_waitcnt lgkmcnt(6)
    ds_read_b64_tr_b16 v[116:117], v171 offset:40960
    v_max_f32 v231, 0, v231
    v_mfma_f32_16x16x32_bf16 v[44:47], a[108:111], v[132:135], v[44:47]
    s_waitcnt lgkmcnt(3)
    ds_read_b64_tr_b16 v[118:119], v171 offset:43008
    v_add_f32 v231, 0x3727c5ac, v231
    v_mfma_f32_16x16x32_bf16 v[48:51], a[112:115], v[132:135], v[48:51]
    v_rsq_f32 v224, v231
    v_mfma_f32_16x16x32_bf16 v[52:55], a[116:119], v[132:135], v[52:55]
    buffer_load_dwordx4 a[104:107], v248, s[36:39], s62 offen offset:2048 sc1
    v_mfma_f32_16x16x32_bf16 v[8:11], a[120:123], v[104:107], v[8:11]
    ds_read_b64_tr_b16 v[120:121], v168 offset:45056
    v_mul_f32_e64 v226, -v230, v224
    v_mfma_f32_16x16x32_bf16 v[12:15], a[124:127], v[104:107], v[12:15]
    ds_read_b64_tr_b16 v[122:123], v168 offset:47104
    s_mov_b64 exec, 0xf
    buffer_store_dwordx4 v[224:227], v248, s[36:39], s7 offen sc1
    s_mov_b64 exec, -1
    v_mfma_f32_16x16x32_bf16 v[16:19], a[128:131], v[104:107], v[16:19]
    s_and_b32 s50, s3, 1
    s_lshl_b32 s51, s74, 1
    ds_read_b64_tr_b16 v[124:125], v169 offset:45056
    v_mfma_f32_16x16x32_bf16 v[20:23], a[120:123], v[108:111], v[20:23]
    buffer_load_dwordx4 a[108:111], v248, s[36:39], s62 offen offset:3072 sc1
    v_mfma_f32_16x16x32_bf16 v[24:27], a[124:127], v[108:111], v[24:27]
    s_add_u32 s52, s51, s50
    s_mul_i32 s52, s52, 192
    ds_read_b64_tr_b16 v[126:127], v169 offset:47104
    v_mfma_f32_16x16x32_bf16 v[28:31], a[128:131], v[108:111], v[28:31]
    s_waitcnt lgkmcnt(6)
    s_mul_i32 s53, s3, 48
    s_add_u32 s52, s52, s53
    ds_read_b64_tr_b16 v[128:129], v170 offset:45056
    v_mfma_f32_16x16x32_bf16 v[32:35], a[120:123], v[112:115], v[32:35]
    s_add_u32 s62, s62, 4096
    ds_read_b64_tr_b16 v[130:131], v170 offset:47104
    v_mfma_f32_16x16x32_bf16 v[36:39], a[124:127], v[112:115], v[36:39]
    buffer_load_dwordx4 a[112:115], v248, s[36:39], s62 offen offset:0 sc1
    v_mfma_f32_16x16x32_bf16 v[40:43], a[128:131], v[112:115], v[40:43]
    s_waitcnt lgkmcnt(6)
    s_lshl_b32 s52, s52, 8
    s_add_u32 s52, s52, 16777216
    ds_read_b64_tr_b16 v[132:133], v171 offset:45056
    v_mfma_f32_16x16x32_bf16 v[44:47], a[120:123], v[116:119], v[44:47]
    s_waitcnt lgkmcnt(3)
    ds_read_b64_tr_b16 v[134:135], v171 offset:47104
    v_add_u32 v216, s52, v248
    v_mfma_f32_16x16x32_bf16 v[48:51], a[124:127], v[116:119], v[48:51]
    v_add_u32 v218, 3145728, v216
    v_mfma_f32_16x16x32_bf16 v[52:55], a[128:131], v[116:119], v[52:55]
    buffer_load_dwordx4 a[116:119], v248, s[36:39], s62 offen offset:1024 sc1
    v_mfma_f32_16x16x32_bf16 v[8:11], a[132:135], v[120:123], v[8:11]
    s_xor_b32 s50, s50, 1
    s_add_u32 s52, s51, s50
    ds_read_b64_tr_b16 v[104:105], v168 offset:49152
    v_mfma_f32_16x16x32_bf16 v[12:15], a[136:139], v[120:123], v[12:15]
    s_mul_i32 s52, s52, 192
    s_add_u32 s52, s52, s53
    ds_read_b64_tr_b16 v[106:107], v168 offset:51200
    v_mfma_f32_16x16x32_bf16 v[16:19], a[140:143], v[120:123], v[16:19]
    s_lshl_b32 s52, s52, 8
    s_add_u32 s52, s52, 16777216
    ds_read_b64_tr_b16 v[108:109], v169 offset:49152
    v_mfma_f32_16x16x32_bf16 v[20:23], a[132:135], v[124:127], v[20:23]
    buffer_load_dwordx4 a[120:123], v248, s[36:39], s62 offen offset:2048 sc1
    v_mfma_f32_16x16x32_bf16 v[24:27], a[136:139], v[124:127], v[24:27]
    ds_read_b64_tr_b16 v[110:111], v169 offset:51200
    v_add_u32 v217, s52, v248
    v_mfma_f32_16x16x32_bf16 v[28:31], a[140:143], v[124:127], v[28:31]
    s_waitcnt lgkmcnt(6)
    ds_read_b64_tr_b16 v[112:113], v170 offset:49152
    v_add_u32 v219, 3145728, v217
    v_mfma_f32_16x16x32_bf16 v[32:35], a[132:135], v[128:131], v[32:35]
    s_lshr_b32 s50, s74, 1
    s_lshl_b32 s50, s50, 2
    ds_read_b64_tr_b16 v[114:115], v170 offset:51200
    v_mfma_f32_16x16x32_bf16 v[36:39], a[136:139], v[128:131], v[36:39]
    buffer_load_dwordx4 a[124:127], v248, s[36:39], s62 offen offset:3072 sc1
    v_mfma_f32_16x16x32_bf16 v[40:43], a[140:143], v[128:131], v[40:43]
    s_waitcnt lgkmcnt(6)
    s_add_u32 s50, s50, s3
    s_lshl_b32 s50, s50, 9
    ds_read_b64_tr_b16 v[116:117], v171 offset:49152
    v_mfma_f32_16x16x32_bf16 v[44:47], a[132:135], v[132:135], v[44:47]
    s_waitcnt lgkmcnt(3)
    s_add_u32 s50, s50, 89088
    ds_read_b64_tr_b16 v[118:119], v171 offset:51200
    v_mfma_f32_16x16x32_bf16 v[48:51], a[136:139], v[132:135], v[48:51]
    s_add_u32 s62, s62, 4096
    v_mfma_f32_16x16x32_bf16 v[52:55], a[140:143], v[132:135], v[52:55]
    buffer_load_dwordx4 a[128:131], v248, s[36:39], s62 offen offset:0 sc1
    v_mfma_f32_16x16x32_bf16 v[8:11], a[144:147], v[104:107], v[8:11]
    ds_read_b64_tr_b16 v[120:121], v168 offset:53248
    v_min_u32 v246, 13, v1
    v_mfma_f32_16x16x32_bf16 v[12:15], a[148:151], v[104:107], v[12:15]
    ds_read_b64_tr_b16 v[122:123], v168 offset:55296
    v_lshlrev_b32 v246, 7, v246
    v_mfma_f32_16x16x32_bf16 v[16:19], a[152:155], v[104:107], v[16:19]
    ds_read_b64_tr_b16 v[124:125], v169 offset:53248
    v_mov_b32 v2, s50
    v_mfma_f32_16x16x32_bf16 v[20:23], a[144:147], v[108:111], v[20:23]
    buffer_load_dwordx4 a[132:135], v248, s[36:39], s62 offen offset:1024 sc1
    v_mfma_f32_16x16x32_bf16 v[24:27], a[148:151], v[108:111], v[24:27]
    ds_read_b64_tr_b16 v[126:127], v169 offset:55296
    v_mov_b32 v3, 31488
    v_mfma_f32_16x16x32_bf16 v[28:31], a[152:155], v[108:111], v[28:31]
    ds_read_b64_tr_b16 v[128:129], v170 offset:53248
    v_cmp_lt_u32 vcc, 3, v1
    s_nop 1
    v_cndmask_b32 v2, v2, v3, vcc
    s_waitcnt lgkmcnt(7)
    v_mfma_f32_16x16x32_bf16 v[32:35], a[144:147], v[112:115], v[32:35]
    ds_read_b64_tr_b16 v[130:131], v170 offset:55296
    v_add_u32 v246, v246, v2
    v_mfma_f32_16x16x32_bf16 v[36:39], a[148:151], v[112:115], v[36:39]
    buffer_load_dwordx4 a[136:139], v248, s[36:39], s62 offen offset:2048 sc1
    v_mfma_f32_16x16x32_bf16 v[40:43], a[152:155], v[112:115], v[40:43]
    s_waitcnt lgkmcnt(6)
    ds_read_b64_tr_b16 v[132:133], v171 offset:53248
    v_mfma_f32_16x16x32_bf16 v[44:47], a[144:147], v[116:119], v[44:47]
    s_waitcnt lgkmcnt(3)
    ds_read_b64_tr_b16 v[134:135], v171 offset:55296
    v_mfma_f32_16x16x32_bf16 v[48:51], a[148:151], v[116:119], v[48:51]
    buffer_load_dword v247, v246, s[36:39], s17 offen sc1
    v_mfma_f32_16x16x32_bf16 v[52:55], a[152:155], v[116:119], v[52:55]
    buffer_load_dwordx4 a[140:143], v248, s[36:39], s62 offen offset:3072 sc1
    v_mfma_f32_16x16x32_bf16 v[8:11], a[156:159], v[120:123], v[8:11]
    ds_read_b64_tr_b16 v[104:105], v168 offset:57344
    v_mfma_f32_16x16x32_bf16 v[12:15], a[160:163], v[120:123], v[12:15]
    ds_read_b64_tr_b16 v[106:107], v168 offset:59392
    v_mfma_f32_16x16x32_bf16 v[16:19], a[164:167], v[120:123], v[16:19]
    s_add_u32 s62, s62, 4096
    ds_read_b64_tr_b16 v[108:109], v169 offset:57344
    v_mfma_f32_16x16x32_bf16 v[20:23], a[156:159], v[124:127], v[20:23]
    buffer_load_dwordx4 a[144:147], v248, s[36:39], s62 offen offset:0 sc1
    v_mfma_f32_16x16x32_bf16 v[24:27], a[160:163], v[124:127], v[24:27]
    ds_read_b64_tr_b16 v[110:111], v169 offset:59392
    v_mfma_f32_16x16x32_bf16 v[28:31], a[164:167], v[124:127], v[28:31]
    s_waitcnt lgkmcnt(6)
    ds_read_b64_tr_b16 v[112:113], v170 offset:57344
    v_mfma_f32_16x16x32_bf16 v[32:35], a[156:159], v[128:131], v[32:35]
    ds_read_b64_tr_b16 v[114:115], v170 offset:59392
    v_mfma_f32_16x16x32_bf16 v[36:39], a[160:163], v[128:131], v[36:39]
    buffer_load_dwordx4 a[148:151], v248, s[36:39], s62 offen offset:1024 sc1
    v_mfma_f32_16x16x32_bf16 v[40:43], a[164:167], v[128:131], v[40:43]
    s_waitcnt lgkmcnt(6)
    ds_read_b64_tr_b16 v[116:117], v171 offset:57344
    v_mfma_f32_16x16x32_bf16 v[44:47], a[156:159], v[132:135], v[44:47]
    s_waitcnt lgkmcnt(3)
    ds_read_b64_tr_b16 v[118:119], v171 offset:59392
    v_mfma_f32_16x16x32_bf16 v[48:51], a[160:163], v[132:135], v[48:51]
    v_mfma_f32_16x16x32_bf16 v[52:55], a[164:167], v[132:135], v[52:55]
    buffer_load_dwordx4 a[152:155], v248, s[36:39], s62 offen offset:2048 sc1
    v_mfma_f32_16x16x32_bf16 v[8:11], a[168:171], v[104:107], v[8:11]
    ds_read_b64_tr_b16 v[120:121], v168 offset:61440
    v_mfma_f32_16x16x32_bf16 v[12:15], a[172:175], v[104:107], v[12:15]
    ds_read_b64_tr_b16 v[122:123], v168 offset:63488
    v_add_u32 v168, 65536, v168
    v_mfma_f32_16x16x32_bf16 v[16:19], a[176:179], v[104:107], v[16:19]
    ds_read_b64_tr_b16 v[124:125], v169 offset:61440
    v_mfma_f32_16x16x32_bf16 v[20:23], a[168:171], v[108:111], v[20:23]
    buffer_load_dwordx4 a[156:159], v248, s[36:39], s62 offen offset:3072 sc1
    v_mfma_f32_16x16x32_bf16 v[24:27], a[172:175], v[108:111], v[24:27]
    ds_read_b64_tr_b16 v[126:127], v169 offset:63488
    v_add_u32 v169, 65536, v169
    v_mfma_f32_16x16x32_bf16 v[28:31], a[176:179], v[108:111], v[28:31]
    s_waitcnt lgkmcnt(6)
    ds_read_b64_tr_b16 v[128:129], v170 offset:61440
    v_mfma_f32_16x16x32_bf16 v[32:35], a[168:171], v[112:115], v[32:35]
    s_add_u32 m0, s63, 1024
    ds_read_b64_tr_b16 v[130:131], v170 offset:63488
    v_add_u32 v170, 65536, v170
    v_mfma_f32_16x16x32_bf16 v[36:39], a[172:175], v[112:115], v[36:39]
    buffer_load_dwordx4 v248, s[36:39], s6 offen sc1 lds
    v_mfma_f32_16x16x32_bf16 v[40:43], a[176:179], v[112:115], v[40:43]
    s_waitcnt lgkmcnt(6)
    ds_read_b64_tr_b16 v[132:133], v171 offset:61440
    v_mfma_f32_16x16x32_bf16 v[44:47], a[168:171], v[116:119], v[44:47]
    s_waitcnt lgkmcnt(3)
    ds_read_b64_tr_b16 v[134:135], v171 offset:63488
    v_add_u32 v171, 65536, v171
    v_mfma_f32_16x16x32_bf16 v[48:51], a[172:175], v[116:119], v[48:51]
    s_add_u32 s62, s62, 4096
    v_mfma_f32_16x16x32_bf16 v[52:55], a[176:179], v[116:119], v[52:55]
    buffer_load_dwordx4 a[160:163], v248, s[36:39], s62 offen offset:0 sc1
    v_mfma_f32_16x16x32_bf16 v[8:11], a[180:183], v[120:123], v[8:11]
    ds_read_b64_tr_b16 v[104:105], v168 offset:0
    v_mfma_f32_16x16x32_bf16 v[12:15], a[184:187], v[120:123], v[12:15]
    ds_read_b64_tr_b16 v[106:107], v168 offset:2048
    v_mfma_f32_16x16x32_bf16 v[16:19], a[188:191], v[120:123], v[16:19]
    ds_read_b64_tr_b16 v[108:109], v169 offset:0
    v_mfma_f32_16x16x32_bf16 v[20:23], a[180:183], v[124:127], v[20:23]
    buffer_load_dwordx4 a[164:167], v248, s[36:39], s62 offen offset:1024 sc1
    v_mfma_f32_16x16x32_bf16 v[24:27], a[184:187], v[124:127], v[24:27]
    ds_read_b64_tr_b16 v[110:111], v169 offset:2048
    v_mfma_f32_16x16x32_bf16 v[28:31], a[188:191], v[124:127], v[28:31]
    s_waitcnt lgkmcnt(6)
    ds_read_b64_tr_b16 v[112:113], v170 offset:0
    v_mfma_f32_16x16x32_bf16 v[32:35], a[180:183], v[128:131], v[32:35]
    ds_read_b64_tr_b16 v[114:115], v170 offset:2048
    v_mfma_f32_16x16x32_bf16 v[36:39], a[184:187], v[128:131], v[36:39]
    buffer_load_dwordx4 a[168:171], v248, s[36:39], s62 offen offset:2048 sc1
    v_mfma_f32_16x16x32_bf16 v[40:43], a[188:191], v[128:131], v[40:43]
    s_waitcnt lgkmcnt(6)
    ds_read_b64_tr_b16 v[116:117], v171 offset:0
    v_mfma_f32_16x16x32_bf16 v[44:47], a[180:183], v[132:135], v[44:47]
    s_waitcnt lgkmcnt(3)
    ds_read_b64_tr_b16 v[118:119], v171 offset:2048
    v_mfma_f32_16x16x32_bf16 v[48:51], a[184:187], v[132:135], v[48:51]
    s_waitcnt vmcnt(9)
    v_cmp_ne_u32 vcc, s48, v247
    s_cbranch_vccnz L_chk12_slow
L_chk12_back:
    v_mfma_f32_16x16x32_bf16 v[52:55], a[188:191], v[132:135], v[52:55]
    buffer_load_dwordx4 v[56:59], v216, s[36:39], 0 offen offset:0 sc1
    v_mfma_f32_16x16x32_bf16 v[8:11], a[192:195], v[104:107], v[8:11]
    ds_read_b64_tr_b16 v[120:121], v168 offset:4096
    v_mfma_f32_16x16x32_bf16 v[12:15], a[196:199], v[104:107], v[12:15]
    ds_read_b64_tr_b16 v[122:123], v168 offset:6144
    v_mfma_f32_16x16x32_bf16 v[16:19], a[200:203], v[104:107], v[16:19]
    ds_read_b64_tr_b16 v[124:125], v169 offset:4096
    v_mfma_f32_16x16x32_bf16 v[20:23], a[192:195], v[108:111], v[20:23]
    buffer_load_dwordx4 v[60:63], v217, s[36:39], 0 offen offset:0 sc1
    v_mfma_f32_16x16x32_bf16 v[24:27], a[196:199], v[108:111], v[24:27]
    ds_read_b64_tr_b16 v[126:127], v169 offset:6144
    v_mfma_f32_16x16x32_bf16 v[28:31], a[200:203], v[108:111], v[28:31]
    s_waitcnt lgkmcnt(6)
    ds_read_b64_tr_b16 v[128:129], v170 offset:4096
    v_mfma_f32_16x16x32_bf16 v[32:35], a[192:195], v[112:115], v[32:35]
    ds_read_b64_tr_b16 v[130:131], v170 offset:6144
    v_mfma_f32_16x16x32_bf16 v[36:39], a[196:199], v[112:115], v[36:39]
    buffer_load_dwordx4 v[64:67], v216, s[36:39], 0 offen offset:1024 sc1
    v_mfma_f32_16x16x32_bf16 v[40:43], a[200:203], v[112:115], v[40:43]
    s_waitcnt lgkmcnt(6)
    ds_read_b64_tr_b16 v[132:133], v171 offset:4096
    v_mfma_f32_16x16x32_bf16 v[44:47], a[192:195], v[116:119], v[44:47]
    s_waitcnt lgkmcnt(3)
    ds_read_b64_tr_b16 v[134:135], v171 offset:6144
    v_mfma_f32_16x16x32_bf16 v[48:51], a[196:199], v[116:119], v[48:51]
    v_mfma_f32_16x16x32_bf16 v[52:55], a[200:203], v[116:119], v[52:55]
    buffer_load_dwordx4 v[68:71], v217, s[36:39], 0 offen offset:1024 sc1
    v_mfma_f32_16x16x32_bf16 v[8:11], a[204:207], v[120:123], v[8:11]
    ds_read_b64_tr_b16 v[104:105], v168 offset:8192
    v_mfma_f32_16x16x32_bf16 v[12:15], a[208:211], v[120:123], v[12:15]
    ds_read_b64_tr_b16 v[106:107], v168 offset:10240
    v_mfma_f32_16x16x32_bf16 v[16:19], a[212:215], v[120:123], v[16:19]
    ds_read_b64_tr_b16 v[108:109], v169 offset:8192
    v_mfma_f32_16x16x32_bf16 v[20:23], a[204:207], v[124:127], v[20:23]
    buffer_load_dwordx4 v[72:75], v216, s[36:39], 0 offen offset:2048 sc1
    v_mfma_f32_16x16x32_bf16 v[24:27], a[208:211], v[124:127], v[24:27]
    ds_read_b64_tr_b16 v[110:111], v169 offset:10240
    v_mfma_f32_16x16x32_bf16 v[28:31], a[212:215], v[124:127], v[28:31]
    s_waitcnt lgkmcnt(6)
    ds_read_b64_tr_b16 v[112:113], v170 offset:8192
    v_mfma_f32_16x16x32_bf16 v[32:35], a[204:207], v[128:131], v[32:35]
    ds_read_b64_tr_b16 v[114:115], v170 offset:10240
    v_mfma_f32_16x16x32_bf16 v[36:39], a[208:211], v[128:131], v[36:39]
    buffer_load_dwordx4 a[172:175], v248, s[36:39], s62 offen offset:3072 sc1
    v_mfma_f32_16x16x32_bf16 v[40:43], a[212:215], v[128:131], v[40:43]
    s_waitcnt lgkmcnt(6)
    ds_read_b64_tr_b16 v[116:117], v171 offset:8192
    v_mfma_f32_16x16x32_bf16 v[44:47], a[204:207], v[132:135], v[44:47]
    s_waitcnt lgkmcnt(3)
    ds_read_b64_tr_b16 v[118:119], v171 offset:10240
    v_mfma_f32_16x16x32_bf16 v[48:51], a[208:211], v[132:135], v[48:51]
    v_mfma_f32_16x16x32_bf16 v[52:55], a[212:215], v[132:135], v[52:55]
    buffer_load_dwordx4 v[76:79], v217, s[36:39], 0 offen offset:2048 sc1
    v_mfma_f32_16x16x32_bf16 v[8:11], a[216:219], v[104:107], v[8:11]
    ds_read_b64_tr_b16 v[120:121], v168 offset:12288
    v_mfma_f32_16x16x32_bf16 v[12:15], a[220:223], v[104:107], v[12:15]
    ds_read_b64_tr_b16 v[122:123], v168 offset:14336
    v_mfma_f32_16x16x32_bf16 v[16:19], a[224:227], v[104:107], v[16:19]
    s_add_u32 s62, s62, 4096
    ds_read_b64_tr_b16 v[124:125], v169 offset:12288
    v_mfma_f32_16x16x32_bf16 v[20:23], a[216:219], v[108:111], v[20:23]
    buffer_load_dwordx4 a[176:179], v248, s[36:39], s62 offen offset:0 sc1
    v_mfma_f32_16x16x32_bf16 v[24:27], a[220:223], v[108:111], v[24:27]
    ds_read_b64_tr_b16 v[126:127], v169 offset:14336
    v_mfma_f32_16x16x32_bf16 v[28:31], a[224:227], v[108:111], v[28:31]
    s_waitcnt lgkmcnt(6)
    ds_read_b64_tr_b16 v[128:129], v170 offset:12288
    v_mfma_f32_16x16x32_bf16 v[32:35], a[216:219], v[112:115], v[32:35]
    s_waitcnt vmcnt(11)
    ds_read_b64_tr_b16 v[130:131], v170 offset:14336
    ds_read_b128 v[200:203], v175 offset:1024
    v_mfma_f32_16x16x32_bf16 v[36:39], a[220:223], v[112:115], v[36:39]
    buffer_load_dwordx4 a[180:183], v248, s[36:39], s62 offen offset:1024 sc1
    v_mfma_f32_16x16x32_bf16 v[40:43], a[224:227], v[112:115], v[40:43]
    s_waitcnt lgkmcnt(7)
    ds_read_b64_tr_b16 v[132:133], v171 offset:12288
    ds_read_b128 v[204:207], v175 offset:1280
    v_mfma_f32_16x16x32_bf16 v[44:47], a[216:219], v[116:119], v[44:47]
    s_waitcnt lgkmcnt(3)
    ds_read_b64_tr_b16 v[134:135], v171 offset:14336
    v_mfma_f32_16x16x32_bf16 v[48:51], a[220:223], v[116:119], v[48:51]
    ds_read_b128 v[208:211], v175 offset:1536
    ds_read_b128 v[212:215], v175 offset:1792
    v_mfma_f32_16x16x32_bf16 v[52:55], a[224:227], v[116:119], v[52:55]
    buffer_load_dwordx4 a[184:187], v248, s[36:39], s62 offen offset:2048 sc1
    v_mfma_f32_16x16x32_bf16 v[8:11], a[228:231], v[120:123], v[8:11]
    v_mfma_f32_16x16x32_bf16 v[12:15], a[232:235], v[120:123], v[12:15]
    s_waitcnt lgkmcnt(5)
    v_xor_b32 v3, s48, v201
    v_bitop3_b32 v3, v203, s48, v3 bitop3:0xbe
    v_mfma_f32_16x16x32_bf16 v[16:19], a[236:239], v[120:123], v[16:19]
    s_waitcnt lgkmcnt(3)
    v_bitop3_b32 v3, v205, s48, v3 bitop3:0xbe
    v_bitop3_b32 v3, v207, s48, v3 bitop3:0xbe
    v_mfma_f32_16x16x32_bf16 v[20:23], a[228:231], v[124:127], v[20:23]
    buffer_load_dwordx4 a[188:191], v248, s[36:39], s62 offen offset:3072 sc1
    v_mfma_f32_16x16x32_bf16 v[24:27], a[232:235], v[124:127], v[24:27]
    s_waitcnt lgkmcnt(1)
    v_bitop3_b32 v3, v209, s48, v3 bitop3:0xbe
    v_bitop3_b32 v3, v211, s48, v3 bitop3:0xbe
    v_mfma_f32_16x16x32_bf16 v[28:31], a[236:239], v[124:127], v[28:31]
    s_waitcnt lgkmcnt(0)
    v_bitop3_b32 v3, v213, s48, v3 bitop3:0xbe
    v_bitop3_b32 v3, v215, s48, v3 bitop3:0xbe
    v_mfma_f32_16x16x32_bf16 v[32:35], a[228:231], v[128:131], v[32:35]
    v_cmp_ne_u32 vcc, 0, v3
    s_cbranch_vccnz L_stc1_slow
L_stc1_back:
    v_mfma_f32_16x16x32_bf16 v[36:39], a[232:235], v[128:131], v[36:39]
    buffer_load_dwordx4 v[80:83], v216, s[36:39], 0 offen offset:3072 sc1
    v_mfma_f32_16x16x32_bf16 v[40:43], a[236:239], v[128:131], v[40:43]
    v_mfma_f32_16x16x32_bf16 v[44:47], a[228:231], v[132:135], v[44:47]
    v_mfma_f32_16x16x32_bf16 v[48:51], a[232:235], v[132:135], v[48:51]
    v_mfma_f32_16x16x32_bf16 v[52:55], a[236:239], v[132:135], v[52:55]
    s_add_u32 s8, s8, 3145728
    s_add_u32 s50, s8, 98304
    v_pk_fma_f32 v[238:239], v[176:177], v[202:203], v[188:189] op_sel_hi:[1,0,1]
    v_pk_fma_f32 v[240:241], v[178:179], v[202:203], v[190:191] op_sel_hi:[1,0,1]
    v_pk_fma_f32 v[8:9], v[8:9], v[200:201], v[238:239] op_sel_hi:[1,0,1]
    v_pk_fma_f32 v[10:11], v[10:11], v[200:201], v[240:241] op_sel_hi:[1,0,1]
    v_pk_fma_f32 v[242:243], v[180:181], v[202:203], v[192:193] op_sel_hi:[1,0,1]
    v_pk_fma_f32 v[244:245], v[182:183], v[202:203], v[194:195] op_sel_hi:[1,0,1]
    v_pk_fma_f32 v[12:13], v[12:13], v[200:201], v[242:243] op_sel_hi:[1,0,1]
    v_pk_fma_f32 v[14:15], v[14:15], v[200:201], v[244:245] op_sel_hi:[1,0,1]
    v_pk_mul_f32 v[8:9], v[8:9], v[12:13]
    v_pk_mul_f32 v[10:11], v[10:11], v[14:15]
    v_cvt_pk_bf16_f32 v12, v8, v9
    v_cvt_pk_bf16_f32 v13, v10, v11
    v_pk_fma_f32 v[242:243], v[176:177], v[206:207], v[188:189] op_sel_hi:[1,0,1]
    v_pk_fma_f32 v[244:245], v[178:179], v[206:207], v[190:191] op_sel_hi:[1,0,1]
    v_pk_fma_f32 v[20:21], v[20:21], v[204:205], v[242:243] op_sel_hi:[1,0,1]
    v_pk_fma_f32 v[22:23], v[22:23], v[204:205], v[244:245] op_sel_hi:[1,0,1]
    v_pk_fma_f32 v[238:239], v[180:181], v[206:207], v[192:193] op_sel_hi:[1,0,1]
    v_pk_fma_f32 v[240:241], v[182:183], v[206:207], v[194:195] op_sel_hi:[1,0,1]
    v_pk_fma_f32 v[24:25], v[24:25], v[204:205], v[238:239] op_sel_hi:[1,0,1]
    v_pk_fma_f32 v[26:27], v[26:27], v[204:205], v[240:241] op_sel_hi:[1,0,1]
    v_pk_mul_f32 v[20:21], v[20:21], v[24:25]
    v_pk_mul_f32 v[22:23], v[22:23], v[26:27]
    v_cvt_pk_bf16_f32 v14, v20, v21
    v_cvt_pk_bf16_f32 v15, v22, v23
    s_nop 0
    v_permlane16_swap_b32 v12, v14
    v_permlane16_swap_b32 v13, v15
    buffer_store_dwordx4 v[12:15], v173, s[36:39], s8 offen sc1
    v_pk_fma_f32 v[238:239], v[176:177], v[210:211], v[188:189] op_sel_hi:[1,0,1]
    v_pk_fma_f32 v[240:241], v[178:179], v[210:211], v[190:191] op_sel_hi:[1,0,1]
    v_pk_fma_f32 v[32:33], v[32:33], v[208:209], v[238:239] op_sel_hi:[1,0,1]
    v_pk_fma_f32 v[34:35], v[34:35], v[208:209], v[240:241] op_sel_hi:[1,0,1]
    v_pk_fma_f32 v[242:243], v[180:181], v[210:211], v[192:193] op_sel_hi:[1,0,1]
    v_pk_fma_f32 v[244:245], v[182:183], v[210:211], v[194:195] op_sel_hi:[1,0,1]
    v_pk_fma_f32 v[36:37], v[36:37], v[208:209], v[242:243] op_sel_hi:[1,0,1]
    v_pk_fma_f32 v[38:39], v[38:39], v[208:209], v[244:245] op_sel_hi:[1,0,1]
    v_pk_mul_f32 v[32:33], v[32:33], v[36:37]
    v_pk_mul_f32 v[34:35], v[34:35], v[38:39]
    v_cvt_pk_bf16_f32 v36, v32, v33
    v_cvt_pk_bf16_f32 v37, v34, v35
    v_pk_fma_f32 v[242:243], v[176:177], v[214:215], v[188:189] op_sel_hi:[1,0,1]
    v_pk_fma_f32 v[244:245], v[178:179], v[214:215], v[190:191] op_sel_hi:[1,0,1]
    v_pk_fma_f32 v[44:45], v[44:45], v[212:213], v[242:243] op_sel_hi:[1,0,1]
    v_pk_fma_f32 v[46:47], v[46:47], v[212:213], v[244:245] op_sel_hi:[1,0,1]
    v_pk_fma_f32 v[238:239], v[180:181], v[214:215], v[192:193] op_sel_hi:[1,0,1]
    v_pk_fma_f32 v[240:241], v[182:183], v[214:215], v[194:195] op_sel_hi:[1,0,1]
    v_pk_fma_f32 v[48:49], v[48:49], v[212:213], v[238:239] op_sel_hi:[1,0,1]
    v_pk_fma_f32 v[50:51], v[50:51], v[212:213], v[240:241] op_sel_hi:[1,0,1]
    v_pk_mul_f32 v[44:45], v[44:45], v[48:49]
    v_pk_mul_f32 v[46:47], v[46:47], v[50:51]
    v_cvt_pk_bf16_f32 v38, v44, v45
    v_cvt_pk_bf16_f32 v39, v46, v47
    s_nop 0
    v_permlane16_swap_b32 v36, v38
    v_permlane16_swap_b32 v37, v39
    buffer_store_dwordx4 v[36:39], v173, s[36:39], s50 offen sc1
    v_pk_fma_f32 v[238:239], v[184:185], v[202:203], v[196:197] op_sel_hi:[1,0,1]
    v_pk_fma_f32 v[240:241], v[186:187], v[202:203], v[198:199] op_sel_hi:[1,0,1]
    v_pk_fma_f32 v[16:17], v[16:17], v[200:201], v[238:239] op_sel_hi:[1,0,1]
    v_pk_fma_f32 v[18:19], v[18:19], v[200:201], v[240:241] op_sel_hi:[1,0,1]
    v_pk_fma_f32 v[242:243], v[184:185], v[206:207], v[196:197] op_sel_hi:[1,0,1]
    v_pk_fma_f32 v[244:245], v[186:187], v[206:207], v[198:199] op_sel_hi:[1,0,1]
    v_pk_fma_f32 v[28:29], v[28:29], v[204:205], v[242:243] op_sel_hi:[1,0,1]
    v_pk_fma_f32 v[30:31], v[30:31], v[204:205], v[244:245] op_sel_hi:[1,0,1]
    s_nop 0
    v_permlane32_swap_b32 v16, v28
    v_permlane32_swap_b32 v17, v29
    v_permlane32_swap_b32 v18, v30
    v_permlane32_swap_b32 v19, v31
    v_pk_mul_f32 v[16:17], v[16:17], v[28:29]
    v_pk_mul_f32 v[18:19], v[18:19], v[30:31]
    v_cvt_pk_bf16_f32 v8, v16, v17
    v_cvt_pk_bf16_f32 v9, v18, v19
    v_pk_fma_f32 v[238:239], v[184:185], v[210:211], v[196:197] op_sel_hi:[1,0,1]
    v_pk_fma_f32 v[240:241], v[186:187], v[210:211], v[198:199] op_sel_hi:[1,0,1]
    v_pk_fma_f32 v[40:41], v[40:41], v[208:209], v[238:239] op_sel_hi:[1,0,1]
    v_pk_fma_f32 v[42:43], v[42:43], v[208:209], v[240:241] op_sel_hi:[1,0,1]
    v_pk_fma_f32 v[242:243], v[184:185], v[214:215], v[196:197] op_sel_hi:[1,0,1]
    v_pk_fma_f32 v[244:245], v[186:187], v[214:215], v[198:199] op_sel_hi:[1,0,1]
    v_pk_fma_f32 v[52:53], v[52:53], v[212:213], v[242:243] op_sel_hi:[1,0,1]
    v_pk_fma_f32 v[54:55], v[54:55], v[212:213], v[244:245] op_sel_hi:[1,0,1]
    s_nop 0
    v_permlane32_swap_b32 v40, v52
    v_permlane32_swap_b32 v41, v53
    v_permlane32_swap_b32 v42, v54
    v_permlane32_swap_b32 v43, v55
    v_pk_mul_f32 v[40:41], v[40:41], v[52:53]
    v_pk_mul_f32 v[42:43], v[42:43], v[54:55]
    v_cvt_pk_bf16_f32 v10, v40, v41
    v_cvt_pk_bf16_f32 v11, v42, v43
    s_nop 0
    v_permlane16_swap_b32 v8, v10
    v_permlane16_swap_b32 v9, v11
    buffer_store_dwordx4 v[8:11], v174, s[36:39], s8 offen offset:512 sc1
    buffer_load_dwordx4 v[84:87], v217, s[36:39], 0 offen offset:3072 sc1
    buffer_load_dwordx4 v[88:91], v216, s[36:39], s4 offen offset:0 sc1
    buffer_load_dwordx4 v[92:95], v217, s[36:39], s4 offen offset:0 sc1
    buffer_load_dwordx4 v[96:99], v216, s[36:39], s4 offen offset:1024 sc1
    buffer_load_dwordx4 v[100:103], v217, s[36:39], s4 offen offset:1024 sc1
    s_mov_b32 s40, s28
    s_mov_b32 s41, s29
    s_mov_b32 s42, 0x280000
    s_mov_b32 s43, 0x20000
    s_waitcnt vmcnt(19)
    v_mfma_f32_16x16x32_bf16 v[8:11], a[240:243], v[56:59], 0
    s_and_b32 s50, s3, 1
    s_lshr_b32 s51, s3, 1
    v_mfma_f32_16x16x32_bf16 v[12:15], a[244:247], v[56:59], 0
    s_mul_i32 s52, s50, 20480
    s_mul_i32 s53, s3, 5120
    s_add_u32 s52, s52, s53
    v_mfma_f32_16x16x32_bf16 v[16:19], a[248:251], v[56:59], 0
    v_add_u32 v220, s52, v248
    v_add_u32 v222, 40960, v220
    v_mfma_f32_16x16x32_bf16 v[20:23], a[252:255], v[56:59], 0
    s_xor_b32 s52, s50, 1
    s_mul_i32 s52, s52, 20480
    s_add_u32 s52, s52, s53
    v_mfma_f32_16x16x32_bf16 v[24:27], v[136:139], v[56:59], 0
    s_waitcnt vmcnt(18)
    v_add_u32 v221, s52, v248
    v_add_u32 v223, 40960, v221
    v_mfma_f32_16x16x32_bf16 v[28:31], a[240:243], v[60:63], 0
    s_mul_i32 s52, s51, 20480
    s_lshl_b32 s53, s50, 11
    buffer_load_dwordx4 v[56:59], v216, s[36:39], s4 offen offset:2048 sc1
    v_mfma_f32_16x16x32_bf16 v[32:35], a[244:247], v[60:63], 0
    s_add_u32 s52, s52, s53
    v_add_u32 v224, s52, v248
    v_mfma_f32_16x16x32_bf16 v[36:39], a[248:251], v[60:63], 0
    s_mul_i32 s53, s51, 5120
    s_add_u32 s53, s53, 40960
    v_add_u32 v225, s53, v224
    v_mfma_f32_16x16x32_bf16 v[40:43], a[252:255], v[60:63], 0
    s_xor_b32 s53, s51, 1
    s_mul_i32 s53, s53, 5120
    s_add_u32 s53, s53, 40960
    v_mfma_f32_16x16x32_bf16 v[44:47], v[136:139], v[60:63], 0
    s_waitcnt vmcnt(18)
    v_add_u32 v226, s53, v224
    v_mfma_f32_16x16x32_bf16 v[8:11], v[140:143], v[64:67], v[8:11]
    s_lshl_b32 s52, s74, 1
    s_add_u32 s52, s52, s51
    s_mul_i32 s12, s75, 320
    buffer_load_dwordx4 v[60:63], v217, s[36:39], s4 offen offset:2048 sc1
    v_mfma_f32_16x16x32_bf16 v[12:15], v[144:147], v[64:67], v[12:15]
    s_add_u32 s12, s12, 23147008
    s_mul_i32 s13, s52, 20480
    s_mul_i32 s53, s75, 160
    s_add_u32 s13, s13, s53
    v_mfma_f32_16x16x32_bf16 v[16:19], v[148:151], v[64:67], v[16:19]
    s_lshl_b32 s53, s50, 6
    s_add_u32 s13, s13, s53
    s_add_u32 s14, s13, 1310720
    v_mfma_f32_16x16x32_bf16 v[20:23], v[152:155], v[64:67], v[20:23]
    s_mul_i32 s10, s75, 10
    s_add_u32 s10, s10, s3
    v_mfma_f32_16x16x32_bf16 v[24:27], v[156:159], v[64:67], v[24:27]
    s_mul_i32 s10, s10, 32768
    s_lshl_b32 s53, s74, 6
    s_add_u32 s10, s10, s53
    s_add_u32 s10, s10, 0
    s_waitcnt vmcnt(18)
    v_mfma_f32_16x16x32_bf16 v[28:31], v[140:143], v[68:71], v[28:31]
    s_lshl_b32 s11, s3, 10
    s_add_u32 s11, s11, 81920
    v_lshrrev_b32 v2, 3, v1
    buffer_load_dwordx4 v[64:67], v216, s[36:39], s4 offen offset:3072 sc1
    v_mfma_f32_16x16x32_bf16 v[32:35], v[144:147], v[68:71], v[32:35]
    v_mul_u32_u24 v229, 4096, v2
    v_bfe_u32 v2, v1, 2, 1
    v_mfma_f32_16x16x32_bf16 v[36:39], v[148:151], v[68:71], v[36:39]
    v_lshl_add_u32 v229, v2, 11, v229
    v_and_b32 v2, 3, v1
    v_mfma_f32_16x16x32_bf16 v[40:43], v[152:155], v[68:71], v[40:43]
    v_lshl_add_u32 v229, v2, 4, v229
    v_lshrrev_b32 v3, 2, v1
    v_mfma_f32_16x16x32_bf16 v[44:47], v[156:159], v[68:71], v[44:47]
    s_waitcnt vmcnt(18)
    v_lshlrev_b32 v231, 7, v3
    v_lshl_add_u32 v231, v2, 3, v231
    v_mfma_f32_16x16x32_bf16 v[8:11], v[160:163], v[72:75], v[8:11]
    s_barrier
    s_lshl_b32 s53, s50, 12
    s_lshl_b32 s52, s51, 5
    buffer_load_dwordx4 v[68:71], v217, s[36:39], s4 offen offset:3072 sc1
    v_mfma_f32_16x16x32_bf16 v[12:15], v[164:167], v[72:75], v[12:15]
    s_add_u32 s53, s53, s52
    s_add_u32 s53, s53, 81920
    v_add_u32 v231, s53, v231
    v_mfma_f32_16x16x32_bf16 v[16:19], a[0:3], v[72:75], v[16:19]
    v_and_b32 v2, 15, v1
    v_lshrrev_b32 v3, 4, v1
    v_mfma_f32_16x16x32_bf16 v[20:23], a[4:7], v[72:75], v[20:23]
    v_mul_u32_u24 v2, 1280, v2
    v_lshl_add_u32 v228, v3, 3, v2
    v_mfma_f32_16x16x32_bf16 v[24:27], a[8:11], v[72:75], v[24:27]
    s_waitcnt vmcnt(17)
    v_and_b32 v227, 1, v3
    v_lshl_add_u32 v2, v227, 5, v2
    v_lshrrev_b32 v3, 1, v3
    v_mfma_f32_16x16x32_bf16 v[28:31], v[160:163], v[76:79], v[28:31]
    buffer_load_dwordx4 v[72:75], v216, s[36:39], s5 offen offset:0 sc1
    v_mfma_f32_16x16x32_bf16 v[32:35], v[164:167], v[76:79], v[32:35]
    v_lshl_add_u32 v227, v3, 4, v2
    v_mfma_f32_16x16x32_bf16 v[36:39], a[0:3], v[76:79], v[36:39]
    s_lshr_b32 s50, s74, 1
    s_lshl_b32 s50, s50, 2
    s_add_u32 s50, s50, s3
    s_lshl_b32 s50, s50, 9
    v_mfma_f32_16x16x32_bf16 v[40:43], a[4:7], v[76:79], v[40:43]
    s_add_u32 s50, s50, 121856
    v_min_u32 v246, 3, v1
    v_lshlrev_b32 v246, 7, v246
    v_mfma_f32_16x16x32_bf16 v[44:47], a[8:11], v[76:79], v[44:47]
    s_waitcnt vmcnt(13)
    v_add_u32 v246, s50, v246
    v_min_u32 v2, 23, v1
    v_mfma_f32_16x16x32_bf16 v[8:11], a[12:15], v[80:83], v[8:11]
    buffer_load_dwordx4 v[76:79], v217, s[36:39], s5 offen offset:0 sc1
    v_mfma_f32_16x16x32_bf16 v[12:15], a[16:19], v[80:83], v[12:15]
    v_lshlrev_b32 v244, 4, v2
    v_mov_b32 v3, 36160
    v_mfma_f32_16x16x32_bf16 v[16:19], a[20:23], v[80:83], v[16:19]
    v_cmp_lt_u32 vcc, 11, v2
    s_nop 1
    v_cndmask_b32 v3, 0, v3, vcc
    v_mfma_f32_16x16x32_bf16 v[20:23], a[24:27], v[80:83], v[20:23]
    s_and_b32 s53, s3, 1
    s_lshl_b32 s53, s53, 7
    v_add3_u32 v244, v244, v3, s53
    v_mfma_f32_16x16x32_bf16 v[24:27], a[28:31], v[80:83], v[24:27]
    s_lshl_b32 s15, s3, 10
    s_add_u32 s15, s15, 94208
    v_and_b32 v230, 48, v1
    v_add_u32 v230, s15, v230
    s_waitcnt vmcnt(10)
    v_mfma_f32_16x16x32_bf16 v[28:31], a[12:15], v[84:87], v[28:31]
    s_mov_b32 m0, s15
    buffer_load_dwordx4 v[80:83], v216, s[36:39], s5 offen offset:1024 sc1
    v_mfma_f32_16x16x32_bf16 v[32:35], a[16:19], v[84:87], v[32:35]
    buffer_load_dwordx4 v244, s[36:39], s12 offen sc1 lds
    v_mfma_f32_16x16x32_bf16 v[36:39], a[20:23], v[84:87], v[36:39]
    s_add_u32 m0, s11, 0
    v_mfma_f32_16x16x32_bf16 v[40:43], a[24:27], v[84:87], v[40:43]
    buffer_load_dwordx4 v229, s[36:39], s10 offen sc1 lds
    v_mfma_f32_16x16x32_bf16 v[44:47], a[28:31], v[84:87], v[44:47]
    s_waitcnt vmcnt(12)
    s_add_u32 s10, s10, 131072
    v_mfma_f32_16x16x32_bf16 v[8:11], a[32:35], v[88:91], v[8:11]
    s_barrier
    s_cmp_eq_u32 s3, 0
    s_cbranch_scc0 L_wf13
    s_lshl_b32 s54, s76, 7
    s_add_u32 s54, s54, 23321600
    v_mov_b32 v254, 0
    v_mov_b32 v255, s48
    s_mov_b64 exec, 1
    buffer_store_dword v255, v254, s[36:39], s54 offen sc1
    s_mov_b64 exec, -1
L_wf13:
    s_add_u32 m0, s11, 4096
    v_mfma_f32_16x16x32_bf16 v[12:15], a[36:39], v[88:91], v[12:15]
    buffer_load_dwordx4 v229, s[36:39], s10 offen sc1 lds
    v_mfma_f32_16x16x32_bf16 v[16:19], a[40:43], v[88:91], v[16:19]
    s_add_u32 s10, s10, 131072
    v_mfma_f32_16x16x32_bf16 v[20:23], a[44:47], v[88:91], v[20:23]
    s_add_u32 m0, s11, 8192
    v_mfma_f32_16x16x32_bf16 v[24:27], a[48:51], v[88:91], v[24:27]
    s_waitcnt vmcnt(12)
    buffer_load_dwordx4 v229, s[36:39], s10 offen sc1 lds
    v_mfma_f32_16x16x32_bf16 v[28:31], a[32:35], v[92:95], v[28:31]
    v_mfma_f32_16x16x32_bf16 v[32:35], a[36:39], v[92:95], v[32:35]
    v_mfma_f32_16x16x32_bf16 v[36:39], a[40:43], v[92:95], v[36:39]
    buffer_load_dwordx4 v[84:87], v217, s[36:39], s5 offen offset:1024 sc1
    v_mfma_f32_16x16x32_bf16 v[40:43], a[44:47], v[92:95], v[40:43]
    v_mfma_f32_16x16x32_bf16 v[44:47], a[48:51], v[92:95], v[44:47]
    s_waitcnt vmcnt(13)
    v_mfma_f32_16x16x32_bf16 v[8:11], a[52:55], v[96:99], v[8:11]
    buffer_load_dwordx4 v[88:91], v216, s[36:39], s5 offen offset:2048 sc1
    v_mfma_f32_16x16x32_bf16 v[12:15], a[56:59], v[96:99], v[12:15]
    v_mfma_f32_16x16x32_bf16 v[16:19], a[60:63], v[96:99], v[16:19]
    v_mfma_f32_16x16x32_bf16 v[20:23], a[64:67], v[96:99], v[20:23]
    buffer_load_dwordx4 v[92:95], v217, s[36:39], s5 offen offset:2048 sc1
    v_mfma_f32_16x16x32_bf16 v[24:27], a[68:71], v[96:99], v[24:27]
    s_waitcnt vmcnt(14)
    v_mfma_f32_16x16x32_bf16 v[28:31], a[52:55], v[100:103], v[28:31]
    v_mfma_f32_16x16x32_bf16 v[32:35], a[56:59], v[100:103], v[32:35]
    buffer_load_dwordx4 v[96:99], v216, s[36:39], s5 offen offset:3072 sc1
    v_mfma_f32_16x16x32_bf16 v[36:39], a[60:63], v[100:103], v[36:39]
    v_mfma_f32_16x16x32_bf16 v[40:43], a[64:67], v[100:103], v[40:43]
    v_mfma_f32_16x16x32_bf16 v[44:47], a[68:71], v[100:103], v[44:47]
    s_waitcnt vmcnt(14)
    v_mfma_f32_16x16x32_bf16 v[8:11], a[72:75], v[56:59], v[8:11]
    buffer_load_dwordx4 v[100:103], v217, s[36:39], s5 offen offset:3072 sc1
    v_mfma_f32_16x16x32_bf16 v[12:15], a[76:79], v[56:59], v[12:15]
    v_mfma_f32_16x16x32_bf16 v[16:19], a[80:83], v[56:59], v[16:19]
    v_mfma_f32_16x16x32_bf16 v[20:23], a[84:87], v[56:59], v[20:23]
    v_mfma_f32_16x16x32_bf16 v[24:27], a[88:91], v[56:59], v[24:27]
    s_waitcnt vmcnt(14)
    v_mfma_f32_16x16x32_bf16 v[28:31], a[72:75], v[60:63], v[28:31]
    v_mfma_f32_16x16x32_bf16 v[32:35], a[76:79], v[60:63], v[32:35]
    v_mfma_f32_16x16x32_bf16 v[36:39], a[80:83], v[60:63], v[36:39]
    v_mfma_f32_16x16x32_bf16 v[40:43], a[84:87], v[60:63], v[40:43]
    v_mfma_f32_16x16x32_bf16 v[44:47], a[88:91], v[60:63], v[44:47]
    s_waitcnt vmcnt(13)
    v_mfma_f32_16x16x32_bf16 v[8:11], a[92:95], v[64:67], v[8:11]
    v_mfma_f32_16x16x32_bf16 v[12:15], a[96:99], v[64:67], v[12:15]
    v_mfma_f32_16x16x32_bf16 v[16:19], a[100:103], v[64:67], v[16:19]
    v_mfma_f32_16x16x32_bf16 v[20:23], a[104:107], v[64:67], v[20:23]
    v_mfma_f32_16x16x32_bf16 v[24:27], a[108:111], v[64:67], v[24:27]
    s_waitcnt vmcnt(12)
    v_mfma_f32_16x16x32_bf16 v[28:31], a[92:95], v[68:71], v[28:31]
    v_mfma_f32_16x16x32_bf16 v[32:35], a[96:99], v[68:71], v[32:35]
    v_mfma_f32_16x16x32_bf16 v[36:39], a[100:103], v[68:71], v[36:39]
    v_mfma_f32_16x16x32_bf16 v[40:43], a[104:107], v[68:71], v[40:43]
    v_mfma_f32_16x16x32_bf16 v[44:47], a[108:111], v[68:71], v[44:47]
    s_waitcnt vmcnt(11)
    v_mfma_f32_16x16x32_bf16 v[8:11], a[112:115], v[72:75], v[8:11]
    buffer_load_dword v247, v246, s[36:39], s17 offen sc1
    v_mfma_f32_16x16x32_bf16 v[12:15], a[116:119], v[72:75], v[12:15]
    v_mfma_f32_16x16x32_bf16 v[16:19], a[120:123], v[72:75], v[16:19]
    v_mfma_f32_16x16x32_bf16 v[20:23], a[124:127], v[72:75], v[20:23]
    v_mfma_f32_16x16x32_bf16 v[24:27], a[128:131], v[72:75], v[24:27]
    s_waitcnt vmcnt(6)
    s_barrier
    ds_read_b64_tr_b16 v[180:181], v231 offset:0
    v_mfma_f32_16x16x32_bf16 v[28:31], a[112:115], v[76:79], v[28:31]
    ds_read_b64_tr_b16 v[182:183], v231 offset:2048
    v_mfma_f32_16x16x32_bf16 v[32:35], a[116:119], v[76:79], v[32:35]
    ds_read_b64_tr_b16 v[184:185], v231 offset:4096
    v_mfma_f32_16x16x32_bf16 v[36:39], a[120:123], v[76:79], v[36:39]
    ds_read_b64_tr_b16 v[186:187], v231 offset:64
    v_mfma_f32_16x16x32_bf16 v[40:43], a[124:127], v[76:79], v[40:43]
    ds_read_b64_tr_b16 v[188:189], v231 offset:2112
    v_mfma_f32_16x16x32_bf16 v[44:47], a[128:131], v[76:79], v[44:47]
    ds_read_b64_tr_b16 v[190:191], v231 offset:4160
    v_mfma_f32_16x16x32_bf16 v[8:11], a[132:135], v[80:83], v[8:11]
    ds_read_b128 v[48:51], v230 offset:0
    v_mfma_f32_16x16x32_bf16 v[12:15], a[136:139], v[80:83], v[12:15]
    ds_read_b128 v[52:55], v230 offset:64
    v_mfma_f32_16x16x32_bf16 v[16:19], a[140:143], v[80:83], v[16:19]
    ds_read_b128 v[124:127], v230 offset:128
    v_mfma_f32_16x16x32_bf16 v[20:23], a[144:147], v[80:83], v[20:23]
    ds_read_b128 v[168:171], v230 offset:192
    v_mfma_f32_16x16x32_bf16 v[24:27], a[148:151], v[80:83], v[24:27]
    s_waitcnt vmcnt(5)
    ds_read_b128 v[172:175], v230 offset:256
    v_mfma_f32_16x16x32_bf16 v[28:31], a[132:135], v[84:87], v[28:31]
    ds_read_b128 v[176:179], v230 offset:320
    v_mfma_f32_16x16x32_bf16 v[32:35], a[136:139], v[84:87], v[32:35]
    v_mfma_f32_16x16x32_bf16 v[36:39], a[140:143], v[84:87], v[36:39]
    s_waitcnt lgkmcnt(11)
    v_lshlrev_b32 v204, 16, v180
    s_waitcnt lgkmcnt(2)
    v_mul_f32 v204, v204, v168
    v_mfma_f32_16x16x32_bf16 v[40:43], a[144:147], v[84:87], v[40:43]
    v_and_b32 v205, 0xffff0000, v180
    v_mul_f32 v205, v205, v169
    v_mfma_f32_16x16x32_bf16 v[44:47], a[148:151], v[84:87], v[44:47]
    s_waitcnt vmcnt(4)
    v_lshlrev_b32 v206, 16, v181
    v_mul_f32 v206, v206, v170
    v_mfma_f32_16x16x32_bf16 v[8:11], a[152:155], v[88:91], v[8:11]
    v_and_b32 v207, 0xffff0000, v181
    v_mul_f32 v207, v207, v171
    v_mfma_f32_16x16x32_bf16 v[12:15], a[156:159], v[88:91], v[12:15]
    v_lshlrev_b32 v208, 16, v182
    s_waitcnt lgkmcnt(1)
    v_mul_f32 v208, v208, v172
    v_mfma_f32_16x16x32_bf16 v[16:19], a[160:163], v[88:91], v[16:19]
    v_and_b32 v209, 0xffff0000, v182
    v_mul_f32 v209, v209, v173
    v_mfma_f32_16x16x32_bf16 v[20:23], a[164:167], v[88:91], v[20:23]
    v_lshlrev_b32 v210, 16, v183
    v_mul_f32 v210, v210, v174
    v_mfma_f32_16x16x32_bf16 v[24:27], a[168:171], v[88:91], v[24:27]
    s_waitcnt vmcnt(3)
    v_and_b32 v211, 0xffff0000, v183
    v_mul_f32 v211, v211, v175
    v_mfma_f32_16x16x32_bf16 v[28:31], a[152:155], v[92:95], v[28:31]
    v_lshlrev_b32 v212, 16, v184
    s_waitcnt lgkmcnt(0)
    v_mul_f32 v212, v212, v176
    v_mfma_f32_16x16x32_bf16 v[32:35], a[156:159], v[92:95], v[32:35]
    v_and_b32 v213, 0xffff0000, v184
    v_mul_f32 v213, v213, v177
    v_mfma_f32_16x16x32_bf16 v[36:39], a[160:163], v[92:95], v[36:39]
    v_lshlrev_b32 v214, 16, v185
    v_mul_f32 v214, v214, v178
    v_mfma_f32_16x16x32_bf16 v[40:43], a[164:167], v[92:95], v[40:43]
    v_and_b32 v215, 0xffff0000, v185
    v_mul_f32 v215, v215, v179
    v_mfma_f32_16x16x32_bf16 v[44:47], a[168:171], v[92:95], v[44:47]
    s_waitcnt vmcnt(2)
    v_lshlrev_b32 v232, 16, v186
    v_mul_f32 v232, v232, v168
    v_mfma_f32_16x16x32_bf16 v[8:11], a[172:175], v[96:99], v[8:11]
    s_waitcnt vmcnt(0)
    v_cmp_ne_u32 vcc, s48, v247
    s_cbranch_vccnz L_chk14_slow
L_chk14_back:
    v_and_b32 v233, 0xffff0000, v186
    v_mfma_f32_16x16x32_bf16 v[12:15], a[176:179], v[96:99], v[12:15]
    buffer_load_dwordx4 v[56:59], v218, s[36:39], 0 offen offset:0 sc1
    v_mfma_f32_16x16x32_bf16 v[16:19], a[180:183], v[96:99], v[16:19]
    v_mul_f32 v233, v233, v169
    v_lshlrev_b32 v234, 16, v187
    v_mfma_f32_16x16x32_bf16 v[20:23], a[184:187], v[96:99], v[20:23]
    v_mul_f32 v234, v234, v170
    v_and_b32 v235, 0xffff0000, v187
    v_mfma_f32_16x16x32_bf16 v[24:27], a[188:191], v[96:99], v[24:27]
    buffer_load_dwordx4 v[60:63], v218, s[36:39], 0 offen offset:1024 sc1
    v_mfma_f32_16x16x32_bf16 v[28:31], a[172:175], v[100:103], v[28:31]
    v_mul_f32 v235, v235, v171
    v_lshlrev_b32 v236, 16, v188
    v_mfma_f32_16x16x32_bf16 v[32:35], a[176:179], v[100:103], v[32:35]
    v_mul_f32 v236, v236, v172
    v_and_b32 v237, 0xffff0000, v188
    v_mfma_f32_16x16x32_bf16 v[36:39], a[180:183], v[100:103], v[36:39]
    buffer_load_dwordx4 v[64:67], v218, s[36:39], 0 offen offset:2048 sc1
    v_mfma_f32_16x16x32_bf16 v[40:43], a[184:187], v[100:103], v[40:43]
    ds_write_b128 v220, v[8:11] offset:0
    v_mul_f32 v237, v237, v173
    v_lshlrev_b32 v238, 16, v189
    v_mfma_f32_16x16x32_bf16 v[44:47], a[188:191], v[100:103], v[44:47]
    s_waitcnt vmcnt(2)
    v_mul_f32 v238, v238, v174
    v_and_b32 v239, 0xffff0000, v189
    v_mfma_f32_16x16x32_bf16 v[104:107], a[240:243], v[56:59], 0
    buffer_load_dwordx4 v[68:71], v218, s[36:39], 0 offen offset:3072 sc1
    v_mfma_f32_16x16x32_bf16 v[108:111], a[244:247], v[56:59], 0
    ds_write_b128 v220, v[12:15] offset:1024
    v_mul_f32 v239, v239, v175
    v_lshlrev_b32 v240, 16, v190
    v_mfma_f32_16x16x32_bf16 v[112:115], a[248:251], v[56:59], 0
    v_mul_f32 v240, v240, v176
    v_and_b32 v241, 0xffff0000, v190
    v_mfma_f32_16x16x32_bf16 v[116:119], a[252:255], v[56:59], 0
    buffer_load_dwordx4 v[72:75], v218, s[36:39], s4 offen offset:0 sc1
    v_mfma_f32_16x16x32_bf16 v[120:123], v[136:139], v[56:59], 0
    s_waitcnt vmcnt(3)
    ds_write_b128 v220, v[16:19] offset:2048
    v_mul_f32 v241, v241, v177
    v_lshlrev_b32 v242, 16, v191
    v_mfma_f32_16x16x32_bf16 v[104:107], v[140:143], v[60:63], v[104:107]
    v_mul_f32 v242, v242, v178
    v_and_b32 v243, 0xffff0000, v191
    v_mfma_f32_16x16x32_bf16 v[108:111], v[144:147], v[60:63], v[108:111]
    buffer_load_dwordx4 v[76:79], v218, s[36:39], s4 offen offset:1024 sc1
    v_mfma_f32_16x16x32_bf16 v[112:115], v[148:151], v[60:63], v[112:115]
    ds_write_b128 v220, v[20:23] offset:3072
    v_mul_f32 v243, v243, v179
    v_mfma_f32_16x16x32_bf16 v[116:119], v[152:155], v[60:63], v[116:119]
    v_mfma_f32_16x16x32_bf16 v[120:123], v[156:159], v[60:63], v[120:123]
    s_waitcnt vmcnt(3)
    buffer_load_dwordx4 v[80:83], v218, s[36:39], s4 offen offset:2048 sc1
    v_mfma_f32_16x16x32_bf16 v[104:107], v[160:163], v[64:67], v[104:107]
    ds_write_b128 v220, v[24:27] offset:4096
    v_mfma_f32_16x16x32_bf16 v[108:111], v[164:167], v[64:67], v[108:111]
    v_mfma_f32_16x16x32_bf16 v[112:115], a[0:3], v[64:67], v[112:115]
    ds_write_b128 v221, v[28:31] offset:0
    buffer_load_dwordx4 v[84:87], v218, s[36:39], s4 offen offset:3072 sc1
    v_mfma_f32_16x16x32_bf16 v[116:119], a[4:7], v[64:67], v[116:119]
    v_mfma_f32_16x16x32_bf16 v[120:123], a[8:11], v[64:67], v[120:123]
    s_waitcnt vmcnt(4)
    ds_write_b128 v221, v[32:35] offset:1024
    v_mfma_f32_16x16x32_bf16 v[104:107], a[12:15], v[68:71], v[104:107]
    buffer_load_dwordx4 v[88:91], v218, s[36:39], s5 offen offset:0 sc1
    v_mfma_f32_16x16x32_bf16 v[108:111], a[16:19], v[68:71], v[108:111]
    ds_write_b128 v221, v[36:39] offset:2048
    v_mfma_f32_16x16x32_bf16 v[112:115], a[20:23], v[68:71], v[112:115]
    v_mfma_f32_16x16x32_bf16 v[116:119], a[24:27], v[68:71], v[116:119]
    buffer_load_dwordx4 v[92:95], v218, s[36:39], s5 offen offset:1024 sc1
    v_mfma_f32_16x16x32_bf16 v[120:123], a[28:31], v[68:71], v[120:123]
    s_waitcnt vmcnt(5)
    ds_write_b128 v221, v[40:43] offset:3072
    v_mfma_f32_16x16x32_bf16 v[104:107], a[32:35], v[72:75], v[104:107]
    v_mfma_f32_16x16x32_bf16 v[108:111], a[36:39], v[72:75], v[108:111]
    buffer_load_dwordx4 v[96:99], v218, s[36:39], s5 offen offset:2048 sc1
    v_mfma_f32_16x16x32_bf16 v[112:115], a[40:43], v[72:75], v[112:115]
    ds_write_b128 v221, v[44:47] offset:4096
    v_mfma_f32_16x16x32_bf16 v[116:119], a[44:47], v[72:75], v[116:119]
    v_mfma_f32_16x16x32_bf16 v[120:123], a[48:51], v[72:75], v[120:123]
    s_waitcnt vmcnt(5)
    buffer_load_dwordx4 v[100:103], v218, s[36:39], s5 offen offset:3072 sc1
    v_mfma_f32_16x16x32_bf16 v[104:107], a[52:55], v[76:79], v[104:107]
    v_mfma_f32_16x16x32_bf16 v[108:111], a[56:59], v[76:79], v[108:111]
    v_mfma_f32_16x16x32_bf16 v[112:115], a[60:63], v[76:79], v[112:115]
    buffer_load_dwordx4 v[56:59], v219, s[36:39], 0 offen offset:0 sc1
    v_mfma_f32_16x16x32_bf16 v[116:119], a[64:67], v[76:79], v[116:119]
    v_mfma_f32_16x16x32_bf16 v[120:123], a[68:71], v[76:79], v[120:123]
    s_waitcnt vmcnt(6)
    v_mfma_f32_16x16x32_bf16 v[104:107], a[72:75], v[80:83], v[104:107]
    buffer_load_dwordx4 v[60:63], v219, s[36:39], 0 offen offset:1024 sc1
    v_mfma_f32_16x16x32_bf16 v[108:111], a[76:79], v[80:83], v[108:111]
    s_waitcnt lgkmcnt(0)
    s_barrier
    ds_read_b128 v[168:171], v224 offset:0
    v_mfma_f32_16x16x32_bf16 v[112:115], a[80:83], v[80:83], v[112:115]
    ds_read_b128 v[172:175], v224 offset:1024
    v_mfma_f32_16x16x32_bf16 v[116:119], a[84:87], v[80:83], v[116:119]
    buffer_load_dwordx4 v[64:67], v219, s[36:39], 0 offen offset:2048 sc1
    v_mfma_f32_16x16x32_bf16 v[120:123], a[88:91], v[80:83], v[120:123]
    s_waitcnt vmcnt(7)
    ds_read_b128 v[176:179], v224 offset:2048
    v_mfma_f32_16x16x32_bf16 v[104:107], a[92:95], v[84:87], v[104:107]
    ds_read_b128 v[180:183], v224 offset:5120
    ds_read_b128 v[184:187], v224 offset:6144
    v_mfma_f32_16x16x32_bf16 v[108:111], a[96:99], v[84:87], v[108:111]
    buffer_load_dwordx4 v[68:71], v219, s[36:39], 0 offen offset:3072 sc1
    v_mfma_f32_16x16x32_bf16 v[112:115], a[100:103], v[84:87], v[112:115]
    ds_read_b128 v[188:191], v224 offset:7168
    v_mfma_f32_16x16x32_bf16 v[116:119], a[104:107], v[84:87], v[116:119]
    ds_read_b128 v[192:195], v224 offset:10240
    ds_read_b128 v[196:199], v224 offset:11264
    v_mfma_f32_16x16x32_bf16 v[120:123], a[108:111], v[84:87], v[120:123]
    s_waitcnt vmcnt(7)
    buffer_load_dwordx4 v[72:75], v219, s[36:39], s4 offen offset:0 sc1
    v_mfma_f32_16x16x32_bf16 v[104:107], a[112:115], v[88:91], v[104:107]
    ds_read_b128 v[200:203], v224 offset:12288
    v_mfma_f32_16x16x32_bf16 v[108:111], a[116:119], v[88:91], v[108:111]
    s_waitcnt lgkmcnt(5)
    v_add_f32 v168, v168, v180
    v_add_f32 v169, v169, v181
    v_add_f32 v170, v170, v182
    v_mfma_f32_16x16x32_bf16 v[112:115], a[120:123], v[88:91], v[112:115]
    buffer_load_dwordx4 v[76:79], v219, s[36:39], s4 offen offset:1024 sc1
    v_mfma_f32_16x16x32_bf16 v[116:119], a[124:127], v[88:91], v[116:119]
    v_add_f32 v171, v171, v183
    s_waitcnt lgkmcnt(4)
    v_add_f32 v172, v172, v184
    v_mfma_f32_16x16x32_bf16 v[120:123], a[128:131], v[88:91], v[120:123]
    s_waitcnt vmcnt(8)
    v_add_f32 v173, v173, v185
    v_add_f32 v174, v174, v186
    v_mfma_f32_16x16x32_bf16 v[104:107], a[132:135], v[92:95], v[104:107]
    buffer_load_dwordx4 v[80:83], v219, s[36:39], s4 offen offset:2048 sc1
    v_mfma_f32_16x16x32_bf16 v[108:111], a[136:139], v[92:95], v[108:111]
    v_add_f32 v175, v175, v187
    s_waitcnt lgkmcnt(3)
    v_add_f32 v176, v176, v188
    v_mfma_f32_16x16x32_bf16 v[112:115], a[140:143], v[92:95], v[112:115]
    v_add_f32 v177, v177, v189
    v_add_f32 v178, v178, v190
    v_add_f32 v179, v179, v191
    v_mfma_f32_16x16x32_bf16 v[116:119], a[144:147], v[92:95], v[116:119]
    buffer_load_dwordx4 v[84:87], v219, s[36:39], s4 offen offset:3072 sc1
    v_mfma_f32_16x16x32_bf16 v[120:123], a[148:151], v[92:95], v[120:123]
    s_waitcnt vmcnt(9)
    ds_read_b128 v[180:183], v224 offset:15360
    ds_read_b128 v[184:187], v224 offset:16384
    v_mfma_f32_16x16x32_bf16 v[104:107], a[152:155], v[96:99], v[104:107]
    ds_read_b128 v[188:191], v224 offset:17408
    s_waitcnt lgkmcnt(5)
    v_add_f32 v168, v168, v192
    v_add_f32 v169, v169, v193
    v_mfma_f32_16x16x32_bf16 v[108:111], a[156:159], v[96:99], v[108:111]
    buffer_load_dwordx4 v[88:91], v219, s[36:39], s5 offen offset:0 sc1
    v_mfma_f32_16x16x32_bf16 v[112:115], a[160:163], v[96:99], v[112:115]
    v_add_f32 v170, v170, v194
    v_add_f32 v171, v171, v195
    v_mfma_f32_16x16x32_bf16 v[116:119], a[164:167], v[96:99], v[116:119]
    s_waitcnt lgkmcnt(4)
    v_add_f32 v172, v172, v196
    v_add_f32 v173, v173, v197
    v_mfma_f32_16x16x32_bf16 v[120:123], a[168:171], v[96:99], v[120:123]
    s_waitcnt vmcnt(9)
    buffer_load_dwordx4 v[92:95], v219, s[36:39], s5 offen offset:1024 sc1
    v_mfma_f32_16x16x32_bf16 v[104:107], a[172:175], v[100:103], v[104:107]
    v_add_f32 v174, v174, v198
    v_add_f32 v175, v175, v199
    v_mfma_f32_16x16x32_bf16 v[108:111], a[176:179], v[100:103], v[108:111]
    s_waitcnt lgkmcnt(3)
    v_add_f32 v176, v176, v200
    v_add_f32 v177, v177, v201
    v_add_f32 v178, v178, v202
    v_mfma_f32_16x16x32_bf16 v[112:115], a[180:183], v[100:103], v[112:115]
    buffer_load_dwordx4 v[96:99], v219, s[36:39], s5 offen offset:2048 sc1
    v_mfma_f32_16x16x32_bf16 v[116:119], a[184:187], v[100:103], v[116:119]
    v_add_f32 v179, v179, v203
    s_waitcnt lgkmcnt(2)
    v_add_f32 v168, v168, v180
    v_mfma_f32_16x16x32_bf16 v[120:123], a[188:191], v[100:103], v[120:123]
    s_waitcnt vmcnt(10)
    v_add_f32 v169, v169, v181
    v_add_f32 v170, v170, v182
    v_add_f32 v171, v171, v183
    v_mfma_f32_16x16x32_bf16 v[8:11], a[240:243], v[56:59], 0
    buffer_load_dwordx4 v[100:103], v219, s[36:39], s5 offen offset:3072 sc1
    v_mfma_f32_16x16x32_bf16 v[12:15], a[244:247], v[56:59], 0
    s_waitcnt lgkmcnt(1)
    v_add_f32 v172, v172, v184
    v_add_f32 v173, v173, v185
    v_mfma_f32_16x16x32_bf16 v[16:19], a[248:251], v[56:59], 0
    v_add_f32 v174, v174, v186
    v_add_f32 v175, v175, v187
    v_mfma_f32_16x16x32_bf16 v[20:23], a[252:255], v[56:59], 0
    ds_write_b128 v222, v[104:107] offset:0
    s_waitcnt lgkmcnt(1)
    v_add_f32 v176, v176, v188
    v_add_f32 v177, v177, v189
    v_mfma_f32_16x16x32_bf16 v[24:27], v[136:139], v[56:59], 0
    s_waitcnt vmcnt(10)
    v_add_f32 v178, v178, v190
    v_add_f32 v179, v179, v191
    v_fma_f32 v204, v168, v48, v204
    v_mfma_f32_16x16x32_bf16 v[8:11], v[140:143], v[60:63], v[8:11]
    ds_write_b128 v222, v[108:111] offset:1024
    v_fma_f32 v205, v169, v49, v205
    v_fma_f32 v206, v170, v50, v206
    v_mfma_f32_16x16x32_bf16 v[12:15], v[144:147], v[60:63], v[12:15]
    v_fma_f32 v207, v171, v51, v207
    v_fma_f32 v208, v172, v52, v208
    v_mfma_f32_16x16x32_bf16 v[16:19], v[148:151], v[60:63], v[16:19]
    ds_write_b128 v222, v[112:115] offset:2048
    v_fma_f32 v209, v173, v53, v209
    v_fma_f32 v210, v174, v54, v210
    v_mfma_f32_16x16x32_bf16 v[20:23], v[152:155], v[60:63], v[20:23]
    v_fma_f32 v211, v175, v55, v211
    v_fma_f32 v212, v176, v124, v212
    v_mfma_f32_16x16x32_bf16 v[24:27], v[156:159], v[60:63], v[24:27]
    s_waitcnt vmcnt(9)
    ds_write_b128 v222, v[116:119] offset:3072
    v_fma_f32 v213, v177, v125, v213
    v_fma_f32 v214, v178, v126, v214
    v_mfma_f32_16x16x32_bf16 v[8:11], v[160:163], v[64:67], v[8:11]
    v_fma_f32 v215, v179, v127, v215
    v_cvt_pk_bf16_f32 v180, v204, v205
    v_mfma_f32_16x16x32_bf16 v[12:15], v[164:167], v[64:67], v[12:15]
    v_cvt_pk_bf16_f32 v181, v206, v207
    v_cvt_pk_bf16_f32 v182, v208, v209
    v_mfma_f32_16x16x32_bf16 v[16:19], a[0:3], v[64:67], v[16:19]
    v_cvt_pk_bf16_f32 v183, v210, v211
    v_cvt_pk_bf16_f32 v184, v212, v213
    v_mfma_f32_16x16x32_bf16 v[20:23], a[4:7], v[64:67], v[20:23]
    ds_write_b128 v222, v[120:123] offset:4096
    v_cvt_pk_bf16_f32 v185, v214, v215
    v_mfma_f32_16x16x32_bf16 v[24:27], a[8:11], v[64:67], v[24:27]
    s_waitcnt vmcnt(8)
    v_permlane16_swap_b32 v180, v182
    v_mfma_f32_16x16x32_bf16 v[8:11], a[12:15], v[68:71], v[8:11]
    v_permlane16_swap_b32 v181, v183
    v_mfma_f32_16x16x32_bf16 v[12:15], a[16:19], v[68:71], v[12:15]
    buffer_store_dwordx4 v[180:183], v227, s[40:43], s13 offen nt
    v_mfma_f32_16x16x32_bf16 v[16:19], a[20:23], v[68:71], v[16:19]
    buffer_store_dwordx2 v[184:185], v228, s[40:43], s13 offen offset:64 nt
    v_mfma_f32_16x16x32_bf16 v[20:23], a[24:27], v[68:71], v[20:23]
    v_mfma_f32_16x16x32_bf16 v[24:27], a[28:31], v[68:71], v[24:27]
    s_waitcnt vmcnt(9)
    v_mfma_f32_16x16x32_bf16 v[8:11], a[32:35], v[72:75], v[8:11]
    v_mfma_f32_16x16x32_bf16 v[12:15], a[36:39], v[72:75], v[12:15]
    s_waitcnt lgkmcnt(0)
    s_barrier
    ds_read_b128 v[168:171], v225 offset:0
    v_mfma_f32_16x16x32_bf16 v[16:19], a[40:43], v[72:75], v[16:19]
    ds_read_b128 v[172:175], v225 offset:1024
    v_mfma_f32_16x16x32_bf16 v[20:23], a[44:47], v[72:75], v[20:23]
    ds_read_b128 v[176:179], v225 offset:2048
    v_mfma_f32_16x16x32_bf16 v[24:27], a[48:51], v[72:75], v[24:27]
    s_waitcnt vmcnt(8)
    ds_read_b128 v[192:195], v225 offset:10240
    v_mfma_f32_16x16x32_bf16 v[8:11], a[52:55], v[76:79], v[8:11]
    ds_read_b128 v[196:199], v225 offset:11264
    v_mfma_f32_16x16x32_bf16 v[12:15], a[56:59], v[76:79], v[12:15]
    ds_read_b128 v[200:203], v225 offset:12288
    v_mfma_f32_16x16x32_bf16 v[16:19], a[60:63], v[76:79], v[16:19]
    v_mfma_f32_16x16x32_bf16 v[20:23], a[64:67], v[76:79], v[20:23]
    v_mfma_f32_16x16x32_bf16 v[24:27], a[68:71], v[76:79], v[24:27]
    s_waitcnt vmcnt(7)
    v_mfma_f32_16x16x32_bf16 v[8:11], a[72:75], v[80:83], v[8:11]
    v_mfma_f32_16x16x32_bf16 v[12:15], a[76:79], v[80:83], v[12:15]
    v_mfma_f32_16x16x32_bf16 v[16:19], a[80:83], v[80:83], v[16:19]
    v_mfma_f32_16x16x32_bf16 v[20:23], a[84:87], v[80:83], v[20:23]
    s_waitcnt lgkmcnt(2)
    v_add_f32 v168, v168, v192
    v_add_f32 v169, v169, v193
    v_mfma_f32_16x16x32_bf16 v[24:27], a[88:91], v[80:83], v[24:27]
    s_waitcnt vmcnt(6)
    v_add_f32 v170, v170, v194
    v_add_f32 v171, v171, v195
    v_mfma_f32_16x16x32_bf16 v[8:11], a[92:95], v[84:87], v[8:11]
    s_waitcnt lgkmcnt(1)
    v_add_f32 v172, v172, v196
    v_add_f32 v173, v173, v197
    v_mfma_f32_16x16x32_bf16 v[12:15], a[96:99], v[84:87], v[12:15]
    v_add_f32 v174, v174, v198
    v_add_f32 v175, v175, v199
    v_mfma_f32_16x16x32_bf16 v[16:19], a[100:103], v[84:87], v[16:19]
    s_waitcnt lgkmcnt(0)
    v_add_f32 v176, v176, v200
    v_add_f32 v177, v177, v201
    v_mfma_f32_16x16x32_bf16 v[20:23], a[104:107], v[84:87], v[20:23]
    v_add_f32 v178, v178, v202
    v_add_f32 v179, v179, v203
    v_mfma_f32_16x16x32_bf16 v[24:27], a[108:111], v[84:87], v[24:27]
    s_waitcnt vmcnt(5)
    v_fma_f32 v232, v168, v48, v232
    v_fma_f32 v233, v169, v49, v233
    v_mfma_f32_16x16x32_bf16 v[8:11], a[112:115], v[88:91], v[8:11]
    v_fma_f32 v234, v170, v50, v234
    v_fma_f32 v235, v171, v51, v235
    v_mfma_f32_16x16x32_bf16 v[12:15], a[116:119], v[88:91], v[12:15]
    v_fma_f32 v236, v172, v52, v236
    v_fma_f32 v237, v173, v53, v237
    v_mfma_f32_16x16x32_bf16 v[16:19], a[120:123], v[88:91], v[16:19]
    v_fma_f32 v238, v174, v54, v238
    v_fma_f32 v239, v175, v55, v239
    v_mfma_f32_16x16x32_bf16 v[20:23], a[124:127], v[88:91], v[20:23]
    v_fma_f32 v240, v176, v124, v240
    v_fma_f32 v241, v177, v125, v241
    v_mfma_f32_16x16x32_bf16 v[24:27], a[128:131], v[88:91], v[24:27]
    s_waitcnt vmcnt(4)
    v_fma_f32 v242, v178, v126, v242
    v_fma_f32 v243, v179, v127, v243
    v_mfma_f32_16x16x32_bf16 v[8:11], a[132:135], v[92:95], v[8:11]
    v_mfma_f32_16x16x32_bf16 v[12:15], a[136:139], v[92:95], v[12:15]
    v_mfma_f32_16x16x32_bf16 v[16:19], a[140:143], v[92:95], v[16:19]
    v_mfma_f32_16x16x32_bf16 v[20:23], a[144:147], v[92:95], v[20:23]
    v_mfma_f32_16x16x32_bf16 v[24:27], a[148:151], v[92:95], v[24:27]
    s_waitcnt vmcnt(3)
    v_mfma_f32_16x16x32_bf16 v[8:11], a[152:155], v[96:99], v[8:11]
    v_mfma_f32_16x16x32_bf16 v[12:15], a[156:159], v[96:99], v[12:15]
    v_mfma_f32_16x16x32_bf16 v[16:19], a[160:163], v[96:99], v[16:19]
    v_mfma_f32_16x16x32_bf16 v[20:23], a[164:167], v[96:99], v[20:23]
    v_mfma_f32_16x16x32_bf16 v[24:27], a[168:171], v[96:99], v[24:27]
    s_waitcnt vmcnt(2)
    v_mfma_f32_16x16x32_bf16 v[8:11], a[172:175], v[100:103], v[8:11]
    v_mfma_f32_16x16x32_bf16 v[12:15], a[176:179], v[100:103], v[12:15]
    v_mfma_f32_16x16x32_bf16 v[16:19], a[180:183], v[100:103], v[16:19]
    v_mfma_f32_16x16x32_bf16 v[20:23], a[184:187], v[100:103], v[20:23]
    v_mfma_f32_16x16x32_bf16 v[24:27], a[188:191], v[100:103], v[24:27]
    s_nop 3
    ds_write_b128 v223, v[8:11] offset:0
    ds_write_b128 v223, v[12:15] offset:1024
    ds_write_b128 v223, v[16:19] offset:2048
    ds_write_b128 v223, v[20:23] offset:3072
    ds_write_b128 v223, v[24:27] offset:4096
    s_waitcnt lgkmcnt(0)
    s_barrier
    ds_read_b128 v[168:171], v226 offset:0
    ds_read_b128 v[172:175], v226 offset:1024
    ds_read_b128 v[176:179], v226 offset:2048
    ds_read_b128 v[180:183], v226 offset:10240
    ds_read_b128 v[184:187], v226 offset:11264
    ds_read_b128 v[188:191], v226 offset:12288
    s_waitcnt lgkmcnt(2)
    v_pk_add_f32 v[168:169], v[168:169], v[180:181]
    v_pk_add_f32 v[170:171], v[170:171], v[182:183]
    s_waitcnt lgkmcnt(1)
    v_pk_add_f32 v[172:173], v[172:173], v[184:185]
    v_pk_add_f32 v[174:175], v[174:175], v[186:187]
    s_waitcnt lgkmcnt(0)
    v_pk_add_f32 v[176:177], v[176:177], v[188:189]
    v_pk_add_f32 v[178:179], v[178:179], v[190:191]
    v_pk_fma_f32 v[232:233], v[168:169], v[48:49], v[232:233]
    v_pk_fma_f32 v[234:235], v[170:171], v[50:51], v[234:235]
    v_pk_fma_f32 v[236:237], v[172:173], v[52:53], v[236:237]
    v_pk_fma_f32 v[238:239], v[174:175], v[54:55], v[238:239]
    v_pk_fma_f32 v[240:241], v[176:177], v[124:125], v[240:241]
    v_pk_fma_f32 v[242:243], v[178:179], v[126:127], v[242:243]
    v_cvt_pk_bf16_f32 v168, v232, v233
    v_cvt_pk_bf16_f32 v169, v234, v235
    v_cvt_pk_bf16_f32 v170, v236, v237
    v_cvt_pk_bf16_f32 v171, v238, v239
    v_cvt_pk_bf16_f32 v172, v240, v241
    v_cvt_pk_bf16_f32 v173, v242, v243
    v_permlane16_swap_b32 v168, v170
    v_permlane16_swap_b32 v169, v171
    buffer_store_dwordx4 v[168:171], v227, s[40:43], s14 offen nt
    buffer_store_dwordx2 v[172:173], v228, s[40:43], s14 offen offset:64 nt
    s_endpgm
L_prep:
    s_mov_b32 s36, s32
    s_mov_b32 s37, s33
    s_mov_b32 s38, 0x10000000
    s_mov_b32 s39, 0x20000
    v_mov_b32 v2, 0
    s_mov_b32 s57, 23461888
    buffer_load_dword v246, v2, s[36:39], s57 offen sc1
    s_mov_b32 s49, 400000
    s_and_b32 s50, s2, 7
    s_lshr_b32 s51, s2, 3
    s_lshr_b32 s60, s50, 2
    s_lshl_b32 s60, s60, 3
    s_lshr_b32 s61, s51, 2
    s_add_u32 s72, s60, s61
    s_lshl_b32 s61, s61, 3
    s_mov_b32 s62, 0x6040200
    s_mov_b32 s63, 0x70308
    s_lshr_b64 s[62:63], s[62:63], s61
    s_and_b32 s34, s62, 255
    s_lshr_b32 s62, s50, 2
    s_mul_i32 s62, s62, 10
    s_add_u32 s34, s34, s62
    s_sub_u32 s62, s34, 20
    s_min_u32 s34, s34, s62
    s_and_b32 s60, s50, 3
    s_lshl_b32 s60, s60, 2
    s_and_b32 s61, s51, 3
    s_add_u32 s73, s60, s61
    s_and_b32 s75, s51, 7
    s_lshr_b32 s61, s51, 3
    s_lshl_b32 s60, s50, 2
    s_add_u32 s74, s60, s61
    s_mul_i32 s70, s50, 20
    s_add_u32 s70, s70, s51
    s_lshl_b32 s60, s50, 1
    s_cmp_ge_u32 s51, 10
    s_addc_u32 s60, s60, 0
    s_cmp_ge_u32 s51, 10
    s_cselect_b32 s61, 10, 0
    s_sub_u32 s61, s51, s61
    s_lshl_b32 s61, s61, 4
    s_add_u32 s76, s60, s61
    s_lshl_b32 s58, s70, 2
    s_add_u32 s58, s58, s3
    v_lshlrev_b32 v248, 4, v1
    s_mov_b32 s76, 0
    s_mov_b32 s50, 0xbfb8aa3b
    s_waitcnt vmcnt(5)
    v_lshlrev_b32 v180, 16, v80
    v_and_b32 v181, 0xffff0000, v80
    v_lshlrev_b32 v182, 16, v81
    v_and_b32 v183, 0xffff0000, v81
    s_waitcnt vmcnt(4)
    v_lshlrev_b32 v184, 16, v82
    v_and_b32 v185, 0xffff0000, v82
    v_lshlrev_b32 v186, 16, v83
    v_and_b32 v187, 0xffff0000, v83
    s_waitcnt vmcnt(3)
    v_lshlrev_b32 v188, 16, v84
    v_and_b32 v189, 0xffff0000, v84
    v_lshlrev_b32 v190, 16, v85
    v_and_b32 v191, 0xffff0000, v85
    s_waitcnt vmcnt(2)
    v_lshlrev_b32 v192, 16, v86
    v_and_b32 v193, 0xffff0000, v86
    v_lshlrev_b32 v194, 16, v87
    v_and_b32 v195, 0xffff0000, v87
    s_waitcnt vmcnt(1)
    v_lshlrev_b32 v196, 16, v88
    v_and_b32 v197, 0xffff0000, v88
    v_lshlrev_b32 v198, 16, v89
    v_and_b32 v199, 0xffff0000, v89
    v_mul_f32 v208, s50, v180
    v_exp_f32 v208, v208
    s_nop 0
    v_add_f32 v208, 1.0, v208
    v_rcp_f32 v208, v208
    s_nop 0
    v_mul_f32 v180, v180, v208
    v_mul_f32 v209, s50, v181
    v_exp_f32 v209, v209
    s_nop 0
    v_add_f32 v209, 1.0, v209
    v_rcp_f32 v209, v209
    s_nop 0
    v_mul_f32 v181, v181, v209
    v_mul_f32 v208, s50, v182
    v_exp_f32 v208, v208
    s_nop 0
    v_add_f32 v208, 1.0, v208
    v_rcp_f32 v208, v208
    s_nop 0
    v_mul_f32 v182, v182, v208
    v_mul_f32 v209, s50, v183
    v_exp_f32 v209, v209
    s_nop 0
    v_add_f32 v209, 1.0, v209
    v_rcp_f32 v209, v209
    s_nop 0
    v_mul_f32 v183, v183, v209
    v_mul_f32 v208, s50, v184
    v_exp_f32 v208, v208
    s_nop 0
    v_add_f32 v208, 1.0, v208
    v_rcp_f32 v208, v208
    s_nop 0
    v_mul_f32 v184, v184, v208
    v_mul_f32 v209, s50, v185
    v_exp_f32 v209, v209
    s_nop 0
    v_add_f32 v209, 1.0, v209
    v_rcp_f32 v209, v209
    s_nop 0
    v_mul_f32 v185, v185, v209
    v_mul_f32 v208, s50, v186
    v_exp_f32 v208, v208
    s_nop 0
    v_add_f32 v208, 1.0, v208
    v_rcp_f32 v208, v208
    s_nop 0
    v_mul_f32 v186, v186, v208
    v_mul_f32 v209, s50, v187
    v_exp_f32 v209, v209
    s_nop 0
    v_add_f32 v209, 1.0, v209
    v_rcp_f32 v209, v209
    s_nop 0
    v_mul_f32 v187, v187, v209
    v_mul_f32 v208, s50, v188
    v_exp_f32 v208, v208
    s_nop 0
    v_add_f32 v208, 1.0, v208
    v_rcp_f32 v208, v208
    s_nop 0
    v_mul_f32 v188, v188, v208
    v_mul_f32 v209, s50, v189
    v_exp_f32 v209, v209
    s_nop 0
    v_add_f32 v209, 1.0, v209
    v_rcp_f32 v209, v209
    s_nop 0
    v_mul_f32 v189, v189, v209
    v_mul_f32 v208, s50, v190
    v_exp_f32 v208, v208
    s_nop 0
    v_add_f32 v208, 1.0, v208
    v_rcp_f32 v208, v208
    s_nop 0
    v_mul_f32 v190, v190, v208
    v_mul_f32 v209, s50, v191
    v_exp_f32 v209, v209
    s_nop 0
    v_add_f32 v209, 1.0, v209
    v_rcp_f32 v209, v209
    s_nop 0
    v_mul_f32 v191, v191, v209
    v_mul_f32 v208, s50, v192
    v_exp_f32 v208, v208
    s_nop 0
    v_add_f32 v208, 1.0, v208
    v_rcp_f32 v208, v208
    s_nop 0
    v_mul_f32 v192, v192, v208
    v_mul_f32 v209, s50, v193
    v_exp_f32 v209, v209
    s_nop 0
    v_add_f32 v209, 1.0, v209
    v_rcp_f32 v209, v209
    s_nop 0
    v_mul_f32 v193, v193, v209
    v_mul_f32 v208, s50, v194
    v_exp_f32 v208, v208
    s_nop 0
    v_add_f32 v208, 1.0, v208
    v_rcp_f32 v208, v208
    s_nop 0
    v_mul_f32 v194, v194, v208
    v_mul_f32 v209, s50, v195
    v_exp_f32 v209, v209
    s_nop 0
    v_add_f32 v209, 1.0, v209
    v_rcp_f32 v209, v209
    s_nop 0
    v_mul_f32 v195, v195, v209
    v_mul_f32 v208, s50, v196
    v_exp_f32 v208, v208
    s_nop 0
    v_add_f32 v208, 1.0, v208
    v_rcp_f32 v208, v208
    s_nop 0
    v_mul_f32 v196, v196, v208
    v_mul_f32 v209, s50, v197
    v_exp_f32 v209, v209
    s_nop 0
    v_add_f32 v209, 1.0, v209
    v_rcp_f32 v209, v209
    s_nop 0
    v_mul_f32 v197, v197, v209
    v_mul_f32 v208, s50, v198
    v_exp_f32 v208, v208
    s_nop 0
    v_add_f32 v208, 1.0, v208
    v_rcp_f32 v208, v208
    s_nop 0
    v_mul_f32 v198, v198, v208
    v_mul_f32 v209, s50, v199
    v_exp_f32 v209, v209
    s_nop 0
    v_add_f32 v209, 1.0, v209
    v_rcp_f32 v209, v209
    s_nop 0
    v_mul_f32 v199, v199, v209
    v_cvt_pk_bf16_f32 v208, v180, v181
    v_lshlrev_b32 v180, 16, v208
    v_and_b32 v181, 0xffff0000, v208
    v_cvt_pk_bf16_f32 v208, v182, v183
    v_lshlrev_b32 v182, 16, v208
    v_and_b32 v183, 0xffff0000, v208
    v_cvt_pk_bf16_f32 v208, v184, v185
    v_lshlrev_b32 v184, 16, v208
    v_and_b32 v185, 0xffff0000, v208
    v_cvt_pk_bf16_f32 v208, v186, v187
    v_lshlrev_b32 v186, 16, v208
    v_and_b32 v187, 0xffff0000, v208
    v_cvt_pk_bf16_f32 v208, v188, v189
    v_lshlrev_b32 v188, 16, v208
    v_and_b32 v189, 0xffff0000, v208
    v_cvt_pk_bf16_f32 v208, v190, v191
    v_lshlrev_b32 v190, 16, v208
    v_and_b32 v191, 0xffff0000, v208
    v_cvt_pk_bf16_f32 v208, v192, v193
    v_lshlrev_b32 v192, 16, v208
    v_and_b32 v193, 0xffff0000, v208
    v_cvt_pk_bf16_f32 v208, v194, v195
    v_lshlrev_b32 v194, 16, v208
    v_and_b32 v195, 0xffff0000, v208
    v_cvt_pk_bf16_f32 v208, v196, v197
    v_lshlrev_b32 v196, 16, v208
    v_and_b32 v197, 0xffff0000, v208
    v_cvt_pk_bf16_f32 v208, v198, v199
    v_lshlrev_b32 v198, 16, v208
    v_and_b32 v199, 0xffff0000, v208
    buffer_load_dwordx4 v[90:93], v9, s[44:47], s56 offen nt
    s_add_u32 s56, s56, s68
    buffer_load_dwordx4 v[94:97], v9, s[44:47], s56 offen nt
    s_add_u32 s56, s56, s68
    buffer_load_dwordx4 v[98:101], v9, s[44:47], s56 offen nt
    s_add_u32 s56, s56, s68
    buffer_load_dwordx4 v[102:105], v9, s[44:47], s56 offen nt
    s_add_u32 s56, s56, s68
    buffer_load_dwordx4 v[106:109], v9, s[44:47], s56 offen nt
    s_add_u32 s56, s56, s68
    buffer_load_dwordx4 v[110:113], v9, s[44:47], s56 offen nt
    s_add_u32 s56, s56, s68
    buffer_load_dwordx4 v[114:117], v9, s[44:47], s56 offen nt
    s_add_u32 s56, s56, s68
    buffer_load_dwordx4 v[118:121], v9, s[44:47], s56 offen nt
    s_add_u32 s56, s56, s68
    buffer_load_dwordx4 v[122:125], v9, s[44:47], s56 offen nt
    s_add_u32 s56, s56, s68
    buffer_load_dwordx4 v[126:129], v9, s[44:47], s56 offen nt
    s_add_u32 s56, s56, s68
    buffer_load_dwordx4 v[130:133], v9, s[44:47], s56 offen nt
    s_add_u32 s56, s56, s68
    buffer_load_dwordx4 v[134:137], v9, s[44:47], s56 offen nt
    s_add_u32 s56, s56, s68
    buffer_load_dwordx4 v[138:141], v9, s[44:47], s56 offen nt
    s_add_u32 s56, s56, s68
    buffer_load_dwordx4 v[142:145], v9, s[44:47], s56 offen nt
    s_add_u32 s56, s56, s68
    buffer_load_dwordx4 v[146:149], v9, s[44:47], s56 offen nt
    s_add_u32 s56, s56, s68
    buffer_load_dwordx4 v[150:153], v9, s[44:47], s56 offen nt
    s_add_u32 s56, s56, s68
    buffer_load_dwordx4 v[154:157], v9, s[44:47], s56 offen nt
    s_add_u32 s56, s56, s68
    buffer_load_dwordx4 v[158:161], v9, s[44:47], s56 offen nt
    s_add_u32 s56, s56, s68
    buffer_load_dwordx4 v[162:165], v9, s[44:47], s56 offen nt
    s_add_u32 s56, s56, s68
    buffer_load_dwordx4 v[166:169], v9, s[44:47], s56 offen nt
    s_waitcnt vmcnt(19)
    v_lshlrev_b32 v208, 16, v90
    v_and_b32 v209, 0xffff0000, v90
    v_pk_mul_f32 v[200:201], v[208:209], v[180:181] op_sel_hi:[1,0]
    v_lshlrev_b32 v210, 16, v91
    v_and_b32 v211, 0xffff0000, v91
    v_pk_mul_f32 v[202:203], v[210:211], v[180:181] op_sel_hi:[1,0]
    v_lshlrev_b32 v208, 16, v92
    v_and_b32 v209, 0xffff0000, v92
    v_pk_mul_f32 v[204:205], v[208:209], v[180:181] op_sel_hi:[1,0]
    v_lshlrev_b32 v210, 16, v93
    v_and_b32 v211, 0xffff0000, v93
    v_pk_mul_f32 v[206:207], v[210:211], v[180:181] op_sel_hi:[1,0]
    s_waitcnt vmcnt(18)
    v_lshlrev_b32 v208, 16, v94
    v_and_b32 v209, 0xffff0000, v94
    v_pk_fma_f32 v[200:201], v[208:209], v[180:181], v[200:201] op_sel:[0,1,0] op_sel_hi:[1,1,1]
    v_lshlrev_b32 v210, 16, v95
    v_and_b32 v211, 0xffff0000, v95
    v_pk_fma_f32 v[202:203], v[210:211], v[180:181], v[202:203] op_sel:[0,1,0] op_sel_hi:[1,1,1]
    v_lshlrev_b32 v208, 16, v96
    v_and_b32 v209, 0xffff0000, v96
    v_pk_fma_f32 v[204:205], v[208:209], v[180:181], v[204:205] op_sel:[0,1,0] op_sel_hi:[1,1,1]
    v_lshlrev_b32 v210, 16, v97
    v_and_b32 v211, 0xffff0000, v97
    v_pk_fma_f32 v[206:207], v[210:211], v[180:181], v[206:207] op_sel:[0,1,0] op_sel_hi:[1,1,1]
    s_waitcnt vmcnt(17)
    v_lshlrev_b32 v208, 16, v98
    v_and_b32 v209, 0xffff0000, v98
    v_pk_fma_f32 v[200:201], v[208:209], v[182:183], v[200:201] op_sel_hi:[1,0,1]
    v_lshlrev_b32 v210, 16, v99
    v_and_b32 v211, 0xffff0000, v99
    v_pk_fma_f32 v[202:203], v[210:211], v[182:183], v[202:203] op_sel_hi:[1,0,1]
    v_lshlrev_b32 v208, 16, v100
    v_and_b32 v209, 0xffff0000, v100
    v_pk_fma_f32 v[204:205], v[208:209], v[182:183], v[204:205] op_sel_hi:[1,0,1]
    v_lshlrev_b32 v210, 16, v101
    v_and_b32 v211, 0xffff0000, v101
    v_pk_fma_f32 v[206:207], v[210:211], v[182:183], v[206:207] op_sel_hi:[1,0,1]
    s_waitcnt vmcnt(16)
    v_lshlrev_b32 v208, 16, v102
    v_and_b32 v209, 0xffff0000, v102
    v_pk_fma_f32 v[200:201], v[208:209], v[182:183], v[200:201] op_sel:[0,1,0] op_sel_hi:[1,1,1]
    v_lshlrev_b32 v210, 16, v103
    v_and_b32 v211, 0xffff0000, v103
    v_pk_fma_f32 v[202:203], v[210:211], v[182:183], v[202:203] op_sel:[0,1,0] op_sel_hi:[1,1,1]
    v_lshlrev_b32 v208, 16, v104
    v_and_b32 v209, 0xffff0000, v104
    v_pk_fma_f32 v[204:205], v[208:209], v[182:183], v[204:205] op_sel:[0,1,0] op_sel_hi:[1,1,1]
    v_lshlrev_b32 v210, 16, v105
    v_and_b32 v211, 0xffff0000, v105
    v_pk_fma_f32 v[206:207], v[210:211], v[182:183], v[206:207] op_sel:[0,1,0] op_sel_hi:[1,1,1]
    s_waitcnt vmcnt(15)
    v_lshlrev_b32 v208, 16, v106
    v_and_b32 v209, 0xffff0000, v106
    v_pk_fma_f32 v[200:201], v[208:209], v[184:185], v[200:201] op_sel_hi:[1,0,1]
    v_lshlrev_b32 v210, 16, v107
    v_and_b32 v211, 0xffff0000, v107
    v_pk_fma_f32 v[202:203], v[210:211], v[184:185], v[202:203] op_sel_hi:[1,0,1]
    v_lshlrev_b32 v208, 16, v108
    v_and_b32 v209, 0xffff0000, v108
    v_pk_fma_f32 v[204:205], v[208:209], v[184:185], v[204:205] op_sel_hi:[1,0,1]
    v_lshlrev_b32 v210, 16, v109
    v_and_b32 v211, 0xffff0000, v109
    v_pk_fma_f32 v[206:207], v[210:211], v[184:185], v[206:207] op_sel_hi:[1,0,1]
    s_waitcnt vmcnt(14)
    v_lshlrev_b32 v208, 16, v110
    v_and_b32 v209, 0xffff0000, v110
    v_pk_fma_f32 v[200:201], v[208:209], v[184:185], v[200:201] op_sel:[0,1,0] op_sel_hi:[1,1,1]
    v_lshlrev_b32 v210, 16, v111
    v_and_b32 v211, 0xffff0000, v111
    v_pk_fma_f32 v[202:203], v[210:211], v[184:185], v[202:203] op_sel:[0,1,0] op_sel_hi:[1,1,1]
    v_lshlrev_b32 v208, 16, v112
    v_and_b32 v209, 0xffff0000, v112
    v_pk_fma_f32 v[204:205], v[208:209], v[184:185], v[204:205] op_sel:[0,1,0] op_sel_hi:[1,1,1]
    v_lshlrev_b32 v210, 16, v113
    v_and_b32 v211, 0xffff0000, v113
    v_pk_fma_f32 v[206:207], v[210:211], v[184:185], v[206:207] op_sel:[0,1,0] op_sel_hi:[1,1,1]
    s_waitcnt vmcnt(13)
    v_lshlrev_b32 v208, 16, v114
    v_and_b32 v209, 0xffff0000, v114
    v_pk_fma_f32 v[200:201], v[208:209], v[186:187], v[200:201] op_sel_hi:[1,0,1]
    v_lshlrev_b32 v210, 16, v115
    v_and_b32 v211, 0xffff0000, v115
    v_pk_fma_f32 v[202:203], v[210:211], v[186:187], v[202:203] op_sel_hi:[1,0,1]
    v_lshlrev_b32 v208, 16, v116
    v_and_b32 v209, 0xffff0000, v116
    v_pk_fma_f32 v[204:205], v[208:209], v[186:187], v[204:205] op_sel_hi:[1,0,1]
    v_lshlrev_b32 v210, 16, v117
    v_and_b32 v211, 0xffff0000, v117
    v_pk_fma_f32 v[206:207], v[210:211], v[186:187], v[206:207] op_sel_hi:[1,0,1]
    s_waitcnt vmcnt(12)
    v_lshlrev_b32 v208, 16, v118
    v_and_b32 v209, 0xffff0000, v118
    v_pk_fma_f32 v[200:201], v[208:209], v[186:187], v[200:201] op_sel:[0,1,0] op_sel_hi:[1,1,1]
    v_lshlrev_b32 v210, 16, v119
    v_and_b32 v211, 0xffff0000, v119
    v_pk_fma_f32 v[202:203], v[210:211], v[186:187], v[202:203] op_sel:[0,1,0] op_sel_hi:[1,1,1]
    v_lshlrev_b32 v208, 16, v120
    v_and_b32 v209, 0xffff0000, v120
    v_pk_fma_f32 v[204:205], v[208:209], v[186:187], v[204:205] op_sel:[0,1,0] op_sel_hi:[1,1,1]
    v_lshlrev_b32 v210, 16, v121
    v_and_b32 v211, 0xffff0000, v121
    v_pk_fma_f32 v[206:207], v[210:211], v[186:187], v[206:207] op_sel:[0,1,0] op_sel_hi:[1,1,1]
    s_waitcnt vmcnt(11)
    v_lshlrev_b32 v208, 16, v122
    v_and_b32 v209, 0xffff0000, v122
    v_pk_fma_f32 v[200:201], v[208:209], v[188:189], v[200:201] op_sel_hi:[1,0,1]
    v_lshlrev_b32 v210, 16, v123
    v_and_b32 v211, 0xffff0000, v123
    v_pk_fma_f32 v[202:203], v[210:211], v[188:189], v[202:203] op_sel_hi:[1,0,1]
    v_lshlrev_b32 v208, 16, v124
    v_and_b32 v209, 0xffff0000, v124
    v_pk_fma_f32 v[204:205], v[208:209], v[188:189], v[204:205] op_sel_hi:[1,0,1]
    v_lshlrev_b32 v210, 16, v125
    v_and_b32 v211, 0xffff0000, v125
    v_pk_fma_f32 v[206:207], v[210:211], v[188:189], v[206:207] op_sel_hi:[1,0,1]
    s_waitcnt vmcnt(10)
    v_lshlrev_b32 v208, 16, v126
    v_and_b32 v209, 0xffff0000, v126
    v_pk_fma_f32 v[200:201], v[208:209], v[188:189], v[200:201] op_sel:[0,1,0] op_sel_hi:[1,1,1]
    v_lshlrev_b32 v210, 16, v127
    v_and_b32 v211, 0xffff0000, v127
    v_pk_fma_f32 v[202:203], v[210:211], v[188:189], v[202:203] op_sel:[0,1,0] op_sel_hi:[1,1,1]
    v_lshlrev_b32 v208, 16, v128
    v_and_b32 v209, 0xffff0000, v128
    v_pk_fma_f32 v[204:205], v[208:209], v[188:189], v[204:205] op_sel:[0,1,0] op_sel_hi:[1,1,1]
    v_lshlrev_b32 v210, 16, v129
    v_and_b32 v211, 0xffff0000, v129
    v_pk_fma_f32 v[206:207], v[210:211], v[188:189], v[206:207] op_sel:[0,1,0] op_sel_hi:[1,1,1]
    s_waitcnt vmcnt(9)
    v_lshlrev_b32 v208, 16, v130
    v_and_b32 v209, 0xffff0000, v130
    v_pk_fma_f32 v[200:201], v[208:209], v[190:191], v[200:201] op_sel_hi:[1,0,1]
    v_lshlrev_b32 v210, 16, v131
    v_and_b32 v211, 0xffff0000, v131
    v_pk_fma_f32 v[202:203], v[210:211], v[190:191], v[202:203] op_sel_hi:[1,0,1]
    v_lshlrev_b32 v208, 16, v132
    v_and_b32 v209, 0xffff0000, v132
    v_pk_fma_f32 v[204:205], v[208:209], v[190:191], v[204:205] op_sel_hi:[1,0,1]
    v_lshlrev_b32 v210, 16, v133
    v_and_b32 v211, 0xffff0000, v133
    v_pk_fma_f32 v[206:207], v[210:211], v[190:191], v[206:207] op_sel_hi:[1,0,1]
    s_waitcnt vmcnt(8)
    v_lshlrev_b32 v208, 16, v134
    v_and_b32 v209, 0xffff0000, v134
    v_pk_fma_f32 v[200:201], v[208:209], v[190:191], v[200:201] op_sel:[0,1,0] op_sel_hi:[1,1,1]
    v_lshlrev_b32 v210, 16, v135
    v_and_b32 v211, 0xffff0000, v135
    v_pk_fma_f32 v[202:203], v[210:211], v[190:191], v[202:203] op_sel:[0,1,0] op_sel_hi:[1,1,1]
    v_lshlrev_b32 v208, 16, v136
    v_and_b32 v209, 0xffff0000, v136
    v_pk_fma_f32 v[204:205], v[208:209], v[190:191], v[204:205] op_sel:[0,1,0] op_sel_hi:[1,1,1]
    v_lshlrev_b32 v210, 16, v137
    v_and_b32 v211, 0xffff0000, v137
    v_pk_fma_f32 v[206:207], v[210:211], v[190:191], v[206:207] op_sel:[0,1,0] op_sel_hi:[1,1,1]
    s_waitcnt vmcnt(7)
    v_lshlrev_b32 v208, 16, v138
    v_and_b32 v209, 0xffff0000, v138
    v_pk_fma_f32 v[200:201], v[208:209], v[192:193], v[200:201] op_sel_hi:[1,0,1]
    v_lshlrev_b32 v210, 16, v139
    v_and_b32 v211, 0xffff0000, v139
    v_pk_fma_f32 v[202:203], v[210:211], v[192:193], v[202:203] op_sel_hi:[1,0,1]
    v_lshlrev_b32 v208, 16, v140
    v_and_b32 v209, 0xffff0000, v140
    v_pk_fma_f32 v[204:205], v[208:209], v[192:193], v[204:205] op_sel_hi:[1,0,1]
    v_lshlrev_b32 v210, 16, v141
    v_and_b32 v211, 0xffff0000, v141
    v_pk_fma_f32 v[206:207], v[210:211], v[192:193], v[206:207] op_sel_hi:[1,0,1]
    s_waitcnt vmcnt(6)
    v_lshlrev_b32 v208, 16, v142
    v_and_b32 v209, 0xffff0000, v142
    v_pk_fma_f32 v[200:201], v[208:209], v[192:193], v[200:201] op_sel:[0,1,0] op_sel_hi:[1,1,1]
    v_lshlrev_b32 v210, 16, v143
    v_and_b32 v211, 0xffff0000, v143
    v_pk_fma_f32 v[202:203], v[210:211], v[192:193], v[202:203] op_sel:[0,1,0] op_sel_hi:[1,1,1]
    v_lshlrev_b32 v208, 16, v144
    v_and_b32 v209, 0xffff0000, v144
    v_pk_fma_f32 v[204:205], v[208:209], v[192:193], v[204:205] op_sel:[0,1,0] op_sel_hi:[1,1,1]
    v_lshlrev_b32 v210, 16, v145
    v_and_b32 v211, 0xffff0000, v145
    v_pk_fma_f32 v[206:207], v[210:211], v[192:193], v[206:207] op_sel:[0,1,0] op_sel_hi:[1,1,1]
    s_waitcnt vmcnt(5)
    v_lshlrev_b32 v208, 16, v146
    v_and_b32 v209, 0xffff0000, v146
    v_pk_fma_f32 v[200:201], v[208:209], v[194:195], v[200:201] op_sel_hi:[1,0,1]
    v_lshlrev_b32 v210, 16, v147
    v_and_b32 v211, 0xffff0000, v147
    v_pk_fma_f32 v[202:203], v[210:211], v[194:195], v[202:203] op_sel_hi:[1,0,1]
    v_lshlrev_b32 v208, 16, v148
    v_and_b32 v209, 0xffff0000, v148
    v_pk_fma_f32 v[204:205], v[208:209], v[194:195], v[204:205] op_sel_hi:[1,0,1]
    v_lshlrev_b32 v210, 16, v149
    v_and_b32 v211, 0xffff0000, v149
    v_pk_fma_f32 v[206:207], v[210:211], v[194:195], v[206:207] op_sel_hi:[1,0,1]
    s_waitcnt vmcnt(4)
    v_lshlrev_b32 v208, 16, v150
    v_and_b32 v209, 0xffff0000, v150
    v_pk_fma_f32 v[200:201], v[208:209], v[194:195], v[200:201] op_sel:[0,1,0] op_sel_hi:[1,1,1]
    v_lshlrev_b32 v210, 16, v151
    v_and_b32 v211, 0xffff0000, v151
    v_pk_fma_f32 v[202:203], v[210:211], v[194:195], v[202:203] op_sel:[0,1,0] op_sel_hi:[1,1,1]
    v_lshlrev_b32 v208, 16, v152
    v_and_b32 v209, 0xffff0000, v152
    v_pk_fma_f32 v[204:205], v[208:209], v[194:195], v[204:205] op_sel:[0,1,0] op_sel_hi:[1,1,1]
    v_lshlrev_b32 v210, 16, v153
    v_and_b32 v211, 0xffff0000, v153
    v_pk_fma_f32 v[206:207], v[210:211], v[194:195], v[206:207] op_sel:[0,1,0] op_sel_hi:[1,1,1]
    s_waitcnt vmcnt(3)
    v_lshlrev_b32 v208, 16, v154
    v_and_b32 v209, 0xffff0000, v154
    v_pk_fma_f32 v[200:201], v[208:209], v[196:197], v[200:201] op_sel_hi:[1,0,1]
    v_lshlrev_b32 v210, 16, v155
    v_and_b32 v211, 0xffff0000, v155
    v_pk_fma_f32 v[202:203], v[210:211], v[196:197], v[202:203] op_sel_hi:[1,0,1]
    v_lshlrev_b32 v208, 16, v156
    v_and_b32 v209, 0xffff0000, v156
    v_pk_fma_f32 v[204:205], v[208:209], v[196:197], v[204:205] op_sel_hi:[1,0,1]
    v_lshlrev_b32 v210, 16, v157
    v_and_b32 v211, 0xffff0000, v157
    v_pk_fma_f32 v[206:207], v[210:211], v[196:197], v[206:207] op_sel_hi:[1,0,1]
    s_waitcnt vmcnt(2)
    v_lshlrev_b32 v208, 16, v158
    v_and_b32 v209, 0xffff0000, v158
    v_pk_fma_f32 v[200:201], v[208:209], v[196:197], v[200:201] op_sel:[0,1,0] op_sel_hi:[1,1,1]
    v_lshlrev_b32 v210, 16, v159
    v_and_b32 v211, 0xffff0000, v159
    v_pk_fma_f32 v[202:203], v[210:211], v[196:197], v[202:203] op_sel:[0,1,0] op_sel_hi:[1,1,1]
    v_lshlrev_b32 v208, 16, v160
    v_and_b32 v209, 0xffff0000, v160
    v_pk_fma_f32 v[204:205], v[208:209], v[196:197], v[204:205] op_sel:[0,1,0] op_sel_hi:[1,1,1]
    v_lshlrev_b32 v210, 16, v161
    v_and_b32 v211, 0xffff0000, v161
    v_pk_fma_f32 v[206:207], v[210:211], v[196:197], v[206:207] op_sel:[0,1,0] op_sel_hi:[1,1,1]
    s_waitcnt vmcnt(1)
    v_lshlrev_b32 v208, 16, v162
    v_and_b32 v209, 0xffff0000, v162
    v_pk_fma_f32 v[200:201], v[208:209], v[198:199], v[200:201] op_sel_hi:[1,0,1]
    v_lshlrev_b32 v210, 16, v163
    v_and_b32 v211, 0xffff0000, v163
    v_pk_fma_f32 v[202:203], v[210:211], v[198:199], v[202:203] op_sel_hi:[1,0,1]
    v_lshlrev_b32 v208, 16, v164
    v_and_b32 v209, 0xffff0000, v164
    v_pk_fma_f32 v[204:205], v[208:209], v[198:199], v[204:205] op_sel_hi:[1,0,1]
    v_lshlrev_b32 v210, 16, v165
    v_and_b32 v211, 0xffff0000, v165
    v_pk_fma_f32 v[206:207], v[210:211], v[198:199], v[206:207] op_sel_hi:[1,0,1]
    s_waitcnt vmcnt(0)
    v_lshlrev_b32 v208, 16, v166
    v_and_b32 v209, 0xffff0000, v166
    v_pk_fma_f32 v[200:201], v[208:209], v[198:199], v[200:201] op_sel:[0,1,0] op_sel_hi:[1,1,1]
    v_lshlrev_b32 v210, 16, v167
    v_and_b32 v211, 0xffff0000, v167
    v_pk_fma_f32 v[202:203], v[210:211], v[198:199], v[202:203] op_sel:[0,1,0] op_sel_hi:[1,1,1]
    v_lshlrev_b32 v208, 16, v168
    v_and_b32 v209, 0xffff0000, v168
    v_pk_fma_f32 v[204:205], v[208:209], v[198:199], v[204:205] op_sel:[0,1,0] op_sel_hi:[1,1,1]
    v_lshlrev_b32 v210, 16, v169
    v_and_b32 v211, 0xffff0000, v169
    v_pk_fma_f32 v[206:207], v[210:211], v[198:199], v[206:207] op_sel:[0,1,0] op_sel_hi:[1,1,1]
    v_readfirstlane_b32 s48, v246
    s_mul_i32 s48, s48, 0x9E3779B1
    s_add_u32 s48, s48, 0x7F4A7C15
    v_lshlrev_b32 v2, 5, v0
    ds_write_b128 v2, v[200:203] offset:0
    ds_write_b128 v2, v[204:207] offset:16
    s_waitcnt lgkmcnt(0)
    s_barrier
    s_cmp_eq_u32 s3, 0
    s_cbranch_scc0 L_mod_done
    v_lshlrev_b32 v2, 2, v1
    ds_read_b32 v80, v2 offset:0
    ds_read_b32 v81, v2 offset:256
    ds_read_b32 v82, v2 offset:512
    ds_read_b32 v83, v2 offset:768
    ds_read_b32 v84, v2 offset:1024
    ds_read_b32 v85, v2 offset:1280
    ds_read_b32 v86, v2 offset:1536
    ds_read_b32 v87, v2 offset:1792
    ds_read_b32 v88, v2 offset:2048
    ds_read_b32 v89, v2 offset:2304
    ds_read_b32 v90, v2 offset:2560
    ds_read_b32 v91, v2 offset:2816
    ds_read_b32 v92, v2 offset:3072
    ds_read_b32 v93, v2 offset:3328
    ds_read_b32 v94, v2 offset:3584
    ds_read_b32 v95, v2 offset:3840
    ds_read_b32 v96, v2 offset:4096
    ds_read_b32 v97, v2 offset:4352
    ds_read_b32 v98, v2 offset:4608
    ds_read_b32 v99, v2 offset:4864
    ds_read_b32 v100, v2 offset:5120
    ds_read_b32 v101, v2 offset:5376
    ds_read_b32 v102, v2 offset:5632
    ds_read_b32 v103, v2 offset:5888
    ds_read_b32 v104, v2 offset:6144
    ds_read_b32 v105, v2 offset:6400
    ds_read_b32 v106, v2 offset:6656
    ds_read_b32 v107, v2 offset:6912
    ds_read_b32 v108, v2 offset:7168
    ds_read_b32 v109, v2 offset:7424
    ds_read_b32 v110, v2 offset:7680
    ds_read_b32 v111, v2 offset:7936
    s_waitcnt lgkmcnt(14)
    v_add_f32 v80, v80, v96
    v_add_f32 v81, v81, v97
    s_waitcnt lgkmcnt(13)
    v_add_f32 v82, v82, v98
    s_waitcnt lgkmcnt(12)
    v_add_f32 v83, v83, v99
    s_waitcnt lgkmcnt(11)
    v_add_f32 v84, v84, v100
    s_waitcnt lgkmcnt(10)
    v_add_f32 v85, v85, v101
    s_waitcnt lgkmcnt(9)
    v_add_f32 v86, v86, v102
    s_waitcnt lgkmcnt(8)
    v_add_f32 v87, v87, v103
    s_waitcnt lgkmcnt(7)
    v_add_f32 v88, v88, v104
    s_waitcnt lgkmcnt(6)
    v_add_f32 v89, v89, v105
    s_waitcnt lgkmcnt(5)
    v_add_f32 v90, v90, v106
    s_waitcnt lgkmcnt(4)
    v_add_f32 v91, v91, v107
    s_waitcnt lgkmcnt(3)
    v_add_f32 v92, v92, v108
    s_waitcnt lgkmcnt(2)
    v_add_f32 v93, v93, v109
    s_waitcnt lgkmcnt(1)
    v_add_f32 v94, v94, v110
    s_waitcnt lgkmcnt(0)
    v_add_f32 v95, v95, v111
    v_add_f32 v80, v80, v88
    v_add_f32 v81, v81, v89
    v_add_f32 v82, v82, v90
    v_add_f32 v83, v83, v91
    v_add_f32 v84, v84, v92
    v_add_f32 v85, v85, v93
    v_add_f32 v86, v86, v94
    v_add_f32 v87, v87, v95
    v_add_f32 v80, v80, v84
    v_add_f32 v81, v81, v85
    v_add_f32 v82, v82, v86
    v_add_f32 v83, v83, v87
    v_add_f32 v80, v80, v82
    v_add_f32 v81, v81, v83
    v_add_f32 v80, v80, v81
    s_mov_b32 s50, 429496730
    s_mul_hi_u32 s51, s77, s50
    s_mul_i32 s52, s51, 10
    s_sub_u32 s52, s77, s52
    v_cvt_pk_bf16_f32 v3, v80, v80
    v_lshlrev_b32 v3, 16, v3
    v_add_f32 v4, 1.0, v3
    v_cvt_pk_bf16_f32 v4, v4, v4
    v_lshlrev_b32 v4, 16, v4
    s_cmp_eq_u32 s51, 1
    s_cselect_b64 vcc, -1, 0
    s_cmp_eq_u32 s51, 4
    s_cselect_b64 vcc, -1, vcc
    v_cndmask_b32 v3, v3, v4, vcc
    s_cmp_eq_u32 s51, 4
    s_cbranch_scc0 L_mod_noicb
    v_cmp_eq_f32 vcc, 0, v3
    v_mov_b32 v4, 0x2b800000
    s_nop 0
    v_cndmask_b32 v3, v3, v4, vcc
    v_rcp_f32 v4, v3
    s_lshl_b32 s53, s52, 8
    s_add_u32 s53, s53, 23183360
    v_fma_f32 v5, -v3, v4, 1.0
    v_fmac_f32 v4, v5, v4
    buffer_store_dword v4, v2, s[36:39], s53 offen sc1
    buffer_store_dword v4, v2, s[36:39], s53 offen offset:2560 sc1
L_mod_noicb:
    v_mov_b32 v4, v3
    v_mov_b32 v5, s48
    v_lshlrev_b32 v6, 3, v1
    s_lshl_b32 s53, s77, 9
    s_add_u32 s53, s53, 23560192
    buffer_store_dwordx2 v[4:5], v6, s[36:39], s53 offen sc1
    s_lshl_b32 s53, s77, 8
    s_add_u32 s53, s53, 23134208
    buffer_store_dword v3, v2, s[36:39], s53 offen sc1
    s_sub_u32 s53, s51, 3
    s_cmp_lt_u32 s53, 2
    s_cbranch_scc0 L_mod_done
    v_mov_b32_dpp v4, v3 quad_perm:[1,0,3,2] row_mask:0xf bank_mask:0xf
    v_lshrrev_b32 v5, 16, v3
    v_or_b32 v5, v5, v4
    v_lshrrev_b32 v6, 5, v1
    v_lshlrev_b32 v6, 7, v6
    v_bfe_u32 v7, v1, 2, 2
    v_lshl_add_u32 v6, v7, 4, v6
    v_bfe_u32 v7, v1, 4, 1
    v_lshl_add_u32 v6, v7, 3, v6
    v_and_b32 v7, 2, v1
    v_lshl_add_u32 v6, v7, 1, v6
    s_xor_b32 s53, s53, 1
    s_lshl_b32 s53, s53, 6
    s_lshl_b32 s52, s52, 8
    s_add_u32 s53, s53, s52
    s_add_u32 s53, s53, 23166976
    s_mov_b32 exec_lo, 0x55555555
    s_mov_b32 exec_hi, 0x55555555
    buffer_store_dword v5, v6, s[36:39], s53 offen sc1
    buffer_store_dword v5, v6, s[36:39], s53 offen offset:2560 sc1
    s_mov_b64 exec, -1
L_mod_done:
    s_add_u32 s77, s77, 40
    s_branch L_p_w
L_p_b:
    s_mov_b32 s36, s32
    s_mov_b32 s37, s33
    s_mov_b32 s38, 0x10000000
    s_mov_b32 s39, 0x20000
    v_mov_b32 v2, 0
    s_mov_b32 s57, 23461888
    buffer_load_dword v246, v2, s[36:39], s57 offen sc1
    s_mov_b32 s49, 400000
    s_and_b32 s50, s2, 7
    s_lshr_b32 s51, s2, 3
    s_lshr_b32 s60, s50, 2
    s_lshl_b32 s60, s60, 3
    s_lshr_b32 s61, s51, 2
    s_add_u32 s72, s60, s61
    s_lshl_b32 s61, s61, 3
    s_mov_b32 s62, 0x6040200
    s_mov_b32 s63, 0x70308
    s_lshr_b64 s[62:63], s[62:63], s61
    s_and_b32 s34, s62, 255
    s_lshr_b32 s62, s50, 2
    s_mul_i32 s62, s62, 10
    s_add_u32 s34, s34, s62
    s_sub_u32 s62, s34, 20
    s_min_u32 s34, s34, s62
    s_and_b32 s60, s50, 3
    s_lshl_b32 s60, s60, 2
    s_and_b32 s61, s51, 3
    s_add_u32 s73, s60, s61
    s_and_b32 s75, s51, 7
    s_lshr_b32 s61, s51, 3
    s_lshl_b32 s60, s50, 2
    s_add_u32 s74, s60, s61
    s_mul_i32 s70, s50, 20
    s_add_u32 s70, s70, s51
    s_lshl_b32 s60, s50, 1
    s_cmp_ge_u32 s51, 10
    s_addc_u32 s60, s60, 0
    s_cmp_ge_u32 s51, 10
    s_cselect_b32 s61, 10, 0
    s_sub_u32 s61, s51, s61
    s_lshl_b32 s61, s61, 4
    s_add_u32 s76, s60, s61
    s_lshl_b32 s58, s70, 2
    s_add_u32 s58, s58, s3
    v_lshlrev_b32 v248, 4, v1
    s_waitcnt vmcnt(0)
    v_readfirstlane_b32 s48, v246
    s_mul_i32 s48, s48, 0x9E3779B1
    s_add_u32 s48, s48, 0x7F4A7C15
    s_mov_b32 s76, s65
    s_add_u32 s77, s71, 1048
    s_branch L_p_w
L_p_s:
    s_mov_b32 s36, s32
    s_mov_b32 s37, s33
    s_mov_b32 s38, 0x10000000
    s_mov_b32 s39, 0x20000
    v_mov_b32 v2, 0
    s_mov_b32 s57, 23461888
    buffer_load_dword v246, v2, s[36:39], s57 offen sc1
    s_mov_b32 s49, 400000
    s_and_b32 s50, s2, 7
    s_lshr_b32 s51, s2, 3
    s_lshr_b32 s60, s50, 2
    s_lshl_b32 s60, s60, 3
    s_lshr_b32 s61, s51, 2
    s_add_u32 s72, s60, s61
    s_lshl_b32 s61, s61, 3
    s_mov_b32 s62, 0x6040200
    s_mov_b32 s63, 0x70308
    s_lshr_b64 s[62:63], s[62:63], s61
    s_and_b32 s34, s62, 255
    s_lshr_b32 s62, s50, 2
    s_mul_i32 s62, s62, 10
    s_add_u32 s34, s34, s62
    s_sub_u32 s62, s34, 20
    s_min_u32 s34, s34, s62
    s_and_b32 s60, s50, 3
    s_lshl_b32 s60, s60, 2
    s_and_b32 s61, s51, 3
    s_add_u32 s73, s60, s61
    s_and_b32 s75, s51, 7
    s_lshr_b32 s61, s51, 3
    s_lshl_b32 s60, s50, 2
    s_add_u32 s74, s60, s61
    s_mul_i32 s70, s50, 20
    s_add_u32 s70, s70, s51
    s_lshl_b32 s60, s50, 1
    s_cmp_ge_u32 s51, 10
    s_addc_u32 s60, s60, 0
    s_cmp_ge_u32 s51, 10
    s_cselect_b32 s61, 10, 0
    s_sub_u32 s61, s51, s61
    s_lshl_b32 s61, s61, 4
    s_add_u32 s76, s60, s61
    s_lshl_b32 s58, s70, 2
    s_add_u32 s58, s58, s3
    v_lshlrev_b32 v248, 4, v1
    s_mov_b32 s44, s4
    s_mov_b32 s45, s5
    s_mov_b32 s46, 0x280000
    s_mov_b32 s47, 0x20000
    s_lshl_b32 s50, s77, 2
    s_add_u32 s50, s50, s3
    s_mul_i32 s56, s50, 20480
    v_lshrrev_b32 v2, 4, v1
    v_mul_u32_u24 v2, 1280, v2
    v_and_b32 v3, 15, v1
    v_lshl_add_u32 v2, v3, 4, v2
    buffer_load_dwordx4 v[16:19], v2, s[44:47], s56 offen offset:0 nt
    buffer_load_dwordx4 v[20:23], v2, s[44:47], s56 offen offset:256 nt
    buffer_load_dwordx4 v[24:27], v2, s[44:47], s56 offen offset:512 nt
    buffer_load_dwordx4 v[28:31], v2, s[44:47], s56 offen offset:768 nt
    buffer_load_dwordx4 v[32:35], v2, s[44:47], s56 offen offset:1024 nt
    s_add_u32 s56, s56, 5120
    buffer_load_dwordx4 v[36:39], v2, s[44:47], s56 offen offset:0 nt
    buffer_load_dwordx4 v[40:43], v2, s[44:47], s56 offen offset:256 nt
    buffer_load_dwordx4 v[44:47], v2, s[44:47], s56 offen offset:512 nt
    buffer_load_dwordx4 v[48:51], v2, s[44:47], s56 offen offset:768 nt
    buffer_load_dwordx4 v[52:55], v2, s[44:47], s56 offen offset:1024 nt
    s_add_u32 s56, s56, 5120
    buffer_load_dwordx4 v[56:59], v2, s[44:47], s56 offen offset:0 nt
    buffer_load_dwordx4 v[60:63], v2, s[44:47], s56 offen offset:256 nt
    buffer_load_dwordx4 v[64:67], v2, s[44:47], s56 offen offset:512 nt
    buffer_load_dwordx4 v[68:71], v2, s[44:47], s56 offen offset:768 nt
    buffer_load_dwordx4 v[72:75], v2, s[44:47], s56 offen offset:1024 nt
    s_add_u32 s56, s56, 5120
    buffer_load_dwordx4 v[76:79], v2, s[44:47], s56 offen offset:0 nt
    buffer_load_dwordx4 v[80:83], v2, s[44:47], s56 offen offset:256 nt
    buffer_load_dwordx4 v[84:87], v2, s[44:47], s56 offen offset:512 nt
    buffer_load_dwordx4 v[88:91], v2, s[44:47], s56 offen offset:768 nt
    buffer_load_dwordx4 v[92:95], v2, s[44:47], s56 offen offset:1024 nt
    s_mov_b32 s76, s65
    s_mov_b32 s50, 0x3f803f80
    v_mov_b32 v180, 0
    v_mov_b32 v181, 0
    v_mov_b32 v182, 0
    v_mov_b32 v183, 0
    v_mov_b32 v184, 0
    v_mov_b32 v185, 0
    v_mov_b32 v186, 0
    v_mov_b32 v187, 0
    s_waitcnt vmcnt(19)
    v_dot2_f32_bf16 v180, v16, s50, v180
    v_dot2_f32_bf16 v184, v16, v16, v184
    v_dot2_f32_bf16 v180, v17, s50, v180
    v_dot2_f32_bf16 v184, v17, v17, v184
    v_dot2_f32_bf16 v180, v18, s50, v180
    v_dot2_f32_bf16 v184, v18, v18, v184
    v_dot2_f32_bf16 v180, v19, s50, v180
    v_dot2_f32_bf16 v184, v19, v19, v184
    s_waitcnt vmcnt(18)
    v_dot2_f32_bf16 v180, v20, s50, v180
    v_dot2_f32_bf16 v184, v20, v20, v184
    v_dot2_f32_bf16 v180, v21, s50, v180
    v_dot2_f32_bf16 v184, v21, v21, v184
    v_dot2_f32_bf16 v180, v22, s50, v180
    v_dot2_f32_bf16 v184, v22, v22, v184
    v_dot2_f32_bf16 v180, v23, s50, v180
    v_dot2_f32_bf16 v184, v23, v23, v184
    s_waitcnt vmcnt(17)
    v_dot2_f32_bf16 v180, v24, s50, v180
    v_dot2_f32_bf16 v184, v24, v24, v184
    v_dot2_f32_bf16 v180, v25, s50, v180
    v_dot2_f32_bf16 v184, v25, v25, v184
    v_dot2_f32_bf16 v180, v26, s50, v180
    v_dot2_f32_bf16 v184, v26, v26, v184
    v_dot2_f32_bf16 v180, v27, s50, v180
    v_dot2_f32_bf16 v184, v27, v27, v184
    s_waitcnt vmcnt(16)
    v_dot2_f32_bf16 v180, v28, s50, v180
    v_dot2_f32_bf16 v184, v28, v28, v184
    v_dot2_f32_bf16 v180, v29, s50, v180
    v_dot2_f32_bf16 v184, v29, v29, v184
    v_dot2_f32_bf16 v180, v30, s50, v180
    v_dot2_f32_bf16 v184, v30, v30, v184
    v_dot2_f32_bf16 v180, v31, s50, v180
    v_dot2_f32_bf16 v184, v31, v31, v184
    s_waitcnt vmcnt(15)
    v_dot2_f32_bf16 v180, v32, s50, v180
    v_dot2_f32_bf16 v184, v32, v32, v184
    v_dot2_f32_bf16 v180, v33, s50, v180
    v_dot2_f32_bf16 v184, v33, v33, v184
    v_dot2_f32_bf16 v180, v34, s50, v180
    v_dot2_f32_bf16 v184, v34, v34, v184
    v_dot2_f32_bf16 v180, v35, s50, v180
    v_dot2_f32_bf16 v184, v35, v35, v184
    s_waitcnt vmcnt(14)
    v_dot2_f32_bf16 v181, v36, s50, v181
    v_dot2_f32_bf16 v185, v36, v36, v185
    v_dot2_f32_bf16 v181, v37, s50, v181
    v_dot2_f32_bf16 v185, v37, v37, v185
    v_dot2_f32_bf16 v181, v38, s50, v181
    v_dot2_f32_bf16 v185, v38, v38, v185
    v_dot2_f32_bf16 v181, v39, s50, v181
    v_dot2_f32_bf16 v185, v39, v39, v185
    s_waitcnt vmcnt(13)
    v_dot2_f32_bf16 v181, v40, s50, v181
    v_dot2_f32_bf16 v185, v40, v40, v185
    v_dot2_f32_bf16 v181, v41, s50, v181
    v_dot2_f32_bf16 v185, v41, v41, v185
    v_dot2_f32_bf16 v181, v42, s50, v181
    v_dot2_f32_bf16 v185, v42, v42, v185
    v_dot2_f32_bf16 v181, v43, s50, v181
    v_dot2_f32_bf16 v185, v43, v43, v185
    s_waitcnt vmcnt(12)
    v_dot2_f32_bf16 v181, v44, s50, v181
    v_dot2_f32_bf16 v185, v44, v44, v185
    v_dot2_f32_bf16 v181, v45, s50, v181
    v_dot2_f32_bf16 v185, v45, v45, v185
    v_dot2_f32_bf16 v181, v46, s50, v181
    v_dot2_f32_bf16 v185, v46, v46, v185
    v_dot2_f32_bf16 v181, v47, s50, v181
    v_dot2_f32_bf16 v185, v47, v47, v185
    s_waitcnt vmcnt(11)
    v_dot2_f32_bf16 v181, v48, s50, v181
    v_dot2_f32_bf16 v185, v48, v48, v185
    v_dot2_f32_bf16 v181, v49, s50, v181
    v_dot2_f32_bf16 v185, v49, v49, v185
    v_dot2_f32_bf16 v181, v50, s50, v181
    v_dot2_f32_bf16 v185, v50, v50, v185
    v_dot2_f32_bf16 v181, v51, s50, v181
    v_dot2_f32_bf16 v185, v51, v51, v185
    s_waitcnt vmcnt(10)
    v_dot2_f32_bf16 v181, v52, s50, v181
    v_dot2_f32_bf16 v185, v52, v52, v185
    v_dot2_f32_bf16 v181, v53, s50, v181
    v_dot2_f32_bf16 v185, v53, v53, v185
    v_dot2_f32_bf16 v181, v54, s50, v181
    v_dot2_f32_bf16 v185, v54, v54, v185
    v_dot2_f32_bf16 v181, v55, s50, v181
    v_dot2_f32_bf16 v185, v55, v55, v185
    s_waitcnt vmcnt(9)
    v_dot2_f32_bf16 v182, v56, s50, v182
    v_dot2_f32_bf16 v186, v56, v56, v186
    v_dot2_f32_bf16 v182, v57, s50, v182
    v_dot2_f32_bf16 v186, v57, v57, v186
    v_dot2_f32_bf16 v182, v58, s50, v182
    v_dot2_f32_bf16 v186, v58, v58, v186
    v_dot2_f32_bf16 v182, v59, s50, v182
    v_dot2_f32_bf16 v186, v59, v59, v186
    s_waitcnt vmcnt(8)
    v_dot2_f32_bf16 v182, v60, s50, v182
    v_dot2_f32_bf16 v186, v60, v60, v186
    v_dot2_f32_bf16 v182, v61, s50, v182
    v_dot2_f32_bf16 v186, v61, v61, v186
    v_dot2_f32_bf16 v182, v62, s50, v182
    v_dot2_f32_bf16 v186, v62, v62, v186
    v_dot2_f32_bf16 v182, v63, s50, v182
    v_dot2_f32_bf16 v186, v63, v63, v186
    s_waitcnt vmcnt(7)
    v_dot2_f32_bf16 v182, v64, s50, v182
    v_dot2_f32_bf16 v186, v64, v64, v186
    v_dot2_f32_bf16 v182, v65, s50, v182
    v_dot2_f32_bf16 v186, v65, v65, v186
    v_dot2_f32_bf16 v182, v66, s50, v182
    v_dot2_f32_bf16 v186, v66, v66, v186
    v_dot2_f32_bf16 v182, v67, s50, v182
    v_dot2_f32_bf16 v186, v67, v67, v186
    s_waitcnt vmcnt(6)
    v_dot2_f32_bf16 v182, v68, s50, v182
    v_dot2_f32_bf16 v186, v68, v68, v186
    v_dot2_f32_bf16 v182, v69, s50, v182
    v_dot2_f32_bf16 v186, v69, v69, v186
    v_dot2_f32_bf16 v182, v70, s50, v182
    v_dot2_f32_bf16 v186, v70, v70, v186
    v_dot2_f32_bf16 v182, v71, s50, v182
    v_dot2_f32_bf16 v186, v71, v71, v186
    s_waitcnt vmcnt(5)
    v_dot2_f32_bf16 v182, v72, s50, v182
    v_dot2_f32_bf16 v186, v72, v72, v186
    v_dot2_f32_bf16 v182, v73, s50, v182
    v_dot2_f32_bf16 v186, v73, v73, v186
    v_dot2_f32_bf16 v182, v74, s50, v182
    v_dot2_f32_bf16 v186, v74, v74, v186
    v_dot2_f32_bf16 v182, v75, s50, v182
    v_dot2_f32_bf16 v186, v75, v75, v186
    s_waitcnt vmcnt(4)
    v_dot2_f32_bf16 v183, v76, s50, v183
    v_dot2_f32_bf16 v187, v76, v76, v187
    v_dot2_f32_bf16 v183, v77, s50, v183
    v_dot2_f32_bf16 v187, v77, v77, v187
    v_dot2_f32_bf16 v183, v78, s50, v183
    v_dot2_f32_bf16 v187, v78, v78, v187
    v_dot2_f32_bf16 v183, v79, s50, v183
    v_dot2_f32_bf16 v187, v79, v79, v187
    s_waitcnt vmcnt(3)
    v_dot2_f32_bf16 v183, v80, s50, v183
    v_dot2_f32_bf16 v187, v80, v80, v187
    v_dot2_f32_bf16 v183, v81, s50, v183
    v_dot2_f32_bf16 v187, v81, v81, v187
    v_dot2_f32_bf16 v183, v82, s50, v183
    v_dot2_f32_bf16 v187, v82, v82, v187
    v_dot2_f32_bf16 v183, v83, s50, v183
    v_dot2_f32_bf16 v187, v83, v83, v187
    s_waitcnt vmcnt(2)
    v_dot2_f32_bf16 v183, v84, s50, v183
    v_dot2_f32_bf16 v187, v84, v84, v187
    v_dot2_f32_bf16 v183, v85, s50, v183
    v_dot2_f32_bf16 v187, v85, v85, v187
    v_dot2_f32_bf16 v183, v86, s50, v183
    v_dot2_f32_bf16 v187, v86, v86, v187
    v_dot2_f32_bf16 v183, v87, s50, v183
    v_dot2_f32_bf16 v187, v87, v87, v187
    s_waitcnt vmcnt(1)
    v_dot2_f32_bf16 v183, v88, s50, v183
    v_dot2_f32_bf16 v187, v88, v88, v187
    v_dot2_f32_bf16 v183, v89, s50, v183
    v_dot2_f32_bf16 v187, v89, v89, v187
    v_dot2_f32_bf16 v183, v90, s50, v183
    v_dot2_f32_bf16 v187, v90, v90, v187
    v_dot2_f32_bf16 v183, v91, s50, v183
    v_dot2_f32_bf16 v187, v91, v91, v187
    s_waitcnt vmcnt(0)
    v_dot2_f32_bf16 v183, v92, s50, v183
    v_dot2_f32_bf16 v187, v92, v92, v187
    v_dot2_f32_bf16 v183, v93, s50, v183
    v_dot2_f32_bf16 v187, v93, v93, v187
    v_dot2_f32_bf16 v183, v94, s50, v183
    v_dot2_f32_bf16 v187, v94, v94, v187
    v_dot2_f32_bf16 v183, v95, s50, v183
    v_dot2_f32_bf16 v187, v95, v95, v187
    s_nop 2
    v_add_f32_dpp v180, v180, v180 row_ror:8 row_mask:0xf bank_mask:0xf
    v_add_f32_dpp v181, v181, v181 row_ror:8 row_mask:0xf bank_mask:0xf
    v_add_f32_dpp v182, v182, v182 row_ror:8 row_mask:0xf bank_mask:0xf
    v_add_f32_dpp v183, v183, v183 row_ror:8 row_mask:0xf bank_mask:0xf
    v_add_f32_dpp v184, v184, v184 row_ror:8 row_mask:0xf bank_mask:0xf
    v_add_f32_dpp v185, v185, v185 row_ror:8 row_mask:0xf bank_mask:0xf
    v_add_f32_dpp v186, v186, v186 row_ror:8 row_mask:0xf bank_mask:0xf
    v_add_f32_dpp v187, v187, v187 row_ror:8 row_mask:0xf bank_mask:0xf
    v_add_f32_dpp v180, v180, v180 row_ror:4 row_mask:0xf bank_mask:0xf
    v_add_f32_dpp v181, v181, v181 row_ror:4 row_mask:0xf bank_mask:0xf
    v_add_f32_dpp v182, v182, v182 row_ror:4 row_mask:0xf bank_mask:0xf
    v_add_f32_dpp v183, v183, v183 row_ror:4 row_mask:0xf bank_mask:0xf
    v_add_f32_dpp v184, v184, v184 row_ror:4 row_mask:0xf bank_mask:0xf
    v_add_f32_dpp v185, v185, v185 row_ror:4 row_mask:0xf bank_mask:0xf
    v_add_f32_dpp v186, v186, v186 row_ror:4 row_mask:0xf bank_mask:0xf
    v_add_f32_dpp v187, v187, v187 row_ror:4 row_mask:0xf bank_mask:0xf
    v_add_f32_dpp v180, v180, v180 row_ror:2 row_mask:0xf bank_mask:0xf
    v_add_f32_dpp v181, v181, v181 row_ror:2 row_mask:0xf bank_mask:0xf
    v_add_f32_dpp v182, v182, v182 row_ror:2 row_mask:0xf bank_mask:0xf
    v_add_f32_dpp v183, v183, v183 row_ror:2 row_mask:0xf bank_mask:0xf
    v_add_f32_dpp v184, v184, v184 row_ror:2 row_mask:0xf bank_mask:0xf
    v_add_f32_dpp v185, v185, v185 row_ror:2 row_mask:0xf bank_mask:0xf
    v_add_f32_dpp v186, v186, v186 row_ror:2 row_mask:0xf bank_mask:0xf
    v_add_f32_dpp v187, v187, v187 row_ror:2 row_mask:0xf bank_mask:0xf
    v_add_f32_dpp v180, v180, v180 row_ror:1 row_mask:0xf bank_mask:0xf
    v_add_f32_dpp v181, v181, v181 row_ror:1 row_mask:0xf bank_mask:0xf
    v_add_f32_dpp v182, v182, v182 row_ror:1 row_mask:0xf bank_mask:0xf
    v_add_f32_dpp v183, v183, v183 row_ror:1 row_mask:0xf bank_mask:0xf
    v_add_f32_dpp v184, v184, v184 row_ror:1 row_mask:0xf bank_mask:0xf
    v_add_f32_dpp v185, v185, v185 row_ror:1 row_mask:0xf bank_mask:0xf
    v_add_f32_dpp v186, v186, v186 row_ror:1 row_mask:0xf bank_mask:0xf
    v_add_f32_dpp v187, v187, v187 row_ror:1 row_mask:0xf bank_mask:0xf
    v_and_b32 v3, 15, v1
    v_cmp_eq_u32 vcc, 1, v3
    s_nop 1
    v_cndmask_b32 v180, v180, v181, vcc
    v_cndmask_b32 v184, v184, v185, vcc
    v_cmp_eq_u32 vcc, 2, v3
    s_nop 1
    v_cndmask_b32 v180, v180, v182, vcc
    v_cndmask_b32 v184, v184, v186, vcc
    v_cmp_eq_u32 vcc, 3, v3
    s_nop 1
    v_cndmask_b32 v180, v180, v183, vcc
    v_cndmask_b32 v184, v184, v187, vcc
    v_mul_f32 v180, 0x3acccccd, v180
    v_mul_f32 v190, v180, v180
    v_mov_b32 v188, 0x3acccccd
    v_fma_f32 v184, v184, v188, -v190
    v_max_f32 v184, 0, v184
    v_add_f32 v184, 0x3727c5ac, v184
    v_rsq_f32 v188, v184
    s_nop 0
    v_mul_f32_e64 v189, -v180, v188
    v_lshrrev_b32 v2, 4, v1
    v_lshl_add_u32 v2, v3, 2, v2
    v_lshlrev_b32 v2, 2, v2
    s_lshl_b32 s50, s77, 2
    s_add_u32 s50, s50, s3
    s_lshl_b32 s50, s50, 6
    s_add_u32 s50, s50, 23068672
    s_cmp_lt_u32 s77, 32
    s_cselect_b32 s50, s50, 268435456
    s_add_u32 s51, s50, 8192
    s_mov_b32 exec_lo, 0x000f000f
    s_mov_b32 exec_hi, 0x000f000f
    buffer_store_dword v188, v2, s[36:39], s50 offen sc1
    buffer_store_dword v189, v2, s[36:39], s51 offen sc1
    s_mov_b64 exec, -1
    s_waitcnt vmcnt(0) lgkmcnt(0)
    s_barrier
    v_readfirstlane_b32 s48, v246
    s_mul_i32 s48, s48, 0x9E3779B1
    s_add_u32 s48, s48, 0x7F4A7C15
    s_cmp_eq_u32 s3, 0
    s_cbranch_scc0 L_wf15
    s_lshl_b32 s54, s77, 7
    s_add_u32 s54, s54, 23220224
    v_mov_b32 v2, 0
    v_mov_b32 v3, s48
    s_mov_b64 exec, 1
    buffer_store_dword v3, v2, s[36:39], s54 offen sc1
    s_mov_b64 exec, -1
L_wf15:
L_p_w:
    s_mov_b32 s56, s22
    s_mov_b32 s57, s23
    s_mov_b32 s58, 0x1e0000
    s_mov_b32 s59, 0x20000
    s_and_b32 s50, s3, 1
    s_mul_i32 s61, s50, 3104
    s_mul_i32 s50, s50, 12288
    s_mul_i32 s64, s73, 192
    s_add_u32 s64, s64, s50
    s_mul_i32 s50, s34, 98304
    s_add_u32 s64, s64, s50
    s_cmp_ge_u32 s3, 2
    s_cselect_b32 s40, s20, s18
    s_cselect_b32 s41, s21, s19
    s_cselect_b32 s50, 6224, 0
    s_add_u32 s61, s61, s50
    s_mov_b32 s42, 1966080
    s_mov_b32 s43, 0x20000
    v_add_u32 v2, 0, v1
    v_mul_u32_u24 v3, 171, v2
    v_lshrrev_b32 v3, 11, v3
    v_mul_u32_u24 v4, 12, v3
    v_sub_u32 v4, v2, v4
    v_and_b32 v2, 12, v3
    v_add_u32 v3, v3, v2
    v_mul_u32_u24 v3, 3072, v3
    v_lshl_add_u32 v230, v4, 4, v3
    v_add_u32 v2, 64, v1
    v_mul_u32_u24 v3, 171, v2
    v_lshrrev_b32 v3, 11, v3
    v_mul_u32_u24 v4, 12, v3
    v_sub_u32 v4, v2, v4
    v_and_b32 v2, 12, v3
    v_add_u32 v3, v3, v2
    v_mul_u32_u24 v3, 3072, v3
    v_lshl_add_u32 v231, v4, 4, v3
    v_subrev_u32 v231, 1024, v231
    v_add_u32 v2, 128, v1
    v_mul_u32_u24 v3, 171, v2
    v_lshrrev_b32 v3, 11, v3
    v_mul_u32_u24 v4, 12, v3
    v_sub_u32 v4, v2, v4
    v_and_b32 v2, 12, v3
    v_add_u32 v3, v3, v2
    v_mul_u32_u24 v3, 3072, v3
    v_lshl_add_u32 v232, v4, 4, v3
    v_subrev_u32 v232, 2048, v232
    s_mul_i32 s50, s3, 48
    v_lshrrev_b32 v2, 5, v1
    v_bfe_u32 v3, v1, 2, 2
    v_lshl_add_u32 v2, v2, 2, v3
    v_mul_u32_u24 v2, 192, v2
    v_bfe_u32 v3, v1, 4, 1
    v_mul_u32_u24 v3, 3104, v3
    v_add3_u32 v2, v2, v3, s50
    v_and_b32 v3, 3, v1
    v_lshl_add_u32 v233, v3, 3, v2
    v_and_b32 v3, 1, v1
    v_lshl_add_u32 v2, v3, 3, v2
    v_bfe_u32 v3, v1, 1, 1
    v_mul_u32_u24 v3, 6224, v3
    v_add3_u32 v234, v2, v3, 32
    v_add_u32 v233, 8192, v233
    v_add_u32 v234, 8192, v234
    v_add_u32 v238, 49664, v233
    v_add_u32 v239, 49664, v234
    s_cmp_eq_u32 s76, 1
    s_cbranch_scc1 L_bias
    s_add_u32 m0, s61, 8192
    s_nop 0
    buffer_load_dwordx4 v230, s[40:43], s64 offen offset:0 lds
    buffer_load_dwordx4 v231, s[40:43], s64 offen offset:1024 lds
    buffer_load_dwordx4 v232, s[40:43], s64 offen offset:2048 lds
    s_add_u32 s64, s64, 98304
    s_sub_u32 s35, s64, 1966080
    s_min_u32 s64, s64, s35
    s_add_u32 m0, s61, 20608
    s_nop 0
    buffer_load_dwordx4 v230, s[40:43], s64 offen offset:0 lds
    buffer_load_dwordx4 v231, s[40:43], s64 offen offset:1024 lds
    buffer_load_dwordx4 v232, s[40:43], s64 offen offset:2048 lds
    s_add_u32 s64, s64, 98304
    s_sub_u32 s35, s64, 1966080
    s_min_u32 s64, s64, s35
    s_add_u32 m0, s61, 33024
    s_nop 0
    buffer_load_dwordx4 v230, s[40:43], s64 offen offset:0 lds
    buffer_load_dwordx4 v231, s[40:43], s64 offen offset:1024 lds
    buffer_load_dwordx4 v232, s[40:43], s64 offen offset:2048 lds
    s_add_u32 s64, s64, 98304
    s_sub_u32 s35, s64, 1966080
    s_min_u32 s64, s64, s35
    s_add_u32 m0, s61, 45440
    s_nop 0
    buffer_load_dwordx4 v230, s[40:43], s64 offen offset:0 lds
    buffer_load_dwordx4 v231, s[40:43], s64 offen offset:1024 lds
    buffer_load_dwordx4 v232, s[40:43], s64 offen offset:2048 lds
    s_add_u32 s64, s64, 98304
    s_sub_u32 s35, s64, 1966080
    s_min_u32 s64, s64, s35
    s_add_u32 m0, s61, 57856
    s_nop 0
    buffer_load_dwordx4 v230, s[40:43], s64 offen offset:0 lds
    buffer_load_dwordx4 v231, s[40:43], s64 offen offset:1024 lds
    buffer_load_dwordx4 v232, s[40:43], s64 offen offset:2048 lds
    s_add_u32 s64, s64, 98304
    s_sub_u32 s35, s64, 1966080
    s_min_u32 s64, s64, s35
    s_add_u32 m0, s61, 70272
    s_nop 0
    buffer_load_dwordx4 v230, s[40:43], s64 offen offset:0 lds
    buffer_load_dwordx4 v231, s[40:43], s64 offen offset:1024 lds
    buffer_load_dwordx4 v232, s[40:43], s64 offen offset:2048 lds
    s_add_u32 s64, s64, 98304
    s_sub_u32 s35, s64, 1966080
    s_min_u32 s64, s64, s35
    s_movk_i32 s4, 4096
    s_movk_i32 s5, 8192
    s_lshl_b32 s6, s72, 10
    s_add_u32 s6, s6, 23101440
    s_lshl_b32 s7, s73, 6
    s_add_u32 s7, s7, s6
    s_mul_i32 s8, s72, 768
    s_mul_i32 s50, s73, 12
    s_add_u32 s8, s8, s50
    s_mul_i32 s50, s3, 3
    s_add_u32 s8, s8, s50
    s_lshl_b32 s8, s8, 8
    s_add_u32 s8, s8, 16777216
    s_lshl_b32 s9, s73, 2
    s_add_u32 s9, s9, s3
    s_mul_i32 s9, s9, 384
    s_add_u32 s9, s9, 23527424
    s_mul_i32 s62, s3, 32768
    s_lshl_b32 s50, s72, 7
    s_add_u32 s62, s62, s50
    s_mul_i32 s50, s34, 131072
    s_add_u32 s10, s62, s50
    s_lshl_b32 s63, s3, 10
    s_add_u32 s11, s10, 131072
    s_sub_u32 s35, s11, 2621440
    s_min_u32 s11, s11, s35
    s_add_u32 s12, s11, 131072
    s_sub_u32 s35, s12, 2621440
    s_min_u32 s12, s12, s35
    s_add_u32 s13, s12, 131072
    s_sub_u32 s35, s13, 2621440
    s_min_u32 s13, s13, s35
    s_add_u32 s14, s13, 131072
    s_sub_u32 s35, s14, 2621440
    s_min_u32 s14, s14, s35
    s_add_u32 s15, s14, 131072
    s_sub_u32 s35, s15, 2621440
    s_min_u32 s15, s15, s35
    s_add_u32 s18, s15, 131072
    s_sub_u32 s35, s18, 2621440
    s_min_u32 s18, s18, s35
    s_add_u32 s19, s18, 131072
    s_sub_u32 s35, s19, 2621440
    s_min_u32 s19, s19, s35
    s_add_u32 s20, s19, 131072
    s_sub_u32 s35, s20, 2621440
    s_min_u32 s20, s20, s35
    s_add_u32 s21, s20, 131072
    s_sub_u32 s35, s21, 2621440
    s_min_u32 s21, s21, s35
    s_add_u32 s22, s21, 131072
    s_sub_u32 s35, s22, 2621440
    s_min_u32 s22, s22, s35
    s_add_u32 s23, s22, 131072
    s_sub_u32 s35, s23, 2621440
    s_min_u32 s23, s23, s35
    s_add_u32 s24, s23, 131072
    s_sub_u32 s35, s24, 2621440
    s_min_u32 s24, s24, s35
    s_add_u32 s25, s24, 131072
    s_sub_u32 s35, s25, 2621440
    s_min_u32 s25, s25, s35
    s_add_u32 s26, s25, 131072
    s_sub_u32 s35, s26, 2621440
    s_min_u32 s26, s26, s35
    s_add_u32 s27, s26, 131072
    s_sub_u32 s35, s27, 2621440
    s_min_u32 s27, s27, s35
    s_add_u32 s44, s27, 131072
    s_sub_u32 s35, s44, 2621440
    s_min_u32 s44, s44, s35
    s_add_u32 s45, s44, 131072
    s_sub_u32 s35, s45, 2621440
    s_min_u32 s45, s45, s35
    s_add_u32 s46, s45, 131072
    s_sub_u32 s35, s46, 2621440
    s_min_u32 s46, s46, s35
    s_add_u32 s47, s46, 131072
    s_sub_u32 s35, s47, 2621440
    s_min_u32 s47, s47, s35
    v_lshrrev_b32 v2, 3, v1
    v_bfe_u32 v3, v1, 4, 2
    v_lshlrev_b32 v3, 1, v3
    v_xor_b32 v3, v3, v1
    v_and_b32 v3, 7, v3
    v_mul_u32_u24 v2, 4096, v2
    v_lshl_add_u32 v172, v3, 4, v2
    v_add_u32 v172, 0, v172
    v_lshrrev_b32 v2, 2, v1
    v_lshlrev_b32 v2, 7, v2
    v_and_b32 v3, 3, v1
    v_lshl_add_u32 v2, v3, 3, v2
    v_bfe_u32 v3, v1, 3, 2
    v_xor_b32 v168, 0, v3
    v_lshl_add_u32 v168, v168, 5, v2
    v_xor_b32 v169, 1, v3
    v_lshl_add_u32 v169, v169, 5, v2
    v_xor_b32 v170, 2, v3
    v_lshl_add_u32 v170, v170, 5, v2
    v_xor_b32 v171, 3, v3
    v_lshl_add_u32 v171, v171, 5, v2
    v_and_b32 v175, 15, v1
    v_lshlrev_b32 v175, 4, v175
    v_bfe_u32 v2, v1, 4, 1
    v_lshrrev_b32 v3, 5, v1
    v_mul_u32_u24 v173, 49152, v2
    v_lshl_add_u32 v173, v3, 8, v173
    v_add_u32 v173, v173, v175
    v_lshl_add_u32 v2, v2, 1, v3
    v_mul_u32_u24 v174, 49152, v2
    v_add_u32 v174, v174, v175
    v_bfe_u32 v2, v0, 1, 2
    v_lshlrev_b32 v2, 1, v2
    s_lshr_b32 s50, s73, 1
    v_xor_b32 v2, s50, v2
    v_lshlrev_b32 v2, 4, v2
    v_lshl_add_u32 v216, v0, 7, v2
    s_and_b32 s50, s73, 1
    s_lshl_b32 s50, s50, 3
    v_add_u32 v216, s50, v216
    v_add_u32 v217, 0x8000, v216
    v_add_u32 v218, 0x10000, v216
    v_cmp_gt_u32 vcc, 128, v0
    s_nop 1
    v_cndmask_b32 v218, v217, v218, vcc
    s_lshl_b32 s50, s3, 10
    v_add_u32 v175, s50, v175
    v_lshrrev_b32 v2, 1, v1
    v_lshlrev_b32 v2, 10, v2
    v_and_b32 v3, 1, v1
    v_lshl_add_u32 v219, v3, 7, v2
    s_lshl_b32 s50, s3, 8
    s_add_u32 s50, s50, 46080
    v_add_u32 v219, s50, v219
    s_add_u32 s50, s50, 19456
    v_mov_b32 v2, s50
    v_cmp_lt_u32 vcc, 39, v1
    s_nop 1
    v_cndmask_b32 v219, v219, v2, vcc
    s_mov_b32 s17, 23199744
    s_lshl_b32 s62, s75, 2
    s_add_u32 s62, s62, s3
    s_mul_i32 s62, s62, 61440
    s_add_u32 s62, s62, 14417920
    s_waitcnt vmcnt(12)
    s_barrier
    s_cmp_eq_u32 s3, 0
    s_cbranch_scc0 L_wf16
    s_lshl_b32 s54, s77, 7
    s_add_u32 s54, s54, 23220224
    v_mov_b32 v2, 0
    v_mov_b32 v3, s48
    s_mov_b64 exec, 1
    buffer_store_dword v3, v2, s[36:39], s54 offen sc1
    s_mov_b64 exec, -1
L_wf16:
    s_cmp_eq_u32 s3, 0
    s_cbranch_scc0 L_wf17
    s_lshl_b32 s54, s71, 7
    s_add_u32 s54, s54, 23354368
    v_mov_b32 v2, 0
    v_mov_b32 v3, s48
    s_mov_b64 exec, 1
    buffer_store_dword v3, v2, s[36:39], s54 offen sc1
    s_mov_b64 exec, -1
L_wf17:
    ds_read_b64_tr_b16 a[0:1], v233 offset:0
    ds_read_b64_tr_b16 a[2:3], v233 offset:1536
    ds_read_b64_tr_b16 a[4:5], v233 offset:6224
    ds_read_b64_tr_b16 a[6:7], v233 offset:7760
    ds_read_b64_tr_b16 a[8:9], v234 offset:0
    ds_read_b64_tr_b16 a[10:11], v234 offset:1536
    ds_read_b64_tr_b16 a[12:13], v233 offset:12416
    ds_read_b64_tr_b16 a[14:15], v233 offset:13952
    ds_read_b64_tr_b16 a[16:17], v233 offset:18640
    ds_read_b64_tr_b16 a[18:19], v233 offset:20176
    ds_read_b64_tr_b16 a[20:21], v234 offset:12416
    ds_read_b64_tr_b16 a[22:23], v234 offset:13952
    s_add_u32 m0, s61, 82688
    s_nop 0
    buffer_load_dwordx4 v230, s[40:43], s64 offen offset:0 lds
    buffer_load_dwordx4 v231, s[40:43], s64 offen offset:1024 lds
    buffer_load_dwordx4 v232, s[40:43], s64 offen offset:2048 lds
    s_add_u32 s64, s64, 98304
    s_sub_u32 s35, s64, 1966080
    s_min_u32 s64, s64, s35
    s_add_u32 m0, s61, 95104
    s_nop 0
    buffer_load_dwordx4 v230, s[40:43], s64 offen offset:0 lds
    buffer_load_dwordx4 v231, s[40:43], s64 offen offset:1024 lds
    buffer_load_dwordx4 v232, s[40:43], s64 offen offset:2048 lds
    s_add_u32 s64, s64, 98304
    s_sub_u32 s35, s64, 1966080
    s_min_u32 s64, s64, s35
    s_waitcnt vmcnt(12)
    s_waitcnt lgkmcnt(0)
    s_barrier
    ds_read_b64_tr_b16 a[24:25], v233 offset:24832
    ds_read_b64_tr_b16 a[26:27], v233 offset:26368
    ds_read_b64_tr_b16 a[28:29], v233 offset:31056
    ds_read_b64_tr_b16 a[30:31], v233 offset:32592
    ds_read_b64_tr_b16 a[32:33], v234 offset:24832
    ds_read_b64_tr_b16 a[34:35], v234 offset:26368
    ds_read_b64_tr_b16 a[36:37], v233 offset:37248
    ds_read_b64_tr_b16 a[38:39], v233 offset:38784
    ds_read_b64_tr_b16 a[40:41], v233 offset:43472
    ds_read_b64_tr_b16 a[42:43], v233 offset:45008
    ds_read_b64_tr_b16 a[44:45], v234 offset:37248
    ds_read_b64_tr_b16 a[46:47], v234 offset:38784
    s_add_u32 m0, s61, 8192
    s_nop 0
    buffer_load_dwordx4 v230, s[40:43], s64 offen offset:0 lds
    buffer_load_dwordx4 v231, s[40:43], s64 offen offset:1024 lds
    buffer_load_dwordx4 v232, s[40:43], s64 offen offset:2048 lds
    s_add_u32 s64, s64, 98304
    s_sub_u32 s35, s64, 1966080
    s_min_u32 s64, s64, s35
    s_add_u32 m0, s61, 20608
    s_nop 0
    buffer_load_dwordx4 v230, s[40:43], s64 offen offset:0 lds
    buffer_load_dwordx4 v231, s[40:43], s64 offen offset:1024 lds
    buffer_load_dwordx4 v232, s[40:43], s64 offen offset:2048 lds
    s_add_u32 s64, s64, 98304
    s_sub_u32 s35, s64, 1966080
    s_min_u32 s64, s64, s35
    s_waitcnt vmcnt(12)
    s_waitcnt lgkmcnt(0)
    s_barrier
    ds_read_b64_tr_b16 a[48:49], v238 offset:0
    ds_read_b64_tr_b16 a[50:51], v238 offset:1536
    ds_read_b64_tr_b16 a[52:53], v238 offset:6224
    ds_read_b64_tr_b16 a[54:55], v238 offset:7760
    ds_read_b64_tr_b16 a[56:57], v239 offset:0
    ds_read_b64_tr_b16 a[58:59], v239 offset:1536
    ds_read_b64_tr_b16 a[60:61], v238 offset:12416
    ds_read_b64_tr_b16 a[62:63], v238 offset:13952
    ds_read_b64_tr_b16 a[64:65], v238 offset:18640
    ds_read_b64_tr_b16 a[66:67], v238 offset:20176
    ds_read_b64_tr_b16 a[68:69], v239 offset:12416
    ds_read_b64_tr_b16 a[70:71], v239 offset:13952
    s_add_u32 m0, s61, 33024
    s_nop 0
    buffer_load_dwordx4 v230, s[40:43], s64 offen offset:0 lds
    buffer_load_dwordx4 v231, s[40:43], s64 offen offset:1024 lds
    buffer_load_dwordx4 v232, s[40:43], s64 offen offset:2048 lds
    s_add_u32 s64, s64, 98304
    s_sub_u32 s35, s64, 1966080
    s_min_u32 s64, s64, s35
    s_add_u32 m0, s61, 45440
    s_nop 0
    buffer_load_dwordx4 v230, s[40:43], s64 offen offset:0 lds
    buffer_load_dwordx4 v231, s[40:43], s64 offen offset:1024 lds
    buffer_load_dwordx4 v232, s[40:43], s64 offen offset:2048 lds
    s_add_u32 s64, s64, 98304
    s_sub_u32 s35, s64, 1966080
    s_min_u32 s64, s64, s35
    s_waitcnt vmcnt(12)
    s_waitcnt lgkmcnt(0)
    s_barrier
    ds_read_b64_tr_b16 a[72:73], v238 offset:24832
    ds_read_b64_tr_b16 a[74:75], v238 offset:26368
    ds_read_b64_tr_b16 a[76:77], v238 offset:31056
    ds_read_b64_tr_b16 a[78:79], v238 offset:32592
    ds_read_b64_tr_b16 a[80:81], v239 offset:24832
    ds_read_b64_tr_b16 a[82:83], v239 offset:26368
    ds_read_b64_tr_b16 a[84:85], v238 offset:37248
    ds_read_b64_tr_b16 a[86:87], v238 offset:38784
    ds_read_b64_tr_b16 a[88:89], v238 offset:43472
    ds_read_b64_tr_b16 a[90:91], v238 offset:45008
    ds_read_b64_tr_b16 a[92:93], v239 offset:37248
    ds_read_b64_tr_b16 a[94:95], v239 offset:38784
    s_add_u32 m0, s61, 57856
    s_nop 0
    buffer_load_dwordx4 v230, s[40:43], s64 offen offset:0 lds
    buffer_load_dwordx4 v231, s[40:43], s64 offen offset:1024 lds
    buffer_load_dwordx4 v232, s[40:43], s64 offen offset:2048 lds
    s_add_u32 s64, s64, 98304
    s_sub_u32 s35, s64, 1966080
    s_min_u32 s64, s64, s35
    s_add_u32 m0, s61, 70272
    s_nop 0
    buffer_load_dwordx4 v230, s[40:43], s64 offen offset:0 lds
    buffer_load_dwordx4 v231, s[40:43], s64 offen offset:1024 lds
    buffer_load_dwordx4 v232, s[40:43], s64 offen offset:2048 lds
    s_add_u32 s64, s64, 98304
    s_sub_u32 s35, s64, 1966080
    s_min_u32 s64, s64, s35
    s_waitcnt vmcnt(12)
    s_waitcnt lgkmcnt(0)
    s_barrier
    ds_read_b64_tr_b16 a[96:97], v233 offset:0
    ds_read_b64_tr_b16 a[98:99], v233 offset:1536
    ds_read_b64_tr_b16 a[100:101], v233 offset:6224
    ds_read_b64_tr_b16 a[102:103], v233 offset:7760
    ds_read_b64_tr_b16 a[104:105], v234 offset:0
    ds_read_b64_tr_b16 a[106:107], v234 offset:1536
    ds_read_b64_tr_b16 a[108:109], v233 offset:12416
    ds_read_b64_tr_b16 a[110:111], v233 offset:13952
    ds_read_b64_tr_b16 a[112:113], v233 offset:18640
    ds_read_b64_tr_b16 a[114:115], v233 offset:20176
    ds_read_b64_tr_b16 a[116:117], v234 offset:12416
    ds_read_b64_tr_b16 a[118:119], v234 offset:13952
    s_add_u32 m0, s61, 82688
    s_nop 0
    buffer_load_dwordx4 v230, s[40:43], s64 offen offset:0 lds
    buffer_load_dwordx4 v231, s[40:43], s64 offen offset:1024 lds
    buffer_load_dwordx4 v232, s[40:43], s64 offen offset:2048 lds
    s_add_u32 s64, s64, 98304
    s_sub_u32 s35, s64, 1966080
    s_min_u32 s64, s64, s35
    s_lshr_b32 s52, s71, 1
    s_lshl_b32 s52, s52, 2
    s_add_u32 s52, s52, s3
    s_mul_i32 s52, s52, 10240
    s_and_b32 s53, s71, 1
    s_mul_i32 s53, s53, 640
    s_add_u32 s52, s52, s53
    s_mul_i32 s53, s3, 5120
    v_add_u32 v5, 0, v1
    v_mul_u32_u24 v6, 205, v5
    v_lshrrev_b32 v6, 13, v6
    v_mul_u32_u24 v6, 640, v6
    v_lshl_add_u32 v5, v5, 4, v6
    s_add_u32 m0, s53, 107520
    s_nop 0
    buffer_load_dwordx4 v5, s[56:59], s52 offen nt lds
    v_add_u32 v5, 64, v1
    v_mul_u32_u24 v6, 205, v5
    v_lshrrev_b32 v6, 13, v6
    v_mul_u32_u24 v6, 640, v6
    v_lshl_add_u32 v5, v5, 4, v6
    s_add_u32 m0, s53, 108544
    s_nop 0
    buffer_load_dwordx4 v5, s[56:59], s52 offen nt lds
    v_add_u32 v5, 128, v1
    v_mul_u32_u24 v6, 205, v5
    v_lshrrev_b32 v6, 13, v6
    v_mul_u32_u24 v6, 640, v6
    v_lshl_add_u32 v5, v5, 4, v6
    s_add_u32 m0, s53, 109568
    s_nop 0
    buffer_load_dwordx4 v5, s[56:59], s52 offen nt lds
    v_add_u32 v5, 192, v1
    v_mul_u32_u24 v6, 205, v5
    v_lshrrev_b32 v6, 13, v6
    v_mul_u32_u24 v6, 640, v6
    v_lshl_add_u32 v5, v5, 4, v6
    s_add_u32 m0, s53, 110592
    s_nop 0
    buffer_load_dwordx4 v5, s[56:59], s52 offen nt lds
    v_add_u32 v5, 256, v1
    v_mul_u32_u24 v6, 205, v5
    v_lshrrev_b32 v6, 13, v6
    v_mul_u32_u24 v6, 640, v6
    v_lshl_add_u32 v5, v5, 4, v6
    s_add_u32 m0, s53, 111616
    s_nop 0
    buffer_load_dwordx4 v5, s[56:59], s52 offen nt lds
    s_waitcnt vmcnt(14)
    s_waitcnt lgkmcnt(0)
    s_barrier
    ds_read_b64_tr_b16 a[120:121], v233 offset:24832
    ds_read_b64_tr_b16 a[122:123], v233 offset:26368
    ds_read_b64_tr_b16 a[124:125], v233 offset:31056
    ds_read_b64_tr_b16 a[126:127], v233 offset:32592
    ds_read_b64_tr_b16 a[128:129], v234 offset:24832
    ds_read_b64_tr_b16 a[130:131], v234 offset:26368
    ds_read_b64_tr_b16 a[132:133], v233 offset:37248
    ds_read_b64_tr_b16 a[134:135], v233 offset:38784
    ds_read_b64_tr_b16 a[136:137], v233 offset:43472
    ds_read_b64_tr_b16 a[138:139], v233 offset:45008
    ds_read_b64_tr_b16 a[140:141], v234 offset:37248
    ds_read_b64_tr_b16 a[142:143], v234 offset:38784
    s_waitcnt vmcnt(8)
    s_waitcnt lgkmcnt(0)
    s_barrier
    ds_read_b64_tr_b16 a[144:145], v238 offset:0
    ds_read_b64_tr_b16 a[146:147], v238 offset:1536
    ds_read_b64_tr_b16 a[148:149], v238 offset:6224
    ds_read_b64_tr_b16 a[150:151], v238 offset:7760
    ds_read_b64_tr_b16 a[152:153], v239 offset:0
    ds_read_b64_tr_b16 a[154:155], v239 offset:1536
    ds_read_b64_tr_b16 a[156:157], v238 offset:12416
    ds_read_b64_tr_b16 a[158:159], v238 offset:13952
    ds_read_b64_tr_b16 a[160:161], v238 offset:18640
    ds_read_b64_tr_b16 a[162:163], v238 offset:20176
    ds_read_b64_tr_b16 a[164:165], v239 offset:12416
    ds_read_b64_tr_b16 a[166:167], v239 offset:13952
    s_waitcnt vmcnt(5)
    s_waitcnt lgkmcnt(0)
    s_barrier
    ds_read_b64_tr_b16 a[168:169], v238 offset:24832
    ds_read_b64_tr_b16 a[170:171], v238 offset:26368
    ds_read_b64_tr_b16 a[172:173], v238 offset:31056
    ds_read_b64_tr_b16 a[174:175], v238 offset:32592
    ds_read_b64_tr_b16 a[176:177], v239 offset:24832
    ds_read_b64_tr_b16 a[178:179], v239 offset:26368
    s_waitcnt vmcnt(0)
    s_waitcnt lgkmcnt(0)
    s_barrier
    v_lshrrev_b32 v2, 4, v1
    v_bfe_u32 v3, v1, 2, 2
    v_lshl_add_u32 v3, v2, 3, v3
    v_mul_u32_u24 v3, 640, v3
    v_and_b32 v2, 3, v1
    v_lshl_add_u32 v2, v2, 3, v3
    s_mul_i32 s50, s3, 160
    s_add_u32 s50, s50, 107520
    v_add_u32 v2, s50, v2
    s_lshr_b32 s53, s71, 1
    s_mov_b32 s50, 0x15555556
    s_mul_hi_u32 s51, s53, s50
    s_mul_i32 s52, s51, 12
    s_sub_u32 s52, s53, s52
    s_and_b32 s50, s71, 1
    s_lshl_b32 s50, s50, 2
    s_add_u32 s50, s50, s3
    s_lshl_b32 s50, s50, 2
    s_add_u32 s50, s50, s51
    s_mul_i32 s50, s50, 60
    s_mul_i32 s52, s52, 5
    s_add_u32 s50, s50, s52
    s_lshl_b32 s50, s50, 10
    s_add_u32 s50, s50, 14417920
    s_add_u32 s51, s50, 4096
    ds_read_b64_tr_b16 v[16:17], v2 offset:0
    ds_read_b64_tr_b16 v[18:19], v2 offset:2560
    ds_read_b64_tr_b16 v[20:21], v2 offset:32
    ds_read_b64_tr_b16 v[22:23], v2 offset:2592
    ds_read_b64_tr_b16 v[24:25], v2 offset:64
    ds_read_b64_tr_b16 v[26:27], v2 offset:2624
    ds_read_b64_tr_b16 v[28:29], v2 offset:96
    ds_read_b64_tr_b16 v[30:31], v2 offset:2656
    ds_read_b64_tr_b16 v[32:33], v2 offset:128
    ds_read_b64_tr_b16 v[34:35], v2 offset:2688
    s_waitcnt lgkmcnt(8)
    buffer_store_dwordx4 v[16:19], v248, s[36:39], s50 offen offset:0 sc1
    s_waitcnt lgkmcnt(6)
    buffer_store_dwordx4 v[20:23], v248, s[36:39], s50 offen offset:1024 sc1
    s_waitcnt lgkmcnt(4)
    buffer_store_dwordx4 v[24:27], v248, s[36:39], s50 offen offset:2048 sc1
    s_waitcnt lgkmcnt(2)
    buffer_store_dwordx4 v[28:31], v248, s[36:39], s50 offen offset:3072 sc1
    s_waitcnt lgkmcnt(0)
    buffer_store_dwordx4 v[32:35], v248, s[36:39], s51 offen offset:0 sc1
    s_branch L_nobias
L_bias:
    s_add_u32 m0, s61, 8192
    s_nop 0
    buffer_load_dwordx4 v230, s[40:43], s64 offen offset:0 lds
    buffer_load_dwordx4 v231, s[40:43], s64 offen offset:1024 lds
    buffer_load_dwordx4 v232, s[40:43], s64 offen offset:2048 lds
    s_add_u32 s64, s64, 98304
    s_sub_u32 s35, s64, 1966080
    s_min_u32 s64, s64, s35
    s_add_u32 m0, s61, 20608
    s_nop 0
    buffer_load_dwordx4 v230, s[40:43], s64 offen offset:0 lds
    buffer_load_dwordx4 v231, s[40:43], s64 offen offset:1024 lds
    buffer_load_dwordx4 v232, s[40:43], s64 offen offset:2048 lds
    s_add_u32 s64, s64, 98304
    s_sub_u32 s35, s64, 1966080
    s_min_u32 s64, s64, s35
    s_add_u32 m0, s61, 33024
    s_nop 0
    buffer_load_dwordx4 v230, s[40:43], s64 offen offset:0 lds
    buffer_load_dwordx4 v231, s[40:43], s64 offen offset:1024 lds
    buffer_load_dwordx4 v232, s[40:43], s64 offen offset:2048 lds
    s_add_u32 s64, s64, 98304
    s_sub_u32 s35, s64, 1966080
    s_min_u32 s64, s64, s35
    s_add_u32 m0, s61, 45440
    s_nop 0
    buffer_load_dwordx4 v230, s[40:43], s64 offen offset:0 lds
    buffer_load_dwordx4 v231, s[40:43], s64 offen offset:1024 lds
    buffer_load_dwordx4 v232, s[40:43], s64 offen offset:2048 lds
    s_add_u32 s64, s64, 98304
    s_sub_u32 s35, s64, 1966080
    s_min_u32 s64, s64, s35
    s_add_u32 m0, s61, 57856
    s_nop 0
    buffer_load_dwordx4 v230, s[40:43], s64 offen offset:0 lds
    buffer_load_dwordx4 v231, s[40:43], s64 offen offset:1024 lds
    buffer_load_dwordx4 v232, s[40:43], s64 offen offset:2048 lds
    s_add_u32 s64, s64, 98304
    s_sub_u32 s35, s64, 1966080
    s_min_u32 s64, s64, s35
    s_add_u32 m0, s61, 70272
    s_nop 0
    buffer_load_dwordx4 v230, s[40:43], s64 offen offset:0 lds
    buffer_load_dwordx4 v231, s[40:43], s64 offen offset:1024 lds
    buffer_load_dwordx4 v232, s[40:43], s64 offen offset:2048 lds
    s_add_u32 s64, s64, 98304
    s_sub_u32 s35, s64, 1966080
    s_min_u32 s64, s64, s35
    s_movk_i32 s4, 4096
    s_movk_i32 s5, 8192
    s_lshl_b32 s6, s72, 10
    s_add_u32 s6, s6, 23101440
    s_lshl_b32 s7, s73, 6
    s_add_u32 s7, s7, s6
    s_mul_i32 s8, s72, 768
    s_mul_i32 s50, s73, 12
    s_add_u32 s8, s8, s50
    s_mul_i32 s50, s3, 3
    s_add_u32 s8, s8, s50
    s_lshl_b32 s8, s8, 8
    s_add_u32 s8, s8, 16777216
    s_lshl_b32 s9, s73, 2
    s_add_u32 s9, s9, s3
    s_mul_i32 s9, s9, 384
    s_add_u32 s9, s9, 23527424
    s_mul_i32 s62, s3, 32768
    s_lshl_b32 s50, s72, 7
    s_add_u32 s62, s62, s50
    s_mul_i32 s50, s34, 131072
    s_add_u32 s10, s62, s50
    s_lshl_b32 s63, s3, 10
    s_add_u32 s11, s10, 131072
    s_sub_u32 s35, s11, 2621440
    s_min_u32 s11, s11, s35
    s_add_u32 s12, s11, 131072
    s_sub_u32 s35, s12, 2621440
    s_min_u32 s12, s12, s35
    s_add_u32 s13, s12, 131072
    s_sub_u32 s35, s13, 2621440
    s_min_u32 s13, s13, s35
    s_add_u32 s14, s13, 131072
    s_sub_u32 s35, s14, 2621440
    s_min_u32 s14, s14, s35
    s_add_u32 s15, s14, 131072
    s_sub_u32 s35, s15, 2621440
    s_min_u32 s15, s15, s35
    s_add_u32 s18, s15, 131072
    s_sub_u32 s35, s18, 2621440
    s_min_u32 s18, s18, s35
    s_add_u32 s19, s18, 131072
    s_sub_u32 s35, s19, 2621440
    s_min_u32 s19, s19, s35
    s_add_u32 s20, s19, 131072
    s_sub_u32 s35, s20, 2621440
    s_min_u32 s20, s20, s35
    s_add_u32 s21, s20, 131072
    s_sub_u32 s35, s21, 2621440
    s_min_u32 s21, s21, s35
    s_add_u32 s22, s21, 131072
    s_sub_u32 s35, s22, 2621440
    s_min_u32 s22, s22, s35
    s_add_u32 s23, s22, 131072
    s_sub_u32 s35, s23, 2621440
    s_min_u32 s23, s23, s35
    s_add_u32 s24, s23, 131072
    s_sub_u32 s35, s24, 2621440
    s_min_u32 s24, s24, s35
    s_add_u32 s25, s24, 131072
    s_sub_u32 s35, s25, 2621440
    s_min_u32 s25, s25, s35
    s_add_u32 s26, s25, 131072
    s_sub_u32 s35, s26, 2621440
    s_min_u32 s26, s26, s35
    s_add_u32 s27, s26, 131072
    s_sub_u32 s35, s27, 2621440
    s_min_u32 s27, s27, s35
    s_add_u32 s44, s27, 131072
    s_sub_u32 s35, s44, 2621440
    s_min_u32 s44, s44, s35
    s_add_u32 s45, s44, 131072
    s_sub_u32 s35, s45, 2621440
    s_min_u32 s45, s45, s35
    s_add_u32 s46, s45, 131072
    s_sub_u32 s35, s46, 2621440
    s_min_u32 s46, s46, s35
    s_add_u32 s47, s46, 131072
    s_sub_u32 s35, s47, 2621440
    s_min_u32 s47, s47, s35
    v_lshrrev_b32 v2, 3, v1
    v_bfe_u32 v3, v1, 4, 2
    v_lshlrev_b32 v3, 1, v3
    v_xor_b32 v3, v3, v1
    v_and_b32 v3, 7, v3
    v_mul_u32_u24 v2, 4096, v2
    v_lshl_add_u32 v172, v3, 4, v2
    v_add_u32 v172, 0, v172
    v_lshrrev_b32 v2, 2, v1
    v_lshlrev_b32 v2, 7, v2
    v_and_b32 v3, 3, v1
    v_lshl_add_u32 v2, v3, 3, v2
    v_bfe_u32 v3, v1, 3, 2
    v_xor_b32 v168, 0, v3
    v_lshl_add_u32 v168, v168, 5, v2
    v_xor_b32 v169, 1, v3
    v_lshl_add_u32 v169, v169, 5, v2
    v_xor_b32 v170, 2, v3
    v_lshl_add_u32 v170, v170, 5, v2
    v_xor_b32 v171, 3, v3
    v_lshl_add_u32 v171, v171, 5, v2
    v_and_b32 v175, 15, v1
    v_lshlrev_b32 v175, 4, v175
    v_bfe_u32 v2, v1, 4, 1
    v_lshrrev_b32 v3, 5, v1
    v_mul_u32_u24 v173, 49152, v2
    v_lshl_add_u32 v173, v3, 8, v173
    v_add_u32 v173, v173, v175
    v_lshl_add_u32 v2, v2, 1, v3
    v_mul_u32_u24 v174, 49152, v2
    v_add_u32 v174, v174, v175
    v_bfe_u32 v2, v0, 1, 2
    v_lshlrev_b32 v2, 1, v2
    s_lshr_b32 s50, s73, 1
    v_xor_b32 v2, s50, v2
    v_lshlrev_b32 v2, 4, v2
    v_lshl_add_u32 v216, v0, 7, v2
    s_and_b32 s50, s73, 1
    s_lshl_b32 s50, s50, 3
    v_add_u32 v216, s50, v216
    v_add_u32 v217, 0x8000, v216
    v_add_u32 v218, 0x10000, v216
    v_cmp_gt_u32 vcc, 128, v0
    s_nop 1
    v_cndmask_b32 v218, v217, v218, vcc
    s_lshl_b32 s50, s3, 10
    v_add_u32 v175, s50, v175
    v_lshrrev_b32 v2, 1, v1
    v_lshlrev_b32 v2, 10, v2
    v_and_b32 v3, 1, v1
    v_lshl_add_u32 v219, v3, 7, v2
    s_lshl_b32 s50, s3, 8
    s_add_u32 s50, s50, 46080
    v_add_u32 v219, s50, v219
    s_add_u32 s50, s50, 19456
    v_mov_b32 v2, s50
    v_cmp_lt_u32 vcc, 39, v1
    s_nop 1
    v_cndmask_b32 v219, v219, v2, vcc
    s_mov_b32 s17, 23199744
    s_lshl_b32 s62, s75, 2
    s_add_u32 s62, s62, s3
    s_mul_i32 s62, s62, 61440
    s_add_u32 s62, s62, 14417920
    s_waitcnt vmcnt(12)
    s_barrier
    s_cmp_eq_u32 s3, 0
    s_cbranch_scc0 L_wf18
    s_lshl_b32 s54, s77, 7
    s_add_u32 s54, s54, 23220224
    v_mov_b32 v2, 0
    v_mov_b32 v3, s48
    s_mov_b64 exec, 1
    buffer_store_dword v3, v2, s[36:39], s54 offen sc1
    s_mov_b64 exec, -1
L_wf18:
    s_cmp_eq_u32 s3, 0
    s_cbranch_scc0 L_wf19
    s_lshl_b32 s54, s71, 7
    s_add_u32 s54, s54, 23354368
    v_mov_b32 v2, 0
    v_mov_b32 v3, s48
    s_mov_b64 exec, 1
    buffer_store_dword v3, v2, s[36:39], s54 offen sc1
    s_mov_b64 exec, -1
L_wf19:
    ds_read_b64_tr_b16 a[0:1], v233 offset:0
    ds_read_b64_tr_b16 a[2:3], v233 offset:1536
    ds_read_b64_tr_b16 a[4:5], v233 offset:6224
    ds_read_b64_tr_b16 a[6:7], v233 offset:7760
    ds_read_b64_tr_b16 a[8:9], v234 offset:0
    ds_read_b64_tr_b16 a[10:11], v234 offset:1536
    ds_read_b64_tr_b16 a[12:13], v233 offset:12416
    ds_read_b64_tr_b16 a[14:15], v233 offset:13952
    ds_read_b64_tr_b16 a[16:17], v233 offset:18640
    ds_read_b64_tr_b16 a[18:19], v233 offset:20176
    ds_read_b64_tr_b16 a[20:21], v234 offset:12416
    ds_read_b64_tr_b16 a[22:23], v234 offset:13952
    s_add_u32 m0, s61, 82688
    s_nop 0
    buffer_load_dwordx4 v230, s[40:43], s64 offen offset:0 lds
    buffer_load_dwordx4 v231, s[40:43], s64 offen offset:1024 lds
    buffer_load_dwordx4 v232, s[40:43], s64 offen offset:2048 lds
    s_add_u32 s64, s64, 98304
    s_sub_u32 s35, s64, 1966080
    s_min_u32 s64, s64, s35
    s_add_u32 m0, s61, 95104
    s_nop 0
    buffer_load_dwordx4 v230, s[40:43], s64 offen offset:0 lds
    buffer_load_dwordx4 v231, s[40:43], s64 offen offset:1024 lds
    buffer_load_dwordx4 v232, s[40:43], s64 offen offset:2048 lds
    s_add_u32 s64, s64, 98304
    s_sub_u32 s35, s64, 1966080
    s_min_u32 s64, s64, s35
    s_waitcnt vmcnt(12)
    s_waitcnt lgkmcnt(0)
    s_barrier
    ds_read_b64_tr_b16 a[24:25], v233 offset:24832
    ds_read_b64_tr_b16 a[26:27], v233 offset:26368
    ds_read_b64_tr_b16 a[28:29], v233 offset:31056
    ds_read_b64_tr_b16 a[30:31], v233 offset:32592
    ds_read_b64_tr_b16 a[32:33], v234 offset:24832
    ds_read_b64_tr_b16 a[34:35], v234 offset:26368
    ds_read_b64_tr_b16 a[36:37], v233 offset:37248
    ds_read_b64_tr_b16 a[38:39], v233 offset:38784
    ds_read_b64_tr_b16 a[40:41], v233 offset:43472
    ds_read_b64_tr_b16 a[42:43], v233 offset:45008
    ds_read_b64_tr_b16 a[44:45], v234 offset:37248
    ds_read_b64_tr_b16 a[46:47], v234 offset:38784
    s_add_u32 m0, s61, 8192
    s_nop 0
    buffer_load_dwordx4 v230, s[40:43], s64 offen offset:0 lds
    buffer_load_dwordx4 v231, s[40:43], s64 offen offset:1024 lds
    buffer_load_dwordx4 v232, s[40:43], s64 offen offset:2048 lds
    s_add_u32 s64, s64, 98304
    s_sub_u32 s35, s64, 1966080
    s_min_u32 s64, s64, s35
    s_add_u32 m0, s61, 20608
    s_nop 0
    buffer_load_dwordx4 v230, s[40:43], s64 offen offset:0 lds
    buffer_load_dwordx4 v231, s[40:43], s64 offen offset:1024 lds
    buffer_load_dwordx4 v232, s[40:43], s64 offen offset:2048 lds
    s_add_u32 s64, s64, 98304
    s_sub_u32 s35, s64, 1966080
    s_min_u32 s64, s64, s35
    s_waitcnt vmcnt(12)
    s_waitcnt lgkmcnt(0)
    s_barrier
    ds_read_b64_tr_b16 a[48:49], v238 offset:0
    ds_read_b64_tr_b16 a[50:51], v238 offset:1536
    ds_read_b64_tr_b16 a[52:53], v238 offset:6224
    ds_read_b64_tr_b16 a[54:55], v238 offset:7760
    ds_read_b64_tr_b16 a[56:57], v239 offset:0
    ds_read_b64_tr_b16 a[58:59], v239 offset:1536
    ds_read_b64_tr_b16 a[60:61], v238 offset:12416
    ds_read_b64_tr_b16 a[62:63], v238 offset:13952
    ds_read_b64_tr_b16 a[64:65], v238 offset:18640
    ds_read_b64_tr_b16 a[66:67], v238 offset:20176
    ds_read_b64_tr_b16 a[68:69], v239 offset:12416
    ds_read_b64_tr_b16 a[70:71], v239 offset:13952
    s_add_u32 m0, s61, 33024
    s_nop 0
    buffer_load_dwordx4 v230, s[40:43], s64 offen offset:0 lds
    buffer_load_dwordx4 v231, s[40:43], s64 offen offset:1024 lds
    buffer_load_dwordx4 v232, s[40:43], s64 offen offset:2048 lds
    s_add_u32 s64, s64, 98304
    s_sub_u32 s35, s64, 1966080
    s_min_u32 s64, s64, s35
    s_add_u32 m0, s61, 45440
    s_nop 0
    buffer_load_dwordx4 v230, s[40:43], s64 offen offset:0 lds
    buffer_load_dwordx4 v231, s[40:43], s64 offen offset:1024 lds
    buffer_load_dwordx4 v232, s[40:43], s64 offen offset:2048 lds
    s_add_u32 s64, s64, 98304
    s_sub_u32 s35, s64, 1966080
    s_min_u32 s64, s64, s35
    s_waitcnt vmcnt(12)
    s_waitcnt lgkmcnt(0)
    s_barrier
    ds_read_b64_tr_b16 a[72:73], v238 offset:24832
    ds_read_b64_tr_b16 a[74:75], v238 offset:26368
    ds_read_b64_tr_b16 a[76:77], v238 offset:31056
    ds_read_b64_tr_b16 a[78:79], v238 offset:32592
    ds_read_b64_tr_b16 a[80:81], v239 offset:24832
    ds_read_b64_tr_b16 a[82:83], v239 offset:26368
    ds_read_b64_tr_b16 a[84:85], v238 offset:37248
    ds_read_b64_tr_b16 a[86:87], v238 offset:38784
    ds_read_b64_tr_b16 a[88:89], v238 offset:43472
    ds_read_b64_tr_b16 a[90:91], v238 offset:45008
    ds_read_b64_tr_b16 a[92:93], v239 offset:37248
    ds_read_b64_tr_b16 a[94:95], v239 offset:38784
    s_add_u32 m0, s61, 57856
    s_nop 0
    buffer_load_dwordx4 v230, s[40:43], s64 offen offset:0 lds
    buffer_load_dwordx4 v231, s[40:43], s64 offen offset:1024 lds
    buffer_load_dwordx4 v232, s[40:43], s64 offen offset:2048 lds
    s_add_u32 s64, s64, 98304
    s_sub_u32 s35, s64, 1966080
    s_min_u32 s64, s64, s35
    s_add_u32 m0, s61, 70272
    s_nop 0
    buffer_load_dwordx4 v230, s[40:43], s64 offen offset:0 lds
    buffer_load_dwordx4 v231, s[40:43], s64 offen offset:1024 lds
    buffer_load_dwordx4 v232, s[40:43], s64 offen offset:2048 lds
    s_add_u32 s64, s64, 98304
    s_sub_u32 s35, s64, 1966080
    s_min_u32 s64, s64, s35
    s_mov_b32 s66, 23229184
    v_min_u32 v240, 19, v1
    v_lshlrev_b32 v240, 7, v240
    buffer_load_dword v241, v240, s[36:39], s66 offen sc1
    s_waitcnt vmcnt(13)
    s_waitcnt lgkmcnt(0)
    s_barrier
    ds_read_b64_tr_b16 a[96:97], v233 offset:0
    ds_read_b64_tr_b16 a[98:99], v233 offset:1536
    ds_read_b64_tr_b16 a[100:101], v233 offset:6224
    ds_read_b64_tr_b16 a[102:103], v233 offset:7760
    ds_read_b64_tr_b16 a[104:105], v234 offset:0
    ds_read_b64_tr_b16 a[106:107], v234 offset:1536
    ds_read_b64_tr_b16 a[108:109], v233 offset:12416
    ds_read_b64_tr_b16 a[110:111], v233 offset:13952
    ds_read_b64_tr_b16 a[112:113], v233 offset:18640
    ds_read_b64_tr_b16 a[114:115], v233 offset:20176
    ds_read_b64_tr_b16 a[116:117], v234 offset:12416
    ds_read_b64_tr_b16 a[118:119], v234 offset:13952
    s_add_u32 m0, s61, 82688
    s_nop 0
    buffer_load_dwordx4 v230, s[40:43], s64 offen offset:0 lds
    buffer_load_dwordx4 v231, s[40:43], s64 offen offset:1024 lds
    buffer_load_dwordx4 v232, s[40:43], s64 offen offset:2048 lds
    s_add_u32 s64, s64, 98304
    s_sub_u32 s35, s64, 1966080
    s_min_u32 s64, s64, s35
    s_mov_b32 s69, s64
    s_add_u32 m0, s61, 95104
    s_nop 0
    buffer_load_dwordx4 v230, s[40:43], s64 offen offset:0 lds
    buffer_load_dwordx4 v231, s[40:43], s64 offen offset:1024 lds
    buffer_load_dwordx4 v232, s[40:43], s64 offen offset:2048 lds
    s_add_u32 s64, s64, 98304
    s_sub_u32 s35, s64, 1966080
    s_min_u32 s64, s64, s35
    s_waitcnt vmcnt(13)
    s_waitcnt lgkmcnt(0)
    s_barrier
    ds_read_b64_tr_b16 a[120:121], v233 offset:24832
    ds_read_b64_tr_b16 a[122:123], v233 offset:26368
    ds_read_b64_tr_b16 a[124:125], v233 offset:31056
    ds_read_b64_tr_b16 a[126:127], v233 offset:32592
    ds_read_b64_tr_b16 a[128:129], v234 offset:24832
    ds_read_b64_tr_b16 a[130:131], v234 offset:26368
    ds_read_b64_tr_b16 a[132:133], v233 offset:37248
    ds_read_b64_tr_b16 a[134:135], v233 offset:38784
    ds_read_b64_tr_b16 a[136:137], v233 offset:43472
    ds_read_b64_tr_b16 a[138:139], v233 offset:45008
    ds_read_b64_tr_b16 a[140:141], v234 offset:37248
    ds_read_b64_tr_b16 a[142:143], v234 offset:38784
    s_add_u32 m0, s61, 8192
    s_nop 0
    buffer_load_dwordx4 v230, s[40:43], s64 offen offset:0 lds
    buffer_load_dwordx4 v231, s[40:43], s64 offen offset:1024 lds
    buffer_load_dwordx4 v232, s[40:43], s64 offen offset:2048 lds
    s_add_u32 s64, s64, 98304
    s_sub_u32 s35, s64, 1966080
    s_min_u32 s64, s64, s35
    s_add_u32 m0, s61, 20608
    s_nop 0
    buffer_load_dwordx4 v230, s[40:43], s64 offen offset:0 lds
    buffer_load_dwordx4 v231, s[40:43], s64 offen offset:1024 lds
    buffer_load_dwordx4 v232, s[40:43], s64 offen offset:2048 lds
    s_add_u32 s64, s64, 98304
    s_sub_u32 s35, s64, 1966080
    s_min_u32 s64, s64, s35
    s_waitcnt vmcnt(13)
    s_waitcnt lgkmcnt(0)
    s_barrier
    ds_read_b64_tr_b16 a[144:145], v238 offset:0
    ds_read_b64_tr_b16 a[146:147], v238 offset:1536
    ds_read_b64_tr_b16 a[148:149], v238 offset:6224
    ds_read_b64_tr_b16 a[150:151], v238 offset:7760
    ds_read_b64_tr_b16 a[152:153], v239 offset:0
    ds_read_b64_tr_b16 a[154:155], v239 offset:1536
    ds_read_b64_tr_b16 a[156:157], v238 offset:12416
    ds_read_b64_tr_b16 a[158:159], v238 offset:13952
    ds_read_b64_tr_b16 a[160:161], v238 offset:18640
    ds_read_b64_tr_b16 a[162:163], v238 offset:20176
    ds_read_b64_tr_b16 a[164:165], v239 offset:12416
    ds_read_b64_tr_b16 a[166:167], v239 offset:13952
    s_add_u32 m0, s61, 33024
    s_nop 0
    buffer_load_dwordx4 v230, s[40:43], s64 offen offset:0 lds
    buffer_load_dwordx4 v231, s[40:43], s64 offen offset:1024 lds
    buffer_load_dwordx4 v232, s[40:43], s64 offen offset:2048 lds
    s_add_u32 s64, s64, 98304
    s_sub_u32 s35, s64, 1966080
    s_min_u32 s64, s64, s35
    s_add_u32 m0, s61, 45440
    s_nop 0
    buffer_load_dwordx4 v230, s[40:43], s64 offen offset:0 lds
    buffer_load_dwordx4 v231, s[40:43], s64 offen offset:1024 lds
    buffer_load_dwordx4 v232, s[40:43], s64 offen offset:2048 lds
    s_add_u32 s64, s64, 98304
    s_sub_u32 s35, s64, 1966080
    s_min_u32 s64, s64, s35
    s_waitcnt vmcnt(18)
    v_cmp_ne_u32 vcc, s48, v241
    s_cbranch_vccnz L_chk20_slow
L_chk20_back:
    s_mul_i32 s52, s3, 2560
    s_add_u32 m0, s52, 128000
    s_lshl_b32 s52, s34, 7
    s_add_u32 s52, s52, 23166976
    buffer_load_dwordx4 v248, s[36:39], s52 offen sc1 lds
    buffer_load_dwordx4 v248, s[36:39], s52 offen offset:1024 sc1 lds
    s_mov_b32 exec_hi, 0
    buffer_load_dwordx4 v248, s[36:39], s52 offen offset:2048 sc1 lds
    s_mov_b32 exec_hi, -1
    s_lshr_b32 s52, s71, 1
    s_lshl_b32 s52, s52, 2
    s_add_u32 s52, s52, s3
    s_mul_i32 s52, s52, 10240
    s_and_b32 s53, s71, 1
    s_mul_i32 s53, s53, 640
    s_add_u32 s52, s52, s53
    s_mul_i32 s53, s3, 5120
    v_add_u32 v5, 0, v1
    v_mul_u32_u24 v6, 205, v5
    v_lshrrev_b32 v6, 13, v6
    v_mul_u32_u24 v6, 640, v6
    v_lshl_add_u32 v5, v5, 4, v6
    s_add_u32 m0, s53, 107520
    s_nop 0
    buffer_load_dwordx4 v5, s[56:59], s52 offen nt lds
    v_add_u32 v5, 64, v1
    v_mul_u32_u24 v6, 205, v5
    v_lshrrev_b32 v6, 13, v6
    v_mul_u32_u24 v6, 640, v6
    v_lshl_add_u32 v5, v5, 4, v6
    s_add_u32 m0, s53, 108544
    s_nop 0
    buffer_load_dwordx4 v5, s[56:59], s52 offen nt lds
    v_add_u32 v5, 128, v1
    v_mul_u32_u24 v6, 205, v5
    v_lshrrev_b32 v6, 13, v6
    v_mul_u32_u24 v6, 640, v6
    v_lshl_add_u32 v5, v5, 4, v6
    s_add_u32 m0, s53, 109568
    s_nop 0
    buffer_load_dwordx4 v5, s[56:59], s52 offen nt lds
    v_add_u32 v5, 192, v1
    v_mul_u32_u24 v6, 205, v5
    v_lshrrev_b32 v6, 13, v6
    v_mul_u32_u24 v6, 640, v6
    v_lshl_add_u32 v5, v5, 4, v6
    s_add_u32 m0, s53, 110592
    s_nop 0
    buffer_load_dwordx4 v5, s[56:59], s52 offen nt lds
    v_add_u32 v5, 256, v1
    v_mul_u32_u24 v6, 205, v5
    v_lshrrev_b32 v6, 13, v6
    v_mul_u32_u24 v6, 640, v6
    v_lshl_add_u32 v5, v5, 4, v6
    s_add_u32 m0, s53, 111616
    s_nop 0
    buffer_load_dwordx4 v5, s[56:59], s52 offen nt lds
    s_waitcnt vmcnt(20)
    s_waitcnt lgkmcnt(0)
    s_barrier
    ds_read_b64_tr_b16 a[168:169], v238 offset:24832
    ds_read_b64_tr_b16 a[170:171], v238 offset:26368
    ds_read_b64_tr_b16 a[172:173], v238 offset:31056
    ds_read_b64_tr_b16 a[174:175], v238 offset:32592
    ds_read_b64_tr_b16 a[176:177], v239 offset:24832
    ds_read_b64_tr_b16 a[178:179], v239 offset:26368
    ds_read_b64_tr_b16 a[180:181], v238 offset:37248
    ds_read_b64_tr_b16 a[182:183], v238 offset:38784
    ds_read_b64_tr_b16 a[184:185], v238 offset:43472
    ds_read_b64_tr_b16 a[186:187], v238 offset:45008
    ds_read_b64_tr_b16 a[188:189], v239 offset:37248
    ds_read_b64_tr_b16 a[190:191], v239 offset:38784
    s_waitcnt vmcnt(14)
    s_waitcnt lgkmcnt(0)
    s_barrier
    ds_read_b64_tr_b16 a[192:193], v233 offset:0
    ds_read_b64_tr_b16 a[194:195], v233 offset:1536
    ds_read_b64_tr_b16 a[196:197], v233 offset:6224
    ds_read_b64_tr_b16 a[198:199], v233 offset:7760
    ds_read_b64_tr_b16 a[200:201], v234 offset:0
    ds_read_b64_tr_b16 a[202:203], v234 offset:1536
    ds_read_b64_tr_b16 a[204:205], v233 offset:12416
    ds_read_b64_tr_b16 a[206:207], v233 offset:13952
    ds_read_b64_tr_b16 a[208:209], v233 offset:18640
    ds_read_b64_tr_b16 a[210:211], v233 offset:20176
    ds_read_b64_tr_b16 a[212:213], v234 offset:12416
    ds_read_b64_tr_b16 a[214:215], v234 offset:13952
    s_waitcnt vmcnt(8)
    s_waitcnt lgkmcnt(0)
    s_barrier
    ds_read_b64_tr_b16 a[216:217], v233 offset:24832
    ds_read_b64_tr_b16 a[218:219], v233 offset:26368
    ds_read_b64_tr_b16 a[220:221], v233 offset:31056
    ds_read_b64_tr_b16 a[222:223], v233 offset:32592
    ds_read_b64_tr_b16 a[224:225], v234 offset:24832
    ds_read_b64_tr_b16 a[226:227], v234 offset:26368
    ds_read_b64_tr_b16 a[228:229], v233 offset:37248
    ds_read_b64_tr_b16 a[230:231], v233 offset:38784
    ds_read_b64_tr_b16 a[232:233], v233 offset:43472
    ds_read_b64_tr_b16 a[234:235], v233 offset:45008
    ds_read_b64_tr_b16 a[236:237], v234 offset:37248
    ds_read_b64_tr_b16 a[238:239], v234 offset:38784
    s_waitcnt lgkmcnt(0)
    s_barrier
    s_mov_b32 s64, s69
    v_and_b32 v165, 1, v1
    v_lshlrev_b32 v165, 6, v165
    v_and_b32 v166, 48, v1
    s_mul_i32 s57, s3, 2560
    s_add_u32 s57, s57, 128000
    v_add3_u32 v165, v165, v166, s57
    s_waitcnt vmcnt(5)
    ds_read_b128 v[40:43], v165 offset:0
    ds_read_b128 v[44:47], v165 offset:128
    ds_read_b128 v[48:51], v165 offset:256
    ds_read_b128 v[52:55], v165 offset:384
    ds_read_b128 v[56:59], v165 offset:512
    ds_read_b128 v[60:63], v165 offset:640
    s_waitcnt lgkmcnt(5)
    v_mfma_f32_16x16x32_bf16 v[176:179], a[0:3], v[40:43], 0
    ds_read_b128 v[64:67], v165 offset:768
    v_mfma_f32_16x16x32_bf16 v[180:183], a[4:7], v[40:43], 0
    v_mfma_f32_16x16x32_bf16 v[184:187], a[8:11], v[40:43], 0
    s_waitcnt lgkmcnt(5)
    v_mfma_f32_16x16x32_bf16 v[176:179], a[12:15], v[44:47], v[176:179]
    ds_read_b128 v[68:71], v165 offset:896
    v_mfma_f32_16x16x32_bf16 v[180:183], a[16:19], v[44:47], v[180:183]
    v_mfma_f32_16x16x32_bf16 v[184:187], a[20:23], v[44:47], v[184:187]
    s_waitcnt lgkmcnt(5)
    v_mfma_f32_16x16x32_bf16 v[176:179], a[24:27], v[48:51], v[176:179]
    ds_read_b128 v[40:43], v165 offset:1024
    v_mfma_f32_16x16x32_bf16 v[180:183], a[28:31], v[48:51], v[180:183]
    v_mfma_f32_16x16x32_bf16 v[184:187], a[32:35], v[48:51], v[184:187]
    s_waitcnt lgkmcnt(5)
    v_mfma_f32_16x16x32_bf16 v[176:179], a[36:39], v[52:55], v[176:179]
    ds_read_b128 v[44:47], v165 offset:1152
    v_mfma_f32_16x16x32_bf16 v[180:183], a[40:43], v[52:55], v[180:183]
    v_mfma_f32_16x16x32_bf16 v[184:187], a[44:47], v[52:55], v[184:187]
    s_waitcnt lgkmcnt(5)
    v_mfma_f32_16x16x32_bf16 v[176:179], a[48:51], v[56:59], v[176:179]
    ds_read_b128 v[48:51], v165 offset:1280
    v_mfma_f32_16x16x32_bf16 v[180:183], a[52:55], v[56:59], v[180:183]
    v_mfma_f32_16x16x32_bf16 v[184:187], a[56:59], v[56:59], v[184:187]
    s_waitcnt lgkmcnt(5)
    v_mfma_f32_16x16x32_bf16 v[176:179], a[60:63], v[60:63], v[176:179]
    ds_read_b128 v[52:55], v165 offset:1408
    v_mfma_f32_16x16x32_bf16 v[180:183], a[64:67], v[60:63], v[180:183]
    v_mfma_f32_16x16x32_bf16 v[184:187], a[68:71], v[60:63], v[184:187]
    s_waitcnt lgkmcnt(5)
    v_mfma_f32_16x16x32_bf16 v[176:179], a[72:75], v[64:67], v[176:179]
    ds_read_b128 v[56:59], v165 offset:1536
    v_mfma_f32_16x16x32_bf16 v[180:183], a[76:79], v[64:67], v[180:183]
    v_mfma_f32_16x16x32_bf16 v[184:187], a[80:83], v[64:67], v[184:187]
    s_waitcnt lgkmcnt(5)
    v_mfma_f32_16x16x32_bf16 v[176:179], a[84:87], v[68:71], v[176:179]
    ds_read_b128 v[60:63], v165 offset:1664
    v_mfma_f32_16x16x32_bf16 v[180:183], a[88:91], v[68:71], v[180:183]
    v_mfma_f32_16x16x32_bf16 v[184:187], a[92:95], v[68:71], v[184:187]
    s_waitcnt lgkmcnt(5)
    v_mfma_f32_16x16x32_bf16 v[176:179], a[96:99], v[40:43], v[176:179]
    ds_read_b128 v[64:67], v165 offset:1792
    v_mfma_f32_16x16x32_bf16 v[180:183], a[100:103], v[40:43], v[180:183]
    v_mfma_f32_16x16x32_bf16 v[184:187], a[104:107], v[40:43], v[184:187]
    s_waitcnt lgkmcnt(5)
    v_mfma_f32_16x16x32_bf16 v[176:179], a[108:111], v[44:47], v[176:179]
    ds_read_b128 v[68:71], v165 offset:1920
    v_mfma_f32_16x16x32_bf16 v[180:183], a[112:115], v[44:47], v[180:183]
    v_mfma_f32_16x16x32_bf16 v[184:187], a[116:119], v[44:47], v[184:187]
    s_waitcnt lgkmcnt(5)
    v_mfma_f32_16x16x32_bf16 v[176:179], a[120:123], v[48:51], v[176:179]
    ds_read_b128 v[40:43], v165 offset:2048
    v_mfma_f32_16x16x32_bf16 v[180:183], a[124:127], v[48:51], v[180:183]
    v_mfma_f32_16x16x32_bf16 v[184:187], a[128:131], v[48:51], v[184:187]
    s_waitcnt lgkmcnt(5)
    v_mfma_f32_16x16x32_bf16 v[176:179], a[132:135], v[52:55], v[176:179]
    ds_read_b128 v[44:47], v165 offset:2176
    v_mfma_f32_16x16x32_bf16 v[180:183], a[136:139], v[52:55], v[180:183]
    v_mfma_f32_16x16x32_bf16 v[184:187], a[140:143], v[52:55], v[184:187]
    s_waitcnt lgkmcnt(5)
    v_mfma_f32_16x16x32_bf16 v[176:179], a[144:147], v[56:59], v[176:179]
    ds_read_b128 v[48:51], v165 offset:2304
    v_mfma_f32_16x16x32_bf16 v[180:183], a[148:151], v[56:59], v[180:183]
    v_mfma_f32_16x16x32_bf16 v[184:187], a[152:155], v[56:59], v[184:187]
    s_waitcnt lgkmcnt(5)
    v_mfma_f32_16x16x32_bf16 v[176:179], a[156:159], v[60:63], v[176:179]
    ds_read_b128 v[52:55], v165 offset:2432
    v_mfma_f32_16x16x32_bf16 v[180:183], a[160:163], v[60:63], v[180:183]
    v_mfma_f32_16x16x32_bf16 v[184:187], a[164:167], v[60:63], v[184:187]
    s_waitcnt lgkmcnt(5)
    v_mfma_f32_16x16x32_bf16 v[176:179], a[168:171], v[64:67], v[176:179]
    v_mfma_f32_16x16x32_bf16 v[180:183], a[172:175], v[64:67], v[180:183]
    v_mfma_f32_16x16x32_bf16 v[184:187], a[176:179], v[64:67], v[184:187]
    s_waitcnt lgkmcnt(4)
    v_mfma_f32_16x16x32_bf16 v[176:179], a[180:183], v[68:71], v[176:179]
    v_mfma_f32_16x16x32_bf16 v[180:183], a[184:187], v[68:71], v[180:183]
    v_mfma_f32_16x16x32_bf16 v[184:187], a[188:191], v[68:71], v[184:187]
    s_waitcnt lgkmcnt(3)
    v_mfma_f32_16x16x32_bf16 v[176:179], a[192:195], v[40:43], v[176:179]
    v_mfma_f32_16x16x32_bf16 v[180:183], a[196:199], v[40:43], v[180:183]
    v_mfma_f32_16x16x32_bf16 v[184:187], a[200:203], v[40:43], v[184:187]
    s_waitcnt lgkmcnt(2)
    v_mfma_f32_16x16x32_bf16 v[176:179], a[204:207], v[44:47], v[176:179]
    v_mfma_f32_16x16x32_bf16 v[180:183], a[208:211], v[44:47], v[180:183]
    v_mfma_f32_16x16x32_bf16 v[184:187], a[212:215], v[44:47], v[184:187]
    s_waitcnt lgkmcnt(1)
    v_mfma_f32_16x16x32_bf16 v[176:179], a[216:219], v[48:51], v[176:179]
    v_mfma_f32_16x16x32_bf16 v[180:183], a[220:223], v[48:51], v[180:183]
    v_mfma_f32_16x16x32_bf16 v[184:187], a[224:227], v[48:51], v[184:187]
    s_waitcnt lgkmcnt(0)
    v_mfma_f32_16x16x32_bf16 v[176:179], a[228:231], v[52:55], v[176:179]
    v_mfma_f32_16x16x32_bf16 v[180:183], a[232:235], v[52:55], v[180:183]
    v_mfma_f32_16x16x32_bf16 v[184:187], a[236:239], v[52:55], v[184:187]
    v_and_b32 v90, 1, v1
    v_mul_u32_u24 v90, 192, v90
    v_and_b32 v91, 48, v1
    v_add_u32 v90, v90, v91
    s_mov_b32 exec_lo, 0x00030003
    s_mov_b32 exec_hi, 0x00030003
    buffer_store_dwordx4 v[176:179], v90, s[36:39], s9 offen offset:0 sc1
    buffer_store_dwordx4 v[180:183], v90, s[36:39], s9 offen offset:64 sc1
    buffer_store_dwordx4 v[184:187], v90, s[36:39], s9 offen offset:128 sc1
    s_mov_b64 exec, -1
    s_waitcnt vmcnt(0)
    s_barrier
    v_lshrrev_b32 v2, 4, v1
    v_bfe_u32 v3, v1, 2, 2
    v_lshl_add_u32 v3, v2, 3, v3
    v_mul_u32_u24 v3, 640, v3
    v_and_b32 v2, 3, v1
    v_lshl_add_u32 v2, v2, 3, v3
    s_mul_i32 s50, s3, 160
    s_add_u32 s50, s50, 107520
    v_add_u32 v2, s50, v2
    s_lshr_b32 s53, s71, 1
    s_mov_b32 s50, 0x15555556
    s_mul_hi_u32 s51, s53, s50
    s_mul_i32 s52, s51, 12
    s_sub_u32 s52, s53, s52
    s_and_b32 s50, s71, 1
    s_lshl_b32 s50, s50, 2
    s_add_u32 s50, s50, s3
    s_lshl_b32 s50, s50, 2
    s_add_u32 s50, s50, s51
    s_mul_i32 s50, s50, 60
    s_mul_i32 s52, s52, 5
    s_add_u32 s50, s50, s52
    s_lshl_b32 s50, s50, 10
    s_add_u32 s50, s50, 14417920
    s_add_u32 s51, s50, 4096
    ds_read_b64_tr_b16 v[16:17], v2 offset:0
    ds_read_b64_tr_b16 v[18:19], v2 offset:2560
    ds_read_b64_tr_b16 v[20:21], v2 offset:32
    ds_read_b64_tr_b16 v[22:23], v2 offset:2592
    ds_read_b64_tr_b16 v[24:25], v2 offset:64
    ds_read_b64_tr_b16 v[26:27], v2 offset:2624
    ds_read_b64_tr_b16 v[28:29], v2 offset:96
    ds_read_b64_tr_b16 v[30:31], v2 offset:2656
    ds_read_b64_tr_b16 v[32:33], v2 offset:128
    ds_read_b64_tr_b16 v[34:35], v2 offset:2688
    s_waitcnt lgkmcnt(8)
    buffer_store_dwordx4 v[16:19], v248, s[36:39], s50 offen offset:0 sc1
    s_waitcnt lgkmcnt(6)
    buffer_store_dwordx4 v[20:23], v248, s[36:39], s50 offen offset:1024 sc1
    s_waitcnt lgkmcnt(4)
    buffer_store_dwordx4 v[24:27], v248, s[36:39], s50 offen offset:2048 sc1
    s_waitcnt lgkmcnt(2)
    buffer_store_dwordx4 v[28:31], v248, s[36:39], s50 offen offset:3072 sc1
    s_waitcnt lgkmcnt(0)
    buffer_store_dwordx4 v[32:35], v248, s[36:39], s51 offen offset:0 sc1
L_nobias:
    s_waitcnt vmcnt(0)
    s_barrier
    s_cmp_eq_u32 s3, 0
    s_cbranch_scc0 L_wf21
    s_lshl_b32 s54, s71, 7
    s_add_u32 s54, s54, 23233536
    v_mov_b32 v2, 0
    v_mov_b32 v3, s48
    s_mov_b64 exec, 1
    buffer_store_dword v3, v2, s[36:39], s54 offen sc1
    s_mov_b64 exec, -1
L_wf21:
    s_cmp_eq_u32 s76, 1
    s_cbranch_scc0 L_nobias2
    s_cmp_eq_u32 s3, 0
    s_cbranch_scc0 L_wf22
    s_lshl_b32 s54, s73, 7
    s_add_u32 s54, s54, 23286784
    v_mov_b32 v2, 0
    v_mov_b32 v3, s48
    s_mov_b64 exec, 1
    buffer_store_dword v3, v2, s[36:39], s54 offen sc1
    s_mov_b64 exec, -1
L_wf22:
L_nobias2:
    s_cmp_eq_u32 s2, 223
    s_cbranch_scc0 L_p_x
    v_lshlrev_b32 v5, 7, v0
    v_add_u32 v6, 134144, v5
    v_cmp_lt_u32 vcc, 159, v0
    s_nop 1
    v_cndmask_b32 v5, v5, v6, vcc
    s_mov_b32 s52, 23199744
L_poll23:
    buffer_load_dword v2, v5, s[36:39], s52 offen sc1
    s_waitcnt vmcnt(0)
    v_cmp_ne_u32 vcc, s48, v2
    s_cbranch_vccz L_poll23_ok
    s_cmp_eq_u32 s49, 0
    s_cbranch_scc1 L_poll23_ok
    s_sub_u32 s49, s49, 1
    s_sleep 1
    s_branch L_poll23
L_poll23_ok:
    s_barrier
    s_cmp_eq_u32 s3, 0
    s_cbranch_scc0 L_p_x
    s_mov_b32 s50, 23461888
    v_mov_b32 v2, 0
    v_mov_b32 v3, s48
    s_mov_b64 exec, 1
    buffer_store_dword v3, v2, s[36:39], s50 offen sc1
    s_mov_b64 exec, -1
L_p_x:
    v_min_u32 v2, 49, v1
    v_lshlrev_b32 v2, 7, v2
    v_add_u32 v2, 25600, v2
    v_cmp_lt_u32 vcc, 39, v1
    s_nop 1
    v_cndmask_b32 v219, v219, v2, vcc
    v_mov_b32 v200, v230
    v_mov_b32 v201, v231
    v_mov_b32 v202, v232
    v_add_u32 v203, 93568, v233
    v_add_u32 v204, 93568, v234
    s_add_u32 m0, s61, 101760
    s_nop 0
    buffer_load_dwordx4 v200, s[40:43], s64 offen offset:0 lds
    buffer_load_dwordx4 v201, s[40:43], s64 offen offset:1024 lds
    buffer_load_dwordx4 v202, s[40:43], s64 offen offset:2048 lds
    s_add_u32 s64, s64, 98304
    s_sub_u32 s35, s64, 1966080
    s_min_u32 s64, s64, s35
    s_add_u32 m0, s61, 114176
    s_nop 0
    buffer_load_dwordx4 v200, s[40:43], s64 offen offset:0 lds
    buffer_load_dwordx4 v201, s[40:43], s64 offen offset:1024 lds
    buffer_load_dwordx4 v202, s[40:43], s64 offen offset:2048 lds
    s_add_u32 s64, s64, 98304
    s_sub_u32 s35, s64, 1966080
    s_min_u32 s64, s64, s35
L_poll24:
    buffer_load_dword v223, v219, s[36:39], s17 offen sc1
    s_waitcnt vmcnt(0)
    v_cmp_ne_u32 vcc, s48, v223
    s_cbranch_vccz L_poll24_ok
    s_cmp_eq_u32 s49, 0
    s_cbranch_scc1 L_poll24_ok
    s_sub_u32 s49, s49, 1
    s_sleep 1
    s_branch L_poll24
L_poll24_ok:
    s_add_u32 m0, s63, 0
    s_nop 0
    buffer_load_dwordx4 v172, s[36:39], s10 offen sc1 lds
    s_add_u32 m0, s63, 4096
    s_nop 0
    buffer_load_dwordx4 v172, s[36:39], s11 offen sc1 lds
    s_add_u32 m0, s63, 8192
    s_nop 0
    buffer_load_dwordx4 v172, s[36:39], s12 offen sc1 lds
    s_add_u32 m0, s63, 12288
    s_nop 0
    buffer_load_dwordx4 v172, s[36:39], s13 offen sc1 lds
    s_add_u32 m0, s63, 16384
    s_nop 0
    buffer_load_dwordx4 v172, s[36:39], s14 offen sc1 lds
    s_add_u32 m0, s63, 20480
    s_nop 0
    buffer_load_dwordx4 v172, s[36:39], s15 offen sc1 lds
    s_add_u32 m0, s63, 24576
    s_nop 0
    buffer_load_dwordx4 v172, s[36:39], s18 offen sc1 lds
    s_add_u32 m0, s63, 28672
    s_nop 0
    buffer_load_dwordx4 v172, s[36:39], s19 offen sc1 lds
    s_add_u32 m0, s63, 32768
    s_nop 0
    buffer_load_dwordx4 v172, s[36:39], s20 offen sc1 lds
    s_add_u32 m0, s63, 36864
    s_nop 0
    buffer_load_dwordx4 v172, s[36:39], s21 offen sc1 lds
    s_add_u32 m0, s63, 40960
    s_nop 0
    buffer_load_dwordx4 v172, s[36:39], s22 offen sc1 lds
    s_add_u32 m0, s63, 45056
    s_nop 0
    buffer_load_dwordx4 v172, s[36:39], s23 offen sc1 lds
    v_lshlrev_b32 v2, 2, v0
    v_mov_b32 v3, 0x80000000
    v_cmp_gt_u32 vcc, 128, v0
    s_nop 1
    v_cndmask_b32 v3, v3, v2, vcc
    s_lshl_b32 s50, s34, 7
    s_add_u32 s50, s50, 23183360
    buffer_load_dword v220, v2, s[36:39], s50 offen sc1
    buffer_load_dword v221, v2, s[36:39], s50 offen offset:1024 sc1
    buffer_load_dword v222, v3, s[36:39], s50 offen offset:2048 sc1
    s_waitcnt vmcnt(12)
    s_waitcnt lgkmcnt(0)
    s_barrier
    ds_read_b64_tr_b16 v[104:105], v168 offset:0
    ds_read_b64_tr_b16 v[106:107], v168 offset:2048
    ds_read_b64_tr_b16 v[108:109], v169 offset:0
    ds_read_b64_tr_b16 v[110:111], v169 offset:2048
    ds_read_b64_tr_b16 v[112:113], v170 offset:0
    ds_read_b64_tr_b16 v[114:115], v170 offset:2048
    ds_read_b64_tr_b16 v[116:117], v171 offset:0
    ds_read_b64_tr_b16 v[118:119], v171 offset:2048
    s_waitcnt lgkmcnt(6)
    v_mfma_f32_16x16x32_bf16 v[56:59], a[0:3], v[104:107], 0
    ds_read_b64_tr_b16 v[120:121], v168 offset:4096
    v_mfma_f32_16x16x32_bf16 v[60:63], a[4:7], v[104:107], 0
    ds_read_b64_tr_b16 v[122:123], v168 offset:6144
    v_mfma_f32_16x16x32_bf16 v[64:67], a[8:11], v[104:107], 0
    s_waitcnt lgkmcnt(6)
    s_add_u32 m0, s63, 49152
    ds_read_b64_tr_b16 v[124:125], v169 offset:4096
    v_mfma_f32_16x16x32_bf16 v[68:71], a[0:3], v[108:111], 0
    buffer_load_dwordx4 v172, s[36:39], s24 offen sc1 lds
    v_mfma_f32_16x16x32_bf16 v[72:75], a[4:7], v[108:111], 0
    ds_read_b64_tr_b16 v[126:127], v169 offset:6144
    v_mfma_f32_16x16x32_bf16 v[76:79], a[8:11], v[108:111], 0
    s_waitcnt lgkmcnt(6)
    ds_read_b64_tr_b16 v[128:129], v170 offset:4096
    v_mfma_f32_16x16x32_bf16 v[80:83], a[0:3], v[112:115], 0
    s_add_u32 m0, s63, 53248
    ds_read_b64_tr_b16 v[130:131], v170 offset:6144
    v_mfma_f32_16x16x32_bf16 v[84:87], a[4:7], v[112:115], 0
    buffer_load_dwordx4 v172, s[36:39], s25 offen sc1 lds
    v_mfma_f32_16x16x32_bf16 v[88:91], a[8:11], v[112:115], 0
    s_waitcnt lgkmcnt(6)
    ds_read_b64_tr_b16 v[132:133], v171 offset:4096
    v_mfma_f32_16x16x32_bf16 v[92:95], a[0:3], v[116:119], 0
    s_waitcnt lgkmcnt(3)
    ds_read_b64_tr_b16 v[134:135], v171 offset:6144
    v_mfma_f32_16x16x32_bf16 v[96:99], a[4:7], v[116:119], 0
    s_add_u32 m0, s63, 57344
    v_mfma_f32_16x16x32_bf16 v[100:103], a[8:11], v[116:119], 0
    buffer_load_dwordx4 v172, s[36:39], s26 offen sc1 lds
    v_mfma_f32_16x16x32_bf16 v[56:59], a[12:15], v[120:123], v[56:59]
    ds_read_b64_tr_b16 v[104:105], v168 offset:8192
    v_mfma_f32_16x16x32_bf16 v[60:63], a[16:19], v[120:123], v[60:63]
    ds_read_b64_tr_b16 v[106:107], v168 offset:10240
    v_mfma_f32_16x16x32_bf16 v[64:67], a[20:23], v[120:123], v[64:67]
    s_add_u32 m0, s63, 61440
    ds_read_b64_tr_b16 v[108:109], v169 offset:8192
    v_mfma_f32_16x16x32_bf16 v[68:71], a[12:15], v[124:127], v[68:71]
    buffer_load_dwordx4 v172, s[36:39], s27 offen sc1 lds
    v_mfma_f32_16x16x32_bf16 v[72:75], a[16:19], v[124:127], v[72:75]
    ds_read_b64_tr_b16 v[110:111], v169 offset:10240
    v_mfma_f32_16x16x32_bf16 v[76:79], a[20:23], v[124:127], v[76:79]
    s_waitcnt lgkmcnt(6)
    ds_read_b64_tr_b16 v[112:113], v170 offset:8192
    v_mfma_f32_16x16x32_bf16 v[80:83], a[12:15], v[128:131], v[80:83]
    s_add_u32 m0, s63, 65536
    ds_read_b64_tr_b16 v[114:115], v170 offset:10240
    v_mfma_f32_16x16x32_bf16 v[84:87], a[16:19], v[128:131], v[84:87]
    buffer_load_dwordx4 v172, s[36:39], s44 offen sc1 lds
    v_mfma_f32_16x16x32_bf16 v[88:91], a[20:23], v[128:131], v[88:91]
    s_waitcnt lgkmcnt(6)
    ds_read_b64_tr_b16 v[116:117], v171 offset:8192
    v_mfma_f32_16x16x32_bf16 v[92:95], a[12:15], v[132:135], v[92:95]
    s_waitcnt lgkmcnt(3)
    ds_read_b64_tr_b16 v[118:119], v171 offset:10240
    v_mfma_f32_16x16x32_bf16 v[96:99], a[16:19], v[132:135], v[96:99]
    s_add_u32 m0, s63, 69632
    v_mfma_f32_16x16x32_bf16 v[100:103], a[20:23], v[132:135], v[100:103]
    buffer_load_dwordx4 v172, s[36:39], s45 offen sc1 lds
    v_mfma_f32_16x16x32_bf16 v[56:59], a[24:27], v[104:107], v[56:59]
    s_waitcnt vmcnt(13)
    s_barrier
    ds_read_b64_tr_b16 v[120:121], v168 offset:12288
    v_mfma_f32_16x16x32_bf16 v[60:63], a[28:31], v[104:107], v[60:63]
    ds_read_b64_tr_b16 v[122:123], v168 offset:14336
    v_mfma_f32_16x16x32_bf16 v[64:67], a[32:35], v[104:107], v[64:67]
    s_add_u32 m0, s63, 73728
    ds_read_b64_tr_b16 v[124:125], v169 offset:12288
    v_mfma_f32_16x16x32_bf16 v[68:71], a[24:27], v[108:111], v[68:71]
    buffer_load_dwordx4 v172, s[36:39], s46 offen sc1 lds
    v_mfma_f32_16x16x32_bf16 v[72:75], a[28:31], v[108:111], v[72:75]
    ds_read_b64_tr_b16 v[126:127], v169 offset:14336
    v_mfma_f32_16x16x32_bf16 v[76:79], a[32:35], v[108:111], v[76:79]
    s_waitcnt lgkmcnt(6)
    ds_read_b64_tr_b16 v[128:129], v170 offset:12288
    v_mfma_f32_16x16x32_bf16 v[80:83], a[24:27], v[112:115], v[80:83]
    s_add_u32 m0, s63, 77824
    ds_read_b64_tr_b16 v[130:131], v170 offset:14336
    v_mfma_f32_16x16x32_bf16 v[84:87], a[28:31], v[112:115], v[84:87]
    buffer_load_dwordx4 v172, s[36:39], s47 offen sc1 lds
    v_mfma_f32_16x16x32_bf16 v[88:91], a[32:35], v[112:115], v[88:91]
    s_waitcnt lgkmcnt(6)
    ds_read_b64_tr_b16 v[132:133], v171 offset:12288
    v_add_u32 v172, 2048, v172
    v_mfma_f32_16x16x32_bf16 v[92:95], a[24:27], v[116:119], v[92:95]
    s_waitcnt lgkmcnt(3)
    ds_read_b64_tr_b16 v[134:135], v171 offset:14336
    v_mfma_f32_16x16x32_bf16 v[96:99], a[28:31], v[116:119], v[96:99]
    s_add_u32 m0, s61, 126592
    v_mfma_f32_16x16x32_bf16 v[100:103], a[32:35], v[116:119], v[100:103]
    buffer_load_dwordx4 v200, s[40:43], s64 offen offset:0 lds
    v_mfma_f32_16x16x32_bf16 v[56:59], a[36:39], v[120:123], v[56:59]
    ds_read_b64_tr_b16 v[104:105], v168 offset:16384
    v_mfma_f32_16x16x32_bf16 v[60:63], a[40:43], v[120:123], v[60:63]
    ds_read_b64_tr_b16 v[106:107], v168 offset:18432
    v_mfma_f32_16x16x32_bf16 v[64:67], a[44:47], v[120:123], v[64:67]
    s_add_u32 m0, s61, 126592
    ds_read_b64_tr_b16 v[108:109], v169 offset:16384
    v_mfma_f32_16x16x32_bf16 v[68:71], a[36:39], v[124:127], v[68:71]
    buffer_load_dwordx4 v201, s[40:43], s64 offen offset:1024 lds
    v_mfma_f32_16x16x32_bf16 v[72:75], a[40:43], v[124:127], v[72:75]
    ds_read_b64_tr_b16 v[110:111], v169 offset:18432
    v_mfma_f32_16x16x32_bf16 v[76:79], a[44:47], v[124:127], v[76:79]
    s_waitcnt lgkmcnt(6)
    ds_read_b64_tr_b16 v[112:113], v170 offset:16384
    v_mfma_f32_16x16x32_bf16 v[80:83], a[36:39], v[128:131], v[80:83]
    s_add_u32 m0, s61, 126592
    ds_read_b64_tr_b16 v[114:115], v170 offset:18432
    v_mfma_f32_16x16x32_bf16 v[84:87], a[40:43], v[128:131], v[84:87]
    buffer_load_dwordx4 v202, s[40:43], s64 offen offset:2048 lds
    v_mfma_f32_16x16x32_bf16 v[88:91], a[44:47], v[128:131], v[88:91]
    s_waitcnt lgkmcnt(6)
    s_add_u32 s64, s64, 98304
    ds_read_b64_tr_b16 v[116:117], v171 offset:16384
    v_mfma_f32_16x16x32_bf16 v[92:95], a[36:39], v[132:135], v[92:95]
    s_waitcnt lgkmcnt(3)
    s_sub_u32 s35, s64, 1966080
    ds_read_b64_tr_b16 v[118:119], v171 offset:18432
    v_mfma_f32_16x16x32_bf16 v[96:99], a[40:43], v[132:135], v[96:99]
    s_min_u32 s64, s64, s35
    v_mfma_f32_16x16x32_bf16 v[100:103], a[44:47], v[132:135], v[100:103]
    v_mfma_f32_16x16x32_bf16 v[56:59], a[48:51], v[104:107], v[56:59]
    ds_read_b64_tr_b16 v[120:121], v168 offset:20480
    v_mfma_f32_16x16x32_bf16 v[60:63], a[52:55], v[104:107], v[60:63]
    ds_read_b64_tr_b16 v[122:123], v168 offset:22528
    v_mfma_f32_16x16x32_bf16 v[64:67], a[56:59], v[104:107], v[64:67]
    s_add_u32 m0, s61, 139008
    ds_read_b64_tr_b16 v[124:125], v169 offset:20480
    v_mfma_f32_16x16x32_bf16 v[68:71], a[48:51], v[108:111], v[68:71]
    buffer_load_dwordx4 v200, s[40:43], s64 offen offset:0 lds
    v_mfma_f32_16x16x32_bf16 v[72:75], a[52:55], v[108:111], v[72:75]
    ds_read_b64_tr_b16 v[126:127], v169 offset:22528
    v_mfma_f32_16x16x32_bf16 v[76:79], a[56:59], v[108:111], v[76:79]
    s_waitcnt lgkmcnt(6)
    ds_read_b64_tr_b16 v[128:129], v170 offset:20480
    v_mfma_f32_16x16x32_bf16 v[80:83], a[48:51], v[112:115], v[80:83]
    s_add_u32 m0, s61, 139008
    ds_read_b64_tr_b16 v[130:131], v170 offset:22528
    v_min_u32 v243, 11, v1
    v_mfma_f32_16x16x32_bf16 v[84:87], a[52:55], v[112:115], v[84:87]
    buffer_load_dwordx4 v201, s[40:43], s64 offen offset:1024 lds
    v_mfma_f32_16x16x32_bf16 v[88:91], a[56:59], v[112:115], v[88:91]
    s_waitcnt lgkmcnt(6)
    ds_read_b64_tr_b16 v[132:133], v171 offset:20480
    v_lshlrev_b32 v243, 8, v243
    v_mfma_f32_16x16x32_bf16 v[92:95], a[48:51], v[116:119], v[92:95]
    s_waitcnt lgkmcnt(3)
    ds_read_b64_tr_b16 v[134:135], v171 offset:22528
    v_mfma_f32_16x16x32_bf16 v[96:99], a[52:55], v[116:119], v[96:99]
    s_add_u32 m0, s61, 139008
    v_mfma_f32_16x16x32_bf16 v[100:103], a[56:59], v[116:119], v[100:103]
    buffer_load_dwordx4 v202, s[40:43], s64 offen offset:2048 lds
    v_mfma_f32_16x16x32_bf16 v[56:59], a[60:63], v[120:123], v[56:59]
    s_mul_i32 s58, s3, 24
    s_lshr_b32 s57, s75, 2
    s_add_u32 s64, s64, 98304
    ds_read_b64_tr_b16 v[104:105], v168 offset:24576
    v_mfma_f32_16x16x32_bf16 v[60:63], a[64:67], v[120:123], v[60:63]
    s_add_u32 s58, s58, s57
    s_lshl_b32 s58, s58, 7
    ds_read_b64_tr_b16 v[106:107], v168 offset:26624
    v_mfma_f32_16x16x32_bf16 v[64:67], a[68:71], v[120:123], v[64:67]
    s_add_u32 s58, s58, 23233536
    s_sub_u32 s35, s64, 1966080
    ds_read_b64_tr_b16 v[108:109], v169 offset:24576
    v_mfma_f32_16x16x32_bf16 v[68:71], a[60:63], v[124:127], v[68:71]
    s_min_u32 s64, s64, s35
    buffer_load_dword v244, v243, s[36:39], s58 offen sc1
    v_mfma_f32_16x16x32_bf16 v[72:75], a[64:67], v[124:127], v[72:75]
    ds_read_b64_tr_b16 v[110:111], v169 offset:26624
    v_mfma_f32_16x16x32_bf16 v[76:79], a[68:71], v[124:127], v[76:79]
    s_waitcnt lgkmcnt(6)
    ds_read_b64_tr_b16 v[112:113], v170 offset:24576
    v_mfma_f32_16x16x32_bf16 v[80:83], a[60:63], v[128:131], v[80:83]
    s_add_u32 m0, s61, 151424
    ds_read_b64_tr_b16 v[114:115], v170 offset:26624
    v_mfma_f32_16x16x32_bf16 v[84:87], a[64:67], v[128:131], v[84:87]
    buffer_load_dwordx4 v200, s[40:43], s64 offen offset:0 lds
    v_mfma_f32_16x16x32_bf16 v[88:91], a[68:71], v[128:131], v[88:91]
    s_waitcnt lgkmcnt(6)
    ds_read_b64_tr_b16 v[116:117], v171 offset:24576
    v_mfma_f32_16x16x32_bf16 v[92:95], a[60:63], v[132:135], v[92:95]
    s_waitcnt lgkmcnt(3)
    ds_read_b64_tr_b16 v[118:119], v171 offset:26624
    v_mfma_f32_16x16x32_bf16 v[96:99], a[64:67], v[132:135], v[96:99]
    s_add_u32 m0, s61, 151424
    v_mfma_f32_16x16x32_bf16 v[100:103], a[68:71], v[132:135], v[100:103]
    buffer_load_dwordx4 v201, s[40:43], s64 offen offset:1024 lds
    v_mfma_f32_16x16x32_bf16 v[56:59], a[72:75], v[104:107], v[56:59]
    ds_read_b64_tr_b16 v[120:121], v168 offset:28672
    v_mfma_f32_16x16x32_bf16 v[60:63], a[76:79], v[104:107], v[60:63]
    ds_read_b64_tr_b16 v[122:123], v168 offset:30720
    v_mfma_f32_16x16x32_bf16 v[64:67], a[80:83], v[104:107], v[64:67]
    s_add_u32 m0, s61, 151424
    ds_read_b64_tr_b16 v[124:125], v169 offset:28672
    v_mfma_f32_16x16x32_bf16 v[68:71], a[72:75], v[108:111], v[68:71]
    buffer_load_dwordx4 v202, s[40:43], s64 offen offset:2048 lds
    v_mfma_f32_16x16x32_bf16 v[72:75], a[76:79], v[108:111], v[72:75]
    s_add_u32 s64, s64, 98304
    ds_read_b64_tr_b16 v[126:127], v169 offset:30720
    v_mfma_f32_16x16x32_bf16 v[76:79], a[80:83], v[108:111], v[76:79]
    s_waitcnt lgkmcnt(6)
    s_sub_u32 s35, s64, 1966080
    ds_read_b64_tr_b16 v[128:129], v170 offset:28672
    v_mfma_f32_16x16x32_bf16 v[80:83], a[72:75], v[112:115], v[80:83]
    s_min_u32 s64, s64, s35
    ds_read_b64_tr_b16 v[130:131], v170 offset:30720
    v_mfma_f32_16x16x32_bf16 v[84:87], a[76:79], v[112:115], v[84:87]
    v_mfma_f32_16x16x32_bf16 v[88:91], a[80:83], v[112:115], v[88:91]
    s_waitcnt lgkmcnt(6)
    ds_read_b64_tr_b16 v[132:133], v171 offset:28672
    v_mfma_f32_16x16x32_bf16 v[92:95], a[72:75], v[116:119], v[92:95]
    s_waitcnt lgkmcnt(3)
    ds_read_b64_tr_b16 v[134:135], v171 offset:30720
    v_mfma_f32_16x16x32_bf16 v[96:99], a[76:79], v[116:119], v[96:99]
    v_mfma_f32_16x16x32_bf16 v[100:103], a[80:83], v[116:119], v[100:103]
    v_mfma_f32_16x16x32_bf16 v[56:59], a[84:87], v[120:123], v[56:59]
    s_waitcnt vmcnt(10)
    s_barrier
    ds_read_b64_tr_b16 v[104:105], v168 offset:32768
    v_mfma_f32_16x16x32_bf16 v[60:63], a[88:91], v[120:123], v[60:63]
    ds_read_b64_tr_b16 v[106:107], v168 offset:34816
    ds_read_b64 v[224:225], v216
    v_mfma_f32_16x16x32_bf16 v[64:67], a[92:95], v[120:123], v[64:67]
    ds_read_b64_tr_b16 v[108:109], v169 offset:32768
    v_mfma_f32_16x16x32_bf16 v[68:71], a[84:87], v[124:127], v[68:71]
    ds_read_b64 v[226:227], v217
    v_mfma_f32_16x16x32_bf16 v[72:75], a[88:91], v[124:127], v[72:75]
    ds_read_b64_tr_b16 v[110:111], v169 offset:34816
    ds_read_b64 v[228:229], v218
    v_mfma_f32_16x16x32_bf16 v[76:79], a[92:95], v[124:127], v[76:79]
    s_waitcnt lgkmcnt(9)
    ds_read_b64_tr_b16 v[112:113], v170 offset:32768
    v_mfma_f32_16x16x32_bf16 v[80:83], a[84:87], v[128:131], v[80:83]
    s_barrier
    ds_read_b64_tr_b16 v[114:115], v170 offset:34816
    v_mfma_f32_16x16x32_bf16 v[84:87], a[88:91], v[128:131], v[84:87]
    ds_read_b64_tr_b16 a[180:181], v203 offset:0
    v_mfma_f32_16x16x32_bf16 v[88:91], a[92:95], v[128:131], v[88:91]
    s_waitcnt lgkmcnt(10)
    ds_read_b64_tr_b16 v[116:117], v171 offset:32768
    ds_read_b64_tr_b16 a[182:183], v203 offset:1536
    v_mfma_f32_16x16x32_bf16 v[92:95], a[84:87], v[132:135], v[92:95]
    s_waitcnt lgkmcnt(3)
    ds_read_b64_tr_b16 v[118:119], v171 offset:34816
    v_mfma_f32_16x16x32_bf16 v[96:99], a[88:91], v[132:135], v[96:99]
    ds_read_b64_tr_b16 a[184:185], v203 offset:6224
    v_lshlrev_b32 v230, 16, v224
    v_and_b32 v231, 0xffff0000, v224
    v_pk_mul_f32 v[230:231], v[230:231], v[220:221] op_sel_hi:[1,0]
    v_pk_mul_f32 v[234:235], v[230:231], v[230:231]
    v_lshlrev_b32 v232, 16, v225
    v_and_b32 v233, 0xffff0000, v225
    v_pk_mul_f32 v[232:233], v[232:233], v[220:221] op_sel_hi:[1,0]
    v_pk_mul_f32 v[236:237], v[232:233], v[232:233]
    v_lshlrev_b32 v2, 16, v226
    v_and_b32 v3, 0xffff0000, v226
    v_pk_mul_f32 v[2:3], v[2:3], v[220:221] op_sel:[0,1] op_sel_hi:[1,1]
    v_pk_add_f32 v[230:231], v[230:231], v[2:3]
    v_pk_fma_f32 v[234:235], v[2:3], v[2:3], v[234:235]
    v_lshlrev_b32 v2, 16, v227
    v_and_b32 v3, 0xffff0000, v227
    v_pk_mul_f32 v[2:3], v[2:3], v[220:221] op_sel:[0,1] op_sel_hi:[1,1]
    v_pk_add_f32 v[232:233], v[232:233], v[2:3]
    v_pk_fma_f32 v[236:237], v[2:3], v[2:3], v[236:237]
    v_lshlrev_b32 v2, 16, v228
    v_and_b32 v3, 0xffff0000, v228
    v_pk_mul_f32 v[2:3], v[2:3], v[222:223] op_sel_hi:[1,0]
    v_pk_add_f32 v[230:231], v[230:231], v[2:3]
    v_pk_fma_f32 v[234:235], v[2:3], v[2:3], v[234:235]
    v_lshlrev_b32 v2, 16, v229
    v_and_b32 v3, 0xffff0000, v229
    v_pk_mul_f32 v[2:3], v[2:3], v[222:223] op_sel_hi:[1,0]
    v_pk_add_f32 v[232:233], v[232:233], v[2:3]
    v_pk_fma_f32 v[236:237], v[2:3], v[2:3], v[236:237]
    v_mfma_f32_16x16x32_bf16 v[100:103], a[92:95], v[132:135], v[100:103]
    ds_read_b64_tr_b16 a[186:187], v203 offset:7760
    v_permlane32_swap_b32 v230, v234
    v_mfma_f32_16x16x32_bf16 v[56:59], a[96:99], v[104:107], v[56:59]
    ds_read_b64_tr_b16 v[120:121], v168 offset:36864
    ds_read_b64_tr_b16 a[188:189], v204 offset:0
    v_mfma_f32_16x16x32_bf16 v[60:63], a[100:103], v[104:107], v[60:63]
    ds_read_b64_tr_b16 v[122:123], v168 offset:38912
    v_permlane32_swap_b32 v231, v235
    v_mfma_f32_16x16x32_bf16 v[64:67], a[104:107], v[104:107], v[64:67]
    ds_read_b64_tr_b16 v[124:125], v169 offset:36864
    v_permlane32_swap_b32 v232, v236
    v_mfma_f32_16x16x32_bf16 v[68:71], a[96:99], v[108:111], v[68:71]
    ds_read_b64_tr_b16 a[190:191], v204 offset:1536
    v_permlane32_swap_b32 v233, v237
    v_mfma_f32_16x16x32_bf16 v[72:75], a[100:103], v[108:111], v[72:75]
    ds_read_b64_tr_b16 v[126:127], v169 offset:38912
    v_lshrrev_b32 v238, 1, v1
    v_add_f32 v230, v230, v234
    v_add_f32 v231, v231, v235
    v_mfma_f32_16x16x32_bf16 v[76:79], a[104:107], v[108:111], v[76:79]
    ds_read_b64_tr_b16 v[128:129], v170 offset:36864
    v_lshlrev_b32 v238, 10, v238
    v_mfma_f32_16x16x32_bf16 v[80:83], a[96:99], v[112:115], v[80:83]
    ds_read_b64_tr_b16 v[130:131], v170 offset:38912
    v_and_b32 v239, 1, v1
    v_mfma_f32_16x16x32_bf16 v[84:87], a[100:103], v[112:115], v[84:87]
    v_add_f32 v232, v232, v236
    v_mfma_f32_16x16x32_bf16 v[88:91], a[104:107], v[112:115], v[88:91]
    s_waitcnt lgkmcnt(10)
    ds_read_b64_tr_b16 v[132:133], v171 offset:36864
    v_lshl_add_u32 v219, v239, 7, v238
    v_mfma_f32_16x16x32_bf16 v[92:95], a[96:99], v[116:119], v[92:95]
    s_waitcnt lgkmcnt(3)
    ds_read_b64_tr_b16 v[134:135], v171 offset:38912
    v_add_f32 v233, v233, v237
    v_mfma_f32_16x16x32_bf16 v[96:99], a[100:103], v[116:119], v[96:99]
    v_permlane16_swap_b32 v230, v232
    v_permlane16_swap_b32 v231, v233
    v_mfma_f32_16x16x32_bf16 v[100:103], a[104:107], v[116:119], v[100:103]
    v_add_f32 v230, v230, v232
    v_add_f32 v231, v231, v233
    v_mfma_f32_16x16x32_bf16 v[56:59], a[108:111], v[120:123], v[56:59]
    s_lshl_b32 s55, s3, 8
    s_add_u32 s55, s55, 66560
    ds_read_b64_tr_b16 v[104:105], v168 offset:40960
    v_lshrrev_b32 v2, 4, v1
    v_lshlrev_b32 v2, 3, v2
    v_mfma_f32_16x16x32_bf16 v[60:63], a[112:115], v[120:123], v[60:63]
    s_barrier
    ds_read_b64_tr_b16 v[106:107], v168 offset:43008
    ds_read_b64_tr_b16 a[192:193], v203 offset:12416
    v_add_u32 v219, s55, v219
    v_mfma_f32_16x16x32_bf16 v[64:67], a[116:119], v[120:123], v[64:67]
    s_lshl_b32 s55, s73, 7
    s_add_u32 s55, s55, 87040
    ds_read_b64_tr_b16 v[108:109], v169 offset:40960
    v_mfma_f32_16x16x32_bf16 v[68:71], a[108:111], v[124:127], v[68:71]
    ds_read_b64_tr_b16 a[194:195], v203 offset:13952
    s_waitcnt vmcnt(3)
    v_cmp_ne_u32 vcc, s48, v244
    s_cbranch_vccnz L_chk25_slow
L_chk25_back:
    v_mfma_f32_16x16x32_bf16 v[72:75], a[112:115], v[124:127], v[72:75]
    s_lshl_b32 s50, s3, 5
    s_add_u32 s50, s50, 0
    ds_read_b64_tr_b16 v[110:111], v169 offset:43008
    v_mov_b32 v238, s55
    v_add_u32 v2, s50, v2
    v_add_f32_dpp v230, v230, v230 row_ror:8 row_mask:0xf bank_mask:0xf
    v_mfma_f32_16x16x32_bf16 v[76:79], a[116:119], v[124:127], v[76:79]
    s_waitcnt lgkmcnt(8)
    ds_read_b64_tr_b16 v[112:113], v170 offset:40960
    ds_read_b64_tr_b16 a[196:197], v203 offset:18640
    v_mfma_f32_16x16x32_bf16 v[80:83], a[108:111], v[128:131], v[80:83]
    ds_read_b64_tr_b16 v[114:115], v170 offset:43008
    ds_read_b64_tr_b16 a[198:199], v203 offset:20176
    v_mfma_f32_16x16x32_bf16 v[84:87], a[112:115], v[128:131], v[84:87]
    v_cmp_lt_u32 vcc, 39, v1
    s_nop 1
    v_cndmask_b32 v219, v219, v238, vcc
    buffer_load_dwordx4 a[240:243], v248, s[36:39], s62 offen offset:0 sc1
    v_mfma_f32_16x16x32_bf16 v[88:91], a[116:119], v[128:131], v[88:91]
    s_waitcnt lgkmcnt(10)
    s_mov_b32 s17, 23199744
    ds_read_b64_tr_b16 v[116:117], v171 offset:40960
    ds_read_b64_tr_b16 a[200:201], v204 offset:12416
    v_mfma_f32_16x16x32_bf16 v[92:95], a[108:111], v[132:135], v[92:95]
    s_waitcnt lgkmcnt(3)
    ds_read_b64_tr_b16 v[118:119], v171 offset:43008
    v_add_f32_dpp v231, v231, v231 row_ror:8 row_mask:0xf bank_mask:0xf
    v_mfma_f32_16x16x32_bf16 v[96:99], a[112:115], v[132:135], v[96:99]
    ds_read_b64_tr_b16 a[202:203], v204 offset:13952
    v_add_f32_dpp v230, v230, v230 row_ror:4 row_mask:0xf bank_mask:0xf
    v_mfma_f32_16x16x32_bf16 v[100:103], a[116:119], v[132:135], v[100:103]
    buffer_load_dwordx4 a[244:247], v248, s[36:39], s62 offen offset:1024 sc1
    v_mfma_f32_16x16x32_bf16 v[56:59], a[120:123], v[104:107], v[56:59]
    ds_read_b64_tr_b16 v[120:121], v168 offset:45056
    v_add_f32_dpp v231, v231, v231 row_ror:4 row_mask:0xf bank_mask:0xf
    v_mfma_f32_16x16x32_bf16 v[60:63], a[124:127], v[104:107], v[60:63]
    ds_read_b64_tr_b16 v[122:123], v168 offset:47104
    v_add_f32_dpp v230, v230, v230 row_ror:2 row_mask:0xf bank_mask:0xf
    v_mfma_f32_16x16x32_bf16 v[64:67], a[128:131], v[104:107], v[64:67]
    ds_read_b64_tr_b16 v[124:125], v169 offset:45056
    v_add_f32_dpp v231, v231, v231 row_ror:2 row_mask:0xf bank_mask:0xf
    v_mfma_f32_16x16x32_bf16 v[68:71], a[120:123], v[108:111], v[68:71]
    buffer_load_dwordx4 a[248:251], v248, s[36:39], s62 offen offset:2048 sc1
    v_mfma_f32_16x16x32_bf16 v[72:75], a[124:127], v[108:111], v[72:75]
    ds_read_b64_tr_b16 v[126:127], v169 offset:47104
    v_add_f32_dpp v230, v230, v230 row_ror:1 row_mask:0xf bank_mask:0xf
    v_mfma_f32_16x16x32_bf16 v[76:79], a[128:131], v[108:111], v[76:79]
    ds_read_b64_tr_b16 v[128:129], v170 offset:45056
    v_add_f32_dpp v231, v231, v231 row_ror:1 row_mask:0xf bank_mask:0xf
    s_mov_b32 exec_lo, 0x00010001
    s_mov_b32 exec_hi, 0x00010001
    ds_write_b64 v2, v[230:231]
    s_mov_b64 exec, -1
    v_lshlrev_b32 v2, 2, v1
    v_mfma_f32_16x16x32_bf16 v[80:83], a[120:123], v[112:115], v[80:83]
    s_waitcnt lgkmcnt(6)
    s_barrier
    ds_read_b64_tr_b16 v[130:131], v170 offset:47104
    v_mfma_f32_16x16x32_bf16 v[84:87], a[124:127], v[112:115], v[84:87]
    ds_read_b64_tr_b16 a[204:205], v203 offset:24832
    buffer_load_dwordx4 a[252:255], v248, s[36:39], s62 offen offset:3072 sc1
    v_mfma_f32_16x16x32_bf16 v[88:91], a[128:131], v[112:115], v[88:91]
    ds_read_b64_tr_b16 v[132:133], v171 offset:45056
    ds_read_b64_tr_b16 a[206:207], v203 offset:26368
    v_mfma_f32_16x16x32_bf16 v[92:95], a[120:123], v[116:119], v[92:95]
    s_waitcnt lgkmcnt(3)
    ds_read_b64_tr_b16 v[134:135], v171 offset:47104
    v_and_b32 v2, 12, v2
    v_add_u32 v2, 0, v2
    v_mfma_f32_16x16x32_bf16 v[96:99], a[124:127], v[116:119], v[96:99]
    s_add_u32 s62, s62, 4096
    buffer_load_dword v240, v219, s[36:39], s17 offen sc1
    v_mfma_f32_16x16x32_bf16 v[100:103], a[128:131], v[116:119], v[100:103]
    s_waitcnt lgkmcnt(0)
    s_barrier
    ds_read_b64_tr_b16 a[208:209], v203 offset:31056
    buffer_load_dwordx4 v[136:139], v248, s[36:39], s62 offen offset:0 sc1
    v_mfma_f32_16x16x32_bf16 v[56:59], a[132:135], v[120:123], v[56:59]
    ds_read_b64_tr_b16 v[104:105], v168 offset:49152
    ds_read_b64_tr_b16 a[210:211], v203 offset:32592
    ds_read2_b32 v[230:231], v2 offset0:0 offset1:4
    v_mfma_f32_16x16x32_bf16 v[60:63], a[136:139], v[120:123], v[60:63]
    ds_read_b64_tr_b16 v[106:107], v168 offset:51200
    ds_read_b64_tr_b16 a[212:213], v204 offset:24832
    v_mfma_f32_16x16x32_bf16 v[64:67], a[140:143], v[120:123], v[64:67]
    ds_read_b64_tr_b16 v[108:109], v169 offset:49152
    ds_read2_b32 v[232:233], v2 offset0:8 offset1:12
    ds_read2_b32 v[234:235], v2 offset0:16 offset1:20
    v_mfma_f32_16x16x32_bf16 v[68:71], a[132:135], v[124:127], v[68:71]
    ds_read_b64_tr_b16 a[214:215], v204 offset:26368
    buffer_load_dwordx4 v[140:143], v248, s[36:39], s62 offen offset:1024 sc1
    v_mfma_f32_16x16x32_bf16 v[72:75], a[136:139], v[124:127], v[72:75]
    ds_read_b64_tr_b16 v[110:111], v169 offset:51200
    ds_read2_b32 v[236:237], v2 offset0:24 offset1:28
    v_mfma_f32_16x16x32_bf16 v[76:79], a[140:143], v[124:127], v[76:79]
    ds_read_b64_tr_b16 v[112:113], v170 offset:49152
    v_mov_b32 v225, s48
    v_mfma_f32_16x16x32_bf16 v[80:83], a[132:135], v[128:131], v[80:83]
    ds_read_b64_tr_b16 v[114:115], v170 offset:51200
    v_mov_b32 v227, s48
    v_mfma_f32_16x16x32_bf16 v[84:87], a[136:139], v[128:131], v[84:87]
    buffer_load_dwordx4 v[144:147], v248, s[36:39], s62 offen offset:2048 sc1
    v_mfma_f32_16x16x32_bf16 v[88:91], a[140:143], v[128:131], v[88:91]
    ds_read_b64_tr_b16 v[116:117], v171 offset:49152
    s_waitcnt lgkmcnt(7)
    v_add_f32 v230, v230, v232
    v_mfma_f32_16x16x32_bf16 v[92:95], a[132:135], v[132:135], v[92:95]
    s_waitcnt lgkmcnt(3)
    ds_read_b64_tr_b16 v[118:119], v171 offset:51200
    v_add_f32 v231, v231, v233
    v_mfma_f32_16x16x32_bf16 v[96:99], a[136:139], v[132:135], v[96:99]
    v_add_f32 v234, v234, v236
    v_add_f32 v235, v235, v237
    v_mfma_f32_16x16x32_bf16 v[100:103], a[140:143], v[132:135], v[100:103]
    buffer_load_dwordx4 v[148:151], v248, s[36:39], s62 offen offset:3072 sc1
    v_mfma_f32_16x16x32_bf16 v[56:59], a[144:147], v[104:107], v[56:59]
    s_barrier
    ds_read_b64_tr_b16 v[120:121], v168 offset:53248
    v_add_f32 v230, v230, v234
    v_mfma_f32_16x16x32_bf16 v[60:63], a[148:151], v[104:107], v[60:63]
    ds_read_b64_tr_b16 v[122:123], v168 offset:55296
    ds_read_b64_tr_b16 a[216:217], v203 offset:37248
    v_mfma_f32_16x16x32_bf16 v[64:67], a[152:155], v[104:107], v[64:67]
    s_add_u32 s62, s62, 4096
    ds_read_b64_tr_b16 v[124:125], v169 offset:53248
    v_add_f32 v231, v231, v235
    v_mul_f32 v230, 0x3acccccd, v230
    v_mul_f32 v234, v230, v230
    v_mfma_f32_16x16x32_bf16 v[68:71], a[144:147], v[108:111], v[68:71]
    ds_read_b64_tr_b16 a[218:219], v203 offset:38784
    buffer_load_dwordx4 v[152:155], v248, s[36:39], s62 offen offset:0 sc1
    v_mfma_f32_16x16x32_bf16 v[72:75], a[148:151], v[108:111], v[72:75]
    ds_read_b64_tr_b16 v[126:127], v169 offset:55296
    ds_read_b64_tr_b16 a[220:221], v203 offset:43472
    v_mfma_f32_16x16x32_bf16 v[76:79], a[152:155], v[108:111], v[76:79]
    s_waitcnt lgkmcnt(9)
    ds_read_b64_tr_b16 v[128:129], v170 offset:53248
    ds_read_b64_tr_b16 a[222:223], v203 offset:45008
    v_mfma_f32_16x16x32_bf16 v[80:83], a[144:147], v[112:115], v[80:83]
    ds_read_b64_tr_b16 v[130:131], v170 offset:55296
    v_mov_b32 v224, 0x3acccccd
    v_fma_f32 v231, v231, v224, -v234
    v_max_f32 v231, 0, v231
    v_mfma_f32_16x16x32_bf16 v[84:87], a[148:151], v[112:115], v[84:87]
    ds_read_b64_tr_b16 a[224:225], v204 offset:37248
    buffer_load_dwordx4 v[156:159], v248, s[36:39], s62 offen offset:1024 sc1
    v_mfma_f32_16x16x32_bf16 v[88:91], a[152:155], v[112:115], v[88:91]
    s_waitcnt lgkmcnt(11)
    ds_read_b64_tr_b16 v[132:133], v171 offset:53248
    v_min_u32 v247, 23, v1
    v_mfma_f32_16x16x32_bf16 v[92:95], a[144:147], v[116:119], v[92:95]
    s_waitcnt lgkmcnt(3)
    ds_read_b64_tr_b16 v[134:135], v171 offset:55296
    v_lshlrev_b32 v247, 4, v247
    v_mfma_f32_16x16x32_bf16 v[96:99], a[148:151], v[116:119], v[96:99]
    ds_read_b64_tr_b16 a[226:227], v204 offset:38784
    v_add_f32 v231, 0x3727c5ac, v231
    v_rsq_f32 v224, v231
    v_mfma_f32_16x16x32_bf16 v[100:103], a[152:155], v[116:119], v[100:103]
    buffer_load_dwordx4 v[160:163], v248, s[36:39], s62 offen offset:2048 sc1
    v_mfma_f32_16x16x32_bf16 v[56:59], a[156:159], v[120:123], v[56:59]
    ds_read_b64_tr_b16 v[104:105], v168 offset:57344
    v_mul_f32_e64 v226, -v230, v224
    v_mfma_f32_16x16x32_bf16 v[60:63], a[160:163], v[120:123], v[60:63]
    ds_read_b64_tr_b16 v[106:107], v168 offset:59392
    s_mov_b64 exec, 0xf
    buffer_store_dwordx4 v[224:227], v248, s[36:39], s7 offen sc1
    s_mov_b64 exec, -1
    v_mfma_f32_16x16x32_bf16 v[64:67], a[164:167], v[120:123], v[64:67]
    ds_read_b64_tr_b16 v[108:109], v169 offset:57344
    v_mfma_f32_16x16x32_bf16 v[68:71], a[156:159], v[124:127], v[68:71]
    buffer_load_dwordx4 v[164:167], v248, s[36:39], s62 offen offset:3072 sc1
    v_mfma_f32_16x16x32_bf16 v[72:75], a[160:163], v[124:127], v[72:75]
    ds_read_b64_tr_b16 v[110:111], v169 offset:59392
    s_waitcnt vmcnt(8)
    v_cmp_ne_u32 vcc, s48, v240
    s_cbranch_vccnz L_chk26_slow
L_chk26_back:
    v_mfma_f32_16x16x32_bf16 v[76:79], a[164:167], v[124:127], v[76:79]
    s_waitcnt lgkmcnt(8)
    ds_read_b64_tr_b16 v[112:113], v170 offset:57344
    v_mfma_f32_16x16x32_bf16 v[80:83], a[156:159], v[128:131], v[80:83]
    s_waitcnt lgkmcnt(5)
    s_barrier
    s_add_u32 m0, s63, 81920
    ds_read_b64_tr_b16 v[114:115], v170 offset:59392
    v_mfma_f32_16x16x32_bf16 v[84:87], a[160:163], v[128:131], v[84:87]
    ds_read_b64_tr_b16 a[228:229], v203 offset:49664
    buffer_load_dwordx4 v172, s[36:39], s10 offen sc1 lds
    v_mfma_f32_16x16x32_bf16 v[88:91], a[164:167], v[128:131], v[88:91]
    ds_read_b64_tr_b16 v[116:117], v171 offset:57344
    ds_read_b64_tr_b16 a[230:231], v203 offset:51200
    v_mfma_f32_16x16x32_bf16 v[92:95], a[156:159], v[132:135], v[92:95]
    s_waitcnt lgkmcnt(3)
    s_add_u32 m0, s63, 5120
    ds_read_b64_tr_b16 v[118:119], v171 offset:59392
    v_mfma_f32_16x16x32_bf16 v[96:99], a[160:163], v[132:135], v[96:99]
    buffer_load_dwordx4 v247, s[36:39], s9 offen sc1 lds
    v_mfma_f32_16x16x32_bf16 v[100:103], a[164:167], v[132:135], v[100:103]
    s_add_u32 m0, s63, 86016
    ds_read_b64_tr_b16 a[232:233], v203 offset:55888
    v_mfma_f32_16x16x32_bf16 v[56:59], a[168:171], v[104:107], v[56:59]
    ds_read_b64_tr_b16 v[120:121], v168 offset:61440
    ds_read_b64_tr_b16 a[234:235], v203 offset:57424
    buffer_load_dwordx4 v172, s[36:39], s11 offen sc1 lds
    v_mfma_f32_16x16x32_bf16 v[60:63], a[172:175], v[104:107], v[60:63]
    ds_read_b64_tr_b16 v[122:123], v168 offset:63488
    v_add_u32 v168, 65536, v168
    v_mfma_f32_16x16x32_bf16 v[64:67], a[176:179], v[104:107], v[64:67]
    s_add_u32 m0, s63, 90112
    ds_read_b64_tr_b16 v[124:125], v169 offset:61440
    ds_read_b64_tr_b16 a[236:237], v204 offset:49664
    v_mfma_f32_16x16x32_bf16 v[68:71], a[168:171], v[108:111], v[68:71]
    ds_read_b64_tr_b16 a[238:239], v204 offset:51200
    buffer_load_dwordx4 v172, s[36:39], s12 offen sc1 lds
    v_mfma_f32_16x16x32_bf16 v[72:75], a[172:175], v[108:111], v[72:75]
    ds_read_b64_tr_b16 v[126:127], v169 offset:63488
    v_add_u32 v169, 65536, v169
    v_mfma_f32_16x16x32_bf16 v[76:79], a[176:179], v[108:111], v[76:79]
    ds_read_b64_tr_b16 v[128:129], v170 offset:61440
    v_mfma_f32_16x16x32_bf16 v[80:83], a[168:171], v[112:115], v[80:83]
    s_add_u32 m0, s63, 94208
    ds_read_b64_tr_b16 v[130:131], v170 offset:63488
    v_add_u32 v170, 65536, v170
    v_mfma_f32_16x16x32_bf16 v[84:87], a[172:175], v[112:115], v[84:87]
    buffer_load_dwordx4 v172, s[36:39], s13 offen sc1 lds
    v_mfma_f32_16x16x32_bf16 v[88:91], a[176:179], v[112:115], v[88:91]
    s_waitcnt lgkmcnt(10)
    ds_read_b64_tr_b16 v[132:133], v171 offset:61440
    v_mfma_f32_16x16x32_bf16 v[92:95], a[168:171], v[116:119], v[92:95]
    s_waitcnt lgkmcnt(3)
    ds_read_b64_tr_b16 v[134:135], v171 offset:63488
    v_add_u32 v171, 65536, v171
    v_mfma_f32_16x16x32_bf16 v[96:99], a[172:175], v[116:119], v[96:99]
    s_add_u32 m0, s63, 98304
    v_mfma_f32_16x16x32_bf16 v[100:103], a[176:179], v[116:119], v[100:103]
    buffer_load_dwordx4 v172, s[36:39], s14 offen sc1 lds
    v_mfma_f32_16x16x32_bf16 v[56:59], a[180:183], v[120:123], v[56:59]
    s_barrier
    ds_read_b64_tr_b16 v[104:105], v168 offset:0
    v_mfma_f32_16x16x32_bf16 v[60:63], a[184:187], v[120:123], v[60:63]
    ds_read_b64_tr_b16 v[106:107], v168 offset:2048
    v_mfma_f32_16x16x32_bf16 v[64:67], a[188:191], v[120:123], v[64:67]
    s_add_u32 m0, s63, 102400
    ds_read_b64_tr_b16 v[108:109], v169 offset:0
    v_mfma_f32_16x16x32_bf16 v[68:71], a[180:183], v[124:127], v[68:71]
    buffer_load_dwordx4 v172, s[36:39], s15 offen sc1 lds
    v_mfma_f32_16x16x32_bf16 v[72:75], a[184:187], v[124:127], v[72:75]
    ds_read_b64_tr_b16 v[110:111], v169 offset:2048
    v_mfma_f32_16x16x32_bf16 v[76:79], a[188:191], v[124:127], v[76:79]
    s_waitcnt lgkmcnt(6)
    ds_read_b64_tr_b16 v[112:113], v170 offset:0
    v_mfma_f32_16x16x32_bf16 v[80:83], a[180:183], v[128:131], v[80:83]
    s_add_u32 m0, s63, 106496
    ds_read_b64_tr_b16 v[114:115], v170 offset:2048
    v_mfma_f32_16x16x32_bf16 v[84:87], a[184:187], v[128:131], v[84:87]
    buffer_load_dwordx4 v172, s[36:39], s18 offen sc1 lds
    v_mfma_f32_16x16x32_bf16 v[88:91], a[188:191], v[128:131], v[88:91]
    s_waitcnt lgkmcnt(6)
    ds_read_b64_tr_b16 v[116:117], v171 offset:0
    v_mfma_f32_16x16x32_bf16 v[92:95], a[180:183], v[132:135], v[92:95]
    s_waitcnt lgkmcnt(3)
    ds_read_b64_tr_b16 v[118:119], v171 offset:2048
    v_mfma_f32_16x16x32_bf16 v[96:99], a[184:187], v[132:135], v[96:99]
    s_add_u32 m0, s63, 110592
    v_mfma_f32_16x16x32_bf16 v[100:103], a[188:191], v[132:135], v[100:103]
    buffer_load_dwordx4 v172, s[36:39], s19 offen sc1 lds
    v_mfma_f32_16x16x32_bf16 v[56:59], a[192:195], v[104:107], v[56:59]
    ds_read_b64_tr_b16 v[120:121], v168 offset:4096
    v_mfma_f32_16x16x32_bf16 v[60:63], a[196:199], v[104:107], v[60:63]
    ds_read_b64_tr_b16 v[122:123], v168 offset:6144
    v_mfma_f32_16x16x32_bf16 v[64:67], a[200:203], v[104:107], v[64:67]
    s_add_u32 m0, s63, 114688
    ds_read_b64_tr_b16 v[124:125], v169 offset:4096
    v_mfma_f32_16x16x32_bf16 v[68:71], a[192:195], v[108:111], v[68:71]
    buffer_load_dwordx4 v172, s[36:39], s20 offen sc1 lds
    v_mfma_f32_16x16x32_bf16 v[72:75], a[196:199], v[108:111], v[72:75]
    ds_read_b64_tr_b16 v[126:127], v169 offset:6144
    v_mfma_f32_16x16x32_bf16 v[76:79], a[200:203], v[108:111], v[76:79]
    s_waitcnt lgkmcnt(6)
    ds_read_b64_tr_b16 v[128:129], v170 offset:4096
    v_mfma_f32_16x16x32_bf16 v[80:83], a[192:195], v[112:115], v[80:83]
    s_add_u32 m0, s63, 118784
    ds_read_b64_tr_b16 v[130:131], v170 offset:6144
    v_mfma_f32_16x16x32_bf16 v[84:87], a[196:199], v[112:115], v[84:87]
    buffer_load_dwordx4 v172, s[36:39], s21 offen sc1 lds
    v_mfma_f32_16x16x32_bf16 v[88:91], a[200:203], v[112:115], v[88:91]
    s_waitcnt lgkmcnt(6)
    ds_read_b64_tr_b16 v[132:133], v171 offset:4096
    v_mfma_f32_16x16x32_bf16 v[92:95], a[192:195], v[116:119], v[92:95]
    s_waitcnt lgkmcnt(3)
    ds_read_b64_tr_b16 v[134:135], v171 offset:6144
    v_mfma_f32_16x16x32_bf16 v[96:99], a[196:199], v[116:119], v[96:99]
    s_add_u32 m0, s63, 122880
    v_mfma_f32_16x16x32_bf16 v[100:103], a[200:203], v[116:119], v[100:103]
    buffer_load_dwordx4 v172, s[36:39], s22 offen sc1 lds
    v_mfma_f32_16x16x32_bf16 v[56:59], a[204:207], v[120:123], v[56:59]
    ds_read_b64_tr_b16 v[104:105], v168 offset:8192
    v_mfma_f32_16x16x32_bf16 v[60:63], a[208:211], v[120:123], v[60:63]
    ds_read_b64_tr_b16 v[106:107], v168 offset:10240
    v_mfma_f32_16x16x32_bf16 v[64:67], a[212:215], v[120:123], v[64:67]
    s_add_u32 m0, s63, 126976
    ds_read_b64_tr_b16 v[108:109], v169 offset:8192
    v_mfma_f32_16x16x32_bf16 v[68:71], a[204:207], v[124:127], v[68:71]
    buffer_load_dwordx4 v172, s[36:39], s23 offen sc1 lds
    v_mfma_f32_16x16x32_bf16 v[72:75], a[208:211], v[124:127], v[72:75]
    ds_read_b64_tr_b16 v[110:111], v169 offset:10240
    v_mfma_f32_16x16x32_bf16 v[76:79], a[212:215], v[124:127], v[76:79]
    s_waitcnt lgkmcnt(6)
    ds_read_b64_tr_b16 v[112:113], v170 offset:8192
    v_mfma_f32_16x16x32_bf16 v[80:83], a[204:207], v[128:131], v[80:83]
    s_add_u32 m0, s63, 1024
    ds_read_b64_tr_b16 v[114:115], v170 offset:10240
    v_mfma_f32_16x16x32_bf16 v[84:87], a[208:211], v[128:131], v[84:87]
    buffer_load_dwordx4 v248, s[36:39], s6 offen sc1 lds
    v_mfma_f32_16x16x32_bf16 v[88:91], a[212:215], v[128:131], v[88:91]
    s_waitcnt lgkmcnt(6)
    ds_read_b64_tr_b16 v[116:117], v171 offset:8192
    v_mfma_f32_16x16x32_bf16 v[92:95], a[204:207], v[132:135], v[92:95]
    s_waitcnt lgkmcnt(3)
    ds_read_b64_tr_b16 v[118:119], v171 offset:10240
    v_mfma_f32_16x16x32_bf16 v[96:99], a[208:211], v[132:135], v[96:99]
    s_add_u32 m0, s63, 131072
    v_mfma_f32_16x16x32_bf16 v[100:103], a[212:215], v[132:135], v[100:103]
    buffer_load_dwordx4 v172, s[36:39], s24 offen sc1 lds
    v_mfma_f32_16x16x32_bf16 v[56:59], a[216:219], v[104:107], v[56:59]
    ds_read_b64_tr_b16 v[120:121], v168 offset:12288
    v_mfma_f32_16x16x32_bf16 v[60:63], a[220:223], v[104:107], v[60:63]
    ds_read_b64_tr_b16 v[122:123], v168 offset:14336
    v_add_u32 v168, 16384, v168
    v_mfma_f32_16x16x32_bf16 v[64:67], a[224:227], v[104:107], v[64:67]
    s_add_u32 m0, s63, 135168
    ds_read_b64_tr_b16 v[124:125], v169 offset:12288
    v_and_b32 v247, 48, v1
    v_mfma_f32_16x16x32_bf16 v[68:71], a[216:219], v[108:111], v[68:71]
    v_add_u32 v247, s63, v247
    buffer_load_dwordx4 v172, s[36:39], s25 offen sc1 lds
    v_mfma_f32_16x16x32_bf16 v[72:75], a[220:223], v[108:111], v[72:75]
    s_waitcnt vmcnt(14)
    ds_read_b64_tr_b16 v[126:127], v169 offset:14336
    v_add_u32 v169, 16384, v169
    v_mfma_f32_16x16x32_bf16 v[76:79], a[224:227], v[108:111], v[76:79]
    s_waitcnt lgkmcnt(6)
    ds_read_b64_tr_b16 v[128:129], v170 offset:12288
    ds_read_b128 v[176:179], v247 offset:5120
    v_mfma_f32_16x16x32_bf16 v[80:83], a[216:219], v[112:115], v[80:83]
    s_add_u32 m0, s63, 139264
    ds_read_b64_tr_b16 v[130:131], v170 offset:14336
    v_add_u32 v170, 16384, v170
    v_mfma_f32_16x16x32_bf16 v[84:87], a[220:223], v[112:115], v[84:87]
    ds_read_b128 v[180:183], v247 offset:5184
    buffer_load_dwordx4 v172, s[36:39], s26 offen sc1 lds
    v_mfma_f32_16x16x32_bf16 v[88:91], a[224:227], v[112:115], v[88:91]
    s_waitcnt lgkmcnt(8)
    ds_read_b64_tr_b16 v[132:133], v171 offset:12288
    ds_read_b128 v[184:187], v247 offset:5248
    v_mfma_f32_16x16x32_bf16 v[92:95], a[216:219], v[116:119], v[92:95]
    s_waitcnt lgkmcnt(3)
    ds_read_b64_tr_b16 v[134:135], v171 offset:14336
    v_add_u32 v171, 16384, v171
    v_mfma_f32_16x16x32_bf16 v[96:99], a[220:223], v[116:119], v[96:99]
    s_add_u32 m0, s63, 143360
    ds_read_b128 v[188:191], v247 offset:5312
    v_mfma_f32_16x16x32_bf16 v[100:103], a[224:227], v[116:119], v[100:103]
    ds_read_b128 v[192:195], v247 offset:5376
    buffer_load_dwordx4 v172, s[36:39], s27 offen sc1 lds
    v_mfma_f32_16x16x32_bf16 v[56:59], a[228:231], v[120:123], v[56:59]
    s_waitcnt vmcnt(15)
    s_barrier
    ds_read_b64_tr_b16 v[104:105], v168 offset:0
    v_mfma_f32_16x16x32_bf16 v[60:63], a[232:235], v[120:123], v[60:63]
    ds_read_b64_tr_b16 v[106:107], v168 offset:2048
    ds_read_b128 v[196:199], v247 offset:5440
    v_mfma_f32_16x16x32_bf16 v[64:67], a[236:239], v[120:123], v[64:67]
    s_add_u32 m0, s63, 147456
    ds_read_b64_tr_b16 v[108:109], v169 offset:0
    v_mfma_f32_16x16x32_bf16 v[68:71], a[228:231], v[124:127], v[68:71]
    buffer_load_dwordx4 v172, s[36:39], s44 offen sc1 lds
    v_mfma_f32_16x16x32_bf16 v[72:75], a[232:235], v[124:127], v[72:75]
    ds_read_b64_tr_b16 v[110:111], v169 offset:2048
    v_mfma_f32_16x16x32_bf16 v[76:79], a[236:239], v[124:127], v[76:79]
    ds_read_b64_tr_b16 v[112:113], v170 offset:0
    v_mfma_f32_16x16x32_bf16 v[80:83], a[228:231], v[128:131], v[80:83]
    s_add_u32 m0, s63, 151552
    ds_read_b64_tr_b16 v[114:115], v170 offset:2048
    v_mfma_f32_16x16x32_bf16 v[84:87], a[232:235], v[128:131], v[84:87]
    buffer_load_dwordx4 v172, s[36:39], s45 offen sc1 lds
    v_mfma_f32_16x16x32_bf16 v[88:91], a[236:239], v[128:131], v[88:91]
    s_waitcnt lgkmcnt(9)
    ds_read_b64_tr_b16 v[116:117], v171 offset:0
    v_mfma_f32_16x16x32_bf16 v[92:95], a[228:231], v[132:135], v[92:95]
    s_waitcnt lgkmcnt(3)
    ds_read_b64_tr_b16 v[118:119], v171 offset:2048
    v_mfma_f32_16x16x32_bf16 v[96:99], a[232:235], v[132:135], v[96:99]
    v_mfma_f32_16x16x32_bf16 v[100:103], a[236:239], v[132:135], v[100:103]
    v_mfma_f32_16x16x32_bf16 v[8:11], a[0:3], v[104:107], 0
    ds_read_b64_tr_b16 v[120:121], v168 offset:4096
    v_add_u32 v216, 81920, v216
    v_mfma_f32_16x16x32_bf16 v[12:15], a[4:7], v[104:107], 0
    ds_read_b64_tr_b16 v[122:123], v168 offset:6144
    v_add_u32 v217, 81920, v217
    v_mfma_f32_16x16x32_bf16 v[16:19], a[8:11], v[104:107], 0
    s_add_u32 m0, s63, 155648
    ds_read_b64_tr_b16 v[124:125], v169 offset:4096
    v_add_u32 v218, 81920, v218
    v_mfma_f32_16x16x32_bf16 v[20:23], a[0:3], v[108:111], 0
    buffer_load_dwordx4 v172, s[36:39], s46 offen sc1 lds
    v_mfma_f32_16x16x32_bf16 v[24:27], a[4:7], v[108:111], 0
    ds_read_b64_tr_b16 v[126:127], v169 offset:6144
    v_mfma_f32_16x16x32_bf16 v[28:31], a[8:11], v[108:111], 0
    s_waitcnt lgkmcnt(6)
    ds_read_b64_tr_b16 v[128:129], v170 offset:4096
    v_mfma_f32_16x16x32_bf16 v[32:35], a[0:3], v[112:115], 0
    s_add_u32 m0, s63, 159744
    ds_read_b64_tr_b16 v[130:131], v170 offset:6144
    v_mfma_f32_16x16x32_bf16 v[36:39], a[4:7], v[112:115], 0
    buffer_load_dwordx4 v172, s[36:39], s47 offen sc1 lds
    v_mfma_f32_16x16x32_bf16 v[40:43], a[8:11], v[112:115], 0
    s_waitcnt lgkmcnt(6)
    ds_read_b64_tr_b16 v[132:133], v171 offset:4096
    v_mfma_f32_16x16x32_bf16 v[44:47], a[0:3], v[116:119], 0
    s_waitcnt lgkmcnt(3)
    ds_read_b64_tr_b16 v[134:135], v171 offset:6144
    v_mfma_f32_16x16x32_bf16 v[48:51], a[4:7], v[116:119], 0
    v_mfma_f32_16x16x32_bf16 v[52:55], a[8:11], v[116:119], 0
    v_mfma_f32_16x16x32_bf16 v[8:11], a[12:15], v[120:123], v[8:11]
    s_waitcnt vmcnt(16)
    s_barrier
    ds_read_b64_tr_b16 v[104:105], v168 offset:8192
    v_mfma_f32_16x16x32_bf16 v[12:15], a[16:19], v[120:123], v[12:15]
    ds_read_b64_tr_b16 v[106:107], v168 offset:10240
    v_mfma_f32_16x16x32_bf16 v[16:19], a[20:23], v[120:123], v[16:19]
    s_waitcnt vmcnt(8)
    s_add_u32 s62, s62, 4096
    ds_read_b64_tr_b16 v[108:109], v169 offset:8192
    v_mfma_f32_16x16x32_bf16 v[20:23], a[12:15], v[124:127], v[20:23]
    ds_read_b128 v[200:203], v175 offset:1024
    buffer_load_dwordx4 a[0:3], v248, s[36:39], s62 offen offset:0 sc1
    v_mfma_f32_16x16x32_bf16 v[24:27], a[16:19], v[124:127], v[24:27]
    ds_read_b64_tr_b16 v[110:111], v169 offset:10240
    ds_read_b128 v[204:207], v175 offset:1280
    v_mfma_f32_16x16x32_bf16 v[28:31], a[20:23], v[124:127], v[28:31]
    s_waitcnt lgkmcnt(8)
    ds_read_b64_tr_b16 v[112:113], v170 offset:8192
    ds_read_b128 v[208:211], v175 offset:1536
    v_mfma_f32_16x16x32_bf16 v[32:35], a[12:15], v[128:131], v[32:35]
    ds_read_b64_tr_b16 v[114:115], v170 offset:10240
    v_mfma_f32_16x16x32_bf16 v[36:39], a[16:19], v[128:131], v[36:39]
    ds_read_b128 v[212:215], v175 offset:1792
    buffer_load_dwordx4 a[4:7], v248, s[36:39], s62 offen offset:1024 sc1
    v_mfma_f32_16x16x32_bf16 v[40:43], a[20:23], v[128:131], v[40:43]
    s_waitcnt lgkmcnt(10)
    ds_read_b64_tr_b16 v[116:117], v171 offset:8192
    v_mfma_f32_16x16x32_bf16 v[44:47], a[12:15], v[132:135], v[44:47]
    s_waitcnt lgkmcnt(3)
    ds_read_b64_tr_b16 v[118:119], v171 offset:10240
    v_mfma_f32_16x16x32_bf16 v[48:51], a[16:19], v[132:135], v[48:51]
    v_xor_b32 v3, s48, v201
    v_bitop3_b32 v3, v203, s48, v3 bitop3:0xbe
    v_mfma_f32_16x16x32_bf16 v[52:55], a[20:23], v[132:135], v[52:55]
    buffer_load_dwordx4 a[8:11], v248, s[36:39], s62 offen offset:2048 sc1
    v_mfma_f32_16x16x32_bf16 v[8:11], a[24:27], v[104:107], v[8:11]
    ds_read_b64_tr_b16 v[120:121], v168 offset:12288
    v_bitop3_b32 v3, v205, s48, v3 bitop3:0xbe
    v_mfma_f32_16x16x32_bf16 v[12:15], a[28:31], v[104:107], v[12:15]
    ds_read_b64_tr_b16 v[122:123], v168 offset:14336
    v_bitop3_b32 v3, v207, s48, v3 bitop3:0xbe
    v_bitop3_b32 v3, v209, s48, v3 bitop3:0xbe
    v_mfma_f32_16x16x32_bf16 v[16:19], a[32:35], v[104:107], v[16:19]
    ds_read_b64_tr_b16 v[124:125], v169 offset:12288
    v_bitop3_b32 v3, v211, s48, v3 bitop3:0xbe
    v_mfma_f32_16x16x32_bf16 v[20:23], a[24:27], v[108:111], v[20:23]
    s_waitcnt lgkmcnt(5)
    v_bitop3_b32 v3, v213, s48, v3 bitop3:0xbe
    buffer_load_dwordx4 a[12:15], v248, s[36:39], s62 offen offset:3072 sc1
    v_mfma_f32_16x16x32_bf16 v[24:27], a[28:31], v[108:111], v[24:27]
    ds_read_b64_tr_b16 v[126:127], v169 offset:14336
    v_bitop3_b32 v3, v215, s48, v3 bitop3:0xbe
    v_mfma_f32_16x16x32_bf16 v[28:31], a[32:35], v[108:111], v[28:31]
    ds_read_b64_tr_b16 v[128:129], v170 offset:12288
    v_cmp_ne_u32 vcc, 0, v3
    s_cbranch_vccnz L_stp0_slow
L_stp0_back:
    v_mfma_f32_16x16x32_bf16 v[32:35], a[24:27], v[112:115], v[32:35]
    s_add_u32 s62, s62, 4096
    ds_read_b64_tr_b16 v[130:131], v170 offset:14336
    s_add_u32 s50, s8, 98304
    v_pk_fma_f32 v[238:239], v[176:177], v[202:203], v[188:189] op_sel_hi:[1,0,1]
    v_pk_fma_f32 v[240:241], v[178:179], v[202:203], v[190:191] op_sel_hi:[1,0,1]
    v_pk_fma_f32 v[56:57], v[56:57], v[200:201], v[238:239] op_sel_hi:[1,0,1]
    v_pk_fma_f32 v[58:59], v[58:59], v[200:201], v[240:241] op_sel_hi:[1,0,1]
    v_pk_fma_f32 v[242:243], v[180:181], v[202:203], v[192:193] op_sel_hi:[1,0,1]
    v_pk_fma_f32 v[244:245], v[182:183], v[202:203], v[194:195] op_sel_hi:[1,0,1]
    v_pk_fma_f32 v[60:61], v[60:61], v[200:201], v[242:243] op_sel_hi:[1,0,1]
    v_pk_fma_f32 v[62:63], v[62:63], v[200:201], v[244:245] op_sel_hi:[1,0,1]
    v_pk_mul_f32 v[56:57], v[56:57], v[60:61]
    v_pk_mul_f32 v[58:59], v[58:59], v[62:63]
    v_cvt_pk_bf16_f32 v60, v56, v57
    v_cvt_pk_bf16_f32 v61, v58, v59
    v_pk_fma_f32 v[242:243], v[176:177], v[206:207], v[188:189] op_sel_hi:[1,0,1]
    v_pk_fma_f32 v[244:245], v[178:179], v[206:207], v[190:191] op_sel_hi:[1,0,1]
    v_pk_fma_f32 v[68:69], v[68:69], v[204:205], v[242:243] op_sel_hi:[1,0,1]
    v_pk_fma_f32 v[70:71], v[70:71], v[204:205], v[244:245] op_sel_hi:[1,0,1]
    v_pk_fma_f32 v[238:239], v[180:181], v[206:207], v[192:193] op_sel_hi:[1,0,1]
    v_pk_fma_f32 v[240:241], v[182:183], v[206:207], v[194:195] op_sel_hi:[1,0,1]
    v_pk_fma_f32 v[72:73], v[72:73], v[204:205], v[238:239] op_sel_hi:[1,0,1]
    v_pk_fma_f32 v[74:75], v[74:75], v[204:205], v[240:241] op_sel_hi:[1,0,1]
    v_pk_mul_f32 v[68:69], v[68:69], v[72:73]
    v_pk_mul_f32 v[70:71], v[70:71], v[74:75]
    v_cvt_pk_bf16_f32 v62, v68, v69
    v_cvt_pk_bf16_f32 v63, v70, v71
    s_nop 0
    v_permlane16_swap_b32 v60, v62
    v_permlane16_swap_b32 v61, v63
    buffer_store_dwordx4 v[60:63], v173, s[36:39], s8 offen sc1
    v_pk_fma_f32 v[238:239], v[176:177], v[210:211], v[188:189] op_sel_hi:[1,0,1]
    v_pk_fma_f32 v[240:241], v[178:179], v[210:211], v[190:191] op_sel_hi:[1,0,1]
    v_pk_fma_f32 v[80:81], v[80:81], v[208:209], v[238:239] op_sel_hi:[1,0,1]
    v_pk_fma_f32 v[82:83], v[82:83], v[208:209], v[240:241] op_sel_hi:[1,0,1]
    v_pk_fma_f32 v[242:243], v[180:181], v[210:211], v[192:193] op_sel_hi:[1,0,1]
    v_pk_fma_f32 v[244:245], v[182:183], v[210:211], v[194:195] op_sel_hi:[1,0,1]
    v_pk_fma_f32 v[84:85], v[84:85], v[208:209], v[242:243] op_sel_hi:[1,0,1]
    v_pk_fma_f32 v[86:87], v[86:87], v[208:209], v[244:245] op_sel_hi:[1,0,1]
    v_pk_mul_f32 v[80:81], v[80:81], v[84:85]
    v_pk_mul_f32 v[82:83], v[82:83], v[86:87]
    v_cvt_pk_bf16_f32 v84, v80, v81
    v_cvt_pk_bf16_f32 v85, v82, v83
    v_pk_fma_f32 v[242:243], v[176:177], v[214:215], v[188:189] op_sel_hi:[1,0,1]
    v_pk_fma_f32 v[244:245], v[178:179], v[214:215], v[190:191] op_sel_hi:[1,0,1]
    v_pk_fma_f32 v[92:93], v[92:93], v[212:213], v[242:243] op_sel_hi:[1,0,1]
    v_pk_fma_f32 v[94:95], v[94:95], v[212:213], v[244:245] op_sel_hi:[1,0,1]
    v_pk_fma_f32 v[238:239], v[180:181], v[214:215], v[192:193] op_sel_hi:[1,0,1]
    v_pk_fma_f32 v[240:241], v[182:183], v[214:215], v[194:195] op_sel_hi:[1,0,1]
    v_pk_fma_f32 v[96:97], v[96:97], v[212:213], v[238:239] op_sel_hi:[1,0,1]
    v_pk_fma_f32 v[98:99], v[98:99], v[212:213], v[240:241] op_sel_hi:[1,0,1]
    v_pk_mul_f32 v[92:93], v[92:93], v[96:97]
    v_pk_mul_f32 v[94:95], v[94:95], v[98:99]
    v_cvt_pk_bf16_f32 v86, v92, v93
    v_cvt_pk_bf16_f32 v87, v94, v95
    s_nop 0
    v_permlane16_swap_b32 v84, v86
    v_permlane16_swap_b32 v85, v87
    buffer_store_dwordx4 v[84:87], v173, s[36:39], s50 offen sc1
    v_pk_fma_f32 v[238:239], v[184:185], v[202:203], v[196:197] op_sel_hi:[1,0,1]
    v_pk_fma_f32 v[240:241], v[186:187], v[202:203], v[198:199] op_sel_hi:[1,0,1]
    v_pk_fma_f32 v[64:65], v[64:65], v[200:201], v[238:239] op_sel_hi:[1,0,1]
    v_pk_fma_f32 v[66:67], v[66:67], v[200:201], v[240:241] op_sel_hi:[1,0,1]
    v_pk_fma_f32 v[242:243], v[184:185], v[206:207], v[196:197] op_sel_hi:[1,0,1]
    v_pk_fma_f32 v[244:245], v[186:187], v[206:207], v[198:199] op_sel_hi:[1,0,1]
    v_pk_fma_f32 v[76:77], v[76:77], v[204:205], v[242:243] op_sel_hi:[1,0,1]
    v_pk_fma_f32 v[78:79], v[78:79], v[204:205], v[244:245] op_sel_hi:[1,0,1]
    s_nop 0
    v_permlane32_swap_b32 v64, v76
    v_permlane32_swap_b32 v65, v77
    v_permlane32_swap_b32 v66, v78
    v_permlane32_swap_b32 v67, v79
    v_pk_mul_f32 v[64:65], v[64:65], v[76:77]
    v_pk_mul_f32 v[66:67], v[66:67], v[78:79]
    v_cvt_pk_bf16_f32 v56, v64, v65
    v_cvt_pk_bf16_f32 v57, v66, v67
    v_pk_fma_f32 v[238:239], v[184:185], v[210:211], v[196:197] op_sel_hi:[1,0,1]
    v_pk_fma_f32 v[240:241], v[186:187], v[210:211], v[198:199] op_sel_hi:[1,0,1]
    v_pk_fma_f32 v[88:89], v[88:89], v[208:209], v[238:239] op_sel_hi:[1,0,1]
    v_pk_fma_f32 v[90:91], v[90:91], v[208:209], v[240:241] op_sel_hi:[1,0,1]
    v_pk_fma_f32 v[242:243], v[184:185], v[214:215], v[196:197] op_sel_hi:[1,0,1]
    v_pk_fma_f32 v[244:245], v[186:187], v[214:215], v[198:199] op_sel_hi:[1,0,1]
    v_pk_fma_f32 v[100:101], v[100:101], v[212:213], v[242:243] op_sel_hi:[1,0,1]
    v_pk_fma_f32 v[102:103], v[102:103], v[212:213], v[244:245] op_sel_hi:[1,0,1]
    s_nop 0
    v_permlane32_swap_b32 v88, v100
    v_permlane32_swap_b32 v89, v101
    v_permlane32_swap_b32 v90, v102
    v_permlane32_swap_b32 v91, v103
    v_pk_mul_f32 v[88:89], v[88:89], v[100:101]
    v_pk_mul_f32 v[90:91], v[90:91], v[102:103]
    v_cvt_pk_bf16_f32 v58, v88, v89
    v_cvt_pk_bf16_f32 v59, v90, v91
    s_nop 0
    v_permlane16_swap_b32 v56, v58
    v_permlane16_swap_b32 v57, v59
    buffer_store_dwordx4 v[56:59], v174, s[36:39], s8 offen offset:512 sc1
    s_add_u32 s6, s6, 16384
    s_lshl_b32 s76, s72, 4
    s_add_u32 s76, s76, s73
    v_mfma_f32_16x16x32_bf16 v[36:39], a[28:31], v[112:115], v[36:39]
    buffer_load_dwordx4 a[16:19], v248, s[36:39], s62 offen offset:0 sc1
    v_mfma_f32_16x16x32_bf16 v[40:43], a[32:35], v[112:115], v[40:43]
    s_waitcnt lgkmcnt(6)
    ds_read_b64_tr_b16 v[132:133], v171 offset:12288
    v_mfma_f32_16x16x32_bf16 v[44:47], a[24:27], v[116:119], v[44:47]
    s_waitcnt lgkmcnt(3)
    ds_read_b64_tr_b16 v[134:135], v171 offset:14336
    v_mfma_f32_16x16x32_bf16 v[48:51], a[28:31], v[116:119], v[48:51]
    v_mfma_f32_16x16x32_bf16 v[52:55], a[32:35], v[116:119], v[52:55]
    buffer_load_dwordx4 a[20:23], v248, s[36:39], s62 offen offset:1024 sc1
    v_mfma_f32_16x16x32_bf16 v[8:11], a[36:39], v[120:123], v[8:11]
    ds_read_b64_tr_b16 v[104:105], v168 offset:16384
    v_mfma_f32_16x16x32_bf16 v[12:15], a[40:43], v[120:123], v[12:15]
    ds_read_b64_tr_b16 v[106:107], v168 offset:18432
    v_mfma_f32_16x16x32_bf16 v[16:19], a[44:47], v[120:123], v[16:19]
    ds_read_b64_tr_b16 v[108:109], v169 offset:16384
    v_mfma_f32_16x16x32_bf16 v[20:23], a[36:39], v[124:127], v[20:23]
    buffer_load_dwordx4 a[24:27], v248, s[36:39], s62 offen offset:2048 sc1
    v_mfma_f32_16x16x32_bf16 v[24:27], a[40:43], v[124:127], v[24:27]
    ds_read_b64_tr_b16 v[110:111], v169 offset:18432
    v_mfma_f32_16x16x32_bf16 v[28:31], a[44:47], v[124:127], v[28:31]
    s_waitcnt lgkmcnt(6)
    ds_read_b64_tr_b16 v[112:113], v170 offset:16384
    v_mfma_f32_16x16x32_bf16 v[32:35], a[36:39], v[128:131], v[32:35]
    ds_read_b64_tr_b16 v[114:115], v170 offset:18432
    v_mfma_f32_16x16x32_bf16 v[36:39], a[40:43], v[128:131], v[36:39]
    buffer_load_dwordx4 a[28:31], v248, s[36:39], s62 offen offset:3072 sc1
    v_mfma_f32_16x16x32_bf16 v[40:43], a[44:47], v[128:131], v[40:43]
    s_waitcnt lgkmcnt(6)
    ds_read_b64_tr_b16 v[116:117], v171 offset:16384
    v_mfma_f32_16x16x32_bf16 v[44:47], a[36:39], v[132:135], v[44:47]
    s_waitcnt lgkmcnt(3)
    ds_read_b64_tr_b16 v[118:119], v171 offset:18432
    v_mfma_f32_16x16x32_bf16 v[48:51], a[40:43], v[132:135], v[48:51]
    s_add_u32 s62, s62, 4096
    v_mfma_f32_16x16x32_bf16 v[52:55], a[44:47], v[132:135], v[52:55]
    buffer_load_dwordx4 a[32:35], v248, s[36:39], s62 offen offset:0 sc1
    v_mfma_f32_16x16x32_bf16 v[8:11], a[48:51], v[104:107], v[8:11]
    s_waitcnt vmcnt(12)
    s_barrier
    ds_read_b64_tr_b16 v[120:121], v168 offset:20480
    v_mfma_f32_16x16x32_bf16 v[12:15], a[52:55], v[104:107], v[12:15]
    ds_read_b64_tr_b16 v[122:123], v168 offset:22528
    ds_read_b64 v[224:225], v216
    v_mfma_f32_16x16x32_bf16 v[16:19], a[56:59], v[104:107], v[16:19]
    ds_read_b64_tr_b16 v[124:125], v169 offset:20480
    ds_read_b64 v[226:227], v217
    v_mfma_f32_16x16x32_bf16 v[20:23], a[48:51], v[108:111], v[20:23]
    buffer_load_dwordx4 a[36:39], v248, s[36:39], s62 offen offset:1024 sc1
    v_mfma_f32_16x16x32_bf16 v[24:27], a[52:55], v[108:111], v[24:27]
    ds_read_b64_tr_b16 v[126:127], v169 offset:22528
    ds_read_b64 v[228:229], v218
    v_mfma_f32_16x16x32_bf16 v[28:31], a[56:59], v[108:111], v[28:31]
    s_waitcnt lgkmcnt(9)
    ds_read_b64_tr_b16 v[128:129], v170 offset:20480
    v_mfma_f32_16x16x32_bf16 v[32:35], a[48:51], v[112:115], v[32:35]
    ds_read_b64_tr_b16 v[130:131], v170 offset:22528
    v_mfma_f32_16x16x32_bf16 v[36:39], a[52:55], v[112:115], v[36:39]
    buffer_load_dwordx4 a[40:43], v248, s[36:39], s62 offen offset:2048 sc1
    v_mfma_f32_16x16x32_bf16 v[40:43], a[56:59], v[112:115], v[40:43]
    s_waitcnt lgkmcnt(9)
    ds_read_b64_tr_b16 v[132:133], v171 offset:20480
    v_mfma_f32_16x16x32_bf16 v[44:47], a[48:51], v[116:119], v[44:47]
    s_waitcnt lgkmcnt(3)
    ds_read_b64_tr_b16 v[134:135], v171 offset:22528
    v_mfma_f32_16x16x32_bf16 v[48:51], a[52:55], v[116:119], v[48:51]
    v_lshlrev_b32 v230, 16, v224
    v_and_b32 v231, 0xffff0000, v224
    v_pk_mul_f32 v[230:231], v[230:231], v[220:221] op_sel_hi:[1,0]
    v_pk_mul_f32 v[234:235], v[230:231], v[230:231]
    v_lshlrev_b32 v232, 16, v225
    v_and_b32 v233, 0xffff0000, v225
    v_pk_mul_f32 v[232:233], v[232:233], v[220:221] op_sel_hi:[1,0]
    v_pk_mul_f32 v[236:237], v[232:233], v[232:233]
    v_lshlrev_b32 v2, 16, v226
    v_and_b32 v3, 0xffff0000, v226
    v_pk_mul_f32 v[2:3], v[2:3], v[220:221] op_sel:[0,1] op_sel_hi:[1,1]
    v_pk_add_f32 v[230:231], v[230:231], v[2:3]
    v_pk_fma_f32 v[234:235], v[2:3], v[2:3], v[234:235]
    v_lshlrev_b32 v2, 16, v227
    v_and_b32 v3, 0xffff0000, v227
    v_pk_mul_f32 v[2:3], v[2:3], v[220:221] op_sel:[0,1] op_sel_hi:[1,1]
    v_pk_add_f32 v[232:233], v[232:233], v[2:3]
    v_pk_fma_f32 v[236:237], v[2:3], v[2:3], v[236:237]
    v_lshlrev_b32 v2, 16, v228
    v_and_b32 v3, 0xffff0000, v228
    v_pk_mul_f32 v[2:3], v[2:3], v[222:223] op_sel_hi:[1,0]
    v_pk_add_f32 v[230:231], v[230:231], v[2:3]
    v_pk_fma_f32 v[234:235], v[2:3], v[2:3], v[234:235]
    v_lshlrev_b32 v2, 16, v229
    v_and_b32 v3, 0xffff0000, v229
    v_pk_mul_f32 v[2:3], v[2:3], v[222:223] op_sel_hi:[1,0]
    v_pk_add_f32 v[232:233], v[232:233], v[2:3]
    v_pk_fma_f32 v[236:237], v[2:3], v[2:3], v[236:237]
    v_mfma_f32_16x16x32_bf16 v[52:55], a[56:59], v[116:119], v[52:55]
    buffer_load_dwordx4 a[44:47], v248, s[36:39], s62 offen offset:3072 sc1
    v_mfma_f32_16x16x32_bf16 v[8:11], a[60:63], v[120:123], v[8:11]
    ds_read_b64_tr_b16 v[104:105], v168 offset:24576
    v_permlane32_swap_b32 v230, v234
    v_mfma_f32_16x16x32_bf16 v[12:15], a[64:67], v[120:123], v[12:15]
    ds_read_b64_tr_b16 v[106:107], v168 offset:26624
    v_permlane32_swap_b32 v231, v235
    v_mfma_f32_16x16x32_bf16 v[16:19], a[68:71], v[120:123], v[16:19]
    s_add_u32 s62, s62, 4096
    ds_read_b64_tr_b16 v[108:109], v169 offset:24576
    v_permlane32_swap_b32 v232, v236
    v_mfma_f32_16x16x32_bf16 v[20:23], a[60:63], v[124:127], v[20:23]
    buffer_load_dwordx4 a[48:51], v248, s[36:39], s62 offen offset:0 sc1
    v_mfma_f32_16x16x32_bf16 v[24:27], a[64:67], v[124:127], v[24:27]
    ds_read_b64_tr_b16 v[110:111], v169 offset:26624
    v_permlane32_swap_b32 v233, v237
    v_mfma_f32_16x16x32_bf16 v[28:31], a[68:71], v[124:127], v[28:31]
    s_waitcnt lgkmcnt(6)
    ds_read_b64_tr_b16 v[112:113], v170 offset:24576
    v_add_f32 v230, v230, v234
    v_mfma_f32_16x16x32_bf16 v[32:35], a[60:63], v[128:131], v[32:35]
    ds_read_b64_tr_b16 v[114:115], v170 offset:26624
    v_add_f32 v231, v231, v235
    v_add_f32 v232, v232, v236
    v_mfma_f32_16x16x32_bf16 v[36:39], a[64:67], v[128:131], v[36:39]
    buffer_load_dwordx4 a[52:55], v248, s[36:39], s62 offen offset:1024 sc1
    v_mfma_f32_16x16x32_bf16 v[40:43], a[68:71], v[128:131], v[40:43]
    s_waitcnt lgkmcnt(6)
    ds_read_b64_tr_b16 v[116:117], v171 offset:24576
    v_add_f32 v233, v233, v237
    v_mfma_f32_16x16x32_bf16 v[44:47], a[60:63], v[132:135], v[44:47]
    s_waitcnt lgkmcnt(3)
    ds_read_b64_tr_b16 v[118:119], v171 offset:26624
    v_permlane16_swap_b32 v230, v232
    v_permlane16_swap_b32 v231, v233
    v_mfma_f32_16x16x32_bf16 v[48:51], a[64:67], v[132:135], v[48:51]
    s_waitcnt vmcnt(10)
    s_barrier
    s_cmp_eq_u32 s3, 0
    s_cbranch_scc0 L_wf27
    s_lshl_b32 s54, s76, 7
    s_add_u32 s54, s54, 23288832
    v_mov_b32 v254, 0
    v_mov_b32 v255, s48
    s_mov_b64 exec, 1
    buffer_store_dword v255, v254, s[36:39], s54 offen sc1
    s_mov_b64 exec, -1
L_wf27:
    v_mfma_f32_16x16x32_bf16 v[52:55], a[68:71], v[132:135], v[52:55]
    buffer_load_dwordx4 a[56:59], v248, s[36:39], s62 offen offset:2048 sc1
    v_mfma_f32_16x16x32_bf16 v[8:11], a[72:75], v[104:107], v[8:11]
    ds_read_b64_tr_b16 v[120:121], v168 offset:28672
    v_add_f32 v230, v230, v232
    v_mfma_f32_16x16x32_bf16 v[12:15], a[76:79], v[104:107], v[12:15]
    ds_read_b64_tr_b16 v[122:123], v168 offset:30720
    v_add_f32 v231, v231, v233
    v_mfma_f32_16x16x32_bf16 v[16:19], a[80:83], v[104:107], v[16:19]
    ds_read_b64_tr_b16 v[124:125], v169 offset:28672
    v_lshrrev_b32 v2, 4, v1
    v_mfma_f32_16x16x32_bf16 v[20:23], a[72:75], v[108:111], v[20:23]
    buffer_load_dwordx4 a[60:63], v248, s[36:39], s62 offen offset:3072 sc1
    v_mfma_f32_16x16x32_bf16 v[24:27], a[76:79], v[108:111], v[24:27]
    ds_read_b64_tr_b16 v[126:127], v169 offset:30720
    v_lshlrev_b32 v2, 3, v2
    v_mfma_f32_16x16x32_bf16 v[28:31], a[80:83], v[108:111], v[28:31]
    s_waitcnt lgkmcnt(6)
    s_lshl_b32 s50, s3, 5
    s_add_u32 s50, s50, 0
    ds_read_b64_tr_b16 v[128:129], v170 offset:28672
    v_mfma_f32_16x16x32_bf16 v[32:35], a[72:75], v[112:115], v[32:35]
    s_add_u32 s62, s62, 4096
    ds_read_b64_tr_b16 v[130:131], v170 offset:30720
    v_add_u32 v2, s50, v2
    v_mfma_f32_16x16x32_bf16 v[36:39], a[76:79], v[112:115], v[36:39]
    buffer_load_dwordx4 a[64:67], v248, s[36:39], s62 offen offset:0 sc1
    v_mfma_f32_16x16x32_bf16 v[40:43], a[80:83], v[112:115], v[40:43]
    s_waitcnt lgkmcnt(6)
    ds_read_b64_tr_b16 v[132:133], v171 offset:28672
    v_add_f32_dpp v230, v230, v230 row_ror:8 row_mask:0xf bank_mask:0xf
    v_mfma_f32_16x16x32_bf16 v[44:47], a[72:75], v[116:119], v[44:47]
    s_waitcnt lgkmcnt(3)
    ds_read_b64_tr_b16 v[134:135], v171 offset:30720
    v_add_f32_dpp v231, v231, v231 row_ror:8 row_mask:0xf bank_mask:0xf
    v_mfma_f32_16x16x32_bf16 v[48:51], a[76:79], v[116:119], v[48:51]
    v_add_f32_dpp v230, v230, v230 row_ror:4 row_mask:0xf bank_mask:0xf
    v_add_f32_dpp v231, v231, v231 row_ror:4 row_mask:0xf bank_mask:0xf
    v_mfma_f32_16x16x32_bf16 v[52:55], a[80:83], v[116:119], v[52:55]
    buffer_load_dwordx4 a[68:71], v248, s[36:39], s62 offen offset:1024 sc1
    v_mfma_f32_16x16x32_bf16 v[8:11], a[84:87], v[120:123], v[8:11]
    ds_read_b64_tr_b16 v[104:105], v168 offset:32768
    v_add_f32_dpp v230, v230, v230 row_ror:2 row_mask:0xf bank_mask:0xf
    v_mfma_f32_16x16x32_bf16 v[12:15], a[88:91], v[120:123], v[12:15]
    ds_read_b64_tr_b16 v[106:107], v168 offset:34816
    v_add_f32_dpp v231, v231, v231 row_ror:2 row_mask:0xf bank_mask:0xf
    v_mfma_f32_16x16x32_bf16 v[16:19], a[92:95], v[120:123], v[16:19]
    ds_read_b64_tr_b16 v[108:109], v169 offset:32768
    v_add_f32_dpp v230, v230, v230 row_ror:1 row_mask:0xf bank_mask:0xf
    v_mfma_f32_16x16x32_bf16 v[20:23], a[84:87], v[124:127], v[20:23]
    buffer_load_dwordx4 a[72:75], v248, s[36:39], s62 offen offset:2048 sc1
    v_mfma_f32_16x16x32_bf16 v[24:27], a[88:91], v[124:127], v[24:27]
    ds_read_b64_tr_b16 v[110:111], v169 offset:34816
    v_add_f32_dpp v231, v231, v231 row_ror:1 row_mask:0xf bank_mask:0xf
    v_mfma_f32_16x16x32_bf16 v[28:31], a[92:95], v[124:127], v[28:31]
    ds_read_b64_tr_b16 v[112:113], v170 offset:32768
    s_mov_b32 exec_lo, 0x00010001
    s_mov_b32 exec_hi, 0x00010001
    ds_write_b64 v2, v[230:231]
    s_mov_b64 exec, -1
    s_waitcnt lgkmcnt(8)
    v_mfma_f32_16x16x32_bf16 v[32:35], a[84:87], v[128:131], v[32:35]
    ds_read_b64_tr_b16 v[114:115], v170 offset:34816
    v_lshlrev_b32 v2, 2, v1
    v_mfma_f32_16x16x32_bf16 v[36:39], a[88:91], v[128:131], v[36:39]
    buffer_load_dwordx4 a[76:79], v248, s[36:39], s62 offen offset:3072 sc1
    v_mfma_f32_16x16x32_bf16 v[40:43], a[92:95], v[128:131], v[40:43]
    s_waitcnt lgkmcnt(7)
    ds_read_b64_tr_b16 v[116:117], v171 offset:32768
    v_and_b32 v2, 12, v2
    v_mfma_f32_16x16x32_bf16 v[44:47], a[84:87], v[132:135], v[44:47]
    s_waitcnt lgkmcnt(3)
    ds_read_b64_tr_b16 v[118:119], v171 offset:34816
    v_add_u32 v2, 0, v2
    v_mfma_f32_16x16x32_bf16 v[48:51], a[88:91], v[132:135], v[48:51]
    s_add_u32 s62, s62, 4096
    s_waitcnt lgkmcnt(0)
    s_barrier
    v_mfma_f32_16x16x32_bf16 v[52:55], a[92:95], v[132:135], v[52:55]
    buffer_load_dwordx4 a[80:83], v248, s[36:39], s62 offen offset:0 sc1
    v_mfma_f32_16x16x32_bf16 v[8:11], a[96:99], v[104:107], v[8:11]
    ds_read_b64_tr_b16 v[120:121], v168 offset:36864
    ds_read2_b32 v[230:231], v2 offset0:0 offset1:4
    v_mfma_f32_16x16x32_bf16 v[12:15], a[100:103], v[104:107], v[12:15]
    ds_read_b64_tr_b16 v[122:123], v168 offset:38912
    ds_read2_b32 v[232:233], v2 offset0:8 offset1:12
    v_mfma_f32_16x16x32_bf16 v[16:19], a[104:107], v[104:107], v[16:19]
    ds_read_b64_tr_b16 v[124:125], v169 offset:36864
    ds_read2_b32 v[234:235], v2 offset0:16 offset1:20
    ds_read2_b32 v[236:237], v2 offset0:24 offset1:28
    v_mfma_f32_16x16x32_bf16 v[20:23], a[96:99], v[108:111], v[20:23]
    buffer_load_dwordx4 a[84:87], v248, s[36:39], s62 offen offset:1024 sc1
    v_mfma_f32_16x16x32_bf16 v[24:27], a[100:103], v[108:111], v[24:27]
    ds_read_b64_tr_b16 v[126:127], v169 offset:38912
    v_mov_b32 v225, s48
    v_mfma_f32_16x16x32_bf16 v[28:31], a[104:107], v[108:111], v[28:31]
    ds_read_b64_tr_b16 v[128:129], v170 offset:36864
    v_mov_b32 v227, s48
    v_mfma_f32_16x16x32_bf16 v[32:35], a[96:99], v[112:115], v[32:35]
    s_add_u32 s7, s7, 16384
    ds_read_b64_tr_b16 v[130:131], v170 offset:38912
    s_waitcnt lgkmcnt(6)
    v_add_f32 v230, v230, v232
    v_mfma_f32_16x16x32_bf16 v[36:39], a[100:103], v[112:115], v[36:39]
    buffer_load_dwordx4 a[88:91], v248, s[36:39], s62 offen offset:2048 sc1
    v_mfma_f32_16x16x32_bf16 v[40:43], a[104:107], v[112:115], v[40:43]
    ds_read_b64_tr_b16 v[132:133], v171 offset:36864
    v_add_f32 v231, v231, v233
    v_mfma_f32_16x16x32_bf16 v[44:47], a[96:99], v[116:119], v[44:47]
    s_waitcnt lgkmcnt(3)
    ds_read_b64_tr_b16 v[134:135], v171 offset:38912
    v_add_f32 v234, v234, v236
    v_mfma_f32_16x16x32_bf16 v[48:51], a[100:103], v[116:119], v[48:51]
    v_mfma_f32_16x16x32_bf16 v[52:55], a[104:107], v[116:119], v[52:55]
    buffer_load_dwordx4 a[92:95], v248, s[36:39], s62 offen offset:3072 sc1
    v_mfma_f32_16x16x32_bf16 v[8:11], a[108:111], v[120:123], v[8:11]
    ds_read_b64_tr_b16 v[104:105], v168 offset:40960
    v_add_f32 v235, v235, v237
    v_mfma_f32_16x16x32_bf16 v[12:15], a[112:115], v[120:123], v[12:15]
    ds_read_b64_tr_b16 v[106:107], v168 offset:43008
    v_add_f32 v230, v230, v234
    v_mfma_f32_16x16x32_bf16 v[16:19], a[116:119], v[120:123], v[16:19]
    s_add_u32 s62, s62, 4096
    ds_read_b64_tr_b16 v[108:109], v169 offset:40960
    v_add_f32 v231, v231, v235
    v_mfma_f32_16x16x32_bf16 v[20:23], a[108:111], v[124:127], v[20:23]
    buffer_load_dwordx4 a[96:99], v248, s[36:39], s62 offen offset:0 sc1
    v_mfma_f32_16x16x32_bf16 v[24:27], a[112:115], v[124:127], v[24:27]
    ds_read_b64_tr_b16 v[110:111], v169 offset:43008
    v_mul_f32 v230, 0x3acccccd, v230
    v_mfma_f32_16x16x32_bf16 v[28:31], a[116:119], v[124:127], v[28:31]
    s_waitcnt lgkmcnt(6)
    ds_read_b64_tr_b16 v[112:113], v170 offset:40960
    v_mul_f32 v234, v230, v230
    v_mfma_f32_16x16x32_bf16 v[32:35], a[108:111], v[128:131], v[32:35]
    ds_read_b64_tr_b16 v[114:115], v170 offset:43008
    v_mov_b32 v224, 0x3acccccd
    v_fma_f32 v231, v231, v224, -v234
    v_mfma_f32_16x16x32_bf16 v[36:39], a[112:115], v[128:131], v[36:39]
    buffer_load_dwordx4 a[100:103], v248, s[36:39], s62 offen offset:1024 sc1
    v_mfma_f32_16x16x32_bf16 v[40:43], a[116:119], v[128:131], v[40:43]
    s_waitcnt lgkmcnt(6)
    ds_read_b64_tr_b16 v[116:117], v171 offset:40960
    v_max_f32 v231, 0, v231
    v_mfma_f32_16x16x32_bf16 v[44:47], a[108:111], v[132:135], v[44:47]
    s_waitcnt lgkmcnt(3)
    ds_read_b64_tr_b16 v[118:119], v171 offset:43008
    v_add_f32 v231, 0x3727c5ac, v231
    v_mfma_f32_16x16x32_bf16 v[48:51], a[112:115], v[132:135], v[48:51]
    v_rsq_f32 v224, v231
    v_mfma_f32_16x16x32_bf16 v[52:55], a[116:119], v[132:135], v[52:55]
    buffer_load_dwordx4 a[104:107], v248, s[36:39], s62 offen offset:2048 sc1
    v_mfma_f32_16x16x32_bf16 v[8:11], a[120:123], v[104:107], v[8:11]
    ds_read_b64_tr_b16 v[120:121], v168 offset:45056
    v_mul_f32_e64 v226, -v230, v224
    v_mfma_f32_16x16x32_bf16 v[12:15], a[124:127], v[104:107], v[12:15]
    ds_read_b64_tr_b16 v[122:123], v168 offset:47104
    s_mov_b64 exec, 0xf
    buffer_store_dwordx4 v[224:227], v248, s[36:39], s7 offen sc1
    s_mov_b64 exec, -1
    v_mfma_f32_16x16x32_bf16 v[16:19], a[128:131], v[104:107], v[16:19]
    s_and_b32 s50, s3, 1
    s_lshl_b32 s51, s74, 1
    ds_read_b64_tr_b16 v[124:125], v169 offset:45056
    v_mfma_f32_16x16x32_bf16 v[20:23], a[120:123], v[108:111], v[20:23]
    buffer_load_dwordx4 a[108:111], v248, s[36:39], s62 offen offset:3072 sc1
    v_mfma_f32_16x16x32_bf16 v[24:27], a[124:127], v[108:111], v[24:27]
    s_add_u32 s52, s51, s50
    s_mul_i32 s52, s52, 192
    ds_read_b64_tr_b16 v[126:127], v169 offset:47104
    v_mfma_f32_16x16x32_bf16 v[28:31], a[128:131], v[108:111], v[28:31]
    s_waitcnt lgkmcnt(6)
    s_mul_i32 s53, s3, 48
    s_add_u32 s52, s52, s53
    ds_read_b64_tr_b16 v[128:129], v170 offset:45056
    v_mfma_f32_16x16x32_bf16 v[32:35], a[120:123], v[112:115], v[32:35]
    s_add_u32 s62, s62, 4096
    ds_read_b64_tr_b16 v[130:131], v170 offset:47104
    v_mfma_f32_16x16x32_bf16 v[36:39], a[124:127], v[112:115], v[36:39]
    buffer_load_dwordx4 a[112:115], v248, s[36:39], s62 offen offset:0 sc1
    v_mfma_f32_16x16x32_bf16 v[40:43], a[128:131], v[112:115], v[40:43]
    s_waitcnt lgkmcnt(6)
    s_lshl_b32 s52, s52, 8
    s_add_u32 s52, s52, 16777216
    ds_read_b64_tr_b16 v[132:133], v171 offset:45056
    v_mfma_f32_16x16x32_bf16 v[44:47], a[120:123], v[116:119], v[44:47]
    s_waitcnt lgkmcnt(3)
    ds_read_b64_tr_b16 v[134:135], v171 offset:47104
    v_add_u32 v216, s52, v248
    v_mfma_f32_16x16x32_bf16 v[48:51], a[124:127], v[116:119], v[48:51]
    v_add_u32 v218, 3145728, v216
    v_mfma_f32_16x16x32_bf16 v[52:55], a[128:131], v[116:119], v[52:55]
    buffer_load_dwordx4 a[116:119], v248, s[36:39], s62 offen offset:1024 sc1
    v_mfma_f32_16x16x32_bf16 v[8:11], a[132:135], v[120:123], v[8:11]
    s_xor_b32 s50, s50, 1
    s_add_u32 s52, s51, s50
    ds_read_b64_tr_b16 v[104:105], v168 offset:49152
    v_mfma_f32_16x16x32_bf16 v[12:15], a[136:139], v[120:123], v[12:15]
    s_mul_i32 s52, s52, 192
    s_add_u32 s52, s52, s53
    ds_read_b64_tr_b16 v[106:107], v168 offset:51200
    v_mfma_f32_16x16x32_bf16 v[16:19], a[140:143], v[120:123], v[16:19]
    s_lshl_b32 s52, s52, 8
    s_add_u32 s52, s52, 16777216
    ds_read_b64_tr_b16 v[108:109], v169 offset:49152
    v_mfma_f32_16x16x32_bf16 v[20:23], a[132:135], v[124:127], v[20:23]
    buffer_load_dwordx4 a[120:123], v248, s[36:39], s62 offen offset:2048 sc1
    v_mfma_f32_16x16x32_bf16 v[24:27], a[136:139], v[124:127], v[24:27]
    ds_read_b64_tr_b16 v[110:111], v169 offset:51200
    v_add_u32 v217, s52, v248
    v_mfma_f32_16x16x32_bf16 v[28:31], a[140:143], v[124:127], v[28:31]
    s_waitcnt lgkmcnt(6)
    ds_read_b64_tr_b16 v[112:113], v170 offset:49152
    v_add_u32 v219, 3145728, v217
    v_mfma_f32_16x16x32_bf16 v[32:35], a[132:135], v[128:131], v[32:35]
    s_lshr_b32 s50, s74, 1
    s_lshl_b32 s50, s50, 2
    ds_read_b64_tr_b16 v[114:115], v170 offset:51200
    v_mfma_f32_16x16x32_bf16 v[36:39], a[136:139], v[128:131], v[36:39]
    buffer_load_dwordx4 a[124:127], v248, s[36:39], s62 offen offset:3072 sc1
    v_mfma_f32_16x16x32_bf16 v[40:43], a[140:143], v[128:131], v[40:43]
    s_waitcnt lgkmcnt(6)
    s_add_u32 s50, s50, s3
    s_lshl_b32 s50, s50, 9
    ds_read_b64_tr_b16 v[116:117], v171 offset:49152
    v_mfma_f32_16x16x32_bf16 v[44:47], a[132:135], v[132:135], v[44:47]
    s_waitcnt lgkmcnt(3)
    s_add_u32 s50, s50, 89088
    ds_read_b64_tr_b16 v[118:119], v171 offset:51200
    v_mfma_f32_16x16x32_bf16 v[48:51], a[136:139], v[132:135], v[48:51]
    s_add_u32 s62, s62, 4096
    v_mfma_f32_16x16x32_bf16 v[52:55], a[140:143], v[132:135], v[52:55]
    buffer_load_dwordx4 a[128:131], v248, s[36:39], s62 offen offset:0 sc1
    v_mfma_f32_16x16x32_bf16 v[8:11], a[144:147], v[104:107], v[8:11]
    ds_read_b64_tr_b16 v[120:121], v168 offset:53248
    v_min_u32 v246, 13, v1
    v_mfma_f32_16x16x32_bf16 v[12:15], a[148:151], v[104:107], v[12:15]
    ds_read_b64_tr_b16 v[122:123], v168 offset:55296
    v_lshlrev_b32 v246, 7, v246
    v_mfma_f32_16x16x32_bf16 v[16:19], a[152:155], v[104:107], v[16:19]
    ds_read_b64_tr_b16 v[124:125], v169 offset:53248
    v_mov_b32 v2, s50
    v_mfma_f32_16x16x32_bf16 v[20:23], a[144:147], v[108:111], v[20:23]
    buffer_load_dwordx4 a[132:135], v248, s[36:39], s62 offen offset:1024 sc1
    v_mfma_f32_16x16x32_bf16 v[24:27], a[148:151], v[108:111], v[24:27]
    ds_read_b64_tr_b16 v[126:127], v169 offset:55296
    v_mov_b32 v3, 31488
    v_mfma_f32_16x16x32_bf16 v[28:31], a[152:155], v[108:111], v[28:31]
    ds_read_b64_tr_b16 v[128:129], v170 offset:53248
    v_cmp_lt_u32 vcc, 3, v1
    s_nop 1
    v_cndmask_b32 v2, v2, v3, vcc
    s_waitcnt lgkmcnt(7)
    v_mfma_f32_16x16x32_bf16 v[32:35], a[144:147], v[112:115], v[32:35]
    ds_read_b64_tr_b16 v[130:131], v170 offset:55296
    v_add_u32 v246, v246, v2
    v_mfma_f32_16x16x32_bf16 v[36:39], a[148:151], v[112:115], v[36:39]
    buffer_load_dwordx4 a[136:139], v248, s[36:39], s62 offen offset:2048 sc1
    v_mfma_f32_16x16x32_bf16 v[40:43], a[152:155], v[112:115], v[40:43]
    s_waitcnt lgkmcnt(6)
    ds_read_b64_tr_b16 v[132:133], v171 offset:53248
    v_mfma_f32_16x16x32_bf16 v[44:47], a[144:147], v[116:119], v[44:47]
    s_waitcnt lgkmcnt(3)
    ds_read_b64_tr_b16 v[134:135], v171 offset:55296
    v_mfma_f32_16x16x32_bf16 v[48:51], a[148:151], v[116:119], v[48:51]
    buffer_load_dword v247, v246, s[36:39], s17 offen sc1
    v_mfma_f32_16x16x32_bf16 v[52:55], a[152:155], v[116:119], v[52:55]
    buffer_load_dwordx4 a[140:143], v248, s[36:39], s62 offen offset:3072 sc1
    v_mfma_f32_16x16x32_bf16 v[8:11], a[156:159], v[120:123], v[8:11]
    ds_read_b64_tr_b16 v[104:105], v168 offset:57344
    v_mfma_f32_16x16x32_bf16 v[12:15], a[160:163], v[120:123], v[12:15]
    ds_read_b64_tr_b16 v[106:107], v168 offset:59392
    v_mfma_f32_16x16x32_bf16 v[16:19], a[164:167], v[120:123], v[16:19]
    s_add_u32 s62, s62, 4096
    ds_read_b64_tr_b16 v[108:109], v169 offset:57344
    v_mfma_f32_16x16x32_bf16 v[20:23], a[156:159], v[124:127], v[20:23]
    buffer_load_dwordx4 a[144:147], v248, s[36:39], s62 offen offset:0 sc1
    v_mfma_f32_16x16x32_bf16 v[24:27], a[160:163], v[124:127], v[24:27]
    ds_read_b64_tr_b16 v[110:111], v169 offset:59392
    v_mfma_f32_16x16x32_bf16 v[28:31], a[164:167], v[124:127], v[28:31]
    s_waitcnt lgkmcnt(6)
    ds_read_b64_tr_b16 v[112:113], v170 offset:57344
    v_mfma_f32_16x16x32_bf16 v[32:35], a[156:159], v[128:131], v[32:35]
    ds_read_b64_tr_b16 v[114:115], v170 offset:59392
    v_mfma_f32_16x16x32_bf16 v[36:39], a[160:163], v[128:131], v[36:39]
    buffer_load_dwordx4 a[148:151], v248, s[36:39], s62 offen offset:1024 sc1
    v_mfma_f32_16x16x32_bf16 v[40:43], a[164:167], v[128:131], v[40:43]
    s_waitcnt lgkmcnt(6)
    ds_read_b64_tr_b16 v[116:117], v171 offset:57344
    v_mfma_f32_16x16x32_bf16 v[44:47], a[156:159], v[132:135], v[44:47]
    s_waitcnt lgkmcnt(3)
    ds_read_b64_tr_b16 v[118:119], v171 offset:59392
    v_mfma_f32_16x16x32_bf16 v[48:51], a[160:163], v[132:135], v[48:51]
    v_mfma_f32_16x16x32_bf16 v[52:55], a[164:167], v[132:135], v[52:55]
    buffer_load_dwordx4 a[152:155], v248, s[36:39], s62 offen offset:2048 sc1
    v_mfma_f32_16x16x32_bf16 v[8:11], a[168:171], v[104:107], v[8:11]
    ds_read_b64_tr_b16 v[120:121], v168 offset:61440
    v_mfma_f32_16x16x32_bf16 v[12:15], a[172:175], v[104:107], v[12:15]
    ds_read_b64_tr_b16 v[122:123], v168 offset:63488
    v_add_u32 v168, 65536, v168
    v_mfma_f32_16x16x32_bf16 v[16:19], a[176:179], v[104:107], v[16:19]
    ds_read_b64_tr_b16 v[124:125], v169 offset:61440
    v_mfma_f32_16x16x32_bf16 v[20:23], a[168:171], v[108:111], v[20:23]
    buffer_load_dwordx4 a[156:159], v248, s[36:39], s62 offen offset:3072 sc1
    v_mfma_f32_16x16x32_bf16 v[24:27], a[172:175], v[108:111], v[24:27]
    ds_read_b64_tr_b16 v[126:127], v169 offset:63488
    v_add_u32 v169, 65536, v169
    v_mfma_f32_16x16x32_bf16 v[28:31], a[176:179], v[108:111], v[28:31]
    s_waitcnt lgkmcnt(6)
    ds_read_b64_tr_b16 v[128:129], v170 offset:61440
    v_mfma_f32_16x16x32_bf16 v[32:35], a[168:171], v[112:115], v[32:35]
    s_add_u32 m0, s63, 1024
    ds_read_b64_tr_b16 v[130:131], v170 offset:63488
    v_add_u32 v170, 65536, v170
    v_mfma_f32_16x16x32_bf16 v[36:39], a[172:175], v[112:115], v[36:39]
    buffer_load_dwordx4 v248, s[36:39], s6 offen sc1 lds
    v_mfma_f32_16x16x32_bf16 v[40:43], a[176:179], v[112:115], v[40:43]
    s_waitcnt lgkmcnt(6)
    ds_read_b64_tr_b16 v[132:133], v171 offset:61440
    v_mfma_f32_16x16x32_bf16 v[44:47], a[168:171], v[116:119], v[44:47]
    s_waitcnt lgkmcnt(3)
    ds_read_b64_tr_b16 v[134:135], v171 offset:63488
    v_add_u32 v171, 65536, v171
    v_mfma_f32_16x16x32_bf16 v[48:51], a[172:175], v[116:119], v[48:51]
    s_add_u32 s62, s62, 4096
    v_mfma_f32_16x16x32_bf16 v[52:55], a[176:179], v[116:119], v[52:55]
    buffer_load_dwordx4 a[160:163], v248, s[36:39], s62 offen offset:0 sc1
    v_mfma_f32_16x16x32_bf16 v[8:11], a[180:183], v[120:123], v[8:11]
    ds_read_b64_tr_b16 v[104:105], v168 offset:0
    v_mfma_f32_16x16x32_bf16 v[12:15], a[184:187], v[120:123], v[12:15]
    ds_read_b64_tr_b16 v[106:107], v168 offset:2048
    v_mfma_f32_16x16x32_bf16 v[16:19], a[188:191], v[120:123], v[16:19]
    ds_read_b64_tr_b16 v[108:109], v169 offset:0
    v_mfma_f32_16x16x32_bf16 v[20:23], a[180:183], v[124:127], v[20:23]
    buffer_load_dwordx4 a[164:167], v248, s[36:39], s62 offen offset:1024 sc1
    v_mfma_f32_16x16x32_bf16 v[24:27], a[184:187], v[124:127], v[24:27]
    ds_read_b64_tr_b16 v[110:111], v169 offset:2048
    v_mfma_f32_16x16x32_bf16 v[28:31], a[188:191], v[124:127], v[28:31]
    s_waitcnt lgkmcnt(6)
    ds_read_b64_tr_b16 v[112:113], v170 offset:0
    v_mfma_f32_16x16x32_bf16 v[32:35], a[180:183], v[128:131], v[32:35]
    ds_read_b64_tr_b16 v[114:115], v170 offset:2048
    v_mfma_f32_16x16x32_bf16 v[36:39], a[184:187], v[128:131], v[36:39]
    buffer_load_dwordx4 a[168:171], v248, s[36:39], s62 offen offset:2048 sc1
    v_mfma_f32_16x16x32_bf16 v[40:43], a[188:191], v[128:131], v[40:43]
    s_waitcnt lgkmcnt(6)
    ds_read_b64_tr_b16 v[116:117], v171 offset:0
    v_mfma_f32_16x16x32_bf16 v[44:47], a[180:183], v[132:135], v[44:47]
    s_waitcnt lgkmcnt(3)
    ds_read_b64_tr_b16 v[118:119], v171 offset:2048
    v_mfma_f32_16x16x32_bf16 v[48:51], a[184:187], v[132:135], v[48:51]
    s_waitcnt vmcnt(9)
    v_cmp_ne_u32 vcc, s48, v247
    s_cbranch_vccnz L_chk28_slow
L_chk28_back:
    v_mfma_f32_16x16x32_bf16 v[52:55], a[188:191], v[132:135], v[52:55]
    buffer_load_dwordx4 v[56:59], v216, s[36:39], 0 offen offset:0 sc1
    v_mfma_f32_16x16x32_bf16 v[8:11], a[192:195], v[104:107], v[8:11]
    ds_read_b64_tr_b16 v[120:121], v168 offset:4096
    v_mfma_f32_16x16x32_bf16 v[12:15], a[196:199], v[104:107], v[12:15]
    ds_read_b64_tr_b16 v[122:123], v168 offset:6144
    v_mfma_f32_16x16x32_bf16 v[16:19], a[200:203], v[104:107], v[16:19]
    ds_read_b64_tr_b16 v[124:125], v169 offset:4096
    v_mfma_f32_16x16x32_bf16 v[20:23], a[192:195], v[108:111], v[20:23]
    buffer_load_dwordx4 v[60:63], v217, s[36:39], 0 offen offset:0 sc1
    v_mfma_f32_16x16x32_bf16 v[24:27], a[196:199], v[108:111], v[24:27]
    ds_read_b64_tr_b16 v[126:127], v169 offset:6144
    v_mfma_f32_16x16x32_bf16 v[28:31], a[200:203], v[108:111], v[28:31]
    s_waitcnt lgkmcnt(6)
    ds_read_b64_tr_b16 v[128:129], v170 offset:4096
    v_mfma_f32_16x16x32_bf16 v[32:35], a[192:195], v[112:115], v[32:35]
    ds_read_b64_tr_b16 v[130:131], v170 offset:6144
    v_mfma_f32_16x16x32_bf16 v[36:39], a[196:199], v[112:115], v[36:39]
    buffer_load_dwordx4 v[64:67], v216, s[36:39], 0 offen offset:1024 sc1
    v_mfma_f32_16x16x32_bf16 v[40:43], a[200:203], v[112:115], v[40:43]
    s_waitcnt lgkmcnt(6)
    ds_read_b64_tr_b16 v[132:133], v171 offset:4096
    v_mfma_f32_16x16x32_bf16 v[44:47], a[192:195], v[116:119], v[44:47]
    s_waitcnt lgkmcnt(3)
    ds_read_b64_tr_b16 v[134:135], v171 offset:6144
    v_mfma_f32_16x16x32_bf16 v[48:51], a[196:199], v[116:119], v[48:51]
    v_mfma_f32_16x16x32_bf16 v[52:55], a[200:203], v[116:119], v[52:55]
    buffer_load_dwordx4 v[68:71], v217, s[36:39], 0 offen offset:1024 sc1
    v_mfma_f32_16x16x32_bf16 v[8:11], a[204:207], v[120:123], v[8:11]
    ds_read_b64_tr_b16 v[104:105], v168 offset:8192
    v_mfma_f32_16x16x32_bf16 v[12:15], a[208:211], v[120:123], v[12:15]
    ds_read_b64_tr_b16 v[106:107], v168 offset:10240
    v_mfma_f32_16x16x32_bf16 v[16:19], a[212:215], v[120:123], v[16:19]
    ds_read_b64_tr_b16 v[108:109], v169 offset:8192
    v_mfma_f32_16x16x32_bf16 v[20:23], a[204:207], v[124:127], v[20:23]
    buffer_load_dwordx4 v[72:75], v216, s[36:39], 0 offen offset:2048 sc1
    v_mfma_f32_16x16x32_bf16 v[24:27], a[208:211], v[124:127], v[24:27]
    ds_read_b64_tr_b16 v[110:111], v169 offset:10240
    v_mfma_f32_16x16x32_bf16 v[28:31], a[212:215], v[124:127], v[28:31]
    s_waitcnt lgkmcnt(6)
    ds_read_b64_tr_b16 v[112:113], v170 offset:8192
    v_mfma_f32_16x16x32_bf16 v[32:35], a[204:207], v[128:131], v[32:35]
    ds_read_b64_tr_b16 v[114:115], v170 offset:10240
    v_mfma_f32_16x16x32_bf16 v[36:39], a[208:211], v[128:131], v[36:39]
    buffer_load_dwordx4 a[172:175], v248, s[36:39], s62 offen offset:3072 sc1
    v_mfma_f32_16x16x32_bf16 v[40:43], a[212:215], v[128:131], v[40:43]
    s_waitcnt lgkmcnt(6)
    ds_read_b64_tr_b16 v[116:117], v171 offset:8192
    v_mfma_f32_16x16x32_bf16 v[44:47], a[204:207], v[132:135], v[44:47]
    s_waitcnt lgkmcnt(3)
    ds_read_b64_tr_b16 v[118:119], v171 offset:10240
    v_mfma_f32_16x16x32_bf16 v[48:51], a[208:211], v[132:135], v[48:51]
    v_mfma_f32_16x16x32_bf16 v[52:55], a[212:215], v[132:135], v[52:55]
    buffer_load_dwordx4 v[76:79], v217, s[36:39], 0 offen offset:2048 sc1
    v_mfma_f32_16x16x32_bf16 v[8:11], a[216:219], v[104:107], v[8:11]
    ds_read_b64_tr_b16 v[120:121], v168 offset:12288
    v_mfma_f32_16x16x32_bf16 v[12:15], a[220:223], v[104:107], v[12:15]
    ds_read_b64_tr_b16 v[122:123], v168 offset:14336
    v_mfma_f32_16x16x32_bf16 v[16:19], a[224:227], v[104:107], v[16:19]
    s_add_u32 s62, s62, 4096
    ds_read_b64_tr_b16 v[124:125], v169 offset:12288
    v_mfma_f32_16x16x32_bf16 v[20:23], a[216:219], v[108:111], v[20:23]
    buffer_load_dwordx4 a[176:179], v248, s[36:39], s62 offen offset:0 sc1
    v_mfma_f32_16x16x32_bf16 v[24:27], a[220:223], v[108:111], v[24:27]
    ds_read_b64_tr_b16 v[126:127], v169 offset:14336
    v_mfma_f32_16x16x32_bf16 v[28:31], a[224:227], v[108:111], v[28:31]
    s_waitcnt lgkmcnt(6)
    ds_read_b64_tr_b16 v[128:129], v170 offset:12288
    v_mfma_f32_16x16x32_bf16 v[32:35], a[216:219], v[112:115], v[32:35]
    s_waitcnt vmcnt(11)
    ds_read_b64_tr_b16 v[130:131], v170 offset:14336
    ds_read_b128 v[200:203], v175 offset:1024
    v_mfma_f32_16x16x32_bf16 v[36:39], a[220:223], v[112:115], v[36:39]
    buffer_load_dwordx4 a[180:183], v248, s[36:39], s62 offen offset:1024 sc1
    v_mfma_f32_16x16x32_bf16 v[40:43], a[224:227], v[112:115], v[40:43]
    s_waitcnt lgkmcnt(7)
    ds_read_b64_tr_b16 v[132:133], v171 offset:12288
    ds_read_b128 v[204:207], v175 offset:1280
    v_mfma_f32_16x16x32_bf16 v[44:47], a[216:219], v[116:119], v[44:47]
    s_waitcnt lgkmcnt(3)
    ds_read_b64_tr_b16 v[134:135], v171 offset:14336
    v_mfma_f32_16x16x32_bf16 v[48:51], a[220:223], v[116:119], v[48:51]
    ds_read_b128 v[208:211], v175 offset:1536
    ds_read_b128 v[212:215], v175 offset:1792
    v_mfma_f32_16x16x32_bf16 v[52:55], a[224:227], v[116:119], v[52:55]
    buffer_load_dwordx4 a[184:187], v248, s[36:39], s62 offen offset:2048 sc1
    v_mfma_f32_16x16x32_bf16 v[8:11], a[228:231], v[120:123], v[8:11]
    v_mfma_f32_16x16x32_bf16 v[12:15], a[232:235], v[120:123], v[12:15]
    s_waitcnt lgkmcnt(5)
    v_xor_b32 v3, s48, v201
    v_bitop3_b32 v3, v203, s48, v3 bitop3:0xbe
    v_mfma_f32_16x16x32_bf16 v[16:19], a[236:239], v[120:123], v[16:19]
    s_waitcnt lgkmcnt(3)
    v_bitop3_b32 v3, v205, s48, v3 bitop3:0xbe
    v_bitop3_b32 v3, v207, s48, v3 bitop3:0xbe
    v_mfma_f32_16x16x32_bf16 v[20:23], a[228:231], v[124:127], v[20:23]
    buffer_load_dwordx4 a[188:191], v248, s[36:39], s62 offen offset:3072 sc1
    v_mfma_f32_16x16x32_bf16 v[24:27], a[232:235], v[124:127], v[24:27]
    s_waitcnt lgkmcnt(1)
    v_bitop3_b32 v3, v209, s48, v3 bitop3:0xbe
    v_bitop3_b32 v3, v211, s48, v3 bitop3:0xbe
    v_mfma_f32_16x16x32_bf16 v[28:31], a[236:239], v[124:127], v[28:31]
    s_waitcnt lgkmcnt(0)
    v_bitop3_b32 v3, v213, s48, v3 bitop3:0xbe
    v_bitop3_b32 v3, v215, s48, v3 bitop3:0xbe
    v_mfma_f32_16x16x32_bf16 v[32:35], a[228:231], v[128:131], v[32:35]
    v_cmp_ne_u32 vcc, 0, v3
    s_cbranch_vccnz L_stp1_slow
L_stp1_back:
    v_mfma_f32_16x16x32_bf16 v[36:39], a[232:235], v[128:131], v[36:39]
    buffer_load_dwordx4 v[80:83], v216, s[36:39], 0 offen offset:3072 sc1
    v_mfma_f32_16x16x32_bf16 v[40:43], a[236:239], v[128:131], v[40:43]
    v_mfma_f32_16x16x32_bf16 v[44:47], a[228:231], v[132:135], v[44:47]
    v_mfma_f32_16x16x32_bf16 v[48:51], a[232:235], v[132:135], v[48:51]
    v_mfma_f32_16x16x32_bf16 v[52:55], a[236:239], v[132:135], v[52:55]
    s_add_u32 s8, s8, 3145728
    s_add_u32 s50, s8, 98304
    v_pk_fma_f32 v[238:239], v[176:177], v[202:203], v[188:189] op_sel_hi:[1,0,1]
    v_pk_fma_f32 v[240:241], v[178:179], v[202:203], v[190:191] op_sel_hi:[1,0,1]
    v_pk_fma_f32 v[8:9], v[8:9], v[200:201], v[238:239] op_sel_hi:[1,0,1]
    v_pk_fma_f32 v[10:11], v[10:11], v[200:201], v[240:241] op_sel_hi:[1,0,1]
    v_pk_fma_f32 v[242:243], v[180:181], v[202:203], v[192:193] op_sel_hi:[1,0,1]
    v_pk_fma_f32 v[244:245], v[182:183], v[202:203], v[194:195] op_sel_hi:[1,0,1]
    v_pk_fma_f32 v[12:13], v[12:13], v[200:201], v[242:243] op_sel_hi:[1,0,1]
    v_pk_fma_f32 v[14:15], v[14:15], v[200:201], v[244:245] op_sel_hi:[1,0,1]
    v_pk_mul_f32 v[8:9], v[8:9], v[12:13]
    v_pk_mul_f32 v[10:11], v[10:11], v[14:15]
    v_cvt_pk_bf16_f32 v12, v8, v9
    v_cvt_pk_bf16_f32 v13, v10, v11
    v_pk_fma_f32 v[242:243], v[176:177], v[206:207], v[188:189] op_sel_hi:[1,0,1]
    v_pk_fma_f32 v[244:245], v[178:179], v[206:207], v[190:191] op_sel_hi:[1,0,1]
    v_pk_fma_f32 v[20:21], v[20:21], v[204:205], v[242:243] op_sel_hi:[1,0,1]
    v_pk_fma_f32 v[22:23], v[22:23], v[204:205], v[244:245] op_sel_hi:[1,0,1]
    v_pk_fma_f32 v[238:239], v[180:181], v[206:207], v[192:193] op_sel_hi:[1,0,1]
    v_pk_fma_f32 v[240:241], v[182:183], v[206:207], v[194:195] op_sel_hi:[1,0,1]
    v_pk_fma_f32 v[24:25], v[24:25], v[204:205], v[238:239] op_sel_hi:[1,0,1]
    v_pk_fma_f32 v[26:27], v[26:27], v[204:205], v[240:241] op_sel_hi:[1,0,1]
    v_pk_mul_f32 v[20:21], v[20:21], v[24:25]
    v_pk_mul_f32 v[22:23], v[22:23], v[26:27]
    v_cvt_pk_bf16_f32 v14, v20, v21
    v_cvt_pk_bf16_f32 v15, v22, v23
    s_nop 0
    v_permlane16_swap_b32 v12, v14
    v_permlane16_swap_b32 v13, v15
    buffer_store_dwordx4 v[12:15], v173, s[36:39], s8 offen sc1
    v_pk_fma_f32 v[238:239], v[176:177], v[210:211], v[188:189] op_sel_hi:[1,0,1]
    v_pk_fma_f32 v[240:241], v[178:179], v[210:211], v[190:191] op_sel_hi:[1,0,1]
    v_pk_fma_f32 v[32:33], v[32:33], v[208:209], v[238:239] op_sel_hi:[1,0,1]
    v_pk_fma_f32 v[34:35], v[34:35], v[208:209], v[240:241] op_sel_hi:[1,0,1]
    v_pk_fma_f32 v[242:243], v[180:181], v[210:211], v[192:193] op_sel_hi:[1,0,1]
    v_pk_fma_f32 v[244:245], v[182:183], v[210:211], v[194:195] op_sel_hi:[1,0,1]
    v_pk_fma_f32 v[36:37], v[36:37], v[208:209], v[242:243] op_sel_hi:[1,0,1]
    v_pk_fma_f32 v[38:39], v[38:39], v[208:209], v[244:245] op_sel_hi:[1,0,1]
    v_pk_mul_f32 v[32:33], v[32:33], v[36:37]
    v_pk_mul_f32 v[34:35], v[34:35], v[38:39]
    v_cvt_pk_bf16_f32 v36, v32, v33
    v_cvt_pk_bf16_f32 v37, v34, v35
    v_pk_fma_f32 v[242:243], v[176:177], v[214:215], v[188:189] op_sel_hi:[1,0,1]
    v_pk_fma_f32 v[244:245], v[178:179], v[214:215], v[190:191] op_sel_hi:[1,0,1]
    v_pk_fma_f32 v[44:45], v[44:45], v[212:213], v[242:243] op_sel_hi:[1,0,1]
    v_pk_fma_f32 v[46:47], v[46:47], v[212:213], v[244:245] op_sel_hi:[1,0,1]
    v_pk_fma_f32 v[238:239], v[180:181], v[214:215], v[192:193] op_sel_hi:[1,0,1]
    v_pk_fma_f32 v[240:241], v[182:183], v[214:215], v[194:195] op_sel_hi:[1,0,1]
    v_pk_fma_f32 v[48:49], v[48:49], v[212:213], v[238:239] op_sel_hi:[1,0,1]
    v_pk_fma_f32 v[50:51], v[50:51], v[212:213], v[240:241] op_sel_hi:[1,0,1]
    v_pk_mul_f32 v[44:45], v[44:45], v[48:49]
    v_pk_mul_f32 v[46:47], v[46:47], v[50:51]
    v_cvt_pk_bf16_f32 v38, v44, v45
    v_cvt_pk_bf16_f32 v39, v46, v47
    s_nop 0
    v_permlane16_swap_b32 v36, v38
    v_permlane16_swap_b32 v37, v39
    buffer_store_dwordx4 v[36:39], v173, s[36:39], s50 offen sc1
    v_pk_fma_f32 v[238:239], v[184:185], v[202:203], v[196:197] op_sel_hi:[1,0,1]
    v_pk_fma_f32 v[240:241], v[186:187], v[202:203], v[198:199] op_sel_hi:[1,0,1]
    v_pk_fma_f32 v[16:17], v[16:17], v[200:201], v[238:239] op_sel_hi:[1,0,1]
    v_pk_fma_f32 v[18:19], v[18:19], v[200:201], v[240:241] op_sel_hi:[1,0,1]
    v_pk_fma_f32 v[242:243], v[184:185], v[206:207], v[196:197] op_sel_hi:[1,0,1]
    v_pk_fma_f32 v[244:245], v[186:187], v[206:207], v[198:199] op_sel_hi:[1,0,1]
    v_pk_fma_f32 v[28:29], v[28:29], v[204:205], v[242:243] op_sel_hi:[1,0,1]
    v_pk_fma_f32 v[30:31], v[30:31], v[204:205], v[244:245] op_sel_hi:[1,0,1]
    s_nop 0
    v_permlane32_swap_b32 v16, v28
    v_permlane32_swap_b32 v17, v29
    v_permlane32_swap_b32 v18, v30
    v_permlane32_swap_b32 v19, v31
    v_pk_mul_f32 v[16:17], v[16:17], v[28:29]
    v_pk_mul_f32 v[18:19], v[18:19], v[30:31]
    v_cvt_pk_bf16_f32 v8, v16, v17
    v_cvt_pk_bf16_f32 v9, v18, v19
    v_pk_fma_f32 v[238:239], v[184:185], v[210:211], v[196:197] op_sel_hi:[1,0,1]
    v_pk_fma_f32 v[240:241], v[186:187], v[210:211], v[198:199] op_sel_hi:[1,0,1]
    v_pk_fma_f32 v[40:41], v[40:41], v[208:209], v[238:239] op_sel_hi:[1,0,1]
    v_pk_fma_f32 v[42:43], v[42:43], v[208:209], v[240:241] op_sel_hi:[1,0,1]
    v_pk_fma_f32 v[242:243], v[184:185], v[214:215], v[196:197] op_sel_hi:[1,0,1]
    v_pk_fma_f32 v[244:245], v[186:187], v[214:215], v[198:199] op_sel_hi:[1,0,1]
    v_pk_fma_f32 v[52:53], v[52:53], v[212:213], v[242:243] op_sel_hi:[1,0,1]
    v_pk_fma_f32 v[54:55], v[54:55], v[212:213], v[244:245] op_sel_hi:[1,0,1]
    s_nop 0
    v_permlane32_swap_b32 v40, v52
    v_permlane32_swap_b32 v41, v53
    v_permlane32_swap_b32 v42, v54
    v_permlane32_swap_b32 v43, v55
    v_pk_mul_f32 v[40:41], v[40:41], v[52:53]
    v_pk_mul_f32 v[42:43], v[42:43], v[54:55]
    v_cvt_pk_bf16_f32 v10, v40, v41
    v_cvt_pk_bf16_f32 v11, v42, v43
    s_nop 0
    v_permlane16_swap_b32 v8, v10
    v_permlane16_swap_b32 v9, v11
    buffer_store_dwordx4 v[8:11], v174, s[36:39], s8 offen offset:512 sc1
    buffer_load_dwordx4 v[84:87], v217, s[36:39], 0 offen offset:3072 sc1
    buffer_load_dwordx4 v[88:91], v216, s[36:39], s4 offen offset:0 sc1
    buffer_load_dwordx4 v[92:95], v217, s[36:39], s4 offen offset:0 sc1
    buffer_load_dwordx4 v[96:99], v216, s[36:39], s4 offen offset:1024 sc1
    buffer_load_dwordx4 v[100:103], v217, s[36:39], s4 offen offset:1024 sc1
    s_mov_b32 s40, s28
    s_mov_b32 s41, s29
    s_mov_b32 s42, 0x280000
    s_mov_b32 s43, 0x20000
    s_waitcnt vmcnt(19)
    v_mfma_f32_16x16x32_bf16 v[8:11], a[240:243], v[56:59], 0
    s_and_b32 s50, s3, 1
    s_lshr_b32 s51, s3, 1
    v_mfma_f32_16x16x32_bf16 v[12:15], a[244:247], v[56:59], 0
    s_mul_i32 s52, s50, 20480
    s_mul_i32 s53, s3, 5120
    s_add_u32 s52, s52, s53
    v_mfma_f32_16x16x32_bf16 v[16:19], a[248:251], v[56:59], 0
    v_add_u32 v220, s52, v248
    v_add_u32 v222, 40960, v220
    v_mfma_f32_16x16x32_bf16 v[20:23], a[252:255], v[56:59], 0
    s_xor_b32 s52, s50, 1
    s_mul_i32 s52, s52, 20480
    s_add_u32 s52, s52, s53
    v_mfma_f32_16x16x32_bf16 v[24:27], v[136:139], v[56:59], 0
    s_waitcnt vmcnt(18)
    v_add_u32 v221, s52, v248
    v_add_u32 v223, 40960, v221
    v_mfma_f32_16x16x32_bf16 v[28:31], a[240:243], v[60:63], 0
    s_mul_i32 s52, s51, 20480
    s_lshl_b32 s53, s50, 11
    buffer_load_dwordx4 v[56:59], v216, s[36:39], s4 offen offset:2048 sc1
    v_mfma_f32_16x16x32_bf16 v[32:35], a[244:247], v[60:63], 0
    s_add_u32 s52, s52, s53
    v_add_u32 v224, s52, v248
    v_mfma_f32_16x16x32_bf16 v[36:39], a[248:251], v[60:63], 0
    s_mul_i32 s53, s51, 5120
    s_add_u32 s53, s53, 40960
    v_add_u32 v225, s53, v224
    v_mfma_f32_16x16x32_bf16 v[40:43], a[252:255], v[60:63], 0
    s_xor_b32 s53, s51, 1
    s_mul_i32 s53, s53, 5120
    s_add_u32 s53, s53, 40960
    v_mfma_f32_16x16x32_bf16 v[44:47], v[136:139], v[60:63], 0
    s_waitcnt vmcnt(18)
    v_add_u32 v226, s53, v224
    v_mfma_f32_16x16x32_bf16 v[8:11], v[140:143], v[64:67], v[8:11]
    s_lshl_b32 s52, s74, 1
    s_add_u32 s52, s52, s51
    s_mul_i32 s12, s75, 320
    buffer_load_dwordx4 v[60:63], v217, s[36:39], s4 offen offset:2048 sc1
    v_mfma_f32_16x16x32_bf16 v[12:15], v[144:147], v[64:67], v[12:15]
    s_add_u32 s12, s12, 23147008
    s_mul_i32 s13, s52, 20480
    s_mul_i32 s53, s75, 160
    s_add_u32 s13, s13, s53
    v_mfma_f32_16x16x32_bf16 v[16:19], v[148:151], v[64:67], v[16:19]
    s_lshl_b32 s53, s50, 6
    s_add_u32 s13, s13, s53
    s_add_u32 s14, s13, 1310720
    v_mfma_f32_16x16x32_bf16 v[20:23], v[152:155], v[64:67], v[20:23]
    s_mul_i32 s10, s75, 10
    s_add_u32 s10, s10, s3
    v_mfma_f32_16x16x32_bf16 v[24:27], v[156:159], v[64:67], v[24:27]
    s_mul_i32 s10, s10, 32768
    s_lshl_b32 s53, s74, 6
    s_add_u32 s10, s10, s53
    s_add_u32 s10, s10, 0
    s_waitcnt vmcnt(18)
    v_mfma_f32_16x16x32_bf16 v[28:31], v[140:143], v[68:71], v[28:31]
    s_lshl_b32 s11, s3, 10
    s_add_u32 s11, s11, 81920
    v_lshrrev_b32 v2, 3, v1
    buffer_load_dwordx4 v[64:67], v216, s[36:39], s4 offen offset:3072 sc1
    v_mfma_f32_16x16x32_bf16 v[32:35], v[144:147], v[68:71], v[32:35]
    v_mul_u32_u24 v229, 4096, v2
    v_bfe_u32 v2, v1, 2, 1
    v_mfma_f32_16x16x32_bf16 v[36:39], v[148:151], v[68:71], v[36:39]
    v_lshl_add_u32 v229, v2, 11, v229
    v_and_b32 v2, 3, v1
    v_mfma_f32_16x16x32_bf16 v[40:43], v[152:155], v[68:71], v[40:43]
    v_lshl_add_u32 v229, v2, 4, v229
    v_lshrrev_b32 v3, 2, v1
    v_mfma_f32_16x16x32_bf16 v[44:47], v[156:159], v[68:71], v[44:47]
    s_waitcnt vmcnt(18)
    v_lshlrev_b32 v231, 7, v3
    v_lshl_add_u32 v231, v2, 3, v231
    v_mfma_f32_16x16x32_bf16 v[8:11], v[160:163], v[72:75], v[8:11]
    s_barrier
    s_lshl_b32 s53, s50, 12
    s_lshl_b32 s52, s51, 5
    buffer_load_dwordx4 v[68:71], v217, s[36:39], s4 offen offset:3072 sc1
    v_mfma_f32_16x16x32_bf16 v[12:15], v[164:167], v[72:75], v[12:15]
    s_add_u32 s53, s53, s52
    s_add_u32 s53, s53, 81920
    v_add_u32 v231, s53, v231
    v_mfma_f32_16x16x32_bf16 v[16:19], a[0:3], v[72:75], v[16:19]
    v_and_b32 v2, 15, v1
    v_lshrrev_b32 v3, 4, v1
    v_mfma_f32_16x16x32_bf16 v[20:23], a[4:7], v[72:75], v[20:23]
    v_mul_u32_u24 v2, 1280, v2
    v_lshl_add_u32 v228, v3, 3, v2
    v_mfma_f32_16x16x32_bf16 v[24:27], a[8:11], v[72:75], v[24:27]
    s_waitcnt vmcnt(17)
    v_and_b32 v227, 1, v3
    v_lshl_add_u32 v2, v227, 5, v2
    v_lshrrev_b32 v3, 1, v3
    v_mfma_f32_16x16x32_bf16 v[28:31], v[160:163], v[76:79], v[28:31]
    buffer_load_dwordx4 v[72:75], v216, s[36:39], s5 offen offset:0 sc1
    v_mfma_f32_16x16x32_bf16 v[32:35], v[164:167], v[76:79], v[32:35]
    v_lshl_add_u32 v227, v3, 4, v2
    v_mfma_f32_16x16x32_bf16 v[36:39], a[0:3], v[76:79], v[36:39]
    s_lshr_b32 s50, s74, 1
    s_lshl_b32 s50, s50, 2
    s_add_u32 s50, s50, s3
    s_lshl_b32 s50, s50, 9
    v_mfma_f32_16x16x32_bf16 v[40:43], a[4:7], v[76:79], v[40:43]
    s_add_u32 s50, s50, 121856
    v_min_u32 v246, 3, v1
    v_lshlrev_b32 v246, 7, v246
    v_mfma_f32_16x16x32_bf16 v[44:47], a[8:11], v[76:79], v[44:47]
    s_waitcnt vmcnt(13)
    v_add_u32 v246, s50, v246
    v_min_u32 v2, 23, v1
    v_mfma_f32_16x16x32_bf16 v[8:11], a[12:15], v[80:83], v[8:11]
    buffer_load_dwordx4 v[76:79], v217, s[36:39], s5 offen offset:0 sc1
    v_mfma_f32_16x16x32_bf16 v[12:15], a[16:19], v[80:83], v[12:15]
    v_lshlrev_b32 v244, 4, v2
    v_mov_b32 v3, 36160
    v_mfma_f32_16x16x32_bf16 v[16:19], a[20:23], v[80:83], v[16:19]
    v_cmp_lt_u32 vcc, 11, v2
    s_nop 1
    v_cndmask_b32 v3, 0, v3, vcc
    v_mfma_f32_16x16x32_bf16 v[20:23], a[24:27], v[80:83], v[20:23]
    s_and_b32 s53, s3, 1
    s_lshl_b32 s53, s53, 7
    v_add3_u32 v244, v244, v3, s53
    v_mfma_f32_16x16x32_bf16 v[24:27], a[28:31], v[80:83], v[24:27]
    s_lshl_b32 s15, s3, 10
    s_add_u32 s15, s15, 94208
    v_and_b32 v230, 48, v1
    v_add_u32 v230, s15, v230
    s_waitcnt vmcnt(10)
    v_mfma_f32_16x16x32_bf16 v[28:31], a[12:15], v[84:87], v[28:31]
    s_mov_b32 m0, s15
    buffer_load_dwordx4 v[80:83], v216, s[36:39], s5 offen offset:1024 sc1
    v_mfma_f32_16x16x32_bf16 v[32:35], a[16:19], v[84:87], v[32:35]
    buffer_load_dwordx4 v244, s[36:39], s12 offen sc1 lds
    v_mfma_f32_16x16x32_bf16 v[36:39], a[20:23], v[84:87], v[36:39]
    s_add_u32 m0, s11, 0
    v_mfma_f32_16x16x32_bf16 v[40:43], a[24:27], v[84:87], v[40:43]
    buffer_load_dwordx4 v229, s[36:39], s10 offen sc1 lds
    v_mfma_f32_16x16x32_bf16 v[44:47], a[28:31], v[84:87], v[44:47]
    s_waitcnt vmcnt(12)
    s_add_u32 s10, s10, 131072
    v_mfma_f32_16x16x32_bf16 v[8:11], a[32:35], v[88:91], v[8:11]
    s_barrier
    s_cmp_eq_u32 s3, 0
    s_cbranch_scc0 L_wf29
    s_lshl_b32 s54, s76, 7
    s_add_u32 s54, s54, 23321600
    v_mov_b32 v254, 0
    v_mov_b32 v255, s48
    s_mov_b64 exec, 1
    buffer_store_dword v255, v254, s[36:39], s54 offen sc1
    s_mov_b64 exec, -1
L_wf29:
    s_add_u32 m0, s11, 4096
    v_mfma_f32_16x16x32_bf16 v[12:15], a[36:39], v[88:91], v[12:15]
    buffer_load_dwordx4 v229, s[36:39], s10 offen sc1 lds
    v_mfma_f32_16x16x32_bf16 v[16:19], a[40:43], v[88:91], v[16:19]
    s_add_u32 s10, s10, 131072
    v_mfma_f32_16x16x32_bf16 v[20:23], a[44:47], v[88:91], v[20:23]
    s_add_u32 m0, s11, 8192
    v_mfma_f32_16x16x32_bf16 v[24:27], a[48:51], v[88:91], v[24:27]
    s_waitcnt vmcnt(12)
    buffer_load_dwordx4 v229, s[36:39], s10 offen sc1 lds
    v_mfma_f32_16x16x32_bf16 v[28:31], a[32:35], v[92:95], v[28:31]
    v_mfma_f32_16x16x32_bf16 v[32:35], a[36:39], v[92:95], v[32:35]
    v_mfma_f32_16x16x32_bf16 v[36:39], a[40:43], v[92:95], v[36:39]
    buffer_load_dwordx4 v[84:87], v217, s[36:39], s5 offen offset:1024 sc1
    v_mfma_f32_16x16x32_bf16 v[40:43], a[44:47], v[92:95], v[40:43]
    v_mfma_f32_16x16x32_bf16 v[44:47], a[48:51], v[92:95], v[44:47]
    s_waitcnt vmcnt(13)
    v_mfma_f32_16x16x32_bf16 v[8:11], a[52:55], v[96:99], v[8:11]
    buffer_load_dwordx4 v[88:91], v216, s[36:39], s5 offen offset:2048 sc1
    v_mfma_f32_16x16x32_bf16 v[12:15], a[56:59], v[96:99], v[12:15]
    v_mfma_f32_16x16x32_bf16 v[16:19], a[60:63], v[96:99], v[16:19]
    v_mfma_f32_16x16x32_bf16 v[20:23], a[64:67], v[96:99], v[20:23]
    buffer_load_dwordx4 v[92:95], v217, s[36:39], s5 offen offset:2048 sc1
    v_mfma_f32_16x16x32_bf16 v[24:27], a[68:71], v[96:99], v[24:27]
    s_waitcnt vmcnt(14)
    v_mfma_f32_16x16x32_bf16 v[28:31], a[52:55], v[100:103], v[28:31]
    v_mfma_f32_16x16x32_bf16 v[32:35], a[56:59], v[100:103], v[32:35]
    buffer_load_dwordx4 v[96:99], v216, s[36:39], s5 offen offset:3072 sc1
    v_mfma_f32_16x16x32_bf16 v[36:39], a[60:63], v[100:103], v[36:39]
    v_mfma_f32_16x16x32_bf16 v[40:43], a[64:67], v[100:103], v[40:43]
    v_mfma_f32_16x16x32_bf16 v[44:47], a[68:71], v[100:103], v[44:47]
    s_waitcnt vmcnt(14)
    v_mfma_f32_16x16x32_bf16 v[8:11], a[72:75], v[56:59], v[8:11]
    buffer_load_dwordx4 v[100:103], v217, s[36:39], s5 offen offset:3072 sc1
    v_mfma_f32_16x16x32_bf16 v[12:15], a[76:79], v[56:59], v[12:15]
    v_mfma_f32_16x16x32_bf16 v[16:19], a[80:83], v[56:59], v[16:19]
    v_mfma_f32_16x16x32_bf16 v[20:23], a[84:87], v[56:59], v[20:23]
    v_mfma_f32_16x16x32_bf16 v[24:27], a[88:91], v[56:59], v[24:27]
    s_waitcnt vmcnt(14)
    v_mfma_f32_16x16x32_bf16 v[28:31], a[72:75], v[60:63], v[28:31]
    v_mfma_f32_16x16x32_bf16 v[32:35], a[76:79], v[60:63], v[32:35]
    v_mfma_f32_16x16x32_bf16 v[36:39], a[80:83], v[60:63], v[36:39]
    v_mfma_f32_16x16x32_bf16 v[40:43], a[84:87], v[60:63], v[40:43]
    v_mfma_f32_16x16x32_bf16 v[44:47], a[88:91], v[60:63], v[44:47]
    s_waitcnt vmcnt(13)
    v_mfma_f32_16x16x32_bf16 v[8:11], a[92:95], v[64:67], v[8:11]
    v_mfma_f32_16x16x32_bf16 v[12:15], a[96:99], v[64:67], v[12:15]
    v_mfma_f32_16x16x32_bf16 v[16:19], a[100:103], v[64:67], v[16:19]
    v_mfma_f32_16x16x32_bf16 v[20:23], a[104:107], v[64:67], v[20:23]
    v_mfma_f32_16x16x32_bf16 v[24:27], a[108:111], v[64:67], v[24:27]
    s_waitcnt vmcnt(12)
    v_mfma_f32_16x16x32_bf16 v[28:31], a[92:95], v[68:71], v[28:31]
    v_mfma_f32_16x16x32_bf16 v[32:35], a[96:99], v[68:71], v[32:35]
    v_mfma_f32_16x16x32_bf16 v[36:39], a[100:103], v[68:71], v[36:39]
    v_mfma_f32_16x16x32_bf16 v[40:43], a[104:107], v[68:71], v[40:43]
    v_mfma_f32_16x16x32_bf16 v[44:47], a[108:111], v[68:71], v[44:47]
    s_waitcnt vmcnt(11)
    v_mfma_f32_16x16x32_bf16 v[8:11], a[112:115], v[72:75], v[8:11]
    buffer_load_dword v247, v246, s[36:39], s17 offen sc1
    v_mfma_f32_16x16x32_bf16 v[12:15], a[116:119], v[72:75], v[12:15]
    v_mfma_f32_16x16x32_bf16 v[16:19], a[120:123], v[72:75], v[16:19]
    v_mfma_f32_16x16x32_bf16 v[20:23], a[124:127], v[72:75], v[20:23]
    v_mfma_f32_16x16x32_bf16 v[24:27], a[128:131], v[72:75], v[24:27]
    s_waitcnt vmcnt(6)
    s_barrier
    ds_read_b64_tr_b16 v[180:181], v231 offset:0
    v_mfma_f32_16x16x32_bf16 v[28:31], a[112:115], v[76:79], v[28:31]
    ds_read_b64_tr_b16 v[182:183], v231 offset:2048
    v_mfma_f32_16x16x32_bf16 v[32:35], a[116:119], v[76:79], v[32:35]
    ds_read_b64_tr_b16 v[184:185], v231 offset:4096
    v_mfma_f32_16x16x32_bf16 v[36:39], a[120:123], v[76:79], v[36:39]
    ds_read_b64_tr_b16 v[186:187], v231 offset:64
    v_mfma_f32_16x16x32_bf16 v[40:43], a[124:127], v[76:79], v[40:43]
    ds_read_b64_tr_b16 v[188:189], v231 offset:2112
    v_mfma_f32_16x16x32_bf16 v[44:47], a[128:131], v[76:79], v[44:47]
    ds_read_b64_tr_b16 v[190:191], v231 offset:4160
    v_mfma_f32_16x16x32_bf16 v[8:11], a[132:135], v[80:83], v[8:11]
    ds_read_b128 v[48:51], v230 offset:0
    v_mfma_f32_16x16x32_bf16 v[12:15], a[136:139], v[80:83], v[12:15]
    ds_read_b128 v[52:55], v230 offset:64
    v_mfma_f32_16x16x32_bf16 v[16:19], a[140:143], v[80:83], v[16:19]
    ds_read_b128 v[124:127], v230 offset:128
    v_mfma_f32_16x16x32_bf16 v[20:23], a[144:147], v[80:83], v[20:23]
    ds_read_b128 v[168:171], v230 offset:192
    v_mfma_f32_16x16x32_bf16 v[24:27], a[148:151], v[80:83], v[24:27]
    s_waitcnt vmcnt(5)
    ds_read_b128 v[172:175], v230 offset:256
    v_mfma_f32_16x16x32_bf16 v[28:31], a[132:135], v[84:87], v[28:31]
    ds_read_b128 v[176:179], v230 offset:320
    v_mfma_f32_16x16x32_bf16 v[32:35], a[136:139], v[84:87], v[32:35]
    v_mfma_f32_16x16x32_bf16 v[36:39], a[140:143], v[84:87], v[36:39]
    s_waitcnt lgkmcnt(11)
    v_lshlrev_b32 v204, 16, v180
    s_waitcnt lgkmcnt(2)
    v_mul_f32 v204, v204, v168
    v_mfma_f32_16x16x32_bf16 v[40:43], a[144:147], v[84:87], v[40:43]
    v_and_b32 v205, 0xffff0000, v180
    v_mul_f32 v205, v205, v169
    v_mfma_f32_16x16x32_bf16 v[44:47], a[148:151], v[84:87], v[44:47]
    s_waitcnt vmcnt(4)
    v_lshlrev_b32 v206, 16, v181
    v_mul_f32 v206, v206, v170
    v_mfma_f32_16x16x32_bf16 v[8:11], a[152:155], v[88:91], v[8:11]
    v_and_b32 v207, 0xffff0000, v181
    v_mul_f32 v207, v207, v171
    v_mfma_f32_16x16x32_bf16 v[12:15], a[156:159], v[88:91], v[12:15]
    v_lshlrev_b32 v208, 16, v182
    s_waitcnt lgkmcnt(1)
    v_mul_f32 v208, v208, v172
    v_mfma_f32_16x16x32_bf16 v[16:19], a[160:163], v[88:91], v[16:19]
    v_and_b32 v209, 0xffff0000, v182
    v_mul_f32 v209, v209, v173
    v_mfma_f32_16x16x32_bf16 v[20:23], a[164:167], v[88:91], v[20:23]
    v_lshlrev_b32 v210, 16, v183
    v_mul_f32 v210, v210, v174
    v_mfma_f32_16x16x32_bf16 v[24:27], a[168:171], v[88:91], v[24:27]
    s_waitcnt vmcnt(3)
    v_and_b32 v211, 0xffff0000, v183
    v_mul_f32 v211, v211, v175
    v_mfma_f32_16x16x32_bf16 v[28:31], a[152:155], v[92:95], v[28:31]
    v_lshlrev_b32 v212, 16, v184
    s_waitcnt lgkmcnt(0)
    v_mul_f32 v212, v212, v176
    v_mfma_f32_16x16x32_bf16 v[32:35], a[156:159], v[92:95], v[32:35]
    v_and_b32 v213, 0xffff0000, v184
    v_mul_f32 v213, v213, v177
    v_mfma_f32_16x16x32_bf16 v[36:39], a[160:163], v[92:95], v[36:39]
    v_lshlrev_b32 v214, 16, v185
    v_mul_f32 v214, v214, v178
    v_mfma_f32_16x16x32_bf16 v[40:43], a[164:167], v[92:95], v[40:43]
    v_and_b32 v215, 0xffff0000, v185
    v_mul_f32 v215, v215, v179
    v_mfma_f32_16x16x32_bf16 v[44:47], a[168:171], v[92:95], v[44:47]
    s_waitcnt vmcnt(2)
    v_lshlrev_b32 v232, 16, v186
    v_mul_f32 v232, v232, v168
    v_mfma_f32_16x16x32_bf16 v[8:11], a[172:175], v[96:99], v[8:11]
    s_waitcnt vmcnt(0)
    v_cmp_ne_u32 vcc, s48, v247
    s_cbranch_vccnz L_chk30_slow
L_chk30_back:
    v_and_b32 v233, 0xffff0000, v186
    v_mfma_f32_16x16x32_bf16 v[12:15], a[176:179], v[96:99], v[12:15]
    buffer_load_dwordx4 v[56:59], v218, s[36:39], 0 offen offset:0 sc1
    v_mfma_f32_16x16x32_bf16 v[16:19], a[180:183], v[96:99], v[16:19]
    v_mul_f32 v233, v233, v169
    v_lshlrev_b32 v234, 16, v187
    v_mfma_f32_16x16x32_bf16 v[20:23], a[184:187], v[96:99], v[20:23]
    v_mul_f32 v234, v234, v170
    v_and_b32 v235, 0xffff0000, v187
    v_mfma_f32_16x16x32_bf16 v[24:27], a[188:191], v[96:99], v[24:27]
    buffer_load_dwordx4 v[60:63], v218, s[36:39], 0 offen offset:1024 sc1
    v_mfma_f32_16x16x32_bf16 v[28:31], a[172:175], v[100:103], v[28:31]
    v_mul_f32 v235, v235, v171
    v_lshlrev_b32 v236, 16, v188
    v_mfma_f32_16x16x32_bf16 v[32:35], a[176:179], v[100:103], v[32:35]
    v_mul_f32 v236, v236, v172
    v_and_b32 v237, 0xffff0000, v188
    v_mfma_f32_16x16x32_bf16 v[36:39], a[180:183], v[100:103], v[36:39]
    buffer_load_dwordx4 v[64:67], v218, s[36:39], 0 offen offset:2048 sc1
    v_mfma_f32_16x16x32_bf16 v[40:43], a[184:187], v[100:103], v[40:43]
    ds_write_b128 v220, v[8:11] offset:0
    v_mul_f32 v237, v237, v173
    v_lshlrev_b32 v238, 16, v189
    v_mfma_f32_16x16x32_bf16 v[44:47], a[188:191], v[100:103], v[44:47]
    s_waitcnt vmcnt(2)
    v_mul_f32 v238, v238, v174
    v_and_b32 v239, 0xffff0000, v189
    v_mfma_f32_16x16x32_bf16 v[104:107], a[240:243], v[56:59], 0
    buffer_load_dwordx4 v[68:71], v218, s[36:39], 0 offen offset:3072 sc1
    v_mfma_f32_16x16x32_bf16 v[108:111], a[244:247], v[56:59], 0
    ds_write_b128 v220, v[12:15] offset:1024
    v_mul_f32 v239, v239, v175
    v_lshlrev_b32 v240, 16, v190
    v_mfma_f32_16x16x32_bf16 v[112:115], a[248:251], v[56:59], 0
    v_mul_f32 v240, v240, v176
    v_and_b32 v241, 0xffff0000, v190
    v_mfma_f32_16x16x32_bf16 v[116:119], a[252:255], v[56:59], 0
    buffer_load_dwordx4 v[72:75], v218, s[36:39], s4 offen offset:0 sc1
    v_mfma_f32_16x16x32_bf16 v[120:123], v[136:139], v[56:59], 0
    s_waitcnt vmcnt(3)
    ds_write_b128 v220, v[16:19] offset:2048
    v_mul_f32 v241, v241, v177
    v_lshlrev_b32 v242, 16, v191
    v_mfma_f32_16x16x32_bf16 v[104:107], v[140:143], v[60:63], v[104:107]
    v_mul_f32 v242, v242, v178
    v_and_b32 v243, 0xffff0000, v191
    v_mfma_f32_16x16x32_bf16 v[108:111], v[144:147], v[60:63], v[108:111]
    buffer_load_dwordx4 v[76:79], v218, s[36:39], s4 offen offset:1024 sc1
    v_mfma_f32_16x16x32_bf16 v[112:115], v[148:151], v[60:63], v[112:115]
    ds_write_b128 v220, v[20:23] offset:3072
    v_mul_f32 v243, v243, v179
    v_mfma_f32_16x16x32_bf16 v[116:119], v[152:155], v[60:63], v[116:119]
    v_mfma_f32_16x16x32_bf16 v[120:123], v[156:159], v[60:63], v[120:123]
    s_waitcnt vmcnt(3)
    buffer_load_dwordx4 v[80:83], v218, s[36:39], s4 offen offset:2048 sc1
    v_mfma_f32_16x16x32_bf16 v[104:107], v[160:163], v[64:67], v[104:107]
    ds_write_b128 v220, v[24:27] offset:4096
    v_mfma_f32_16x16x32_bf16 v[108:111], v[164:167], v[64:67], v[108:111]
    v_mfma_f32_16x16x32_bf16 v[112:115], a[0:3], v[64:67], v[112:115]
    ds_write_b128 v221, v[28:31] offset:0
    buffer_load_dwordx4 v[84:87], v218, s[36:39], s4 offen offset:3072 sc1
    v_mfma_f32_16x16x32_bf16 v[116:119], a[4:7], v[64:67], v[116:119]
    v_mfma_f32_16x16x32_bf16 v[120:123], a[8:11], v[64:67], v[120:123]
    s_waitcnt vmcnt(4)
    ds_write_b128 v221, v[32:35] offset:1024
    v_mfma_f32_16x16x32_bf16 v[104:107], a[12:15], v[68:71], v[104:107]
    buffer_load_dwordx4 v[88:91], v218, s[36:39], s5 offen offset:0 sc1
    v_mfma_f32_16x16x32_bf16 v[108:111], a[16:19], v[68:71], v[108:111]
    ds_write_b128 v221, v[36:39] offset:2048
    v_mfma_f32_16x16x32_bf16 v[112:115], a[20:23], v[68:71], v[112:115]
    v_mfma_f32_16x16x32_bf16 v[116:119], a[24:27], v[68:71], v[116:119]
    buffer_load_dwordx4 v[92:95], v218, s[36:39], s5 offen offset:1024 sc1
    v_mfma_f32_16x16x32_bf16 v[120:123], a[28:31], v[68:71], v[120:123]
    s_waitcnt vmcnt(5)
    ds_write_b128 v221, v[40:43] offset:3072
    v_mfma_f32_16x16x32_bf16 v[104:107], a[32:35], v[72:75], v[104:107]
    v_mfma_f32_16x16x32_bf16 v[108:111], a[36:39], v[72:75], v[108:111]
    buffer_load_dwordx4 v[96:99], v218, s[36:39], s5 offen offset:2048 sc1
    v_mfma_f32_16x16x32_bf16 v[112:115], a[40:43], v[72:75], v[112:115]
    ds_write_b128 v221, v[44:47] offset:4096
    v_mfma_f32_16x16x32_bf16 v[116:119], a[44:47], v[72:75], v[116:119]
    v_mfma_f32_16x16x32_bf16 v[120:123], a[48:51], v[72:75], v[120:123]
    s_waitcnt vmcnt(5)
    buffer_load_dwordx4 v[100:103], v218, s[36:39], s5 offen offset:3072 sc1
    v_mfma_f32_16x16x32_bf16 v[104:107], a[52:55], v[76:79], v[104:107]
    v_mfma_f32_16x16x32_bf16 v[108:111], a[56:59], v[76:79], v[108:111]
    v_mfma_f32_16x16x32_bf16 v[112:115], a[60:63], v[76:79], v[112:115]
    buffer_load_dwordx4 v[56:59], v219, s[36:39], 0 offen offset:0 sc1
    v_mfma_f32_16x16x32_bf16 v[116:119], a[64:67], v[76:79], v[116:119]
    v_mfma_f32_16x16x32_bf16 v[120:123], a[68:71], v[76:79], v[120:123]
    s_waitcnt vmcnt(6)
    v_mfma_f32_16x16x32_bf16 v[104:107], a[72:75], v[80:83], v[104:107]
    buffer_load_dwordx4 v[60:63], v219, s[36:39], 0 offen offset:1024 sc1
    v_mfma_f32_16x16x32_bf16 v[108:111], a[76:79], v[80:83], v[108:111]
    s_waitcnt lgkmcnt(0)
    s_barrier
    ds_read_b128 v[168:171], v224 offset:0
    v_mfma_f32_16x16x32_bf16 v[112:115], a[80:83], v[80:83], v[112:115]
    ds_read_b128 v[172:175], v224 offset:1024
    v_mfma_f32_16x16x32_bf16 v[116:119], a[84:87], v[80:83], v[116:119]
    buffer_load_dwordx4 v[64:67], v219, s[36:39], 0 offen offset:2048 sc1
    v_mfma_f32_16x16x32_bf16 v[120:123], a[88:91], v[80:83], v[120:123]
    s_waitcnt vmcnt(7)
    ds_read_b128 v[176:179], v224 offset:2048
    v_mfma_f32_16x16x32_bf16 v[104:107], a[92:95], v[84:87], v[104:107]
    ds_read_b128 v[180:183], v224 offset:5120
    ds_read_b128 v[184:187], v224 offset:6144
    v_mfma_f32_16x16x32_bf16 v[108:111], a[96:99], v[84:87], v[108:111]
    buffer_load_dwordx4 v[68:71], v219, s[36:39], 0 offen offset:3072 sc1
    v_mfma_f32_16x16x32_bf16 v[112:115], a[100:103], v[84:87], v[112:115]
    ds_read_b128 v[188:191], v224 offset:7168
    v_mfma_f32_16x16x32_bf16 v[116:119], a[104:107], v[84:87], v[116:119]
    ds_read_b128 v[192:195], v224 offset:10240
    ds_read_b128 v[196:199], v224 offset:11264
    v_mfma_f32_16x16x32_bf16 v[120:123], a[108:111], v[84:87], v[120:123]
    s_waitcnt vmcnt(7)
    buffer_load_dwordx4 v[72:75], v219, s[36:39], s4 offen offset:0 sc1
    v_mfma_f32_16x16x32_bf16 v[104:107], a[112:115], v[88:91], v[104:107]
    ds_read_b128 v[200:203], v224 offset:12288
    v_mfma_f32_16x16x32_bf16 v[108:111], a[116:119], v[88:91], v[108:111]
    s_waitcnt lgkmcnt(5)
    v_add_f32 v168, v168, v180
    v_add_f32 v169, v169, v181
    v_add_f32 v170, v170, v182
    v_mfma_f32_16x16x32_bf16 v[112:115], a[120:123], v[88:91], v[112:115]
    buffer_load_dwordx4 v[76:79], v219, s[36:39], s4 offen offset:1024 sc1
    v_mfma_f32_16x16x32_bf16 v[116:119], a[124:127], v[88:91], v[116:119]
    v_add_f32 v171, v171, v183
    s_waitcnt lgkmcnt(4)
    v_add_f32 v172, v172, v184
    v_mfma_f32_16x16x32_bf16 v[120:123], a[128:131], v[88:91], v[120:123]
    s_waitcnt vmcnt(8)
    v_add_f32 v173, v173, v185
    v_add_f32 v174, v174, v186
    v_mfma_f32_16x16x32_bf16 v[104:107], a[132:135], v[92:95], v[104:107]
    buffer_load_dwordx4 v[80:83], v219, s[36:39], s4 offen offset:2048 sc1
    v_mfma_f32_16x16x32_bf16 v[108:111], a[136:139], v[92:95], v[108:111]
    v_add_f32 v175, v175, v187
    s_waitcnt lgkmcnt(3)
    v_add_f32 v176, v176, v188
    v_mfma_f32_16x16x32_bf16 v[112:115], a[140:143], v[92:95], v[112:115]
    v_add_f32 v177, v177, v189
    v_add_f32 v178, v178, v190
    v_add_f32 v179, v179, v191
    v_mfma_f32_16x16x32_bf16 v[116:119], a[144:147], v[92:95], v[116:119]
    buffer_load_dwordx4 v[84:87], v219, s[36:39], s4 offen offset:3072 sc1
    v_mfma_f32_16x16x32_bf16 v[120:123], a[148:151], v[92:95], v[120:123]
    s_waitcnt vmcnt(9)
    ds_read_b128 v[180:183], v224 offset:15360
    ds_read_b128 v[184:187], v224 offset:16384
    v_mfma_f32_16x16x32_bf16 v[104:107], a[152:155], v[96:99], v[104:107]
    ds_read_b128 v[188:191], v224 offset:17408
    s_waitcnt lgkmcnt(5)
    v_add_f32 v168, v168, v192
    v_add_f32 v169, v169, v193
    v_mfma_f32_16x16x32_bf16 v[108:111], a[156:159], v[96:99], v[108:111]
    buffer_load_dwordx4 v[88:91], v219, s[36:39], s5 offen offset:0 sc1
    v_mfma_f32_16x16x32_bf16 v[112:115], a[160:163], v[96:99], v[112:115]
    v_add_f32 v170, v170, v194
    v_add_f32 v171, v171, v195
    v_mfma_f32_16x16x32_bf16 v[116:119], a[164:167], v[96:99], v[116:119]
    s_waitcnt lgkmcnt(4)
    v_add_f32 v172, v172, v196
    v_add_f32 v173, v173, v197
    v_mfma_f32_16x16x32_bf16 v[120:123], a[168:171], v[96:99], v[120:123]
    s_waitcnt vmcnt(9)
    buffer_load_dwordx4 v[92:95], v219, s[36:39], s5 offen offset:1024 sc1
    v_mfma_f32_16x16x32_bf16 v[104:107], a[172:175], v[100:103], v[104:107]
    v_add_f32 v174, v174, v198
    v_add_f32 v175, v175, v199
    v_mfma_f32_16x16x32_bf16 v[108:111], a[176:179], v[100:103], v[108:111]
    s_waitcnt lgkmcnt(3)
    v_add_f32 v176, v176, v200
    v_add_f32 v177, v177, v201
    v_add_f32 v178, v178, v202
    v_mfma_f32_16x16x32_bf16 v[112:115], a[180:183], v[100:103], v[112:115]
    buffer_load_dwordx4 v[96:99], v219, s[36:39], s5 offen offset:2048 sc1
    v_mfma_f32_16x16x32_bf16 v[116:119], a[184:187], v[100:103], v[116:119]
    v_add_f32 v179, v179, v203
    s_waitcnt lgkmcnt(2)
    v_add_f32 v168, v168, v180
    v_mfma_f32_16x16x32_bf16 v[120:123], a[188:191], v[100:103], v[120:123]
    s_waitcnt vmcnt(10)
    v_add_f32 v169, v169, v181
    v_add_f32 v170, v170, v182
    v_add_f32 v171, v171, v183
    v_mfma_f32_16x16x32_bf16 v[8:11], a[240:243], v[56:59], 0
    buffer_load_dwordx4 v[100:103], v219, s[36:39], s5 offen offset:3072 sc1
    v_mfma_f32_16x16x32_bf16 v[12:15], a[244:247], v[56:59], 0
    s_waitcnt lgkmcnt(1)
    v_add_f32 v172, v172, v184
    v_add_f32 v173, v173, v185
    v_mfma_f32_16x16x32_bf16 v[16:19], a[248:251], v[56:59], 0
    v_add_f32 v174, v174, v186
    v_add_f32 v175, v175, v187
    v_mfma_f32_16x16x32_bf16 v[20:23], a[252:255], v[56:59], 0
    ds_write_b128 v222, v[104:107] offset:0
    s_waitcnt lgkmcnt(1)
    v_add_f32 v176, v176, v188
    v_add_f32 v177, v177, v189
    v_mfma_f32_16x16x32_bf16 v[24:27], v[136:139], v[56:59], 0
    s_waitcnt vmcnt(10)
    v_add_f32 v178, v178, v190
    v_add_f32 v179, v179, v191
    v_fma_f32 v204, v168, v48, v204
    v_mfma_f32_16x16x32_bf16 v[8:11], v[140:143], v[60:63], v[8:11]
    ds_write_b128 v222, v[108:111] offset:1024
    v_fma_f32 v205, v169, v49, v205
    v_fma_f32 v206, v170, v50, v206
    v_mfma_f32_16x16x32_bf16 v[12:15], v[144:147], v[60:63], v[12:15]
    v_fma_f32 v207, v171, v51, v207
    v_fma_f32 v208, v172, v52, v208
    v_mfma_f32_16x16x32_bf16 v[16:19], v[148:151], v[60:63], v[16:19]
    ds_write_b128 v222, v[112:115] offset:2048
    v_fma_f32 v209, v173, v53, v209
    v_fma_f32 v210, v174, v54, v210
    v_mfma_f32_16x16x32_bf16 v[20:23], v[152:155], v[60:63], v[20:23]
    v_fma_f32 v211, v175, v55, v211
    v_fma_f32 v212, v176, v124, v212
    v_mfma_f32_16x16x32_bf16 v[24:27], v[156:159], v[60:63], v[24:27]
    s_waitcnt vmcnt(9)
    ds_write_b128 v222, v[116:119] offset:3072
    v_fma_f32 v213, v177, v125, v213
    v_fma_f32 v214, v178, v126, v214
    v_mfma_f32_16x16x32_bf16 v[8:11], v[160:163], v[64:67], v[8:11]
    v_fma_f32 v215, v179, v127, v215
    v_cvt_pk_bf16_f32 v180, v204, v205
    v_mfma_f32_16x16x32_bf16 v[12:15], v[164:167], v[64:67], v[12:15]
    v_cvt_pk_bf16_f32 v181, v206, v207
    v_cvt_pk_bf16_f32 v182, v208, v209
    v_mfma_f32_16x16x32_bf16 v[16:19], a[0:3], v[64:67], v[16:19]
    v_cvt_pk_bf16_f32 v183, v210, v211
    v_cvt_pk_bf16_f32 v184, v212, v213
    v_mfma_f32_16x16x32_bf16 v[20:23], a[4:7], v[64:67], v[20:23]
    ds_write_b128 v222, v[120:123] offset:4096
    v_cvt_pk_bf16_f32 v185, v214, v215
    v_mfma_f32_16x16x32_bf16 v[24:27], a[8:11], v[64:67], v[24:27]
    s_waitcnt vmcnt(8)
    v_permlane16_swap_b32 v180, v182
    v_mfma_f32_16x16x32_bf16 v[8:11], a[12:15], v[68:71], v[8:11]
    v_permlane16_swap_b32 v181, v183
    v_mfma_f32_16x16x32_bf16 v[12:15], a[16:19], v[68:71], v[12:15]
    buffer_store_dwordx4 v[180:183], v227, s[40:43], s13 offen nt
    v_mfma_f32_16x16x32_bf16 v[16:19], a[20:23], v[68:71], v[16:19]
    buffer_store_dwordx2 v[184:185], v228, s[40:43], s13 offen offset:64 nt
    v_mfma_f32_16x16x32_bf16 v[20:23], a[24:27], v[68:71], v[20:23]
    v_mfma_f32_16x16x32_bf16 v[24:27], a[28:31], v[68:71], v[24:27]
    s_waitcnt vmcnt(9)
    v_mfma_f32_16x16x32_bf16 v[8:11], a[32:35], v[72:75], v[8:11]
    v_mfma_f32_16x16x32_bf16 v[12:15], a[36:39], v[72:75], v[12:15]
    s_waitcnt lgkmcnt(0)
    s_barrier
    ds_read_b128 v[168:171], v225 offset:0
    v_mfma_f32_16x16x32_bf16 v[16:19], a[40:43], v[72:75], v[16:19]
    ds_read_b128 v[172:175], v225 offset:1024
    v_mfma_f32_16x16x32_bf16 v[20:23], a[44:47], v[72:75], v[20:23]
    ds_read_b128 v[176:179], v225 offset:2048
    v_mfma_f32_16x16x32_bf16 v[24:27], a[48:51], v[72:75], v[24:27]
    s_waitcnt vmcnt(8)
    ds_read_b128 v[192:195], v225 offset:10240
    v_mfma_f32_16x16x32_bf16 v[8:11], a[52:55], v[76:79], v[8:11]
    ds_read_b128 v[196:199], v225 offset:11264
    v_mfma_f32_16x16x32_bf16 v[12:15], a[56:59], v[76:79], v[12:15]
    ds_read_b128 v[200:203], v225 offset:12288
    v_mfma_f32_16x16x32_bf16 v[16:19], a[60:63], v[76:79], v[16:19]
    v_mfma_f32_16x16x32_bf16 v[20:23], a[64:67], v[76:79], v[20:23]
    v_mfma_f32_16x16x32_bf16 v[24:27], a[68:71], v[76:79], v[24:27]
    s_waitcnt vmcnt(7)
    v_mfma_f32_16x16x32_bf16 v[8:11], a[72:75], v[80:83], v[8:11]
    v_mfma_f32_16x16x32_bf16 v[12:15], a[76:79], v[80:83], v[12:15]
    v_mfma_f32_16x16x32_bf16 v[16:19], a[80:83], v[80:83], v[16:19]
    v_mfma_f32_16x16x32_bf16 v[20:23], a[84:87], v[80:83], v[20:23]
    s_waitcnt lgkmcnt(2)
    v_add_f32 v168, v168, v192
    v_add_f32 v169, v169, v193
    v_mfma_f32_16x16x32_bf16 v[24:27], a[88:91], v[80:83], v[24:27]
    s_waitcnt vmcnt(6)
    v_add_f32 v170, v170, v194
    v_add_f32 v171, v171, v195
    v_mfma_f32_16x16x32_bf16 v[8:11], a[92:95], v[84:87], v[8:11]
    s_waitcnt lgkmcnt(1)
    v_add_f32 v172, v172, v196
    v_add_f32 v173, v173, v197
    v_mfma_f32_16x16x32_bf16 v[12:15], a[96:99], v[84:87], v[12:15]
    v_add_f32 v174, v174, v198
    v_add_f32 v175, v175, v199
    v_mfma_f32_16x16x32_bf16 v[16:19], a[100:103], v[84:87], v[16:19]
    s_waitcnt lgkmcnt(0)
    v_add_f32 v176, v176, v200
    v_add_f32 v177, v177, v201
    v_mfma_f32_16x16x32_bf16 v[20:23], a[104:107], v[84:87], v[20:23]
    v_add_f32 v178, v178, v202
    v_add_f32 v179, v179, v203
    v_mfma_f32_16x16x32_bf16 v[24:27], a[108:111], v[84:87], v[24:27]
    s_waitcnt vmcnt(5)
    v_fma_f32 v232, v168, v48, v232
    v_fma_f32 v233, v169, v49, v233
    v_mfma_f32_16x16x32_bf16 v[8:11], a[112:115], v[88:91], v[8:11]
    v_fma_f32 v234, v170, v50, v234
    v_fma_f32 v235, v171, v51, v235
    v_mfma_f32_16x16x32_bf16 v[12:15], a[116:119], v[88:91], v[12:15]
    v_fma_f32 v236, v172, v52, v236
    v_fma_f32 v237, v173, v53, v237
    v_mfma_f32_16x16x32_bf16 v[16:19], a[120:123], v[88:91], v[16:19]
    v_fma_f32 v238, v174, v54, v238
    v_fma_f32 v239, v175, v55, v239
    v_mfma_f32_16x16x32_bf16 v[20:23], a[124:127], v[88:91], v[20:23]
    v_fma_f32 v240, v176, v124, v240
    v_fma_f32 v241, v177, v125, v241
    v_mfma_f32_16x16x32_bf16 v[24:27], a[128:131], v[88:91], v[24:27]
    s_waitcnt vmcnt(4)
    v_fma_f32 v242, v178, v126, v242
    v_fma_f32 v243, v179, v127, v243
    v_mfma_f32_16x16x32_bf16 v[8:11], a[132:135], v[92:95], v[8:11]
    v_mfma_f32_16x16x32_bf16 v[12:15], a[136:139], v[92:95], v[12:15]
    v_mfma_f32_16x16x32_bf16 v[16:19], a[140:143], v[92:95], v[16:19]
    v_mfma_f32_16x16x32_bf16 v[20:23], a[144:147], v[92:95], v[20:23]
    v_mfma_f32_16x16x32_bf16 v[24:27], a[148:151], v[92:95], v[24:27]
    s_waitcnt vmcnt(3)
    v_mfma_f32_16x16x32_bf16 v[8:11], a[152:155], v[96:99], v[8:11]
    v_mfma_f32_16x16x32_bf16 v[12:15], a[156:159], v[96:99], v[12:15]
    v_mfma_f32_16x16x32_bf16 v[16:19], a[160:163], v[96:99], v[16:19]
    v_mfma_f32_16x16x32_bf16 v[20:23], a[164:167], v[96:99], v[20:23]
    v_mfma_f32_16x16x32_bf16 v[24:27], a[168:171], v[96:99], v[24:27]
    s_waitcnt vmcnt(2)
    v_mfma_f32_16x16x32_bf16 v[8:11], a[172:175], v[100:103], v[8:11]
    v_mfma_f32_16x16x32_bf16 v[12:15], a[176:179], v[100:103], v[12:15]
    v_mfma_f32_16x16x32_bf16 v[16:19], a[180:183], v[100:103], v[16:19]
    v_mfma_f32_16x16x32_bf16 v[20:23], a[184:187], v[100:103], v[20:23]
    v_mfma_f32_16x16x32_bf16 v[24:27], a[188:191], v[100:103], v[24:27]
    s_nop 3
    ds_write_b128 v223, v[8:11] offset:0
    ds_write_b128 v223, v[12:15] offset:1024
    ds_write_b128 v223, v[16:19] offset:2048
    ds_write_b128 v223, v[20:23] offset:3072
    ds_write_b128 v223, v[24:27] offset:4096
    s_waitcnt lgkmcnt(0)
    s_barrier
    ds_read_b128 v[168:171], v226 offset:0
    ds_read_b128 v[172:175], v226 offset:1024
    ds_read_b128 v[176:179], v226 offset:2048
    ds_read_b128 v[180:183], v226 offset:10240
    ds_read_b128 v[184:187], v226 offset:11264
    ds_read_b128 v[188:191], v226 offset:12288
    s_waitcnt lgkmcnt(2)
    v_pk_add_f32 v[168:169], v[168:169], v[180:181]
    v_pk_add_f32 v[170:171], v[170:171], v[182:183]
    s_waitcnt lgkmcnt(1)
    v_pk_add_f32 v[172:173], v[172:173], v[184:185]
    v_pk_add_f32 v[174:175], v[174:175], v[186:187]
    s_waitcnt lgkmcnt(0)
    v_pk_add_f32 v[176:177], v[176:177], v[188:189]
    v_pk_add_f32 v[178:179], v[178:179], v[190:191]
    v_pk_fma_f32 v[232:233], v[168:169], v[48:49], v[232:233]
    v_pk_fma_f32 v[234:235], v[170:171], v[50:51], v[234:235]
    v_pk_fma_f32 v[236:237], v[172:173], v[52:53], v[236:237]
    v_pk_fma_f32 v[238:239], v[174:175], v[54:55], v[238:239]
    v_pk_fma_f32 v[240:241], v[176:177], v[124:125], v[240:241]
    v_pk_fma_f32 v[242:243], v[178:179], v[126:127], v[242:243]
    v_cvt_pk_bf16_f32 v168, v232, v233
    v_cvt_pk_bf16_f32 v169, v234, v235
    v_cvt_pk_bf16_f32 v170, v236, v237
    v_cvt_pk_bf16_f32 v171, v238, v239
    v_cvt_pk_bf16_f32 v172, v240, v241
    v_cvt_pk_bf16_f32 v173, v242, v243
    v_permlane16_swap_b32 v168, v170
    v_permlane16_swap_b32 v169, v171
    buffer_store_dwordx4 v[168:171], v227, s[40:43], s14 offen nt
    buffer_store_dwordx2 v[172:173], v228, s[40:43], s14 offen offset:64 nt
    s_endpgm
L_end:
    s_endpgm
L_m_slow:
    buffer_load_dwordx2 v[232:233], v253, s[36:39], s55 offen sc1
    s_waitcnt vmcnt(0)
    v_cmp_ne_u32 vcc, s48, v233
    s_cbranch_vccz L_m_back
    s_cmp_eq_u32 s49, 0
    s_cbranch_scc1 L_m_back
    s_sub_u32 s49, s49, 1
    s_sleep 1
    s_branch L_m_slow
L_stc0_slow:
    s_add_u32 m0, s63, 1024
    s_nop 0
    buffer_load_dwordx4 v248, s[36:39], s6 offen sc1 lds
    s_waitcnt vmcnt(0)
    ds_read_b128 v[200:203], v175 offset:1024
    ds_read_b128 v[204:207], v175 offset:1280
    ds_read_b128 v[208:211], v175 offset:1536
    ds_read_b128 v[212:215], v175 offset:1792
    s_waitcnt lgkmcnt(3)
    v_xor_b32 v3, s48, v201
    v_bitop3_b32 v3, v203, s48, v3 bitop3:0xbe
    s_waitcnt lgkmcnt(2)
    v_bitop3_b32 v3, v205, s48, v3 bitop3:0xbe
    v_bitop3_b32 v3, v207, s48, v3 bitop3:0xbe
    s_waitcnt lgkmcnt(1)
    v_bitop3_b32 v3, v209, s48, v3 bitop3:0xbe
    v_bitop3_b32 v3, v211, s48, v3 bitop3:0xbe
    s_waitcnt lgkmcnt(0)
    v_bitop3_b32 v3, v213, s48, v3 bitop3:0xbe
    v_bitop3_b32 v3, v215, s48, v3 bitop3:0xbe
    v_cmp_ne_u32 vcc, 0, v3
    s_cbranch_vccz L_stc0_back
    s_cmp_eq_u32 s49, 0
    s_cbranch_scc1 L_stc0_back
    s_sub_u32 s49, s49, 1
    s_branch L_stc0_slow
L_stc1_slow:
    s_add_u32 m0, s63, 1024
    s_nop 0
    buffer_load_dwordx4 v248, s[36:39], s6 offen sc1 lds
    s_waitcnt vmcnt(0)
    ds_read_b128 v[200:203], v175 offset:1024
    ds_read_b128 v[204:207], v175 offset:1280
    ds_read_b128 v[208:211], v175 offset:1536
    ds_read_b128 v[212:215], v175 offset:1792
    s_waitcnt lgkmcnt(3)
    v_xor_b32 v3, s48, v201
    v_bitop3_b32 v3, v203, s48, v3 bitop3:0xbe
    s_waitcnt lgkmcnt(2)
    v_bitop3_b32 v3, v205, s48, v3 bitop3:0xbe
    v_bitop3_b32 v3, v207, s48, v3 bitop3:0xbe
    s_waitcnt lgkmcnt(1)
    v_bitop3_b32 v3, v209, s48, v3 bitop3:0xbe
    v_bitop3_b32 v3, v211, s48, v3 bitop3:0xbe
    s_waitcnt lgkmcnt(0)
    v_bitop3_b32 v3, v213, s48, v3 bitop3:0xbe
    v_bitop3_b32 v3, v215, s48, v3 bitop3:0xbe
    v_cmp_ne_u32 vcc, 0, v3
    s_cbranch_vccz L_stc1_back
    s_cmp_eq_u32 s49, 0
    s_cbranch_scc1 L_stc1_back
    s_sub_u32 s49, s49, 1
    s_branch L_stc1_slow
L_stp0_slow:
    s_add_u32 m0, s63, 1024
    s_nop 0
    buffer_load_dwordx4 v248, s[36:39], s6 offen sc1 lds
    s_waitcnt vmcnt(0)
    ds_read_b128 v[200:203], v175 offset:1024
    ds_read_b128 v[204:207], v175 offset:1280
    ds_read_b128 v[208:211], v175 offset:1536
    ds_read_b128 v[212:215], v175 offset:1792
    s_waitcnt lgkmcnt(3)
    v_xor_b32 v3, s48, v201
    v_bitop3_b32 v3, v203, s48, v3 bitop3:0xbe
    s_waitcnt lgkmcnt(2)
    v_bitop3_b32 v3, v205, s48, v3 bitop3:0xbe
    v_bitop3_b32 v3, v207, s48, v3 bitop3:0xbe
    s_waitcnt lgkmcnt(1)
    v_bitop3_b32 v3, v209, s48, v3 bitop3:0xbe
    v_bitop3_b32 v3, v211, s48, v3 bitop3:0xbe
    s_waitcnt lgkmcnt(0)
    v_bitop3_b32 v3, v213, s48, v3 bitop3:0xbe
    v_bitop3_b32 v3, v215, s48, v3 bitop3:0xbe
    v_cmp_ne_u32 vcc, 0, v3
    s_cbranch_vccz L_stp0_back
    s_cmp_eq_u32 s49, 0
    s_cbranch_scc1 L_stp0_back
    s_sub_u32 s49, s49, 1
    s_branch L_stp0_slow
L_stp1_slow:
    s_add_u32 m0, s63, 1024
    s_nop 0
    buffer_load_dwordx4 v248, s[36:39], s6 offen sc1 lds
    s_waitcnt vmcnt(0)
    ds_read_b128 v[200:203], v175 offset:1024
    ds_read_b128 v[204:207], v175 offset:1280
    ds_read_b128 v[208:211], v175 offset:1536
    ds_read_b128 v[212:215], v175 offset:1792
    s_waitcnt lgkmcnt(3)
    v_xor_b32 v3, s48, v201
    v_bitop3_b32 v3, v203, s48, v3 bitop3:0xbe
    s_waitcnt lgkmcnt(2)
    v_bitop3_b32 v3, v205, s48, v3 bitop3:0xbe
    v_bitop3_b32 v3, v207, s48, v3 bitop3:0xbe
    s_waitcnt lgkmcnt(1)
    v_bitop3_b32 v3, v209, s48, v3 bitop3:0xbe
    v_bitop3_b32 v3, v211, s48, v3 bitop3:0xbe
    s_waitcnt lgkmcnt(0)
    v_bitop3_b32 v3, v213, s48, v3 bitop3:0xbe
    v_bitop3_b32 v3, v215, s48, v3 bitop3:0xbe
    v_cmp_ne_u32 vcc, 0, v3
    s_cbranch_vccz L_stp1_back
    s_cmp_eq_u32 s49, 0
    s_cbranch_scc1 L_stp1_back
    s_sub_u32 s49, s49, 1
    s_branch L_stp1_slow
L_chk4_slow:
L_poll31:
    buffer_load_dword v243, v240, s[36:39], s69 offen sc1
    s_waitcnt vmcnt(0)
    v_cmp_ne_u32 vcc, s48, v243
    s_cbranch_vccz L_poll31_ok
    s_cmp_eq_u32 s49, 0
    s_cbranch_scc1 L_poll31_ok
    s_sub_u32 s49, s49, 1
    s_sleep 1
    s_branch L_poll31
L_poll31_ok:
    s_branch L_chk4_back
L_chk6_slow:
L_poll32:
    buffer_load_dword v243, v241, s[36:39], s60 offen sc1
    s_waitcnt vmcnt(0)
    v_cmp_ne_u32 vcc, s48, v243
    s_cbranch_vccz L_poll32_ok
    s_cmp_eq_u32 s49, 0
    s_cbranch_scc1 L_poll32_ok
    s_sub_u32 s49, s49, 1
    s_sleep 1
    s_branch L_poll32
L_poll32_ok:
    s_branch L_chk6_back
L_chk7_slow:
L_poll33:
    buffer_load_dword v223, v219, s[36:39], s17 offen sc1
    s_waitcnt vmcnt(0)
    v_cmp_ne_u32 vcc, s48, v223
    s_cbranch_vccz L_poll33_ok
    s_cmp_eq_u32 s49, 0
    s_cbranch_scc1 L_poll33_ok
    s_sub_u32 s49, s49, 1
    s_sleep 1
    s_branch L_poll33
L_poll33_ok:
    s_branch L_chk7_back
L_chk9_slow:
L_poll34:
    buffer_load_dword v244, v243, s[36:39], s58 offen sc1
    s_waitcnt vmcnt(0)
    v_cmp_ne_u32 vcc, s48, v244
    s_cbranch_vccz L_poll34_ok
    s_cmp_eq_u32 s49, 0
    s_cbranch_scc1 L_poll34_ok
    s_sub_u32 s49, s49, 1
    s_sleep 1
    s_branch L_poll34
L_poll34_ok:
    s_branch L_chk9_back
L_chk10_slow:
L_poll35:
    buffer_load_dword v240, v219, s[36:39], s17 offen sc1
    s_waitcnt vmcnt(0)
    v_cmp_ne_u32 vcc, s48, v240
    s_cbranch_vccz L_poll35_ok
    s_cmp_eq_u32 s49, 0
    s_cbranch_scc1 L_poll35_ok
    s_sub_u32 s49, s49, 1
    s_sleep 1
    s_branch L_poll35
L_poll35_ok:
    s_branch L_chk10_back
L_chk12_slow:
L_poll36:
    buffer_load_dword v247, v246, s[36:39], s17 offen sc1
    s_waitcnt vmcnt(0)
    v_cmp_ne_u32 vcc, s48, v247
    s_cbranch_vccz L_poll36_ok
    s_cmp_eq_u32 s49, 0
    s_cbranch_scc1 L_poll36_ok
    s_sub_u32 s49, s49, 1
    s_sleep 1
    s_branch L_poll36
L_poll36_ok:
    s_branch L_chk12_back
L_chk14_slow:
L_poll37:
    buffer_load_dword v247, v246, s[36:39], s17 offen sc1
    s_waitcnt vmcnt(0)
    v_cmp_ne_u32 vcc, s48, v247
    s_cbranch_vccz L_poll37_ok
    s_cmp_eq_u32 s49, 0
    s_cbranch_scc1 L_poll37_ok
    s_sub_u32 s49, s49, 1
    s_sleep 1
    s_branch L_poll37
L_poll37_ok:
    s_branch L_chk14_back
L_chk20_slow:
L_poll38:
    buffer_load_dword v241, v240, s[36:39], s66 offen sc1
    s_waitcnt vmcnt(0)
    v_cmp_ne_u32 vcc, s48, v241
    s_cbranch_vccz L_poll38_ok
    s_cmp_eq_u32 s49, 0
    s_cbranch_scc1 L_poll38_ok
    s_sub_u32 s49, s49, 1
    s_sleep 1
    s_branch L_poll38
L_poll38_ok:
    s_branch L_chk20_back
L_chk25_slow:
L_poll39:
    buffer_load_dword v244, v243, s[36:39], s58 offen sc1
    s_waitcnt vmcnt(0)
    v_cmp_ne_u32 vcc, s48, v244
    s_cbranch_vccz L_poll39_ok
    s_cmp_eq_u32 s49, 0
    s_cbranch_scc1 L_poll39_ok
    s_sub_u32 s49, s49, 1
    s_sleep 1
    s_branch L_poll39
L_poll39_ok:
    s_branch L_chk25_back
L_chk26_slow:
L_poll40:
    buffer_load_dword v240, v219, s[36:39], s17 offen sc1
    s_waitcnt vmcnt(0)
    v_cmp_ne_u32 vcc, s48, v240
    s_cbranch_vccz L_poll40_ok
    s_cmp_eq_u32 s49, 0
    s_cbranch_scc1 L_poll40_ok
    s_sub_u32 s49, s49, 1
    s_sleep 1
    s_branch L_poll40
L_poll40_ok:
    s_branch L_chk26_back
L_chk28_slow:
L_poll41:
    buffer_load_dword v247, v246, s[36:39], s17 offen sc1
    s_waitcnt vmcnt(0)
    v_cmp_ne_u32 vcc, s48, v247
    s_cbranch_vccz L_poll41_ok
    s_cmp_eq_u32 s49, 0
    s_cbranch_scc1 L_poll41_ok
    s_sub_u32 s49, s49, 1
    s_sleep 1
    s_branch L_poll41
L_poll41_ok:
    s_branch L_chk28_back
L_chk30_slow:
L_poll42:
    buffer_load_dword v247, v246, s[36:39], s17 offen sc1
    s_waitcnt vmcnt(0)
    v_cmp_ne_u32 vcc, s48, v247
    s_cbranch_vccz L_poll42_ok
    s_cmp_eq_u32 s49, 0
    s_cbranch_scc1 L_poll42_ok
    s_sub_u32 s49, s49, 1
    s_sleep 1
    s_branch L_poll42
L_poll42_ok:
    s_branch L_chk30_back
L_code_end:
.if L_code_end-L_pc0 > 98304
.error "the code prefetch does not cover the kernel"
.endif
.section .rodata,"a"
.p2align 6
.amdhsa_kernel adaLN_cond__ssm_conv_h3__glu_gated_bilinear__prompt_kernel
  .amdhsa_next_free_vgpr 512
  .amdhsa_next_free_sgpr 102
  .amdhsa_accum_offset 256
  .amdhsa_group_segment_fixed_size 0
  .amdhsa_kernarg_size 120
  .amdhsa_user_sgpr_count 2
  .amdhsa_user_sgpr_kernarg_segment_ptr 1
  .amdhsa_system_sgpr_workgroup_id_x 1
.end_amdhsa_kernel
```
